```python
import torch

def _softmax(x, axis=-1):
    return torch.softmax(x, dim=axis)

def _gelu(x):
    return torch.nn.functional.gelu(x, approximate='tanh')

def _silu(x):
    return torch.nn.functional.silu(x)

def _sigmoid(x):
    return torch.sigmoid(x)

def _layernorm(x, axis=-1, eps=1e-05):
    m = x.mean(dim=axis, keepdim=True)
    v = x.var(dim=axis, keepdim=True, unbiased=False)
    return (x - m) / torch.sqrt(v + eps)

def _scatter_add(tgt, idx, src, axis=0):
    return tgt.clone().index_add_(axis, idx, src)

def _segment_sum(src, seg, n):
    out = torch.zeros((n,) + src.shape[1:], dtype=src.dtype)
    return out.index_add_(0, seg, src)

def _pad(x, pw):
    flat = tuple((v for pair in reversed(pw) for v in pair))
    return torch.nn.functional.pad(x, flat)
kernel_name = 'adaLN_cond__compressed_kv_cla__mixer_channel_mlp__prompt'

def setup_inputs():

    _w = lambda a: (lambda t: t.to(torch.bfloat16) if t.is_floating_point() else t)(torch.as_tensor(a))

    def _A_setup():
        B, H, Sq, Sk, D, M = (1, 32, 2048, 2048, 128, 512)
        Dc = 4 * D
        return {'x': _w((lambda *s: torch.randn(*s, dtype=torch.bfloat16) * 0.05)(B, Sq, M)), 'c_kv': _w((lambda *s: torch.randn(*s, dtype=torch.bfloat16) * 0.4)(B, Sk, Dc)), 'w_q': _w((lambda *s: torch.randn(*s, dtype=torch.bfloat16) * 3.2)(M, H, D) * M ** (-0.5)), 'w_uk': _w((lambda *s: torch.randn(*s, dtype=torch.bfloat16) * 3.2)(Dc, H, D) * Dc ** (-0.5)), 'w_uv': _w((lambda *s: torch.randn(*s, dtype=torch.bfloat16) * 0.4)(Dc, H, D) * Dc ** (-0.5)), 'w_o': _w((lambda *s: torch.randn(*s, dtype=torch.bfloat16) * 0.4)(H, D, M) * (H * D) ** (-0.5))}
    _A_in = _A_setup()

    def _B_setup():
        B, S, D, F = (1, 2048, 512, 1376)
        return {'x': _w((lambda *s: torch.randn(*s, dtype=torch.bfloat16) * 0.05)(B, S, D)), 'w1': _w((lambda *s: torch.randn(*s, dtype=torch.bfloat16) * 3.2)(D, F) * D ** (-0.5)), 'b1': _w((lambda *s: torch.randn(*s, dtype=torch.bfloat16) * 0.8)(F)), 'w2': _w((lambda *s: torch.randn(*s, dtype=torch.bfloat16) * 0.05)(F, D) * F ** (-0.5)), 'b2': _w((lambda *s: torch.randn(*s, dtype=torch.bfloat16) * 0.1)(D))}
    _B_in = _B_setup()
    return {'A_x': _A_in['x'], 'A_c_kv': _A_in['c_kv'], 'A_w_q': _A_in['w_q'], 'A_w_uk': _A_in['w_uk'], 'A_w_uv': _A_in['w_uv'], 'A_w_o': _A_in['w_o'], 'B_x': _B_in['x'], 'B_w1': _B_in['w1'], 'B_b1': _B_in['b1'], 'B_w2': _B_in['w2'], 'B_b2': _B_in['b2'], 'c': _w((lambda *s: torch.randn(*s, dtype=torch.bfloat16) * 0.1)(1, 512) * 8.0), 'w_mod': _w((lambda *s: torch.randn(*s, dtype=torch.bfloat16) * 0.1)(512, 6 * 512) * 512 ** (-0.5) * 8.0)}

def reference(A_x, A_c_kv, A_w_q, A_w_uk, A_w_uv, A_w_o, B_x, B_w1, B_b1, B_w2, B_b2, c, w_mod):

    def _A_ref(x, c_kv, w_q, w_uk, w_uv, w_o):
        B, Sq, M = (x.shape[0], x.shape[1], x.shape[2])
        Sk = c_kv.shape[1]
        H, D = (w_q.shape[1], w_q.shape[2])
        q = torch.einsum('bqm,mhd->bhqd', x, w_q)
        k = torch.einsum('bkc,chd->bhkd', c_kv, w_uk)
        v = torch.einsum('bkc,chd->bhkd', c_kv, w_uv)
        scores = torch.einsum('bhqd,bhkd->bhqk', q, k) * D ** (-0.5)
        off = Sk - Sq
        qi = torch.arange(Sq)[:, None]
        kj = torch.arange(Sk)[None, :]
        cmask = kj <= qi + off
        scores = torch.where(cmask[None, None], scores, -1000000000.0)
        p = _softmax(scores, axis=-1)
        ctx = torch.einsum('bhqk,bhkd->bhqd', p, v)
        return torch.einsum('bhqd,hdm->bqm', ctx, w_o)

    def _B_ref(x, w1, b1, w2, b2):
        y = _layernorm(x, axis=-1)
        h = _gelu(torch.einsum('bsd,df->bsf', y, w1) + b1)
        return torch.einsum('bsf,fd->bsd', h, w2) + b2
    x = A_x
    mod = (_silu(c) @ w_mod).reshape(c.shape[0], 6, 1, -1)
    sa, ca, ga, sb, cb, gb = (mod[:, 0].clone(), mod[:, 1].clone(), mod[:, 2].clone(), mod[:, 3].clone(), mod[:, 4].clone(), mod[:, 5].clone())
    h = _layernorm(x, axis=-1) * (1 + ca) + sa
    x = x + ga * _A_ref(h, A_c_kv, A_w_q, A_w_uk, A_w_uv, A_w_o)
    h = _layernorm(x, axis=-1) * (1 + cb) + sb
    x = x + gb * _B_ref(h, B_w1, B_b1, B_w2, B_b2)
    return x
```

```asm
; @launch grid=(256,1,1) block=(256,1,1) lds=163840
.amdgcn_target "amdgcn-amd-amdhsa--gfx950"
.text
.globl adaLN_cond__compressed_kv_cla__mixer_channel_mlp__prompt_kernel
.p2align 8
.type adaLN_cond__compressed_kv_cla__mixer_channel_mlp__prompt_kernel,@function
adaLN_cond__compressed_kv_cla__mixer_channel_mlp__prompt_kernel:
  s_cmp_ge_u32 s2, 256
  s_cbranch_scc1 adaLN_cond__compressed_kv_cla__mixer_channel_mlp__prompt_kernel_end
  s_load_dwordx16 s[64:79], s[0:1], 0
  s_load_dwordx16 s[80:95], s[0:1], 64
  v_lshrrev_b32 v2, 6, v0
  v_and_b32 v1, 63, v0
  v_readfirstlane_b32 s40, v2
  s_and_b32 s43, s2, 7
  s_lshr_b32 s44, s2, 3
  s_and_b32 s44, s44, 3
  s_lshl_b32 s41, s43, 2
  s_add_u32 s41, s41, s44
  s_lshr_b32 s42, s2, 5
  v_lshlrev_b32 v2, 4, v1
  s_getpc_b64 s[24:25]
Lpc1:
  s_add_u32 s24, s24, Lstart - Lpc1
  s_addc_u32 s25, s25, 0
  s_and_b32 s25, s25, 0xffff
  s_mov_b32 s26, Lattn - Lstart
  s_mov_b32 s27, 0x20000
  s_lshr_b32 s4, s2, 3
  s_lshl_b32 s4, s4, 2
  s_add_u32 s4, s4, s40
  v_and_b32 v0, 1, v1
  v_lshlrev_b32 v0, 14, v0
  v_bfe_u32 v3, v1, 1, 1
  v_lshl_add_u32 v0, v3, 15, v0
  s_lshl_b32 s4, s4, 7
  v_add_u32 v0, s4, v0
Lstart:
  buffer_load_dword v63, v0, s[24:27], 0 offen
  s_lshl_b32 s33, s42, 18
  s_lshl_b32 s4, s40, 16
  s_add_u32 s33, s33, s4
  s_lshl_b32 s34, s40, 17
  s_lshl_b32 s4, s41, 8
  s_add_u32 s34, s34, s4
  s_lshl_b32 s35, s40, 13
  s_lshl_b32 s36, s40, 12
  s_lshl_b32 s38, s44, 1
  s_add_u32 s38, s38, s42
  s_and_b32 s38, s38, 0
  v_lshrrev_b32 v24, 3, v1
  v_lshrrev_b32 v25, 4, v1
  v_and_b32 v26, 7, v1
  v_and_b32 v27, 15, v1
  v_add_u32 v28, 0, v25
  v_xor_b32 v28, v28, v26
  v_lshlrev_b32 v28, 4, v28
  v_lshl_add_u32 v28, v24, 10, v28
  v_add_u32 v4, 0, v28
  v_or_b32 v28, 0, v25
  v_lshlrev_b32 v28, 1, v28
  v_xor_b32 v28, v28, v27
  v_lshlrev_b32 v28, 4, v28
  v_lshl_add_u32 v28, v25, 13, v28
  v_add_u32 v8, 0, v28
  v_add_u32 v28, 4, v25
  v_xor_b32 v28, v28, v26
  v_lshlrev_b32 v28, 4, v28
  v_lshl_add_u32 v28, v24, 10, v28
  v_add_u32 v5, 7168, v28
  v_or_b32 v28, 0, v25
  v_lshlrev_b32 v28, 1, v28
  v_xor_b32 v28, v28, v27
  v_lshlrev_b32 v28, 4, v28
  v_lshl_add_u32 v28, v25, 13, v28
  v_add_u32 v9, 31744, v28
  v_add_u32 v28, 0, v25
  v_xor_b32 v28, v28, v26
  v_lshlrev_b32 v28, 4, v28
  v_lshl_add_u32 v28, v24, 10, v28
  v_add_u32 v6, 14336, v28
  v_or_b32 v28, 4, v25
  v_lshlrev_b32 v28, 1, v28
  v_xor_b32 v28, v28, v27
  v_lshlrev_b32 v28, 4, v28
  v_lshl_add_u32 v28, v25, 13, v28
  v_add_u32 v10, 63488, v28
  v_add_u32 v28, 4, v25
  v_xor_b32 v28, v28, v26
  v_lshlrev_b32 v28, 4, v28
  v_lshl_add_u32 v28, v24, 10, v28
  v_add_u32 v7, 21504, v28
  v_or_b32 v28, 4, v25
  v_lshlrev_b32 v28, 1, v28
  v_xor_b32 v28, v28, v27
  v_lshlrev_b32 v28, 4, v28
  v_lshl_add_u32 v28, v25, 13, v28
  v_add_u32 v11, 95232, v28
  s_waitcnt lgkmcnt(0)
  s_mov_b32 s8, s66
  s_and_b32 s9, s67, 0xffff
  s_mov_b32 s10, 2097152
  s_mov_b32 s11, 0x20000
  s_mov_b32 s12, s70
  s_and_b32 s13, s71, 0xffff
  s_mov_b32 s14, 4194304
  s_mov_b32 s15, 0x20000
  s_mov_b32 s20, s94
  s_and_b32 s21, s95, 0xffff
  s_mov_b32 s22, 268435456
  s_mov_b32 s23, 0x20000
  s_cmp_lg_u32 s40, 0
  s_cbranch_scc1 Lzf2
  s_cmp_ge_u32 s2, 8
  s_cbranch_scc1 Lzf2
  s_lshl_b32 s4, s2, 13
  s_add_u32 s4, s4, 65011712
  v_lshlrev_b32 v28, 7, v1
  v_mov_b32 v120, 0
  v_mov_b32 v121, 0
  v_mov_b32 v122, 0
  v_mov_b32 v123, 0
  buffer_store_dwordx4 v[120:123], v28, s[20:23], s4 offen sc1
Lzf2:
  s_add_u32 m0, s36, 32768
  s_add_u32 s51, s34, 0
  buffer_load_dwordx4 v8, s[12:15], s51 offen offset:0 nt lds
  buffer_load_dwordx4 v9, s[12:15], s51 offen offset:1024 nt lds
  buffer_load_dwordx4 v10, s[12:15], s51 offen offset:2048 nt lds
  buffer_load_dwordx4 v11, s[12:15], s51 offen offset:3072 nt lds
  s_add_u32 m0, s35, 0
  s_add_u32 s50, s33, 0
  buffer_load_dwordx4 v4, s[8:11], s50 offen offset:0 lds
  buffer_load_dwordx4 v5, s[8:11], s50 offen offset:1024 lds
  buffer_load_dwordx4 v6, s[8:11], s50 offen offset:2048 lds
  buffer_load_dwordx4 v7, s[8:11], s50 offen offset:3072 lds
  s_add_u32 m0, s35, 4096
  s_add_u32 s50, s50, 32768
  buffer_load_dwordx4 v4, s[8:11], s50 offen offset:0 lds
  buffer_load_dwordx4 v5, s[8:11], s50 offen offset:1024 lds
  buffer_load_dwordx4 v6, s[8:11], s50 offen offset:2048 lds
  buffer_load_dwordx4 v7, s[8:11], s50 offen offset:3072 lds
  s_mov_b32 s28, s88
  s_and_b32 s29, s89, 0xffff
  s_mov_b32 s30, 3145728
  s_mov_b32 s31, 0x20000
  s_mov_b32 s16, s86
  s_and_b32 s17, s87, 0xffff
  s_mov_b32 s18, 1024
  s_mov_b32 s19, 0x20000
  s_mov_b32 s24, s64
  s_and_b32 s25, s65, 0xffff
  s_mov_b32 s26, 2097152
  s_mov_b32 s27, 0x20000
  s_cmp_lt_u32 s2, 192
  s_cselect_b32 s30, s30, 0
  s_lshl_b32 s54, s42, 3
  s_add_u32 s54, s54, s43
  s_lshl_b32 s4, s44, 2
  s_add_u32 s4, s4, s40
  s_lshl_b32 s5, s4, 6
  s_mul_i32 s4, s4, 196608
  s_lshl_b32 s6, s54, 7
  s_add_u32 s6, s6, s4
  v_mul_u32_u24 v15, 6144, v24
  v_lshl_add_u32 v15, v26, 4, v15
  v_lshlrev_b32 v14, 1, v24
  s_mov_b32 s7, s5
  v_lshlrev_b32 v3, 10, v26
  v_lshl_add_u32 v3, v24, 4, v3
  s_lshl_b32 s52, s2, 13
  s_lshl_b32 s4, s40, 8
  s_add_u32 s52, s52, s4
  s_lshl_b32 s37, s41, 19
  s_lshl_b32 s4, s42, 16
  s_add_u32 s37, s37, s4
  s_lshl_b32 s4, s40, 14
  s_add_u32 s37, s37, s4
  v_bfe_u32 v28, v1, 1, 3
  v_xor_b32 v28, v28, v25
  v_lshlrev_b32 v29, 7, v27
  v_add_u32 v29, s35, v29
  v_lshl_add_u32 v12, v28, 4, v29
  v_xor_b32 v28, 4, v28
  v_lshl_add_u32 v13, v28, 4, v29
  v_bfe_u32 v28, v1, 2, 2
  v_lshl_add_u32 v29, v25, 3, v28
  v_lshlrev_b32 v29, 8, v29
  v_and_b32 v30, 3, v1
  v_lshl_add_u32 v29, v30, 3, v29
  v_bfe_u32 v30, v1, 4, 1
  v_lshl_or_b32 v28, v30, 2, v28
  v_xor_b32 v30, 0, v28
  v_lshl_add_u32 v16, v30, 5, v29
  v_xor_b32 v30, 1, v28
  v_lshl_add_u32 v17, v30, 5, v29
  v_xor_b32 v30, 2, v28
  v_lshl_add_u32 v18, v30, 5, v29
  v_xor_b32 v30, 3, v28
  v_lshl_add_u32 v19, v30, 5, v29
  v_xor_b32 v30, 4, v28
  v_lshl_add_u32 v20, v30, 5, v29
  v_xor_b32 v30, 5, v28
  v_lshl_add_u32 v21, v30, 5, v29
  v_xor_b32 v30, 6, v28
  v_lshl_add_u32 v22, v30, 5, v29
  v_xor_b32 v30, 7, v28
  v_lshl_add_u32 v23, v30, 5, v29
  buffer_load_dwordx4 v[96:99], v15, s[28:31], s6 offen nt
  buffer_load_ushort v88, v14, s[16:19], s7 offen offset:0
  s_add_u32 s6, s6, 49152
  buffer_load_dwordx4 v[100:103], v15, s[28:31], s6 offen nt
  buffer_load_ushort v89, v14, s[16:19], s7 offen offset:16
  s_add_u32 s6, s6, 49152
  buffer_load_dwordx4 v[104:107], v15, s[28:31], s6 offen nt
  buffer_load_ushort v90, v14, s[16:19], s7 offen offset:32
  s_add_u32 s6, s6, 49152
  buffer_load_dwordx4 v[108:111], v15, s[28:31], s6 offen nt
  buffer_load_ushort v91, v14, s[16:19], s7 offen offset:48
  buffer_load_dwordx4 v[64:67], v3, s[24:27], s52 offen
  buffer_load_dwordx4 v[68:71], v3, s[24:27], s52 offen offset:128
  s_waitcnt vmcnt(10)
  s_cmp_lg_u32 s40, 0
  s_cbranch_scc1 Lzd3
  s_cmp_ge_u32 s2, 8
  s_cbranch_scc1 Lzd3
  s_lshl_b32 s4, s2, 2
  v_mov_b32 v28, 1
  v_mov_b32 v29, s4
  s_mov_b64 exec, 1
  global_store_dword v29, v28, s[92:93] sc1
  s_mov_b64 exec, -1
Lzd3:
  s_barrier
  ds_read_b64_tr_b16 v[32:33], v16 offset:32768
  ds_read_b64_tr_b16 v[34:35], v16 offset:33792
  ds_read_b64_tr_b16 v[36:37], v16 offset:40960
  ds_read_b64_tr_b16 v[38:39], v16 offset:41984
  ds_read_b128 a[0:3], v12 offset:0
  ds_read_b128 a[4:7], v13 offset:0
  ds_read_b128 a[64:67], v12 offset:2048
  ds_read_b128 a[68:71], v13 offset:2048
  ds_read_b128 a[128:131], v12 offset:4096
  ds_read_b128 a[132:135], v13 offset:4096
  ds_read_b128 a[192:195], v12 offset:6144
  ds_read_b128 a[196:199], v13 offset:6144
  ds_read_b64_tr_b16 v[40:41], v17 offset:32768
  ds_read_b64_tr_b16 v[42:43], v17 offset:33792
  ds_read_b64_tr_b16 v[44:45], v17 offset:40960
  ds_read_b64_tr_b16 v[46:47], v17 offset:41984
  s_waitcnt lgkmcnt(4)
  v_mfma_f32_16x16x32_bf16 v[128:131], v[32:35], a[0:3], 0
  s_add_u32 m0, s36, 81920
  ds_read_b64_tr_b16 v[48:49], v18 offset:32768
  ds_read_b64_tr_b16 v[50:51], v18 offset:33792
  v_mfma_f32_16x16x32_bf16 v[128:131], v[36:39], a[4:7], v[128:131]
  s_add_u32 s51, s34, 524288
  ds_read_b64_tr_b16 v[52:53], v18 offset:40960
  ds_read_b64_tr_b16 v[54:55], v18 offset:41984
  v_mfma_f32_16x16x32_bf16 v[132:135], v[36:39], a[68:71], 0
  buffer_load_dwordx4 v8, s[12:15], s51 offen offset:0 nt lds
  v_mfma_f32_16x16x32_bf16 v[132:135], v[32:35], a[64:67], v[132:135]
  buffer_load_dwordx4 v9, s[12:15], s51 offen offset:1024 nt lds
  v_mfma_f32_16x16x32_bf16 v[136:139], v[32:35], a[128:131], 0
  v_mfma_f32_16x16x32_bf16 v[136:139], v[36:39], a[132:135], v[136:139]
  buffer_load_dwordx4 v10, s[12:15], s51 offen offset:2048 nt lds
  v_mfma_f32_16x16x32_bf16 v[140:143], v[36:39], a[196:199], 0
  s_waitcnt vmcnt(3)
  s_mov_b32 s16, s72
  s_and_b32 s17, s73, 0xffff
  s_mov_b32 s18, 4194304
  s_mov_b32 s19, 0x20000
  s_mov_b32 s28, s92
  s_and_b32 s29, s93, 0xffff
  s_mov_b32 s30, 256
  s_mov_b32 s31, 0x20000
  v_lshlrev_b32 v88, 16, v88
  v_lshlrev_b32 v89, 16, v89
  v_mfma_f32_16x16x32_bf16 v[140:143], v[32:35], a[192:195], v[140:143]
  s_waitcnt lgkmcnt(4)
  buffer_load_dwordx4 v11, s[12:15], s51 offen offset:3072 nt lds
  v_lshlrev_b32 v90, 16, v90
  v_lshlrev_b32 v91, 16, v91
  v_mul_f32 v92, 0xbfb8aa3b, v88
  v_mfma_f32_16x16x32_bf16 v[156:159], v[40:43], a[192:195], 0
  s_add_u32 m0, s35, 49152
  ds_read_b64_tr_b16 v[32:33], v19 offset:32768
  ds_read_b64_tr_b16 v[34:35], v19 offset:33792
  v_mul_f32 v93, 0xbfb8aa3b, v89
  v_mul_f32 v94, 0xbfb8aa3b, v90
  v_mfma_f32_16x16x32_bf16 v[156:159], v[44:47], a[196:199], v[156:159]
  s_add_u32 s50, s33, 128
  ds_read_b64_tr_b16 v[36:37], v19 offset:40960
  ds_read_b64_tr_b16 v[38:39], v19 offset:41984
  v_mul_f32 v95, 0xbfb8aa3b, v91
  v_mfma_f32_16x16x32_bf16 v[152:155], v[44:47], a[132:135], 0
  buffer_load_dwordx4 v4, s[8:11], s50 offen offset:0 lds
  v_exp_f32 v92, v92
  v_mfma_f32_16x16x32_bf16 v[152:155], v[40:43], a[128:131], v[152:155]
  buffer_load_dwordx4 v5, s[8:11], s50 offen offset:1024 lds
  v_exp_f32 v93, v93
  v_mfma_f32_16x16x32_bf16 v[148:151], v[40:43], a[64:67], 0
  v_exp_f32 v94, v94
  v_exp_f32 v95, v95
  v_mfma_f32_16x16x32_bf16 v[148:151], v[44:47], a[68:71], v[148:151]
  buffer_load_dwordx4 v6, s[8:11], s50 offen offset:2048 lds
  v_add_f32 v92, 1.0, v92
  v_add_f32 v93, 1.0, v93
  v_add_f32 v94, 1.0, v94
  v_mfma_f32_16x16x32_bf16 v[144:147], v[44:47], a[4:7], 0
  v_add_f32 v95, 1.0, v95
  v_rcp_f32 v92, v92
  v_mfma_f32_16x16x32_bf16 v[144:147], v[40:43], a[0:3], v[144:147]
  s_waitcnt lgkmcnt(4)
  buffer_load_dwordx4 v7, s[8:11], s50 offen offset:3072 lds
  v_rcp_f32 v93, v93
  v_mfma_f32_16x16x32_bf16 v[160:163], v[48:51], a[0:3], 0
  s_add_u32 m0, s35, 53248
  ds_read_b64_tr_b16 v[40:41], v20 offset:32768
  ds_read_b64_tr_b16 v[42:43], v20 offset:33792
  v_rcp_f32 v94, v94
  v_mfma_f32_16x16x32_bf16 v[160:163], v[52:55], a[4:7], v[160:163]
  s_add_u32 s50, s50, 32768
  ds_read_b64_tr_b16 v[44:45], v20 offset:40960
  ds_read_b64_tr_b16 v[46:47], v20 offset:41984
  v_rcp_f32 v95, v95
  v_mfma_f32_16x16x32_bf16 v[164:167], v[52:55], a[68:71], 0
  buffer_load_dwordx4 v4, s[8:11], s50 offen offset:0 lds
  v_mul_f32 v88, v88, v92
  v_mul_f32 v89, v89, v93
  v_mul_f32 v90, v90, v94
  v_mfma_f32_16x16x32_bf16 v[164:167], v[48:51], a[64:67], v[164:167]
  buffer_load_dwordx4 v5, s[8:11], s50 offen offset:1024 lds
  v_mul_f32 v91, v91, v95
  v_cvt_pk_bf16_f32 v92, v88, v89
  v_cvt_pk_bf16_f32 v93, v90, v91
  v_mfma_f32_16x16x32_bf16 v[168:171], v[48:51], a[128:131], 0
  v_lshlrev_b32 v88, 16, v92
  v_and_b32 v89, 0xffff0000, v92
  v_lshlrev_b32 v90, 16, v93
  v_and_b32 v91, 0xffff0000, v93
  v_mfma_f32_16x16x32_bf16 v[168:171], v[52:55], a[132:135], v[168:171]
  buffer_load_dwordx4 v6, s[8:11], s50 offen offset:2048 lds
  v_lshlrev_b32 v72, 16, v96
  v_and_b32 v73, 0xffff0000, v96
  v_lshlrev_b32 v74, 16, v97
  v_mfma_f32_16x16x32_bf16 v[172:175], v[52:55], a[196:199], 0
  v_and_b32 v75, 0xffff0000, v97
  v_lshlrev_b32 v76, 16, v98
  v_and_b32 v77, 0xffff0000, v98
  v_lshlrev_b32 v78, 16, v99
  v_mfma_f32_16x16x32_bf16 v[172:175], v[48:51], a[192:195], v[172:175]
  s_waitcnt lgkmcnt(4)
  buffer_load_dwordx4 v7, s[8:11], s50 offen offset:3072 lds
  v_and_b32 v79, 0xffff0000, v99
  v_mul_f32 v112, v88, v72
  v_mul_f32 v113, v88, v73
  v_mfma_f32_16x16x32_bf16 v[188:191], v[32:35], a[192:195], 0
  s_add_u32 m0, s36, 131072
  ds_read_b64_tr_b16 v[48:49], v21 offset:32768
  ds_read_b64_tr_b16 v[50:51], v21 offset:33792
  v_mul_f32 v114, v88, v74
  v_mul_f32 v115, v88, v75
  v_mfma_f32_16x16x32_bf16 v[188:191], v[36:39], a[196:199], v[188:191]
  s_add_u32 s51, s34, 1048576
  ds_read_b64_tr_b16 v[52:53], v21 offset:40960
  ds_read_b64_tr_b16 v[54:55], v21 offset:41984
  v_mul_f32 v116, v88, v76
  v_mul_f32 v117, v88, v77
  v_mfma_f32_16x16x32_bf16 v[184:187], v[36:39], a[132:135], 0
  buffer_load_dwordx4 v8, s[12:15], s51 offen offset:0 nt lds
  v_mul_f32 v118, v88, v78
  v_mul_f32 v119, v88, v79
  v_lshlrev_b32 v72, 16, v100
  v_mfma_f32_16x16x32_bf16 v[184:187], v[32:35], a[128:131], v[184:187]
  buffer_load_dwordx4 v9, s[12:15], s51 offen offset:1024 nt lds
  v_and_b32 v73, 0xffff0000, v100
  v_lshlrev_b32 v74, 16, v101
  v_and_b32 v75, 0xffff0000, v101
  v_mfma_f32_16x16x32_bf16 v[180:183], v[32:35], a[64:67], 0
  v_lshlrev_b32 v76, 16, v102
  v_and_b32 v77, 0xffff0000, v102
  v_lshlrev_b32 v78, 16, v103
  v_and_b32 v79, 0xffff0000, v103
  v_mfma_f32_16x16x32_bf16 v[180:183], v[36:39], a[68:71], v[180:183]
  buffer_load_dwordx4 v10, s[12:15], s51 offen offset:2048 nt lds
  v_fmac_f32 v112, v89, v72
  v_fmac_f32 v113, v89, v73
  v_fmac_f32 v114, v89, v74
  v_mfma_f32_16x16x32_bf16 v[176:179], v[36:39], a[4:7], 0
  v_fmac_f32 v115, v89, v75
  v_fmac_f32 v116, v89, v76
  v_fmac_f32 v117, v89, v77
  v_fmac_f32 v118, v89, v78
  v_mfma_f32_16x16x32_bf16 v[176:179], v[32:35], a[0:3], v[176:179]
  s_waitcnt lgkmcnt(4)
  buffer_load_dwordx4 v11, s[12:15], s51 offen offset:3072 nt lds
  v_fmac_f32 v119, v89, v79
  v_lshlrev_b32 v72, 16, v104
  v_and_b32 v73, 0xffff0000, v104
  v_mfma_f32_16x16x32_bf16 v[192:195], v[40:43], a[0:3], 0
  s_add_u32 m0, s35, 98304
  ds_read_b64_tr_b16 v[32:33], v22 offset:32768
  ds_read_b64_tr_b16 v[34:35], v22 offset:33792
  v_lshlrev_b32 v74, 16, v105
  v_and_b32 v75, 0xffff0000, v105
  v_mfma_f32_16x16x32_bf16 v[192:195], v[44:47], a[4:7], v[192:195]
  s_add_u32 s50, s33, 256
  ds_read_b64_tr_b16 v[36:37], v22 offset:40960
  ds_read_b64_tr_b16 v[38:39], v22 offset:41984
  v_lshlrev_b32 v76, 16, v106
  v_and_b32 v77, 0xffff0000, v106
  v_mfma_f32_16x16x32_bf16 v[196:199], v[44:47], a[68:71], 0
  buffer_load_dwordx4 v4, s[8:11], s50 offen offset:0 lds
  v_lshlrev_b32 v78, 16, v107
  v_and_b32 v79, 0xffff0000, v107
  v_fmac_f32 v112, v90, v72
  v_mfma_f32_16x16x32_bf16 v[196:199], v[40:43], a[64:67], v[196:199]
  buffer_load_dwordx4 v5, s[8:11], s50 offen offset:1024 lds
  v_fmac_f32 v113, v90, v73
  v_fmac_f32 v114, v90, v74
  v_fmac_f32 v115, v90, v75
  v_mfma_f32_16x16x32_bf16 v[200:203], v[40:43], a[128:131], 0
  v_fmac_f32 v116, v90, v76
  v_fmac_f32 v117, v90, v77
  v_fmac_f32 v118, v90, v78
  v_fmac_f32 v119, v90, v79
  v_mfma_f32_16x16x32_bf16 v[200:203], v[44:47], a[132:135], v[200:203]
  buffer_load_dwordx4 v6, s[8:11], s50 offen offset:2048 lds
  v_lshlrev_b32 v72, 16, v108
  v_and_b32 v73, 0xffff0000, v108
  v_lshlrev_b32 v74, 16, v109
  v_mfma_f32_16x16x32_bf16 v[204:207], v[44:47], a[196:199], 0
  v_and_b32 v75, 0xffff0000, v109
  v_lshlrev_b32 v76, 16, v110
  v_and_b32 v77, 0xffff0000, v110
  v_lshlrev_b32 v78, 16, v111
  v_mfma_f32_16x16x32_bf16 v[204:207], v[40:43], a[192:195], v[204:207]
  s_waitcnt lgkmcnt(4)
  buffer_load_dwordx4 v7, s[8:11], s50 offen offset:3072 lds
  v_and_b32 v79, 0xffff0000, v111
  v_fmac_f32 v112, v91, v72
  v_fmac_f32 v113, v91, v73
  v_mfma_f32_16x16x32_bf16 v[220:223], v[48:51], a[192:195], 0
  s_add_u32 m0, s35, 102400
  ds_read_b64_tr_b16 v[40:41], v23 offset:32768
  ds_read_b64_tr_b16 v[42:43], v23 offset:33792
  v_fmac_f32 v114, v91, v74
  v_fmac_f32 v115, v91, v75
  v_mfma_f32_16x16x32_bf16 v[220:223], v[52:55], a[196:199], v[220:223]
  s_add_u32 s50, s50, 32768
  ds_read_b64_tr_b16 v[44:45], v23 offset:40960
  ds_read_b64_tr_b16 v[46:47], v23 offset:41984
  v_fmac_f32 v116, v91, v76
  v_fmac_f32 v117, v91, v77
  v_mfma_f32_16x16x32_bf16 v[216:219], v[52:55], a[132:135], 0
  buffer_load_dwordx4 v4, s[8:11], s50 offen offset:0 lds
  v_fmac_f32 v118, v91, v78
  v_fmac_f32 v119, v91, v79
  s_lshl_b32 s3, s40, 2
  v_mfma_f32_16x16x32_bf16 v[216:219], v[48:51], a[128:131], v[216:219]
  buffer_load_dwordx4 v5, s[8:11], s50 offen offset:1024 lds
  v_add_u32 v100, s3, v25
  v_lshlrev_b32 v100, 8, v100
  v_lshl_add_u32 v100, v26, 5, v100
  v_mfma_f32_16x16x32_bf16 v[212:215], v[48:51], a[64:67], 0
  v_add_u32 v100, 147456, v100
  v_add_f32_dpp v112, v112, v112 row_ror:8 row_mask:0xf bank_mask:0xf
  v_add_f32_dpp v113, v113, v113 row_ror:8 row_mask:0xf bank_mask:0xf
  v_add_f32_dpp v114, v114, v114 row_ror:8 row_mask:0xf bank_mask:0xf
  v_mfma_f32_16x16x32_bf16 v[212:215], v[52:55], a[68:71], v[212:215]
  buffer_load_dwordx4 v6, s[8:11], s50 offen offset:2048 lds
  v_add_f32_dpp v115, v115, v115 row_ror:8 row_mask:0xf bank_mask:0xf
  v_add_f32_dpp v116, v116, v116 row_ror:8 row_mask:0xf bank_mask:0xf
  v_add_f32_dpp v117, v117, v117 row_ror:8 row_mask:0xf bank_mask:0xf
  v_mfma_f32_16x16x32_bf16 v[208:211], v[52:55], a[4:7], 0
  v_add_f32_dpp v118, v118, v118 row_ror:8 row_mask:0xf bank_mask:0xf
  v_add_f32_dpp v119, v119, v119 row_ror:8 row_mask:0xf bank_mask:0xf
  ds_write_b128 v100, v[112:115] offset:0
  ds_write_b128 v100, v[116:119] offset:16
  v_mfma_f32_16x16x32_bf16 v[208:211], v[48:51], a[0:3], v[208:211]
  s_waitcnt lgkmcnt(6)
  buffer_load_dwordx4 v7, s[8:11], s50 offen offset:3072 lds
  v_lshlrev_b32 v72, 16, v64
  v_and_b32 v73, 0xffff0000, v64
  v_lshlrev_b32 v74, 16, v65
  v_mfma_f32_16x16x32_bf16 v[224:227], v[32:35], a[0:3], 0
  v_and_b32 v75, 0xffff0000, v65
  v_lshlrev_b32 v76, 16, v66
  v_and_b32 v77, 0xffff0000, v66
  v_lshlrev_b32 v78, 16, v67
  v_mfma_f32_16x16x32_bf16 v[224:227], v[36:39], a[4:7], v[224:227]
  v_and_b32 v79, 0xffff0000, v67
  v_lshlrev_b32 v80, 16, v68
  v_and_b32 v81, 0xffff0000, v68
  v_lshlrev_b32 v82, 16, v69
  v_mfma_f32_16x16x32_bf16 v[228:231], v[36:39], a[68:71], 0
  s_waitcnt vmcnt(12) lgkmcnt(0)
  s_barrier
  s_cmp_lg_u32 s40, 0
  s_cbranch_scc1 Lnomod4
  s_cmp_ge_u32 s2, 192
  s_cbranch_scc1 Lnomod4
  v_lshlrev_b32 v28, 2, v1
  v_add_u32 v29, 147456, v28
  ds_read2st64_b32 v[112:113], v29 offset0:0 offset1:1
  ds_read2st64_b32 v[114:115], v29 offset0:2 offset1:3
  ds_read2st64_b32 v[116:117], v29 offset0:4 offset1:5
  ds_read2st64_b32 v[118:119], v29 offset0:6 offset1:7
  ds_read2st64_b32 v[120:121], v29 offset0:8 offset1:9
  ds_read2st64_b32 v[122:123], v29 offset0:10 offset1:11
  ds_read2st64_b32 v[124:125], v29 offset0:12 offset1:13
  ds_read2st64_b32 v[126:127], v29 offset0:14 offset1:15
  s_mul_i32 s4, s44, 12288
  s_lshl_b32 s5, s54, 8
  s_add_u32 s4, s4, s5
  s_add_u32 s4, s4, 66060288
  s_waitcnt lgkmcnt(0)
  v_add_f32 v112, v112, v120
  v_add_f32 v113, v113, v121
  v_add_f32 v114, v114, v122
  v_add_f32 v115, v115, v123
  v_add_f32 v116, v116, v124
  v_add_f32 v117, v117, v125
  v_add_f32 v118, v118, v126
  v_add_f32 v119, v119, v127
  v_add_f32 v112, v112, v116
  v_add_f32 v113, v113, v117
  v_add_f32 v114, v114, v118
  v_add_f32 v115, v115, v119
  v_add_f32 v112, v112, v114
  v_add_f32 v113, v113, v115
  v_add_f32 v112, v112, v113
  buffer_store_dword v112, v28, s[20:23], s4 offen sc1
Lnomod4:
  v_lshlrev_b32 v29, 2, v26
  s_mov_b32 s61, 0
  buffer_load_dword v28, v29, s[28:31], s61 offen sc1
  v_add_u32 v16, 0x14000, v16
  v_add_u32 v17, 0x14000, v17
  v_add_u32 v18, 0x14000, v18
  v_add_u32 v19, 0x14000, v19
  v_add_u32 v20, 0x14000, v20
  v_add_u32 v21, 0x14000, v21
  v_add_u32 v22, 0x14000, v22
  v_add_u32 v23, 0x14000, v23
  ds_read_b64_tr_b16 v[48:49], v16 offset:0
  ds_read_b64_tr_b16 v[50:51], v16 offset:1024
  v_and_b32 v83, 0xffff0000, v69
  v_lshlrev_b32 v84, 16, v70
  v_mfma_f32_16x16x32_bf16 v[228:231], v[32:35], a[64:67], v[228:231]
  s_add_u32 m0, s36, 32768
  ds_read_b64_tr_b16 v[52:53], v16 offset:8192
  ds_read_b64_tr_b16 v[54:55], v16 offset:9216
  v_and_b32 v85, 0xffff0000, v70
  v_lshlrev_b32 v86, 16, v71
  v_mfma_f32_16x16x32_bf16 v[232:235], v[32:35], a[128:131], 0
  s_add_u32 s51, s34, 1572864
  ds_read_b128 a[8:11], v12 offset:49152
  ds_read_b128 a[12:15], v13 offset:49152
  v_and_b32 v87, 0xffff0000, v71
  v_add_f32 v64, v72, v73
  v_mfma_f32_16x16x32_bf16 v[232:235], v[36:39], a[132:135], v[232:235]
  ds_read_b128 a[72:75], v12 offset:51200
  ds_read_b128 a[76:79], v13 offset:51200
  v_add_f32 v64, v64, v74
  v_add_f32 v64, v64, v75
  v_mfma_f32_16x16x32_bf16 v[236:239], v[36:39], a[196:199], 0
  ds_read_b128 a[136:139], v12 offset:53248
  ds_read_b128 a[140:143], v13 offset:53248
  v_add_f32 v64, v64, v76
  v_add_f32 v64, v64, v77
  v_mfma_f32_16x16x32_bf16 v[236:239], v[32:35], a[192:195], v[236:239]
  ds_read_b128 a[200:203], v12 offset:55296
  ds_read_b128 a[204:207], v13 offset:55296
  v_add_f32 v64, v64, v78
  v_add_f32 v64, v64, v79
  v_mfma_f32_16x16x32_bf16 v[252:255], v[40:43], a[192:195], 0
  ds_read_b64_tr_b16 v[32:33], v17 offset:0
  ds_read_b64_tr_b16 v[34:35], v17 offset:1024
  v_add_f32 v64, v64, v80
  v_add_f32 v64, v64, v81
  v_mfma_f32_16x16x32_bf16 v[252:255], v[44:47], a[196:199], v[252:255]
  ds_read_b64_tr_b16 v[36:37], v17 offset:8192
  ds_read_b64_tr_b16 v[38:39], v17 offset:9216
  v_add_f32 v64, v64, v82
  v_add_f32 v64, v64, v83
  v_mfma_f32_16x16x32_bf16 v[248:251], v[44:47], a[132:135], 0
  buffer_load_dwordx4 v8, s[12:15], s51 offen offset:0 nt lds
  v_add_f32 v64, v64, v84
  v_add_f32 v64, v64, v85
  v_add_f32 v64, v64, v86
  v_mfma_f32_16x16x32_bf16 v[248:251], v[40:43], a[128:131], v[248:251]
  buffer_load_dwordx4 v9, s[12:15], s51 offen offset:1024 nt lds
  v_add_f32 v64, v64, v87
  s_nop 0
  v_mfma_f32_16x16x32_bf16 v[244:247], v[40:43], a[64:67], 0
  v_add_f32_dpp v64, v64, v64 row_ror:8 row_mask:0xf bank_mask:0xf
  v_mov_b32 v66, v64
  s_nop 0
  v_mfma_f32_16x16x32_bf16 v[244:247], v[44:47], a[68:71], v[244:247]
  buffer_load_dwordx4 v10, s[12:15], s51 offen offset:2048 nt lds
  v_permlane16_swap_b32 v64, v66
  v_add_f32 v64, v64, v66
  v_mov_b32 v66, v64
  s_nop 0
  v_mfma_f32_16x16x32_bf16 v[240:243], v[44:47], a[4:7], 0
  v_permlane32_swap_b32 v64, v66
  v_add_f32 v64, v64, v66
  v_mul_f32 v64, 0x3c000000, v64
  v_sub_f32 v72, v72, v64
  v_mfma_f32_16x16x32_bf16 v[240:243], v[40:43], a[0:3], v[240:243]
  s_waitcnt lgkmcnt(4)
  buffer_load_dwordx4 v11, s[12:15], s51 offen offset:3072 nt lds
  v_sub_f32 v73, v73, v64
  v_sub_f32 v74, v74, v64
  v_sub_f32 v75, v75, v64
  v_mfma_f32_16x16x32_bf16 v[128:131], v[48:51], a[8:11], v[128:131]
  s_add_u32 m0, s35, 0
  ds_read_b64_tr_b16 v[40:41], v18 offset:0
  ds_read_b64_tr_b16 v[42:43], v18 offset:1024
  v_sub_f32 v76, v76, v64
  v_sub_f32 v77, v77, v64
  v_mfma_f32_16x16x32_bf16 v[128:131], v[52:55], a[12:15], v[128:131]
  s_add_u32 s50, s33, 384
  ds_read_b64_tr_b16 v[44:45], v18 offset:8192
  ds_read_b64_tr_b16 v[46:47], v18 offset:9216
  v_sub_f32 v78, v78, v64
  v_sub_f32 v79, v79, v64
  v_mfma_f32_16x16x32_bf16 v[132:135], v[52:55], a[76:79], v[132:135]
  buffer_load_dwordx4 v4, s[8:11], s50 offen offset:0 lds
  v_sub_f32 v80, v80, v64
  v_sub_f32 v81, v81, v64
  v_sub_f32 v82, v82, v64
  v_mfma_f32_16x16x32_bf16 v[132:135], v[48:51], a[72:75], v[132:135]
  v_sub_f32 v83, v83, v64
  v_sub_f32 v84, v84, v64
  v_sub_f32 v85, v85, v64
  v_sub_f32 v86, v86, v64
  v_mfma_f32_16x16x32_bf16 v[136:139], v[48:51], a[136:139], v[136:139]
  v_sub_f32 v87, v87, v64
  v_mul_f32 v65, v72, v72
  v_fmac_f32 v65, v73, v73
  v_fmac_f32 v65, v74, v74
  v_mfma_f32_16x16x32_bf16 v[136:139], v[52:55], a[140:143], v[136:139]
  buffer_load_dwordx4 v5, s[8:11], s50 offen offset:1024 lds
  v_fmac_f32 v65, v75, v75
  v_fmac_f32 v65, v76, v76
  v_fmac_f32 v65, v77, v77
  v_mfma_f32_16x16x32_bf16 v[140:143], v[52:55], a[204:207], v[140:143]
  v_fmac_f32 v65, v78, v78
  v_fmac_f32 v65, v79, v79
  v_fmac_f32 v65, v80, v80
  v_fmac_f32 v65, v81, v81
  v_mfma_f32_16x16x32_bf16 v[140:143], v[48:51], a[200:203], v[140:143]
  s_waitcnt lgkmcnt(4)
  v_fmac_f32 v65, v82, v82
  v_fmac_f32 v65, v83, v83
  v_fmac_f32 v65, v84, v84
  v_fmac_f32 v65, v85, v85
  v_mfma_f32_16x16x32_bf16 v[156:159], v[32:35], a[200:203], v[156:159]
  ds_read_b64_tr_b16 v[48:49], v19 offset:0
  ds_read_b64_tr_b16 v[50:51], v19 offset:1024
  v_fmac_f32 v65, v86, v86
  v_fmac_f32 v65, v87, v87
  s_nop 0
  v_mfma_f32_16x16x32_bf16 v[156:159], v[36:39], a[204:207], v[156:159]
  ds_read_b64_tr_b16 v[52:53], v19 offset:8192
  ds_read_b64_tr_b16 v[54:55], v19 offset:9216
  v_add_f32_dpp v65, v65, v65 row_ror:8 row_mask:0xf bank_mask:0xf
  v_mov_b32 v66, v65
  s_nop 0
  v_mfma_f32_16x16x32_bf16 v[152:155], v[36:39], a[140:143], v[152:155]
  buffer_load_dwordx4 v6, s[8:11], s50 offen offset:2048 lds
  v_permlane16_swap_b32 v65, v66
  v_add_f32 v65, v65, v66
  v_mov_b32 v66, v65
  s_nop 0
  v_mfma_f32_16x16x32_bf16 v[152:155], v[32:35], a[136:139], v[152:155]
  v_permlane32_swap_b32 v65, v66
  v_add_f32 v65, v65, v66
  s_lshl_b32 s3, s40, 8
  v_lshlrev_b32 v66, 3, v26
  v_mfma_f32_16x16x32_bf16 v[148:151], v[32:35], a[72:75], v[148:151]
  v_add_u32 v66, 147456, v66
  v_add_u32 v67, s3, v66
  ds_write_b64 v67, v[64:65] offset:4096
  v_mfma_f32_16x16x32_bf16 v[148:151], v[36:39], a[76:79], v[148:151]
  buffer_load_dwordx4 v7, s[8:11], s50 offen offset:3072 lds
  v_mfma_f32_16x16x32_bf16 v[144:147], v[36:39], a[12:15], v[144:147]
  s_add_u32 m0, s35, 4096
  v_mfma_f32_16x16x32_bf16 v[144:147], v[32:35], a[8:11], v[144:147]
  s_waitcnt lgkmcnt(5)
  v_mfma_f32_16x16x32_bf16 v[160:163], v[40:43], a[8:11], v[160:163]
  s_add_u32 s50, s50, 32768
  ds_read_b64_tr_b16 v[32:33], v20 offset:0
  ds_read_b64_tr_b16 v[34:35], v20 offset:1024
  v_mfma_f32_16x16x32_bf16 v[160:163], v[44:47], a[12:15], v[160:163]
  ds_read_b64_tr_b16 v[36:37], v20 offset:8192
  ds_read_b64_tr_b16 v[38:39], v20 offset:9216
  v_mfma_f32_16x16x32_bf16 v[164:167], v[44:47], a[76:79], v[164:167]
  buffer_load_dwordx4 v4, s[8:11], s50 offen offset:0 lds
  v_mfma_f32_16x16x32_bf16 v[164:167], v[40:43], a[72:75], v[164:167]
  v_mfma_f32_16x16x32_bf16 v[168:171], v[40:43], a[136:139], v[168:171]
  v_mfma_f32_16x16x32_bf16 v[168:171], v[44:47], a[140:143], v[168:171]
  buffer_load_dwordx4 v5, s[8:11], s50 offen offset:1024 lds
  v_mfma_f32_16x16x32_bf16 v[172:175], v[44:47], a[204:207], v[172:175]
  v_mfma_f32_16x16x32_bf16 v[172:175], v[40:43], a[200:203], v[172:175]
  s_waitcnt lgkmcnt(5)
  v_mfma_f32_16x16x32_bf16 v[188:191], v[48:51], a[200:203], v[188:191]
  ds_read_b64_tr_b16 v[40:41], v21 offset:0
  ds_read_b64_tr_b16 v[42:43], v21 offset:1024
  v_mfma_f32_16x16x32_bf16 v[188:191], v[52:55], a[204:207], v[188:191]
  ds_read_b64_tr_b16 v[44:45], v21 offset:8192
  ds_read_b64_tr_b16 v[46:47], v21 offset:9216
  v_mfma_f32_16x16x32_bf16 v[184:187], v[52:55], a[140:143], v[184:187]
  buffer_load_dwordx4 v6, s[8:11], s50 offen offset:2048 lds
  v_mfma_f32_16x16x32_bf16 v[184:187], v[48:51], a[136:139], v[184:187]
  v_mfma_f32_16x16x32_bf16 v[180:183], v[48:51], a[72:75], v[180:183]
  v_mfma_f32_16x16x32_bf16 v[180:183], v[52:55], a[76:79], v[180:183]
  buffer_load_dwordx4 v7, s[8:11], s50 offen offset:3072 lds
  v_mfma_f32_16x16x32_bf16 v[176:179], v[52:55], a[12:15], v[176:179]
  v_mfma_f32_16x16x32_bf16 v[176:179], v[48:51], a[8:11], v[176:179]
  s_waitcnt lgkmcnt(4)
  v_mfma_f32_16x16x32_bf16 v[192:195], v[32:35], a[8:11], v[192:195]
  ds_read_b64_tr_b16 v[48:49], v22 offset:0
  ds_read_b64_tr_b16 v[50:51], v22 offset:1024
  v_mfma_f32_16x16x32_bf16 v[192:195], v[36:39], a[12:15], v[192:195]
  ds_read_b64_tr_b16 v[52:53], v22 offset:8192
  ds_read_b64_tr_b16 v[54:55], v22 offset:9216
  v_mfma_f32_16x16x32_bf16 v[196:199], v[36:39], a[76:79], v[196:199]
  v_mfma_f32_16x16x32_bf16 v[196:199], v[32:35], a[72:75], v[196:199]
  v_mfma_f32_16x16x32_bf16 v[200:203], v[32:35], a[136:139], v[200:203]
  v_mfma_f32_16x16x32_bf16 v[200:203], v[36:39], a[140:143], v[200:203]
  v_mfma_f32_16x16x32_bf16 v[204:207], v[36:39], a[204:207], v[204:207]
  v_mfma_f32_16x16x32_bf16 v[204:207], v[32:35], a[200:203], v[204:207]
  s_waitcnt lgkmcnt(4)
  v_mfma_f32_16x16x32_bf16 v[220:223], v[40:43], a[200:203], v[220:223]
  ds_read_b64_tr_b16 v[32:33], v23 offset:0
  ds_read_b64_tr_b16 v[34:35], v23 offset:1024
  v_mfma_f32_16x16x32_bf16 v[220:223], v[44:47], a[204:207], v[220:223]
  ds_read_b64_tr_b16 v[36:37], v23 offset:8192
  ds_read_b64_tr_b16 v[38:39], v23 offset:9216
  v_mfma_f32_16x16x32_bf16 v[216:219], v[44:47], a[140:143], v[216:219]
  v_mfma_f32_16x16x32_bf16 v[216:219], v[40:43], a[136:139], v[216:219]
  v_mfma_f32_16x16x32_bf16 v[212:215], v[40:43], a[72:75], v[212:215]
  v_mfma_f32_16x16x32_bf16 v[212:215], v[44:47], a[76:79], v[212:215]
  v_mfma_f32_16x16x32_bf16 v[208:211], v[44:47], a[12:15], v[208:211]
  v_mfma_f32_16x16x32_bf16 v[208:211], v[40:43], a[8:11], v[208:211]
  s_waitcnt lgkmcnt(4)
  v_mfma_f32_16x16x32_bf16 v[224:227], v[48:51], a[8:11], v[224:227]
  v_mfma_f32_16x16x32_bf16 v[224:227], v[52:55], a[12:15], v[224:227]
  v_mfma_f32_16x16x32_bf16 v[228:231], v[52:55], a[76:79], v[228:231]
  s_waitcnt vmcnt(13) lgkmcnt(0)
  s_barrier
  s_waitcnt vmcnt(12)
  v_cmp_ne_u32 vcc, 1, v28
  s_cbranch_vccz Lspok6
  s_mov_b32 s5, 0
Lspin5:
  s_sleep 16
  buffer_load_dword v28, v29, s[28:31], s61 offen sc1
  s_add_u32 s5, s5, 1
  s_waitcnt vmcnt(0)
  v_cmp_ne_u32 vcc, 1, v28
  s_cbranch_vccz Lspok6
  s_cmp_lt_u32 s5, 0x10000
  s_cbranch_scc1 Lspin5
Lspok6:
  s_lshl_b32 s60, s54, 2
  s_add_u32 s60, s60, s44
  s_cmp_lg_u32 s40, 0
  s_cbranch_scc1 Lpub7
  s_lshr_b32 s4, s60, 2
  s_lshl_b32 s4, s4, 5
  s_and_b32 s5, s60, 3
  s_add_u32 s4, s4, s5
  s_lshl_b32 s4, s4, 2
  s_add_u32 s4, s4, 65052672
  v_mov_b32 v28, 1
  s_mov_b64 exec, 1
  buffer_store_dword v28, off, s[20:23], s4 sc1
  s_mov_b64 exec, -1
Lpub7:
  ds_read_b64_tr_b16 v[40:41], v16 offset:49152
  ds_read_b64_tr_b16 v[42:43], v16 offset:50176
  v_mfma_f32_16x16x32_bf16 v[228:231], v[48:51], a[72:75], v[228:231]
  s_add_u32 m0, s36, 81920
  ds_read_b64_tr_b16 v[44:45], v16 offset:57344
  ds_read_b64_tr_b16 v[46:47], v16 offset:58368
  v_mfma_f32_16x16x32_bf16 v[232:235], v[48:51], a[136:139], v[232:235]
  s_add_u32 s51, s34, 2097152
  v_add_u32 v12, 0x18000, v12
  v_add_u32 v13, 0x18000, v13
  ds_read_b128 a[16:19], v12 offset:0
  ds_read_b128 a[20:23], v13 offset:0
  v_mfma_f32_16x16x32_bf16 v[232:235], v[52:55], a[140:143], v[232:235]
  ds_read_b128 a[80:83], v12 offset:2048
  ds_read_b128 a[84:87], v13 offset:2048
  v_mfma_f32_16x16x32_bf16 v[236:239], v[52:55], a[204:207], v[236:239]
  ds_read_b128 a[144:147], v12 offset:4096
  ds_read_b128 a[148:151], v13 offset:4096
  v_mfma_f32_16x16x32_bf16 v[236:239], v[48:51], a[200:203], v[236:239]
  ds_read_b128 a[208:211], v12 offset:6144
  ds_read_b128 a[212:215], v13 offset:6144
  v_mfma_f32_16x16x32_bf16 v[252:255], v[32:35], a[200:203], v[252:255]
  ds_read_b64_tr_b16 v[48:49], v17 offset:49152
  ds_read_b64_tr_b16 v[50:51], v17 offset:50176
  v_mfma_f32_16x16x32_bf16 v[252:255], v[36:39], a[204:207], v[252:255]
  ds_read_b64_tr_b16 v[52:53], v17 offset:57344
  ds_read_b64_tr_b16 v[54:55], v17 offset:58368
  v_mfma_f32_16x16x32_bf16 v[248:251], v[36:39], a[140:143], v[248:251]
  buffer_load_dwordx4 v8, s[12:15], s51 offen offset:0 nt lds
  ds_read_b64 v[104:105], v66 offset:4096
  v_mfma_f32_16x16x32_bf16 v[248:251], v[32:35], a[136:139], v[248:251]
  buffer_load_dwordx4 v9, s[12:15], s51 offen offset:1024 nt lds
  ds_read_b64 v[106:107], v66 offset:4352
  v_mfma_f32_16x16x32_bf16 v[244:247], v[32:35], a[72:75], v[244:247]
  ds_read_b64 v[108:109], v66 offset:4608
  ds_read_b64 v[110:111], v66 offset:4864
  v_mfma_f32_16x16x32_bf16 v[244:247], v[36:39], a[76:79], v[244:247]
  v_mfma_f32_16x16x32_bf16 v[240:243], v[36:39], a[12:15], v[240:243]
  v_mfma_f32_16x16x32_bf16 v[240:243], v[32:35], a[8:11], v[240:243]
  s_waitcnt lgkmcnt(8)
  buffer_load_dwordx4 v10, s[12:15], s51 offen offset:2048 nt lds
  v_mfma_f32_16x16x32_bf16 v[128:131], v[40:43], a[16:19], v[128:131]
  ds_read_b64_tr_b16 v[32:33], v18 offset:49152
  ds_read_b64_tr_b16 v[34:35], v18 offset:50176
  v_mfma_f32_16x16x32_bf16 v[128:131], v[44:47], a[20:23], v[128:131]
  ds_read_b64_tr_b16 v[36:37], v18 offset:57344
  ds_read_b64_tr_b16 v[38:39], v18 offset:58368
  v_mfma_f32_16x16x32_bf16 v[132:135], v[44:47], a[84:87], v[132:135]
  s_waitcnt lgkmcnt(4)
  v_add_f32 v68, v104, v106
  v_mfma_f32_16x16x32_bf16 v[132:135], v[40:43], a[80:83], v[132:135]
  buffer_load_dwordx4 v11, s[12:15], s51 offen offset:3072 nt lds
  v_add_f32 v69, v108, v110
  v_mfma_f32_16x16x32_bf16 v[136:139], v[40:43], a[144:147], v[136:139]
  s_add_u32 m0, s35, 49152
  v_add_f32 v68, v68, v69
  v_mul_f32 v68, 0x3e800000, v68
  v_mfma_f32_16x16x32_bf16 v[136:139], v[44:47], a[148:151], v[136:139]
  s_add_u32 s50, s33, 512
  v_add_f32 v69, v105, v107
  v_add_f32 v70, v109, v111
  v_mfma_f32_16x16x32_bf16 v[140:143], v[44:47], a[212:215], v[140:143]
  v_add_f32 v69, v69, v70
  v_sub_f32 v104, v104, v68
  v_mfma_f32_16x16x32_bf16 v[140:143], v[40:43], a[208:211], v[140:143]
  buffer_load_dwordx4 v4, s[8:11], s50 offen offset:0 lds
  v_sub_f32 v106, v106, v68
  v_mfma_f32_16x16x32_bf16 v[156:159], v[48:51], a[208:211], v[156:159]
  ds_read_b64_tr_b16 v[40:41], v19 offset:49152
  ds_read_b64_tr_b16 v[42:43], v19 offset:50176
  v_mfma_f32_16x16x32_bf16 v[156:159], v[52:55], a[212:215], v[156:159]
  ds_read_b64_tr_b16 v[44:45], v19 offset:57344
  ds_read_b64_tr_b16 v[46:47], v19 offset:58368
  v_mfma_f32_16x16x32_bf16 v[152:155], v[52:55], a[148:151], v[152:155]
  v_sub_f32 v108, v108, v68
  v_sub_f32 v110, v110, v68
  v_mfma_f32_16x16x32_bf16 v[152:155], v[48:51], a[144:147], v[152:155]
  buffer_load_dwordx4 v5, s[8:11], s50 offen offset:1024 lds
  v_mul_f32 v70, v104, v104
  v_mfma_f32_16x16x32_bf16 v[148:151], v[48:51], a[80:83], v[148:151]
  v_fmac_f32 v70, v106, v106
  v_fmac_f32 v70, v108, v108
  v_mfma_f32_16x16x32_bf16 v[148:151], v[52:55], a[84:87], v[148:151]
  v_fmac_f32 v70, v110, v110
  v_fmac_f32 v69, 0x43000000, v70
  v_mfma_f32_16x16x32_bf16 v[144:147], v[52:55], a[20:23], v[144:147]
  v_mov_b32 v70, 0x3727c5ac
  v_fmac_f32 v70, 0x3b000000, v69
  v_mfma_f32_16x16x32_bf16 v[144:147], v[48:51], a[16:19], v[144:147]
  s_waitcnt lgkmcnt(4)
  buffer_load_dwordx4 v6, s[8:11], s50 offen offset:2048 lds
  v_mfma_f32_16x16x32_bf16 v[160:163], v[32:35], a[16:19], v[160:163]
  ds_read_b64_tr_b16 v[48:49], v20 offset:49152
  ds_read_b64_tr_b16 v[50:51], v20 offset:50176
  v_mfma_f32_16x16x32_bf16 v[160:163], v[36:39], a[20:23], v[160:163]
  ds_read_b64_tr_b16 v[52:53], v20 offset:57344
  ds_read_b64_tr_b16 v[54:55], v20 offset:58368
  v_mfma_f32_16x16x32_bf16 v[164:167], v[36:39], a[84:87], v[164:167]
  v_rsq_f32 v70, v70
  v_mfma_f32_16x16x32_bf16 v[164:167], v[32:35], a[80:83], v[164:167]
  buffer_load_dwordx4 v7, s[8:11], s50 offen offset:3072 lds
  v_sub_f32 v64, v64, v68
  v_mfma_f32_16x16x32_bf16 v[168:171], v[32:35], a[144:147], v[168:171]
  s_add_u32 m0, s35, 53248
  v_mul_f32 v64, v64, v70
  v_fma_f32 v72, v72, v70, v64
  v_mfma_f32_16x16x32_bf16 v[168:171], v[36:39], a[148:151], v[168:171]
  s_add_u32 s50, s50, 32768
  v_fma_f32 v73, v73, v70, v64
  v_fma_f32 v74, v74, v70, v64
  v_mfma_f32_16x16x32_bf16 v[172:175], v[36:39], a[212:215], v[172:175]
  v_fma_f32 v75, v75, v70, v64
  v_fma_f32 v76, v76, v70, v64
  v_mfma_f32_16x16x32_bf16 v[172:175], v[32:35], a[208:211], v[172:175]
  s_waitcnt lgkmcnt(4)
  buffer_load_dwordx4 v4, s[8:11], s50 offen offset:0 lds
  v_fma_f32 v77, v77, v70, v64
  v_mfma_f32_16x16x32_bf16 v[188:191], v[40:43], a[208:211], v[188:191]
  ds_read_b64_tr_b16 v[32:33], v21 offset:49152
  ds_read_b64_tr_b16 v[34:35], v21 offset:50176
  v_mfma_f32_16x16x32_bf16 v[188:191], v[44:47], a[212:215], v[188:191]
  ds_read_b64_tr_b16 v[36:37], v21 offset:57344
  ds_read_b64_tr_b16 v[38:39], v21 offset:58368
  v_mfma_f32_16x16x32_bf16 v[184:187], v[44:47], a[148:151], v[184:187]
  v_fma_f32 v78, v78, v70, v64
  v_fma_f32 v79, v79, v70, v64
  v_mfma_f32_16x16x32_bf16 v[184:187], v[40:43], a[144:147], v[184:187]
  buffer_load_dwordx4 v5, s[8:11], s50 offen offset:1024 lds
  v_fma_f32 v80, v80, v70, v64
  v_mfma_f32_16x16x32_bf16 v[180:183], v[40:43], a[80:83], v[180:183]
  v_fma_f32 v81, v81, v70, v64
  v_fma_f32 v82, v82, v70, v64
  v_mfma_f32_16x16x32_bf16 v[180:183], v[44:47], a[84:87], v[180:183]
  v_fma_f32 v83, v83, v70, v64
  v_fma_f32 v84, v84, v70, v64
  v_mfma_f32_16x16x32_bf16 v[176:179], v[44:47], a[20:23], v[176:179]
  v_fma_f32 v85, v85, v70, v64
  v_fma_f32 v86, v86, v70, v64
  v_mfma_f32_16x16x32_bf16 v[176:179], v[40:43], a[16:19], v[176:179]
  s_waitcnt lgkmcnt(4)
  buffer_load_dwordx4 v6, s[8:11], s50 offen offset:2048 lds
  v_fma_f32 v87, v87, v70, v64
  v_mfma_f32_16x16x32_bf16 v[192:195], v[48:51], a[16:19], v[192:195]
  ds_read_b64_tr_b16 v[40:41], v22 offset:49152
  ds_read_b64_tr_b16 v[42:43], v22 offset:50176
  v_mfma_f32_16x16x32_bf16 v[192:195], v[52:55], a[20:23], v[192:195]
  ds_read_b64_tr_b16 v[44:45], v22 offset:57344
  ds_read_b64_tr_b16 v[46:47], v22 offset:58368
  v_mfma_f32_16x16x32_bf16 v[196:199], v[52:55], a[84:87], v[196:199]
  v_cvt_pk_bf16_f32 v56, v72, v73
  v_cvt_pk_bf16_f32 v57, v74, v75
  v_mfma_f32_16x16x32_bf16 v[196:199], v[48:51], a[80:83], v[196:199]
  buffer_load_dwordx4 v7, s[8:11], s50 offen offset:3072 lds
  v_cvt_pk_bf16_f32 v58, v76, v77
  v_mfma_f32_16x16x32_bf16 v[200:203], v[48:51], a[144:147], v[200:203]
  v_cvt_pk_bf16_f32 v59, v78, v79
  v_cvt_pk_bf16_f32 v60, v80, v81
  v_mfma_f32_16x16x32_bf16 v[200:203], v[52:55], a[148:151], v[200:203]
  v_cvt_pk_bf16_f32 v61, v82, v83
  v_cvt_pk_bf16_f32 v62, v84, v85
  v_mfma_f32_16x16x32_bf16 v[204:207], v[52:55], a[212:215], v[204:207]
  v_cvt_pk_bf16_f32 v63, v86, v87
  v_lshlrev_b32 v80, 16, v56
  v_mfma_f32_16x16x32_bf16 v[204:207], v[48:51], a[208:211], v[204:207]
  s_waitcnt lgkmcnt(4)
  s_lshr_b32 s4, s2, 3
  s_lshl_b32 s4, s4, 2
  s_add_u32 s4, s4, s40
  s_lshl_b32 s4, s4, 14
  s_lshl_b32 s5, s43, 10
  s_add_u32 s4, s4, s5
  s_add_u32 s4, s4, 0
  v_lshrrev_b32 v28, 5, v1
  v_lshlrev_b32 v28, 13, v28
  v_and_b32 v29, 7, v1
  v_lshl_add_u32 v28, v29, 7, v28
  v_add_u32 v28, s4, v28
  global_load_dword v27, v28, s[72:73]
  v_and_b32 v81, 0xffff0000, v56
  v_mfma_f32_16x16x32_bf16 v[220:223], v[32:35], a[208:211], v[220:223]
  ds_read_b64_tr_b16 v[48:49], v23 offset:49152
  ds_read_b64_tr_b16 v[50:51], v23 offset:50176
  v_mfma_f32_16x16x32_bf16 v[220:223], v[36:39], a[212:215], v[220:223]
  ds_read_b64_tr_b16 v[52:53], v23 offset:57344
  ds_read_b64_tr_b16 v[54:55], v23 offset:58368
  v_mfma_f32_16x16x32_bf16 v[216:219], v[36:39], a[148:151], v[216:219]
  v_lshlrev_b32 v82, 16, v57
  v_and_b32 v83, 0xffff0000, v57
  v_mfma_f32_16x16x32_bf16 v[216:219], v[32:35], a[144:147], v[216:219]
  v_lshlrev_b32 v84, 16, v58
  v_and_b32 v85, 0xffff0000, v58
  v_mfma_f32_16x16x32_bf16 v[212:215], v[32:35], a[80:83], v[212:215]
  v_lshlrev_b32 v86, 16, v59
  v_and_b32 v87, 0xffff0000, v59
  v_mfma_f32_16x16x32_bf16 v[212:215], v[36:39], a[84:87], v[212:215]
  v_lshlrev_b32 v88, 16, v60
  v_and_b32 v89, 0xffff0000, v60
  v_mfma_f32_16x16x32_bf16 v[208:211], v[36:39], a[20:23], v[208:211]
  v_lshlrev_b32 v90, 16, v61
  v_and_b32 v91, 0xffff0000, v61
  v_mfma_f32_16x16x32_bf16 v[208:211], v[32:35], a[16:19], v[208:211]
  s_waitcnt lgkmcnt(4)
  v_lshlrev_b32 v92, 16, v62
  v_and_b32 v93, 0xffff0000, v62
  v_mfma_f32_16x16x32_bf16 v[224:227], v[40:43], a[16:19], v[224:227]
  v_lshlrev_b32 v94, 16, v63
  v_and_b32 v95, 0xffff0000, v63
  v_mfma_f32_16x16x32_bf16 v[224:227], v[44:47], a[20:23], v[224:227]
  v_lshrrev_b32 v3, 3, v1
  v_and_b32 v30, 7, v1
  v_mfma_f32_16x16x32_bf16 v[228:231], v[44:47], a[84:87], v[228:231]
  s_waitcnt vmcnt(13) lgkmcnt(0)
  s_barrier
  v_add_u32 v16, 0xffff4000, v16
  v_add_u32 v17, 0xffff4000, v17
  v_add_u32 v18, 0xffff4000, v18
  v_add_u32 v19, 0xffff4000, v19
  v_add_u32 v20, 0xffff4000, v20
  v_add_u32 v21, 0xffff4000, v21
  v_add_u32 v22, 0xffff4000, v22
  v_add_u32 v23, 0xffff4000, v23
  ds_read_b64_tr_b16 v[32:33], v16 offset:0
  ds_read_b64_tr_b16 v[34:35], v16 offset:1024
  v_mfma_f32_16x16x32_bf16 v[228:231], v[40:43], a[80:83], v[228:231]
  s_add_u32 m0, s36, 131072
  ds_read_b64_tr_b16 v[36:37], v16 offset:8192
  ds_read_b64_tr_b16 v[38:39], v16 offset:9216
  v_mfma_f32_16x16x32_bf16 v[232:235], v[40:43], a[144:147], v[232:235]
  s_add_u32 s51, s34, 2621440
  v_add_u32 v12, 0xfffe8000, v12
  v_add_u32 v13, 0xfffe8000, v13
  ds_read_b128 a[24:27], v12 offset:0
  ds_read_b128 a[28:31], v13 offset:0
  v_mfma_f32_16x16x32_bf16 v[232:235], v[44:47], a[148:151], v[232:235]
  ds_read_b128 a[88:91], v12 offset:2048
  ds_read_b128 a[92:95], v13 offset:2048
  v_mfma_f32_16x16x32_bf16 v[236:239], v[44:47], a[212:215], v[236:239]
  ds_read_b128 a[152:155], v12 offset:4096
  ds_read_b128 a[156:159], v13 offset:4096
  v_mfma_f32_16x16x32_bf16 v[236:239], v[40:43], a[208:211], v[236:239]
  ds_read_b128 a[216:219], v12 offset:6144
  ds_read_b128 a[220:223], v13 offset:6144
  v_mfma_f32_16x16x32_bf16 v[252:255], v[48:51], a[208:211], v[252:255]
  ds_read_b64_tr_b16 v[40:41], v17 offset:0
  ds_read_b64_tr_b16 v[42:43], v17 offset:1024
  v_mfma_f32_16x16x32_bf16 v[252:255], v[52:55], a[212:215], v[252:255]
  ds_read_b64_tr_b16 v[44:45], v17 offset:8192
  ds_read_b64_tr_b16 v[46:47], v17 offset:9216
  v_mfma_f32_16x16x32_bf16 v[248:251], v[52:55], a[148:151], v[248:251]
  buffer_load_dwordx4 v8, s[12:15], s51 offen offset:0 nt lds
  v_lshlrev_b32 v30, 4, v30
  v_mfma_f32_16x16x32_bf16 v[248:251], v[48:51], a[144:147], v[248:251]
  buffer_load_dwordx4 v9, s[12:15], s51 offen offset:1024 nt lds
  v_lshl_add_u32 v30, v3, 8, v30
  v_mfma_f32_16x16x32_bf16 v[244:247], v[48:51], a[80:83], v[244:247]
  s_lshl_b32 s3, s40, 12
  s_add_u32 s3, s3, 149504
  v_mfma_f32_16x16x32_bf16 v[244:247], v[52:55], a[84:87], v[244:247]
  v_lshl_add_u32 v3, v3, 5, s3
  v_add_u32 v15, s3, v2
  v_mfma_f32_16x16x32_bf16 v[240:243], v[52:55], a[20:23], v[240:243]
  v_and_b32 v14, 31, v1
  v_lshlrev_b32 v14, 4, v14
  v_mfma_f32_16x16x32_bf16 v[240:243], v[48:51], a[16:19], v[240:243]
  s_waitcnt lgkmcnt(4)
  buffer_load_dwordx4 v10, s[12:15], s51 offen offset:2048 nt lds
  v_lshrrev_b32 v24, 5, v1
  v_mfma_f32_16x16x32_bf16 v[128:131], v[32:35], a[24:27], v[128:131]
  ds_read_b64_tr_b16 v[48:49], v18 offset:0
  ds_read_b64_tr_b16 v[50:51], v18 offset:1024
  v_mfma_f32_16x16x32_bf16 v[128:131], v[36:39], a[28:31], v[128:131]
  ds_read_b64_tr_b16 v[52:53], v18 offset:8192
  ds_read_b64_tr_b16 v[54:55], v18 offset:9216
  v_mfma_f32_16x16x32_bf16 v[132:135], v[36:39], a[92:95], v[132:135]
  v_lshl_add_u32 v14, v24, 11, v14
  v_cvt_f32_u32 v64, v24
  v_mfma_f32_16x16x32_bf16 v[132:135], v[32:35], a[88:91], v[132:135]
  buffer_load_dwordx4 v11, s[12:15], s51 offen offset:3072 nt lds
  s_lshl_b32 s52, s40, 9
  v_mfma_f32_16x16x32_bf16 v[136:139], v[32:35], a[152:155], v[136:139]
  s_add_u32 m0, s35, 98304
  s_add_u32 s52, s52, 66060288
  s_lshl_b32 s7, s2, 5
  v_mfma_f32_16x16x32_bf16 v[136:139], v[36:39], a[156:159], v[136:139]
  s_add_u32 s50, s33, 640
  s_add_u32 s7, s7, 66064384
  s_lshr_b32 s53, s2, 1
  v_mfma_f32_16x16x32_bf16 v[140:143], v[36:39], a[220:223], v[140:143]
  s_lshl_b32 s53, s53, 14
  s_and_b32 s3, s2, 1
  v_mfma_f32_16x16x32_bf16 v[140:143], v[32:35], a[216:219], v[140:143]
  s_waitcnt lgkmcnt(4)
  buffer_load_dwordx4 v4, s[8:11], s50 offen offset:0 lds
  s_lshl_b32 s3, s3, 7
  v_mfma_f32_16x16x32_bf16 v[156:159], v[40:43], a[216:219], v[156:159]
  ds_read_b64_tr_b16 v[32:33], v19 offset:0
  ds_read_b64_tr_b16 v[34:35], v19 offset:1024
  v_mfma_f32_16x16x32_bf16 v[156:159], v[44:47], a[220:223], v[156:159]
  ds_read_b64_tr_b16 v[36:37], v19 offset:8192
  ds_read_b64_tr_b16 v[38:39], v19 offset:9216
  v_mfma_f32_16x16x32_bf16 v[152:155], v[44:47], a[156:159], v[152:155]
  s_add_u32 s53, s53, s3
  s_lshl_b32 s3, s40, 12
  v_mfma_f32_16x16x32_bf16 v[152:155], v[40:43], a[152:155], v[152:155]
  buffer_load_dwordx4 v5, s[8:11], s50 offen offset:1024 lds
  s_add_u32 s53, s53, s3
  v_mfma_f32_16x16x32_bf16 v[148:151], v[40:43], a[88:91], v[148:151]
  s_add_u32 s53, s53, 50331648
  s_mov_b32 s6, 0x3e0293ee
  v_mfma_f32_16x16x32_bf16 v[148:151], v[44:47], a[92:95], v[148:151]
  v_bfe_u32 v25, v1, 2, 1
  v_bfe_u32 v65, v1, 3, 1
  v_mfma_f32_16x16x32_bf16 v[144:147], v[44:47], a[28:31], v[144:147]
  v_lshl_add_u32 v25, v65, 3, v25
  s_lshl_b32 s3, s40, 1
  v_mfma_f32_16x16x32_bf16 v[144:147], v[40:43], a[24:27], v[144:147]
  s_waitcnt lgkmcnt(4)
  buffer_load_dwordx4 v6, s[8:11], s50 offen offset:2048 lds
  v_add_u32 v25, s3, v25
  v_mfma_f32_16x16x32_bf16 v[160:163], v[48:51], a[24:27], v[160:163]
  ds_read_b64_tr_b16 v[40:41], v20 offset:0
  ds_read_b64_tr_b16 v[42:43], v20 offset:1024
  v_mfma_f32_16x16x32_bf16 v[160:163], v[52:55], a[28:31], v[160:163]
  ds_read_b64_tr_b16 v[44:45], v20 offset:8192
  ds_read_b64_tr_b16 v[46:47], v20 offset:9216
  v_mfma_f32_16x16x32_bf16 v[164:167], v[52:55], a[92:95], v[164:167]
  s_lshr_b32 s3, s2, 3
  s_add_u32 s3, s3, 16
  v_mfma_f32_16x16x32_bf16 v[164:167], v[48:51], a[88:91], v[164:167]
  buffer_load_dwordx4 v7, s[8:11], s50 offen offset:3072 lds
  v_mov_b32 v65, s3
  v_mfma_f32_16x16x32_bf16 v[168:171], v[48:51], a[152:155], v[168:171]
  s_add_u32 m0, s35, 102400
  v_cmp_gt_u32 s[62:63], 16, v1
  v_and_b32 v66, 3, v1
  v_mfma_f32_16x16x32_bf16 v[168:171], v[52:55], a[156:159], v[168:171]
  s_add_u32 s50, s50, 32768
  v_lshlrev_b32 v66, 2, v66
  v_cndmask_b32 v25, v65, v25, s[62:63]
  v_mfma_f32_16x16x32_bf16 v[172:175], v[52:55], a[220:223], v[172:175]
  v_lshl_add_u32 v25, v25, 7, v66
  v_lshlrev_b32 v65, 2, v26
  v_mfma_f32_16x16x32_bf16 v[172:175], v[48:51], a[216:219], v[172:175]
  s_waitcnt lgkmcnt(4)
  buffer_load_dwordx4 v4, s[8:11], s50 offen offset:0 lds
  s_mov_b32 s55, 65052672
  v_mfma_f32_16x16x32_bf16 v[188:191], v[32:35], a[216:219], v[188:191]
  ds_read_b64_tr_b16 v[48:49], v21 offset:0
  ds_read_b64_tr_b16 v[50:51], v21 offset:1024
  v_mfma_f32_16x16x32_bf16 v[188:191], v[36:39], a[220:223], v[188:191]
  ds_read_b64_tr_b16 v[52:53], v21 offset:8192
  ds_read_b64_tr_b16 v[54:55], v21 offset:9216
  v_mfma_f32_16x16x32_bf16 v[184:187], v[36:39], a[156:159], v[184:187]
  v_mfma_f32_16x16x32_bf16 v[184:187], v[32:35], a[152:155], v[184:187]
  buffer_load_dwordx4 v5, s[8:11], s50 offen offset:1024 lds
  v_mfma_f32_16x16x32_bf16 v[180:183], v[32:35], a[88:91], v[180:183]
  v_mfma_f32_16x16x32_bf16 v[180:183], v[36:39], a[92:95], v[180:183]
  v_mfma_f32_16x16x32_bf16 v[176:179], v[36:39], a[28:31], v[176:179]
  v_mfma_f32_16x16x32_bf16 v[176:179], v[32:35], a[24:27], v[176:179]
  s_waitcnt lgkmcnt(4)
  buffer_load_dwordx4 v6, s[8:11], s50 offen offset:2048 lds
  v_mfma_f32_16x16x32_bf16 v[192:195], v[40:43], a[24:27], v[192:195]
  ds_read_b64_tr_b16 v[32:33], v22 offset:0
  ds_read_b64_tr_b16 v[34:35], v22 offset:1024
  v_mfma_f32_16x16x32_bf16 v[192:195], v[44:47], a[28:31], v[192:195]
  ds_read_b64_tr_b16 v[36:37], v22 offset:8192
  ds_read_b64_tr_b16 v[38:39], v22 offset:9216
  v_mfma_f32_16x16x32_bf16 v[196:199], v[44:47], a[92:95], v[196:199]
  v_mfma_f32_16x16x32_bf16 v[196:199], v[40:43], a[88:91], v[196:199]
  buffer_load_dwordx4 v7, s[8:11], s50 offen offset:3072 lds
  v_mfma_f32_16x16x32_bf16 v[200:203], v[40:43], a[152:155], v[200:203]
  v_mfma_f32_16x16x32_bf16 v[200:203], v[44:47], a[156:159], v[200:203]
  v_mfma_f32_16x16x32_bf16 v[204:207], v[44:47], a[220:223], v[204:207]
  v_mfma_f32_16x16x32_bf16 v[204:207], v[40:43], a[216:219], v[204:207]
  s_waitcnt lgkmcnt(4)
  s_lshr_b32 s4, s2, 3
  s_lshl_b32 s4, s4, 2
  s_add_u32 s4, s4, s40
  s_lshl_b32 s4, s4, 14
  s_lshl_b32 s5, s43, 10
  s_add_u32 s4, s4, s5
  s_add_u32 s4, s4, 2097152
  v_lshrrev_b32 v28, 5, v1
  v_lshlrev_b32 v28, 13, v28
  v_and_b32 v29, 7, v1
  v_lshl_add_u32 v28, v29, 7, v28
  v_add_u32 v28, s4, v28
  global_load_dword v27, v28, s[72:73]
  v_mfma_f32_16x16x32_bf16 v[220:223], v[48:51], a[216:219], v[220:223]
  ds_read_b64_tr_b16 v[40:41], v23 offset:0
  ds_read_b64_tr_b16 v[42:43], v23 offset:1024
  v_mfma_f32_16x16x32_bf16 v[220:223], v[52:55], a[220:223], v[220:223]
  ds_read_b64_tr_b16 v[44:45], v23 offset:8192
  ds_read_b64_tr_b16 v[46:47], v23 offset:9216
  v_mfma_f32_16x16x32_bf16 v[216:219], v[52:55], a[156:159], v[216:219]
  v_mfma_f32_16x16x32_bf16 v[216:219], v[48:51], a[152:155], v[216:219]
  v_mfma_f32_16x16x32_bf16 v[212:215], v[48:51], a[88:91], v[212:215]
  v_mfma_f32_16x16x32_bf16 v[212:215], v[52:55], a[92:95], v[212:215]
  v_mfma_f32_16x16x32_bf16 v[208:211], v[52:55], a[28:31], v[208:211]
  v_mfma_f32_16x16x32_bf16 v[208:211], v[48:51], a[24:27], v[208:211]
  s_waitcnt lgkmcnt(4)
  v_mfma_f32_16x16x32_bf16 v[224:227], v[32:35], a[24:27], v[224:227]
  v_mfma_f32_16x16x32_bf16 v[224:227], v[36:39], a[28:31], v[224:227]
  v_mfma_f32_16x16x32_bf16 v[228:231], v[36:39], a[92:95], v[228:231]
  s_waitcnt vmcnt(14) lgkmcnt(0)
  s_barrier
  ds_read_b64_tr_b16 v[48:49], v16 offset:49152
  ds_read_b64_tr_b16 v[50:51], v16 offset:50176
  v_mfma_f32_16x16x32_bf16 v[228:231], v[32:35], a[88:91], v[228:231]
  s_add_u32 m0, s36, 32768
  ds_read_b64_tr_b16 v[52:53], v16 offset:57344
  ds_read_b64_tr_b16 v[54:55], v16 offset:58368
  v_mfma_f32_16x16x32_bf16 v[232:235], v[32:35], a[152:155], v[232:235]
  s_add_u32 s51, s34, 3145728
  ds_read_b128 a[32:35], v12 offset:49152
  ds_read_b128 a[36:39], v13 offset:49152
  v_mfma_f32_16x16x32_bf16 v[232:235], v[36:39], a[156:159], v[232:235]
  ds_read_b128 a[96:99], v12 offset:51200
  ds_read_b128 a[100:103], v13 offset:51200
  v_mfma_f32_16x16x32_bf16 v[236:239], v[36:39], a[220:223], v[236:239]
  ds_read_b128 a[160:163], v12 offset:53248
  ds_read_b128 a[164:167], v13 offset:53248
  v_mfma_f32_16x16x32_bf16 v[236:239], v[32:35], a[216:219], v[236:239]
  ds_read_b128 a[224:227], v12 offset:55296
  ds_read_b128 a[228:231], v13 offset:55296
  v_mfma_f32_16x16x32_bf16 v[252:255], v[40:43], a[216:219], v[252:255]
  ds_read_b64_tr_b16 v[32:33], v17 offset:49152
  ds_read_b64_tr_b16 v[34:35], v17 offset:50176
  v_mfma_f32_16x16x32_bf16 v[252:255], v[44:47], a[220:223], v[252:255]
  ds_read_b64_tr_b16 v[36:37], v17 offset:57344
  ds_read_b64_tr_b16 v[38:39], v17 offset:58368
  v_mfma_f32_16x16x32_bf16 v[248:251], v[44:47], a[156:159], v[248:251]
  buffer_load_dwordx4 v8, s[12:15], s51 offen offset:0 nt lds
  v_mfma_f32_16x16x32_bf16 v[248:251], v[40:43], a[152:155], v[248:251]
  buffer_load_dwordx4 v9, s[12:15], s51 offen offset:1024 nt lds
  v_mfma_f32_16x16x32_bf16 v[244:247], v[40:43], a[88:91], v[244:247]
  v_mfma_f32_16x16x32_bf16 v[244:247], v[44:47], a[92:95], v[244:247]
  v_mfma_f32_16x16x32_bf16 v[240:243], v[44:47], a[28:31], v[240:243]
  v_mfma_f32_16x16x32_bf16 v[240:243], v[40:43], a[24:27], v[240:243]
  s_waitcnt lgkmcnt(4)
  buffer_load_dwordx4 v10, s[12:15], s51 offen offset:2048 nt lds
  v_mfma_f32_16x16x32_bf16 v[128:131], v[48:51], a[32:35], v[128:131]
  ds_read_b64_tr_b16 v[40:41], v18 offset:49152
  ds_read_b64_tr_b16 v[42:43], v18 offset:50176
  v_mfma_f32_16x16x32_bf16 v[128:131], v[52:55], a[36:39], v[128:131]
  ds_read_b64_tr_b16 v[44:45], v18 offset:57344
  ds_read_b64_tr_b16 v[46:47], v18 offset:58368
  v_mfma_f32_16x16x32_bf16 v[132:135], v[52:55], a[100:103], v[132:135]
  buffer_load_dword v24, v25, s[20:23], s55 offen sc1
  v_mfma_f32_16x16x32_bf16 v[132:135], v[48:51], a[96:99], v[132:135]
  buffer_load_dwordx4 v11, s[12:15], s51 offen offset:3072 nt lds
  v_mfma_f32_16x16x32_bf16 v[136:139], v[48:51], a[160:163], v[136:139]
  s_add_u32 m0, s35, 0
  v_mfma_f32_16x16x32_bf16 v[136:139], v[52:55], a[164:167], v[136:139]
  s_add_u32 s50, s33, 768
  v_mfma_f32_16x16x32_bf16 v[140:143], v[52:55], a[228:231], v[140:143]
  v_mfma_f32_16x16x32_bf16 v[140:143], v[48:51], a[224:227], v[140:143]
  s_waitcnt lgkmcnt(4)
  buffer_load_dwordx4 v4, s[8:11], s50 offen offset:0 lds
  v_mfma_f32_16x16x32_bf16 v[156:159], v[32:35], a[224:227], v[156:159]
  ds_read_b64_tr_b16 v[48:49], v19 offset:49152
  ds_read_b64_tr_b16 v[50:51], v19 offset:50176
  v_mfma_f32_16x16x32_bf16 v[156:159], v[36:39], a[228:231], v[156:159]
  ds_read_b64_tr_b16 v[52:53], v19 offset:57344
  ds_read_b64_tr_b16 v[54:55], v19 offset:58368
  v_mfma_f32_16x16x32_bf16 v[152:155], v[36:39], a[164:167], v[152:155]
  v_mfma_f32_16x16x32_bf16 v[152:155], v[32:35], a[160:163], v[152:155]
  buffer_load_dwordx4 v5, s[8:11], s50 offen offset:1024 lds
  v_mfma_f32_16x16x32_bf16 v[148:151], v[32:35], a[96:99], v[148:151]
  v_mfma_f32_16x16x32_bf16 v[148:151], v[36:39], a[100:103], v[148:151]
  v_mfma_f32_16x16x32_bf16 v[144:147], v[36:39], a[36:39], v[144:147]
  v_mfma_f32_16x16x32_bf16 v[144:147], v[32:35], a[32:35], v[144:147]
  s_waitcnt lgkmcnt(4)
  buffer_load_dwordx4 v6, s[8:11], s50 offen offset:2048 lds
  v_mfma_f32_16x16x32_bf16 v[160:163], v[40:43], a[32:35], v[160:163]
  ds_read_b64_tr_b16 v[32:33], v20 offset:49152
  ds_read_b64_tr_b16 v[34:35], v20 offset:50176
  v_mfma_f32_16x16x32_bf16 v[160:163], v[44:47], a[36:39], v[160:163]
  ds_read_b64_tr_b16 v[36:37], v20 offset:57344
  ds_read_b64_tr_b16 v[38:39], v20 offset:58368
  v_mfma_f32_16x16x32_bf16 v[164:167], v[44:47], a[100:103], v[164:167]
  v_mfma_f32_16x16x32_bf16 v[164:167], v[40:43], a[96:99], v[164:167]
  buffer_load_dwordx4 v7, s[8:11], s50 offen offset:3072 lds
  v_mfma_f32_16x16x32_bf16 v[168:171], v[40:43], a[160:163], v[168:171]
  s_add_u32 m0, s35, 4096
  v_mfma_f32_16x16x32_bf16 v[168:171], v[44:47], a[164:167], v[168:171]
  s_add_u32 s50, s50, 32768
  v_mfma_f32_16x16x32_bf16 v[172:175], v[44:47], a[228:231], v[172:175]
  v_mfma_f32_16x16x32_bf16 v[172:175], v[40:43], a[224:227], v[172:175]
  s_waitcnt lgkmcnt(4)
  buffer_load_dwordx4 v4, s[8:11], s50 offen offset:0 lds
  v_mfma_f32_16x16x32_bf16 v[188:191], v[48:51], a[224:227], v[188:191]
  ds_read_b64_tr_b16 v[40:41], v21 offset:49152
  ds_read_b64_tr_b16 v[42:43], v21 offset:50176
  v_mfma_f32_16x16x32_bf16 v[188:191], v[52:55], a[228:231], v[188:191]
  ds_read_b64_tr_b16 v[44:45], v21 offset:57344
  ds_read_b64_tr_b16 v[46:47], v21 offset:58368
  v_mfma_f32_16x16x32_bf16 v[184:187], v[52:55], a[164:167], v[184:187]
  v_mfma_f32_16x16x32_bf16 v[184:187], v[48:51], a[160:163], v[184:187]
  buffer_load_dwordx4 v5, s[8:11], s50 offen offset:1024 lds
  v_mfma_f32_16x16x32_bf16 v[180:183], v[48:51], a[96:99], v[180:183]
  v_mfma_f32_16x16x32_bf16 v[180:183], v[52:55], a[100:103], v[180:183]
  v_mfma_f32_16x16x32_bf16 v[176:179], v[52:55], a[36:39], v[176:179]
  v_mfma_f32_16x16x32_bf16 v[176:179], v[48:51], a[32:35], v[176:179]
  s_waitcnt lgkmcnt(4)
  buffer_load_dwordx4 v6, s[8:11], s50 offen offset:2048 lds
  v_mfma_f32_16x16x32_bf16 v[192:195], v[32:35], a[32:35], v[192:195]
  ds_read_b64_tr_b16 v[48:49], v22 offset:49152
  ds_read_b64_tr_b16 v[50:51], v22 offset:50176
  v_mfma_f32_16x16x32_bf16 v[192:195], v[36:39], a[36:39], v[192:195]
  ds_read_b64_tr_b16 v[52:53], v22 offset:57344
  ds_read_b64_tr_b16 v[54:55], v22 offset:58368
  v_mfma_f32_16x16x32_bf16 v[196:199], v[36:39], a[100:103], v[196:199]
  v_mfma_f32_16x16x32_bf16 v[196:199], v[32:35], a[96:99], v[196:199]
  buffer_load_dwordx4 v7, s[8:11], s50 offen offset:3072 lds
  v_mfma_f32_16x16x32_bf16 v[200:203], v[32:35], a[160:163], v[200:203]
  v_mfma_f32_16x16x32_bf16 v[200:203], v[36:39], a[164:167], v[200:203]
  v_mfma_f32_16x16x32_bf16 v[204:207], v[36:39], a[228:231], v[204:207]
  v_mfma_f32_16x16x32_bf16 v[204:207], v[32:35], a[224:227], v[204:207]
  s_waitcnt lgkmcnt(4)
  s_lshr_b32 s4, s2, 3
  s_lshl_b32 s4, s4, 2
  s_add_u32 s4, s4, s40
  s_lshl_b32 s4, s4, 14
  s_lshl_b32 s5, s43, 10
  s_add_u32 s4, s4, s5
  s_add_u32 s4, s4, 0
  v_lshrrev_b32 v28, 5, v1
  v_lshlrev_b32 v28, 13, v28
  v_and_b32 v29, 7, v1
  v_lshl_add_u32 v28, v29, 7, v28
  v_add_u32 v28, s4, v28
  global_load_dword v27, v28, s[68:69]
  v_mfma_f32_16x16x32_bf16 v[220:223], v[40:43], a[224:227], v[220:223]
  ds_read_b64_tr_b16 v[32:33], v23 offset:49152
  ds_read_b64_tr_b16 v[34:35], v23 offset:50176
  v_mfma_f32_16x16x32_bf16 v[220:223], v[44:47], a[228:231], v[220:223]
  ds_read_b64_tr_b16 v[36:37], v23 offset:57344
  ds_read_b64_tr_b16 v[38:39], v23 offset:58368
  v_mfma_f32_16x16x32_bf16 v[216:219], v[44:47], a[164:167], v[216:219]
  v_mfma_f32_16x16x32_bf16 v[216:219], v[40:43], a[160:163], v[216:219]
  v_mfma_f32_16x16x32_bf16 v[212:215], v[40:43], a[96:99], v[212:215]
  v_mfma_f32_16x16x32_bf16 v[212:215], v[44:47], a[100:103], v[212:215]
  v_mfma_f32_16x16x32_bf16 v[208:211], v[44:47], a[36:39], v[208:211]
  v_mfma_f32_16x16x32_bf16 v[208:211], v[40:43], a[32:35], v[208:211]
  s_waitcnt lgkmcnt(4)
  v_mfma_f32_16x16x32_bf16 v[224:227], v[48:51], a[32:35], v[224:227]
  v_mfma_f32_16x16x32_bf16 v[224:227], v[52:55], a[36:39], v[224:227]
  v_mfma_f32_16x16x32_bf16 v[228:231], v[52:55], a[100:103], v[228:231]
  s_waitcnt vmcnt(15) lgkmcnt(0)
  s_barrier
  v_add_u32 v16, 0x18000, v16
  v_add_u32 v17, 0x18000, v17
  v_add_u32 v18, 0x18000, v18
  v_add_u32 v19, 0x18000, v19
  v_add_u32 v20, 0x18000, v20
  v_add_u32 v21, 0x18000, v21
  v_add_u32 v22, 0x18000, v22
  v_add_u32 v23, 0x18000, v23
  ds_read_b64_tr_b16 v[40:41], v16 offset:0
  ds_read_b64_tr_b16 v[42:43], v16 offset:1024
  v_mfma_f32_16x16x32_bf16 v[228:231], v[48:51], a[96:99], v[228:231]
  s_add_u32 m0, s36, 81920
  ds_read_b64_tr_b16 v[44:45], v16 offset:8192
  ds_read_b64_tr_b16 v[46:47], v16 offset:9216
  v_mfma_f32_16x16x32_bf16 v[232:235], v[48:51], a[160:163], v[232:235]
  s_add_u32 s51, s34, 3670016
  v_add_u32 v12, 0x18000, v12
  v_add_u32 v13, 0x18000, v13
  ds_read_b128 a[40:43], v12 offset:0
  ds_read_b128 a[44:47], v13 offset:0
  v_mfma_f32_16x16x32_bf16 v[232:235], v[52:55], a[164:167], v[232:235]
  ds_read_b128 a[104:107], v12 offset:2048
  ds_read_b128 a[108:111], v13 offset:2048
  v_mfma_f32_16x16x32_bf16 v[236:239], v[52:55], a[228:231], v[236:239]
  ds_read_b128 a[168:171], v12 offset:4096
  ds_read_b128 a[172:175], v13 offset:4096
  v_mfma_f32_16x16x32_bf16 v[236:239], v[48:51], a[224:227], v[236:239]
  ds_read_b128 a[232:235], v12 offset:6144
  ds_read_b128 a[236:239], v13 offset:6144
  v_mfma_f32_16x16x32_bf16 v[252:255], v[32:35], a[224:227], v[252:255]
  ds_read_b64_tr_b16 v[48:49], v17 offset:0
  ds_read_b64_tr_b16 v[50:51], v17 offset:1024
  v_mfma_f32_16x16x32_bf16 v[252:255], v[36:39], a[228:231], v[252:255]
  ds_read_b64_tr_b16 v[52:53], v17 offset:8192
  ds_read_b64_tr_b16 v[54:55], v17 offset:9216
  v_mfma_f32_16x16x32_bf16 v[248:251], v[36:39], a[164:167], v[248:251]
  buffer_load_dwordx4 v8, s[12:15], s51 offen offset:0 nt lds
  v_mfma_f32_16x16x32_bf16 v[248:251], v[32:35], a[160:163], v[248:251]
  buffer_load_dwordx4 v9, s[12:15], s51 offen offset:1024 nt lds
  v_mfma_f32_16x16x32_bf16 v[244:247], v[32:35], a[96:99], v[244:247]
  v_mfma_f32_16x16x32_bf16 v[244:247], v[36:39], a[100:103], v[244:247]
  v_mfma_f32_16x16x32_bf16 v[240:243], v[36:39], a[36:39], v[240:243]
  s_waitcnt vmcnt(12)
  v_cmp_ne_u32 vcc, 1, v24
  s_cbranch_vccz Lspok9
  s_mov_b32 s5, 0
Lspin8:
  s_sleep 16
  buffer_load_dword v24, v25, s[20:23], s55 offen sc1
  s_add_u32 s5, s5, 1
  s_waitcnt vmcnt(0)
  v_cmp_ne_u32 vcc, 1, v24
  s_cbranch_vccz Lspok9
  s_cmp_lt_u32 s5, 0x10000
  s_cbranch_scc1 Lspin8
Lspok9:
  buffer_load_dwordx4 v[96:99], v14, s[20:23], s52 offen sc1
  v_mfma_f32_16x16x32_bf16 v[240:243], v[32:35], a[32:35], v[240:243]
  s_waitcnt lgkmcnt(4)
  buffer_load_dwordx4 v10, s[12:15], s51 offen offset:2048 nt lds
  buffer_load_dword v112, v65, s[20:23], s7 offen sc1
  v_mfma_f32_16x16x32_bf16 v[128:131], v[40:43], a[40:43], v[128:131]
  ds_read_b64_tr_b16 v[32:33], v18 offset:0
  ds_read_b64_tr_b16 v[34:35], v18 offset:1024
  v_mfma_f32_16x16x32_bf16 v[128:131], v[44:47], a[44:47], v[128:131]
  ds_read_b64_tr_b16 v[36:37], v18 offset:8192
  ds_read_b64_tr_b16 v[38:39], v18 offset:9216
  v_mfma_f32_16x16x32_bf16 v[132:135], v[44:47], a[108:111], v[132:135]
  s_add_u32 s52, s52, 12288
  s_add_u32 s7, s7, 12288
  v_mfma_f32_16x16x32_bf16 v[132:135], v[40:43], a[104:107], v[132:135]
  buffer_load_dwordx4 v11, s[12:15], s51 offen offset:3072 nt lds
  buffer_load_dwordx4 v[100:103], v14, s[20:23], s52 offen sc1
  v_mfma_f32_16x16x32_bf16 v[136:139], v[40:43], a[168:171], v[136:139]
  s_add_u32 m0, s35, 49152
  buffer_load_dword v113, v65, s[20:23], s7 offen sc1
  s_add_u32 s52, s52, 12288
  v_mfma_f32_16x16x32_bf16 v[136:139], v[44:47], a[172:175], v[136:139]
  s_add_u32 s50, s33, 896
  s_add_u32 s7, s7, 12288
  buffer_load_dwordx4 v[104:107], v14, s[20:23], s52 offen sc1
  v_mfma_f32_16x16x32_bf16 v[140:143], v[44:47], a[236:239], v[140:143]
  buffer_load_dword v114, v65, s[20:23], s7 offen sc1
  s_add_u32 s52, s52, 12288
  v_mfma_f32_16x16x32_bf16 v[140:143], v[40:43], a[232:235], v[140:143]
  s_waitcnt lgkmcnt(4)
  buffer_load_dwordx4 v4, s[8:11], s50 offen offset:0 lds
  s_add_u32 s7, s7, 12288
  v_mfma_f32_16x16x32_bf16 v[156:159], v[48:51], a[232:235], v[156:159]
  ds_read_b64_tr_b16 v[40:41], v19 offset:0
  ds_read_b64_tr_b16 v[42:43], v19 offset:1024
  v_mfma_f32_16x16x32_bf16 v[156:159], v[52:55], a[236:239], v[156:159]
  ds_read_b64_tr_b16 v[44:45], v19 offset:8192
  ds_read_b64_tr_b16 v[46:47], v19 offset:9216
  v_mfma_f32_16x16x32_bf16 v[152:155], v[52:55], a[172:175], v[152:155]
  buffer_load_dwordx4 v[108:111], v14, s[20:23], s52 offen sc1
  buffer_load_dword v115, v65, s[20:23], s7 offen sc1
  v_mfma_f32_16x16x32_bf16 v[152:155], v[48:51], a[168:171], v[152:155]
  buffer_load_dwordx4 v5, s[8:11], s50 offen offset:1024 lds
  v_mfma_f32_16x16x32_bf16 v[148:151], v[48:51], a[104:107], v[148:151]
  v_mfma_f32_16x16x32_bf16 v[148:151], v[52:55], a[108:111], v[148:151]
  v_mfma_f32_16x16x32_bf16 v[144:147], v[52:55], a[44:47], v[144:147]
  v_mfma_f32_16x16x32_bf16 v[144:147], v[48:51], a[40:43], v[144:147]
  s_waitcnt lgkmcnt(4)
  buffer_load_dwordx4 v6, s[8:11], s50 offen offset:2048 lds
  v_mfma_f32_16x16x32_bf16 v[160:163], v[32:35], a[40:43], v[160:163]
  ds_read_b64_tr_b16 v[48:49], v20 offset:0
  ds_read_b64_tr_b16 v[50:51], v20 offset:1024
  v_mfma_f32_16x16x32_bf16 v[160:163], v[36:39], a[44:47], v[160:163]
  ds_read_b64_tr_b16 v[52:53], v20 offset:8192
  ds_read_b64_tr_b16 v[54:55], v20 offset:9216
  v_mfma_f32_16x16x32_bf16 v[164:167], v[36:39], a[108:111], v[164:167]
  v_mfma_f32_16x16x32_bf16 v[164:167], v[32:35], a[104:107], v[164:167]
  buffer_load_dwordx4 v7, s[8:11], s50 offen offset:3072 lds
  v_mfma_f32_16x16x32_bf16 v[168:171], v[32:35], a[168:171], v[168:171]
  s_add_u32 m0, s35, 53248
  v_mfma_f32_16x16x32_bf16 v[168:171], v[36:39], a[172:175], v[168:171]
  s_add_u32 s50, s50, 32768
  v_mfma_f32_16x16x32_bf16 v[172:175], v[36:39], a[236:239], v[172:175]
  v_mfma_f32_16x16x32_bf16 v[172:175], v[32:35], a[232:235], v[172:175]
  s_waitcnt lgkmcnt(4)
  buffer_load_dwordx4 v4, s[8:11], s50 offen offset:0 lds
  v_mfma_f32_16x16x32_bf16 v[188:191], v[40:43], a[232:235], v[188:191]
  ds_read_b64_tr_b16 v[32:33], v21 offset:0
  ds_read_b64_tr_b16 v[34:35], v21 offset:1024
  v_mfma_f32_16x16x32_bf16 v[188:191], v[44:47], a[236:239], v[188:191]
  ds_read_b64_tr_b16 v[36:37], v21 offset:8192
  ds_read_b64_tr_b16 v[38:39], v21 offset:9216
  v_mfma_f32_16x16x32_bf16 v[184:187], v[44:47], a[172:175], v[184:187]
  v_mfma_f32_16x16x32_bf16 v[184:187], v[40:43], a[168:171], v[184:187]
  buffer_load_dwordx4 v5, s[8:11], s50 offen offset:1024 lds
  v_mfma_f32_16x16x32_bf16 v[180:183], v[40:43], a[104:107], v[180:183]
  v_mfma_f32_16x16x32_bf16 v[180:183], v[44:47], a[108:111], v[180:183]
  v_mfma_f32_16x16x32_bf16 v[176:179], v[44:47], a[44:47], v[176:179]
  v_mfma_f32_16x16x32_bf16 v[176:179], v[40:43], a[40:43], v[176:179]
  s_waitcnt lgkmcnt(4)
  buffer_load_dwordx4 v6, s[8:11], s50 offen offset:2048 lds
  v_mfma_f32_16x16x32_bf16 v[192:195], v[48:51], a[40:43], v[192:195]
  ds_read_b64_tr_b16 v[40:41], v22 offset:0
  ds_read_b64_tr_b16 v[42:43], v22 offset:1024
  v_mfma_f32_16x16x32_bf16 v[192:195], v[52:55], a[44:47], v[192:195]
  ds_read_b64_tr_b16 v[44:45], v22 offset:8192
  ds_read_b64_tr_b16 v[46:47], v22 offset:9216
  v_mfma_f32_16x16x32_bf16 v[196:199], v[52:55], a[108:111], v[196:199]
  v_mfma_f32_16x16x32_bf16 v[196:199], v[48:51], a[104:107], v[196:199]
  buffer_load_dwordx4 v7, s[8:11], s50 offen offset:3072 lds
  v_mfma_f32_16x16x32_bf16 v[200:203], v[48:51], a[168:171], v[200:203]
  v_mfma_f32_16x16x32_bf16 v[200:203], v[52:55], a[172:175], v[200:203]
  v_mfma_f32_16x16x32_bf16 v[204:207], v[52:55], a[236:239], v[204:207]
  v_mfma_f32_16x16x32_bf16 v[204:207], v[48:51], a[232:235], v[204:207]
  s_waitcnt lgkmcnt(4)
  s_lshr_b32 s4, s2, 3
  s_lshl_b32 s4, s4, 2
  s_add_u32 s4, s4, s40
  s_lshl_b32 s4, s4, 14
  s_lshl_b32 s5, s43, 10
  s_add_u32 s4, s4, s5
  s_add_u32 s4, s4, 2097152
  v_lshrrev_b32 v28, 5, v1
  v_lshlrev_b32 v28, 13, v28
  v_and_b32 v29, 7, v1
  v_lshl_add_u32 v28, v29, 7, v28
  v_add_u32 v28, s4, v28
  global_load_dword v27, v28, s[68:69]
  v_mfma_f32_16x16x32_bf16 v[220:223], v[32:35], a[232:235], v[220:223]
  ds_read_b64_tr_b16 v[48:49], v23 offset:0
  ds_read_b64_tr_b16 v[50:51], v23 offset:1024
  v_mfma_f32_16x16x32_bf16 v[220:223], v[36:39], a[236:239], v[220:223]
  ds_read_b64_tr_b16 v[52:53], v23 offset:8192
  ds_read_b64_tr_b16 v[54:55], v23 offset:9216
  v_mfma_f32_16x16x32_bf16 v[216:219], v[36:39], a[172:175], v[216:219]
  v_mfma_f32_16x16x32_bf16 v[216:219], v[32:35], a[168:171], v[216:219]
  v_mfma_f32_16x16x32_bf16 v[212:215], v[32:35], a[104:107], v[212:215]
  v_mfma_f32_16x16x32_bf16 v[212:215], v[36:39], a[108:111], v[212:215]
  v_mfma_f32_16x16x32_bf16 v[208:211], v[36:39], a[44:47], v[208:211]
  v_mfma_f32_16x16x32_bf16 v[208:211], v[32:35], a[40:43], v[208:211]
  s_waitcnt lgkmcnt(4)
  v_mfma_f32_16x16x32_bf16 v[224:227], v[40:43], a[40:43], v[224:227]
  v_mfma_f32_16x16x32_bf16 v[224:227], v[44:47], a[44:47], v[224:227]
  v_mfma_f32_16x16x32_bf16 v[228:231], v[44:47], a[108:111], v[228:231]
  s_waitcnt vmcnt(22) lgkmcnt(0)
  s_barrier
  v_add_u32 v16, 0xfffe8000, v16
  v_add_u32 v17, 0xfffe8000, v17
  v_add_u32 v18, 0xfffe8000, v18
  v_add_u32 v19, 0xfffe8000, v19
  v_add_u32 v20, 0xfffe8000, v20
  v_add_u32 v21, 0xfffe8000, v21
  v_add_u32 v22, 0xfffe8000, v22
  v_add_u32 v23, 0xfffe8000, v23
  ds_read_b64_tr_b16 v[32:33], v16 offset:0
  ds_read_b64_tr_b16 v[34:35], v16 offset:1024
  v_mfma_f32_16x16x32_bf16 v[228:231], v[40:43], a[104:107], v[228:231]
  s_add_u32 m0, s36, 98304
  ds_read_b64_tr_b16 v[36:37], v16 offset:8192
  ds_read_b64_tr_b16 v[38:39], v16 offset:9216
  v_mfma_f32_16x16x32_bf16 v[232:235], v[40:43], a[168:171], v[232:235]
  s_add_u32 s51, s34, 0
  v_add_u32 v12, 0xfffe8000, v12
  v_add_u32 v13, 0xfffe8000, v13
  ds_read_b128 a[48:51], v12 offset:0
  ds_read_b128 a[52:55], v13 offset:0
  v_mfma_f32_16x16x32_bf16 v[232:235], v[44:47], a[172:175], v[232:235]
  ds_read_b128 a[112:115], v12 offset:2048
  ds_read_b128 a[116:119], v13 offset:2048
  v_mfma_f32_16x16x32_bf16 v[236:239], v[44:47], a[236:239], v[236:239]
  ds_read_b128 a[176:179], v12 offset:4096
  ds_read_b128 a[180:183], v13 offset:4096
  v_mfma_f32_16x16x32_bf16 v[236:239], v[40:43], a[232:235], v[236:239]
  ds_read_b128 a[240:243], v12 offset:6144
  ds_read_b128 a[244:247], v13 offset:6144
  v_mfma_f32_16x16x32_bf16 v[252:255], v[48:51], a[232:235], v[252:255]
  ds_read_b64_tr_b16 v[40:41], v17 offset:0
  ds_read_b64_tr_b16 v[42:43], v17 offset:1024
  v_mfma_f32_16x16x32_bf16 v[252:255], v[52:55], a[236:239], v[252:255]
  ds_read_b64_tr_b16 v[44:45], v17 offset:8192
  ds_read_b64_tr_b16 v[46:47], v17 offset:9216
  v_mfma_f32_16x16x32_bf16 v[248:251], v[52:55], a[172:175], v[248:251]
  buffer_load_dwordx4 v8, s[16:19], s51 offen offset:0 lds
  v_mfma_f32_16x16x32_bf16 v[248:251], v[48:51], a[168:171], v[248:251]
  buffer_load_dwordx4 v9, s[16:19], s51 offen offset:1024 lds
  v_mfma_f32_16x16x32_bf16 v[244:247], v[48:51], a[104:107], v[244:247]
  v_mfma_f32_16x16x32_bf16 v[244:247], v[52:55], a[108:111], v[244:247]
  v_mfma_f32_16x16x32_bf16 v[240:243], v[52:55], a[44:47], v[240:243]
  v_mfma_f32_16x16x32_bf16 v[240:243], v[48:51], a[40:43], v[240:243]
  s_waitcnt lgkmcnt(4)
  buffer_load_dwordx4 v10, s[16:19], s51 offen offset:2048 lds
  v_mfma_f32_16x16x32_bf16 v[128:131], v[32:35], a[48:51], v[128:131]
  ds_read_b64_tr_b16 v[48:49], v18 offset:0
  ds_read_b64_tr_b16 v[50:51], v18 offset:1024
  v_mfma_f32_16x16x32_bf16 v[128:131], v[36:39], a[52:55], v[128:131]
  ds_read_b64_tr_b16 v[52:53], v18 offset:8192
  ds_read_b64_tr_b16 v[54:55], v18 offset:9216
  v_mfma_f32_16x16x32_bf16 v[132:135], v[36:39], a[116:119], v[132:135]
  v_mfma_f32_16x16x32_bf16 v[132:135], v[32:35], a[112:115], v[132:135]
  buffer_load_dwordx4 v11, s[16:19], s51 offen offset:3072 lds
  v_mfma_f32_16x16x32_bf16 v[136:139], v[32:35], a[176:179], v[136:139]
  s_add_u32 m0, s36, 114688
  v_mfma_f32_16x16x32_bf16 v[136:139], v[36:39], a[180:183], v[136:139]
  s_add_u32 s51, s34, 524288
  v_mfma_f32_16x16x32_bf16 v[140:143], v[36:39], a[244:247], v[140:143]
  s_waitcnt vmcnt(12)
  v_add_f32 v96, v96, v100
  v_mfma_f32_16x16x32_bf16 v[140:143], v[32:35], a[240:243], v[140:143]
  s_waitcnt lgkmcnt(4)
  buffer_load_dwordx4 v8, s[16:19], s51 offen offset:0 lds
  v_add_f32 v104, v104, v108
  v_mfma_f32_16x16x32_bf16 v[156:159], v[40:43], a[240:243], v[156:159]
  ds_read_b64_tr_b16 v[32:33], v19 offset:0
  ds_read_b64_tr_b16 v[34:35], v19 offset:1024
  v_mfma_f32_16x16x32_bf16 v[156:159], v[44:47], a[244:247], v[156:159]
  ds_read_b64_tr_b16 v[36:37], v19 offset:8192
  ds_read_b64_tr_b16 v[38:39], v19 offset:9216
  v_mfma_f32_16x16x32_bf16 v[152:155], v[44:47], a[180:183], v[152:155]
  v_add_f32 v97, v97, v101
  v_add_f32 v105, v105, v109
  v_mfma_f32_16x16x32_bf16 v[152:155], v[40:43], a[176:179], v[152:155]
  buffer_load_dwordx4 v9, s[16:19], s51 offen offset:1024 lds
  v_add_f32 v98, v98, v102
  v_mfma_f32_16x16x32_bf16 v[148:151], v[40:43], a[112:115], v[148:151]
  v_add_f32 v106, v106, v110
  v_add_f32 v99, v99, v103
  v_mfma_f32_16x16x32_bf16 v[148:151], v[44:47], a[116:119], v[148:151]
  v_add_f32 v107, v107, v111
  v_add_f32 v96, v96, v104
  v_mfma_f32_16x16x32_bf16 v[144:147], v[44:47], a[52:55], v[144:147]
  v_add_f32 v97, v97, v105
  v_add_f32 v98, v98, v106
  v_mfma_f32_16x16x32_bf16 v[144:147], v[40:43], a[48:51], v[144:147]
  s_waitcnt lgkmcnt(4)
  buffer_load_dwordx4 v10, s[16:19], s51 offen offset:2048 lds
  v_add_f32 v99, v99, v107
  v_mfma_f32_16x16x32_bf16 v[160:163], v[48:51], a[48:51], v[160:163]
  ds_read_b64_tr_b16 v[40:41], v20 offset:0
  ds_read_b64_tr_b16 v[42:43], v20 offset:1024
  v_mfma_f32_16x16x32_bf16 v[160:163], v[52:55], a[52:55], v[160:163]
  ds_read_b64_tr_b16 v[44:45], v20 offset:8192
  ds_read_b64_tr_b16 v[46:47], v20 offset:9216
  v_mfma_f32_16x16x32_bf16 v[164:167], v[52:55], a[116:119], v[164:167]
  v_cvt_pk_bf16_f32 v100, v96, v97
  v_cvt_pk_bf16_f32 v101, v98, v99
  v_mfma_f32_16x16x32_bf16 v[164:167], v[48:51], a[112:115], v[164:167]
  buffer_load_dwordx4 v11, s[16:19], s51 offen offset:3072 lds
  v_lshlrev_b32 v96, 16, v100
  v_mfma_f32_16x16x32_bf16 v[168:171], v[48:51], a[176:179], v[168:171]
  s_add_u32 m0, s36, 131072
  v_and_b32 v97, 0xffff0000, v100
  v_lshlrev_b32 v98, 16, v101
  v_mfma_f32_16x16x32_bf16 v[168:171], v[52:55], a[180:183], v[168:171]
  s_add_u32 s51, s34, 1048576
  v_and_b32 v99, 0xffff0000, v101
  v_add_f32 v96, v96, v64
  v_mfma_f32_16x16x32_bf16 v[172:175], v[52:55], a[244:247], v[172:175]
  v_add_f32 v97, v97, v64
  v_add_f32 v98, v98, v64
  v_mfma_f32_16x16x32_bf16 v[172:175], v[48:51], a[240:243], v[172:175]
  s_waitcnt lgkmcnt(4)
  buffer_load_dwordx4 v8, s[16:19], s51 offen offset:0 lds
  v_add_f32 v99, v99, v64
  v_mfma_f32_16x16x32_bf16 v[188:191], v[32:35], a[240:243], v[188:191]
  ds_read_b64_tr_b16 v[48:49], v21 offset:0
  ds_read_b64_tr_b16 v[50:51], v21 offset:1024
  v_mfma_f32_16x16x32_bf16 v[188:191], v[36:39], a[244:247], v[188:191]
  ds_read_b64_tr_b16 v[52:53], v21 offset:8192
  ds_read_b64_tr_b16 v[54:55], v21 offset:9216
  v_mfma_f32_16x16x32_bf16 v[184:187], v[36:39], a[180:183], v[184:187]
  v_cvt_pk_bf16_f32 v100, v96, v97
  v_cvt_pk_bf16_f32 v101, v98, v99
  v_mfma_f32_16x16x32_bf16 v[184:187], v[32:35], a[176:179], v[184:187]
  buffer_load_dwordx4 v9, s[16:19], s51 offen offset:1024 lds
  v_lshlrev_b32 v96, 16, v100
  v_mfma_f32_16x16x32_bf16 v[180:183], v[32:35], a[112:115], v[180:183]
  v_and_b32 v97, 0xffff0000, v100
  v_lshlrev_b32 v98, 16, v101
  v_mfma_f32_16x16x32_bf16 v[180:183], v[36:39], a[116:119], v[180:183]
  v_and_b32 v99, 0xffff0000, v101
  ds_write_b128 v15, v[96:99]
  v_mfma_f32_16x16x32_bf16 v[176:179], v[36:39], a[52:55], v[176:179]
  s_cmp_lg_u32 s40, 0
  s_cbranch_scc1 Lfin10
  v_add_f32 v112, v112, v113
  v_add_f32 v114, v114, v115
  s_lshr_b32 s4, s2, 6
  s_cmp_eq_u32 s4, 2
  s_cselect_b32 s5, 1.0, 0
  v_add_f32 v112, v112, v114
  v_cvt_pk_bf16_f32 v112, v112, v112
  v_lshlrev_b32 v112, 16, v112
  v_add_f32 v112, s5, v112
  v_cvt_pk_bf16_f32 v112, v112, v112
  v_lshlrev_b32 v112, 16, v112
  s_lshl_b32 s4, s2, 5
  s_add_u32 s5, s4, 62918656
  s_lshr_b32 s4, s4, 1
  s_add_u32 s4, s4, 62932992
  v_lshrrev_b32 v113, 1, v65
  s_mov_b64 exec, 0xff
  buffer_store_dword v112, v65, s[20:23], s5 offen sc1
  buffer_store_short_d16_hi v112, v113, s[20:23], s4 offen sc1
  v_mov_b32 v114, 0x3f803f80
  s_lshl_b32 s4, s2, 2
  s_add_u32 s4, s4, 62930944
  s_mov_b64 exec, 1
  buffer_store_dword v114, off, s[20:23], s4 sc1
  s_mov_b64 exec, -1
Lfin10:
  s_waitcnt lgkmcnt(0)
  v_mfma_f32_16x16x32_bf16 v[176:179], v[32:35], a[48:51], v[176:179]
  buffer_load_dwordx4 v10, s[16:19], s51 offen offset:2048 lds
  ds_read_b128 v[96:99], v3 offset:0
  v_mfma_f32_16x16x32_bf16 v[192:195], v[40:43], a[48:51], v[192:195]
  ds_read_b64_tr_b16 v[32:33], v22 offset:0
  ds_read_b64_tr_b16 v[34:35], v22 offset:1024
  v_mfma_f32_16x16x32_bf16 v[192:195], v[44:47], a[52:55], v[192:195]
  ds_read_b64_tr_b16 v[36:37], v22 offset:8192
  ds_read_b64_tr_b16 v[38:39], v22 offset:9216
  v_mfma_f32_16x16x32_bf16 v[196:199], v[44:47], a[116:119], v[196:199]
  ds_read_b128 v[100:103], v3 offset:16
  ds_read_b128 v[104:107], v3 offset:512
  v_mfma_f32_16x16x32_bf16 v[196:199], v[40:43], a[112:115], v[196:199]
  buffer_load_dwordx4 v11, s[16:19], s51 offen offset:3072 lds
  ds_read_b128 v[108:111], v3 offset:528
  v_mfma_f32_16x16x32_bf16 v[200:203], v[40:43], a[176:179], v[200:203]
  ds_read_b128 v[112:115], v3 offset:256
  ds_read_b128 v[116:119], v3 offset:272
  v_mfma_f32_16x16x32_bf16 v[200:203], v[44:47], a[180:183], v[200:203]
  ds_read_b128 v[120:123], v3 offset:768
  ds_read_b128 v[124:127], v3 offset:784
  v_mfma_f32_16x16x32_bf16 v[204:207], v[44:47], a[244:247], v[204:207]
  v_mfma_f32_16x16x32_bf16 v[204:207], v[40:43], a[240:243], v[204:207]
  v_mfma_f32_16x16x32_bf16 v[220:223], v[48:51], a[240:243], v[220:223]
  ds_read_b64_tr_b16 v[40:41], v23 offset:0
  ds_read_b64_tr_b16 v[42:43], v23 offset:1024
  v_mfma_f32_16x16x32_bf16 v[220:223], v[52:55], a[244:247], v[220:223]
  ds_read_b64_tr_b16 v[44:45], v23 offset:8192
  ds_read_b64_tr_b16 v[46:47], v23 offset:9216
  v_mfma_f32_16x16x32_bf16 v[216:219], v[52:55], a[180:183], v[216:219]
  v_mfma_f32_16x16x32_bf16 v[216:219], v[48:51], a[176:179], v[216:219]
  s_waitcnt lgkmcnt(4)
  v_fma_f32 v80, v80, v104, v96
  v_mfma_f32_16x16x32_bf16 v[212:215], v[48:51], a[112:115], v[212:215]
  v_mul_f32 v80, s6, v80
  v_fma_f32 v81, v81, v105, v97
  v_mfma_f32_16x16x32_bf16 v[212:215], v[52:55], a[116:119], v[212:215]
  v_mul_f32 v81, s6, v81
  v_fma_f32 v82, v82, v106, v98
  v_mfma_f32_16x16x32_bf16 v[208:211], v[52:55], a[52:55], v[208:211]
  v_mul_f32 v82, s6, v82
  v_fma_f32 v83, v83, v107, v99
  v_mfma_f32_16x16x32_bf16 v[208:211], v[48:51], a[48:51], v[208:211]
  v_mul_f32 v83, s6, v83
  v_fma_f32 v84, v84, v108, v100
  v_mfma_f32_16x16x32_bf16 v[224:227], v[32:35], a[48:51], v[224:227]
  v_mul_f32 v84, s6, v84
  v_fma_f32 v85, v85, v109, v101
  v_mfma_f32_16x16x32_bf16 v[224:227], v[36:39], a[52:55], v[224:227]
  v_mul_f32 v85, s6, v85
  v_fma_f32 v86, v86, v110, v102
  v_mfma_f32_16x16x32_bf16 v[228:231], v[36:39], a[116:119], v[228:231]
  s_waitcnt vmcnt(13) lgkmcnt(0)
  s_barrier
  ds_read_b64_tr_b16 v[48:49], v16 offset:49152
  ds_read_b64_tr_b16 v[50:51], v16 offset:50176
  v_mfma_f32_16x16x32_bf16 v[228:231], v[32:35], a[112:115], v[228:231]
  s_add_u32 m0, s36, 0
  ds_read_b64_tr_b16 v[52:53], v16 offset:57344
  ds_read_b64_tr_b16 v[54:55], v16 offset:58368
  v_mfma_f32_16x16x32_bf16 v[232:235], v[32:35], a[176:179], v[232:235]
  s_add_u32 s51, s34, 2097152
  ds_read_b128 a[56:59], v12 offset:49152
  ds_read_b128 a[60:63], v13 offset:49152
  v_mfma_f32_16x16x32_bf16 v[232:235], v[36:39], a[180:183], v[232:235]
  ds_read_b128 a[120:123], v12 offset:51200
  ds_read_b128 a[124:127], v13 offset:51200
  v_mfma_f32_16x16x32_bf16 v[236:239], v[36:39], a[244:247], v[236:239]
  ds_read_b128 a[184:187], v12 offset:53248
  ds_read_b128 a[188:191], v13 offset:53248
  v_mfma_f32_16x16x32_bf16 v[236:239], v[32:35], a[240:243], v[236:239]
  ds_read_b128 a[248:251], v12 offset:55296
  ds_read_b128 a[252:255], v13 offset:55296
  v_mfma_f32_16x16x32_bf16 v[252:255], v[40:43], a[240:243], v[252:255]
  ds_read_b64_tr_b16 v[32:33], v17 offset:49152
  ds_read_b64_tr_b16 v[34:35], v17 offset:50176
  v_mfma_f32_16x16x32_bf16 v[252:255], v[44:47], a[244:247], v[252:255]
  ds_read_b64_tr_b16 v[36:37], v17 offset:57344
  ds_read_b64_tr_b16 v[38:39], v17 offset:58368
  v_mfma_f32_16x16x32_bf16 v[248:251], v[44:47], a[180:183], v[248:251]
  buffer_load_dwordx4 v8, s[16:19], s51 offen offset:0 lds
  v_mul_f32 v86, s6, v86
  v_mfma_f32_16x16x32_bf16 v[248:251], v[40:43], a[176:179], v[248:251]
  buffer_load_dwordx4 v9, s[16:19], s51 offen offset:1024 lds
  v_fma_f32 v87, v87, v111, v103
  v_mfma_f32_16x16x32_bf16 v[244:247], v[40:43], a[112:115], v[244:247]
  v_mul_f32 v87, s6, v87
  v_fma_f32 v88, v88, v120, v112
  v_mfma_f32_16x16x32_bf16 v[244:247], v[44:47], a[116:119], v[244:247]
  v_mul_f32 v88, s6, v88
  v_fma_f32 v89, v89, v121, v113
  v_mfma_f32_16x16x32_bf16 v[240:243], v[44:47], a[52:55], v[240:243]
  v_mul_f32 v89, s6, v89
  v_fma_f32 v90, v90, v122, v114
  v_mfma_f32_16x16x32_bf16 v[240:243], v[40:43], a[48:51], v[240:243]
  s_waitcnt lgkmcnt(4)
  buffer_load_dwordx4 v10, s[16:19], s51 offen offset:2048 lds
  v_mul_f32 v90, s6, v90
  v_mfma_f32_16x16x32_bf16 v[128:131], v[48:51], a[56:59], v[128:131]
  ds_read_b64_tr_b16 v[40:41], v18 offset:49152
  ds_read_b64_tr_b16 v[42:43], v18 offset:50176
  v_mfma_f32_16x16x32_bf16 v[128:131], v[52:55], a[60:63], v[128:131]
  ds_read_b64_tr_b16 v[44:45], v18 offset:57344
  ds_read_b64_tr_b16 v[46:47], v18 offset:58368
  v_mfma_f32_16x16x32_bf16 v[132:135], v[52:55], a[124:127], v[132:135]
  v_fma_f32 v91, v91, v123, v115
  v_mul_f32 v91, s6, v91
  v_mfma_f32_16x16x32_bf16 v[132:135], v[48:51], a[120:123], v[132:135]
  buffer_load_dwordx4 v11, s[16:19], s51 offen offset:3072 lds
  v_fma_f32 v92, v92, v124, v116
  v_mfma_f32_16x16x32_bf16 v[136:139], v[48:51], a[184:187], v[136:139]
  s_add_u32 m0, s36, 16384
  v_mul_f32 v92, s6, v92
  v_fma_f32 v93, v93, v125, v117
  v_mfma_f32_16x16x32_bf16 v[136:139], v[52:55], a[188:191], v[136:139]
  s_add_u32 s51, s34, 2621440
  v_mul_f32 v93, s6, v93
  v_fma_f32 v94, v94, v126, v118
  v_mfma_f32_16x16x32_bf16 v[140:143], v[52:55], a[252:255], v[140:143]
  v_mul_f32 v94, s6, v94
  v_fma_f32 v95, v95, v127, v119
  v_mfma_f32_16x16x32_bf16 v[140:143], v[48:51], a[248:251], v[140:143]
  s_waitcnt lgkmcnt(4)
  buffer_load_dwordx4 v8, s[16:19], s51 offen offset:0 lds
  v_mul_f32 v95, s6, v95
  v_mfma_f32_16x16x32_bf16 v[156:159], v[32:35], a[248:251], v[156:159]
  ds_read_b64_tr_b16 v[48:49], v19 offset:49152
  ds_read_b64_tr_b16 v[50:51], v19 offset:50176
  v_mfma_f32_16x16x32_bf16 v[156:159], v[36:39], a[252:255], v[156:159]
  ds_read_b64_tr_b16 v[52:53], v19 offset:57344
  ds_read_b64_tr_b16 v[54:55], v19 offset:58368
  v_mfma_f32_16x16x32_bf16 v[152:155], v[36:39], a[188:191], v[152:155]
  v_cvt_pk_bf16_f32 v56, v80, v81
  v_cvt_pk_bf16_f32 v57, v82, v83
  v_mfma_f32_16x16x32_bf16 v[152:155], v[32:35], a[184:187], v[152:155]
  buffer_load_dwordx4 v9, s[16:19], s51 offen offset:1024 lds
  v_cvt_pk_bf16_f32 v58, v84, v85
  v_mfma_f32_16x16x32_bf16 v[148:151], v[32:35], a[120:123], v[148:151]
  v_cvt_pk_bf16_f32 v59, v86, v87
  v_cvt_pk_bf16_f32 v60, v88, v89
  v_mfma_f32_16x16x32_bf16 v[148:151], v[36:39], a[124:127], v[148:151]
  v_cvt_pk_bf16_f32 v61, v90, v91
  v_cvt_pk_bf16_f32 v62, v92, v93
  v_mfma_f32_16x16x32_bf16 v[144:147], v[36:39], a[60:63], v[144:147]
  v_cvt_pk_bf16_f32 v63, v94, v95
  buffer_store_dwordx4 v[56:59], v30, s[20:23], s53 offen sc1
  v_mfma_f32_16x16x32_bf16 v[144:147], v[32:35], a[56:59], v[144:147]
  s_waitcnt lgkmcnt(4)
  buffer_load_dwordx4 v10, s[16:19], s51 offen offset:2048 lds
  buffer_store_dwordx4 v[60:63], v30, s[20:23], s53 offen offset:2048 sc1
  v_mfma_f32_16x16x32_bf16 v[160:163], v[40:43], a[56:59], v[160:163]
  ds_read_b64_tr_b16 v[32:33], v20 offset:49152
  ds_read_b64_tr_b16 v[34:35], v20 offset:50176
  v_mfma_f32_16x16x32_bf16 v[160:163], v[44:47], a[60:63], v[160:163]
  ds_read_b64_tr_b16 v[36:37], v20 offset:57344
  ds_read_b64_tr_b16 v[38:39], v20 offset:58368
  v_mfma_f32_16x16x32_bf16 v[164:167], v[44:47], a[124:127], v[164:167]
  v_cvt_pk_bf16_f32 v64, v128, v129
  v_cvt_pk_bf16_f32 v65, v130, v131
  v_mfma_f32_16x16x32_bf16 v[164:167], v[40:43], a[120:123], v[164:167]
  buffer_load_dwordx4 v11, s[16:19], s51 offen offset:3072 lds
  v_cvt_pk_bf16_f32 v66, v144, v145
  v_mfma_f32_16x16x32_bf16 v[168:171], v[40:43], a[184:187], v[168:171]
  s_add_u32 m0, s36, 32768
  v_cvt_pk_bf16_f32 v67, v146, v147
  v_cvt_pk_bf16_f32 v68, v132, v133
  v_mfma_f32_16x16x32_bf16 v[168:171], v[44:47], a[188:191], v[168:171]
  s_add_u32 s51, s34, 3145728
  v_cvt_pk_bf16_f32 v69, v134, v135
  v_cvt_pk_bf16_f32 v70, v148, v149
  v_mfma_f32_16x16x32_bf16 v[172:175], v[44:47], a[252:255], v[172:175]
  v_cvt_pk_bf16_f32 v71, v150, v151
  v_cvt_pk_bf16_f32 v72, v136, v137
  v_mfma_f32_16x16x32_bf16 v[172:175], v[40:43], a[248:251], v[172:175]
  s_waitcnt lgkmcnt(4)
  buffer_load_dwordx4 v8, s[16:19], s51 offen offset:0 lds
  v_cvt_pk_bf16_f32 v73, v138, v139
  v_mfma_f32_16x16x32_bf16 v[188:191], v[48:51], a[248:251], v[188:191]
  ds_read_b64_tr_b16 v[40:41], v21 offset:49152
  ds_read_b64_tr_b16 v[42:43], v21 offset:50176
  v_mfma_f32_16x16x32_bf16 v[188:191], v[52:55], a[252:255], v[188:191]
  ds_read_b64_tr_b16 v[44:45], v21 offset:57344
  ds_read_b64_tr_b16 v[46:47], v21 offset:58368
  v_mfma_f32_16x16x32_bf16 v[184:187], v[52:55], a[188:191], v[184:187]
  v_cvt_pk_bf16_f32 v74, v152, v153
  v_cvt_pk_bf16_f32 v75, v154, v155
  v_mfma_f32_16x16x32_bf16 v[184:187], v[48:51], a[184:187], v[184:187]
  buffer_load_dwordx4 v9, s[16:19], s51 offen offset:1024 lds
  v_cvt_pk_bf16_f32 v76, v140, v141
  v_mfma_f32_16x16x32_bf16 v[180:183], v[48:51], a[120:123], v[180:183]
  v_cvt_pk_bf16_f32 v77, v142, v143
  v_cvt_pk_bf16_f32 v78, v156, v157
  v_mfma_f32_16x16x32_bf16 v[180:183], v[52:55], a[124:127], v[180:183]
  v_cvt_pk_bf16_f32 v79, v158, v159
  s_add_u32 s39, s37, 0
  buffer_store_dwordx4 v[64:67], v2, s[20:23], s39 offen sc1
  v_mfma_f32_16x16x32_bf16 v[176:179], v[52:55], a[60:63], v[176:179]
  v_mfma_f32_16x16x32_bf16 v[176:179], v[48:51], a[56:59], v[176:179]
  s_waitcnt lgkmcnt(4)
  buffer_load_dwordx4 v10, s[16:19], s51 offen offset:2048 lds
  v_mfma_f32_16x16x32_bf16 v[192:195], v[32:35], a[56:59], v[192:195]
  ds_read_b64_tr_b16 v[48:49], v22 offset:49152
  ds_read_b64_tr_b16 v[50:51], v22 offset:50176
  v_mfma_f32_16x16x32_bf16 v[192:195], v[36:39], a[60:63], v[192:195]
  ds_read_b64_tr_b16 v[52:53], v22 offset:57344
  ds_read_b64_tr_b16 v[54:55], v22 offset:58368
  v_mfma_f32_16x16x32_bf16 v[196:199], v[36:39], a[124:127], v[196:199]
  v_cvt_pk_bf16_f32 v80, v160, v161
  v_cvt_pk_bf16_f32 v81, v162, v163
  v_mfma_f32_16x16x32_bf16 v[196:199], v[32:35], a[120:123], v[196:199]
  buffer_load_dwordx4 v11, s[16:19], s51 offen offset:3072 lds
  v_cvt_pk_bf16_f32 v82, v176, v177
  v_mfma_f32_16x16x32_bf16 v[200:203], v[32:35], a[184:187], v[200:203]
  v_cvt_pk_bf16_f32 v83, v178, v179
  v_cvt_pk_bf16_f32 v84, v164, v165
  v_mfma_f32_16x16x32_bf16 v[200:203], v[36:39], a[188:191], v[200:203]
  v_cvt_pk_bf16_f32 v85, v166, v167
  v_cvt_pk_bf16_f32 v86, v180, v181
  v_mfma_f32_16x16x32_bf16 v[204:207], v[36:39], a[252:255], v[204:207]
  v_cvt_pk_bf16_f32 v87, v182, v183
  v_cvt_pk_bf16_f32 v88, v168, v169
  v_mfma_f32_16x16x32_bf16 v[204:207], v[32:35], a[248:251], v[204:207]
  s_waitcnt lgkmcnt(4)
  v_cvt_pk_bf16_f32 v89, v170, v171
  v_cvt_pk_bf16_f32 v90, v184, v185
  v_mfma_f32_16x16x32_bf16 v[220:223], v[40:43], a[248:251], v[220:223]
  ds_read_b64_tr_b16 v[32:33], v23 offset:49152
  ds_read_b64_tr_b16 v[34:35], v23 offset:50176
  v_mfma_f32_16x16x32_bf16 v[220:223], v[44:47], a[252:255], v[220:223]
  ds_read_b64_tr_b16 v[36:37], v23 offset:57344
  ds_read_b64_tr_b16 v[38:39], v23 offset:58368
  v_mfma_f32_16x16x32_bf16 v[216:219], v[44:47], a[188:191], v[216:219]
  v_cvt_pk_bf16_f32 v91, v186, v187
  v_cvt_pk_bf16_f32 v92, v172, v173
  v_mfma_f32_16x16x32_bf16 v[216:219], v[40:43], a[184:187], v[216:219]
  v_cvt_pk_bf16_f32 v93, v174, v175
  v_cvt_pk_bf16_f32 v94, v188, v189
  v_mfma_f32_16x16x32_bf16 v[212:215], v[40:43], a[120:123], v[212:215]
  v_cvt_pk_bf16_f32 v95, v190, v191
  v_mfma_f32_16x16x32_bf16 v[212:215], v[44:47], a[124:127], v[212:215]
  v_mfma_f32_16x16x32_bf16 v[208:211], v[44:47], a[60:63], v[208:211]
  v_mfma_f32_16x16x32_bf16 v[208:211], v[40:43], a[56:59], v[208:211]
  s_waitcnt lgkmcnt(4)
  v_mfma_f32_16x16x32_bf16 v[224:227], v[48:51], a[56:59], v[224:227]
  v_mfma_f32_16x16x32_bf16 v[224:227], v[52:55], a[60:63], v[224:227]
  v_mfma_f32_16x16x32_bf16 v[228:231], v[52:55], a[124:127], v[228:231]
  s_waitcnt vmcnt(15) lgkmcnt(0)
  s_barrier
  v_add_u32 v16, 0x10000, v16
  v_add_u32 v17, 0x10000, v17
  v_add_u32 v18, 0x10000, v18
  v_add_u32 v19, 0x10000, v19
  v_add_u32 v20, 0x10000, v20
  v_add_u32 v21, 0x10000, v21
  v_add_u32 v22, 0x10000, v22
  v_add_u32 v23, 0x10000, v23
  ds_read_b64_tr_b16 v[40:41], v16 offset:0
  ds_read_b64_tr_b16 v[42:43], v16 offset:1024
  v_mfma_f32_16x16x32_bf16 v[228:231], v[48:51], a[120:123], v[228:231]
  s_add_u32 m0, s36, 147456
  ds_read_b64_tr_b16 v[44:45], v16 offset:8192
  ds_read_b64_tr_b16 v[46:47], v16 offset:9216
  v_mfma_f32_16x16x32_bf16 v[232:235], v[48:51], a[184:187], v[232:235]
  s_add_u32 s51, s34, 1572864
  buffer_load_dwordx4 v8, s[16:19], s51 offen offset:0 lds
  v_cvt_pk_bf16_f32 v96, v192, v193
  v_mfma_f32_16x16x32_bf16 v[232:235], v[52:55], a[188:191], v[232:235]
  buffer_load_dwordx4 v9, s[16:19], s51 offen offset:1024 lds
  v_cvt_pk_bf16_f32 v97, v194, v195
  v_mfma_f32_16x16x32_bf16 v[236:239], v[52:55], a[252:255], v[236:239]
  v_cvt_pk_bf16_f32 v98, v208, v209
  v_cvt_pk_bf16_f32 v99, v210, v211
  v_mfma_f32_16x16x32_bf16 v[236:239], v[48:51], a[248:251], v[236:239]
  v_cvt_pk_bf16_f32 v100, v196, v197
  v_cvt_pk_bf16_f32 v101, v198, v199
  v_mfma_f32_16x16x32_bf16 v[252:255], v[32:35], a[248:251], v[252:255]
  ds_read_b64_tr_b16 v[48:49], v17 offset:0
  ds_read_b64_tr_b16 v[50:51], v17 offset:1024
  v_mfma_f32_16x16x32_bf16 v[252:255], v[36:39], a[252:255], v[252:255]
  ds_read_b64_tr_b16 v[52:53], v17 offset:8192
  ds_read_b64_tr_b16 v[54:55], v17 offset:9216
  v_mfma_f32_16x16x32_bf16 v[248:251], v[36:39], a[188:191], v[248:251]
  buffer_load_dwordx4 v10, s[16:19], s51 offen offset:2048 lds
  v_cvt_pk_bf16_f32 v102, v212, v213
  v_mfma_f32_16x16x32_bf16 v[248:251], v[32:35], a[184:187], v[248:251]
  v_cvt_pk_bf16_f32 v103, v214, v215
  v_cvt_pk_bf16_f32 v104, v200, v201
  v_mfma_f32_16x16x32_bf16 v[244:247], v[32:35], a[120:123], v[244:247]
  v_cvt_pk_bf16_f32 v105, v202, v203
  v_cvt_pk_bf16_f32 v106, v216, v217
  v_mfma_f32_16x16x32_bf16 v[244:247], v[36:39], a[124:127], v[244:247]
  buffer_load_dwordx4 v11, s[16:19], s51 offen offset:3072 lds
  v_cvt_pk_bf16_f32 v107, v218, v219
  v_mfma_f32_16x16x32_bf16 v[240:243], v[36:39], a[60:63], v[240:243]
  s_add_u32 m0, s36, 49152
  v_cvt_pk_bf16_f32 v108, v204, v205
  v_cvt_pk_bf16_f32 v109, v206, v207
  v_mfma_f32_16x16x32_bf16 v[240:243], v[32:35], a[56:59], v[240:243]
  s_waitcnt lgkmcnt(4)
  v_cvt_pk_bf16_f32 v110, v220, v221
  v_cvt_pk_bf16_f32 v111, v222, v223
  v_mfma_f32_16x16x32_bf16 v[128:131], a[0:3], v[40:43], 0
  s_add_u32 s51, s34, 3670016
  ds_read_b64_tr_b16 v[32:33], v18 offset:0
  ds_read_b64_tr_b16 v[34:35], v18 offset:1024
  v_mfma_f32_16x16x32_bf16 v[128:131], a[4:7], v[44:47], v[128:131]
  ds_read_b64_tr_b16 v[36:37], v18 offset:8192
  ds_read_b64_tr_b16 v[38:39], v18 offset:9216
  v_mfma_f32_16x16x32_bf16 v[132:135], a[68:71], v[44:47], 0
  buffer_load_dwordx4 v8, s[16:19], s51 offen offset:0 lds
  v_cvt_pk_bf16_f32 v112, v224, v225
  v_mfma_f32_16x16x32_bf16 v[132:135], a[64:67], v[40:43], v[132:135]
  v_cvt_pk_bf16_f32 v113, v226, v227
  v_cvt_pk_bf16_f32 v114, v240, v241
  v_mfma_f32_16x16x32_bf16 v[136:139], a[128:131], v[40:43], 0
  v_cvt_pk_bf16_f32 v115, v242, v243
  v_cvt_pk_bf16_f32 v116, v228, v229
  v_mfma_f32_16x16x32_bf16 v[136:139], a[132:135], v[44:47], v[136:139]
  buffer_load_dwordx4 v9, s[16:19], s51 offen offset:1024 lds
  v_cvt_pk_bf16_f32 v117, v230, v231
  v_mfma_f32_16x16x32_bf16 v[140:143], a[196:199], v[44:47], 0
  v_cvt_pk_bf16_f32 v118, v244, v245
  v_cvt_pk_bf16_f32 v119, v246, v247
  v_mfma_f32_16x16x32_bf16 v[140:143], a[192:195], v[40:43], v[140:143]
  s_waitcnt lgkmcnt(4)
  v_cvt_pk_bf16_f32 v120, v232, v233
  v_cvt_pk_bf16_f32 v121, v234, v235
  v_mfma_f32_16x16x32_bf16 v[156:159], a[192:195], v[48:51], 0
  ds_read_b64_tr_b16 v[40:41], v19 offset:0
  ds_read_b64_tr_b16 v[42:43], v19 offset:1024
  v_mfma_f32_16x16x32_bf16 v[156:159], a[196:199], v[52:55], v[156:159]
  ds_read_b64_tr_b16 v[44:45], v19 offset:8192
  ds_read_b64_tr_b16 v[46:47], v19 offset:9216
  v_mfma_f32_16x16x32_bf16 v[152:155], a[132:135], v[52:55], 0
  buffer_load_dwordx4 v10, s[16:19], s51 offen offset:2048 lds
  v_cvt_pk_bf16_f32 v122, v248, v249
  v_mfma_f32_16x16x32_bf16 v[152:155], a[128:131], v[48:51], v[152:155]
  v_cvt_pk_bf16_f32 v123, v250, v251
  v_cvt_pk_bf16_f32 v124, v236, v237
  v_mfma_f32_16x16x32_bf16 v[148:151], a[64:67], v[48:51], 0
  v_cvt_pk_bf16_f32 v125, v238, v239
  v_cvt_pk_bf16_f32 v126, v252, v253
  v_mfma_f32_16x16x32_bf16 v[148:151], a[68:71], v[52:55], v[148:151]
  buffer_load_dwordx4 v11, s[16:19], s51 offen offset:3072 lds
  v_cvt_pk_bf16_f32 v127, v254, v255
  v_mfma_f32_16x16x32_bf16 v[144:147], a[4:7], v[52:55], 0
  s_add_u32 s39, s37, 4096
  buffer_store_dwordx4 v[68:71], v2, s[20:23], s39 offen sc1
  v_mfma_f32_16x16x32_bf16 v[144:147], a[0:3], v[48:51], v[144:147]
  s_waitcnt lgkmcnt(4)
  v_mfma_f32_16x16x32_bf16 v[160:163], a[0:3], v[32:35], 0
  ds_read_b64_tr_b16 v[48:49], v16 offset:16384
  ds_read_b64_tr_b16 v[50:51], v16 offset:17408
  v_mfma_f32_16x16x32_bf16 v[160:163], a[4:7], v[36:39], v[160:163]
  ds_read_b64_tr_b16 v[52:53], v16 offset:24576
  ds_read_b64_tr_b16 v[54:55], v16 offset:25600
  v_mfma_f32_16x16x32_bf16 v[164:167], a[68:71], v[36:39], 0
  s_mov_b32 s12, s68
  s_and_b32 s13, s69, 0xffff
  s_mov_b32 s14, 4194304
  s_mov_b32 s15, 0x20000
  s_and_b32 s38, s42, 7
  s_add_u32 m0, s36, 65536
  s_add_u32 s51, s38, 0
  s_and_b32 s51, s51, 7
  s_lshl_b32 s51, s51, 19
  s_add_u32 s51, s51, s34
  buffer_load_dwordx4 v8, s[12:15], s51 offen offset:0 lds
  v_mfma_f32_16x16x32_bf16 v[164:167], a[64:67], v[32:35], v[164:167]
  v_mfma_f32_16x16x32_bf16 v[168:171], a[128:131], v[32:35], 0
  v_mfma_f32_16x16x32_bf16 v[168:171], a[132:135], v[36:39], v[168:171]
  buffer_load_dwordx4 v9, s[12:15], s51 offen offset:1024 lds
  v_mfma_f32_16x16x32_bf16 v[172:175], a[196:199], v[36:39], 0
  v_mfma_f32_16x16x32_bf16 v[172:175], a[192:195], v[32:35], v[172:175]
  s_waitcnt lgkmcnt(4)
  v_mfma_f32_16x16x32_bf16 v[188:191], a[192:195], v[40:43], 0
  ds_read_b64_tr_b16 v[32:33], v17 offset:16384
  ds_read_b64_tr_b16 v[34:35], v17 offset:17408
  v_mfma_f32_16x16x32_bf16 v[188:191], a[196:199], v[44:47], v[188:191]
  ds_read_b64_tr_b16 v[36:37], v17 offset:24576
  ds_read_b64_tr_b16 v[38:39], v17 offset:25600
  v_mfma_f32_16x16x32_bf16 v[184:187], a[132:135], v[44:47], 0
  buffer_load_dwordx4 v10, s[12:15], s51 offen offset:2048 lds
  v_mfma_f32_16x16x32_bf16 v[184:187], a[128:131], v[40:43], v[184:187]
  v_mfma_f32_16x16x32_bf16 v[180:183], a[64:67], v[40:43], 0
  v_mfma_f32_16x16x32_bf16 v[180:183], a[68:71], v[44:47], v[180:183]
  buffer_load_dwordx4 v11, s[12:15], s51 offen offset:3072 lds
  v_mfma_f32_16x16x32_bf16 v[176:179], a[4:7], v[44:47], 0
  s_add_u32 m0, s36, 81920
  v_mfma_f32_16x16x32_bf16 v[176:179], a[0:3], v[40:43], v[176:179]
  s_waitcnt lgkmcnt(4)
  v_mfma_f32_16x16x32_bf16 v[128:131], a[8:11], v[48:51], v[128:131]
  s_add_u32 s51, s38, 1
  ds_read_b64_tr_b16 v[40:41], v18 offset:16384
  ds_read_b64_tr_b16 v[42:43], v18 offset:17408
  v_mfma_f32_16x16x32_bf16 v[128:131], a[12:15], v[52:55], v[128:131]
  s_and_b32 s51, s51, 7
  ds_read_b64_tr_b16 v[44:45], v18 offset:24576
  ds_read_b64_tr_b16 v[46:47], v18 offset:25600
  v_mfma_f32_16x16x32_bf16 v[132:135], a[76:79], v[52:55], v[132:135]
  s_lshl_b32 s51, s51, 19
  v_mfma_f32_16x16x32_bf16 v[132:135], a[72:75], v[48:51], v[132:135]
  s_add_u32 s51, s51, s34
  buffer_load_dwordx4 v8, s[12:15], s51 offen offset:0 lds
  v_mfma_f32_16x16x32_bf16 v[136:139], a[136:139], v[48:51], v[136:139]
  s_add_u32 s39, s37, 8192
  buffer_store_dwordx4 v[72:75], v2, s[20:23], s39 offen sc1
  v_mfma_f32_16x16x32_bf16 v[136:139], a[140:143], v[52:55], v[136:139]
  buffer_load_dwordx4 v9, s[12:15], s51 offen offset:1024 lds
  v_mfma_f32_16x16x32_bf16 v[140:143], a[204:207], v[52:55], v[140:143]
  v_mfma_f32_16x16x32_bf16 v[140:143], a[200:203], v[48:51], v[140:143]
  s_waitcnt lgkmcnt(4)
  v_mfma_f32_16x16x32_bf16 v[156:159], a[200:203], v[32:35], v[156:159]
  ds_read_b64_tr_b16 v[48:49], v19 offset:16384
  ds_read_b64_tr_b16 v[50:51], v19 offset:17408
  v_mfma_f32_16x16x32_bf16 v[156:159], a[204:207], v[36:39], v[156:159]
  ds_read_b64_tr_b16 v[52:53], v19 offset:24576
  ds_read_b64_tr_b16 v[54:55], v19 offset:25600
  v_mfma_f32_16x16x32_bf16 v[152:155], a[140:143], v[36:39], v[152:155]
  buffer_load_dwordx4 v10, s[12:15], s51 offen offset:2048 lds
  v_mfma_f32_16x16x32_bf16 v[152:155], a[136:139], v[32:35], v[152:155]
  v_mfma_f32_16x16x32_bf16 v[148:151], a[72:75], v[32:35], v[148:151]
  v_mfma_f32_16x16x32_bf16 v[148:151], a[76:79], v[36:39], v[148:151]
  buffer_load_dwordx4 v11, s[12:15], s51 offen offset:3072 lds
  v_mfma_f32_16x16x32_bf16 v[144:147], a[12:15], v[36:39], v[144:147]
  v_mfma_f32_16x16x32_bf16 v[144:147], a[8:11], v[32:35], v[144:147]
  s_waitcnt lgkmcnt(4)
  v_mfma_f32_16x16x32_bf16 v[160:163], a[8:11], v[40:43], v[160:163]
  ds_read_b64_tr_b16 v[32:33], v16 offset:32768
  ds_read_b64_tr_b16 v[34:35], v16 offset:33792
  v_mfma_f32_16x16x32_bf16 v[160:163], a[12:15], v[44:47], v[160:163]
  ds_read_b64_tr_b16 v[36:37], v16 offset:40960
  ds_read_b64_tr_b16 v[38:39], v16 offset:41984
  v_mfma_f32_16x16x32_bf16 v[164:167], a[76:79], v[44:47], v[164:167]
  v_mfma_f32_16x16x32_bf16 v[164:167], a[72:75], v[40:43], v[164:167]
  v_mfma_f32_16x16x32_bf16 v[168:171], a[136:139], v[40:43], v[168:171]
  v_mfma_f32_16x16x32_bf16 v[168:171], a[140:143], v[44:47], v[168:171]
  v_mfma_f32_16x16x32_bf16 v[172:175], a[204:207], v[44:47], v[172:175]
  v_mfma_f32_16x16x32_bf16 v[172:175], a[200:203], v[40:43], v[172:175]
  s_waitcnt lgkmcnt(4)
  v_mfma_f32_16x16x32_bf16 v[188:191], a[200:203], v[48:51], v[188:191]
  s_add_u32 s39, s37, 12288
  ds_read_b64_tr_b16 v[40:41], v17 offset:32768
  ds_read_b64_tr_b16 v[42:43], v17 offset:33792
  v_mfma_f32_16x16x32_bf16 v[188:191], a[204:207], v[52:55], v[188:191]
  ds_read_b64_tr_b16 v[44:45], v17 offset:40960
  ds_read_b64_tr_b16 v[46:47], v17 offset:41984
  v_mfma_f32_16x16x32_bf16 v[184:187], a[140:143], v[52:55], v[184:187]
  buffer_store_dwordx4 v[76:79], v2, s[20:23], s39 offen sc1
  v_mfma_f32_16x16x32_bf16 v[184:187], a[136:139], v[48:51], v[184:187]
  v_mfma_f32_16x16x32_bf16 v[180:183], a[72:75], v[48:51], v[180:183]
  v_mfma_f32_16x16x32_bf16 v[180:183], a[76:79], v[52:55], v[180:183]
  v_mfma_f32_16x16x32_bf16 v[176:179], a[12:15], v[52:55], v[176:179]
  v_mfma_f32_16x16x32_bf16 v[176:179], a[8:11], v[48:51], v[176:179]
  s_waitcnt lgkmcnt(4)
  v_mfma_f32_16x16x32_bf16 v[128:131], a[16:19], v[32:35], v[128:131]
  ds_read_b64_tr_b16 v[48:49], v18 offset:32768
  ds_read_b64_tr_b16 v[50:51], v18 offset:33792
  v_mfma_f32_16x16x32_bf16 v[128:131], a[20:23], v[36:39], v[128:131]
  ds_read_b64_tr_b16 v[52:53], v18 offset:40960
  ds_read_b64_tr_b16 v[54:55], v18 offset:41984
  v_mfma_f32_16x16x32_bf16 v[132:135], a[84:87], v[36:39], v[132:135]
  v_mfma_f32_16x16x32_bf16 v[132:135], a[80:83], v[32:35], v[132:135]
  v_mfma_f32_16x16x32_bf16 v[136:139], a[144:147], v[32:35], v[136:139]
  v_mfma_f32_16x16x32_bf16 v[136:139], a[148:151], v[36:39], v[136:139]
  v_mfma_f32_16x16x32_bf16 v[140:143], a[212:215], v[36:39], v[140:143]
  v_mfma_f32_16x16x32_bf16 v[140:143], a[208:211], v[32:35], v[140:143]
  s_waitcnt lgkmcnt(4)
  v_mfma_f32_16x16x32_bf16 v[156:159], a[208:211], v[40:43], v[156:159]
  ds_read_b64_tr_b16 v[32:33], v19 offset:32768
  ds_read_b64_tr_b16 v[34:35], v19 offset:33792
  v_mfma_f32_16x16x32_bf16 v[156:159], a[212:215], v[44:47], v[156:159]
  ds_read_b64_tr_b16 v[36:37], v19 offset:40960
  ds_read_b64_tr_b16 v[38:39], v19 offset:41984
  v_mfma_f32_16x16x32_bf16 v[152:155], a[148:151], v[44:47], v[152:155]
  v_mfma_f32_16x16x32_bf16 v[152:155], a[144:147], v[40:43], v[152:155]
  v_mfma_f32_16x16x32_bf16 v[148:151], a[80:83], v[40:43], v[148:151]
  v_mfma_f32_16x16x32_bf16 v[148:151], a[84:87], v[44:47], v[148:151]
  v_mfma_f32_16x16x32_bf16 v[144:147], a[20:23], v[44:47], v[144:147]
  s_add_u32 s39, s37, 1024
  v_mfma_f32_16x16x32_bf16 v[144:147], a[16:19], v[40:43], v[144:147]
  s_waitcnt lgkmcnt(4)
  v_mfma_f32_16x16x32_bf16 v[160:163], a[16:19], v[48:51], v[160:163]
  buffer_store_dwordx4 v[80:83], v2, s[20:23], s39 offen sc1
  v_mfma_f32_16x16x32_bf16 v[160:163], a[20:23], v[52:55], v[160:163]
  v_mfma_f32_16x16x32_bf16 v[164:167], a[84:87], v[52:55], v[164:167]
  s_waitcnt vmcnt(16) lgkmcnt(0)
  s_barrier
  s_cmp_lg_u32 s40, 0
  s_cbranch_scc1 Lpub11
  s_lshr_b32 s4, s2, 2
  s_lshl_b32 s4, s4, 5
  s_and_b32 s5, s2, 3
  s_add_u32 s4, s4, s5
  s_lshl_b32 s4, s4, 2
  s_add_u32 s4, s4, 65011712
  v_mov_b32 v26, 1
  s_mov_b64 exec, 1
  buffer_store_dword v26, off, s[20:23], s4 sc1
  s_mov_b64 exec, -1
Lpub11:
  ds_read_b64_tr_b16 v[40:41], v16 offset:49152
  ds_read_b64_tr_b16 v[42:43], v16 offset:50176
  v_mfma_f32_16x16x32_bf16 v[164:167], a[80:83], v[48:51], v[164:167]
  ds_read_b64_tr_b16 v[44:45], v16 offset:57344
  ds_read_b64_tr_b16 v[46:47], v16 offset:58368
  v_mfma_f32_16x16x32_bf16 v[168:171], a[144:147], v[48:51], v[168:171]
  v_mfma_f32_16x16x32_bf16 v[168:171], a[148:151], v[52:55], v[168:171]
  v_mfma_f32_16x16x32_bf16 v[172:175], a[212:215], v[52:55], v[172:175]
  v_mfma_f32_16x16x32_bf16 v[172:175], a[208:211], v[48:51], v[172:175]
  v_mfma_f32_16x16x32_bf16 v[188:191], a[208:211], v[32:35], v[188:191]
  ds_read_b64_tr_b16 v[48:49], v17 offset:49152
  ds_read_b64_tr_b16 v[50:51], v17 offset:50176
  v_mfma_f32_16x16x32_bf16 v[188:191], a[212:215], v[36:39], v[188:191]
  ds_read_b64_tr_b16 v[52:53], v17 offset:57344
  ds_read_b64_tr_b16 v[54:55], v17 offset:58368
  v_mfma_f32_16x16x32_bf16 v[184:187], a[148:151], v[36:39], v[184:187]
  v_mfma_f32_16x16x32_bf16 v[184:187], a[144:147], v[32:35], v[184:187]
  v_mfma_f32_16x16x32_bf16 v[180:183], a[80:83], v[32:35], v[180:183]
  v_mfma_f32_16x16x32_bf16 v[180:183], a[84:87], v[36:39], v[180:183]
  v_mfma_f32_16x16x32_bf16 v[176:179], a[20:23], v[36:39], v[176:179]
  v_mfma_f32_16x16x32_bf16 v[176:179], a[16:19], v[32:35], v[176:179]
  s_waitcnt lgkmcnt(4)
  v_mfma_f32_16x16x32_bf16 v[128:131], a[24:27], v[40:43], v[128:131]
  ds_read_b64_tr_b16 v[32:33], v18 offset:49152
  ds_read_b64_tr_b16 v[34:35], v18 offset:50176
  v_mfma_f32_16x16x32_bf16 v[128:131], a[28:31], v[44:47], v[128:131]
  ds_read_b64_tr_b16 v[36:37], v18 offset:57344
  ds_read_b64_tr_b16 v[38:39], v18 offset:58368
  v_mfma_f32_16x16x32_bf16 v[132:135], a[92:95], v[44:47], v[132:135]
  v_mfma_f32_16x16x32_bf16 v[132:135], a[88:91], v[40:43], v[132:135]
  v_mfma_f32_16x16x32_bf16 v[136:139], a[152:155], v[40:43], v[136:139]
  s_add_u32 s39, s37, 5120
  v_mfma_f32_16x16x32_bf16 v[136:139], a[156:159], v[44:47], v[136:139]
  v_mfma_f32_16x16x32_bf16 v[140:143], a[220:223], v[44:47], v[140:143]
  buffer_store_dwordx4 v[84:87], v2, s[20:23], s39 offen sc1
  v_mfma_f32_16x16x32_bf16 v[140:143], a[216:219], v[40:43], v[140:143]
  s_waitcnt lgkmcnt(4)
  v_mfma_f32_16x16x32_bf16 v[156:159], a[216:219], v[48:51], v[156:159]
  ds_read_b64_tr_b16 v[40:41], v19 offset:49152
  ds_read_b64_tr_b16 v[42:43], v19 offset:50176
  v_mfma_f32_16x16x32_bf16 v[156:159], a[220:223], v[52:55], v[156:159]
  ds_read_b64_tr_b16 v[44:45], v19 offset:57344
  ds_read_b64_tr_b16 v[46:47], v19 offset:58368
  v_mfma_f32_16x16x32_bf16 v[152:155], a[156:159], v[52:55], v[152:155]
  v_mfma_f32_16x16x32_bf16 v[152:155], a[152:155], v[48:51], v[152:155]
  v_mfma_f32_16x16x32_bf16 v[148:151], a[88:91], v[48:51], v[148:151]
  v_mfma_f32_16x16x32_bf16 v[148:151], a[92:95], v[52:55], v[148:151]
  v_mfma_f32_16x16x32_bf16 v[144:147], a[28:31], v[52:55], v[144:147]
  v_mfma_f32_16x16x32_bf16 v[144:147], a[24:27], v[48:51], v[144:147]
  s_waitcnt lgkmcnt(4)
  v_mfma_f32_16x16x32_bf16 v[160:163], a[24:27], v[32:35], v[160:163]
  v_add_u32 v16, 0xfffe8000, v16
  v_add_u32 v17, 0xfffe8000, v17
  v_add_u32 v18, 0xfffe8000, v18
  v_add_u32 v19, 0xfffe8000, v19
  v_add_u32 v20, 0xfffe8000, v20
  v_add_u32 v21, 0xfffe8000, v21
  v_add_u32 v22, 0xfffe8000, v22
  v_add_u32 v23, 0xfffe8000, v23
  ds_read_b64_tr_b16 v[48:49], v16 offset:0
  ds_read_b64_tr_b16 v[50:51], v16 offset:1024
  v_mfma_f32_16x16x32_bf16 v[160:163], a[28:31], v[36:39], v[160:163]
  ds_read_b64_tr_b16 v[52:53], v16 offset:8192
  ds_read_b64_tr_b16 v[54:55], v16 offset:9216
  v_mfma_f32_16x16x32_bf16 v[164:167], a[92:95], v[36:39], v[164:167]
  v_mfma_f32_16x16x32_bf16 v[164:167], a[88:91], v[32:35], v[164:167]
  v_mfma_f32_16x16x32_bf16 v[168:171], a[152:155], v[32:35], v[168:171]
  v_mfma_f32_16x16x32_bf16 v[168:171], a[156:159], v[36:39], v[168:171]
  v_mfma_f32_16x16x32_bf16 v[172:175], a[220:223], v[36:39], v[172:175]
  v_mfma_f32_16x16x32_bf16 v[172:175], a[216:219], v[32:35], v[172:175]
  s_waitcnt lgkmcnt(4)
  v_mfma_f32_16x16x32_bf16 v[188:191], a[216:219], v[40:43], v[188:191]
  ds_read_b64_tr_b16 v[32:33], v17 offset:0
  ds_read_b64_tr_b16 v[34:35], v17 offset:1024
  v_mfma_f32_16x16x32_bf16 v[188:191], a[220:223], v[44:47], v[188:191]
  ds_read_b64_tr_b16 v[36:37], v17 offset:8192
  ds_read_b64_tr_b16 v[38:39], v17 offset:9216
  v_mfma_f32_16x16x32_bf16 v[184:187], a[156:159], v[44:47], v[184:187]
  s_add_u32 s39, s37, 9216
  v_mfma_f32_16x16x32_bf16 v[184:187], a[152:155], v[40:43], v[184:187]
  v_mfma_f32_16x16x32_bf16 v[180:183], a[88:91], v[40:43], v[180:183]
  buffer_store_dwordx4 v[88:91], v2, s[20:23], s39 offen sc1
  v_mfma_f32_16x16x32_bf16 v[180:183], a[92:95], v[44:47], v[180:183]
  v_mfma_f32_16x16x32_bf16 v[176:179], a[28:31], v[44:47], v[176:179]
  v_mfma_f32_16x16x32_bf16 v[176:179], a[24:27], v[40:43], v[176:179]
  s_waitcnt lgkmcnt(4)
  v_mfma_f32_16x16x32_bf16 v[128:131], a[32:35], v[48:51], v[128:131]
  ds_read_b64_tr_b16 v[40:41], v18 offset:0
  ds_read_b64_tr_b16 v[42:43], v18 offset:1024
  v_mfma_f32_16x16x32_bf16 v[128:131], a[36:39], v[52:55], v[128:131]
  ds_read_b64_tr_b16 v[44:45], v18 offset:8192
  ds_read_b64_tr_b16 v[46:47], v18 offset:9216
  v_mfma_f32_16x16x32_bf16 v[132:135], a[100:103], v[52:55], v[132:135]
  v_mfma_f32_16x16x32_bf16 v[132:135], a[96:99], v[48:51], v[132:135]
  v_mfma_f32_16x16x32_bf16 v[136:139], a[160:163], v[48:51], v[136:139]
  v_mfma_f32_16x16x32_bf16 v[136:139], a[164:167], v[52:55], v[136:139]
  v_mfma_f32_16x16x32_bf16 v[140:143], a[228:231], v[52:55], v[140:143]
  v_mfma_f32_16x16x32_bf16 v[140:143], a[224:227], v[48:51], v[140:143]
  s_waitcnt lgkmcnt(4)
  v_mfma_f32_16x16x32_bf16 v[156:159], a[224:227], v[32:35], v[156:159]
  ds_read_b64_tr_b16 v[48:49], v19 offset:0
  ds_read_b64_tr_b16 v[50:51], v19 offset:1024
  v_mfma_f32_16x16x32_bf16 v[156:159], a[228:231], v[36:39], v[156:159]
  ds_read_b64_tr_b16 v[52:53], v19 offset:8192
  ds_read_b64_tr_b16 v[54:55], v19 offset:9216
  v_mfma_f32_16x16x32_bf16 v[152:155], a[164:167], v[36:39], v[152:155]
  v_mfma_f32_16x16x32_bf16 v[152:155], a[160:163], v[32:35], v[152:155]
  v_mfma_f32_16x16x32_bf16 v[148:151], a[96:99], v[32:35], v[148:151]
  v_mfma_f32_16x16x32_bf16 v[148:151], a[100:103], v[36:39], v[148:151]
  v_mfma_f32_16x16x32_bf16 v[144:147], a[36:39], v[36:39], v[144:147]
  v_mfma_f32_16x16x32_bf16 v[144:147], a[32:35], v[32:35], v[144:147]
  s_waitcnt lgkmcnt(4)
  v_mfma_f32_16x16x32_bf16 v[160:163], a[32:35], v[40:43], v[160:163]
  s_add_u32 s39, s37, 13312
  ds_read_b64_tr_b16 v[32:33], v16 offset:16384
  ds_read_b64_tr_b16 v[34:35], v16 offset:17408
  v_mfma_f32_16x16x32_bf16 v[160:163], a[36:39], v[44:47], v[160:163]
  ds_read_b64_tr_b16 v[36:37], v16 offset:24576
  ds_read_b64_tr_b16 v[38:39], v16 offset:25600
  v_mfma_f32_16x16x32_bf16 v[164:167], a[100:103], v[44:47], v[164:167]
  buffer_store_dwordx4 v[92:95], v2, s[20:23], s39 offen sc1
  v_mfma_f32_16x16x32_bf16 v[164:167], a[96:99], v[40:43], v[164:167]
  v_mfma_f32_16x16x32_bf16 v[168:171], a[160:163], v[40:43], v[168:171]
  v_mfma_f32_16x16x32_bf16 v[168:171], a[164:167], v[44:47], v[168:171]
  v_mfma_f32_16x16x32_bf16 v[172:175], a[228:231], v[44:47], v[172:175]
  v_mfma_f32_16x16x32_bf16 v[172:175], a[224:227], v[40:43], v[172:175]
  s_waitcnt lgkmcnt(4)
  v_mfma_f32_16x16x32_bf16 v[188:191], a[224:227], v[48:51], v[188:191]
  ds_read_b64_tr_b16 v[40:41], v17 offset:16384
  ds_read_b64_tr_b16 v[42:43], v17 offset:17408
  v_mfma_f32_16x16x32_bf16 v[188:191], a[228:231], v[52:55], v[188:191]
  ds_read_b64_tr_b16 v[44:45], v17 offset:24576
  ds_read_b64_tr_b16 v[46:47], v17 offset:25600
  v_mfma_f32_16x16x32_bf16 v[184:187], a[164:167], v[52:55], v[184:187]
  v_mfma_f32_16x16x32_bf16 v[184:187], a[160:163], v[48:51], v[184:187]
  v_mfma_f32_16x16x32_bf16 v[180:183], a[96:99], v[48:51], v[180:183]
  v_mfma_f32_16x16x32_bf16 v[180:183], a[100:103], v[52:55], v[180:183]
  v_mfma_f32_16x16x32_bf16 v[176:179], a[36:39], v[52:55], v[176:179]
  v_mfma_f32_16x16x32_bf16 v[176:179], a[32:35], v[48:51], v[176:179]
  s_waitcnt lgkmcnt(4)
  v_mfma_f32_16x16x32_bf16 v[128:131], a[40:43], v[32:35], v[128:131]
  ds_read_b64_tr_b16 v[48:49], v18 offset:16384
  ds_read_b64_tr_b16 v[50:51], v18 offset:17408
  v_mfma_f32_16x16x32_bf16 v[128:131], a[44:47], v[36:39], v[128:131]
  ds_read_b64_tr_b16 v[52:53], v18 offset:24576
  ds_read_b64_tr_b16 v[54:55], v18 offset:25600
  v_mfma_f32_16x16x32_bf16 v[132:135], a[108:111], v[36:39], v[132:135]
  v_mfma_f32_16x16x32_bf16 v[132:135], a[104:107], v[32:35], v[132:135]
  v_mfma_f32_16x16x32_bf16 v[136:139], a[168:171], v[32:35], v[136:139]
  v_mfma_f32_16x16x32_bf16 v[136:139], a[172:175], v[36:39], v[136:139]
  v_mfma_f32_16x16x32_bf16 v[140:143], a[236:239], v[36:39], v[140:143]
  s_add_u32 s39, s37, 2048
  v_mfma_f32_16x16x32_bf16 v[140:143], a[232:235], v[32:35], v[140:143]
  s_waitcnt lgkmcnt(4)
  v_mfma_f32_16x16x32_bf16 v[156:159], a[232:235], v[40:43], v[156:159]
  ds_read_b64_tr_b16 v[32:33], v19 offset:16384
  ds_read_b64_tr_b16 v[34:35], v19 offset:17408
  v_mfma_f32_16x16x32_bf16 v[156:159], a[236:239], v[44:47], v[156:159]
  ds_read_b64_tr_b16 v[36:37], v19 offset:24576
  ds_read_b64_tr_b16 v[38:39], v19 offset:25600
  v_mfma_f32_16x16x32_bf16 v[152:155], a[172:175], v[44:47], v[152:155]
  buffer_store_dwordx4 v[96:99], v2, s[20:23], s39 offen sc1
  v_mfma_f32_16x16x32_bf16 v[152:155], a[168:171], v[40:43], v[152:155]
  v_mfma_f32_16x16x32_bf16 v[148:151], a[104:107], v[40:43], v[148:151]
  v_mfma_f32_16x16x32_bf16 v[148:151], a[108:111], v[44:47], v[148:151]
  v_mfma_f32_16x16x32_bf16 v[144:147], a[44:47], v[44:47], v[144:147]
  v_mfma_f32_16x16x32_bf16 v[144:147], a[40:43], v[40:43], v[144:147]
  s_waitcnt lgkmcnt(4)
  v_mfma_f32_16x16x32_bf16 v[160:163], a[40:43], v[48:51], v[160:163]
  v_mfma_f32_16x16x32_bf16 v[160:163], a[44:47], v[52:55], v[160:163]
  v_mfma_f32_16x16x32_bf16 v[164:167], a[108:111], v[52:55], v[164:167]
  s_waitcnt vmcnt(16) lgkmcnt(0)
  s_barrier
  ds_read_b64_tr_b16 v[40:41], v16 offset:32768
  ds_read_b64_tr_b16 v[42:43], v16 offset:33792
  v_mfma_f32_16x16x32_bf16 v[164:167], a[104:107], v[48:51], v[164:167]
  ds_read_b64_tr_b16 v[44:45], v16 offset:40960
  ds_read_b64_tr_b16 v[46:47], v16 offset:41984
  v_mfma_f32_16x16x32_bf16 v[168:171], a[168:171], v[48:51], v[168:171]
  v_mfma_f32_16x16x32_bf16 v[168:171], a[172:175], v[52:55], v[168:171]
  v_mfma_f32_16x16x32_bf16 v[172:175], a[236:239], v[52:55], v[172:175]
  v_mfma_f32_16x16x32_bf16 v[172:175], a[232:235], v[48:51], v[172:175]
  v_mfma_f32_16x16x32_bf16 v[188:191], a[232:235], v[32:35], v[188:191]
  ds_read_b64_tr_b16 v[48:49], v17 offset:32768
  ds_read_b64_tr_b16 v[50:51], v17 offset:33792
  v_mfma_f32_16x16x32_bf16 v[188:191], a[236:239], v[36:39], v[188:191]
  ds_read_b64_tr_b16 v[52:53], v17 offset:40960
  ds_read_b64_tr_b16 v[54:55], v17 offset:41984
  v_mfma_f32_16x16x32_bf16 v[184:187], a[172:175], v[36:39], v[184:187]
  v_mfma_f32_16x16x32_bf16 v[184:187], a[168:171], v[32:35], v[184:187]
  v_mfma_f32_16x16x32_bf16 v[180:183], a[104:107], v[32:35], v[180:183]
  v_mfma_f32_16x16x32_bf16 v[180:183], a[108:111], v[36:39], v[180:183]
  v_mfma_f32_16x16x32_bf16 v[176:179], a[44:47], v[36:39], v[176:179]
  s_add_u32 s39, s37, 6144
  v_mfma_f32_16x16x32_bf16 v[176:179], a[40:43], v[32:35], v[176:179]
  s_waitcnt lgkmcnt(4)
  v_mfma_f32_16x16x32_bf16 v[128:131], a[48:51], v[40:43], v[128:131]
  ds_read_b64_tr_b16 v[32:33], v18 offset:32768
  ds_read_b64_tr_b16 v[34:35], v18 offset:33792
  v_mfma_f32_16x16x32_bf16 v[128:131], a[52:55], v[44:47], v[128:131]
  ds_read_b64_tr_b16 v[36:37], v18 offset:40960
  ds_read_b64_tr_b16 v[38:39], v18 offset:41984
  v_mfma_f32_16x16x32_bf16 v[132:135], a[116:119], v[44:47], v[132:135]
  buffer_store_dwordx4 v[100:103], v2, s[20:23], s39 offen sc1
  v_mfma_f32_16x16x32_bf16 v[132:135], a[112:115], v[40:43], v[132:135]
  v_mfma_f32_16x16x32_bf16 v[136:139], a[176:179], v[40:43], v[136:139]
  v_mfma_f32_16x16x32_bf16 v[136:139], a[180:183], v[44:47], v[136:139]
  v_mfma_f32_16x16x32_bf16 v[140:143], a[244:247], v[44:47], v[140:143]
  v_mfma_f32_16x16x32_bf16 v[140:143], a[240:243], v[40:43], v[140:143]
  s_waitcnt lgkmcnt(4)
  v_mfma_f32_16x16x32_bf16 v[156:159], a[240:243], v[48:51], v[156:159]
  ds_read_b64_tr_b16 v[40:41], v19 offset:32768
  ds_read_b64_tr_b16 v[42:43], v19 offset:33792
  v_mfma_f32_16x16x32_bf16 v[156:159], a[244:247], v[52:55], v[156:159]
  ds_read_b64_tr_b16 v[44:45], v19 offset:40960
  ds_read_b64_tr_b16 v[46:47], v19 offset:41984
  v_mfma_f32_16x16x32_bf16 v[152:155], a[180:183], v[52:55], v[152:155]
  v_mfma_f32_16x16x32_bf16 v[152:155], a[176:179], v[48:51], v[152:155]
  v_mfma_f32_16x16x32_bf16 v[148:151], a[112:115], v[48:51], v[148:151]
  v_mfma_f32_16x16x32_bf16 v[148:151], a[116:119], v[52:55], v[148:151]
  v_mfma_f32_16x16x32_bf16 v[144:147], a[52:55], v[52:55], v[144:147]
  v_mfma_f32_16x16x32_bf16 v[144:147], a[48:51], v[48:51], v[144:147]
  s_waitcnt lgkmcnt(4)
  v_mfma_f32_16x16x32_bf16 v[160:163], a[48:51], v[32:35], v[160:163]
  ds_read_b64_tr_b16 v[48:49], v16 offset:49152
  ds_read_b64_tr_b16 v[50:51], v16 offset:50176
  v_mfma_f32_16x16x32_bf16 v[160:163], a[52:55], v[36:39], v[160:163]
  ds_read_b64_tr_b16 v[52:53], v16 offset:57344
  ds_read_b64_tr_b16 v[54:55], v16 offset:58368
  v_mfma_f32_16x16x32_bf16 v[164:167], a[116:119], v[36:39], v[164:167]
  v_mfma_f32_16x16x32_bf16 v[164:167], a[112:115], v[32:35], v[164:167]
  v_mfma_f32_16x16x32_bf16 v[168:171], a[176:179], v[32:35], v[168:171]
  v_mfma_f32_16x16x32_bf16 v[168:171], a[180:183], v[36:39], v[168:171]
  v_mfma_f32_16x16x32_bf16 v[172:175], a[244:247], v[36:39], v[172:175]
  s_add_u32 s39, s37, 10240
  v_mfma_f32_16x16x32_bf16 v[172:175], a[240:243], v[32:35], v[172:175]
  s_waitcnt lgkmcnt(4)
  v_mfma_f32_16x16x32_bf16 v[188:191], a[240:243], v[40:43], v[188:191]
  ds_read_b64_tr_b16 v[32:33], v17 offset:49152
  ds_read_b64_tr_b16 v[34:35], v17 offset:50176
  v_mfma_f32_16x16x32_bf16 v[188:191], a[244:247], v[44:47], v[188:191]
  ds_read_b64_tr_b16 v[36:37], v17 offset:57344
  ds_read_b64_tr_b16 v[38:39], v17 offset:58368
  v_mfma_f32_16x16x32_bf16 v[184:187], a[180:183], v[44:47], v[184:187]
  buffer_store_dwordx4 v[104:107], v2, s[20:23], s39 offen sc1
  v_mfma_f32_16x16x32_bf16 v[184:187], a[176:179], v[40:43], v[184:187]
  v_mfma_f32_16x16x32_bf16 v[180:183], a[112:115], v[40:43], v[180:183]
  v_mfma_f32_16x16x32_bf16 v[180:183], a[116:119], v[44:47], v[180:183]
  v_mfma_f32_16x16x32_bf16 v[176:179], a[52:55], v[44:47], v[176:179]
  v_mfma_f32_16x16x32_bf16 v[176:179], a[48:51], v[40:43], v[176:179]
  s_waitcnt lgkmcnt(4)
  v_mfma_f32_16x16x32_bf16 v[128:131], a[56:59], v[48:51], v[128:131]
  ds_read_b64_tr_b16 v[40:41], v18 offset:49152
  ds_read_b64_tr_b16 v[42:43], v18 offset:50176
  v_mfma_f32_16x16x32_bf16 v[128:131], a[60:63], v[52:55], v[128:131]
  ds_read_b64_tr_b16 v[44:45], v18 offset:57344
  ds_read_b64_tr_b16 v[46:47], v18 offset:58368
  v_mfma_f32_16x16x32_bf16 v[132:135], a[124:127], v[52:55], v[132:135]
  s_lshl_b32 s3, s42, 3
  s_add_u32 s53, s3, s40
  v_mfma_f32_16x16x32_bf16 v[132:135], a[120:123], v[48:51], v[132:135]
  s_sub_u32 s52, 120, s3
  s_add_u32 s52, s52, s40
  v_mfma_f32_16x16x32_bf16 v[136:139], a[184:187], v[48:51], v[136:139]
  v_mov_b32 v24, s52
  v_mov_b32 v25, s53
  v_mfma_f32_16x16x32_bf16 v[136:139], a[188:191], v[52:55], v[136:139]
  v_cmp_gt_u32 vcc, 32, v1
  v_and_b32 v26, 4, v1
  v_mfma_f32_16x16x32_bf16 v[140:143], a[252:255], v[52:55], v[140:143]
  s_mov_b32 s55, 65011712
  v_cndmask_b32 v24, v24, v25, vcc
  v_mfma_f32_16x16x32_bf16 v[140:143], a[248:251], v[48:51], v[140:143]
  s_waitcnt lgkmcnt(4)
  v_add_u32 v24, v24, v26
  v_and_b32 v25, 1, v24
  v_mfma_f32_16x16x32_bf16 v[156:159], a[248:251], v[32:35], v[156:159]
  ds_read_b64_tr_b16 v[48:49], v19 offset:49152
  ds_read_b64_tr_b16 v[50:51], v19 offset:50176
  v_mfma_f32_16x16x32_bf16 v[156:159], a[252:255], v[36:39], v[156:159]
  ds_read_b64_tr_b16 v[52:53], v19 offset:57344
  ds_read_b64_tr_b16 v[54:55], v19 offset:58368
  v_mfma_f32_16x16x32_bf16 v[152:155], a[188:191], v[36:39], v[152:155]
  v_cvt_pk_bf16_f32 v64, v128, v129
  v_cvt_pk_bf16_f32 v65, v130, v131
  v_mfma_f32_16x16x32_bf16 v[152:155], a[184:187], v[32:35], v[152:155]
  v_cvt_pk_bf16_f32 v66, v132, v133
  v_cvt_pk_bf16_f32 v67, v134, v135
  v_mfma_f32_16x16x32_bf16 v[148:151], a[120:123], v[32:35], v[148:151]
  v_cvt_pk_bf16_f32 v68, v136, v137
  v_cvt_pk_bf16_f32 v69, v138, v139
  v_mfma_f32_16x16x32_bf16 v[148:151], a[124:127], v[36:39], v[148:151]
  v_cvt_pk_bf16_f32 v70, v140, v141
  v_cvt_pk_bf16_f32 v71, v142, v143
  v_mfma_f32_16x16x32_bf16 v[144:147], a[60:63], v[36:39], v[144:147]
  s_add_u32 s39, s37, 14336
  v_lshrrev_b32 v24, 1, v24
  v_lshlrev_b32 v24, 7, v24
  v_mfma_f32_16x16x32_bf16 v[144:147], a[56:59], v[32:35], v[144:147]
  s_waitcnt lgkmcnt(4)
  v_lshl_add_u32 v24, v25, 3, v24
  v_and_b32 v25, 1, v1
  v_mfma_f32_16x16x32_bf16 v[160:163], a[56:59], v[40:43], v[160:163]
  v_add_u32 v16, 0x18000, v16
  v_add_u32 v17, 0x18000, v17
  v_add_u32 v18, 0x18000, v18
  v_add_u32 v19, 0x18000, v19
  v_add_u32 v20, 0x18000, v20
  v_add_u32 v21, 0x18000, v21
  v_add_u32 v22, 0x18000, v22
  v_add_u32 v23, 0x18000, v23
  ds_read_b64_tr_b16 v[32:33], v20 offset:0
  ds_read_b64_tr_b16 v[34:35], v20 offset:1024
  v_mfma_f32_16x16x32_bf16 v[160:163], a[60:63], v[44:47], v[160:163]
  ds_read_b64_tr_b16 v[36:37], v20 offset:8192
  ds_read_b64_tr_b16 v[38:39], v20 offset:9216
  v_mfma_f32_16x16x32_bf16 v[164:167], a[124:127], v[44:47], v[164:167]
  v_cvt_pk_bf16_f32 v72, v144, v145
  v_cvt_pk_bf16_f32 v73, v146, v147
  v_mfma_f32_16x16x32_bf16 v[164:167], a[120:123], v[40:43], v[164:167]
  v_cvt_pk_bf16_f32 v74, v148, v149
  v_cvt_pk_bf16_f32 v75, v150, v151
  v_mfma_f32_16x16x32_bf16 v[168:171], a[184:187], v[40:43], v[168:171]
  v_cvt_pk_bf16_f32 v76, v152, v153
  v_cvt_pk_bf16_f32 v77, v154, v155
  v_mfma_f32_16x16x32_bf16 v[168:171], a[188:191], v[44:47], v[168:171]
  v_cvt_pk_bf16_f32 v78, v156, v157
  v_cvt_pk_bf16_f32 v79, v158, v159
  v_mfma_f32_16x16x32_bf16 v[172:175], a[252:255], v[44:47], v[172:175]
  buffer_store_dwordx4 v[108:111], v2, s[20:23], s39 offen sc1
  v_lshl_add_u32 v29, v25, 2, v24
  v_mfma_f32_16x16x32_bf16 v[172:175], a[248:251], v[40:43], v[172:175]
  s_waitcnt lgkmcnt(4)
  buffer_load_dword v28, v29, s[20:23], s55 offen sc1
  s_lshl_b32 s52, s52, 14
  v_mfma_f32_16x16x32_bf16 v[188:191], a[248:251], v[48:51], v[188:191]
  ds_read_b64_tr_b16 v[40:41], v21 offset:0
  ds_read_b64_tr_b16 v[42:43], v21 offset:1024
  v_mfma_f32_16x16x32_bf16 v[188:191], a[252:255], v[52:55], v[188:191]
  ds_read_b64_tr_b16 v[44:45], v21 offset:8192
  ds_read_b64_tr_b16 v[46:47], v21 offset:9216
  v_mfma_f32_16x16x32_bf16 v[184:187], a[188:191], v[52:55], v[184:187]
  v_cvt_pk_bf16_f32 v80, v160, v161
  v_cvt_pk_bf16_f32 v81, v162, v163
  v_mfma_f32_16x16x32_bf16 v[184:187], a[184:187], v[48:51], v[184:187]
  v_cvt_pk_bf16_f32 v82, v164, v165
  v_cvt_pk_bf16_f32 v83, v166, v167
  v_mfma_f32_16x16x32_bf16 v[180:183], a[120:123], v[48:51], v[180:183]
  v_cvt_pk_bf16_f32 v84, v168, v169
  v_cvt_pk_bf16_f32 v85, v170, v171
  v_mfma_f32_16x16x32_bf16 v[180:183], a[124:127], v[52:55], v[180:183]
  v_cvt_pk_bf16_f32 v86, v172, v173
  v_cvt_pk_bf16_f32 v87, v174, v175
  v_mfma_f32_16x16x32_bf16 v[176:179], a[60:63], v[52:55], v[176:179]
  s_add_u32 s52, s52, 50331648
  s_lshl_b32 s53, s53, 14
  v_mfma_f32_16x16x32_bf16 v[176:179], a[56:59], v[48:51], v[176:179]
  s_waitcnt lgkmcnt(4)
  s_add_u32 s53, s53, 50331648
  v_add_u32 v3, 65536, v2
  v_mfma_f32_16x16x32_bf16 v[192:195], a[0:3], v[32:35], 0
  ds_read_b64_tr_b16 v[48:49], v22 offset:0
  ds_read_b64_tr_b16 v[50:51], v22 offset:1024
  v_mfma_f32_16x16x32_bf16 v[192:195], a[4:7], v[36:39], v[192:195]
  ds_read_b64_tr_b16 v[52:53], v22 offset:8192
  ds_read_b64_tr_b16 v[54:55], v22 offset:9216
  v_mfma_f32_16x16x32_bf16 v[196:199], a[68:71], v[36:39], 0
  v_cvt_pk_bf16_f32 v88, v176, v177
  v_cvt_pk_bf16_f32 v89, v178, v179
  v_mfma_f32_16x16x32_bf16 v[196:199], a[64:67], v[32:35], v[196:199]
  v_cvt_pk_bf16_f32 v90, v180, v181
  v_cvt_pk_bf16_f32 v91, v182, v183
  v_mfma_f32_16x16x32_bf16 v[200:203], a[128:131], v[32:35], 0
  v_cvt_pk_bf16_f32 v92, v184, v185
  v_cvt_pk_bf16_f32 v93, v186, v187
  v_mfma_f32_16x16x32_bf16 v[200:203], a[132:135], v[36:39], v[200:203]
  v_cvt_pk_bf16_f32 v94, v188, v189
  v_cvt_pk_bf16_f32 v95, v190, v191
  v_mfma_f32_16x16x32_bf16 v[204:207], a[196:199], v[36:39], 0
  v_mfma_f32_16x16x32_bf16 v[204:207], a[192:195], v[32:35], v[204:207]
  s_waitcnt lgkmcnt(4)
  v_mfma_f32_16x16x32_bf16 v[220:223], a[192:195], v[40:43], 0
  ds_read_b64_tr_b16 v[32:33], v23 offset:0
  ds_read_b64_tr_b16 v[34:35], v23 offset:1024
  v_mfma_f32_16x16x32_bf16 v[220:223], a[196:199], v[44:47], v[220:223]
  ds_read_b64_tr_b16 v[36:37], v23 offset:8192
  ds_read_b64_tr_b16 v[38:39], v23 offset:9216
  v_mfma_f32_16x16x32_bf16 v[216:219], a[132:135], v[44:47], 0
  s_add_u32 s39, s37, 3072
  v_mfma_f32_16x16x32_bf16 v[216:219], a[128:131], v[40:43], v[216:219]
  v_mfma_f32_16x16x32_bf16 v[212:215], a[64:67], v[40:43], 0
  buffer_store_dwordx4 v[112:115], v2, s[20:23], s39 offen sc1
  v_mfma_f32_16x16x32_bf16 v[212:215], a[68:71], v[44:47], v[212:215]
  v_mfma_f32_16x16x32_bf16 v[208:211], a[4:7], v[44:47], 0
  v_mfma_f32_16x16x32_bf16 v[208:211], a[0:3], v[40:43], v[208:211]
  s_waitcnt lgkmcnt(4)
  v_mfma_f32_16x16x32_bf16 v[224:227], a[0:3], v[48:51], 0
  ds_read_b64_tr_b16 v[40:41], v20 offset:16384
  ds_read_b64_tr_b16 v[42:43], v20 offset:17408
  v_mfma_f32_16x16x32_bf16 v[224:227], a[4:7], v[52:55], v[224:227]
  ds_read_b64_tr_b16 v[44:45], v20 offset:24576
  ds_read_b64_tr_b16 v[46:47], v20 offset:25600
  v_mfma_f32_16x16x32_bf16 v[228:231], a[68:71], v[52:55], 0
  v_mfma_f32_16x16x32_bf16 v[228:231], a[64:67], v[48:51], v[228:231]
  v_mfma_f32_16x16x32_bf16 v[232:235], a[128:131], v[48:51], 0
  v_mfma_f32_16x16x32_bf16 v[232:235], a[132:135], v[52:55], v[232:235]
  v_mfma_f32_16x16x32_bf16 v[236:239], a[196:199], v[52:55], 0
  v_mfma_f32_16x16x32_bf16 v[236:239], a[192:195], v[48:51], v[236:239]
  s_waitcnt lgkmcnt(4)
  v_mfma_f32_16x16x32_bf16 v[252:255], a[192:195], v[32:35], 0
  ds_read_b64_tr_b16 v[48:49], v21 offset:16384
  ds_read_b64_tr_b16 v[50:51], v21 offset:17408
  v_mfma_f32_16x16x32_bf16 v[252:255], a[196:199], v[36:39], v[252:255]
  ds_read_b64_tr_b16 v[52:53], v21 offset:24576
  ds_read_b64_tr_b16 v[54:55], v21 offset:25600
  v_mfma_f32_16x16x32_bf16 v[248:251], a[132:135], v[36:39], 0
  v_mfma_f32_16x16x32_bf16 v[248:251], a[128:131], v[32:35], v[248:251]
  v_mfma_f32_16x16x32_bf16 v[244:247], a[64:67], v[32:35], 0
  v_mfma_f32_16x16x32_bf16 v[244:247], a[68:71], v[36:39], v[244:247]
  v_mfma_f32_16x16x32_bf16 v[240:243], a[4:7], v[36:39], 0
  v_mfma_f32_16x16x32_bf16 v[240:243], a[0:3], v[32:35], v[240:243]
  s_waitcnt lgkmcnt(4)
  v_mfma_f32_16x16x32_bf16 v[192:195], a[8:11], v[40:43], v[192:195]
  s_add_u32 s39, s37, 7168
  ds_read_b64_tr_b16 v[32:33], v22 offset:16384
  ds_read_b64_tr_b16 v[34:35], v22 offset:17408
  v_mfma_f32_16x16x32_bf16 v[192:195], a[12:15], v[44:47], v[192:195]
  ds_read_b64_tr_b16 v[36:37], v22 offset:24576
  ds_read_b64_tr_b16 v[38:39], v22 offset:25600
  v_mfma_f32_16x16x32_bf16 v[196:199], a[76:79], v[44:47], v[196:199]
  buffer_store_dwordx4 v[116:119], v2, s[20:23], s39 offen sc1
  v_mfma_f32_16x16x32_bf16 v[196:199], a[72:75], v[40:43], v[196:199]
  v_mfma_f32_16x16x32_bf16 v[200:203], a[136:139], v[40:43], v[200:203]
  v_mfma_f32_16x16x32_bf16 v[200:203], a[140:143], v[44:47], v[200:203]
  v_mfma_f32_16x16x32_bf16 v[204:207], a[204:207], v[44:47], v[204:207]
  v_mfma_f32_16x16x32_bf16 v[204:207], a[200:203], v[40:43], v[204:207]
  s_waitcnt lgkmcnt(4)
  v_mfma_f32_16x16x32_bf16 v[220:223], a[200:203], v[48:51], v[220:223]
  ds_read_b64_tr_b16 v[40:41], v23 offset:16384
  ds_read_b64_tr_b16 v[42:43], v23 offset:17408
  v_mfma_f32_16x16x32_bf16 v[220:223], a[204:207], v[52:55], v[220:223]
  ds_read_b64_tr_b16 v[44:45], v23 offset:24576
  ds_read_b64_tr_b16 v[46:47], v23 offset:25600
  v_mfma_f32_16x16x32_bf16 v[216:219], a[140:143], v[52:55], v[216:219]
  v_mfma_f32_16x16x32_bf16 v[216:219], a[136:139], v[48:51], v[216:219]
  v_mfma_f32_16x16x32_bf16 v[212:215], a[72:75], v[48:51], v[212:215]
  v_mfma_f32_16x16x32_bf16 v[212:215], a[76:79], v[52:55], v[212:215]
  v_mfma_f32_16x16x32_bf16 v[208:211], a[12:15], v[52:55], v[208:211]
  v_mfma_f32_16x16x32_bf16 v[208:211], a[8:11], v[48:51], v[208:211]
  s_waitcnt lgkmcnt(4)
  v_mfma_f32_16x16x32_bf16 v[224:227], a[8:11], v[32:35], v[224:227]
  ds_read_b64_tr_b16 v[48:49], v20 offset:32768
  ds_read_b64_tr_b16 v[50:51], v20 offset:33792
  v_mfma_f32_16x16x32_bf16 v[224:227], a[12:15], v[36:39], v[224:227]
  ds_read_b64_tr_b16 v[52:53], v20 offset:40960
  ds_read_b64_tr_b16 v[54:55], v20 offset:41984
  v_mfma_f32_16x16x32_bf16 v[228:231], a[76:79], v[36:39], v[228:231]
  v_mfma_f32_16x16x32_bf16 v[228:231], a[72:75], v[32:35], v[228:231]
  v_mfma_f32_16x16x32_bf16 v[232:235], a[136:139], v[32:35], v[232:235]
  v_mfma_f32_16x16x32_bf16 v[232:235], a[140:143], v[36:39], v[232:235]
  v_mfma_f32_16x16x32_bf16 v[236:239], a[204:207], v[36:39], v[236:239]
  s_add_u32 s39, s37, 11264
  v_mfma_f32_16x16x32_bf16 v[236:239], a[200:203], v[32:35], v[236:239]
  s_waitcnt lgkmcnt(4)
  v_mfma_f32_16x16x32_bf16 v[252:255], a[200:203], v[40:43], v[252:255]
  ds_read_b64_tr_b16 v[32:33], v21 offset:32768
  ds_read_b64_tr_b16 v[34:35], v21 offset:33792
  v_mfma_f32_16x16x32_bf16 v[252:255], a[204:207], v[44:47], v[252:255]
  ds_read_b64_tr_b16 v[36:37], v21 offset:40960
  ds_read_b64_tr_b16 v[38:39], v21 offset:41984
  v_mfma_f32_16x16x32_bf16 v[248:251], a[140:143], v[44:47], v[248:251]
  buffer_store_dwordx4 v[120:123], v2, s[20:23], s39 offen sc1
  v_mfma_f32_16x16x32_bf16 v[248:251], a[136:139], v[40:43], v[248:251]
  v_mfma_f32_16x16x32_bf16 v[244:247], a[72:75], v[40:43], v[244:247]
  v_mfma_f32_16x16x32_bf16 v[244:247], a[76:79], v[44:47], v[244:247]
  v_mfma_f32_16x16x32_bf16 v[240:243], a[12:15], v[44:47], v[240:243]
  v_mfma_f32_16x16x32_bf16 v[240:243], a[8:11], v[40:43], v[240:243]
  s_waitcnt lgkmcnt(4)
  v_mfma_f32_16x16x32_bf16 v[192:195], a[16:19], v[48:51], v[192:195]
  ds_read_b64_tr_b16 v[40:41], v22 offset:32768
  ds_read_b64_tr_b16 v[42:43], v22 offset:33792
  v_mfma_f32_16x16x32_bf16 v[192:195], a[20:23], v[52:55], v[192:195]
  ds_read_b64_tr_b16 v[44:45], v22 offset:40960
  ds_read_b64_tr_b16 v[46:47], v22 offset:41984
  v_mfma_f32_16x16x32_bf16 v[196:199], a[84:87], v[52:55], v[196:199]
  v_mfma_f32_16x16x32_bf16 v[196:199], a[80:83], v[48:51], v[196:199]
  v_mfma_f32_16x16x32_bf16 v[200:203], a[144:147], v[48:51], v[200:203]
  v_mfma_f32_16x16x32_bf16 v[200:203], a[148:151], v[52:55], v[200:203]
  v_mfma_f32_16x16x32_bf16 v[204:207], a[212:215], v[52:55], v[204:207]
  v_mfma_f32_16x16x32_bf16 v[204:207], a[208:211], v[48:51], v[204:207]
  s_waitcnt lgkmcnt(4)
  v_mfma_f32_16x16x32_bf16 v[220:223], a[208:211], v[32:35], v[220:223]
  ds_read_b64_tr_b16 v[48:49], v23 offset:32768
  ds_read_b64_tr_b16 v[50:51], v23 offset:33792
  v_mfma_f32_16x16x32_bf16 v[220:223], a[212:215], v[36:39], v[220:223]
  ds_read_b64_tr_b16 v[52:53], v23 offset:40960
  ds_read_b64_tr_b16 v[54:55], v23 offset:41984
  v_mfma_f32_16x16x32_bf16 v[216:219], a[148:151], v[36:39], v[216:219]
  v_mfma_f32_16x16x32_bf16 v[216:219], a[144:147], v[32:35], v[216:219]
  v_mfma_f32_16x16x32_bf16 v[212:215], a[80:83], v[32:35], v[212:215]
  v_mfma_f32_16x16x32_bf16 v[212:215], a[84:87], v[36:39], v[212:215]
  v_mfma_f32_16x16x32_bf16 v[208:211], a[20:23], v[36:39], v[208:211]
  s_add_u32 s39, s37, 15360
  v_mfma_f32_16x16x32_bf16 v[208:211], a[16:19], v[32:35], v[208:211]
  s_waitcnt lgkmcnt(4)
  v_mfma_f32_16x16x32_bf16 v[224:227], a[16:19], v[40:43], v[224:227]
  ds_read_b64_tr_b16 v[32:33], v20 offset:49152
  ds_read_b64_tr_b16 v[34:35], v20 offset:50176
  v_mfma_f32_16x16x32_bf16 v[224:227], a[20:23], v[44:47], v[224:227]
  ds_read_b64_tr_b16 v[36:37], v20 offset:57344
  ds_read_b64_tr_b16 v[38:39], v20 offset:58368
  v_mfma_f32_16x16x32_bf16 v[228:231], a[84:87], v[44:47], v[228:231]
  buffer_store_dwordx4 v[124:127], v2, s[20:23], s39 offen sc1
  v_mfma_f32_16x16x32_bf16 v[228:231], a[80:83], v[40:43], v[228:231]
  v_mfma_f32_16x16x32_bf16 v[232:235], a[144:147], v[40:43], v[232:235]
  v_mfma_f32_16x16x32_bf16 v[232:235], a[148:151], v[44:47], v[232:235]
  v_mfma_f32_16x16x32_bf16 v[236:239], a[212:215], v[44:47], v[236:239]
  v_mfma_f32_16x16x32_bf16 v[236:239], a[208:211], v[40:43], v[236:239]
  s_waitcnt lgkmcnt(4)
  v_mfma_f32_16x16x32_bf16 v[252:255], a[208:211], v[48:51], v[252:255]
  ds_read_b64_tr_b16 v[40:41], v21 offset:49152
  ds_read_b64_tr_b16 v[42:43], v21 offset:50176
  v_mfma_f32_16x16x32_bf16 v[252:255], a[212:215], v[52:55], v[252:255]
  ds_read_b64_tr_b16 v[44:45], v21 offset:57344
  ds_read_b64_tr_b16 v[46:47], v21 offset:58368
  v_mfma_f32_16x16x32_bf16 v[248:251], a[148:151], v[52:55], v[248:251]
  s_waitcnt vmcnt(4)
  v_cmp_ne_u32 vcc, 1, v28
  s_cbranch_vccz Lspok13
  s_mov_b32 s5, 0
Lspin12:
  s_sleep 16
  buffer_load_dword v28, v29, s[20:23], s55 offen sc1
  s_add_u32 s5, s5, 1
  s_waitcnt vmcnt(0)
  v_cmp_ne_u32 vcc, 1, v28
  s_cbranch_vccz Lspok13
  s_cmp_lt_u32 s5, 0x10000
  s_cbranch_scc1 Lspin12
Lspok13:
  v_mfma_f32_16x16x32_bf16 v[248:251], a[144:147], v[48:51], v[248:251]
  v_mfma_f32_16x16x32_bf16 v[244:247], a[80:83], v[48:51], v[244:247]
  v_mfma_f32_16x16x32_bf16 v[244:247], a[84:87], v[52:55], v[244:247]
  v_mfma_f32_16x16x32_bf16 v[240:243], a[20:23], v[52:55], v[240:243]
  v_mfma_f32_16x16x32_bf16 v[240:243], a[16:19], v[48:51], v[240:243]
  s_waitcnt lgkmcnt(4)
  v_mfma_f32_16x16x32_bf16 v[192:195], a[24:27], v[32:35], v[192:195]
  s_add_u32 s50, s38, 0
  ds_read_b64_tr_b16 v[48:49], v22 offset:49152
  ds_read_b64_tr_b16 v[50:51], v22 offset:50176
  v_mfma_f32_16x16x32_bf16 v[192:195], a[28:31], v[36:39], v[192:195]
  s_and_b32 s50, s50, 7
  ds_read_b64_tr_b16 v[52:53], v22 offset:57344
  ds_read_b64_tr_b16 v[54:55], v22 offset:58368
  v_mfma_f32_16x16x32_bf16 v[196:199], a[92:95], v[36:39], v[196:199]
  s_lshl_b32 s50, s50, 11
  s_add_u32 s49, s50, s52
  s_add_u32 s50, s50, s53
  buffer_load_dwordx4 a[0:3], v2, s[20:23], s49 offen offset:0 sc1
  v_mfma_f32_16x16x32_bf16 v[196:199], a[88:91], v[32:35], v[196:199]
  buffer_load_dwordx4 a[4:7], v2, s[20:23], s49 offen offset:1024 sc1
  v_mfma_f32_16x16x32_bf16 v[200:203], a[152:155], v[32:35], v[200:203]
  v_mfma_f32_16x16x32_bf16 v[200:203], a[156:159], v[36:39], v[200:203]
  v_mfma_f32_16x16x32_bf16 v[204:207], a[220:223], v[36:39], v[204:207]
  s_add_u32 s39, s37, 16777216
  v_mfma_f32_16x16x32_bf16 v[204:207], a[216:219], v[32:35], v[204:207]
  s_waitcnt lgkmcnt(4)
  v_mfma_f32_16x16x32_bf16 v[220:223], a[216:219], v[40:43], v[220:223]
  ds_read_b64_tr_b16 v[32:33], v23 offset:49152
  ds_read_b64_tr_b16 v[34:35], v23 offset:50176
  v_mfma_f32_16x16x32_bf16 v[220:223], a[220:223], v[44:47], v[220:223]
  ds_read_b64_tr_b16 v[36:37], v23 offset:57344
  ds_read_b64_tr_b16 v[38:39], v23 offset:58368
  v_mfma_f32_16x16x32_bf16 v[216:219], a[156:159], v[44:47], v[216:219]
  buffer_load_dwordx4 a[64:67], v3, s[20:23], s49 offen offset:0 sc1
  buffer_store_dwordx4 v[64:67], v2, s[20:23], s39 offen sc1
  v_mfma_f32_16x16x32_bf16 v[216:219], a[152:155], v[40:43], v[216:219]
  v_mfma_f32_16x16x32_bf16 v[212:215], a[88:91], v[40:43], v[212:215]
  v_mfma_f32_16x16x32_bf16 v[212:215], a[92:95], v[44:47], v[212:215]
  v_mfma_f32_16x16x32_bf16 v[208:211], a[28:31], v[44:47], v[208:211]
  v_mfma_f32_16x16x32_bf16 v[208:211], a[24:27], v[40:43], v[208:211]
  s_waitcnt lgkmcnt(4)
  buffer_load_dwordx4 a[68:71], v3, s[20:23], s49 offen offset:1024 sc1
  v_mfma_f32_16x16x32_bf16 v[224:227], a[24:27], v[48:51], v[224:227]
  v_mfma_f32_16x16x32_bf16 v[224:227], a[28:31], v[52:55], v[224:227]
  v_mfma_f32_16x16x32_bf16 v[228:231], a[92:95], v[52:55], v[228:231]
  s_waitcnt lgkmcnt(0)
  s_barrier
  v_add_u32 v16, 0xfffe8000, v16
  v_add_u32 v17, 0xfffe8000, v17
  v_add_u32 v18, 0xfffe8000, v18
  v_add_u32 v19, 0xfffe8000, v19
  v_add_u32 v20, 0xfffe8000, v20
  v_add_u32 v21, 0xfffe8000, v21
  v_add_u32 v22, 0xfffe8000, v22
  v_add_u32 v23, 0xfffe8000, v23
  ds_read_b64_tr_b16 v[40:41], v20 offset:0
  ds_read_b64_tr_b16 v[42:43], v20 offset:1024
  v_mfma_f32_16x16x32_bf16 v[228:231], a[88:91], v[48:51], v[228:231]
  ds_read_b64_tr_b16 v[44:45], v20 offset:8192
  ds_read_b64_tr_b16 v[46:47], v20 offset:9216
  v_mfma_f32_16x16x32_bf16 v[232:235], a[152:155], v[48:51], v[232:235]
  v_mfma_f32_16x16x32_bf16 v[232:235], a[156:159], v[52:55], v[232:235]
  buffer_load_dwordx4 a[128:131], v2, s[20:23], s50 offen offset:0 sc1
  v_mfma_f32_16x16x32_bf16 v[236:239], a[220:223], v[52:55], v[236:239]
  v_mfma_f32_16x16x32_bf16 v[236:239], a[216:219], v[48:51], v[236:239]
  v_mfma_f32_16x16x32_bf16 v[252:255], a[216:219], v[32:35], v[252:255]
  ds_read_b64_tr_b16 v[48:49], v21 offset:0
  ds_read_b64_tr_b16 v[50:51], v21 offset:1024
  v_mfma_f32_16x16x32_bf16 v[252:255], a[220:223], v[36:39], v[252:255]
  ds_read_b64_tr_b16 v[52:53], v21 offset:8192
  ds_read_b64_tr_b16 v[54:55], v21 offset:9216
  v_mfma_f32_16x16x32_bf16 v[248:251], a[156:159], v[36:39], v[248:251]
  v_mfma_f32_16x16x32_bf16 v[248:251], a[152:155], v[32:35], v[248:251]
  buffer_load_dwordx4 a[132:135], v2, s[20:23], s50 offen offset:1024 sc1
  v_mfma_f32_16x16x32_bf16 v[244:247], a[88:91], v[32:35], v[244:247]
  v_mfma_f32_16x16x32_bf16 v[244:247], a[92:95], v[36:39], v[244:247]
  v_mfma_f32_16x16x32_bf16 v[240:243], a[28:31], v[36:39], v[240:243]
  s_add_u32 s39, s37, 16785408
  v_mfma_f32_16x16x32_bf16 v[240:243], a[24:27], v[32:35], v[240:243]
  s_waitcnt lgkmcnt(4)
  v_mfma_f32_16x16x32_bf16 v[192:195], a[32:35], v[40:43], v[192:195]
  ds_read_b64_tr_b16 v[32:33], v22 offset:0
  ds_read_b64_tr_b16 v[34:35], v22 offset:1024
  v_mfma_f32_16x16x32_bf16 v[192:195], a[36:39], v[44:47], v[192:195]
  ds_read_b64_tr_b16 v[36:37], v22 offset:8192
  ds_read_b64_tr_b16 v[38:39], v22 offset:9216
  v_mfma_f32_16x16x32_bf16 v[196:199], a[100:103], v[44:47], v[196:199]
  buffer_load_dwordx4 a[192:195], v3, s[20:23], s50 offen offset:0 sc1
  buffer_store_dwordx4 v[68:71], v2, s[20:23], s39 offen sc1
  v_mfma_f32_16x16x32_bf16 v[196:199], a[96:99], v[40:43], v[196:199]
  v_mfma_f32_16x16x32_bf16 v[200:203], a[160:163], v[40:43], v[200:203]
  v_mfma_f32_16x16x32_bf16 v[200:203], a[164:167], v[44:47], v[200:203]
  v_mfma_f32_16x16x32_bf16 v[204:207], a[228:231], v[44:47], v[204:207]
  v_mfma_f32_16x16x32_bf16 v[204:207], a[224:227], v[40:43], v[204:207]
  s_waitcnt lgkmcnt(4)
  buffer_load_dwordx4 a[196:199], v3, s[20:23], s50 offen offset:1024 sc1
  v_mfma_f32_16x16x32_bf16 v[220:223], a[224:227], v[48:51], v[220:223]
  s_add_u32 s50, s38, 1
  ds_read_b64_tr_b16 v[40:41], v23 offset:0
  ds_read_b64_tr_b16 v[42:43], v23 offset:1024
  v_mfma_f32_16x16x32_bf16 v[220:223], a[228:231], v[52:55], v[220:223]
  s_and_b32 s50, s50, 7
  ds_read_b64_tr_b16 v[44:45], v23 offset:8192
  ds_read_b64_tr_b16 v[46:47], v23 offset:9216
  v_mfma_f32_16x16x32_bf16 v[216:219], a[164:167], v[52:55], v[216:219]
  s_lshl_b32 s50, s50, 11
  v_mfma_f32_16x16x32_bf16 v[216:219], a[160:163], v[48:51], v[216:219]
  s_add_u32 s49, s50, s52
  v_mfma_f32_16x16x32_bf16 v[212:215], a[96:99], v[48:51], v[212:215]
  s_add_u32 s50, s50, s53
  v_mfma_f32_16x16x32_bf16 v[212:215], a[100:103], v[52:55], v[212:215]
  buffer_load_dwordx4 a[8:11], v2, s[20:23], s49 offen offset:0 sc1
  v_mfma_f32_16x16x32_bf16 v[208:211], a[36:39], v[52:55], v[208:211]
  v_mfma_f32_16x16x32_bf16 v[208:211], a[32:35], v[48:51], v[208:211]
  s_waitcnt lgkmcnt(4)
  v_mfma_f32_16x16x32_bf16 v[224:227], a[32:35], v[32:35], v[224:227]
  ds_read_b64_tr_b16 v[48:49], v20 offset:16384
  ds_read_b64_tr_b16 v[50:51], v20 offset:17408
  v_mfma_f32_16x16x32_bf16 v[224:227], a[36:39], v[36:39], v[224:227]
  ds_read_b64_tr_b16 v[52:53], v20 offset:24576
  ds_read_b64_tr_b16 v[54:55], v20 offset:25600
  v_mfma_f32_16x16x32_bf16 v[228:231], a[100:103], v[36:39], v[228:231]
  v_mfma_f32_16x16x32_bf16 v[228:231], a[96:99], v[32:35], v[228:231]
  buffer_load_dwordx4 a[12:15], v2, s[20:23], s49 offen offset:1024 sc1
  v_mfma_f32_16x16x32_bf16 v[232:235], a[160:163], v[32:35], v[232:235]
  v_mfma_f32_16x16x32_bf16 v[232:235], a[164:167], v[36:39], v[232:235]
  v_mfma_f32_16x16x32_bf16 v[236:239], a[228:231], v[36:39], v[236:239]
  s_add_u32 s39, s37, 16778240
  v_mfma_f32_16x16x32_bf16 v[236:239], a[224:227], v[32:35], v[236:239]
  s_waitcnt lgkmcnt(4)
  v_mfma_f32_16x16x32_bf16 v[252:255], a[224:227], v[40:43], v[252:255]
  ds_read_b64_tr_b16 v[32:33], v21 offset:16384
  ds_read_b64_tr_b16 v[34:35], v21 offset:17408
  v_mfma_f32_16x16x32_bf16 v[252:255], a[228:231], v[44:47], v[252:255]
  ds_read_b64_tr_b16 v[36:37], v21 offset:24576
  ds_read_b64_tr_b16 v[38:39], v21 offset:25600
  v_mfma_f32_16x16x32_bf16 v[248:251], a[164:167], v[44:47], v[248:251]
  buffer_load_dwordx4 a[72:75], v3, s[20:23], s49 offen offset:0 sc1
  buffer_store_dwordx4 v[72:75], v2, s[20:23], s39 offen sc1
  v_mfma_f32_16x16x32_bf16 v[248:251], a[160:163], v[40:43], v[248:251]
  v_mfma_f32_16x16x32_bf16 v[244:247], a[96:99], v[40:43], v[244:247]
  v_mfma_f32_16x16x32_bf16 v[244:247], a[100:103], v[44:47], v[244:247]
  v_mfma_f32_16x16x32_bf16 v[240:243], a[36:39], v[44:47], v[240:243]
  v_mfma_f32_16x16x32_bf16 v[240:243], a[32:35], v[40:43], v[240:243]
  s_waitcnt lgkmcnt(4)
  buffer_load_dwordx4 a[76:79], v3, s[20:23], s49 offen offset:1024 sc1
  v_mfma_f32_16x16x32_bf16 v[192:195], a[40:43], v[48:51], v[192:195]
  ds_read_b64_tr_b16 v[40:41], v22 offset:16384
  ds_read_b64_tr_b16 v[42:43], v22 offset:17408
  v_mfma_f32_16x16x32_bf16 v[192:195], a[44:47], v[52:55], v[192:195]
  ds_read_b64_tr_b16 v[44:45], v22 offset:24576
  ds_read_b64_tr_b16 v[46:47], v22 offset:25600
  v_mfma_f32_16x16x32_bf16 v[196:199], a[108:111], v[52:55], v[196:199]
  v_mfma_f32_16x16x32_bf16 v[196:199], a[104:107], v[48:51], v[196:199]
  v_mfma_f32_16x16x32_bf16 v[200:203], a[168:171], v[48:51], v[200:203]
  v_mfma_f32_16x16x32_bf16 v[200:203], a[172:175], v[52:55], v[200:203]
  buffer_load_dwordx4 a[136:139], v2, s[20:23], s50 offen offset:0 sc1
  v_mfma_f32_16x16x32_bf16 v[204:207], a[236:239], v[52:55], v[204:207]
  v_mfma_f32_16x16x32_bf16 v[204:207], a[232:235], v[48:51], v[204:207]
  s_waitcnt lgkmcnt(4)
  v_mfma_f32_16x16x32_bf16 v[220:223], a[232:235], v[32:35], v[220:223]
  ds_read_b64_tr_b16 v[48:49], v23 offset:16384
  ds_read_b64_tr_b16 v[50:51], v23 offset:17408
  v_mfma_f32_16x16x32_bf16 v[220:223], a[236:239], v[36:39], v[220:223]
  ds_read_b64_tr_b16 v[52:53], v23 offset:24576
  ds_read_b64_tr_b16 v[54:55], v23 offset:25600
  v_mfma_f32_16x16x32_bf16 v[216:219], a[172:175], v[36:39], v[216:219]
  v_mfma_f32_16x16x32_bf16 v[216:219], a[168:171], v[32:35], v[216:219]
  buffer_load_dwordx4 a[140:143], v2, s[20:23], s50 offen offset:1024 sc1
  v_mfma_f32_16x16x32_bf16 v[212:215], a[104:107], v[32:35], v[212:215]
  v_mfma_f32_16x16x32_bf16 v[212:215], a[108:111], v[36:39], v[212:215]
  v_mfma_f32_16x16x32_bf16 v[208:211], a[44:47], v[36:39], v[208:211]
  s_add_u32 s39, s37, 16786432
  v_mfma_f32_16x16x32_bf16 v[208:211], a[40:43], v[32:35], v[208:211]
  s_waitcnt lgkmcnt(4)
  v_mfma_f32_16x16x32_bf16 v[224:227], a[40:43], v[40:43], v[224:227]
  ds_read_b64_tr_b16 v[32:33], v20 offset:32768
  ds_read_b64_tr_b16 v[34:35], v20 offset:33792
  v_mfma_f32_16x16x32_bf16 v[224:227], a[44:47], v[44:47], v[224:227]
  ds_read_b64_tr_b16 v[36:37], v20 offset:40960
  ds_read_b64_tr_b16 v[38:39], v20 offset:41984
  v_mfma_f32_16x16x32_bf16 v[228:231], a[108:111], v[44:47], v[228:231]
  buffer_load_dwordx4 a[200:203], v3, s[20:23], s50 offen offset:0 sc1
  buffer_store_dwordx4 v[76:79], v2, s[20:23], s39 offen sc1
  v_mfma_f32_16x16x32_bf16 v[228:231], a[104:107], v[40:43], v[228:231]
  v_mfma_f32_16x16x32_bf16 v[232:235], a[168:171], v[40:43], v[232:235]
  v_mfma_f32_16x16x32_bf16 v[232:235], a[172:175], v[44:47], v[232:235]
  v_mfma_f32_16x16x32_bf16 v[236:239], a[236:239], v[44:47], v[236:239]
  v_mfma_f32_16x16x32_bf16 v[236:239], a[232:235], v[40:43], v[236:239]
  s_waitcnt lgkmcnt(4)
  buffer_load_dwordx4 a[204:207], v3, s[20:23], s50 offen offset:1024 sc1
  v_mfma_f32_16x16x32_bf16 v[252:255], a[232:235], v[48:51], v[252:255]
  s_add_u32 s50, s38, 2
  ds_read_b64_tr_b16 v[40:41], v21 offset:32768
  ds_read_b64_tr_b16 v[42:43], v21 offset:33792
  v_mfma_f32_16x16x32_bf16 v[252:255], a[236:239], v[52:55], v[252:255]
  s_and_b32 s50, s50, 7
  ds_read_b64_tr_b16 v[44:45], v21 offset:40960
  ds_read_b64_tr_b16 v[46:47], v21 offset:41984
  v_mfma_f32_16x16x32_bf16 v[248:251], a[172:175], v[52:55], v[248:251]
  s_lshl_b32 s50, s50, 11
  v_mfma_f32_16x16x32_bf16 v[248:251], a[168:171], v[48:51], v[248:251]
  s_add_u32 s49, s50, s52
  v_mfma_f32_16x16x32_bf16 v[244:247], a[104:107], v[48:51], v[244:247]
  s_add_u32 s50, s50, s53
  v_mfma_f32_16x16x32_bf16 v[244:247], a[108:111], v[52:55], v[244:247]
  buffer_load_dwordx4 a[16:19], v2, s[20:23], s49 offen offset:0 sc1
  v_mfma_f32_16x16x32_bf16 v[240:243], a[44:47], v[52:55], v[240:243]
  v_mfma_f32_16x16x32_bf16 v[240:243], a[40:43], v[48:51], v[240:243]
  s_waitcnt lgkmcnt(4)
  v_mfma_f32_16x16x32_bf16 v[192:195], a[48:51], v[32:35], v[192:195]
  ds_read_b64_tr_b16 v[48:49], v22 offset:32768
  ds_read_b64_tr_b16 v[50:51], v22 offset:33792
  v_mfma_f32_16x16x32_bf16 v[192:195], a[52:55], v[36:39], v[192:195]
  ds_read_b64_tr_b16 v[52:53], v22 offset:40960
  ds_read_b64_tr_b16 v[54:55], v22 offset:41984
  v_mfma_f32_16x16x32_bf16 v[196:199], a[116:119], v[36:39], v[196:199]
  v_mfma_f32_16x16x32_bf16 v[196:199], a[112:115], v[32:35], v[196:199]
  buffer_load_dwordx4 a[20:23], v2, s[20:23], s49 offen offset:1024 sc1
  v_mfma_f32_16x16x32_bf16 v[200:203], a[176:179], v[32:35], v[200:203]
  v_mfma_f32_16x16x32_bf16 v[200:203], a[180:183], v[36:39], v[200:203]
  v_mfma_f32_16x16x32_bf16 v[204:207], a[244:247], v[36:39], v[204:207]
  s_add_u32 s39, s37, 16779264
  v_mfma_f32_16x16x32_bf16 v[204:207], a[240:243], v[32:35], v[204:207]
  s_waitcnt lgkmcnt(4)
  v_mfma_f32_16x16x32_bf16 v[220:223], a[240:243], v[40:43], v[220:223]
  ds_read_b64_tr_b16 v[32:33], v23 offset:32768
  ds_read_b64_tr_b16 v[34:35], v23 offset:33792
  v_mfma_f32_16x16x32_bf16 v[220:223], a[244:247], v[44:47], v[220:223]
  ds_read_b64_tr_b16 v[36:37], v23 offset:40960
  ds_read_b64_tr_b16 v[38:39], v23 offset:41984
  v_mfma_f32_16x16x32_bf16 v[216:219], a[180:183], v[44:47], v[216:219]
  buffer_load_dwordx4 a[80:83], v3, s[20:23], s49 offen offset:0 sc1
  buffer_store_dwordx4 v[80:83], v2, s[20:23], s39 offen sc1
  v_mfma_f32_16x16x32_bf16 v[216:219], a[176:179], v[40:43], v[216:219]
  v_mfma_f32_16x16x32_bf16 v[212:215], a[112:115], v[40:43], v[212:215]
  v_mfma_f32_16x16x32_bf16 v[212:215], a[116:119], v[44:47], v[212:215]
  v_mfma_f32_16x16x32_bf16 v[208:211], a[52:55], v[44:47], v[208:211]
  v_mfma_f32_16x16x32_bf16 v[208:211], a[48:51], v[40:43], v[208:211]
  s_waitcnt lgkmcnt(4)
  buffer_load_dwordx4 a[84:87], v3, s[20:23], s49 offen offset:1024 sc1
  v_mfma_f32_16x16x32_bf16 v[224:227], a[48:51], v[48:51], v[224:227]
  ds_read_b64_tr_b16 v[40:41], v20 offset:49152
  ds_read_b64_tr_b16 v[42:43], v20 offset:50176
  v_mfma_f32_16x16x32_bf16 v[224:227], a[52:55], v[52:55], v[224:227]
  ds_read_b64_tr_b16 v[44:45], v20 offset:57344
  ds_read_b64_tr_b16 v[46:47], v20 offset:58368
  v_mfma_f32_16x16x32_bf16 v[228:231], a[116:119], v[52:55], v[228:231]
  v_mfma_f32_16x16x32_bf16 v[228:231], a[112:115], v[48:51], v[228:231]
  v_mfma_f32_16x16x32_bf16 v[232:235], a[176:179], v[48:51], v[232:235]
  v_mfma_f32_16x16x32_bf16 v[232:235], a[180:183], v[52:55], v[232:235]
  buffer_load_dwordx4 a[144:147], v2, s[20:23], s50 offen offset:0 sc1
  v_mfma_f32_16x16x32_bf16 v[236:239], a[244:247], v[52:55], v[236:239]
  v_mfma_f32_16x16x32_bf16 v[236:239], a[240:243], v[48:51], v[236:239]
  s_waitcnt lgkmcnt(4)
  v_mfma_f32_16x16x32_bf16 v[252:255], a[240:243], v[32:35], v[252:255]
  ds_read_b64_tr_b16 v[48:49], v21 offset:49152
  ds_read_b64_tr_b16 v[50:51], v21 offset:50176
  v_mfma_f32_16x16x32_bf16 v[252:255], a[244:247], v[36:39], v[252:255]
  ds_read_b64_tr_b16 v[52:53], v21 offset:57344
  ds_read_b64_tr_b16 v[54:55], v21 offset:58368
  v_mfma_f32_16x16x32_bf16 v[248:251], a[180:183], v[36:39], v[248:251]
  v_mfma_f32_16x16x32_bf16 v[248:251], a[176:179], v[32:35], v[248:251]
  buffer_load_dwordx4 a[148:151], v2, s[20:23], s50 offen offset:1024 sc1
  v_mfma_f32_16x16x32_bf16 v[244:247], a[112:115], v[32:35], v[244:247]
  v_mfma_f32_16x16x32_bf16 v[244:247], a[116:119], v[36:39], v[244:247]
  v_mfma_f32_16x16x32_bf16 v[240:243], a[52:55], v[36:39], v[240:243]
  s_add_u32 s39, s37, 16787456
  v_mfma_f32_16x16x32_bf16 v[240:243], a[48:51], v[32:35], v[240:243]
  s_waitcnt lgkmcnt(4)
  v_mfma_f32_16x16x32_bf16 v[192:195], a[56:59], v[40:43], v[192:195]
  ds_read_b64_tr_b16 v[32:33], v22 offset:49152
  ds_read_b64_tr_b16 v[34:35], v22 offset:50176
  v_mfma_f32_16x16x32_bf16 v[192:195], a[60:63], v[44:47], v[192:195]
  ds_read_b64_tr_b16 v[36:37], v22 offset:57344
  ds_read_b64_tr_b16 v[38:39], v22 offset:58368
  v_mfma_f32_16x16x32_bf16 v[196:199], a[124:127], v[44:47], v[196:199]
  buffer_load_dwordx4 a[208:211], v3, s[20:23], s50 offen offset:0 sc1
  buffer_store_dwordx4 v[84:87], v2, s[20:23], s39 offen sc1
  v_mfma_f32_16x16x32_bf16 v[196:199], a[120:123], v[40:43], v[196:199]
  v_mfma_f32_16x16x32_bf16 v[200:203], a[184:187], v[40:43], v[200:203]
  v_mfma_f32_16x16x32_bf16 v[200:203], a[188:191], v[44:47], v[200:203]
  v_mfma_f32_16x16x32_bf16 v[204:207], a[252:255], v[44:47], v[204:207]
  v_mfma_f32_16x16x32_bf16 v[204:207], a[248:251], v[40:43], v[204:207]
  s_waitcnt lgkmcnt(4)
  buffer_load_dwordx4 a[212:215], v3, s[20:23], s50 offen offset:1024 sc1
  v_mfma_f32_16x16x32_bf16 v[220:223], a[248:251], v[48:51], v[220:223]
  s_add_u32 m0, s36, 98304
  ds_read_b64_tr_b16 v[40:41], v23 offset:49152
  ds_read_b64_tr_b16 v[42:43], v23 offset:50176
  v_mfma_f32_16x16x32_bf16 v[220:223], a[252:255], v[52:55], v[220:223]
  s_add_u32 s51, s38, 2
  ds_read_b64_tr_b16 v[44:45], v23 offset:57344
  ds_read_b64_tr_b16 v[46:47], v23 offset:58368
  v_mfma_f32_16x16x32_bf16 v[216:219], a[188:191], v[52:55], v[216:219]
  s_and_b32 s51, s51, 7
  v_cvt_pk_bf16_f32 v96, v192, v193
  v_cvt_pk_bf16_f32 v97, v194, v195
  v_mfma_f32_16x16x32_bf16 v[216:219], a[184:187], v[48:51], v[216:219]
  s_lshl_b32 s51, s51, 19
  v_cvt_pk_bf16_f32 v98, v196, v197
  v_cvt_pk_bf16_f32 v99, v198, v199
  v_mfma_f32_16x16x32_bf16 v[212:215], a[120:123], v[48:51], v[212:215]
  s_add_u32 s51, s51, s34
  v_cvt_pk_bf16_f32 v100, v200, v201
  v_cvt_pk_bf16_f32 v101, v202, v203
  v_mfma_f32_16x16x32_bf16 v[212:215], a[124:127], v[52:55], v[212:215]
  buffer_load_dwordx4 v8, s[12:15], s51 offen offset:0 lds
  v_cvt_pk_bf16_f32 v102, v204, v205
  v_mfma_f32_16x16x32_bf16 v[208:211], a[60:63], v[52:55], v[208:211]
  v_cvt_pk_bf16_f32 v103, v206, v207
  v_mfma_f32_16x16x32_bf16 v[208:211], a[56:59], v[48:51], v[208:211]
  s_waitcnt lgkmcnt(4)
  v_mfma_f32_16x16x32_bf16 v[224:227], a[56:59], v[32:35], v[224:227]
  v_mfma_f32_16x16x32_bf16 v[224:227], a[60:63], v[36:39], v[224:227]
  v_mfma_f32_16x16x32_bf16 v[228:231], a[124:127], v[36:39], v[228:231]
  s_waitcnt lgkmcnt(0)
  s_barrier
  v_add_u32 v16, 0x10000, v16
  v_add_u32 v17, 0x10000, v17
  v_add_u32 v18, 0x10000, v18
  v_add_u32 v19, 0x10000, v19
  v_add_u32 v20, 0x10000, v20
  v_add_u32 v21, 0x10000, v21
  v_add_u32 v22, 0x10000, v22
  v_add_u32 v23, 0x10000, v23
  ds_read_b64_tr_b16 v[48:49], v16 offset:0
  ds_read_b64_tr_b16 v[50:51], v16 offset:1024
  v_mfma_f32_16x16x32_bf16 v[228:231], a[120:123], v[32:35], v[228:231]
  ds_read_b64_tr_b16 v[52:53], v16 offset:8192
  ds_read_b64_tr_b16 v[54:55], v16 offset:9216
  v_mfma_f32_16x16x32_bf16 v[232:235], a[184:187], v[32:35], v[232:235]
  buffer_load_dwordx4 v9, s[12:15], s51 offen offset:1024 lds
  v_cvt_pk_bf16_f32 v104, v208, v209
  v_mfma_f32_16x16x32_bf16 v[232:235], a[188:191], v[36:39], v[232:235]
  v_cvt_pk_bf16_f32 v105, v210, v211
  v_cvt_pk_bf16_f32 v106, v212, v213
  v_mfma_f32_16x16x32_bf16 v[236:239], a[252:255], v[36:39], v[236:239]
  v_cvt_pk_bf16_f32 v107, v214, v215
  v_cvt_pk_bf16_f32 v108, v216, v217
  v_mfma_f32_16x16x32_bf16 v[236:239], a[248:251], v[32:35], v[236:239]
  v_cvt_pk_bf16_f32 v109, v218, v219
  v_cvt_pk_bf16_f32 v110, v220, v221
  v_mfma_f32_16x16x32_bf16 v[252:255], a[248:251], v[40:43], v[252:255]
  ds_read_b64_tr_b16 v[32:33], v17 offset:0
  ds_read_b64_tr_b16 v[34:35], v17 offset:1024
  v_mfma_f32_16x16x32_bf16 v[252:255], a[252:255], v[44:47], v[252:255]
  ds_read_b64_tr_b16 v[36:37], v17 offset:8192
  ds_read_b64_tr_b16 v[38:39], v17 offset:9216
  v_mfma_f32_16x16x32_bf16 v[248:251], a[188:191], v[44:47], v[248:251]
  buffer_load_dwordx4 v10, s[12:15], s51 offen offset:2048 lds
  v_cvt_pk_bf16_f32 v111, v222, v223
  v_mfma_f32_16x16x32_bf16 v[248:251], a[184:187], v[40:43], v[248:251]
  v_cvt_pk_bf16_f32 v112, v224, v225
  v_cvt_pk_bf16_f32 v113, v226, v227
  v_mfma_f32_16x16x32_bf16 v[244:247], a[120:123], v[40:43], v[244:247]
  v_cvt_pk_bf16_f32 v114, v228, v229
  v_cvt_pk_bf16_f32 v115, v230, v231
  v_mfma_f32_16x16x32_bf16 v[244:247], a[124:127], v[44:47], v[244:247]
  v_cvt_pk_bf16_f32 v116, v232, v233
  v_cvt_pk_bf16_f32 v117, v234, v235
  v_mfma_f32_16x16x32_bf16 v[240:243], a[60:63], v[44:47], v[240:243]
  v_cvt_pk_bf16_f32 v118, v236, v237
  v_cvt_pk_bf16_f32 v119, v238, v239
  v_mfma_f32_16x16x32_bf16 v[240:243], a[56:59], v[40:43], v[240:243]
  s_waitcnt lgkmcnt(4)
  buffer_load_dwordx4 v11, s[12:15], s51 offen offset:3072 lds
  s_add_u32 s39, s37, 16780288
  buffer_store_dwordx4 v[88:91], v2, s[20:23], s39 offen sc1
  s_waitcnt vmcnt(25)
  v_mfma_f32_16x16x32_bf16 v[128:131], v[48:51], a[0:3], 0
  s_add_u32 m0, s36, 114688
  ds_read_b64_tr_b16 v[40:41], v18 offset:0
  ds_read_b64_tr_b16 v[42:43], v18 offset:1024
  v_mfma_f32_16x16x32_bf16 v[128:131], v[52:55], a[4:7], v[128:131]
  s_add_u32 s51, s38, 3
  ds_read_b64_tr_b16 v[44:45], v18 offset:8192
  ds_read_b64_tr_b16 v[46:47], v18 offset:9216
  v_mfma_f32_16x16x32_bf16 v[132:135], v[52:55], a[68:71], 0
  s_and_b32 s51, s51, 7
  v_cvt_pk_bf16_f32 v120, v240, v241
  v_cvt_pk_bf16_f32 v121, v242, v243
  v_mfma_f32_16x16x32_bf16 v[132:135], v[48:51], a[64:67], v[132:135]
  s_lshl_b32 s51, s51, 19
  v_cvt_pk_bf16_f32 v122, v244, v245
  v_cvt_pk_bf16_f32 v123, v246, v247
  v_mfma_f32_16x16x32_bf16 v[136:139], v[48:51], a[128:131], 0
  s_add_u32 s51, s51, s34
  v_cvt_pk_bf16_f32 v124, v248, v249
  v_cvt_pk_bf16_f32 v125, v250, v251
  v_mfma_f32_16x16x32_bf16 v[136:139], v[52:55], a[132:135], v[136:139]
  buffer_load_dwordx4 v8, s[12:15], s51 offen offset:0 lds
  v_cvt_pk_bf16_f32 v126, v252, v253
  v_mfma_f32_16x16x32_bf16 v[140:143], v[52:55], a[196:199], 0
  v_cvt_pk_bf16_f32 v127, v254, v255
  v_mfma_f32_16x16x32_bf16 v[140:143], v[48:51], a[192:195], v[140:143]
  s_waitcnt lgkmcnt(4)
  v_mfma_f32_16x16x32_bf16 v[156:159], v[32:35], a[192:195], 0
  ds_read_b64_tr_b16 v[48:49], v19 offset:0
  ds_read_b64_tr_b16 v[50:51], v19 offset:1024
  v_mfma_f32_16x16x32_bf16 v[156:159], v[36:39], a[196:199], v[156:159]
  ds_read_b64_tr_b16 v[52:53], v19 offset:8192
  ds_read_b64_tr_b16 v[54:55], v19 offset:9216
  v_mfma_f32_16x16x32_bf16 v[152:155], v[36:39], a[132:135], 0
  v_mfma_f32_16x16x32_bf16 v[152:155], v[32:35], a[128:131], v[152:155]
  buffer_load_dwordx4 v9, s[12:15], s51 offen offset:1024 lds
  v_mfma_f32_16x16x32_bf16 v[148:151], v[32:35], a[64:67], 0
  v_mfma_f32_16x16x32_bf16 v[148:151], v[36:39], a[68:71], v[148:151]
  v_mfma_f32_16x16x32_bf16 v[144:147], v[36:39], a[4:7], 0
  v_mfma_f32_16x16x32_bf16 v[144:147], v[32:35], a[0:3], v[144:147]
  s_waitcnt lgkmcnt(4)
  v_mfma_f32_16x16x32_bf16 v[160:163], v[40:43], a[0:3], 0
  ds_read_b64_tr_b16 v[32:33], v20 offset:0
  ds_read_b64_tr_b16 v[34:35], v20 offset:1024
  v_mfma_f32_16x16x32_bf16 v[160:163], v[44:47], a[4:7], v[160:163]
  ds_read_b64_tr_b16 v[36:37], v20 offset:8192
  ds_read_b64_tr_b16 v[38:39], v20 offset:9216
  v_mfma_f32_16x16x32_bf16 v[164:167], v[44:47], a[68:71], 0
  buffer_load_dwordx4 v10, s[12:15], s51 offen offset:2048 lds
  v_mfma_f32_16x16x32_bf16 v[164:167], v[40:43], a[64:67], v[164:167]
  s_add_u32 s39, s37, 16788480
  v_mfma_f32_16x16x32_bf16 v[168:171], v[40:43], a[128:131], 0
  v_mfma_f32_16x16x32_bf16 v[168:171], v[44:47], a[132:135], v[168:171]
  buffer_store_dwordx4 v[92:95], v2, s[20:23], s39 offen sc1
  v_mfma_f32_16x16x32_bf16 v[172:175], v[44:47], a[196:199], 0
  v_mfma_f32_16x16x32_bf16 v[172:175], v[40:43], a[192:195], v[172:175]
  s_waitcnt lgkmcnt(4)
  buffer_load_dwordx4 v11, s[12:15], s51 offen offset:3072 lds
  v_mfma_f32_16x16x32_bf16 v[188:191], v[48:51], a[192:195], 0
  s_add_u32 m0, s36, 131072
  ds_read_b64_tr_b16 v[40:41], v21 offset:0
  ds_read_b64_tr_b16 v[42:43], v21 offset:1024
  v_mfma_f32_16x16x32_bf16 v[188:191], v[52:55], a[196:199], v[188:191]
  s_add_u32 s51, s38, 4
  ds_read_b64_tr_b16 v[44:45], v21 offset:8192
  ds_read_b64_tr_b16 v[46:47], v21 offset:9216
  v_mfma_f32_16x16x32_bf16 v[184:187], v[52:55], a[132:135], 0
  s_and_b32 s51, s51, 7
  v_mfma_f32_16x16x32_bf16 v[184:187], v[48:51], a[128:131], v[184:187]
  s_lshl_b32 s51, s51, 19
  v_mfma_f32_16x16x32_bf16 v[180:183], v[48:51], a[64:67], 0
  s_add_u32 s51, s51, s34
  v_mfma_f32_16x16x32_bf16 v[180:183], v[52:55], a[68:71], v[180:183]
  buffer_load_dwordx4 v8, s[12:15], s51 offen offset:0 lds
  v_mfma_f32_16x16x32_bf16 v[176:179], v[52:55], a[4:7], 0
  v_mfma_f32_16x16x32_bf16 v[176:179], v[48:51], a[0:3], v[176:179]
  s_waitcnt lgkmcnt(4)
  v_mfma_f32_16x16x32_bf16 v[192:195], v[32:35], a[0:3], 0
  ds_read_b64_tr_b16 v[48:49], v22 offset:0
  ds_read_b64_tr_b16 v[50:51], v22 offset:1024
  v_mfma_f32_16x16x32_bf16 v[192:195], v[36:39], a[4:7], v[192:195]
  ds_read_b64_tr_b16 v[52:53], v22 offset:8192
  ds_read_b64_tr_b16 v[54:55], v22 offset:9216
  v_mfma_f32_16x16x32_bf16 v[196:199], v[36:39], a[68:71], 0
  v_mfma_f32_16x16x32_bf16 v[196:199], v[32:35], a[64:67], v[196:199]
  buffer_load_dwordx4 v9, s[12:15], s51 offen offset:1024 lds
  v_mfma_f32_16x16x32_bf16 v[200:203], v[32:35], a[128:131], 0
  v_mfma_f32_16x16x32_bf16 v[200:203], v[36:39], a[132:135], v[200:203]
  v_mfma_f32_16x16x32_bf16 v[204:207], v[36:39], a[196:199], 0
  v_mfma_f32_16x16x32_bf16 v[204:207], v[32:35], a[192:195], v[204:207]
  s_waitcnt lgkmcnt(4)
  v_mfma_f32_16x16x32_bf16 v[220:223], v[40:43], a[192:195], 0
  ds_read_b64_tr_b16 v[32:33], v23 offset:0
  ds_read_b64_tr_b16 v[34:35], v23 offset:1024
  v_mfma_f32_16x16x32_bf16 v[220:223], v[44:47], a[196:199], v[220:223]
  s_add_u32 s39, s37, 16781312
  ds_read_b64_tr_b16 v[36:37], v23 offset:8192
  ds_read_b64_tr_b16 v[38:39], v23 offset:9216
  v_mfma_f32_16x16x32_bf16 v[216:219], v[44:47], a[132:135], 0
  buffer_load_dwordx4 v10, s[12:15], s51 offen offset:2048 lds
  v_mfma_f32_16x16x32_bf16 v[216:219], v[40:43], a[128:131], v[216:219]
  buffer_store_dwordx4 v[96:99], v2, s[20:23], s39 offen sc1
  v_mfma_f32_16x16x32_bf16 v[212:215], v[40:43], a[64:67], 0
  v_mfma_f32_16x16x32_bf16 v[212:215], v[44:47], a[68:71], v[212:215]
  v_mfma_f32_16x16x32_bf16 v[208:211], v[44:47], a[4:7], 0
  v_mfma_f32_16x16x32_bf16 v[208:211], v[40:43], a[0:3], v[208:211]
  s_waitcnt lgkmcnt(4)
  buffer_load_dwordx4 v11, s[12:15], s51 offen offset:3072 lds
  v_mfma_f32_16x16x32_bf16 v[224:227], v[48:51], a[0:3], 0
  s_add_u32 m0, s36, 147456
  ds_read_b64_tr_b16 v[40:41], v16 offset:16384
  ds_read_b64_tr_b16 v[42:43], v16 offset:17408
  v_mfma_f32_16x16x32_bf16 v[224:227], v[52:55], a[4:7], v[224:227]
  s_add_u32 s51, s38, 5
  ds_read_b64_tr_b16 v[44:45], v16 offset:24576
  ds_read_b64_tr_b16 v[46:47], v16 offset:25600
  v_mfma_f32_16x16x32_bf16 v[228:231], v[52:55], a[68:71], 0
  s_and_b32 s51, s51, 7
  v_mfma_f32_16x16x32_bf16 v[228:231], v[48:51], a[64:67], v[228:231]
  s_lshl_b32 s51, s51, 19
  v_mfma_f32_16x16x32_bf16 v[232:235], v[48:51], a[128:131], 0
  s_add_u32 s51, s51, s34
  v_mfma_f32_16x16x32_bf16 v[232:235], v[52:55], a[132:135], v[232:235]
  buffer_load_dwordx4 v8, s[12:15], s51 offen offset:0 lds
  v_mfma_f32_16x16x32_bf16 v[236:239], v[52:55], a[196:199], 0
  v_mfma_f32_16x16x32_bf16 v[236:239], v[48:51], a[192:195], v[236:239]
  s_waitcnt lgkmcnt(4)
  v_mfma_f32_16x16x32_bf16 v[252:255], v[32:35], a[192:195], 0
  ds_read_b64_tr_b16 v[48:49], v17 offset:16384
  ds_read_b64_tr_b16 v[50:51], v17 offset:17408
  v_mfma_f32_16x16x32_bf16 v[252:255], v[36:39], a[196:199], v[252:255]
  ds_read_b64_tr_b16 v[52:53], v17 offset:24576
  ds_read_b64_tr_b16 v[54:55], v17 offset:25600
  v_mfma_f32_16x16x32_bf16 v[248:251], v[36:39], a[132:135], 0
  v_mfma_f32_16x16x32_bf16 v[248:251], v[32:35], a[128:131], v[248:251]
  buffer_load_dwordx4 v9, s[12:15], s51 offen offset:1024 lds
  v_mfma_f32_16x16x32_bf16 v[244:247], v[32:35], a[64:67], 0
  v_mfma_f32_16x16x32_bf16 v[244:247], v[36:39], a[68:71], v[244:247]
  v_mfma_f32_16x16x32_bf16 v[240:243], v[36:39], a[4:7], 0
  v_mfma_f32_16x16x32_bf16 v[240:243], v[32:35], a[0:3], v[240:243]
  s_waitcnt lgkmcnt(4)
  s_waitcnt vmcnt(27)
  v_mfma_f32_16x16x32_bf16 v[128:131], v[40:43], a[8:11], v[128:131]
  s_add_u32 s39, s37, 16789504
  ds_read_b64_tr_b16 v[32:33], v18 offset:16384
  ds_read_b64_tr_b16 v[34:35], v18 offset:17408
  v_mfma_f32_16x16x32_bf16 v[128:131], v[44:47], a[12:15], v[128:131]
  ds_read_b64_tr_b16 v[36:37], v18 offset:24576
  ds_read_b64_tr_b16 v[38:39], v18 offset:25600
  v_mfma_f32_16x16x32_bf16 v[132:135], v[44:47], a[76:79], v[132:135]
  buffer_load_dwordx4 v10, s[12:15], s51 offen offset:2048 lds
  buffer_store_dwordx4 v[100:103], v2, s[20:23], s39 offen sc1
  v_mfma_f32_16x16x32_bf16 v[132:135], v[40:43], a[72:75], v[132:135]
  v_mfma_f32_16x16x32_bf16 v[136:139], v[40:43], a[136:139], v[136:139]
  v_mfma_f32_16x16x32_bf16 v[136:139], v[44:47], a[140:143], v[136:139]
  v_mfma_f32_16x16x32_bf16 v[140:143], v[44:47], a[204:207], v[140:143]
  v_mfma_f32_16x16x32_bf16 v[140:143], v[40:43], a[200:203], v[140:143]
  s_waitcnt lgkmcnt(4)
  buffer_load_dwordx4 v11, s[12:15], s51 offen offset:3072 lds
  v_mfma_f32_16x16x32_bf16 v[156:159], v[48:51], a[200:203], v[156:159]
  s_add_u32 s50, s38, 3
  ds_read_b64_tr_b16 v[40:41], v19 offset:16384
  ds_read_b64_tr_b16 v[42:43], v19 offset:17408
  v_mfma_f32_16x16x32_bf16 v[156:159], v[52:55], a[204:207], v[156:159]
  s_and_b32 s50, s50, 7
  ds_read_b64_tr_b16 v[44:45], v19 offset:24576
  ds_read_b64_tr_b16 v[46:47], v19 offset:25600
  v_mfma_f32_16x16x32_bf16 v[152:155], v[52:55], a[140:143], v[152:155]
  s_lshl_b32 s50, s50, 11
  v_mfma_f32_16x16x32_bf16 v[152:155], v[48:51], a[136:139], v[152:155]
  s_add_u32 s49, s50, s52
  v_mfma_f32_16x16x32_bf16 v[148:151], v[48:51], a[72:75], v[148:151]
  s_add_u32 s50, s50, s53
  v_mfma_f32_16x16x32_bf16 v[148:151], v[52:55], a[76:79], v[148:151]
  buffer_load_dwordx4 a[24:27], v2, s[20:23], s49 offen offset:0 sc1
  v_mfma_f32_16x16x32_bf16 v[144:147], v[52:55], a[12:15], v[144:147]
  v_mfma_f32_16x16x32_bf16 v[144:147], v[48:51], a[8:11], v[144:147]
  s_waitcnt lgkmcnt(4)
  v_mfma_f32_16x16x32_bf16 v[160:163], v[32:35], a[8:11], v[160:163]
  ds_read_b64_tr_b16 v[48:49], v20 offset:16384
  ds_read_b64_tr_b16 v[50:51], v20 offset:17408
  v_mfma_f32_16x16x32_bf16 v[160:163], v[36:39], a[12:15], v[160:163]
  ds_read_b64_tr_b16 v[52:53], v20 offset:24576
  ds_read_b64_tr_b16 v[54:55], v20 offset:25600
  v_mfma_f32_16x16x32_bf16 v[164:167], v[36:39], a[76:79], v[164:167]
  v_mfma_f32_16x16x32_bf16 v[164:167], v[32:35], a[72:75], v[164:167]
  buffer_load_dwordx4 a[28:31], v2, s[20:23], s49 offen offset:1024 sc1
  v_mfma_f32_16x16x32_bf16 v[168:171], v[32:35], a[136:139], v[168:171]
  v_mfma_f32_16x16x32_bf16 v[168:171], v[36:39], a[140:143], v[168:171]
  v_mfma_f32_16x16x32_bf16 v[172:175], v[36:39], a[204:207], v[172:175]
  s_add_u32 s39, s37, 16782336
  v_mfma_f32_16x16x32_bf16 v[172:175], v[32:35], a[200:203], v[172:175]
  s_waitcnt lgkmcnt(4)
  v_mfma_f32_16x16x32_bf16 v[188:191], v[40:43], a[200:203], v[188:191]
  ds_read_b64_tr_b16 v[32:33], v21 offset:16384
  ds_read_b64_tr_b16 v[34:35], v21 offset:17408
  v_mfma_f32_16x16x32_bf16 v[188:191], v[44:47], a[204:207], v[188:191]
  ds_read_b64_tr_b16 v[36:37], v21 offset:24576
  ds_read_b64_tr_b16 v[38:39], v21 offset:25600
  v_mfma_f32_16x16x32_bf16 v[184:187], v[44:47], a[140:143], v[184:187]
  buffer_load_dwordx4 a[88:91], v3, s[20:23], s49 offen offset:0 sc1
  buffer_store_dwordx4 v[104:107], v2, s[20:23], s39 offen sc1
  v_mfma_f32_16x16x32_bf16 v[184:187], v[40:43], a[136:139], v[184:187]
  v_mfma_f32_16x16x32_bf16 v[180:183], v[40:43], a[72:75], v[180:183]
  v_mfma_f32_16x16x32_bf16 v[180:183], v[44:47], a[76:79], v[180:183]
  v_mfma_f32_16x16x32_bf16 v[176:179], v[44:47], a[12:15], v[176:179]
  v_mfma_f32_16x16x32_bf16 v[176:179], v[40:43], a[8:11], v[176:179]
  s_waitcnt lgkmcnt(4)
  buffer_load_dwordx4 a[92:95], v3, s[20:23], s49 offen offset:1024 sc1
  v_mfma_f32_16x16x32_bf16 v[192:195], v[48:51], a[8:11], v[192:195]
  ds_read_b64_tr_b16 v[40:41], v22 offset:16384
  ds_read_b64_tr_b16 v[42:43], v22 offset:17408
  v_mfma_f32_16x16x32_bf16 v[192:195], v[52:55], a[12:15], v[192:195]
  ds_read_b64_tr_b16 v[44:45], v22 offset:24576
  ds_read_b64_tr_b16 v[46:47], v22 offset:25600
  v_mfma_f32_16x16x32_bf16 v[196:199], v[52:55], a[76:79], v[196:199]
  v_mfma_f32_16x16x32_bf16 v[196:199], v[48:51], a[72:75], v[196:199]
  v_mfma_f32_16x16x32_bf16 v[200:203], v[48:51], a[136:139], v[200:203]
  v_mfma_f32_16x16x32_bf16 v[200:203], v[52:55], a[140:143], v[200:203]
  buffer_load_dwordx4 a[152:155], v2, s[20:23], s50 offen offset:0 sc1
  v_mfma_f32_16x16x32_bf16 v[204:207], v[52:55], a[204:207], v[204:207]
  v_mfma_f32_16x16x32_bf16 v[204:207], v[48:51], a[200:203], v[204:207]
  s_waitcnt lgkmcnt(4)
  v_mfma_f32_16x16x32_bf16 v[220:223], v[32:35], a[200:203], v[220:223]
  ds_read_b64_tr_b16 v[48:49], v23 offset:16384
  ds_read_b64_tr_b16 v[50:51], v23 offset:17408
  v_mfma_f32_16x16x32_bf16 v[220:223], v[36:39], a[204:207], v[220:223]
  ds_read_b64_tr_b16 v[52:53], v23 offset:24576
  ds_read_b64_tr_b16 v[54:55], v23 offset:25600
  v_mfma_f32_16x16x32_bf16 v[216:219], v[36:39], a[140:143], v[216:219]
  v_mfma_f32_16x16x32_bf16 v[216:219], v[32:35], a[136:139], v[216:219]
  buffer_load_dwordx4 a[156:159], v2, s[20:23], s50 offen offset:1024 sc1
  v_mfma_f32_16x16x32_bf16 v[212:215], v[32:35], a[72:75], v[212:215]
  v_mfma_f32_16x16x32_bf16 v[212:215], v[36:39], a[76:79], v[212:215]
  v_mfma_f32_16x16x32_bf16 v[208:211], v[36:39], a[12:15], v[208:211]
  s_add_u32 s39, s37, 16790528
  v_mfma_f32_16x16x32_bf16 v[208:211], v[32:35], a[8:11], v[208:211]
  s_waitcnt lgkmcnt(4)
  v_mfma_f32_16x16x32_bf16 v[224:227], v[40:43], a[8:11], v[224:227]
  buffer_store_dwordx4 v[108:111], v2, s[20:23], s39 offen sc1
  v_mfma_f32_16x16x32_bf16 v[224:227], v[44:47], a[12:15], v[224:227]
  buffer_load_dwordx4 a[216:219], v3, s[20:23], s50 offen offset:0 sc1
  v_mfma_f32_16x16x32_bf16 v[228:231], v[44:47], a[76:79], v[228:231]
  s_waitcnt vmcnt(19) lgkmcnt(0)
  s_barrier
  ds_read_b64_tr_b16 v[32:33], v16 offset:32768
  ds_read_b64_tr_b16 v[34:35], v16 offset:33792
  v_mfma_f32_16x16x32_bf16 v[228:231], v[40:43], a[72:75], v[228:231]
  ds_read_b64_tr_b16 v[36:37], v16 offset:40960
  ds_read_b64_tr_b16 v[38:39], v16 offset:41984
  v_mfma_f32_16x16x32_bf16 v[232:235], v[40:43], a[136:139], v[232:235]
  v_mfma_f32_16x16x32_bf16 v[232:235], v[44:47], a[140:143], v[232:235]
  v_mfma_f32_16x16x32_bf16 v[236:239], v[44:47], a[204:207], v[236:239]
  v_mfma_f32_16x16x32_bf16 v[236:239], v[40:43], a[200:203], v[236:239]
  buffer_load_dwordx4 a[220:223], v3, s[20:23], s50 offen offset:1024 sc1
  v_mfma_f32_16x16x32_bf16 v[252:255], v[48:51], a[200:203], v[252:255]
  s_add_u32 s50, s38, 4
  ds_read_b64_tr_b16 v[40:41], v17 offset:32768
  ds_read_b64_tr_b16 v[42:43], v17 offset:33792
  v_mfma_f32_16x16x32_bf16 v[252:255], v[52:55], a[204:207], v[252:255]
  s_and_b32 s50, s50, 7
  ds_read_b64_tr_b16 v[44:45], v17 offset:40960
  ds_read_b64_tr_b16 v[46:47], v17 offset:41984
  v_mfma_f32_16x16x32_bf16 v[248:251], v[52:55], a[140:143], v[248:251]
  s_lshl_b32 s50, s50, 11
  v_mfma_f32_16x16x32_bf16 v[248:251], v[48:51], a[136:139], v[248:251]
  s_add_u32 s49, s50, s52
  v_mfma_f32_16x16x32_bf16 v[244:247], v[48:51], a[72:75], v[244:247]
  s_add_u32 s50, s50, s53
  v_mfma_f32_16x16x32_bf16 v[244:247], v[52:55], a[76:79], v[244:247]
  buffer_load_dwordx4 a[32:35], v2, s[20:23], s49 offen offset:0 sc1
  v_mfma_f32_16x16x32_bf16 v[240:243], v[52:55], a[12:15], v[240:243]
  v_mfma_f32_16x16x32_bf16 v[240:243], v[48:51], a[8:11], v[240:243]
  s_waitcnt lgkmcnt(4)
  v_mfma_f32_16x16x32_bf16 v[128:131], v[32:35], a[16:19], v[128:131]
  ds_read_b64_tr_b16 v[48:49], v18 offset:32768
  ds_read_b64_tr_b16 v[50:51], v18 offset:33792
  v_mfma_f32_16x16x32_bf16 v[128:131], v[36:39], a[20:23], v[128:131]
  ds_read_b64_tr_b16 v[52:53], v18 offset:40960
  ds_read_b64_tr_b16 v[54:55], v18 offset:41984
  v_mfma_f32_16x16x32_bf16 v[132:135], v[36:39], a[84:87], v[132:135]
  v_mfma_f32_16x16x32_bf16 v[132:135], v[32:35], a[80:83], v[132:135]
  buffer_load_dwordx4 a[36:39], v2, s[20:23], s49 offen offset:1024 sc1
  v_mfma_f32_16x16x32_bf16 v[136:139], v[32:35], a[144:147], v[136:139]
  s_add_u32 s39, s37, 16783360
  v_mfma_f32_16x16x32_bf16 v[136:139], v[36:39], a[148:151], v[136:139]
  v_mfma_f32_16x16x32_bf16 v[140:143], v[36:39], a[212:215], v[140:143]
  buffer_store_dwordx4 v[112:115], v2, s[20:23], s39 offen sc1
  v_mfma_f32_16x16x32_bf16 v[140:143], v[32:35], a[208:211], v[140:143]
  s_waitcnt lgkmcnt(4)
  v_mfma_f32_16x16x32_bf16 v[156:159], v[40:43], a[208:211], v[156:159]
  ds_read_b64_tr_b16 v[32:33], v19 offset:32768
  ds_read_b64_tr_b16 v[34:35], v19 offset:33792
  v_mfma_f32_16x16x32_bf16 v[156:159], v[44:47], a[212:215], v[156:159]
  ds_read_b64_tr_b16 v[36:37], v19 offset:40960
  ds_read_b64_tr_b16 v[38:39], v19 offset:41984
  v_mfma_f32_16x16x32_bf16 v[152:155], v[44:47], a[148:151], v[152:155]
  buffer_load_dwordx4 a[96:99], v3, s[20:23], s49 offen offset:0 sc1
  v_mfma_f32_16x16x32_bf16 v[152:155], v[40:43], a[144:147], v[152:155]
  v_mfma_f32_16x16x32_bf16 v[148:151], v[40:43], a[80:83], v[148:151]
  v_mfma_f32_16x16x32_bf16 v[148:151], v[44:47], a[84:87], v[148:151]
  v_mfma_f32_16x16x32_bf16 v[144:147], v[44:47], a[20:23], v[144:147]
  v_mfma_f32_16x16x32_bf16 v[144:147], v[40:43], a[16:19], v[144:147]
  s_waitcnt lgkmcnt(4)
  buffer_load_dwordx4 a[100:103], v3, s[20:23], s49 offen offset:1024 sc1
  v_mfma_f32_16x16x32_bf16 v[160:163], v[48:51], a[16:19], v[160:163]
  ds_read_b64_tr_b16 v[40:41], v20 offset:32768
  ds_read_b64_tr_b16 v[42:43], v20 offset:33792
  v_mfma_f32_16x16x32_bf16 v[160:163], v[52:55], a[20:23], v[160:163]
  ds_read_b64_tr_b16 v[44:45], v20 offset:40960
  ds_read_b64_tr_b16 v[46:47], v20 offset:41984
  v_mfma_f32_16x16x32_bf16 v[164:167], v[52:55], a[84:87], v[164:167]
  v_mfma_f32_16x16x32_bf16 v[164:167], v[48:51], a[80:83], v[164:167]
  v_mfma_f32_16x16x32_bf16 v[168:171], v[48:51], a[144:147], v[168:171]
  v_mfma_f32_16x16x32_bf16 v[168:171], v[52:55], a[148:151], v[168:171]
  buffer_load_dwordx4 a[160:163], v2, s[20:23], s50 offen offset:0 sc1
  v_mfma_f32_16x16x32_bf16 v[172:175], v[52:55], a[212:215], v[172:175]
  v_mfma_f32_16x16x32_bf16 v[172:175], v[48:51], a[208:211], v[172:175]
  s_waitcnt lgkmcnt(4)
  v_mfma_f32_16x16x32_bf16 v[188:191], v[32:35], a[208:211], v[188:191]
  ds_read_b64_tr_b16 v[48:49], v21 offset:32768
  ds_read_b64_tr_b16 v[50:51], v21 offset:33792
  v_mfma_f32_16x16x32_bf16 v[188:191], v[36:39], a[212:215], v[188:191]
  ds_read_b64_tr_b16 v[52:53], v21 offset:40960
  ds_read_b64_tr_b16 v[54:55], v21 offset:41984
  v_mfma_f32_16x16x32_bf16 v[184:187], v[36:39], a[148:151], v[184:187]
  s_add_u32 s39, s37, 16791552
  v_mfma_f32_16x16x32_bf16 v[184:187], v[32:35], a[144:147], v[184:187]
  buffer_load_dwordx4 a[164:167], v2, s[20:23], s50 offen offset:1024 sc1
  v_mfma_f32_16x16x32_bf16 v[180:183], v[32:35], a[80:83], v[180:183]
  buffer_store_dwordx4 v[116:119], v2, s[20:23], s39 offen sc1
  v_mfma_f32_16x16x32_bf16 v[180:183], v[36:39], a[84:87], v[180:183]
  v_mfma_f32_16x16x32_bf16 v[176:179], v[36:39], a[20:23], v[176:179]
  v_mfma_f32_16x16x32_bf16 v[176:179], v[32:35], a[16:19], v[176:179]
  s_waitcnt lgkmcnt(4)
  v_mfma_f32_16x16x32_bf16 v[192:195], v[40:43], a[16:19], v[192:195]
  ds_read_b64_tr_b16 v[32:33], v22 offset:32768
  ds_read_b64_tr_b16 v[34:35], v22 offset:33792
  v_mfma_f32_16x16x32_bf16 v[192:195], v[44:47], a[20:23], v[192:195]
  ds_read_b64_tr_b16 v[36:37], v22 offset:40960
  ds_read_b64_tr_b16 v[38:39], v22 offset:41984
  v_mfma_f32_16x16x32_bf16 v[196:199], v[44:47], a[84:87], v[196:199]
  buffer_load_dwordx4 a[224:227], v3, s[20:23], s50 offen offset:0 sc1
  v_mfma_f32_16x16x32_bf16 v[196:199], v[40:43], a[80:83], v[196:199]
  v_mfma_f32_16x16x32_bf16 v[200:203], v[40:43], a[144:147], v[200:203]
  v_mfma_f32_16x16x32_bf16 v[200:203], v[44:47], a[148:151], v[200:203]
  v_mfma_f32_16x16x32_bf16 v[204:207], v[44:47], a[212:215], v[204:207]
  v_mfma_f32_16x16x32_bf16 v[204:207], v[40:43], a[208:211], v[204:207]
  s_waitcnt lgkmcnt(4)
  buffer_load_dwordx4 a[228:231], v3, s[20:23], s50 offen offset:1024 sc1
  v_mfma_f32_16x16x32_bf16 v[220:223], v[48:51], a[208:211], v[220:223]
  s_add_u32 s50, s38, 5
  ds_read_b64_tr_b16 v[40:41], v23 offset:32768
  ds_read_b64_tr_b16 v[42:43], v23 offset:33792
  v_mfma_f32_16x16x32_bf16 v[220:223], v[52:55], a[212:215], v[220:223]
  s_and_b32 s50, s50, 7
  ds_read_b64_tr_b16 v[44:45], v23 offset:40960
  ds_read_b64_tr_b16 v[46:47], v23 offset:41984
  v_mfma_f32_16x16x32_bf16 v[216:219], v[52:55], a[148:151], v[216:219]
  s_lshl_b32 s50, s50, 11
  v_mfma_f32_16x16x32_bf16 v[216:219], v[48:51], a[144:147], v[216:219]
  s_add_u32 s49, s50, s52
  v_mfma_f32_16x16x32_bf16 v[212:215], v[48:51], a[80:83], v[212:215]
  s_add_u32 s50, s50, s53
  v_mfma_f32_16x16x32_bf16 v[212:215], v[52:55], a[84:87], v[212:215]
  buffer_load_dwordx4 a[40:43], v2, s[20:23], s49 offen offset:0 sc1
  v_mfma_f32_16x16x32_bf16 v[208:211], v[52:55], a[20:23], v[208:211]
  v_mfma_f32_16x16x32_bf16 v[208:211], v[48:51], a[16:19], v[208:211]
  s_waitcnt lgkmcnt(4)
  v_mfma_f32_16x16x32_bf16 v[224:227], v[32:35], a[16:19], v[224:227]
  s_add_u32 s39, s37, 16784384
  ds_read_b64_tr_b16 v[48:49], v16 offset:49152
  ds_read_b64_tr_b16 v[50:51], v16 offset:50176
  v_mfma_f32_16x16x32_bf16 v[224:227], v[36:39], a[20:23], v[224:227]
  ds_read_b64_tr_b16 v[52:53], v16 offset:57344
  ds_read_b64_tr_b16 v[54:55], v16 offset:58368
  v_mfma_f32_16x16x32_bf16 v[228:231], v[36:39], a[84:87], v[228:231]
  buffer_store_dwordx4 v[120:123], v2, s[20:23], s39 offen sc1
  v_mfma_f32_16x16x32_bf16 v[228:231], v[32:35], a[80:83], v[228:231]
  buffer_load_dwordx4 a[44:47], v2, s[20:23], s49 offen offset:1024 sc1
  v_mfma_f32_16x16x32_bf16 v[232:235], v[32:35], a[144:147], v[232:235]
  v_mfma_f32_16x16x32_bf16 v[232:235], v[36:39], a[148:151], v[232:235]
  v_mfma_f32_16x16x32_bf16 v[236:239], v[36:39], a[212:215], v[236:239]
  v_mfma_f32_16x16x32_bf16 v[236:239], v[32:35], a[208:211], v[236:239]
  s_waitcnt lgkmcnt(4)
  v_mfma_f32_16x16x32_bf16 v[252:255], v[40:43], a[208:211], v[252:255]
  ds_read_b64_tr_b16 v[32:33], v17 offset:49152
  ds_read_b64_tr_b16 v[34:35], v17 offset:50176
  v_mfma_f32_16x16x32_bf16 v[252:255], v[44:47], a[212:215], v[252:255]
  ds_read_b64_tr_b16 v[36:37], v17 offset:57344
  ds_read_b64_tr_b16 v[38:39], v17 offset:58368
  v_mfma_f32_16x16x32_bf16 v[248:251], v[44:47], a[148:151], v[248:251]
  buffer_load_dwordx4 a[104:107], v3, s[20:23], s49 offen offset:0 sc1
  v_mfma_f32_16x16x32_bf16 v[248:251], v[40:43], a[144:147], v[248:251]
  v_mfma_f32_16x16x32_bf16 v[244:247], v[40:43], a[80:83], v[244:247]
  v_mfma_f32_16x16x32_bf16 v[244:247], v[44:47], a[84:87], v[244:247]
  v_mfma_f32_16x16x32_bf16 v[240:243], v[44:47], a[20:23], v[240:243]
  v_mfma_f32_16x16x32_bf16 v[240:243], v[40:43], a[16:19], v[240:243]
  s_waitcnt lgkmcnt(4)
  buffer_load_dwordx4 a[108:111], v3, s[20:23], s49 offen offset:1024 sc1
  s_waitcnt vmcnt(15)
  v_mfma_f32_16x16x32_bf16 v[128:131], v[48:51], a[24:27], v[128:131]
  ds_read_b64_tr_b16 v[40:41], v18 offset:49152
  ds_read_b64_tr_b16 v[42:43], v18 offset:50176
  v_mfma_f32_16x16x32_bf16 v[128:131], v[52:55], a[28:31], v[128:131]
  ds_read_b64_tr_b16 v[44:45], v18 offset:57344
  ds_read_b64_tr_b16 v[46:47], v18 offset:58368
  v_mfma_f32_16x16x32_bf16 v[132:135], v[52:55], a[92:95], v[132:135]
  v_mfma_f32_16x16x32_bf16 v[132:135], v[48:51], a[88:91], v[132:135]
  v_mfma_f32_16x16x32_bf16 v[136:139], v[48:51], a[152:155], v[136:139]
  v_mfma_f32_16x16x32_bf16 v[136:139], v[52:55], a[156:159], v[136:139]
  buffer_load_dwordx4 a[168:171], v2, s[20:23], s50 offen offset:0 sc1
  v_mfma_f32_16x16x32_bf16 v[140:143], v[52:55], a[220:223], v[140:143]
  s_add_u32 s39, s37, 16792576
  v_mfma_f32_16x16x32_bf16 v[140:143], v[48:51], a[216:219], v[140:143]
  s_waitcnt lgkmcnt(4)
  v_mfma_f32_16x16x32_bf16 v[156:159], v[32:35], a[216:219], v[156:159]
  ds_read_b64_tr_b16 v[48:49], v19 offset:49152
  ds_read_b64_tr_b16 v[50:51], v19 offset:50176
  v_mfma_f32_16x16x32_bf16 v[156:159], v[36:39], a[220:223], v[156:159]
  ds_read_b64_tr_b16 v[52:53], v19 offset:57344
  ds_read_b64_tr_b16 v[54:55], v19 offset:58368
  v_mfma_f32_16x16x32_bf16 v[152:155], v[36:39], a[156:159], v[152:155]
  buffer_store_dwordx4 v[124:127], v2, s[20:23], s39 offen sc1
  v_mfma_f32_16x16x32_bf16 v[152:155], v[32:35], a[152:155], v[152:155]
  buffer_load_dwordx4 a[172:175], v2, s[20:23], s50 offen offset:1024 sc1
  v_mfma_f32_16x16x32_bf16 v[148:151], v[32:35], a[88:91], v[148:151]
  v_mfma_f32_16x16x32_bf16 v[148:151], v[36:39], a[92:95], v[148:151]
  v_mfma_f32_16x16x32_bf16 v[144:147], v[36:39], a[28:31], v[144:147]
  v_mfma_f32_16x16x32_bf16 v[144:147], v[32:35], a[24:27], v[144:147]
  s_waitcnt lgkmcnt(4)
  v_mfma_f32_16x16x32_bf16 v[160:163], v[40:43], a[24:27], v[160:163]
  ds_read_b64_tr_b16 v[32:33], v20 offset:49152
  ds_read_b64_tr_b16 v[34:35], v20 offset:50176
  v_mfma_f32_16x16x32_bf16 v[160:163], v[44:47], a[28:31], v[160:163]
  ds_read_b64_tr_b16 v[36:37], v20 offset:57344
  ds_read_b64_tr_b16 v[38:39], v20 offset:58368
  v_mfma_f32_16x16x32_bf16 v[164:167], v[44:47], a[92:95], v[164:167]
  buffer_load_dwordx4 a[232:235], v3, s[20:23], s50 offen offset:0 sc1
  v_mfma_f32_16x16x32_bf16 v[164:167], v[40:43], a[88:91], v[164:167]
  v_mfma_f32_16x16x32_bf16 v[168:171], v[40:43], a[152:155], v[168:171]
  v_mfma_f32_16x16x32_bf16 v[168:171], v[44:47], a[156:159], v[168:171]
  v_mfma_f32_16x16x32_bf16 v[172:175], v[44:47], a[220:223], v[172:175]
  v_mfma_f32_16x16x32_bf16 v[172:175], v[40:43], a[216:219], v[172:175]
  s_waitcnt lgkmcnt(4)
  buffer_load_dwordx4 a[236:239], v3, s[20:23], s50 offen offset:1024 sc1
  v_mfma_f32_16x16x32_bf16 v[188:191], v[48:51], a[216:219], v[188:191]
  s_add_u32 s50, s38, 6
  ds_read_b64_tr_b16 v[40:41], v21 offset:49152
  ds_read_b64_tr_b16 v[42:43], v21 offset:50176
  v_mfma_f32_16x16x32_bf16 v[188:191], v[52:55], a[220:223], v[188:191]
  s_and_b32 s50, s50, 7
  ds_read_b64_tr_b16 v[44:45], v21 offset:57344
  ds_read_b64_tr_b16 v[46:47], v21 offset:58368
  v_mfma_f32_16x16x32_bf16 v[184:187], v[52:55], a[156:159], v[184:187]
  s_lshl_b32 s50, s50, 11
  v_mfma_f32_16x16x32_bf16 v[184:187], v[48:51], a[152:155], v[184:187]
  s_add_u32 s49, s50, s52
  v_mfma_f32_16x16x32_bf16 v[180:183], v[48:51], a[88:91], v[180:183]
  s_add_u32 s50, s50, s53
  v_mfma_f32_16x16x32_bf16 v[180:183], v[52:55], a[92:95], v[180:183]
  buffer_load_dwordx4 a[48:51], v2, s[20:23], s49 offen offset:0 sc1
  v_mfma_f32_16x16x32_bf16 v[176:179], v[52:55], a[28:31], v[176:179]
  v_mfma_f32_16x16x32_bf16 v[176:179], v[48:51], a[24:27], v[176:179]
  s_waitcnt lgkmcnt(4)
  v_mfma_f32_16x16x32_bf16 v[192:195], v[32:35], a[24:27], v[192:195]
  ds_read_b64_tr_b16 v[48:49], v22 offset:49152
  ds_read_b64_tr_b16 v[50:51], v22 offset:50176
  v_mfma_f32_16x16x32_bf16 v[192:195], v[36:39], a[28:31], v[192:195]
  ds_read_b64_tr_b16 v[52:53], v22 offset:57344
  ds_read_b64_tr_b16 v[54:55], v22 offset:58368
  v_mfma_f32_16x16x32_bf16 v[196:199], v[36:39], a[92:95], v[196:199]
  v_mfma_f32_16x16x32_bf16 v[196:199], v[32:35], a[88:91], v[196:199]
  buffer_load_dwordx4 a[52:55], v2, s[20:23], s49 offen offset:1024 sc1
  v_mfma_f32_16x16x32_bf16 v[200:203], v[32:35], a[152:155], v[200:203]
  v_mfma_f32_16x16x32_bf16 v[200:203], v[36:39], a[156:159], v[200:203]
  v_mfma_f32_16x16x32_bf16 v[204:207], v[36:39], a[220:223], v[204:207]
  v_mfma_f32_16x16x32_bf16 v[204:207], v[32:35], a[216:219], v[204:207]
  s_waitcnt lgkmcnt(4)
  v_mfma_f32_16x16x32_bf16 v[220:223], v[40:43], a[216:219], v[220:223]
  ds_read_b64_tr_b16 v[32:33], v23 offset:49152
  ds_read_b64_tr_b16 v[34:35], v23 offset:50176
  v_mfma_f32_16x16x32_bf16 v[220:223], v[44:47], a[220:223], v[220:223]
  ds_read_b64_tr_b16 v[36:37], v23 offset:57344
  ds_read_b64_tr_b16 v[38:39], v23 offset:58368
  v_mfma_f32_16x16x32_bf16 v[216:219], v[44:47], a[156:159], v[216:219]
  buffer_load_dwordx4 a[112:115], v3, s[20:23], s49 offen offset:0 sc1
  v_mfma_f32_16x16x32_bf16 v[216:219], v[40:43], a[152:155], v[216:219]
  v_mfma_f32_16x16x32_bf16 v[212:215], v[40:43], a[88:91], v[212:215]
  v_mfma_f32_16x16x32_bf16 v[212:215], v[44:47], a[92:95], v[212:215]
  v_mfma_f32_16x16x32_bf16 v[208:211], v[44:47], a[28:31], v[208:211]
  v_mfma_f32_16x16x32_bf16 v[208:211], v[40:43], a[24:27], v[208:211]
  s_waitcnt lgkmcnt(4)
  buffer_load_dwordx4 a[116:119], v3, s[20:23], s49 offen offset:1024 sc1
  v_mfma_f32_16x16x32_bf16 v[224:227], v[48:51], a[24:27], v[224:227]
  v_mfma_f32_16x16x32_bf16 v[224:227], v[52:55], a[28:31], v[224:227]
  v_mfma_f32_16x16x32_bf16 v[228:231], v[52:55], a[92:95], v[228:231]
  s_waitcnt lgkmcnt(0)
  s_barrier
  v_add_u32 v16, 0x10000, v16
  v_add_u32 v17, 0x10000, v17
  v_add_u32 v18, 0x10000, v18
  v_add_u32 v19, 0x10000, v19
  v_add_u32 v20, 0x10000, v20
  v_add_u32 v21, 0x10000, v21
  v_add_u32 v22, 0x10000, v22
  v_add_u32 v23, 0x10000, v23
  ds_read_b64_tr_b16 v[40:41], v16 offset:0
  ds_read_b64_tr_b16 v[42:43], v16 offset:1024
  v_mfma_f32_16x16x32_bf16 v[228:231], v[48:51], a[88:91], v[228:231]
  ds_read_b64_tr_b16 v[44:45], v16 offset:8192
  ds_read_b64_tr_b16 v[46:47], v16 offset:9216
  v_mfma_f32_16x16x32_bf16 v[232:235], v[48:51], a[152:155], v[232:235]
  v_mfma_f32_16x16x32_bf16 v[232:235], v[52:55], a[156:159], v[232:235]
  buffer_load_dwordx4 a[176:179], v2, s[20:23], s50 offen offset:0 sc1
  v_mfma_f32_16x16x32_bf16 v[236:239], v[52:55], a[220:223], v[236:239]
  v_mfma_f32_16x16x32_bf16 v[236:239], v[48:51], a[216:219], v[236:239]
  v_mfma_f32_16x16x32_bf16 v[252:255], v[32:35], a[216:219], v[252:255]
  ds_read_b64_tr_b16 v[48:49], v17 offset:0
  ds_read_b64_tr_b16 v[50:51], v17 offset:1024
  v_mfma_f32_16x16x32_bf16 v[252:255], v[36:39], a[220:223], v[252:255]
  ds_read_b64_tr_b16 v[52:53], v17 offset:8192
  ds_read_b64_tr_b16 v[54:55], v17 offset:9216
  v_mfma_f32_16x16x32_bf16 v[248:251], v[36:39], a[156:159], v[248:251]
  v_mfma_f32_16x16x32_bf16 v[248:251], v[32:35], a[152:155], v[248:251]
  buffer_load_dwordx4 a[180:183], v2, s[20:23], s50 offen offset:1024 sc1
  v_mfma_f32_16x16x32_bf16 v[244:247], v[32:35], a[88:91], v[244:247]
  v_mfma_f32_16x16x32_bf16 v[244:247], v[36:39], a[92:95], v[244:247]
  v_mfma_f32_16x16x32_bf16 v[240:243], v[36:39], a[28:31], v[240:243]
  v_mfma_f32_16x16x32_bf16 v[240:243], v[32:35], a[24:27], v[240:243]
  s_waitcnt lgkmcnt(4)
  s_waitcnt vmcnt(16)
  v_mfma_f32_16x16x32_bf16 v[128:131], v[40:43], a[32:35], v[128:131]
  ds_read_b64_tr_b16 v[32:33], v18 offset:0
  ds_read_b64_tr_b16 v[34:35], v18 offset:1024
  v_mfma_f32_16x16x32_bf16 v[128:131], v[44:47], a[36:39], v[128:131]
  ds_read_b64_tr_b16 v[36:37], v18 offset:8192
  ds_read_b64_tr_b16 v[38:39], v18 offset:9216
  v_mfma_f32_16x16x32_bf16 v[132:135], v[44:47], a[100:103], v[132:135]
  buffer_load_dwordx4 a[240:243], v3, s[20:23], s50 offen offset:0 sc1
  v_mfma_f32_16x16x32_bf16 v[132:135], v[40:43], a[96:99], v[132:135]
  v_mfma_f32_16x16x32_bf16 v[136:139], v[40:43], a[160:163], v[136:139]
  v_mfma_f32_16x16x32_bf16 v[136:139], v[44:47], a[164:167], v[136:139]
  v_mfma_f32_16x16x32_bf16 v[140:143], v[44:47], a[228:231], v[140:143]
  v_mfma_f32_16x16x32_bf16 v[140:143], v[40:43], a[224:227], v[140:143]
  s_waitcnt lgkmcnt(4)
  buffer_load_dwordx4 a[244:247], v3, s[20:23], s50 offen offset:1024 sc1
  v_mfma_f32_16x16x32_bf16 v[156:159], v[48:51], a[224:227], v[156:159]
  s_add_u32 m0, s36, 0
  ds_read_b64_tr_b16 v[40:41], v19 offset:0
  ds_read_b64_tr_b16 v[42:43], v19 offset:1024
  v_mfma_f32_16x16x32_bf16 v[156:159], v[52:55], a[228:231], v[156:159]
  s_add_u32 s51, s38, 6
  ds_read_b64_tr_b16 v[44:45], v19 offset:8192
  ds_read_b64_tr_b16 v[46:47], v19 offset:9216
  v_mfma_f32_16x16x32_bf16 v[152:155], v[52:55], a[164:167], v[152:155]
  s_and_b32 s51, s51, 7
  v_mfma_f32_16x16x32_bf16 v[152:155], v[48:51], a[160:163], v[152:155]
  s_lshl_b32 s51, s51, 19
  v_mfma_f32_16x16x32_bf16 v[148:151], v[48:51], a[96:99], v[148:151]
  s_add_u32 s51, s51, s34
  v_mfma_f32_16x16x32_bf16 v[148:151], v[52:55], a[100:103], v[148:151]
  buffer_load_dwordx4 v8, s[12:15], s51 offen offset:0 lds
  v_mfma_f32_16x16x32_bf16 v[144:147], v[52:55], a[36:39], v[144:147]
  v_mfma_f32_16x16x32_bf16 v[144:147], v[48:51], a[32:35], v[144:147]
  s_waitcnt lgkmcnt(4)
  v_mfma_f32_16x16x32_bf16 v[160:163], v[32:35], a[32:35], v[160:163]
  ds_read_b64_tr_b16 v[48:49], v20 offset:0
  ds_read_b64_tr_b16 v[50:51], v20 offset:1024
  v_mfma_f32_16x16x32_bf16 v[160:163], v[36:39], a[36:39], v[160:163]
  ds_read_b64_tr_b16 v[52:53], v20 offset:8192
  ds_read_b64_tr_b16 v[54:55], v20 offset:9216
  v_mfma_f32_16x16x32_bf16 v[164:167], v[36:39], a[100:103], v[164:167]
  v_mfma_f32_16x16x32_bf16 v[164:167], v[32:35], a[96:99], v[164:167]
  buffer_load_dwordx4 v9, s[12:15], s51 offen offset:1024 lds
  v_mfma_f32_16x16x32_bf16 v[168:171], v[32:35], a[160:163], v[168:171]
  v_mfma_f32_16x16x32_bf16 v[168:171], v[36:39], a[164:167], v[168:171]
  v_mfma_f32_16x16x32_bf16 v[172:175], v[36:39], a[228:231], v[172:175]
  v_mfma_f32_16x16x32_bf16 v[172:175], v[32:35], a[224:227], v[172:175]
  s_waitcnt lgkmcnt(4)
  v_mfma_f32_16x16x32_bf16 v[188:191], v[40:43], a[224:227], v[188:191]
  ds_read_b64_tr_b16 v[32:33], v21 offset:0
  ds_read_b64_tr_b16 v[34:35], v21 offset:1024
  v_mfma_f32_16x16x32_bf16 v[188:191], v[44:47], a[228:231], v[188:191]
  ds_read_b64_tr_b16 v[36:37], v21 offset:8192
  ds_read_b64_tr_b16 v[38:39], v21 offset:9216
  v_mfma_f32_16x16x32_bf16 v[184:187], v[44:47], a[164:167], v[184:187]
  buffer_load_dwordx4 v10, s[12:15], s51 offen offset:2048 lds
  v_mfma_f32_16x16x32_bf16 v[184:187], v[40:43], a[160:163], v[184:187]
  v_mfma_f32_16x16x32_bf16 v[180:183], v[40:43], a[96:99], v[180:183]
  v_mfma_f32_16x16x32_bf16 v[180:183], v[44:47], a[100:103], v[180:183]
  v_mfma_f32_16x16x32_bf16 v[176:179], v[44:47], a[36:39], v[176:179]
  v_mfma_f32_16x16x32_bf16 v[176:179], v[40:43], a[32:35], v[176:179]
  s_waitcnt lgkmcnt(4)
  buffer_load_dwordx4 v11, s[12:15], s51 offen offset:3072 lds
  v_mfma_f32_16x16x32_bf16 v[192:195], v[48:51], a[32:35], v[192:195]
  s_add_u32 m0, s36, 16384
  ds_read_b64_tr_b16 v[40:41], v22 offset:0
  ds_read_b64_tr_b16 v[42:43], v22 offset:1024
  v_mfma_f32_16x16x32_bf16 v[192:195], v[52:55], a[36:39], v[192:195]
  s_add_u32 s51, s38, 7
  ds_read_b64_tr_b16 v[44:45], v22 offset:8192
  ds_read_b64_tr_b16 v[46:47], v22 offset:9216
  v_mfma_f32_16x16x32_bf16 v[196:199], v[52:55], a[100:103], v[196:199]
  s_and_b32 s51, s51, 7
  v_mfma_f32_16x16x32_bf16 v[196:199], v[48:51], a[96:99], v[196:199]
  s_lshl_b32 s51, s51, 19
  v_mfma_f32_16x16x32_bf16 v[200:203], v[48:51], a[160:163], v[200:203]
  s_add_u32 s51, s51, s34
  v_mfma_f32_16x16x32_bf16 v[200:203], v[52:55], a[164:167], v[200:203]
  buffer_load_dwordx4 v8, s[12:15], s51 offen offset:0 lds
  v_mfma_f32_16x16x32_bf16 v[204:207], v[52:55], a[228:231], v[204:207]
  v_mfma_f32_16x16x32_bf16 v[204:207], v[48:51], a[224:227], v[204:207]
  s_waitcnt lgkmcnt(4)
  v_mfma_f32_16x16x32_bf16 v[220:223], v[32:35], a[224:227], v[220:223]
  ds_read_b64_tr_b16 v[48:49], v23 offset:0
  ds_read_b64_tr_b16 v[50:51], v23 offset:1024
  v_mfma_f32_16x16x32_bf16 v[220:223], v[36:39], a[228:231], v[220:223]
  ds_read_b64_tr_b16 v[52:53], v23 offset:8192
  ds_read_b64_tr_b16 v[54:55], v23 offset:9216
  v_mfma_f32_16x16x32_bf16 v[216:219], v[36:39], a[164:167], v[216:219]
  v_mfma_f32_16x16x32_bf16 v[216:219], v[32:35], a[160:163], v[216:219]
  buffer_load_dwordx4 v9, s[12:15], s51 offen offset:1024 lds
  v_mfma_f32_16x16x32_bf16 v[212:215], v[32:35], a[96:99], v[212:215]
  v_mfma_f32_16x16x32_bf16 v[212:215], v[36:39], a[100:103], v[212:215]
  v_mfma_f32_16x16x32_bf16 v[208:211], v[36:39], a[36:39], v[208:211]
  v_mfma_f32_16x16x32_bf16 v[208:211], v[32:35], a[32:35], v[208:211]
  s_waitcnt lgkmcnt(4)
  v_mfma_f32_16x16x32_bf16 v[224:227], v[40:43], a[32:35], v[224:227]
  v_mfma_f32_16x16x32_bf16 v[224:227], v[44:47], a[36:39], v[224:227]
  buffer_load_dwordx4 v10, s[12:15], s51 offen offset:2048 lds
  v_mfma_f32_16x16x32_bf16 v[228:231], v[44:47], a[100:103], v[228:231]
  s_waitcnt vmcnt(18) lgkmcnt(0)
  s_barrier
  s_lshl_b32 s61, s41, 3
  s_add_u32 s61, s61, s42
  s_cmp_lg_u32 s40, 0
  s_cbranch_scc1 Lpub14
  s_lshr_b32 s4, s61, 2
  s_lshl_b32 s4, s4, 5
  s_and_b32 s5, s61, 3
  s_add_u32 s4, s4, s5
  s_lshl_b32 s4, s4, 2
  s_add_u32 s4, s4, 65019904
  v_mov_b32 v26, 1
  s_mov_b64 exec, 1
  buffer_store_dword v26, off, s[20:23], s4 sc1
  s_mov_b64 exec, -1
Lpub14:
  ds_read_b64_tr_b16 v[32:33], v16 offset:16384
  ds_read_b64_tr_b16 v[34:35], v16 offset:17408
  v_mfma_f32_16x16x32_bf16 v[228:231], v[40:43], a[96:99], v[228:231]
  ds_read_b64_tr_b16 v[36:37], v16 offset:24576
  ds_read_b64_tr_b16 v[38:39], v16 offset:25600
  v_mfma_f32_16x16x32_bf16 v[232:235], v[40:43], a[160:163], v[232:235]
  v_mfma_f32_16x16x32_bf16 v[232:235], v[44:47], a[164:167], v[232:235]
  v_mfma_f32_16x16x32_bf16 v[236:239], v[44:47], a[228:231], v[236:239]
  v_mfma_f32_16x16x32_bf16 v[236:239], v[40:43], a[224:227], v[236:239]
  buffer_load_dwordx4 v11, s[12:15], s51 offen offset:3072 lds
  v_mfma_f32_16x16x32_bf16 v[252:255], v[48:51], a[224:227], v[252:255]
  s_add_u32 s50, s38, 7
  ds_read_b64_tr_b16 v[40:41], v17 offset:16384
  ds_read_b64_tr_b16 v[42:43], v17 offset:17408
  v_mfma_f32_16x16x32_bf16 v[252:255], v[52:55], a[228:231], v[252:255]
  s_and_b32 s50, s50, 7
  ds_read_b64_tr_b16 v[44:45], v17 offset:24576
  ds_read_b64_tr_b16 v[46:47], v17 offset:25600
  v_mfma_f32_16x16x32_bf16 v[248:251], v[52:55], a[164:167], v[248:251]
  s_lshl_b32 s50, s50, 11
  v_mfma_f32_16x16x32_bf16 v[248:251], v[48:51], a[160:163], v[248:251]
  s_add_u32 s49, s50, s52
  v_mfma_f32_16x16x32_bf16 v[244:247], v[48:51], a[96:99], v[244:247]
  s_add_u32 s50, s50, s53
  v_mfma_f32_16x16x32_bf16 v[244:247], v[52:55], a[100:103], v[244:247]
  buffer_load_dwordx4 a[56:59], v2, s[20:23], s49 offen offset:0 sc1
  v_mfma_f32_16x16x32_bf16 v[240:243], v[52:55], a[36:39], v[240:243]
  v_mfma_f32_16x16x32_bf16 v[240:243], v[48:51], a[32:35], v[240:243]
  s_waitcnt lgkmcnt(4)
  s_waitcnt vmcnt(17)
  v_mfma_f32_16x16x32_bf16 v[128:131], v[32:35], a[40:43], v[128:131]
  ds_read_b64_tr_b16 v[48:49], v18 offset:16384
  ds_read_b64_tr_b16 v[50:51], v18 offset:17408
  v_mfma_f32_16x16x32_bf16 v[128:131], v[36:39], a[44:47], v[128:131]
  ds_read_b64_tr_b16 v[52:53], v18 offset:24576
  ds_read_b64_tr_b16 v[54:55], v18 offset:25600
  v_mfma_f32_16x16x32_bf16 v[132:135], v[36:39], a[108:111], v[132:135]
  v_mfma_f32_16x16x32_bf16 v[132:135], v[32:35], a[104:107], v[132:135]
  buffer_load_dwordx4 a[60:63], v2, s[20:23], s49 offen offset:1024 sc1
  v_mfma_f32_16x16x32_bf16 v[136:139], v[32:35], a[168:171], v[136:139]
  v_mfma_f32_16x16x32_bf16 v[136:139], v[36:39], a[172:175], v[136:139]
  v_mfma_f32_16x16x32_bf16 v[140:143], v[36:39], a[236:239], v[140:143]
  v_mfma_f32_16x16x32_bf16 v[140:143], v[32:35], a[232:235], v[140:143]
  s_waitcnt lgkmcnt(4)
  v_mfma_f32_16x16x32_bf16 v[156:159], v[40:43], a[232:235], v[156:159]
  ds_read_b64_tr_b16 v[32:33], v19 offset:16384
  ds_read_b64_tr_b16 v[34:35], v19 offset:17408
  v_mfma_f32_16x16x32_bf16 v[156:159], v[44:47], a[236:239], v[156:159]
  ds_read_b64_tr_b16 v[36:37], v19 offset:24576
  ds_read_b64_tr_b16 v[38:39], v19 offset:25600
  v_mfma_f32_16x16x32_bf16 v[152:155], v[44:47], a[172:175], v[152:155]
  buffer_load_dwordx4 a[120:123], v3, s[20:23], s49 offen offset:0 sc1
  v_mfma_f32_16x16x32_bf16 v[152:155], v[40:43], a[168:171], v[152:155]
  v_mfma_f32_16x16x32_bf16 v[148:151], v[40:43], a[104:107], v[148:151]
  v_mfma_f32_16x16x32_bf16 v[148:151], v[44:47], a[108:111], v[148:151]
  v_mfma_f32_16x16x32_bf16 v[144:147], v[44:47], a[44:47], v[144:147]
  v_mfma_f32_16x16x32_bf16 v[144:147], v[40:43], a[40:43], v[144:147]
  s_waitcnt lgkmcnt(4)
  buffer_load_dwordx4 a[124:127], v3, s[20:23], s49 offen offset:1024 sc1
  v_mfma_f32_16x16x32_bf16 v[160:163], v[48:51], a[40:43], v[160:163]
  ds_read_b64_tr_b16 v[40:41], v20 offset:16384
  ds_read_b64_tr_b16 v[42:43], v20 offset:17408
  v_mfma_f32_16x16x32_bf16 v[160:163], v[52:55], a[44:47], v[160:163]
  ds_read_b64_tr_b16 v[44:45], v20 offset:24576
  ds_read_b64_tr_b16 v[46:47], v20 offset:25600
  v_mfma_f32_16x16x32_bf16 v[164:167], v[52:55], a[108:111], v[164:167]
  v_mfma_f32_16x16x32_bf16 v[164:167], v[48:51], a[104:107], v[164:167]
  v_mfma_f32_16x16x32_bf16 v[168:171], v[48:51], a[168:171], v[168:171]
  v_mfma_f32_16x16x32_bf16 v[168:171], v[52:55], a[172:175], v[168:171]
  buffer_load_dwordx4 a[184:187], v2, s[20:23], s50 offen offset:0 sc1
  v_mfma_f32_16x16x32_bf16 v[172:175], v[52:55], a[236:239], v[172:175]
  v_mfma_f32_16x16x32_bf16 v[172:175], v[48:51], a[232:235], v[172:175]
  s_waitcnt lgkmcnt(4)
  v_mfma_f32_16x16x32_bf16 v[188:191], v[32:35], a[232:235], v[188:191]
  ds_read_b64_tr_b16 v[48:49], v21 offset:16384
  ds_read_b64_tr_b16 v[50:51], v21 offset:17408
  v_mfma_f32_16x16x32_bf16 v[188:191], v[36:39], a[236:239], v[188:191]
  ds_read_b64_tr_b16 v[52:53], v21 offset:24576
  ds_read_b64_tr_b16 v[54:55], v21 offset:25600
  v_mfma_f32_16x16x32_bf16 v[184:187], v[36:39], a[172:175], v[184:187]
  v_mfma_f32_16x16x32_bf16 v[184:187], v[32:35], a[168:171], v[184:187]
  buffer_load_dwordx4 a[188:191], v2, s[20:23], s50 offen offset:1024 sc1
  v_mfma_f32_16x16x32_bf16 v[180:183], v[32:35], a[104:107], v[180:183]
  v_mfma_f32_16x16x32_bf16 v[180:183], v[36:39], a[108:111], v[180:183]
  v_mfma_f32_16x16x32_bf16 v[176:179], v[36:39], a[44:47], v[176:179]
  v_mfma_f32_16x16x32_bf16 v[176:179], v[32:35], a[40:43], v[176:179]
  s_waitcnt lgkmcnt(4)
  v_mfma_f32_16x16x32_bf16 v[192:195], v[40:43], a[40:43], v[192:195]
  ds_read_b64_tr_b16 v[32:33], v22 offset:16384
  ds_read_b64_tr_b16 v[34:35], v22 offset:17408
  v_mfma_f32_16x16x32_bf16 v[192:195], v[44:47], a[44:47], v[192:195]
  ds_read_b64_tr_b16 v[36:37], v22 offset:24576
  ds_read_b64_tr_b16 v[38:39], v22 offset:25600
  v_mfma_f32_16x16x32_bf16 v[196:199], v[44:47], a[108:111], v[196:199]
  buffer_load_dwordx4 a[248:251], v3, s[20:23], s50 offen offset:0 sc1
  v_mfma_f32_16x16x32_bf16 v[196:199], v[40:43], a[104:107], v[196:199]
  v_mfma_f32_16x16x32_bf16 v[200:203], v[40:43], a[168:171], v[200:203]
  v_mfma_f32_16x16x32_bf16 v[200:203], v[44:47], a[172:175], v[200:203]
  v_mfma_f32_16x16x32_bf16 v[204:207], v[44:47], a[236:239], v[204:207]
  v_mfma_f32_16x16x32_bf16 v[204:207], v[40:43], a[232:235], v[204:207]
  s_waitcnt lgkmcnt(4)
  buffer_load_dwordx4 a[252:255], v3, s[20:23], s50 offen offset:1024 sc1
  v_mfma_f32_16x16x32_bf16 v[220:223], v[48:51], a[232:235], v[220:223]
  ds_read_b64_tr_b16 v[40:41], v23 offset:16384
  ds_read_b64_tr_b16 v[42:43], v23 offset:17408
  v_mfma_f32_16x16x32_bf16 v[220:223], v[52:55], a[236:239], v[220:223]
  ds_read_b64_tr_b16 v[44:45], v23 offset:24576
  ds_read_b64_tr_b16 v[46:47], v23 offset:25600
  v_mfma_f32_16x16x32_bf16 v[216:219], v[52:55], a[172:175], v[216:219]
  v_mfma_f32_16x16x32_bf16 v[216:219], v[48:51], a[168:171], v[216:219]
  v_mfma_f32_16x16x32_bf16 v[212:215], v[48:51], a[104:107], v[212:215]
  v_mfma_f32_16x16x32_bf16 v[212:215], v[52:55], a[108:111], v[212:215]
  s_getpc_b64 s[24:25]
Lpc15:
  s_add_u32 s24, s24, Lattn - Lpc15
  s_addc_u32 s25, s25, 0
  s_and_b32 s25, s25, 0xffff
  s_mov_b32 s26, Ldrain - Lattn
  s_mov_b32 s27, 0x20000
  buffer_load_dword v27, v0, s[24:27], 0 offen
  v_mfma_f32_16x16x32_bf16 v[208:211], v[52:55], a[44:47], v[208:211]
  v_mfma_f32_16x16x32_bf16 v[208:211], v[48:51], a[40:43], v[208:211]
  s_waitcnt lgkmcnt(4)
  v_mfma_f32_16x16x32_bf16 v[224:227], v[32:35], a[40:43], v[224:227]
  v_mfma_f32_16x16x32_bf16 v[224:227], v[36:39], a[44:47], v[224:227]
  v_mfma_f32_16x16x32_bf16 v[228:231], v[36:39], a[108:111], v[228:231]
  s_waitcnt vmcnt(9) lgkmcnt(0)
  s_barrier
  v_add_u32 v16, 0xfffe0000, v16
  v_add_u32 v17, 0xfffe0000, v17
  v_add_u32 v18, 0xfffe0000, v18
  v_add_u32 v19, 0xfffe0000, v19
  v_add_u32 v20, 0xfffe0000, v20
  v_add_u32 v21, 0xfffe0000, v21
  v_add_u32 v22, 0xfffe0000, v22
  v_add_u32 v23, 0xfffe0000, v23
  ds_read_b64_tr_b16 v[48:49], v16 offset:0
  ds_read_b64_tr_b16 v[50:51], v16 offset:1024
  v_mfma_f32_16x16x32_bf16 v[228:231], v[32:35], a[104:107], v[228:231]
  ds_read_b64_tr_b16 v[52:53], v16 offset:8192
  ds_read_b64_tr_b16 v[54:55], v16 offset:9216
  v_mfma_f32_16x16x32_bf16 v[232:235], v[32:35], a[168:171], v[232:235]
  v_mfma_f32_16x16x32_bf16 v[232:235], v[36:39], a[172:175], v[232:235]
  v_mfma_f32_16x16x32_bf16 v[236:239], v[36:39], a[236:239], v[236:239]
  v_mfma_f32_16x16x32_bf16 v[236:239], v[32:35], a[232:235], v[236:239]
  v_mfma_f32_16x16x32_bf16 v[252:255], v[40:43], a[232:235], v[252:255]
  ds_read_b64_tr_b16 v[32:33], v17 offset:0
  ds_read_b64_tr_b16 v[34:35], v17 offset:1024
  v_mfma_f32_16x16x32_bf16 v[252:255], v[44:47], a[236:239], v[252:255]
  ds_read_b64_tr_b16 v[36:37], v17 offset:8192
  ds_read_b64_tr_b16 v[38:39], v17 offset:9216
  v_mfma_f32_16x16x32_bf16 v[248:251], v[44:47], a[172:175], v[248:251]
  v_mfma_f32_16x16x32_bf16 v[248:251], v[40:43], a[168:171], v[248:251]
  v_mfma_f32_16x16x32_bf16 v[244:247], v[40:43], a[104:107], v[244:247]
  v_mfma_f32_16x16x32_bf16 v[244:247], v[44:47], a[108:111], v[244:247]
  v_mfma_f32_16x16x32_bf16 v[240:243], v[44:47], a[44:47], v[240:243]
  v_mfma_f32_16x16x32_bf16 v[240:243], v[40:43], a[40:43], v[240:243]
  s_waitcnt lgkmcnt(4)
  v_mfma_f32_16x16x32_bf16 v[128:131], v[48:51], a[48:51], v[128:131]
  ds_read_b64_tr_b16 v[40:41], v18 offset:0
  ds_read_b64_tr_b16 v[42:43], v18 offset:1024
  v_mfma_f32_16x16x32_bf16 v[128:131], v[52:55], a[52:55], v[128:131]
  ds_read_b64_tr_b16 v[44:45], v18 offset:8192
  ds_read_b64_tr_b16 v[46:47], v18 offset:9216
  v_mfma_f32_16x16x32_bf16 v[132:135], v[52:55], a[116:119], v[132:135]
  s_lshl_b32 s55, s41, 8
  s_add_u32 s55, s55, 65019904
  v_mfma_f32_16x16x32_bf16 v[132:135], v[48:51], a[112:115], v[132:135]
  v_mov_b32 v29, 0
  buffer_load_dword v28, v29, s[20:23], s55 offen sc1
  v_mfma_f32_16x16x32_bf16 v[136:139], v[48:51], a[176:179], v[136:139]
  s_lshl_b32 s45, s41, 19
  s_lshl_b32 s60, s40, 13
  v_mfma_f32_16x16x32_bf16 v[136:139], v[52:55], a[180:183], v[136:139]
  s_add_u32 s45, s45, s60
  s_add_u32 s46, s45, 16769024
  v_mfma_f32_16x16x32_bf16 v[140:143], v[52:55], a[244:247], v[140:143]
  s_add_u32 s47, s60, 32768
  s_add_u32 s48, s60, 65536
  v_mfma_f32_16x16x32_bf16 v[140:143], v[48:51], a[240:243], v[140:143]
  s_waitcnt lgkmcnt(4)
  v_mfma_f32_16x16x32_bf16 v[156:159], v[32:35], a[240:243], v[156:159]
  ds_read_b64_tr_b16 v[48:49], v19 offset:0
  ds_read_b64_tr_b16 v[50:51], v19 offset:1024
  v_mfma_f32_16x16x32_bf16 v[156:159], v[36:39], a[244:247], v[156:159]
  ds_read_b64_tr_b16 v[52:53], v19 offset:8192
  ds_read_b64_tr_b16 v[54:55], v19 offset:9216
  v_mfma_f32_16x16x32_bf16 v[152:155], v[36:39], a[180:183], v[152:155]
  v_mfma_f32_16x16x32_bf16 v[152:155], v[32:35], a[176:179], v[152:155]
  v_mfma_f32_16x16x32_bf16 v[148:151], v[32:35], a[112:115], v[148:151]
  v_mfma_f32_16x16x32_bf16 v[148:151], v[36:39], a[116:119], v[148:151]
  v_mfma_f32_16x16x32_bf16 v[144:147], v[36:39], a[52:55], v[144:147]
  v_mfma_f32_16x16x32_bf16 v[144:147], v[32:35], a[48:51], v[144:147]
  s_waitcnt lgkmcnt(4)
  v_mfma_f32_16x16x32_bf16 v[160:163], v[40:43], a[48:51], v[160:163]
  ds_read_b64_tr_b16 v[32:33], v20 offset:0
  ds_read_b64_tr_b16 v[34:35], v20 offset:1024
  v_mfma_f32_16x16x32_bf16 v[160:163], v[44:47], a[52:55], v[160:163]
  ds_read_b64_tr_b16 v[36:37], v20 offset:8192
  ds_read_b64_tr_b16 v[38:39], v20 offset:9216
  v_mfma_f32_16x16x32_bf16 v[164:167], v[44:47], a[116:119], v[164:167]
  v_mfma_f32_16x16x32_bf16 v[164:167], v[40:43], a[112:115], v[164:167]
  v_mfma_f32_16x16x32_bf16 v[168:171], v[40:43], a[176:179], v[168:171]
  v_mfma_f32_16x16x32_bf16 v[168:171], v[44:47], a[180:183], v[168:171]
  v_mfma_f32_16x16x32_bf16 v[172:175], v[44:47], a[244:247], v[172:175]
  v_mfma_f32_16x16x32_bf16 v[172:175], v[40:43], a[240:243], v[172:175]
  s_waitcnt lgkmcnt(4)
  v_mfma_f32_16x16x32_bf16 v[188:191], v[48:51], a[240:243], v[188:191]
  ds_read_b64_tr_b16 v[40:41], v21 offset:0
  ds_read_b64_tr_b16 v[42:43], v21 offset:1024
  v_mfma_f32_16x16x32_bf16 v[188:191], v[52:55], a[244:247], v[188:191]
  ds_read_b64_tr_b16 v[44:45], v21 offset:8192
  ds_read_b64_tr_b16 v[46:47], v21 offset:9216
  v_mfma_f32_16x16x32_bf16 v[184:187], v[52:55], a[180:183], v[184:187]
  v_mfma_f32_16x16x32_bf16 v[184:187], v[48:51], a[176:179], v[184:187]
  v_mfma_f32_16x16x32_bf16 v[180:183], v[48:51], a[112:115], v[180:183]
  v_mfma_f32_16x16x32_bf16 v[180:183], v[52:55], a[116:119], v[180:183]
  v_mfma_f32_16x16x32_bf16 v[176:179], v[52:55], a[52:55], v[176:179]
  v_mfma_f32_16x16x32_bf16 v[176:179], v[48:51], a[48:51], v[176:179]
  s_waitcnt lgkmcnt(4)
  v_mfma_f32_16x16x32_bf16 v[192:195], v[32:35], a[48:51], v[192:195]
  ds_read_b64_tr_b16 v[48:49], v22 offset:0
  ds_read_b64_tr_b16 v[50:51], v22 offset:1024
  v_mfma_f32_16x16x32_bf16 v[192:195], v[36:39], a[52:55], v[192:195]
  ds_read_b64_tr_b16 v[52:53], v22 offset:8192
  ds_read_b64_tr_b16 v[54:55], v22 offset:9216
  v_mfma_f32_16x16x32_bf16 v[196:199], v[36:39], a[116:119], v[196:199]
  v_mfma_f32_16x16x32_bf16 v[196:199], v[32:35], a[112:115], v[196:199]
  v_mfma_f32_16x16x32_bf16 v[200:203], v[32:35], a[176:179], v[200:203]
  s_waitcnt vmcnt(0)
  v_cmp_ne_u32 vcc, 1, v28
  s_cbranch_vccz Lspok17
  s_mov_b32 s5, 0
Lspin16:
  s_sleep 16
  buffer_load_dword v28, v29, s[20:23], s55 offen sc1
  s_add_u32 s5, s5, 1
  s_waitcnt vmcnt(0)
  v_cmp_ne_u32 vcc, 1, v28
  s_cbranch_vccz Lspok17
  s_cmp_lt_u32 s5, 0x10000
  s_cbranch_scc1 Lspin16
Lspok17:
  v_mfma_f32_16x16x32_bf16 v[200:203], v[36:39], a[180:183], v[200:203]
  s_mov_b32 m0, s47
  s_nop 0
  buffer_load_dwordx4 v2, s[20:23], s45 offen offset:0 sc1 lds
  v_mfma_f32_16x16x32_bf16 v[204:207], v[36:39], a[244:247], v[204:207]
  buffer_load_dwordx4 v2, s[20:23], s45 offen offset:1024 sc1 lds
  v_mfma_f32_16x16x32_bf16 v[204:207], v[32:35], a[240:243], v[204:207]
  s_waitcnt lgkmcnt(4)
  v_mfma_f32_16x16x32_bf16 v[220:223], v[40:43], a[240:243], v[220:223]
  ds_read_b64_tr_b16 v[32:33], v23 offset:0
  ds_read_b64_tr_b16 v[34:35], v23 offset:1024
  v_mfma_f32_16x16x32_bf16 v[220:223], v[44:47], a[244:247], v[220:223]
  ds_read_b64_tr_b16 v[36:37], v23 offset:8192
  ds_read_b64_tr_b16 v[38:39], v23 offset:9216
  v_mfma_f32_16x16x32_bf16 v[216:219], v[44:47], a[180:183], v[216:219]
  buffer_load_dwordx4 v2, s[20:23], s45 offen offset:2048 sc1 lds
  v_mfma_f32_16x16x32_bf16 v[216:219], v[40:43], a[176:179], v[216:219]
  v_mfma_f32_16x16x32_bf16 v[212:215], v[40:43], a[112:115], v[212:215]
  v_mfma_f32_16x16x32_bf16 v[212:215], v[44:47], a[116:119], v[212:215]
  v_mfma_f32_16x16x32_bf16 v[208:211], v[44:47], a[52:55], v[208:211]
  buffer_load_dwordx4 v2, s[20:23], s45 offen offset:3072 sc1 lds
  v_mfma_f32_16x16x32_bf16 v[208:211], v[40:43], a[48:51], v[208:211]
  s_waitcnt lgkmcnt(4)
  v_mfma_f32_16x16x32_bf16 v[224:227], v[48:51], a[48:51], v[224:227]
  s_add_u32 m0, s47, 4096
  ds_read_b64_tr_b16 v[40:41], v16 offset:16384
  ds_read_b64_tr_b16 v[42:43], v16 offset:17408
  v_mfma_f32_16x16x32_bf16 v[224:227], v[52:55], a[52:55], v[224:227]
  s_add_u32 s45, s45, 4096
  ds_read_b64_tr_b16 v[44:45], v16 offset:24576
  ds_read_b64_tr_b16 v[46:47], v16 offset:25600
  v_mfma_f32_16x16x32_bf16 v[228:231], v[52:55], a[116:119], v[228:231]
  buffer_load_dwordx4 v2, s[20:23], s45 offen offset:0 sc1 lds
  v_mfma_f32_16x16x32_bf16 v[228:231], v[48:51], a[112:115], v[228:231]
  v_mfma_f32_16x16x32_bf16 v[232:235], v[48:51], a[176:179], v[232:235]
  v_mfma_f32_16x16x32_bf16 v[232:235], v[52:55], a[180:183], v[232:235]
  v_mfma_f32_16x16x32_bf16 v[236:239], v[52:55], a[244:247], v[236:239]
  buffer_load_dwordx4 v2, s[20:23], s45 offen offset:1024 sc1 lds
  v_mfma_f32_16x16x32_bf16 v[236:239], v[48:51], a[240:243], v[236:239]
  s_waitcnt lgkmcnt(4)
  v_mfma_f32_16x16x32_bf16 v[252:255], v[32:35], a[240:243], v[252:255]
  ds_read_b64_tr_b16 v[48:49], v17 offset:16384
  ds_read_b64_tr_b16 v[50:51], v17 offset:17408
  v_mfma_f32_16x16x32_bf16 v[252:255], v[36:39], a[244:247], v[252:255]
  ds_read_b64_tr_b16 v[52:53], v17 offset:24576
  ds_read_b64_tr_b16 v[54:55], v17 offset:25600
  v_mfma_f32_16x16x32_bf16 v[248:251], v[36:39], a[180:183], v[248:251]
  buffer_load_dwordx4 v2, s[20:23], s45 offen offset:2048 sc1 lds
  v_mfma_f32_16x16x32_bf16 v[248:251], v[32:35], a[176:179], v[248:251]
  v_mfma_f32_16x16x32_bf16 v[244:247], v[32:35], a[112:115], v[244:247]
  v_mfma_f32_16x16x32_bf16 v[244:247], v[36:39], a[116:119], v[244:247]
  v_mfma_f32_16x16x32_bf16 v[240:243], v[36:39], a[52:55], v[240:243]
  buffer_load_dwordx4 v2, s[20:23], s45 offen offset:3072 sc1 lds
  v_mfma_f32_16x16x32_bf16 v[240:243], v[32:35], a[48:51], v[240:243]
  s_waitcnt lgkmcnt(4)
  v_mfma_f32_16x16x32_bf16 v[128:131], v[40:43], a[56:59], v[128:131]
  s_add_u32 s45, s45, 28672
  ds_read_b64_tr_b16 v[32:33], v18 offset:16384
  ds_read_b64_tr_b16 v[34:35], v18 offset:17408
  v_mfma_f32_16x16x32_bf16 v[128:131], v[44:47], a[60:63], v[128:131]
  s_mov_b32 m0, s48
  ds_read_b64_tr_b16 v[36:37], v18 offset:24576
  ds_read_b64_tr_b16 v[38:39], v18 offset:25600
  v_mfma_f32_16x16x32_bf16 v[132:135], v[44:47], a[124:127], v[132:135]
  s_nop 0
  buffer_load_dwordx4 v2, s[20:23], s46 offen offset:0 sc1 lds
  v_mfma_f32_16x16x32_bf16 v[132:135], v[40:43], a[120:123], v[132:135]
  v_mfma_f32_16x16x32_bf16 v[136:139], v[40:43], a[184:187], v[136:139]
  v_mfma_f32_16x16x32_bf16 v[136:139], v[44:47], a[188:191], v[136:139]
  v_mfma_f32_16x16x32_bf16 v[140:143], v[44:47], a[252:255], v[140:143]
  buffer_load_dwordx4 v2, s[20:23], s46 offen offset:1024 sc1 lds
  v_mfma_f32_16x16x32_bf16 v[140:143], v[40:43], a[248:251], v[140:143]
  s_waitcnt lgkmcnt(4)
  v_mfma_f32_16x16x32_bf16 v[156:159], v[48:51], a[248:251], v[156:159]
  ds_read_b64_tr_b16 v[40:41], v19 offset:16384
  ds_read_b64_tr_b16 v[42:43], v19 offset:17408
  v_mfma_f32_16x16x32_bf16 v[156:159], v[52:55], a[252:255], v[156:159]
  ds_read_b64_tr_b16 v[44:45], v19 offset:24576
  ds_read_b64_tr_b16 v[46:47], v19 offset:25600
  v_mfma_f32_16x16x32_bf16 v[152:155], v[52:55], a[188:191], v[152:155]
  buffer_load_dwordx4 v2, s[20:23], s46 offen offset:2048 sc1 lds
  v_mfma_f32_16x16x32_bf16 v[152:155], v[48:51], a[184:187], v[152:155]
  v_mfma_f32_16x16x32_bf16 v[148:151], v[48:51], a[120:123], v[148:151]
  v_mfma_f32_16x16x32_bf16 v[148:151], v[52:55], a[124:127], v[148:151]
  v_mfma_f32_16x16x32_bf16 v[144:147], v[52:55], a[60:63], v[144:147]
  buffer_load_dwordx4 v2, s[20:23], s46 offen offset:3072 sc1 lds
  v_mfma_f32_16x16x32_bf16 v[144:147], v[48:51], a[56:59], v[144:147]
  s_waitcnt lgkmcnt(4)
  v_mfma_f32_16x16x32_bf16 v[160:163], v[32:35], a[56:59], v[160:163]
  s_add_u32 m0, s48, 4096
  ds_read_b64_tr_b16 v[48:49], v20 offset:16384
  ds_read_b64_tr_b16 v[50:51], v20 offset:17408
  v_mfma_f32_16x16x32_bf16 v[160:163], v[36:39], a[60:63], v[160:163]
  s_add_u32 s46, s46, 4096
  ds_read_b64_tr_b16 v[52:53], v20 offset:24576
  ds_read_b64_tr_b16 v[54:55], v20 offset:25600
  v_mfma_f32_16x16x32_bf16 v[164:167], v[36:39], a[124:127], v[164:167]
  buffer_load_dwordx4 v2, s[20:23], s46 offen offset:0 sc1 lds
  v_cvt_pk_bf16_f32 v64, v128, v129
  v_mfma_f32_16x16x32_bf16 v[164:167], v[32:35], a[120:123], v[164:167]
  v_cvt_pk_bf16_f32 v65, v130, v131
  v_cvt_pk_bf16_f32 v66, v144, v145
  v_mfma_f32_16x16x32_bf16 v[168:171], v[32:35], a[184:187], v[168:171]
  v_cvt_pk_bf16_f32 v67, v146, v147
  v_cvt_pk_bf16_f32 v80, v132, v133
  v_mfma_f32_16x16x32_bf16 v[168:171], v[36:39], a[188:191], v[168:171]
  v_cvt_pk_bf16_f32 v81, v134, v135
  v_cvt_pk_bf16_f32 v82, v148, v149
  v_mfma_f32_16x16x32_bf16 v[172:175], v[36:39], a[252:255], v[172:175]
  buffer_load_dwordx4 v2, s[20:23], s46 offen offset:1024 sc1 lds
  v_cvt_pk_bf16_f32 v83, v150, v151
  v_mfma_f32_16x16x32_bf16 v[172:175], v[32:35], a[248:251], v[172:175]
  s_waitcnt lgkmcnt(4)
  v_cvt_pk_bf16_f32 v96, v136, v137
  v_cvt_pk_bf16_f32 v97, v138, v139
  v_mfma_f32_16x16x32_bf16 v[188:191], v[40:43], a[248:251], v[188:191]
  ds_read_b64_tr_b16 v[32:33], v21 offset:16384
  ds_read_b64_tr_b16 v[34:35], v21 offset:17408
  v_mfma_f32_16x16x32_bf16 v[188:191], v[44:47], a[252:255], v[188:191]
  ds_read_b64_tr_b16 v[36:37], v21 offset:24576
  ds_read_b64_tr_b16 v[38:39], v21 offset:25600
  v_mfma_f32_16x16x32_bf16 v[184:187], v[44:47], a[188:191], v[184:187]
  buffer_load_dwordx4 v2, s[20:23], s46 offen offset:2048 sc1 lds
  v_cvt_pk_bf16_f32 v98, v152, v153
  v_mfma_f32_16x16x32_bf16 v[184:187], v[40:43], a[184:187], v[184:187]
  v_cvt_pk_bf16_f32 v99, v154, v155
  v_cvt_pk_bf16_f32 v112, v140, v141
  v_mfma_f32_16x16x32_bf16 v[180:183], v[40:43], a[120:123], v[180:183]
  v_cvt_pk_bf16_f32 v113, v142, v143
  v_cvt_pk_bf16_f32 v114, v156, v157
  v_mfma_f32_16x16x32_bf16 v[180:183], v[44:47], a[124:127], v[180:183]
  v_cvt_pk_bf16_f32 v115, v158, v159
  v_mfma_f32_16x16x32_bf16 v[176:179], v[44:47], a[60:63], v[176:179]
  buffer_load_dwordx4 v2, s[20:23], s46 offen offset:3072 sc1 lds
  v_mfma_f32_16x16x32_bf16 v[176:179], v[40:43], a[56:59], v[176:179]
  s_waitcnt lgkmcnt(4)
  v_mfma_f32_16x16x32_bf16 v[192:195], v[48:51], a[56:59], v[192:195]
  s_add_u32 s46, s46, 28672
  ds_read_b64_tr_b16 v[40:41], v22 offset:16384
  ds_read_b64_tr_b16 v[42:43], v22 offset:17408
  v_mfma_f32_16x16x32_bf16 v[192:195], v[52:55], a[60:63], v[192:195]
  ds_read_b64_tr_b16 v[44:45], v22 offset:24576
  ds_read_b64_tr_b16 v[46:47], v22 offset:25600
  v_mfma_f32_16x16x32_bf16 v[196:199], v[52:55], a[124:127], v[196:199]
  v_cvt_pk_bf16_f32 v68, v160, v161
  v_cvt_pk_bf16_f32 v69, v162, v163
  v_mfma_f32_16x16x32_bf16 v[196:199], v[48:51], a[120:123], v[196:199]
  v_cvt_pk_bf16_f32 v70, v176, v177
  v_cvt_pk_bf16_f32 v71, v178, v179
  v_mfma_f32_16x16x32_bf16 v[200:203], v[48:51], a[184:187], v[200:203]
  v_cvt_pk_bf16_f32 v84, v164, v165
  v_cvt_pk_bf16_f32 v85, v166, v167
  v_mfma_f32_16x16x32_bf16 v[200:203], v[52:55], a[188:191], v[200:203]
  v_cvt_pk_bf16_f32 v86, v180, v181
  v_cvt_pk_bf16_f32 v87, v182, v183
  v_mfma_f32_16x16x32_bf16 v[204:207], v[52:55], a[252:255], v[204:207]
  v_cvt_pk_bf16_f32 v100, v168, v169
  v_cvt_pk_bf16_f32 v101, v170, v171
  v_mfma_f32_16x16x32_bf16 v[204:207], v[48:51], a[248:251], v[204:207]
  s_waitcnt lgkmcnt(4)
  v_cvt_pk_bf16_f32 v102, v184, v185
  v_cvt_pk_bf16_f32 v103, v186, v187
  v_mfma_f32_16x16x32_bf16 v[220:223], v[32:35], a[248:251], v[220:223]
  ds_read_b64_tr_b16 v[48:49], v23 offset:16384
  ds_read_b64_tr_b16 v[50:51], v23 offset:17408
  v_mfma_f32_16x16x32_bf16 v[220:223], v[36:39], a[252:255], v[220:223]
  ds_read_b64_tr_b16 v[52:53], v23 offset:24576
  ds_read_b64_tr_b16 v[54:55], v23 offset:25600
  v_mfma_f32_16x16x32_bf16 v[216:219], v[36:39], a[188:191], v[216:219]
  v_cvt_pk_bf16_f32 v116, v172, v173
  v_cvt_pk_bf16_f32 v117, v174, v175
  v_mfma_f32_16x16x32_bf16 v[216:219], v[32:35], a[184:187], v[216:219]
  v_cvt_pk_bf16_f32 v118, v188, v189
  v_cvt_pk_bf16_f32 v119, v190, v191
  v_mfma_f32_16x16x32_bf16 v[212:215], v[32:35], a[120:123], v[212:215]
  v_mfma_f32_16x16x32_bf16 v[212:215], v[36:39], a[124:127], v[212:215]
  v_mfma_f32_16x16x32_bf16 v[208:211], v[36:39], a[60:63], v[208:211]
  v_mfma_f32_16x16x32_bf16 v[208:211], v[32:35], a[56:59], v[208:211]
  s_waitcnt lgkmcnt(4)
  v_mfma_f32_16x16x32_bf16 v[224:227], v[40:43], a[56:59], v[224:227]
  v_mfma_f32_16x16x32_bf16 v[224:227], v[44:47], a[60:63], v[224:227]
  v_mfma_f32_16x16x32_bf16 v[228:231], v[44:47], a[124:127], v[228:231]
  v_cvt_pk_bf16_f32 v72, v192, v193
  v_cvt_pk_bf16_f32 v73, v194, v195
  v_mfma_f32_16x16x32_bf16 v[228:231], v[40:43], a[120:123], v[228:231]
  v_cvt_pk_bf16_f32 v74, v208, v209
  v_cvt_pk_bf16_f32 v75, v210, v211
  v_mfma_f32_16x16x32_bf16 v[232:235], v[40:43], a[184:187], v[232:235]
  v_cvt_pk_bf16_f32 v88, v196, v197
  v_cvt_pk_bf16_f32 v89, v198, v199
  v_mfma_f32_16x16x32_bf16 v[232:235], v[44:47], a[188:191], v[232:235]
  v_cvt_pk_bf16_f32 v90, v212, v213
  v_cvt_pk_bf16_f32 v91, v214, v215
  v_mfma_f32_16x16x32_bf16 v[236:239], v[44:47], a[252:255], v[236:239]
  v_cvt_pk_bf16_f32 v104, v200, v201
  v_cvt_pk_bf16_f32 v105, v202, v203
  v_mfma_f32_16x16x32_bf16 v[236:239], v[40:43], a[248:251], v[236:239]
  s_waitcnt lgkmcnt(0)
  v_cvt_pk_bf16_f32 v106, v216, v217
  v_cvt_pk_bf16_f32 v107, v218, v219
  v_mfma_f32_16x16x32_bf16 v[252:255], v[48:51], a[248:251], v[252:255]
  v_cvt_pk_bf16_f32 v120, v204, v205
  v_cvt_pk_bf16_f32 v121, v206, v207
  v_mfma_f32_16x16x32_bf16 v[252:255], v[52:55], a[252:255], v[252:255]
  v_cvt_pk_bf16_f32 v122, v220, v221
  v_cvt_pk_bf16_f32 v123, v222, v223
  v_mfma_f32_16x16x32_bf16 v[248:251], v[52:55], a[188:191], v[248:251]
  v_mfma_f32_16x16x32_bf16 v[248:251], v[48:51], a[184:187], v[248:251]
  v_mfma_f32_16x16x32_bf16 v[244:247], v[48:51], a[120:123], v[244:247]
  v_mfma_f32_16x16x32_bf16 v[244:247], v[52:55], a[124:127], v[244:247]
  v_mfma_f32_16x16x32_bf16 v[240:243], v[52:55], a[60:63], v[240:243]
  v_mfma_f32_16x16x32_bf16 v[240:243], v[48:51], a[56:59], v[240:243]
  s_nop 3
Lattn:
  s_lshl_b32 s47, s40, 13
  s_mov_b32 s8, s20
  s_mov_b32 s9, s21
  s_mov_b32 s12, s20
  s_mov_b32 s13, s21
  s_sub_u32 s4, 16, s42
  s_lshl_b32 s4, s4, 15
  s_lshl_b32 s5, s41, 19
  s_add_u32 s10, s4, s5
  s_add_u32 s14, s10, 16777216
  s_mov_b32 s52, 32768
  s_mov_b32 s53, 0
  s_mov_b32 s54, 131072
  s_xor_b32 s48, s48, 32768
  s_mov_b32 s49, 0
  s_mov_b32 s50, s42
  s_cmp_eq_u32 s42, 0
  s_cselect_b32 s51, s40, 64
  v_add_u32 v51, 32768, v2
  v_add_u32 v52, 65536, v2
  v_and_b32 v29, 3, v1
  v_bfe_u32 v28, v1, 2, 1
  v_lshlrev_b32 v29, 2, v29
  v_lshl_add_u32 v29, v28, 7, v29
  s_mov_b32 s100, 4096
  s_mov_b32 s101, 28672
  s_sub_u32 s76, 14, s42
  s_waitcnt vmcnt(0)
  s_barrier
  v_mov_b32 v53, v2
  v_mov_b32 v54, v2
  v_mov_b32 v55, v2
  v_mov_b32 v30, v2
  ds_read_b128 a[128:131], v51 offset:0
  ds_read_b128 a[132:135], v51 offset:1024
  ds_read_b128 a[136:139], v51 offset:2048
  ds_read_b128 a[140:143], v51 offset:3072
  ds_read_b128 a[144:147], v51 offset:4096
  ds_read_b128 a[148:151], v51 offset:5120
  ds_read_b128 a[152:155], v51 offset:6144
  ds_read_b128 a[156:159], v51 offset:7168
  buffer_load_dword v28, v29, s[20:23], s55 offen sc1
  v_cvt_pk_bf16_f32 v76, v224, v225
  v_cvt_pk_bf16_f32 v77, v226, v227
  v_cvt_pk_bf16_f32 v78, v240, v241
  v_cvt_pk_bf16_f32 v79, v242, v243
  v_cvt_pk_bf16_f32 v92, v228, v229
  v_cvt_pk_bf16_f32 v93, v230, v231
  v_cvt_pk_bf16_f32 v94, v244, v245
  v_cvt_pk_bf16_f32 v95, v246, v247
  v_cvt_pk_bf16_f32 v108, v232, v233
  v_cvt_pk_bf16_f32 v109, v234, v235
  v_cvt_pk_bf16_f32 v110, v248, v249
  v_cvt_pk_bf16_f32 v111, v250, v251
  v_cvt_pk_bf16_f32 v124, v236, v237
  v_cvt_pk_bf16_f32 v125, v238, v239
  v_cvt_pk_bf16_f32 v126, v252, v253
  v_cvt_pk_bf16_f32 v127, v254, v255
  s_cmp_eq_u32 s42, 0
  s_cbranch_scc1 Lf0
  s_waitcnt lgkmcnt(4)
  v_mfma_f32_16x16x32_bf16 v[128:131], a[128:131], v[64:67], 0
  v_and_b32 v56, 15, v1
  v_lshrrev_b32 v57, 4, v1
  v_mfma_f32_16x16x32_bf16 v[128:131], a[132:135], v[68:71], v[128:131]
  s_add_u32 m0, s48, 0
  v_lshlrev_b32 v57, 2, v57
  v_sub_u32 v56, v56, v57
  v_mfma_f32_16x16x32_bf16 v[128:131], a[136:139], v[72:75], v[128:131]
  s_getpc_b64 s[28:29]
Lpc39:
  s_add_u32 s28, s28, Lp2y - Lpc39
  s_addc_u32 s29, s29, 0
  ds_read_b128 a[160:163], v51 offset:8192
  buffer_load_dwordx4 v2, s[12:15], s46 offen offset:0 sc1 lds
  v_mov_b32 v49, 0x5d800000
  v_mfma_f32_16x16x32_bf16 v[128:131], a[140:143], v[76:79], v[128:131]
  s_and_b32 s29, s29, 0xffff
  v_mov_b32 v50, 0xf149f2ca
  v_mov_b32 v57, 0x3f803f80
  v_mfma_f32_16x16x32_bf16 v[136:139], a[140:143], v[92:95], 0
  s_mov_b32 s30, adaLN_cond__compressed_kv_cla__mixer_channel_mlp__prompt_kernel_end - Lp2y
  ds_read_b128 a[164:167], v51 offset:9216
  v_cmp_le_i32 s[56:57], 0, v56
  v_mfma_f32_16x16x32_bf16 v[136:139], a[136:139], v[88:91], v[136:139]
  s_mov_b32 s31, 0x20000
  v_cmp_le_i32 s[58:59], 1, v56
  v_cmp_le_i32 s[60:61], 2, v56
  v_mfma_f32_16x16x32_bf16 v[136:139], a[132:135], v[84:87], v[136:139]
  s_lshl_b32 s72, s44, 2
  v_cmp_le_i32 s[62:63], 3, v56
  v_accvgpr_write_b32 a224, v57
  v_mfma_f32_16x16x32_bf16 v[136:139], a[128:131], v[80:83], v[136:139]
  s_waitcnt lgkmcnt(2)
  ds_read_b128 a[168:171], v51 offset:10240
  buffer_load_dwordx4 v2, s[12:15], s46 offen offset:1024 sc1 lds
  v_accvgpr_write_b32 a225, v57
  v_mfma_f32_16x16x32_bf16 v[140:143], a[144:147], v[80:83], 0
  s_add_u32 s72, s72, s40
  v_accvgpr_write_b32 a226, v57
  v_accvgpr_write_b32 a227, v57
  v_mfma_f32_16x16x32_bf16 v[140:143], a[148:151], v[84:87], v[140:143]
  s_mul_i32 s72, s72, 2560
  ds_read_b128 a[172:175], v51 offset:11264
  v_mov_b32 v36, 0
  v_mfma_f32_16x16x32_bf16 v[140:143], a[152:155], v[88:91], v[140:143]
  v_min_u32 v0, 19, v1
  v_mov_b32 v37, 0
  v_mov_b32 v38, 0
  v_mfma_f32_16x16x32_bf16 v[140:143], a[156:159], v[92:95], v[140:143]
  v_lshl_add_u32 v0, v0, 7, s72
  v_mov_b32 v39, 0
  v_mov_b32 v40, 0
  v_mfma_f32_16x16x32_bf16 v[132:135], a[156:159], v[76:79], 0
  s_lshr_b32 s32, s2, 3
  ds_read_b128 a[176:179], v51 offset:12288
  v_mov_b32 v41, 0
  v_mfma_f32_16x16x32_bf16 v[132:135], a[152:155], v[72:75], v[132:135]
  s_lshl_b32 s32, s32, 2
  v_mov_b32 v42, 0
  v_mov_b32 v43, 0
  v_mfma_f32_16x16x32_bf16 v[132:135], a[148:151], v[68:71], v[132:135]
  s_add_u32 s32, s32, s40
  ds_read_b128 a[180:183], v51 offset:13312
  v_mov_b32 v44, 0
  v_mfma_f32_16x16x32_bf16 v[132:135], a[144:147], v[64:67], v[132:135]
  s_lshl_b32 s32, s32, 13
  v_mov_b32 v45, 0
  v_mov_b32 v46, 0
  v_mfma_f32_16x16x32_bf16 v[144:147], a[128:131], v[96:99], 0
  s_and_b32 s72, s43, 3
  ds_read_b128 a[184:187], v51 offset:14336
  v_mov_b32 v47, 0
  v_mfma_f32_16x16x32_bf16 v[144:147], a[132:135], v[100:103], v[144:147]
  s_lshl_b32 s72, s72, 20
  ds_read_b128 a[188:191], v51 offset:15360
  buffer_load_dwordx4 v2, s[12:15], s46 offen offset:2048 sc1 lds
  v_mfma_f32_16x16x32_bf16 v[144:147], a[136:139], v[104:107], v[144:147]
  s_add_u32 s32, s32, s72
  buffer_load_dwordx4 v2, s[12:15], s46 offen offset:3072 sc1 lds
  v_max3_f32 v240, v128, v129, v130
  v_max3_f32 v240, v240, v131, v132
  v_max3_f32 v240, v240, v133, v134
  v_mfma_f32_16x16x32_bf16 v[144:147], a[140:143], v[108:111], v[144:147]
  s_add_u32 m0, s48, 4096
  v_max_f32 v240, v240, v135
  v_max3_f32 v241, v136, v137, v138
  v_max3_f32 v241, v241, v139, v140
  v_mfma_f32_16x16x32_bf16 v[152:155], a[140:143], v[124:127], 0
  s_add_u32 s46, s46, 4096
  v_max3_f32 v241, v241, v141, v142
  v_max_f32 v241, v241, v143
  v_mov_b32 v244, v240
  v_mfma_f32_16x16x32_bf16 v[152:155], a[136:139], v[120:123], v[152:155]
  v_lshlrev_b32 v25, 7, v1
  v_mov_b32 v245, v241
  s_nop 0
  v_permlane16_swap_b32 v240, v244
  v_mfma_f32_16x16x32_bf16 v[152:155], a[132:135], v[116:119], v[152:155]
  s_mov_b32 s38, s42
  v_permlane16_swap_b32 v241, v245
  v_max_f32 v240, v240, v244
  v_max_f32 v241, v241, v245
  v_mfma_f32_16x16x32_bf16 v[152:155], a[128:131], v[112:115], v[152:155]
  s_lshl_b32 s38, s38, 3
  buffer_load_dwordx4 v2, s[12:15], s46 offen offset:0 sc1 lds
  v_mov_b32 v244, v240
  v_mov_b32 v245, v241
  s_nop 0
  v_mfma_f32_16x16x32_bf16 v[156:159], a[144:147], v[112:115], 0
  s_add_u32 s38, s38, s40
  v_permlane32_swap_b32 v240, v244
  v_permlane32_swap_b32 v241, v245
  v_max_f32 v240, v240, v244
  v_mfma_f32_16x16x32_bf16 v[156:159], a[148:151], v[116:119], v[156:159]
  s_lshl_b32 s38, s38, 17
  v_max_f32 v241, v241, v245
  v_sub_f32 v44, 0, v240
  v_sub_f32 v128, v128, v240
  v_mfma_f32_16x16x32_bf16 v[156:159], a[152:155], v[120:123], v[156:159]
  s_lshl_b32 s39, s41, 12
  v_sub_f32 v129, v129, v240
  v_sub_f32 v130, v130, v240
  v_sub_f32 v131, v131, v240
  v_mfma_f32_16x16x32_bf16 v[156:159], a[156:159], v[124:127], v[156:159]
  s_add_u32 s38, s38, s39
  v_sub_f32 v132, v132, v240
  v_sub_f32 v133, v133, v240
  v_sub_f32 v134, v134, v240
  v_mfma_f32_16x16x32_bf16 v[148:151], a[156:159], v[108:111], 0
  s_add_u32 s38, s38, 33554432
  v_sub_f32 v135, v135, v240
  v_mov_b32 v208, v44
  v_mov_b32 v209, v44
  v_mfma_f32_16x16x32_bf16 v[148:151], a[152:155], v[104:107], v[148:151]
  s_add_u32 s39, s38, 524288
  v_mov_b32 v210, v44
  v_mov_b32 v211, v44
  v_mov_b32 v212, v44
  v_mfma_f32_16x16x32_bf16 v[148:151], a[148:151], v[100:103], v[148:151]
  v_mov_b32 v20, -1
  v_mov_b32 v213, v44
  v_mov_b32 v214, v44
  v_mov_b32 v215, v44
  v_mfma_f32_16x16x32_bf16 v[148:151], a[144:147], v[96:99], v[148:151]
  s_waitcnt lgkmcnt(4)
  v_sub_f32 v45, 0, v241
  v_sub_f32 v136, v136, v241
  v_sub_f32 v137, v137, v241
  v_sub_f32 v138, v138, v241
  v_sub_f32 v139, v139, v241
  v_sub_f32 v140, v140, v241
  v_sub_f32 v141, v141, v241
  v_sub_f32 v142, v142, v241
  v_sub_f32 v143, v143, v241
  v_mov_b32 v216, v45
  v_mov_b32 v217, v45
  v_mov_b32 v218, v45
  v_mov_b32 v219, v45
  v_mov_b32 v220, v45
  v_mov_b32 v221, v45
  v_mov_b32 v222, v45
  v_mov_b32 v223, v45
  v_exp_f32 v32, v128
  v_exp_f32 v33, v129
  v_exp_f32 v34, v130
  v_cvt_pk_bf16_f32 v192, v32, v33
  v_exp_f32 v35, v131
  v_exp_f32 v32, v132
  v_cvt_pk_bf16_f32 v193, v34, v35
  v_exp_f32 v33, v133
  v_exp_f32 v34, v134
  v_cvt_pk_bf16_f32 v194, v32, v33
  v_exp_f32 v35, v135
  v_exp_f32 v32, v136
  v_cvt_pk_bf16_f32 v195, v34, v35
  v_exp_f32 v33, v137
  v_exp_f32 v34, v138
  v_cvt_pk_bf16_f32 v196, v32, v33
  v_exp_f32 v35, v139
  s_nop 0
  v_cvt_pk_bf16_f32 v197, v34, v35
  v_mfma_f32_16x16x32_bf16 v[56:59], a[224:227], v[192:195], 0
  v_max3_f32 v242, v144, v145, v146
  v_max3_f32 v242, v242, v147, v148
  v_max3_f32 v242, v242, v149, v150
  v_max_f32 v242, v242, v151
  v_max3_f32 v243, v152, v153, v154
  v_max3_f32 v243, v243, v155, v156
  v_max3_f32 v243, v243, v157, v158
  v_max_f32 v243, v243, v159
  v_mov_b32 v244, v242
  v_mov_b32 v245, v243
  s_nop 0
  v_permlane16_swap_b32 v242, v244
  v_permlane16_swap_b32 v243, v245
  v_max_f32 v242, v242, v244
  v_max_f32 v243, v243, v245
  v_mov_b32 v244, v242
  v_mov_b32 v245, v243
  s_nop 0
  v_permlane32_swap_b32 v242, v244
  v_permlane32_swap_b32 v243, v245
  v_max_f32 v242, v242, v244
  v_max_f32 v243, v243, v245
  v_sub_f32 v46, 0, v242
  v_sub_f32 v144, v144, v242
  v_sub_f32 v145, v145, v242
  v_sub_f32 v146, v146, v242
  v_sub_f32 v147, v147, v242
  v_sub_f32 v148, v148, v242
  v_sub_f32 v149, v149, v242
  v_sub_f32 v150, v150, v242
  v_sub_f32 v151, v151, v242
  v_sub_f32 v47, 0, v243
  v_sub_f32 v152, v152, v243
  v_sub_f32 v153, v153, v243
  v_sub_f32 v154, v154, v243
  v_sub_f32 v155, v155, v243
  v_sub_f32 v156, v156, v243
  v_sub_f32 v157, v157, v243
  v_sub_f32 v158, v158, v243
  v_sub_f32 v159, v159, v243
  v_add_f32 v37, v36, v56
  v_mfma_f32_16x16x32_bf16 v[160:163], a[160:163], v[64:67], v[208:211]
  v_mov_b32 v21, -1
  buffer_load_dwordx4 v2, s[12:15], s46 offen offset:1024 sc1 lds
  v_exp_f32 v32, v140
  v_mfma_f32_16x16x32_bf16 v[160:163], a[164:167], v[68:71], v[160:163]
  v_mov_b32 v22, -1
  buffer_load_dwordx4 v2, s[12:15], s46 offen offset:2048 sc1 lds
  v_mov_b32 v224, v46
  v_mov_b32 v225, v46
  v_mfma_f32_16x16x32_bf16 v[160:163], a[168:171], v[72:75], v[160:163]
  v_mov_b32 v23, -1
  v_exp_f32 v33, v141
  v_mfma_f32_16x16x32_bf16 v[160:163], a[172:175], v[76:79], v[160:163]
  s_lshr_b32 s72, s43, 2
  v_cvt_pk_bf16_f32 v198, v32, v33
  v_mov_b32 v226, v46
  v_mov_b32 v227, v46
  v_mfma_f32_16x16x32_bf16 v[168:171], a[172:175], v[92:95], v[216:219]
  s_sub_u32 s73, 15, s42
  v_exp_f32 v34, v142
  v_mfma_f32_16x16x32_bf16 v[168:171], a[168:171], v[88:91], v[168:171]
  s_cmp_eq_u32 s72, 0
  s_cselect_b32 s72, s42, s73
  v_mov_b32 v228, v46
  v_mov_b32 v229, v46
  v_mfma_f32_16x16x32_bf16 v[168:171], a[164:167], v[84:87], v[168:171]
  s_lshl_b32 s72, s72, 2
  buffer_load_dwordx4 v2, s[12:15], s46 offen offset:3072 sc1 lds
  v_exp_f32 v35, v143
  v_mfma_f32_16x16x32_bf16 v[168:171], a[160:163], v[80:83], v[168:171]
  s_waitcnt lgkmcnt(0)
  v_cvt_pk_bf16_f32 v199, v34, v35
  v_mov_b32 v230, v46
  v_mov_b32 v231, v46
  v_mfma_f32_16x16x32_bf16 v[172:175], a[176:179], v[80:83], v[220:223]
  s_add_u32 s46, s46, 28672
  ds_read_b128 a[192:195], v52 offset:8192
  ds_read_b128 a[196:199], v52 offset:9216
  ds_read_b128 a[200:203], v52 offset:10240
  v_mfma_f32_16x16x32_bf16 v[60:63], a[224:227], v[196:199], 0
  s_xor_b32 s48, s48, 32768
  ds_read_b128 a[204:207], v52 offset:11264
  v_mov_b32 v232, v47
  v_mov_b32 v233, v47
  v_mfma_f32_16x16x32_bf16 v[172:175], a[180:183], v[84:87], v[172:175]
  s_add_u32 m0, s53, s47
  v_exp_f32 v32, v144
  v_mfma_f32_16x16x32_bf16 v[172:175], a[184:187], v[88:91], v[172:175]
  s_add_u32 s72, s72, s44
  v_add_f32 v39, v38, v60
  v_max_f32 v48, v37, v39
  v_mov_b32 v234, v47
  v_mov_b32 v235, v47
  v_mfma_f32_16x16x32_bf16 v[172:175], a[188:191], v[92:95], v[172:175]
  s_lshl_b32 s72, s72, 2
  buffer_load_dwordx4 v53, s[8:11], s45 offen offset:0 sc1 lds
  v_exp_f32 v33, v145
  v_mfma_f32_16x16x32_bf16 v[164:167], a[188:191], v[76:79], v[212:215]
  s_and_b32 s73, s43, 3
  v_cmp_lt_f32 vcc, v49, v48
  v_cvt_pk_bf16_f32 v200, v32, v33
  v_mov_b32 v236, v47
  v_mov_b32 v237, v47
  v_mfma_f32_16x16x32_bf16 v[164:167], a[184:187], v[72:75], v[164:167]
  s_add_u32 s72, s72, s73
  v_exp_f32 v34, v146
  v_mov_b32 v238, v47
  v_mov_b32 v239, v47
  v_mfma_f32_16x16x32_bf16 v[164:167], a[180:183], v[68:71], v[164:167]
  s_cmp_lg_u64 vcc, 0
  ds_read_b128 a[208:211], v52 offset:12288
  ds_read_b128 a[212:215], v52 offset:13312
  v_mfma_f32_16x16x32_bf16 v[164:167], a[176:179], v[64:67], v[164:167]
  s_cbranch_scc1 Lrare40
Lrr41:
  v_exp_f32 v35, v147
  v_mfma_f32_16x16x32_bf16 v[176:179], a[160:163], v[96:99], v[224:227]
  s_lshl_b32 s70, s72, 15
  ds_read_b128 a[216:219], v52 offset:14336
  v_cvt_pk_bf16_f32 v201, v34, v35
  v_mfma_f32_16x16x32_bf16 v[176:179], a[164:167], v[100:103], v[176:179]
  s_lshl_b32 s72, s40, 13
  v_exp_f32 v32, v148
  v_mfma_f32_16x16x32_bf16 v[176:179], a[168:171], v[104:107], v[176:179]
  s_add_u32 s70, s70, s72
  ds_read_b128 a[220:223], v52 offset:15360
  buffer_load_dwordx4 v54, s[8:11], s45 offen offset:1024 sc1 lds
  v_mfma_f32_16x16x32_bf16 v[176:179], a[172:175], v[108:111], v[176:179]
  s_add_u32 s70, s70, 67108864
  v_exp_f32 v33, v149
  v_mfma_f32_16x16x32_bf16 v[184:187], a[172:175], v[124:127], v[232:235]
  s_mov_b32 s87, s70
  v_cvt_pk_bf16_f32 v202, v32, v33
  v_mfma_f32_16x16x32_bf16 v[184:187], a[168:171], v[120:123], v[184:187]
  s_lshr_b32 s72, s43, 2
  v_exp_f32 v34, v150
  v_mfma_f32_16x16x32_bf16 v[184:187], a[164:167], v[116:119], v[184:187]
  s_sub_u32 s73, 15, s42
  buffer_load_dwordx4 v55, s[8:11], s45 offen offset:2048 sc1 lds
  v_mfma_f32_16x16x32_bf16 v[184:187], a[160:163], v[112:115], v[184:187]
  s_cmp_eq_u32 s72, 0
  s_cselect_b32 s72, s42, s73
  v_exp_f32 v35, v151
  v_mfma_f32_16x16x32_bf16 v[188:191], a[176:179], v[112:115], v[236:239]
  s_lshl_b32 s72, s72, 2
  v_cvt_pk_bf16_f32 v203, v34, v35
  v_mfma_f32_16x16x32_bf16 v[188:191], a[180:183], v[116:119], v[188:191]
  s_add_u32 s72, s72, s40
  v_exp_f32 v32, v152
  v_mfma_f32_16x16x32_bf16 v[56:59], a[224:227], v[200:203], 0
  s_mul_i32 s72, s72, 88064
  buffer_load_dwordx4 v30, s[8:11], s45 offen offset:3072 sc1 lds
  v_mfma_f32_16x16x32_bf16 v[188:191], a[184:187], v[120:123], v[188:191]
  s_add_u32 m0, m0, 4096
  v_exp_f32 v33, v153
  v_mfma_f32_16x16x32_bf16 v[188:191], a[188:191], v[124:127], v[188:191]
  s_add_u32 s45, s45, s100
  v_cvt_pk_bf16_f32 v204, v32, v33
  v_mfma_f32_16x16x32_bf16 v[180:183], a[188:191], v[108:111], v[228:231]
  s_and_b32 s73, s43, 3
  v_exp_f32 v34, v154
  v_mfma_f32_16x16x32_bf16 v[180:183], a[184:187], v[104:107], v[180:183]
  s_lshl_b32 s73, s73, 2
  v_add_f32 v41, v40, v56
  v_mfma_f32_16x16x32_bf16 v[180:183], a[180:183], v[100:103], v[180:183]
  s_add_u32 s73, s73, s44
  v_exp_f32 v35, v155
  v_mfma_f32_16x16x32_bf16 v[180:183], a[176:179], v[96:99], v[180:183]
  s_waitcnt lgkmcnt(4)
  buffer_load_dwordx4 v53, s[8:11], s45 offen offset:0 sc1 lds
  v_cvt_pk_bf16_f32 v205, v34, v35
  v_mfma_f32_16x16x32_bf16 a[0:3], a[192:195], v[192:195], 0
  s_mul_i32 s73, s73, 3072
  v_exp_f32 v32, v156
  v_mfma_f32_16x16x32_bf16 a[32:35], a[192:195], v[196:199], 0
  s_min_u32 s73, s73, 40960
  v_mfma_f32_16x16x32_bf16 a[36:39], a[196:199], v[196:199], 0
  s_add_u32 s72, s72, s73
  v_exp_f32 v33, v157
  v_mfma_f32_16x16x32_bf16 a[4:7], a[196:199], v[192:195], 0
  s_add_u32 s88, s72, 56623104
  ds_read_b128 a[160:163], v51 offset:16384
  v_cvt_pk_bf16_f32 v206, v32, v33
  v_mfma_f32_16x16x32_bf16 a[8:11], a[200:203], v[192:195], 0
  v_lshrrev_b32 v26, 5, v1
  v_exp_f32 v34, v158
  v_mfma_f32_16x16x32_bf16 a[40:43], a[200:203], v[196:199], 0
  v_mul_u32_u24 v26, 43520, v26
  ds_read_b128 a[164:167], v51 offset:17408
  ds_read_b128 a[168:171], v51 offset:18432
  v_mfma_f32_16x16x32_bf16 a[44:47], a[204:207], v[196:199], 0
  v_add_u32 v26, v26, v2
  v_exp_f32 v35, v159
  v_mfma_f32_16x16x32_bf16 a[12:15], a[204:207], v[192:195], 0
  s_waitcnt lgkmcnt(3)
  ds_read_b128 a[172:175], v51 offset:19456
  v_cvt_pk_bf16_f32 v207, v34, v35
  v_mfma_f32_16x16x32_bf16 a[16:19], a[208:211], v[192:195], 0
  s_lshr_b32 s72, s43, 2
  buffer_load_dwordx4 v54, s[8:11], s45 offen offset:1024 sc1 lds
  v_mfma_f32_16x16x32_bf16 v[60:63], a[224:227], v[204:207], 0
  s_sub_u32 s73, 15, s42
  buffer_load_dwordx4 v55, s[8:11], s45 offen offset:2048 sc1 lds
  v_mfma_f32_16x16x32_bf16 a[48:51], a[208:211], v[196:199], 0
  s_cmp_eq_u32 s72, 0
  s_cselect_b32 s72, s42, s73
  v_exp_f32 v32, v160
  v_mfma_f32_16x16x32_bf16 a[52:55], a[212:215], v[196:199], 0
  s_lshl_b32 s72, s72, 1
  v_add_f32 v43, v42, v60
  v_max_f32 v48, v41, v43
  v_mfma_f32_16x16x32_bf16 a[20:23], a[212:215], v[192:195], 0
  s_lshr_b32 s73, s40, 1
  v_exp_f32 v33, v161
  v_mfma_f32_16x16x32_bf16 a[24:27], a[216:219], v[192:195], 0
  s_add_u32 s72, s72, s73
  v_cmp_lt_f32 vcc, v49, v48
  v_cvt_pk_bf16_f32 v248, v32, v33
  v_mfma_f32_16x16x32_bf16 a[56:59], a[216:219], v[196:199], 0
  s_lshl_b32 s86, s72, 10
  v_exp_f32 v34, v162
  v_mfma_f32_16x16x32_bf16 a[60:63], a[220:223], v[196:199], 0
  s_cmp_lg_u64 vcc, 0
  ds_read_b128 a[176:179], v51 offset:20480
  ds_read_b128 a[180:183], v51 offset:21504
  v_mfma_f32_16x16x32_bf16 a[28:31], a[220:223], v[192:195], 0
  s_cbranch_scc1 Lrare42
Lrr43:
  v_exp_f32 v35, v163
  v_mfma_f32_16x16x32_bf16 a[64:67], a[192:195], v[200:203], 0
  s_and_b32 s72, s43, 3
  ds_read_b128 a[184:187], v51 offset:22528
  v_cvt_pk_bf16_f32 v249, v34, v35
  v_mfma_f32_16x16x32_bf16 a[96:99], a[192:195], v[204:207], 0
  s_lshl_b32 s72, s72, 8
  v_exp_f32 v32, v164
  v_mfma_f32_16x16x32_bf16 a[100:103], a[196:199], v[204:207], 0
  s_add_u32 s86, s86, s72
  ds_read_b128 a[188:191], v51 offset:23552
  buffer_load_dwordx4 v30, s[8:11], s45 offen offset:3072 sc1 lds
  v_mfma_f32_16x16x32_bf16 a[68:71], a[196:199], v[200:203], 0
  s_add_u32 s45, s45, s101
  v_exp_f32 v33, v165
  v_mfma_f32_16x16x32_bf16 a[72:75], a[200:203], v[200:203], 0
  s_waitcnt vmcnt(16)
  v_cmp_ne_u32 vcc, 1, v28
  s_cbranch_vccz Lspok53
  s_mov_b32 s5, 0
Lspin52:
  s_sleep 16
  buffer_load_dword v28, v29, s[20:23], s55 offen sc1
  s_add_u32 s5, s5, 1
  s_waitcnt vmcnt(0)
  v_cmp_ne_u32 vcc, 1, v28
  s_cbranch_vccz Lspok53
  s_cmp_lt_u32 s5, 0x10000
  s_cbranch_scc1 Lspin52
Lspok53:
  v_cvt_pk_bf16_f32 v250, v32, v33
  v_mfma_f32_16x16x32_bf16 a[104:107], a[200:203], v[204:207], 0
  s_add_u32 m0, s54, s47
  v_exp_f32 v34, v166
  v_mfma_f32_16x16x32_bf16 a[108:111], a[204:207], v[204:207], 0
  s_lshr_b32 s72, s44, 1
  buffer_load_dwordx4 v53, s[8:11], s45 offen offset:0 sc1 lds
  v_mfma_f32_16x16x32_bf16 a[76:79], a[204:207], v[200:203], 0
  s_lshl_b32 s72, s72, 7
  v_exp_f32 v35, v167
  v_mfma_f32_16x16x32_bf16 a[80:83], a[208:211], v[200:203], 0
  s_add_u32 s86, s86, s72
  buffer_load_dwordx4 v54, s[8:11], s45 offen offset:1024 sc1 lds
  v_cvt_pk_bf16_f32 v251, v34, v35
  v_mfma_f32_16x16x32_bf16 a[112:115], a[208:211], v[204:207], 0
  s_and_b32 s72, s44, 1
  v_exp_f32 v32, v168
  v_mfma_f32_16x16x32_bf16 v[56:59], a[224:227], v[248:251], 0
  s_lshl_b32 s72, s72, 3
  v_mfma_f32_16x16x32_bf16 a[116:119], a[212:215], v[204:207], 0
  s_add_u32 s86, s86, s72
  v_exp_f32 v33, v169
  v_mfma_f32_16x16x32_bf16 a[84:87], a[212:215], v[200:203], 0
  s_and_b32 s72, s40, 1
  v_cvt_pk_bf16_f32 v252, v32, v33
  v_mfma_f32_16x16x32_bf16 a[88:91], a[216:219], v[200:203], 0
  s_lshl_b32 s72, s72, 2
  v_exp_f32 v34, v170
  v_mfma_f32_16x16x32_bf16 a[120:123], a[216:219], v[204:207], 0
  s_add_u32 s86, s86, s72
  buffer_load_dwordx4 v55, s[8:11], s45 offen offset:2048 sc1 lds
  v_add_f32 v36, v37, v56
  v_mfma_f32_16x16x32_bf16 a[124:127], a[220:223], v[204:207], 0
  s_add_u32 s86, s86, 65142784
  v_exp_f32 v35, v171
  v_mfma_f32_16x16x32_bf16 a[92:95], a[220:223], v[200:203], 0
  s_waitcnt lgkmcnt(4)
  v_cvt_pk_bf16_f32 v253, v34, v35
  v_mfma_f32_16x16x32_bf16 v[128:131], a[160:163], v[64:67], v[208:211]
  v_exp_f32 v32, v172
  v_mfma_f32_16x16x32_bf16 v[128:131], a[164:167], v[68:71], v[128:131]
  buffer_load_dwordx4 v30, s[8:11], s45 offen offset:3072 sc1 lds
  v_mfma_f32_16x16x32_bf16 v[128:131], a[168:171], v[72:75], v[128:131]
  s_add_u32 m0, m0, 4096
  v_exp_f32 v33, v173
  v_mfma_f32_16x16x32_bf16 v[128:131], a[172:175], v[76:79], v[128:131]
  s_add_u32 s45, s45, s100
  ds_read_b128 a[192:195], v52 offset:16384
  v_cvt_pk_bf16_f32 v254, v32, v33
  v_mfma_f32_16x16x32_bf16 v[136:139], a[172:175], v[92:95], v[216:219]
  v_exp_f32 v34, v174
  v_mfma_f32_16x16x32_bf16 v[136:139], a[168:171], v[88:91], v[136:139]
  ds_read_b128 a[196:199], v52 offset:17408
  v_mfma_f32_16x16x32_bf16 v[136:139], a[164:167], v[84:87], v[136:139]
  v_exp_f32 v35, v175
  v_mfma_f32_16x16x32_bf16 v[136:139], a[160:163], v[80:83], v[136:139]
  s_waitcnt lgkmcnt(2)
  ds_read_b128 a[200:203], v52 offset:18432
  v_cvt_pk_bf16_f32 v255, v34, v35
  v_mfma_f32_16x16x32_bf16 v[140:143], a[176:179], v[80:83], v[220:223]
  ds_read_b128 a[204:207], v52 offset:19456
  buffer_load_dwordx4 v53, s[8:11], s45 offen offset:0 sc1 lds
  v_mfma_f32_16x16x32_bf16 v[60:63], a[224:227], v[252:255], 0
  v_mfma_f32_16x16x32_bf16 v[140:143], a[180:183], v[84:87], v[140:143]
  s_mov_b64 exec, 1
  buffer_store_dword v20, off, s[20:23], s86 sc1
  s_mov_b64 exec, -1
  v_exp_f32 v32, v176
  v_mfma_f32_16x16x32_bf16 v[140:143], a[184:187], v[88:91], v[140:143]
  v_add_f32 v38, v39, v60
  v_max_f32 v48, v36, v38
  v_mfma_f32_16x16x32_bf16 v[140:143], a[188:191], v[92:95], v[140:143]
  buffer_load_dwordx4 v54, s[8:11], s45 offen offset:1024 sc1 lds
  v_exp_f32 v33, v177
  v_mfma_f32_16x16x32_bf16 v[132:135], a[188:191], v[76:79], v[212:215]
  v_cmp_lt_f32 vcc, v49, v48
  v_cvt_pk_bf16_f32 v200, v32, v33
  v_mfma_f32_16x16x32_bf16 v[132:135], a[184:187], v[72:75], v[132:135]
  v_exp_f32 v34, v178
  v_mfma_f32_16x16x32_bf16 v[132:135], a[180:183], v[68:71], v[132:135]
  s_cmp_lg_u64 vcc, 0
  ds_read_b128 a[208:211], v52 offset:20480
  ds_read_b128 a[212:215], v52 offset:21504
  v_mfma_f32_16x16x32_bf16 v[132:135], a[176:179], v[64:67], v[132:135]
  s_cbranch_scc1 Lrare44
Lrr45:
  v_exp_f32 v35, v179
  v_mfma_f32_16x16x32_bf16 v[144:147], a[160:163], v[96:99], v[224:227]
  ds_read_b128 a[216:219], v52 offset:22528
  v_cvt_pk_bf16_f32 v201, v34, v35
  v_mfma_f32_16x16x32_bf16 v[144:147], a[164:167], v[100:103], v[144:147]
  v_exp_f32 v32, v180
  v_mfma_f32_16x16x32_bf16 v[144:147], a[168:171], v[104:107], v[144:147]
  ds_read_b128 a[220:223], v52 offset:23552
  buffer_load_dwordx4 v55, s[8:11], s45 offen offset:2048 sc1 lds
  v_mfma_f32_16x16x32_bf16 v[144:147], a[172:175], v[108:111], v[144:147]
  v_exp_f32 v33, v181
  v_mfma_f32_16x16x32_bf16 v[152:155], a[172:175], v[124:127], v[232:235]
  v_cvt_pk_bf16_f32 v202, v32, v33
  v_mfma_f32_16x16x32_bf16 v[152:155], a[168:171], v[120:123], v[152:155]
  v_exp_f32 v34, v182
  v_mfma_f32_16x16x32_bf16 v[152:155], a[164:167], v[116:119], v[152:155]
  buffer_load_dwordx4 v30, s[8:11], s45 offen offset:3072 sc1 lds
  buffer_store_dwordx4 v[20:23], v2, s[20:23], s87 offen sc1
  v_mfma_f32_16x16x32_bf16 v[152:155], a[160:163], v[112:115], v[152:155]
  s_add_u32 s45, s45, s101
  v_exp_f32 v35, v183
  v_mfma_f32_16x16x32_bf16 v[156:159], a[176:179], v[112:115], v[236:239]
  v_cvt_pk_bf16_f32 v203, v34, v35
  v_mfma_f32_16x16x32_bf16 v[156:159], a[180:183], v[116:119], v[156:159]
  v_exp_f32 v32, v184
  v_mfma_f32_16x16x32_bf16 v[56:59], a[224:227], v[200:203], 0
  v_mfma_f32_16x16x32_bf16 v[156:159], a[184:187], v[120:123], v[156:159]
  v_exp_f32 v33, v185
  v_mfma_f32_16x16x32_bf16 v[156:159], a[188:191], v[124:127], v[156:159]
  v_cvt_pk_bf16_f32 v204, v32, v33
  v_mfma_f32_16x16x32_bf16 v[148:151], a[188:191], v[108:111], v[228:231]
  v_exp_f32 v34, v186
  v_mfma_f32_16x16x32_bf16 v[148:151], a[184:187], v[104:107], v[148:151]
  v_add_f32 v40, v41, v56
  v_mfma_f32_16x16x32_bf16 v[148:151], a[180:183], v[100:103], v[148:151]
  v_exp_f32 v35, v187
  v_mfma_f32_16x16x32_bf16 v[148:151], a[176:179], v[96:99], v[148:151]
  s_waitcnt lgkmcnt(4)
  v_cvt_pk_bf16_f32 v205, v34, v35
  v_mfma_f32_16x16x32_bf16 a[0:3], a[192:195], v[248:251], a[0:3]
  v_exp_f32 v32, v188
  v_mfma_f32_16x16x32_bf16 a[32:35], a[192:195], v[252:255], a[32:35]
  buffer_store_dwordx4 v[20:23], v26, s[20:23], s88 offen sc1
  v_mfma_f32_16x16x32_bf16 a[36:39], a[196:199], v[252:255], a[36:39]
  s_add_u32 s87, s87, 1024
  v_exp_f32 v33, v189
  v_mfma_f32_16x16x32_bf16 a[4:7], a[196:199], v[248:251], a[4:7]
  s_add_u32 s88, s88, 512
  ds_read_b128 a[160:163], v51 offset:24576
  v_cvt_pk_bf16_f32 v206, v32, v33
  v_mfma_f32_16x16x32_bf16 a[8:11], a[200:203], v[248:251], a[8:11]
  v_exp_f32 v34, v190
  v_mfma_f32_16x16x32_bf16 a[40:43], a[200:203], v[252:255], a[40:43]
  ds_read_b128 a[164:167], v51 offset:25600
  ds_read_b128 a[168:171], v51 offset:26624
  v_mfma_f32_16x16x32_bf16 a[44:47], a[204:207], v[252:255], a[44:47]
  v_exp_f32 v35, v191
  v_mfma_f32_16x16x32_bf16 a[12:15], a[204:207], v[248:251], a[12:15]
  s_waitcnt lgkmcnt(3)
  ds_read_b128 a[172:175], v51 offset:27648
  v_cvt_pk_bf16_f32 v207, v34, v35
  v_mfma_f32_16x16x32_bf16 a[16:19], a[208:211], v[248:251], a[16:19]
  v_mfma_f32_16x16x32_bf16 v[60:63], a[224:227], v[204:207], 0
  v_mfma_f32_16x16x32_bf16 a[48:51], a[208:211], v[252:255], a[48:51]
  v_exp_f32 v32, v128
  v_mfma_f32_16x16x32_bf16 a[52:55], a[212:215], v[252:255], a[52:55]
  v_add_f32 v42, v43, v60
  v_max_f32 v48, v40, v42
  v_mfma_f32_16x16x32_bf16 a[20:23], a[212:215], v[248:251], a[20:23]
  v_exp_f32 v33, v129
  v_mfma_f32_16x16x32_bf16 a[24:27], a[216:219], v[248:251], a[24:27]
  v_cmp_lt_f32 vcc, v49, v48
  v_cvt_pk_bf16_f32 v192, v32, v33
  v_mfma_f32_16x16x32_bf16 a[56:59], a[216:219], v[252:255], a[56:59]
  v_exp_f32 v34, v130
  v_mfma_f32_16x16x32_bf16 a[60:63], a[220:223], v[252:255], a[60:63]
  s_cmp_lg_u64 vcc, 0
  ds_read_b128 a[176:179], v51 offset:28672
  ds_read_b128 a[180:183], v51 offset:29696
  v_mfma_f32_16x16x32_bf16 a[28:31], a[220:223], v[248:251], a[28:31]
  s_cbranch_scc1 Lrare46
Lrr47:
  v_exp_f32 v35, v131
  v_mfma_f32_16x16x32_bf16 a[64:67], a[192:195], v[200:203], a[64:67]
  ds_read_b128 a[184:187], v51 offset:30720
  v_cvt_pk_bf16_f32 v193, v34, v35
  v_mfma_f32_16x16x32_bf16 a[96:99], a[192:195], v[204:207], a[96:99]
  v_exp_f32 v32, v132
  v_mfma_f32_16x16x32_bf16 a[100:103], a[196:199], v[204:207], a[100:103]
  ds_read_b128 a[188:191], v51 offset:31744
  buffer_store_dwordx4 v[20:23], v2, s[20:23], s87 offen sc1
  v_mfma_f32_16x16x32_bf16 a[68:71], a[196:199], v[200:203], a[68:71]
  v_exp_f32 v33, v133
  v_mfma_f32_16x16x32_bf16 a[72:75], a[200:203], v[200:203], a[72:75]
  v_cvt_pk_bf16_f32 v194, v32, v33
  v_mfma_f32_16x16x32_bf16 a[104:107], a[200:203], v[204:207], a[104:107]
  v_exp_f32 v34, v134
  v_mfma_f32_16x16x32_bf16 a[108:111], a[204:207], v[204:207], a[108:111]
  v_mfma_f32_16x16x32_bf16 a[76:79], a[204:207], v[200:203], a[76:79]
  v_exp_f32 v35, v135
  v_mfma_f32_16x16x32_bf16 a[80:83], a[208:211], v[200:203], a[80:83]
  v_cvt_pk_bf16_f32 v195, v34, v35
  v_mfma_f32_16x16x32_bf16 a[112:115], a[208:211], v[204:207], a[112:115]
  v_exp_f32 v32, v136
  v_mfma_f32_16x16x32_bf16 v[56:59], a[224:227], v[192:195], 0
  v_mfma_f32_16x16x32_bf16 a[116:119], a[212:215], v[204:207], a[116:119]
  v_exp_f32 v33, v137
  v_mfma_f32_16x16x32_bf16 a[84:87], a[212:215], v[200:203], a[84:87]
  v_cvt_pk_bf16_f32 v196, v32, v33
  v_mfma_f32_16x16x32_bf16 a[88:91], a[216:219], v[200:203], a[88:91]
  v_exp_f32 v34, v138
  v_mfma_f32_16x16x32_bf16 a[120:123], a[216:219], v[204:207], a[120:123]
  buffer_store_dwordx4 v[20:23], v26, s[20:23], s88 offen sc1
  v_add_f32 v37, v36, v56
  v_mfma_f32_16x16x32_bf16 a[124:127], a[220:223], v[204:207], a[124:127]
  s_add_u32 s87, s87, 1024
  v_exp_f32 v35, v139
  v_mfma_f32_16x16x32_bf16 a[92:95], a[220:223], v[200:203], a[92:95]
  s_waitcnt lgkmcnt(4)
  v_cvt_pk_bf16_f32 v197, v34, v35
  v_mfma_f32_16x16x32_bf16 v[160:163], a[160:163], v[64:67], v[208:211]
  s_add_u32 s88, s88, 512
  v_exp_f32 v32, v140
  v_mfma_f32_16x16x32_bf16 v[160:163], a[164:167], v[68:71], v[160:163]
  v_mfma_f32_16x16x32_bf16 v[160:163], a[168:171], v[72:75], v[160:163]
  v_exp_f32 v33, v141
  v_mfma_f32_16x16x32_bf16 v[160:163], a[172:175], v[76:79], v[160:163]
  ds_read_b128 a[192:195], v52 offset:24576
  v_cvt_pk_bf16_f32 v198, v32, v33
  v_mfma_f32_16x16x32_bf16 v[168:171], a[172:175], v[92:95], v[216:219]
  v_exp_f32 v34, v142
  v_mfma_f32_16x16x32_bf16 v[168:171], a[168:171], v[88:91], v[168:171]
  ds_read_b128 a[196:199], v52 offset:25600
  v_mfma_f32_16x16x32_bf16 v[168:171], a[164:167], v[84:87], v[168:171]
  v_exp_f32 v35, v143
  v_mfma_f32_16x16x32_bf16 v[168:171], a[160:163], v[80:83], v[168:171]
  s_waitcnt lgkmcnt(2)
  ds_read_b128 a[200:203], v52 offset:26624
  v_cvt_pk_bf16_f32 v199, v34, v35
  v_mfma_f32_16x16x32_bf16 v[172:175], a[176:179], v[80:83], v[220:223]
  ds_read_b128 a[204:207], v52 offset:27648
  v_mfma_f32_16x16x32_bf16 v[60:63], a[224:227], v[196:199], 0
  v_mfma_f32_16x16x32_bf16 v[172:175], a[180:183], v[84:87], v[172:175]
  v_exp_f32 v32, v144
  v_mfma_f32_16x16x32_bf16 v[172:175], a[184:187], v[88:91], v[172:175]
  v_add_f32 v39, v38, v60
  v_max_f32 v48, v37, v39
  v_mfma_f32_16x16x32_bf16 v[172:175], a[188:191], v[92:95], v[172:175]
  buffer_store_dwordx4 v[20:23], v2, s[20:23], s87 offen sc1
  v_exp_f32 v33, v145
  v_mfma_f32_16x16x32_bf16 v[164:167], a[188:191], v[76:79], v[212:215]
  v_cmp_lt_f32 vcc, v49, v48
  v_cvt_pk_bf16_f32 v200, v32, v33
  v_mfma_f32_16x16x32_bf16 v[164:167], a[184:187], v[72:75], v[164:167]
  v_exp_f32 v34, v146
  v_mfma_f32_16x16x32_bf16 v[164:167], a[180:183], v[68:71], v[164:167]
  s_cmp_lg_u64 vcc, 0
  ds_read_b128 a[208:211], v52 offset:28672
  ds_read_b128 a[212:215], v52 offset:29696
  v_mfma_f32_16x16x32_bf16 v[164:167], a[176:179], v[64:67], v[164:167]
  s_cbranch_scc1 Lrare48
Lrr49:
  v_exp_f32 v35, v147
  v_mfma_f32_16x16x32_bf16 v[176:179], a[160:163], v[96:99], v[224:227]
  ds_read_b128 a[216:219], v52 offset:30720
  v_cvt_pk_bf16_f32 v201, v34, v35
  v_mfma_f32_16x16x32_bf16 v[176:179], a[164:167], v[100:103], v[176:179]
  v_exp_f32 v32, v148
  v_mfma_f32_16x16x32_bf16 v[176:179], a[168:171], v[104:107], v[176:179]
  ds_read_b128 a[220:223], v52 offset:31744
  v_mfma_f32_16x16x32_bf16 v[176:179], a[172:175], v[108:111], v[176:179]
  v_exp_f32 v33, v149
  v_mfma_f32_16x16x32_bf16 v[184:187], a[172:175], v[124:127], v[232:235]
  v_cvt_pk_bf16_f32 v202, v32, v33
  v_mfma_f32_16x16x32_bf16 v[184:187], a[168:171], v[120:123], v[184:187]
  v_exp_f32 v34, v150
  v_mfma_f32_16x16x32_bf16 v[184:187], a[164:167], v[116:119], v[184:187]
  v_mfma_f32_16x16x32_bf16 v[184:187], a[160:163], v[112:115], v[184:187]
  v_exp_f32 v35, v151
  v_mfma_f32_16x16x32_bf16 v[188:191], a[176:179], v[112:115], v[236:239]
  buffer_store_dwordx4 v[20:23], v26, s[20:23], s88 offen sc1
  v_cvt_pk_bf16_f32 v203, v34, v35
  v_mfma_f32_16x16x32_bf16 v[188:191], a[180:183], v[116:119], v[188:191]
  s_add_u32 s87, s87, 1024
  v_exp_f32 v32, v152
  v_mfma_f32_16x16x32_bf16 v[56:59], a[224:227], v[200:203], 0
  s_add_u32 s88, s88, 512
  v_mfma_f32_16x16x32_bf16 v[188:191], a[184:187], v[120:123], v[188:191]
  s_lshl_b32 s72, s2, 2
  v_exp_f32 v33, v153
  v_mfma_f32_16x16x32_bf16 v[188:191], a[188:191], v[124:127], v[188:191]
  s_add_u32 s72, s72, s40
  v_cvt_pk_bf16_f32 v204, v32, v33
  v_mfma_f32_16x16x32_bf16 v[180:183], a[188:191], v[108:111], v[228:231]
  s_lshl_b32 s72, s72, 12
  v_exp_f32 v34, v154
  v_mfma_f32_16x16x32_bf16 v[180:183], a[184:187], v[104:107], v[180:183]
  v_lshlrev_b32 v24, 2, v2
  v_add_f32 v41, v40, v56
  v_mfma_f32_16x16x32_bf16 v[180:183], a[180:183], v[100:103], v[180:183]
  s_mov_b32 s16, s74
  v_exp_f32 v35, v155
  v_mfma_f32_16x16x32_bf16 v[180:183], a[176:179], v[96:99], v[180:183]
  s_waitcnt lgkmcnt(4)
  v_cvt_pk_bf16_f32 v205, v34, v35
  v_mfma_f32_16x16x32_bf16 a[0:3], a[192:195], v[192:195], a[0:3]
  s_and_b32 s17, s75, 0xffff
  v_exp_f32 v32, v156
  v_mfma_f32_16x16x32_bf16 a[32:35], a[192:195], v[196:199], a[32:35]
  s_mov_b32 s18, 4194304
  v_mfma_f32_16x16x32_bf16 a[36:39], a[196:199], v[196:199], a[36:39]
  s_mov_b32 s19, 0x20000
  v_exp_f32 v33, v157
  v_mfma_f32_16x16x32_bf16 a[4:7], a[196:199], v[192:195], a[4:7]
  v_cvt_pk_bf16_f32 v206, v32, v33
  v_mfma_f32_16x16x32_bf16 a[8:11], a[200:203], v[192:195], a[8:11]
  v_exp_f32 v34, v158
  v_mfma_f32_16x16x32_bf16 a[40:43], a[200:203], v[196:199], a[40:43]
  v_mfma_f32_16x16x32_bf16 a[44:47], a[204:207], v[196:199], a[44:47]
  v_exp_f32 v35, v159
  v_mfma_f32_16x16x32_bf16 a[12:15], a[204:207], v[192:195], a[12:15]
  s_waitcnt lgkmcnt(0)
  v_cvt_pk_bf16_f32 v207, v34, v35
  v_mfma_f32_16x16x32_bf16 a[16:19], a[208:211], v[192:195], a[16:19]
  s_waitcnt vmcnt(15)
  s_barrier
  v_add_u32 v51, s53, v2
  v_xor_b32 v52, 32768, v52
  v_mfma_f32_16x16x32_bf16 v[60:63], a[224:227], v[204:207], 0
  ds_read_b128 a[128:131], v51 offset:0
  ds_read_b128 a[132:135], v51 offset:1024
  ds_read_b128 a[136:139], v51 offset:2048
  v_mfma_f32_16x16x32_bf16 a[48:51], a[208:211], v[196:199], a[48:51]
  ds_read_b128 a[140:143], v51 offset:3072
  v_exp_f32 v32, v160
  v_mfma_f32_16x16x32_bf16 a[52:55], a[212:215], v[196:199], a[52:55]
  v_add_f32 v43, v42, v60
  v_max_f32 v48, v41, v43
  v_mfma_f32_16x16x32_bf16 a[20:23], a[212:215], v[192:195], a[20:23]
  v_exp_f32 v33, v161
  v_mfma_f32_16x16x32_bf16 a[24:27], a[216:219], v[192:195], a[24:27]
  v_cmp_lt_f32 vcc, v49, v48
  v_cvt_pk_bf16_f32 v248, v32, v33
  v_mfma_f32_16x16x32_bf16 a[56:59], a[216:219], v[196:199], a[56:59]
  v_exp_f32 v34, v162
  v_mfma_f32_16x16x32_bf16 a[60:63], a[220:223], v[196:199], a[60:63]
  s_cmp_lg_u64 vcc, 0
  ds_read_b128 a[144:147], v51 offset:4096
  ds_read_b128 a[148:151], v51 offset:5120
  v_mfma_f32_16x16x32_bf16 a[28:31], a[220:223], v[192:195], a[28:31]
  s_cbranch_scc1 Lrare50
Lrr51:
  v_exp_f32 v35, v163
  v_mfma_f32_16x16x32_bf16 a[64:67], a[192:195], v[200:203], a[64:67]
  ds_read_b128 a[152:155], v51 offset:6144
  v_cvt_pk_bf16_f32 v249, v34, v35
  v_mfma_f32_16x16x32_bf16 a[96:99], a[192:195], v[204:207], a[96:99]
  v_exp_f32 v32, v164
  v_mfma_f32_16x16x32_bf16 a[100:103], a[196:199], v[204:207], a[100:103]
  ds_read_b128 a[156:159], v51 offset:7168
  buffer_load_dword v27, v24, s[16:19], s72 offen
  v_mfma_f32_16x16x32_bf16 a[68:71], a[196:199], v[200:203], a[68:71]
  s_mov_b32 s4, s52
  v_exp_f32 v33, v165
  v_mfma_f32_16x16x32_bf16 a[72:75], a[200:203], v[200:203], a[72:75]
  s_mov_b32 s52, s53
  v_cvt_pk_bf16_f32 v250, v32, v33
  v_mfma_f32_16x16x32_bf16 a[104:107], a[200:203], v[204:207], a[104:107]
  s_mov_b32 s53, s54
  v_exp_f32 v34, v166
  v_mfma_f32_16x16x32_bf16 a[108:111], a[204:207], v[204:207], a[108:111]
  s_mov_b32 s54, s4
  v_mfma_f32_16x16x32_bf16 a[76:79], a[204:207], v[200:203], a[76:79]
  s_add_u32 s49, s49, 1
  v_exp_f32 v35, v167
  v_mfma_f32_16x16x32_bf16 a[80:83], a[208:211], v[200:203], a[80:83]
  s_cmp_ge_u32 s49, s42
  v_cvt_pk_bf16_f32 v251, v34, v35
  v_mfma_f32_16x16x32_bf16 a[112:115], a[208:211], v[204:207], a[112:115]
  v_exp_f32 v32, v168
  v_mfma_f32_16x16x32_bf16 v[56:59], a[224:227], v[248:251], 0
  v_mfma_f32_16x16x32_bf16 a[116:119], a[212:215], v[204:207], a[116:119]
  v_exp_f32 v33, v169
  v_mfma_f32_16x16x32_bf16 a[84:87], a[212:215], v[200:203], a[84:87]
  v_cvt_pk_bf16_f32 v252, v32, v33
  v_mfma_f32_16x16x32_bf16 a[88:91], a[216:219], v[200:203], a[88:91]
  v_exp_f32 v34, v170
  v_mfma_f32_16x16x32_bf16 a[120:123], a[216:219], v[204:207], a[120:123]
  v_add_f32 v36, v37, v56
  v_mfma_f32_16x16x32_bf16 a[124:127], a[220:223], v[204:207], a[124:127]
  v_exp_f32 v35, v171
  v_mfma_f32_16x16x32_bf16 a[92:95], a[220:223], v[200:203], a[92:95]
  v_cvt_pk_bf16_f32 v253, v34, v35
  s_cbranch_scc1 Lp1x
Lp1:
  s_waitcnt lgkmcnt(4)
  v_mfma_f32_16x16x32_bf16 v[128:131], a[128:131], v[64:67], v[208:211]
  v_exp_f32 v32, v172
  v_mfma_f32_16x16x32_bf16 v[128:131], a[132:135], v[68:71], v[128:131]
  s_add_u32 m0, s48, 0
  v_mfma_f32_16x16x32_bf16 v[128:131], a[136:139], v[72:75], v[128:131]
  v_exp_f32 v33, v173
  v_mfma_f32_16x16x32_bf16 v[128:131], a[140:143], v[76:79], v[128:131]
  ds_read_b128 a[160:163], v52 offset:0
  v_cvt_pk_bf16_f32 v254, v32, v33
  v_mfma_f32_16x16x32_bf16 v[136:139], a[140:143], v[92:95], v[216:219]
  v_exp_f32 v34, v174
  v_mfma_f32_16x16x32_bf16 v[136:139], a[136:139], v[88:91], v[136:139]
  ds_read_b128 a[164:167], v52 offset:1024
  buffer_load_dwordx4 v2, s[12:15], s46 offen offset:0 sc1 lds
  v_mfma_f32_16x16x32_bf16 v[136:139], a[132:135], v[84:87], v[136:139]
  v_exp_f32 v35, v175
  v_mfma_f32_16x16x32_bf16 v[136:139], a[128:131], v[80:83], v[136:139]
  s_waitcnt lgkmcnt(2)
  ds_read_b128 a[168:171], v52 offset:2048
  v_cvt_pk_bf16_f32 v255, v34, v35
  v_mfma_f32_16x16x32_bf16 v[140:143], a[144:147], v[80:83], v[220:223]
  ds_read_b128 a[172:175], v52 offset:3072
  v_mfma_f32_16x16x32_bf16 v[60:63], a[224:227], v[252:255], 0
  v_mfma_f32_16x16x32_bf16 v[140:143], a[148:151], v[84:87], v[140:143]
  v_exp_f32 v32, v176
  v_mfma_f32_16x16x32_bf16 v[140:143], a[152:155], v[88:91], v[140:143]
  v_add_f32 v38, v39, v60
  v_max_f32 v48, v36, v38
  v_mfma_f32_16x16x32_bf16 v[140:143], a[156:159], v[92:95], v[140:143]
  buffer_load_dwordx4 v2, s[12:15], s46 offen offset:1024 sc1 lds
  v_exp_f32 v33, v177
  v_mfma_f32_16x16x32_bf16 v[132:135], a[156:159], v[76:79], v[212:215]
  v_cmp_lt_f32 vcc, v49, v48
  v_cvt_pk_bf16_f32 v200, v32, v33
  v_mfma_f32_16x16x32_bf16 v[132:135], a[152:155], v[72:75], v[132:135]
  v_exp_f32 v34, v178
  v_mfma_f32_16x16x32_bf16 v[132:135], a[148:151], v[68:71], v[132:135]
  s_cmp_lg_u64 vcc, 0
  ds_read_b128 a[176:179], v52 offset:4096
  ds_read_b128 a[180:183], v52 offset:5120
  v_mfma_f32_16x16x32_bf16 v[132:135], a[144:147], v[64:67], v[132:135]
  s_cbranch_scc1 Lrare54
Lrr55:
  v_exp_f32 v35, v179
  v_mfma_f32_16x16x32_bf16 v[144:147], a[128:131], v[96:99], v[224:227]
  ds_read_b128 a[184:187], v52 offset:6144
  v_cvt_pk_bf16_f32 v201, v34, v35
  v_mfma_f32_16x16x32_bf16 v[144:147], a[132:135], v[100:103], v[144:147]
  v_exp_f32 v32, v180
  v_mfma_f32_16x16x32_bf16 v[144:147], a[136:139], v[104:107], v[144:147]
  ds_read_b128 a[188:191], v52 offset:7168
  v_mfma_f32_16x16x32_bf16 v[144:147], a[140:143], v[108:111], v[144:147]
  v_exp_f32 v33, v181
  v_mfma_f32_16x16x32_bf16 v[152:155], a[140:143], v[124:127], v[232:235]
  v_cvt_pk_bf16_f32 v202, v32, v33
  v_mfma_f32_16x16x32_bf16 v[152:155], a[136:139], v[120:123], v[152:155]
  v_exp_f32 v34, v182
  v_mfma_f32_16x16x32_bf16 v[152:155], a[132:135], v[116:119], v[152:155]
  buffer_load_dwordx4 v2, s[12:15], s46 offen offset:2048 sc1 lds
  v_mfma_f32_16x16x32_bf16 v[152:155], a[128:131], v[112:115], v[152:155]
  v_exp_f32 v35, v183
  v_mfma_f32_16x16x32_bf16 v[156:159], a[144:147], v[112:115], v[236:239]
  v_cvt_pk_bf16_f32 v203, v34, v35
  v_mfma_f32_16x16x32_bf16 v[156:159], a[148:151], v[116:119], v[156:159]
  v_exp_f32 v32, v184
  v_mfma_f32_16x16x32_bf16 v[56:59], a[224:227], v[200:203], 0
  v_mfma_f32_16x16x32_bf16 v[156:159], a[152:155], v[120:123], v[156:159]
  v_exp_f32 v33, v185
  v_mfma_f32_16x16x32_bf16 v[156:159], a[156:159], v[124:127], v[156:159]
  v_cvt_pk_bf16_f32 v204, v32, v33
  v_mfma_f32_16x16x32_bf16 v[148:151], a[156:159], v[108:111], v[228:231]
  v_exp_f32 v34, v186
  v_mfma_f32_16x16x32_bf16 v[148:151], a[152:155], v[104:107], v[148:151]
  v_add_f32 v40, v41, v56
  v_mfma_f32_16x16x32_bf16 v[148:151], a[148:151], v[100:103], v[148:151]
  v_exp_f32 v35, v187
  v_mfma_f32_16x16x32_bf16 v[148:151], a[144:147], v[96:99], v[148:151]
  s_waitcnt lgkmcnt(4)
  v_cvt_pk_bf16_f32 v205, v34, v35
  v_mfma_f32_16x16x32_bf16 a[0:3], a[160:163], v[248:251], a[0:3]
  v_exp_f32 v32, v188
  v_mfma_f32_16x16x32_bf16 a[32:35], a[160:163], v[252:255], a[32:35]
  buffer_load_dwordx4 v2, s[12:15], s46 offen offset:3072 sc1 lds
  v_mfma_f32_16x16x32_bf16 a[36:39], a[164:167], v[252:255], a[36:39]
  s_add_u32 m0, s48, 4096
  v_exp_f32 v33, v189
  v_mfma_f32_16x16x32_bf16 a[4:7], a[164:167], v[248:251], a[4:7]
  s_add_u32 s46, s46, 4096
  ds_read_b128 a[192:195], v51 offset:8192
  v_cvt_pk_bf16_f32 v206, v32, v33
  v_mfma_f32_16x16x32_bf16 a[8:11], a[168:171], v[248:251], a[8:11]
  v_exp_f32 v34, v190
  v_mfma_f32_16x16x32_bf16 a[40:43], a[168:171], v[252:255], a[40:43]
  ds_read_b128 a[196:199], v51 offset:9216
  ds_read_b128 a[200:203], v51 offset:10240
  v_mfma_f32_16x16x32_bf16 a[44:47], a[172:175], v[252:255], a[44:47]
  v_exp_f32 v35, v191
  v_mfma_f32_16x16x32_bf16 a[12:15], a[172:175], v[248:251], a[12:15]
  s_waitcnt lgkmcnt(3)
  ds_read_b128 a[204:207], v51 offset:11264
  v_cvt_pk_bf16_f32 v207, v34, v35
  v_mfma_f32_16x16x32_bf16 a[16:19], a[176:179], v[248:251], a[16:19]
  v_mfma_f32_16x16x32_bf16 v[60:63], a[224:227], v[204:207], 0
  v_mfma_f32_16x16x32_bf16 a[48:51], a[176:179], v[252:255], a[48:51]
  v_exp_f32 v32, v128
  v_mfma_f32_16x16x32_bf16 a[52:55], a[180:183], v[252:255], a[52:55]
  buffer_load_dwordx4 v2, s[12:15], s46 offen offset:0 sc1 lds
  v_add_f32 v42, v43, v60
  v_max_f32 v48, v40, v42
  v_mfma_f32_16x16x32_bf16 a[20:23], a[180:183], v[248:251], a[20:23]
  v_exp_f32 v33, v129
  v_mfma_f32_16x16x32_bf16 a[24:27], a[184:187], v[248:251], a[24:27]
  v_cmp_lt_f32 vcc, v49, v48
  v_cvt_pk_bf16_f32 v192, v32, v33
  v_mfma_f32_16x16x32_bf16 a[56:59], a[184:187], v[252:255], a[56:59]
  v_exp_f32 v34, v130
  v_mfma_f32_16x16x32_bf16 a[60:63], a[188:191], v[252:255], a[60:63]
  s_cmp_lg_u64 vcc, 0
  ds_read_b128 a[208:211], v51 offset:12288
  ds_read_b128 a[212:215], v51 offset:13312
  v_mfma_f32_16x16x32_bf16 a[28:31], a[188:191], v[248:251], a[28:31]
  s_cbranch_scc1 Lrare56
Lrr57:
  v_exp_f32 v35, v131
  v_mfma_f32_16x16x32_bf16 a[64:67], a[160:163], v[200:203], a[64:67]
  ds_read_b128 a[216:219], v51 offset:14336
  v_cvt_pk_bf16_f32 v193, v34, v35
  v_mfma_f32_16x16x32_bf16 a[96:99], a[160:163], v[204:207], a[96:99]
  v_exp_f32 v32, v132
  v_mfma_f32_16x16x32_bf16 a[100:103], a[164:167], v[204:207], a[100:103]
  ds_read_b128 a[220:223], v51 offset:15360
  v_mfma_f32_16x16x32_bf16 a[68:71], a[164:167], v[200:203], a[68:71]
  v_exp_f32 v33, v133
  v_mfma_f32_16x16x32_bf16 a[72:75], a[168:171], v[200:203], a[72:75]
  buffer_load_dwordx4 v2, s[12:15], s46 offen offset:1024 sc1 lds
  v_cvt_pk_bf16_f32 v194, v32, v33
  v_mfma_f32_16x16x32_bf16 a[104:107], a[168:171], v[204:207], a[104:107]
  v_exp_f32 v34, v134
  v_mfma_f32_16x16x32_bf16 a[108:111], a[172:175], v[204:207], a[108:111]
  v_mfma_f32_16x16x32_bf16 a[76:79], a[172:175], v[200:203], a[76:79]
  v_exp_f32 v35, v135
  v_mfma_f32_16x16x32_bf16 a[80:83], a[176:179], v[200:203], a[80:83]
  v_cvt_pk_bf16_f32 v195, v34, v35
  v_mfma_f32_16x16x32_bf16 a[112:115], a[176:179], v[204:207], a[112:115]
  v_exp_f32 v32, v136
  v_mfma_f32_16x16x32_bf16 v[56:59], a[224:227], v[192:195], 0
  v_mfma_f32_16x16x32_bf16 a[116:119], a[180:183], v[204:207], a[116:119]
  v_exp_f32 v33, v137
  v_mfma_f32_16x16x32_bf16 a[84:87], a[180:183], v[200:203], a[84:87]
  v_cvt_pk_bf16_f32 v196, v32, v33
  v_mfma_f32_16x16x32_bf16 a[88:91], a[184:187], v[200:203], a[88:91]
  v_exp_f32 v34, v138
  v_mfma_f32_16x16x32_bf16 a[120:123], a[184:187], v[204:207], a[120:123]
  v_add_f32 v37, v36, v56
  v_mfma_f32_16x16x32_bf16 a[124:127], a[188:191], v[204:207], a[124:127]
  v_exp_f32 v35, v139
  v_mfma_f32_16x16x32_bf16 a[92:95], a[188:191], v[200:203], a[92:95]
  s_waitcnt lgkmcnt(4)
  buffer_load_dwordx4 v2, s[12:15], s46 offen offset:2048 sc1 lds
  v_cvt_pk_bf16_f32 v197, v34, v35
  v_mfma_f32_16x16x32_bf16 v[160:163], a[192:195], v[64:67], v[208:211]
  v_exp_f32 v32, v140
  v_mfma_f32_16x16x32_bf16 v[160:163], a[196:199], v[68:71], v[160:163]
  v_mfma_f32_16x16x32_bf16 v[160:163], a[200:203], v[72:75], v[160:163]
  v_exp_f32 v33, v141
  v_mfma_f32_16x16x32_bf16 v[160:163], a[204:207], v[76:79], v[160:163]
  ds_read_b128 a[160:163], v52 offset:8192
  v_cvt_pk_bf16_f32 v198, v32, v33
  v_mfma_f32_16x16x32_bf16 v[168:171], a[204:207], v[92:95], v[216:219]
  v_exp_f32 v34, v142
  v_mfma_f32_16x16x32_bf16 v[168:171], a[200:203], v[88:91], v[168:171]
  ds_read_b128 a[164:167], v52 offset:9216
  v_mfma_f32_16x16x32_bf16 v[168:171], a[196:199], v[84:87], v[168:171]
  v_exp_f32 v35, v143
  v_mfma_f32_16x16x32_bf16 v[168:171], a[192:195], v[80:83], v[168:171]
  s_waitcnt lgkmcnt(2)
  ds_read_b128 a[168:171], v52 offset:10240
  v_cvt_pk_bf16_f32 v199, v34, v35
  v_mfma_f32_16x16x32_bf16 v[172:175], a[208:211], v[80:83], v[220:223]
  ds_read_b128 a[172:175], v52 offset:11264
  v_mfma_f32_16x16x32_bf16 v[60:63], a[224:227], v[196:199], 0
  buffer_load_dwordx4 v2, s[12:15], s46 offen offset:3072 sc1 lds
  v_mfma_f32_16x16x32_bf16 v[172:175], a[212:215], v[84:87], v[172:175]
  s_add_u32 s46, s46, 28672
  v_exp_f32 v32, v144
  v_mfma_f32_16x16x32_bf16 v[172:175], a[216:219], v[88:91], v[172:175]
  s_xor_b32 s48, s48, 32768
  v_add_f32 v39, v38, v60
  v_max_f32 v48, v37, v39
  v_mfma_f32_16x16x32_bf16 v[172:175], a[220:223], v[92:95], v[172:175]
  s_add_u32 m0, s54, s47
  v_exp_f32 v33, v145
  v_mfma_f32_16x16x32_bf16 v[164:167], a[220:223], v[76:79], v[212:215]
  v_cmp_lt_f32 vcc, v49, v48
  v_cvt_pk_bf16_f32 v200, v32, v33
  v_mfma_f32_16x16x32_bf16 v[164:167], a[216:219], v[72:75], v[164:167]
  v_exp_f32 v34, v146
  v_mfma_f32_16x16x32_bf16 v[164:167], a[212:215], v[68:71], v[164:167]
  s_cmp_lg_u64 vcc, 0
  ds_read_b128 a[176:179], v52 offset:12288
  ds_read_b128 a[180:183], v52 offset:13312
  v_mfma_f32_16x16x32_bf16 v[164:167], a[208:211], v[64:67], v[164:167]
  s_cbranch_scc1 Lrare58
Lrr59:
  v_exp_f32 v35, v147
  v_mfma_f32_16x16x32_bf16 v[176:179], a[192:195], v[96:99], v[224:227]
  ds_read_b128 a[184:187], v52 offset:14336
  v_cvt_pk_bf16_f32 v201, v34, v35
  v_mfma_f32_16x16x32_bf16 v[176:179], a[196:199], v[100:103], v[176:179]
  v_exp_f32 v32, v148
  v_mfma_f32_16x16x32_bf16 v[176:179], a[200:203], v[104:107], v[176:179]
  ds_read_b128 a[188:191], v52 offset:15360
  v_mfma_f32_16x16x32_bf16 v[176:179], a[204:207], v[108:111], v[176:179]
  v_exp_f32 v33, v149
  v_mfma_f32_16x16x32_bf16 v[184:187], a[204:207], v[124:127], v[232:235]
  buffer_load_dwordx4 v53, s[8:11], s45 offen offset:0 sc1 lds
  v_cvt_pk_bf16_f32 v202, v32, v33
  v_mfma_f32_16x16x32_bf16 v[184:187], a[200:203], v[120:123], v[184:187]
  v_exp_f32 v34, v150
  v_mfma_f32_16x16x32_bf16 v[184:187], a[196:199], v[116:119], v[184:187]
  v_mfma_f32_16x16x32_bf16 v[184:187], a[192:195], v[112:115], v[184:187]
  v_exp_f32 v35, v151
  v_mfma_f32_16x16x32_bf16 v[188:191], a[208:211], v[112:115], v[236:239]
  v_cvt_pk_bf16_f32 v203, v34, v35
  v_mfma_f32_16x16x32_bf16 v[188:191], a[212:215], v[116:119], v[188:191]
  v_exp_f32 v32, v152
  v_mfma_f32_16x16x32_bf16 v[56:59], a[224:227], v[200:203], 0
  v_mfma_f32_16x16x32_bf16 v[188:191], a[216:219], v[120:123], v[188:191]
  v_exp_f32 v33, v153
  v_mfma_f32_16x16x32_bf16 v[188:191], a[220:223], v[124:127], v[188:191]
  v_cvt_pk_bf16_f32 v204, v32, v33
  v_mfma_f32_16x16x32_bf16 v[180:183], a[220:223], v[108:111], v[228:231]
  v_exp_f32 v34, v154
  v_mfma_f32_16x16x32_bf16 v[180:183], a[216:219], v[104:107], v[180:183]
  buffer_load_dwordx4 v54, s[8:11], s45 offen offset:1024 sc1 lds
  v_add_f32 v41, v40, v56
  v_mfma_f32_16x16x32_bf16 v[180:183], a[212:215], v[100:103], v[180:183]
  v_exp_f32 v35, v155
  v_mfma_f32_16x16x32_bf16 v[180:183], a[208:211], v[96:99], v[180:183]
  s_waitcnt lgkmcnt(4)
  v_cvt_pk_bf16_f32 v205, v34, v35
  v_mfma_f32_16x16x32_bf16 a[0:3], a[160:163], v[192:195], a[0:3]
  v_exp_f32 v32, v156
  v_mfma_f32_16x16x32_bf16 a[32:35], a[160:163], v[196:199], a[32:35]
  v_mfma_f32_16x16x32_bf16 a[36:39], a[164:167], v[196:199], a[36:39]
  v_exp_f32 v33, v157
  v_mfma_f32_16x16x32_bf16 a[4:7], a[164:167], v[192:195], a[4:7]
  ds_read_b128 a[192:195], v51 offset:16384
  v_cvt_pk_bf16_f32 v206, v32, v33
  v_mfma_f32_16x16x32_bf16 a[8:11], a[168:171], v[192:195], a[8:11]
  v_exp_f32 v34, v158
  v_mfma_f32_16x16x32_bf16 a[40:43], a[168:171], v[196:199], a[40:43]
  ds_read_b128 a[196:199], v51 offset:17408
  ds_read_b128 a[200:203], v51 offset:18432
  v_mfma_f32_16x16x32_bf16 a[44:47], a[172:175], v[196:199], a[44:47]
  v_exp_f32 v35, v159
  v_mfma_f32_16x16x32_bf16 a[12:15], a[172:175], v[192:195], a[12:15]
  s_waitcnt lgkmcnt(3)
  ds_read_b128 a[204:207], v51 offset:19456
  v_cvt_pk_bf16_f32 v207, v34, v35
  v_mfma_f32_16x16x32_bf16 a[16:19], a[176:179], v[192:195], a[16:19]
  buffer_load_dwordx4 v55, s[8:11], s45 offen offset:2048 sc1 lds
  v_mfma_f32_16x16x32_bf16 v[60:63], a[224:227], v[204:207], 0
  v_mfma_f32_16x16x32_bf16 a[48:51], a[176:179], v[196:199], a[48:51]
  v_exp_f32 v32, v160
  v_mfma_f32_16x16x32_bf16 a[52:55], a[180:183], v[196:199], a[52:55]
  v_add_f32 v43, v42, v60
  v_max_f32 v48, v41, v43
  v_mfma_f32_16x16x32_bf16 a[20:23], a[180:183], v[192:195], a[20:23]
  v_exp_f32 v33, v161
  v_mfma_f32_16x16x32_bf16 a[24:27], a[184:187], v[192:195], a[24:27]
  v_cmp_lt_f32 vcc, v49, v48
  v_cvt_pk_bf16_f32 v248, v32, v33
  v_mfma_f32_16x16x32_bf16 a[56:59], a[184:187], v[196:199], a[56:59]
  v_exp_f32 v34, v162
  v_mfma_f32_16x16x32_bf16 a[60:63], a[188:191], v[196:199], a[60:63]
  s_cmp_lg_u64 vcc, 0
  ds_read_b128 a[208:211], v51 offset:20480
  ds_read_b128 a[212:215], v51 offset:21504
  v_mfma_f32_16x16x32_bf16 a[28:31], a[188:191], v[192:195], a[28:31]
  s_cbranch_scc1 Lrare60
Lrr61:
  v_exp_f32 v35, v163
  v_mfma_f32_16x16x32_bf16 a[64:67], a[160:163], v[200:203], a[64:67]
  ds_read_b128 a[216:219], v51 offset:22528
  v_cvt_pk_bf16_f32 v249, v34, v35
  v_mfma_f32_16x16x32_bf16 a[96:99], a[160:163], v[204:207], a[96:99]
  v_exp_f32 v32, v164
  v_mfma_f32_16x16x32_bf16 a[100:103], a[164:167], v[204:207], a[100:103]
  ds_read_b128 a[220:223], v51 offset:23552
  buffer_load_dwordx4 v30, s[8:11], s45 offen offset:3072 sc1 lds
  v_mfma_f32_16x16x32_bf16 a[68:71], a[164:167], v[200:203], a[68:71]
  s_add_u32 m0, m0, 4096
  v_exp_f32 v33, v165
  v_mfma_f32_16x16x32_bf16 a[72:75], a[168:171], v[200:203], a[72:75]
  s_add_u32 s45, s45, s100
  v_cvt_pk_bf16_f32 v250, v32, v33
  v_mfma_f32_16x16x32_bf16 a[104:107], a[168:171], v[204:207], a[104:107]
  v_exp_f32 v34, v166
  v_mfma_f32_16x16x32_bf16 a[108:111], a[172:175], v[204:207], a[108:111]
  v_mfma_f32_16x16x32_bf16 a[76:79], a[172:175], v[200:203], a[76:79]
  v_exp_f32 v35, v167
  v_mfma_f32_16x16x32_bf16 a[80:83], a[176:179], v[200:203], a[80:83]
  v_cvt_pk_bf16_f32 v251, v34, v35
  v_mfma_f32_16x16x32_bf16 a[112:115], a[176:179], v[204:207], a[112:115]
  v_exp_f32 v32, v168
  v_mfma_f32_16x16x32_bf16 v[56:59], a[224:227], v[248:251], 0
  v_mfma_f32_16x16x32_bf16 a[116:119], a[180:183], v[204:207], a[116:119]
  v_exp_f32 v33, v169
  v_mfma_f32_16x16x32_bf16 a[84:87], a[180:183], v[200:203], a[84:87]
  buffer_load_dwordx4 v53, s[8:11], s45 offen offset:0 sc1 lds
  v_cvt_pk_bf16_f32 v252, v32, v33
  v_mfma_f32_16x16x32_bf16 a[88:91], a[184:187], v[200:203], a[88:91]
  v_exp_f32 v34, v170
  v_mfma_f32_16x16x32_bf16 a[120:123], a[184:187], v[204:207], a[120:123]
  v_add_f32 v36, v37, v56
  v_mfma_f32_16x16x32_bf16 a[124:127], a[188:191], v[204:207], a[124:127]
  v_exp_f32 v35, v171
  v_mfma_f32_16x16x32_bf16 a[92:95], a[188:191], v[200:203], a[92:95]
  s_waitcnt lgkmcnt(4)
  v_cvt_pk_bf16_f32 v253, v34, v35
  v_mfma_f32_16x16x32_bf16 v[128:131], a[192:195], v[64:67], v[208:211]
  v_exp_f32 v32, v172
  v_mfma_f32_16x16x32_bf16 v[128:131], a[196:199], v[68:71], v[128:131]
  v_mfma_f32_16x16x32_bf16 v[128:131], a[200:203], v[72:75], v[128:131]
  v_exp_f32 v33, v173
  v_mfma_f32_16x16x32_bf16 v[128:131], a[204:207], v[76:79], v[128:131]
  ds_read_b128 a[160:163], v52 offset:16384
  v_cvt_pk_bf16_f32 v254, v32, v33
  v_mfma_f32_16x16x32_bf16 v[136:139], a[204:207], v[92:95], v[216:219]
  v_exp_f32 v34, v174
  v_mfma_f32_16x16x32_bf16 v[136:139], a[200:203], v[88:91], v[136:139]
  ds_read_b128 a[164:167], v52 offset:17408
  buffer_load_dwordx4 v54, s[8:11], s45 offen offset:1024 sc1 lds
  v_mfma_f32_16x16x32_bf16 v[136:139], a[196:199], v[84:87], v[136:139]
  v_exp_f32 v35, v175
  v_mfma_f32_16x16x32_bf16 v[136:139], a[192:195], v[80:83], v[136:139]
  s_waitcnt lgkmcnt(2)
  ds_read_b128 a[168:171], v52 offset:18432
  v_cvt_pk_bf16_f32 v255, v34, v35
  v_mfma_f32_16x16x32_bf16 v[140:143], a[208:211], v[80:83], v[220:223]
  ds_read_b128 a[172:175], v52 offset:19456
  v_mfma_f32_16x16x32_bf16 v[60:63], a[224:227], v[252:255], 0
  v_mfma_f32_16x16x32_bf16 v[140:143], a[212:215], v[84:87], v[140:143]
  v_exp_f32 v32, v176
  v_mfma_f32_16x16x32_bf16 v[140:143], a[216:219], v[88:91], v[140:143]
  v_add_f32 v38, v39, v60
  v_max_f32 v48, v36, v38
  v_mfma_f32_16x16x32_bf16 v[140:143], a[220:223], v[92:95], v[140:143]
  v_exp_f32 v33, v177
  v_mfma_f32_16x16x32_bf16 v[132:135], a[220:223], v[76:79], v[212:215]
  v_cmp_lt_f32 vcc, v49, v48
  v_cvt_pk_bf16_f32 v200, v32, v33
  v_mfma_f32_16x16x32_bf16 v[132:135], a[216:219], v[72:75], v[132:135]
  v_exp_f32 v34, v178
  v_mfma_f32_16x16x32_bf16 v[132:135], a[212:215], v[68:71], v[132:135]
  s_cmp_lg_u64 vcc, 0
  ds_read_b128 a[176:179], v52 offset:20480
  ds_read_b128 a[180:183], v52 offset:21504
  v_mfma_f32_16x16x32_bf16 v[132:135], a[208:211], v[64:67], v[132:135]
  s_cbranch_scc1 Lrare62
Lrr63:
  v_exp_f32 v35, v179
  v_mfma_f32_16x16x32_bf16 v[144:147], a[192:195], v[96:99], v[224:227]
  ds_read_b128 a[184:187], v52 offset:22528
  v_cvt_pk_bf16_f32 v201, v34, v35
  v_mfma_f32_16x16x32_bf16 v[144:147], a[196:199], v[100:103], v[144:147]
  v_exp_f32 v32, v180
  v_mfma_f32_16x16x32_bf16 v[144:147], a[200:203], v[104:107], v[144:147]
  ds_read_b128 a[188:191], v52 offset:23552
  buffer_load_dwordx4 v55, s[8:11], s45 offen offset:2048 sc1 lds
  v_mfma_f32_16x16x32_bf16 v[144:147], a[204:207], v[108:111], v[144:147]
  v_exp_f32 v33, v181
  v_mfma_f32_16x16x32_bf16 v[152:155], a[204:207], v[124:127], v[232:235]
  v_cvt_pk_bf16_f32 v202, v32, v33
  v_mfma_f32_16x16x32_bf16 v[152:155], a[200:203], v[120:123], v[152:155]
  v_exp_f32 v34, v182
  v_mfma_f32_16x16x32_bf16 v[152:155], a[196:199], v[116:119], v[152:155]
  v_mfma_f32_16x16x32_bf16 v[152:155], a[192:195], v[112:115], v[152:155]
  v_exp_f32 v35, v183
  v_mfma_f32_16x16x32_bf16 v[156:159], a[208:211], v[112:115], v[236:239]
  v_cvt_pk_bf16_f32 v203, v34, v35
  v_mfma_f32_16x16x32_bf16 v[156:159], a[212:215], v[116:119], v[156:159]
  v_exp_f32 v32, v184
  v_mfma_f32_16x16x32_bf16 v[56:59], a[224:227], v[200:203], 0
  buffer_load_dwordx4 v30, s[8:11], s45 offen offset:3072 sc1 lds
  v_mfma_f32_16x16x32_bf16 v[156:159], a[216:219], v[120:123], v[156:159]
  s_add_u32 s45, s45, s101
  v_exp_f32 v33, v185
  v_mfma_f32_16x16x32_bf16 v[156:159], a[220:223], v[124:127], v[156:159]
  v_cvt_pk_bf16_f32 v204, v32, v33
  v_mfma_f32_16x16x32_bf16 v[148:151], a[220:223], v[108:111], v[228:231]
  v_exp_f32 v34, v186
  v_mfma_f32_16x16x32_bf16 v[148:151], a[216:219], v[104:107], v[148:151]
  v_add_f32 v40, v41, v56
  v_mfma_f32_16x16x32_bf16 v[148:151], a[212:215], v[100:103], v[148:151]
  v_exp_f32 v35, v187
  v_mfma_f32_16x16x32_bf16 v[148:151], a[208:211], v[96:99], v[148:151]
  s_waitcnt lgkmcnt(4)
  v_cvt_pk_bf16_f32 v205, v34, v35
  v_mfma_f32_16x16x32_bf16 a[0:3], a[160:163], v[248:251], a[0:3]
  v_exp_f32 v32, v188
  v_mfma_f32_16x16x32_bf16 a[32:35], a[160:163], v[252:255], a[32:35]
  v_mfma_f32_16x16x32_bf16 a[36:39], a[164:167], v[252:255], a[36:39]
  v_exp_f32 v33, v189
  v_mfma_f32_16x16x32_bf16 a[4:7], a[164:167], v[248:251], a[4:7]
  ds_read_b128 a[192:195], v51 offset:24576
  v_cvt_pk_bf16_f32 v206, v32, v33
  v_mfma_f32_16x16x32_bf16 a[8:11], a[168:171], v[248:251], a[8:11]
  v_exp_f32 v34, v190
  v_mfma_f32_16x16x32_bf16 a[40:43], a[168:171], v[252:255], a[40:43]
  ds_read_b128 a[196:199], v51 offset:25600
  ds_read_b128 a[200:203], v51 offset:26624
  v_mfma_f32_16x16x32_bf16 a[44:47], a[172:175], v[252:255], a[44:47]
  v_exp_f32 v35, v191
  v_mfma_f32_16x16x32_bf16 a[12:15], a[172:175], v[248:251], a[12:15]
  s_waitcnt lgkmcnt(3)
  ds_read_b128 a[204:207], v51 offset:27648
  v_cvt_pk_bf16_f32 v207, v34, v35
  v_mfma_f32_16x16x32_bf16 a[16:19], a[176:179], v[248:251], a[16:19]
  v_mfma_f32_16x16x32_bf16 v[60:63], a[224:227], v[204:207], 0
  v_mfma_f32_16x16x32_bf16 a[48:51], a[176:179], v[252:255], a[48:51]
  v_exp_f32 v32, v128
  v_mfma_f32_16x16x32_bf16 a[52:55], a[180:183], v[252:255], a[52:55]
  v_add_f32 v42, v43, v60
  v_max_f32 v48, v40, v42
  v_mfma_f32_16x16x32_bf16 a[20:23], a[180:183], v[248:251], a[20:23]
  v_exp_f32 v33, v129
  v_mfma_f32_16x16x32_bf16 a[24:27], a[184:187], v[248:251], a[24:27]
  v_cmp_lt_f32 vcc, v49, v48
  v_cvt_pk_bf16_f32 v192, v32, v33
  v_mfma_f32_16x16x32_bf16 a[56:59], a[184:187], v[252:255], a[56:59]
  v_exp_f32 v34, v130
  v_mfma_f32_16x16x32_bf16 a[60:63], a[188:191], v[252:255], a[60:63]
  s_cmp_lg_u64 vcc, 0
  ds_read_b128 a[208:211], v51 offset:28672
  ds_read_b128 a[212:215], v51 offset:29696
  v_mfma_f32_16x16x32_bf16 a[28:31], a[188:191], v[248:251], a[28:31]
  s_cbranch_scc1 Lrare64
Lrr65:
  v_exp_f32 v35, v131
  v_mfma_f32_16x16x32_bf16 a[64:67], a[160:163], v[200:203], a[64:67]
  ds_read_b128 a[216:219], v51 offset:30720
  v_cvt_pk_bf16_f32 v193, v34, v35
  v_mfma_f32_16x16x32_bf16 a[96:99], a[160:163], v[204:207], a[96:99]
  v_exp_f32 v32, v132
  v_mfma_f32_16x16x32_bf16 a[100:103], a[164:167], v[204:207], a[100:103]
  ds_read_b128 a[220:223], v51 offset:31744
  v_mfma_f32_16x16x32_bf16 a[68:71], a[164:167], v[200:203], a[68:71]
  v_exp_f32 v33, v133
  v_mfma_f32_16x16x32_bf16 a[72:75], a[168:171], v[200:203], a[72:75]
  v_cvt_pk_bf16_f32 v194, v32, v33
  v_mfma_f32_16x16x32_bf16 a[104:107], a[168:171], v[204:207], a[104:107]
  v_exp_f32 v34, v134
  v_mfma_f32_16x16x32_bf16 a[108:111], a[172:175], v[204:207], a[108:111]
  v_mfma_f32_16x16x32_bf16 a[76:79], a[172:175], v[200:203], a[76:79]
  v_exp_f32 v35, v135
  v_mfma_f32_16x16x32_bf16 a[80:83], a[176:179], v[200:203], a[80:83]
  v_cvt_pk_bf16_f32 v195, v34, v35
  v_mfma_f32_16x16x32_bf16 a[112:115], a[176:179], v[204:207], a[112:115]
  v_exp_f32 v32, v136
  v_mfma_f32_16x16x32_bf16 v[56:59], a[224:227], v[192:195], 0
  v_mfma_f32_16x16x32_bf16 a[116:119], a[180:183], v[204:207], a[116:119]
  v_exp_f32 v33, v137
  v_mfma_f32_16x16x32_bf16 a[84:87], a[180:183], v[200:203], a[84:87]
  v_cvt_pk_bf16_f32 v196, v32, v33
  v_mfma_f32_16x16x32_bf16 a[88:91], a[184:187], v[200:203], a[88:91]
  v_exp_f32 v34, v138
  v_mfma_f32_16x16x32_bf16 a[120:123], a[184:187], v[204:207], a[120:123]
  v_add_f32 v37, v36, v56
  v_mfma_f32_16x16x32_bf16 a[124:127], a[188:191], v[204:207], a[124:127]
  v_exp_f32 v35, v139
  v_mfma_f32_16x16x32_bf16 a[92:95], a[188:191], v[200:203], a[92:95]
  s_waitcnt lgkmcnt(4)
  v_cvt_pk_bf16_f32 v197, v34, v35
  v_mfma_f32_16x16x32_bf16 v[160:163], a[192:195], v[64:67], v[208:211]
  v_exp_f32 v32, v140
  v_mfma_f32_16x16x32_bf16 v[160:163], a[196:199], v[68:71], v[160:163]
  v_mfma_f32_16x16x32_bf16 v[160:163], a[200:203], v[72:75], v[160:163]
  v_exp_f32 v33, v141
  v_mfma_f32_16x16x32_bf16 v[160:163], a[204:207], v[76:79], v[160:163]
  ds_read_b128 a[160:163], v52 offset:24576
  v_cvt_pk_bf16_f32 v198, v32, v33
  v_mfma_f32_16x16x32_bf16 v[168:171], a[204:207], v[92:95], v[216:219]
  v_exp_f32 v34, v142
  v_mfma_f32_16x16x32_bf16 v[168:171], a[200:203], v[88:91], v[168:171]
  ds_read_b128 a[164:167], v52 offset:25600
  v_mfma_f32_16x16x32_bf16 v[168:171], a[196:199], v[84:87], v[168:171]
  v_exp_f32 v35, v143
  v_mfma_f32_16x16x32_bf16 v[168:171], a[192:195], v[80:83], v[168:171]
  s_waitcnt lgkmcnt(2)
  ds_read_b128 a[168:171], v52 offset:26624
  v_cvt_pk_bf16_f32 v199, v34, v35
  v_mfma_f32_16x16x32_bf16 v[172:175], a[208:211], v[80:83], v[220:223]
  ds_read_b128 a[172:175], v52 offset:27648
  v_mfma_f32_16x16x32_bf16 v[60:63], a[224:227], v[196:199], 0
  v_mfma_f32_16x16x32_bf16 v[172:175], a[212:215], v[84:87], v[172:175]
  v_exp_f32 v32, v144
  v_mfma_f32_16x16x32_bf16 v[172:175], a[216:219], v[88:91], v[172:175]
  v_add_f32 v39, v38, v60
  v_max_f32 v48, v37, v39
  v_mfma_f32_16x16x32_bf16 v[172:175], a[220:223], v[92:95], v[172:175]
  v_exp_f32 v33, v145
  v_mfma_f32_16x16x32_bf16 v[164:167], a[220:223], v[76:79], v[212:215]
  v_cmp_lt_f32 vcc, v49, v48
  v_cvt_pk_bf16_f32 v200, v32, v33
  v_mfma_f32_16x16x32_bf16 v[164:167], a[216:219], v[72:75], v[164:167]
  v_exp_f32 v34, v146
  v_mfma_f32_16x16x32_bf16 v[164:167], a[212:215], v[68:71], v[164:167]
  s_cmp_lg_u64 vcc, 0
  ds_read_b128 a[176:179], v52 offset:28672
  ds_read_b128 a[180:183], v52 offset:29696
  v_mfma_f32_16x16x32_bf16 v[164:167], a[208:211], v[64:67], v[164:167]
  s_cbranch_scc1 Lrare66
Lrr67:
  v_exp_f32 v35, v147
  v_mfma_f32_16x16x32_bf16 v[176:179], a[192:195], v[96:99], v[224:227]
  ds_read_b128 a[184:187], v52 offset:30720
  v_cvt_pk_bf16_f32 v201, v34, v35
  v_mfma_f32_16x16x32_bf16 v[176:179], a[196:199], v[100:103], v[176:179]
  v_exp_f32 v32, v148
  v_mfma_f32_16x16x32_bf16 v[176:179], a[200:203], v[104:107], v[176:179]
  ds_read_b128 a[188:191], v52 offset:31744
  v_mfma_f32_16x16x32_bf16 v[176:179], a[204:207], v[108:111], v[176:179]
  v_exp_f32 v33, v149
  v_mfma_f32_16x16x32_bf16 v[184:187], a[204:207], v[124:127], v[232:235]
  v_cvt_pk_bf16_f32 v202, v32, v33
  v_mfma_f32_16x16x32_bf16 v[184:187], a[200:203], v[120:123], v[184:187]
  v_exp_f32 v34, v150
  v_mfma_f32_16x16x32_bf16 v[184:187], a[196:199], v[116:119], v[184:187]
  v_mfma_f32_16x16x32_bf16 v[184:187], a[192:195], v[112:115], v[184:187]
  v_exp_f32 v35, v151
  v_mfma_f32_16x16x32_bf16 v[188:191], a[208:211], v[112:115], v[236:239]
  v_cvt_pk_bf16_f32 v203, v34, v35
  v_mfma_f32_16x16x32_bf16 v[188:191], a[212:215], v[116:119], v[188:191]
  v_exp_f32 v32, v152
  v_mfma_f32_16x16x32_bf16 v[56:59], a[224:227], v[200:203], 0
  v_mfma_f32_16x16x32_bf16 v[188:191], a[216:219], v[120:123], v[188:191]
  v_exp_f32 v33, v153
  v_mfma_f32_16x16x32_bf16 v[188:191], a[220:223], v[124:127], v[188:191]
  v_cvt_pk_bf16_f32 v204, v32, v33
  v_mfma_f32_16x16x32_bf16 v[180:183], a[220:223], v[108:111], v[228:231]
  v_exp_f32 v34, v154
  v_mfma_f32_16x16x32_bf16 v[180:183], a[216:219], v[104:107], v[180:183]
  v_add_f32 v41, v40, v56
  v_mfma_f32_16x16x32_bf16 v[180:183], a[212:215], v[100:103], v[180:183]
  v_exp_f32 v35, v155
  v_mfma_f32_16x16x32_bf16 v[180:183], a[208:211], v[96:99], v[180:183]
  s_waitcnt lgkmcnt(4)
  v_cvt_pk_bf16_f32 v205, v34, v35
  v_mfma_f32_16x16x32_bf16 a[0:3], a[160:163], v[192:195], a[0:3]
  v_exp_f32 v32, v156
  v_mfma_f32_16x16x32_bf16 a[32:35], a[160:163], v[196:199], a[32:35]
  v_mfma_f32_16x16x32_bf16 a[36:39], a[164:167], v[196:199], a[36:39]
  v_exp_f32 v33, v157
  v_mfma_f32_16x16x32_bf16 a[4:7], a[164:167], v[192:195], a[4:7]
  v_cvt_pk_bf16_f32 v206, v32, v33
  v_mfma_f32_16x16x32_bf16 a[8:11], a[168:171], v[192:195], a[8:11]
  v_exp_f32 v34, v158
  v_mfma_f32_16x16x32_bf16 a[40:43], a[168:171], v[196:199], a[40:43]
  v_mfma_f32_16x16x32_bf16 a[44:47], a[172:175], v[196:199], a[44:47]
  v_exp_f32 v35, v159
  v_mfma_f32_16x16x32_bf16 a[12:15], a[172:175], v[192:195], a[12:15]
  s_waitcnt lgkmcnt(0)
  v_cvt_pk_bf16_f32 v207, v34, v35
  v_mfma_f32_16x16x32_bf16 a[16:19], a[176:179], v[192:195], a[16:19]
  s_waitcnt vmcnt(8)
  s_barrier
  v_add_u32 v51, s53, v2
  v_xor_b32 v52, 32768, v52
  v_mfma_f32_16x16x32_bf16 v[60:63], a[224:227], v[204:207], 0
  s_mov_b32 s4, s52
  ds_read_b128 a[128:131], v51 offset:0
  ds_read_b128 a[132:135], v51 offset:1024
  ds_read_b128 a[136:139], v51 offset:2048
  v_mfma_f32_16x16x32_bf16 a[48:51], a[176:179], v[196:199], a[48:51]
  s_mov_b32 s52, s53
  ds_read_b128 a[140:143], v51 offset:3072
  v_exp_f32 v32, v160
  v_mfma_f32_16x16x32_bf16 a[52:55], a[180:183], v[196:199], a[52:55]
  s_mov_b32 s53, s54
  v_add_f32 v43, v42, v60
  v_max_f32 v48, v41, v43
  v_mfma_f32_16x16x32_bf16 a[20:23], a[180:183], v[192:195], a[20:23]
  s_mov_b32 s54, s4
  v_exp_f32 v33, v161
  v_mfma_f32_16x16x32_bf16 a[24:27], a[184:187], v[192:195], a[24:27]
  s_add_u32 s49, s49, 1
  v_cmp_lt_f32 vcc, v49, v48
  v_cvt_pk_bf16_f32 v248, v32, v33
  v_mfma_f32_16x16x32_bf16 a[56:59], a[184:187], v[196:199], a[56:59]
  v_exp_f32 v34, v162
  v_mfma_f32_16x16x32_bf16 a[60:63], a[188:191], v[196:199], a[60:63]
  s_cmp_lg_u64 vcc, 0
  ds_read_b128 a[144:147], v51 offset:4096
  ds_read_b128 a[148:151], v51 offset:5120
  v_mfma_f32_16x16x32_bf16 a[28:31], a[188:191], v[192:195], a[28:31]
  s_cbranch_scc1 Lrare68
Lrr69:
  v_exp_f32 v35, v163
  v_mfma_f32_16x16x32_bf16 a[64:67], a[160:163], v[200:203], a[64:67]
  s_cmp_lt_u32 s49, s42
  ds_read_b128 a[152:155], v51 offset:6144
  v_cvt_pk_bf16_f32 v249, v34, v35
  v_mfma_f32_16x16x32_bf16 a[96:99], a[160:163], v[204:207], a[96:99]
  v_exp_f32 v32, v164
  v_mfma_f32_16x16x32_bf16 a[100:103], a[164:167], v[204:207], a[100:103]
  ds_read_b128 a[156:159], v51 offset:7168
  v_mfma_f32_16x16x32_bf16 a[68:71], a[164:167], v[200:203], a[68:71]
  v_exp_f32 v33, v165
  v_mfma_f32_16x16x32_bf16 a[72:75], a[168:171], v[200:203], a[72:75]
  v_cvt_pk_bf16_f32 v250, v32, v33
  v_mfma_f32_16x16x32_bf16 a[104:107], a[168:171], v[204:207], a[104:107]
  v_exp_f32 v34, v166
  v_mfma_f32_16x16x32_bf16 a[108:111], a[172:175], v[204:207], a[108:111]
  v_mfma_f32_16x16x32_bf16 a[76:79], a[172:175], v[200:203], a[76:79]
  v_exp_f32 v35, v167
  v_mfma_f32_16x16x32_bf16 a[80:83], a[176:179], v[200:203], a[80:83]
  v_cvt_pk_bf16_f32 v251, v34, v35
  v_mfma_f32_16x16x32_bf16 a[112:115], a[176:179], v[204:207], a[112:115]
  v_exp_f32 v32, v168
  v_mfma_f32_16x16x32_bf16 v[56:59], a[224:227], v[248:251], 0
  v_mfma_f32_16x16x32_bf16 a[116:119], a[180:183], v[204:207], a[116:119]
  v_exp_f32 v33, v169
  v_mfma_f32_16x16x32_bf16 a[84:87], a[180:183], v[200:203], a[84:87]
  v_cvt_pk_bf16_f32 v252, v32, v33
  v_mfma_f32_16x16x32_bf16 a[88:91], a[184:187], v[200:203], a[88:91]
  v_exp_f32 v34, v170
  v_mfma_f32_16x16x32_bf16 a[120:123], a[184:187], v[204:207], a[120:123]
  v_add_f32 v36, v37, v56
  v_mfma_f32_16x16x32_bf16 a[124:127], a[188:191], v[204:207], a[124:127]
  v_exp_f32 v35, v171
  v_mfma_f32_16x16x32_bf16 a[92:95], a[188:191], v[200:203], a[92:95]
  v_cvt_pk_bf16_f32 v253, v34, v35
  s_cbranch_scc1 Lp1
Lp1x:
  s_cmp_eq_u32 s49, s50
  s_cselect_b32 s51, s40, 64
  s_cbranch_scc0 Ltr
  s_cmp_eq_u32 s49, s76
  s_cbranch_scc0 Lp1m
  s_cmp_lt_u32 s42, 6
  s_cbranch_scc0 Lps70
  s_lshl_b32 s3, s42, 5
  s_add_u32 s3, s3, s41
  s_cmp_lg_u32 s40, 0
  s_cbranch_scc1 Lpub71
  s_lshr_b32 s4, s3, 2
  s_lshl_b32 s4, s4, 5
  s_and_b32 s5, s3, 3
  s_add_u32 s4, s4, s5
  s_lshl_b32 s4, s4, 2
  s_add_u32 s4, s4, 65060864
  v_mov_b32 v24, 1
  s_mov_b64 exec, 1
  buffer_store_dword v24, off, s[20:23], s4 sc1
  s_mov_b64 exec, -1
Lpub71:
Lps70:
  s_mov_b32 s8, s74
  s_and_b32 s9, s75, 0xffff
  s_mov_b32 s10, 4194304
  s_mov_b32 s11, 0x20000
  s_and_b32 s4, s43, 3
  s_lshl_b32 s45, s4, 20
  s_lshl_b32 s4, s40, 14
  s_add_u32 s45, s45, s4
  s_lshl_b32 s4, s44, 8
  s_add_u32 s45, s45, s4
  s_mov_b32 s100, 65536
  s_mov_b32 s101, 65536
  v_lshrrev_b32 v54, 4, v1
  v_and_b32 v55, 15, v1
  v_lshlrev_b32 v30, 1, v54
  v_xor_b32 v30, v30, v55
  v_lshlrev_b32 v30, 4, v30
  v_lshl_add_u32 v53, v54, 10, v30
  v_xor_b32 v30, 128, v53
  v_add_u32 v54, 3072, v30
  v_add_u32 v55, 6144, v53
  v_add_u32 v30, 9216, v30
Lp1m:
  s_waitcnt lgkmcnt(4)
  v_mfma_f32_16x16x32_bf16 v[128:131], a[128:131], v[64:67], v[208:211]
  s_cmp_gt_u32 s51, 0
  s_cselect_b64 s[0:1], -1, 0
  v_exp_f32 v32, v172
  v_mfma_f32_16x16x32_bf16 v[128:131], a[132:135], v[68:71], v[128:131]
  s_cmp_eq_u32 s51, 0
  s_cselect_b64 s[66:67], s[56:57], s[0:1]
  s_cselect_b64 s[68:69], s[58:59], s[0:1]
  s_cselect_b64 s[34:35], s[60:61], s[0:1]
  s_cselect_b64 s[36:37], s[62:63], s[0:1]
  v_mfma_f32_16x16x32_bf16 v[128:131], a[136:139], v[72:75], v[128:131]
  s_add_u32 m0, s48, 0
  v_exp_f32 v33, v173
  v_mfma_f32_16x16x32_bf16 v[128:131], a[140:143], v[76:79], v[128:131]
  buffer_load_dwordx4 v2, s[12:15], s46 offen offset:0 sc1 lds
  v_cndmask_b32 v224, v50, v46, s[66:67]
  v_cvt_pk_bf16_f32 v254, v32, v33
  v_mfma_f32_16x16x32_bf16 v[136:139], a[140:143], v[92:95], v[216:219]
  v_exp_f32 v34, v174
  v_mfma_f32_16x16x32_bf16 v[136:139], a[136:139], v[88:91], v[136:139]
  v_cndmask_b32 v226, v50, v46, s[34:35]
  v_cndmask_b32 v225, v50, v46, s[68:69]
  v_mfma_f32_16x16x32_bf16 v[136:139], a[132:135], v[84:87], v[136:139]
  v_exp_f32 v35, v175
  v_mfma_f32_16x16x32_bf16 v[136:139], a[128:131], v[80:83], v[136:139]
  s_waitcnt lgkmcnt(0)
  v_cndmask_b32 v227, v50, v46, s[36:37]
  v_cvt_pk_bf16_f32 v255, v34, v35
  v_mfma_f32_16x16x32_bf16 v[140:143], a[144:147], v[80:83], v[220:223]
  s_cmp_gt_u32 s51, 1
  s_cselect_b64 s[0:1], -1, 0
  ds_read_b128 a[160:163], v52 offset:0
  ds_read_b128 a[164:167], v52 offset:1024
  v_mfma_f32_16x16x32_bf16 v[60:63], a[224:227], v[252:255], 0
  s_cmp_eq_u32 s51, 1
  s_cselect_b64 s[66:67], s[56:57], s[0:1]
  s_cselect_b64 s[68:69], s[58:59], s[0:1]
  s_cselect_b64 s[34:35], s[60:61], s[0:1]
  s_cselect_b64 s[36:37], s[62:63], s[0:1]
  v_mfma_f32_16x16x32_bf16 v[140:143], a[148:151], v[84:87], v[140:143]
  v_cndmask_b32 v230, v50, v46, s[34:35]
  v_exp_f32 v32, v176
  v_mfma_f32_16x16x32_bf16 v[140:143], a[152:155], v[88:91], v[140:143]
  v_cndmask_b32 v231, v50, v46, s[36:37]
  v_add_f32 v38, v39, v60
  v_max_f32 v48, v36, v38
  v_mfma_f32_16x16x32_bf16 v[140:143], a[156:159], v[92:95], v[140:143]
  ds_read_b128 a[168:171], v52 offset:2048
  v_exp_f32 v33, v177
  v_mfma_f32_16x16x32_bf16 v[132:135], a[156:159], v[76:79], v[212:215]
  buffer_load_dwordx4 v2, s[12:15], s46 offen offset:1024 sc1 lds
  v_cmp_lt_f32 vcc, v49, v48
  v_cvt_pk_bf16_f32 v200, v32, v33
  v_mfma_f32_16x16x32_bf16 v[132:135], a[152:155], v[72:75], v[132:135]
  v_exp_f32 v34, v178
  v_mfma_f32_16x16x32_bf16 v[132:135], a[148:151], v[68:71], v[132:135]
  s_cmp_lg_u64 vcc, 0
  v_cndmask_b32 v229, v50, v46, s[68:69]
  v_cndmask_b32 v228, v50, v46, s[66:67]
  v_mfma_f32_16x16x32_bf16 v[132:135], a[144:147], v[64:67], v[132:135]
  s_cbranch_scc1 Lrare72
Lrr73:
  v_exp_f32 v35, v179
  v_mfma_f32_16x16x32_bf16 v[144:147], a[128:131], v[96:99], v[224:227]
  ds_read_b128 a[172:175], v52 offset:3072
  v_cvt_pk_bf16_f32 v201, v34, v35
  v_mfma_f32_16x16x32_bf16 v[144:147], a[132:135], v[100:103], v[144:147]
  v_exp_f32 v32, v180
  v_mfma_f32_16x16x32_bf16 v[144:147], a[136:139], v[104:107], v[144:147]
  ds_read_b128 a[176:179], v52 offset:4096
  ds_read_b128 a[180:183], v52 offset:5120
  v_mfma_f32_16x16x32_bf16 v[144:147], a[140:143], v[108:111], v[144:147]
  v_exp_f32 v33, v181
  v_mfma_f32_16x16x32_bf16 v[152:155], a[140:143], v[124:127], v[232:235]
  ds_read_b128 a[184:187], v52 offset:6144
  v_cvt_pk_bf16_f32 v202, v32, v33
  v_mfma_f32_16x16x32_bf16 v[152:155], a[136:139], v[120:123], v[152:155]
  v_exp_f32 v34, v182
  v_mfma_f32_16x16x32_bf16 v[152:155], a[132:135], v[116:119], v[152:155]
  ds_read_b128 a[188:191], v52 offset:7168
  buffer_load_dwordx4 v2, s[12:15], s46 offen offset:2048 sc1 lds
  v_mfma_f32_16x16x32_bf16 v[152:155], a[128:131], v[112:115], v[152:155]
  v_exp_f32 v35, v183
  v_mfma_f32_16x16x32_bf16 v[156:159], a[144:147], v[112:115], v[236:239]
  v_cvt_pk_bf16_f32 v203, v34, v35
  v_mfma_f32_16x16x32_bf16 v[156:159], a[148:151], v[116:119], v[156:159]
  v_exp_f32 v32, v184
  v_mfma_f32_16x16x32_bf16 v[56:59], a[224:227], v[200:203], 0
  v_mfma_f32_16x16x32_bf16 v[156:159], a[152:155], v[120:123], v[156:159]
  v_exp_f32 v33, v185
  v_mfma_f32_16x16x32_bf16 v[156:159], a[156:159], v[124:127], v[156:159]
  v_cvt_pk_bf16_f32 v204, v32, v33
  v_mfma_f32_16x16x32_bf16 v[148:151], a[156:159], v[108:111], v[228:231]
  v_exp_f32 v34, v186
  v_mfma_f32_16x16x32_bf16 v[148:151], a[152:155], v[104:107], v[148:151]
  v_add_f32 v40, v41, v56
  v_mfma_f32_16x16x32_bf16 v[148:151], a[148:151], v[100:103], v[148:151]
  v_exp_f32 v35, v187
  v_mfma_f32_16x16x32_bf16 v[148:151], a[144:147], v[96:99], v[148:151]
  s_waitcnt lgkmcnt(4)
  v_cvt_pk_bf16_f32 v205, v34, v35
  v_mfma_f32_16x16x32_bf16 a[0:3], a[160:163], v[248:251], a[0:3]
  s_cmp_gt_u32 s51, 2
  s_cselect_b64 s[0:1], -1, 0
  v_exp_f32 v32, v188
  v_mfma_f32_16x16x32_bf16 a[32:35], a[160:163], v[252:255], a[32:35]
  s_cmp_eq_u32 s51, 2
  s_cselect_b64 s[66:67], s[56:57], s[0:1]
  s_cselect_b64 s[68:69], s[58:59], s[0:1]
  s_cselect_b64 s[34:35], s[60:61], s[0:1]
  s_cselect_b64 s[36:37], s[62:63], s[0:1]
  v_mfma_f32_16x16x32_bf16 a[36:39], a[164:167], v[252:255], a[36:39]
  buffer_load_dwordx4 v2, s[12:15], s46 offen offset:3072 sc1 lds
  v_exp_f32 v33, v189
  v_mfma_f32_16x16x32_bf16 a[4:7], a[164:167], v[248:251], a[4:7]
  s_add_u32 m0, s48, 4096
  v_cndmask_b32 v224, v50, v46, s[66:67]
  v_cvt_pk_bf16_f32 v206, v32, v33
  v_mfma_f32_16x16x32_bf16 a[8:11], a[168:171], v[248:251], a[8:11]
  s_add_u32 s46, s46, 4096
  v_exp_f32 v34, v190
  v_mfma_f32_16x16x32_bf16 a[40:43], a[168:171], v[252:255], a[40:43]
  v_cndmask_b32 v226, v50, v46, s[34:35]
  v_cndmask_b32 v225, v50, v46, s[68:69]
  v_mfma_f32_16x16x32_bf16 a[44:47], a[172:175], v[252:255], a[44:47]
  v_exp_f32 v35, v191
  v_mfma_f32_16x16x32_bf16 a[12:15], a[172:175], v[248:251], a[12:15]
  s_waitcnt lgkmcnt(0)
  v_cndmask_b32 v227, v50, v46, s[36:37]
  v_cvt_pk_bf16_f32 v207, v34, v35
  v_mfma_f32_16x16x32_bf16 a[16:19], a[176:179], v[248:251], a[16:19]
  ds_read_b128 a[192:195], v51 offset:8192
  ds_read_b128 a[196:199], v51 offset:9216
  v_mfma_f32_16x16x32_bf16 v[60:63], a[224:227], v[204:207], 0
  ds_read_b128 a[200:203], v51 offset:10240
  ds_read_b128 a[204:207], v51 offset:11264
  v_mfma_f32_16x16x32_bf16 a[48:51], a[176:179], v[252:255], a[48:51]
  v_exp_f32 v32, v128
  v_mfma_f32_16x16x32_bf16 a[52:55], a[180:183], v[252:255], a[52:55]
  buffer_load_dwordx4 v2, s[12:15], s46 offen offset:0 sc1 lds
  v_add_f32 v42, v43, v60
  v_max_f32 v48, v40, v42
  v_mfma_f32_16x16x32_bf16 a[20:23], a[180:183], v[248:251], a[20:23]
  v_exp_f32 v33, v129
  v_mfma_f32_16x16x32_bf16 a[24:27], a[184:187], v[248:251], a[24:27]
  v_cmp_lt_f32 vcc, v49, v48
  v_cvt_pk_bf16_f32 v192, v32, v33
  v_mfma_f32_16x16x32_bf16 a[56:59], a[184:187], v[252:255], a[56:59]
  v_exp_f32 v34, v130
  v_mfma_f32_16x16x32_bf16 a[60:63], a[188:191], v[252:255], a[60:63]
  s_cmp_lg_u64 vcc, 0
  ds_read_b128 a[208:211], v51 offset:12288
  ds_read_b128 a[212:215], v51 offset:13312
  v_mfma_f32_16x16x32_bf16 a[28:31], a[188:191], v[248:251], a[28:31]
  s_cbranch_scc1 Lrare74
Lrr75:
  v_exp_f32 v35, v131
  v_mfma_f32_16x16x32_bf16 a[64:67], a[160:163], v[200:203], a[64:67]
  ds_read_b128 a[216:219], v51 offset:14336
  v_cvt_pk_bf16_f32 v193, v34, v35
  v_mfma_f32_16x16x32_bf16 a[96:99], a[160:163], v[204:207], a[96:99]
  v_exp_f32 v32, v132
  v_mfma_f32_16x16x32_bf16 a[100:103], a[164:167], v[204:207], a[100:103]
  ds_read_b128 a[220:223], v51 offset:15360
  v_mfma_f32_16x16x32_bf16 a[68:71], a[164:167], v[200:203], a[68:71]
  v_exp_f32 v33, v133
  v_mfma_f32_16x16x32_bf16 a[72:75], a[168:171], v[200:203], a[72:75]
  buffer_load_dwordx4 v2, s[12:15], s46 offen offset:1024 sc1 lds
  v_cvt_pk_bf16_f32 v194, v32, v33
  v_mfma_f32_16x16x32_bf16 a[104:107], a[168:171], v[204:207], a[104:107]
  v_exp_f32 v34, v134
  v_mfma_f32_16x16x32_bf16 a[108:111], a[172:175], v[204:207], a[108:111]
  v_mfma_f32_16x16x32_bf16 a[76:79], a[172:175], v[200:203], a[76:79]
  v_exp_f32 v35, v135
  v_mfma_f32_16x16x32_bf16 a[80:83], a[176:179], v[200:203], a[80:83]
  s_cmp_gt_u32 s51, 3
  s_cselect_b64 s[0:1], -1, 0
  v_cvt_pk_bf16_f32 v195, v34, v35
  v_mfma_f32_16x16x32_bf16 a[112:115], a[176:179], v[204:207], a[112:115]
  s_cmp_eq_u32 s51, 3
  s_cselect_b64 s[66:67], s[56:57], s[0:1]
  s_cselect_b64 s[68:69], s[58:59], s[0:1]
  s_cselect_b64 s[34:35], s[60:61], s[0:1]
  s_cselect_b64 s[36:37], s[62:63], s[0:1]
  v_exp_f32 v32, v136
  v_mfma_f32_16x16x32_bf16 v[56:59], a[224:227], v[192:195], 0
  v_cndmask_b32 v229, v50, v46, s[68:69]
  v_cndmask_b32 v228, v50, v46, s[66:67]
  v_mfma_f32_16x16x32_bf16 a[116:119], a[180:183], v[204:207], a[116:119]
  v_exp_f32 v33, v137
  v_mfma_f32_16x16x32_bf16 a[84:87], a[180:183], v[200:203], a[84:87]
  v_cndmask_b32 v230, v50, v46, s[34:35]
  v_cvt_pk_bf16_f32 v196, v32, v33
  v_mfma_f32_16x16x32_bf16 a[88:91], a[184:187], v[200:203], a[88:91]
  v_exp_f32 v34, v138
  v_mfma_f32_16x16x32_bf16 a[120:123], a[184:187], v[204:207], a[120:123]
  v_cndmask_b32 v231, v50, v46, s[36:37]
  v_add_f32 v37, v36, v56
  v_mfma_f32_16x16x32_bf16 a[124:127], a[188:191], v[204:207], a[124:127]
  v_exp_f32 v35, v139
  v_mfma_f32_16x16x32_bf16 a[92:95], a[188:191], v[200:203], a[92:95]
  s_waitcnt lgkmcnt(4)
  buffer_load_dwordx4 v2, s[12:15], s46 offen offset:2048 sc1 lds
  v_cvt_pk_bf16_f32 v197, v34, v35
  v_mfma_f32_16x16x32_bf16 v[160:163], a[192:195], v[64:67], v[208:211]
  v_exp_f32 v32, v140
  v_mfma_f32_16x16x32_bf16 v[160:163], a[196:199], v[68:71], v[160:163]
  v_mfma_f32_16x16x32_bf16 v[160:163], a[200:203], v[72:75], v[160:163]
  v_exp_f32 v33, v141
  v_mfma_f32_16x16x32_bf16 v[160:163], a[204:207], v[76:79], v[160:163]
  ds_read_b128 a[160:163], v52 offset:8192
  v_cvt_pk_bf16_f32 v198, v32, v33
  v_mfma_f32_16x16x32_bf16 v[168:171], a[204:207], v[92:95], v[216:219]
  v_exp_f32 v34, v142
  v_mfma_f32_16x16x32_bf16 v[168:171], a[200:203], v[88:91], v[168:171]
  ds_read_b128 a[164:167], v52 offset:9216
  v_mfma_f32_16x16x32_bf16 v[168:171], a[196:199], v[84:87], v[168:171]
  v_exp_f32 v35, v143
  v_mfma_f32_16x16x32_bf16 v[168:171], a[192:195], v[80:83], v[168:171]
  s_waitcnt lgkmcnt(2)
  ds_read_b128 a[168:171], v52 offset:10240
  v_cvt_pk_bf16_f32 v199, v34, v35
  v_mfma_f32_16x16x32_bf16 v[172:175], a[208:211], v[80:83], v[220:223]
  ds_read_b128 a[172:175], v52 offset:11264
  v_mfma_f32_16x16x32_bf16 v[60:63], a[224:227], v[196:199], 0
  buffer_load_dwordx4 v2, s[12:15], s46 offen offset:3072 sc1 lds
  v_mfma_f32_16x16x32_bf16 v[172:175], a[212:215], v[84:87], v[172:175]
  s_add_u32 s46, s46, 28672
  v_exp_f32 v32, v144
  v_mfma_f32_16x16x32_bf16 v[172:175], a[216:219], v[88:91], v[172:175]
  s_xor_b32 s48, s48, 32768
  v_add_f32 v39, v38, v60
  v_max_f32 v48, v37, v39
  v_mfma_f32_16x16x32_bf16 v[172:175], a[220:223], v[92:95], v[172:175]
  s_add_u32 m0, s54, s47
  v_exp_f32 v33, v145
  v_mfma_f32_16x16x32_bf16 v[164:167], a[220:223], v[76:79], v[212:215]
  v_cmp_lt_f32 vcc, v49, v48
  v_cvt_pk_bf16_f32 v200, v32, v33
  v_mfma_f32_16x16x32_bf16 v[164:167], a[216:219], v[72:75], v[164:167]
  v_exp_f32 v34, v146
  v_mfma_f32_16x16x32_bf16 v[164:167], a[212:215], v[68:71], v[164:167]
  s_cmp_lg_u64 vcc, 0
  ds_read_b128 a[176:179], v52 offset:12288
  ds_read_b128 a[180:183], v52 offset:13312
  v_mfma_f32_16x16x32_bf16 v[164:167], a[208:211], v[64:67], v[164:167]
  s_cbranch_scc1 Lrare76
Lrr77:
  v_exp_f32 v35, v147
  v_mfma_f32_16x16x32_bf16 v[176:179], a[192:195], v[96:99], v[224:227]
  ds_read_b128 a[184:187], v52 offset:14336
  v_cvt_pk_bf16_f32 v201, v34, v35
  v_mfma_f32_16x16x32_bf16 v[176:179], a[196:199], v[100:103], v[176:179]
  v_exp_f32 v32, v148
  v_mfma_f32_16x16x32_bf16 v[176:179], a[200:203], v[104:107], v[176:179]
  ds_read_b128 a[188:191], v52 offset:15360
  v_mfma_f32_16x16x32_bf16 v[176:179], a[204:207], v[108:111], v[176:179]
  v_exp_f32 v33, v149
  v_mfma_f32_16x16x32_bf16 v[184:187], a[204:207], v[124:127], v[232:235]
  buffer_load_dwordx4 v53, s[8:11], s45 offen offset:0 sc1 lds
  v_cvt_pk_bf16_f32 v202, v32, v33
  v_mfma_f32_16x16x32_bf16 v[184:187], a[200:203], v[120:123], v[184:187]
  v_exp_f32 v34, v150
  v_mfma_f32_16x16x32_bf16 v[184:187], a[196:199], v[116:119], v[184:187]
  v_mfma_f32_16x16x32_bf16 v[184:187], a[192:195], v[112:115], v[184:187]
  v_exp_f32 v35, v151
  v_mfma_f32_16x16x32_bf16 v[188:191], a[208:211], v[112:115], v[236:239]
  v_cvt_pk_bf16_f32 v203, v34, v35
  v_mfma_f32_16x16x32_bf16 v[188:191], a[212:215], v[116:119], v[188:191]
  v_exp_f32 v32, v152
  v_mfma_f32_16x16x32_bf16 v[56:59], a[224:227], v[200:203], 0
  v_mfma_f32_16x16x32_bf16 v[188:191], a[216:219], v[120:123], v[188:191]
  v_exp_f32 v33, v153
  v_mfma_f32_16x16x32_bf16 v[188:191], a[220:223], v[124:127], v[188:191]
  v_cvt_pk_bf16_f32 v204, v32, v33
  v_mfma_f32_16x16x32_bf16 v[180:183], a[220:223], v[108:111], v[228:231]
  v_exp_f32 v34, v154
  v_mfma_f32_16x16x32_bf16 v[180:183], a[216:219], v[104:107], v[180:183]
  buffer_load_dwordx4 v54, s[8:11], s45 offen offset:1024 sc1 lds
  v_add_f32 v41, v40, v56
  v_mfma_f32_16x16x32_bf16 v[180:183], a[212:215], v[100:103], v[180:183]
  v_exp_f32 v35, v155
  v_mfma_f32_16x16x32_bf16 v[180:183], a[208:211], v[96:99], v[180:183]
  s_waitcnt lgkmcnt(4)
  v_cvt_pk_bf16_f32 v205, v34, v35
  v_mfma_f32_16x16x32_bf16 a[0:3], a[160:163], v[192:195], a[0:3]
  s_cmp_gt_u32 s51, 0
  s_cselect_b64 s[0:1], -1, 0
  v_exp_f32 v32, v156
  v_mfma_f32_16x16x32_bf16 a[32:35], a[160:163], v[196:199], a[32:35]
  s_cmp_eq_u32 s51, 0
  s_cselect_b64 s[66:67], s[56:57], s[0:1]
  s_cselect_b64 s[68:69], s[58:59], s[0:1]
  s_cselect_b64 s[34:35], s[60:61], s[0:1]
  s_cselect_b64 s[36:37], s[62:63], s[0:1]
  v_mfma_f32_16x16x32_bf16 a[36:39], a[164:167], v[196:199], a[36:39]
  v_exp_f32 v33, v157
  v_mfma_f32_16x16x32_bf16 a[4:7], a[164:167], v[192:195], a[4:7]
  v_cndmask_b32 v232, v50, v47, s[66:67]
  v_cvt_pk_bf16_f32 v206, v32, v33
  v_mfma_f32_16x16x32_bf16 a[8:11], a[168:171], v[192:195], a[8:11]
  v_exp_f32 v34, v158
  v_mfma_f32_16x16x32_bf16 a[40:43], a[168:171], v[196:199], a[40:43]
  v_cndmask_b32 v234, v50, v47, s[34:35]
  v_cndmask_b32 v233, v50, v47, s[68:69]
  v_mfma_f32_16x16x32_bf16 a[44:47], a[172:175], v[196:199], a[44:47]
  v_exp_f32 v35, v159
  v_mfma_f32_16x16x32_bf16 a[12:15], a[172:175], v[192:195], a[12:15]
  s_waitcnt lgkmcnt(0)
  buffer_load_dwordx4 v55, s[8:11], s45 offen offset:2048 sc1 lds
  v_cndmask_b32 v235, v50, v47, s[36:37]
  v_cvt_pk_bf16_f32 v207, v34, v35
  v_mfma_f32_16x16x32_bf16 a[16:19], a[176:179], v[192:195], a[16:19]
  ds_read_b128 a[192:195], v51 offset:16384
  ds_read_b128 a[196:199], v51 offset:17408
  v_mfma_f32_16x16x32_bf16 v[60:63], a[224:227], v[204:207], 0
  ds_read_b128 a[200:203], v51 offset:18432
  ds_read_b128 a[204:207], v51 offset:19456
  v_mfma_f32_16x16x32_bf16 a[48:51], a[176:179], v[196:199], a[48:51]
  v_exp_f32 v32, v160
  v_mfma_f32_16x16x32_bf16 a[52:55], a[180:183], v[196:199], a[52:55]
  v_add_f32 v43, v42, v60
  v_max_f32 v48, v41, v43
  v_mfma_f32_16x16x32_bf16 a[20:23], a[180:183], v[192:195], a[20:23]
  v_exp_f32 v33, v161
  v_mfma_f32_16x16x32_bf16 a[24:27], a[184:187], v[192:195], a[24:27]
  v_cmp_lt_f32 vcc, v49, v48
  v_cvt_pk_bf16_f32 v248, v32, v33
  v_mfma_f32_16x16x32_bf16 a[56:59], a[184:187], v[196:199], a[56:59]
  v_exp_f32 v34, v162
  v_mfma_f32_16x16x32_bf16 a[60:63], a[188:191], v[196:199], a[60:63]
  s_cmp_lg_u64 vcc, 0
  ds_read_b128 a[208:211], v51 offset:20480
  ds_read_b128 a[212:215], v51 offset:21504
  v_mfma_f32_16x16x32_bf16 a[28:31], a[188:191], v[192:195], a[28:31]
  s_cbranch_scc1 Lrare78
Lrr79:
  v_exp_f32 v35, v163
  v_mfma_f32_16x16x32_bf16 a[64:67], a[160:163], v[200:203], a[64:67]
  ds_read_b128 a[216:219], v51 offset:22528
  v_cvt_pk_bf16_f32 v249, v34, v35
  v_mfma_f32_16x16x32_bf16 a[96:99], a[160:163], v[204:207], a[96:99]
  v_exp_f32 v32, v164
  v_mfma_f32_16x16x32_bf16 a[100:103], a[164:167], v[204:207], a[100:103]
  ds_read_b128 a[220:223], v51 offset:23552
  buffer_load_dwordx4 v30, s[8:11], s45 offen offset:3072 sc1 lds
  v_mfma_f32_16x16x32_bf16 a[68:71], a[164:167], v[200:203], a[68:71]
  s_add_u32 m0, m0, 4096
  v_exp_f32 v33, v165
  v_mfma_f32_16x16x32_bf16 a[72:75], a[168:171], v[200:203], a[72:75]
  s_add_u32 s45, s45, s100
  v_cvt_pk_bf16_f32 v250, v32, v33
  v_mfma_f32_16x16x32_bf16 a[104:107], a[168:171], v[204:207], a[104:107]
  v_exp_f32 v34, v166
  v_mfma_f32_16x16x32_bf16 a[108:111], a[172:175], v[204:207], a[108:111]
  v_mfma_f32_16x16x32_bf16 a[76:79], a[172:175], v[200:203], a[76:79]
  v_exp_f32 v35, v167
  v_mfma_f32_16x16x32_bf16 a[80:83], a[176:179], v[200:203], a[80:83]
  s_cmp_gt_u32 s51, 1
  s_cselect_b64 s[0:1], -1, 0
  v_cvt_pk_bf16_f32 v251, v34, v35
  v_mfma_f32_16x16x32_bf16 a[112:115], a[176:179], v[204:207], a[112:115]
  s_cmp_eq_u32 s51, 1
  s_cselect_b64 s[66:67], s[56:57], s[0:1]
  s_cselect_b64 s[68:69], s[58:59], s[0:1]
  s_cselect_b64 s[34:35], s[60:61], s[0:1]
  s_cselect_b64 s[36:37], s[62:63], s[0:1]
  v_exp_f32 v32, v168
  v_mfma_f32_16x16x32_bf16 v[56:59], a[224:227], v[248:251], 0
  v_cndmask_b32 v237, v50, v47, s[68:69]
  v_cndmask_b32 v236, v50, v47, s[66:67]
  v_mfma_f32_16x16x32_bf16 a[116:119], a[180:183], v[204:207], a[116:119]
  v_exp_f32 v33, v169
  v_mfma_f32_16x16x32_bf16 a[84:87], a[180:183], v[200:203], a[84:87]
  v_cndmask_b32 v238, v50, v47, s[34:35]
  v_cvt_pk_bf16_f32 v252, v32, v33
  v_mfma_f32_16x16x32_bf16 a[88:91], a[184:187], v[200:203], a[88:91]
  v_exp_f32 v34, v170
  v_mfma_f32_16x16x32_bf16 a[120:123], a[184:187], v[204:207], a[120:123]
  v_cndmask_b32 v239, v50, v47, s[36:37]
  v_add_f32 v36, v37, v56
  v_mfma_f32_16x16x32_bf16 a[124:127], a[188:191], v[204:207], a[124:127]
  v_exp_f32 v35, v171
  v_mfma_f32_16x16x32_bf16 a[92:95], a[188:191], v[200:203], a[92:95]
  s_waitcnt lgkmcnt(4)
  buffer_load_dwordx4 v53, s[8:11], s45 offen offset:0 sc1 lds
  v_cvt_pk_bf16_f32 v253, v34, v35
  v_mfma_f32_16x16x32_bf16 v[128:131], a[192:195], v[64:67], v[208:211]
  v_exp_f32 v32, v172
  v_mfma_f32_16x16x32_bf16 v[128:131], a[196:199], v[68:71], v[128:131]
  v_mfma_f32_16x16x32_bf16 v[128:131], a[200:203], v[72:75], v[128:131]
  v_exp_f32 v33, v173
  v_mfma_f32_16x16x32_bf16 v[128:131], a[204:207], v[76:79], v[128:131]
  ds_read_b128 a[160:163], v52 offset:16384
  v_cvt_pk_bf16_f32 v254, v32, v33
  v_mfma_f32_16x16x32_bf16 v[136:139], a[204:207], v[92:95], v[216:219]
  v_exp_f32 v34, v174
  v_mfma_f32_16x16x32_bf16 v[136:139], a[200:203], v[88:91], v[136:139]
  ds_read_b128 a[164:167], v52 offset:17408
  buffer_load_dwordx4 v54, s[8:11], s45 offen offset:1024 sc1 lds
  v_mfma_f32_16x16x32_bf16 v[136:139], a[196:199], v[84:87], v[136:139]
  v_exp_f32 v35, v175
  v_mfma_f32_16x16x32_bf16 v[136:139], a[192:195], v[80:83], v[136:139]
  s_waitcnt lgkmcnt(2)
  ds_read_b128 a[168:171], v52 offset:18432
  v_cvt_pk_bf16_f32 v255, v34, v35
  v_mfma_f32_16x16x32_bf16 v[140:143], a[208:211], v[80:83], v[220:223]
  ds_read_b128 a[172:175], v52 offset:19456
  v_mfma_f32_16x16x32_bf16 v[60:63], a[224:227], v[252:255], 0
  v_mfma_f32_16x16x32_bf16 v[140:143], a[212:215], v[84:87], v[140:143]
  v_exp_f32 v32, v176
  v_mfma_f32_16x16x32_bf16 v[140:143], a[216:219], v[88:91], v[140:143]
  v_add_f32 v38, v39, v60
  v_max_f32 v48, v36, v38
  v_mfma_f32_16x16x32_bf16 v[140:143], a[220:223], v[92:95], v[140:143]
  v_exp_f32 v33, v177
  v_mfma_f32_16x16x32_bf16 v[132:135], a[220:223], v[76:79], v[212:215]
  v_cmp_lt_f32 vcc, v49, v48
  v_cvt_pk_bf16_f32 v200, v32, v33
  v_mfma_f32_16x16x32_bf16 v[132:135], a[216:219], v[72:75], v[132:135]
  v_exp_f32 v34, v178
  v_mfma_f32_16x16x32_bf16 v[132:135], a[212:215], v[68:71], v[132:135]
  s_cmp_lg_u64 vcc, 0
  ds_read_b128 a[176:179], v52 offset:20480
  ds_read_b128 a[180:183], v52 offset:21504
  v_mfma_f32_16x16x32_bf16 v[132:135], a[208:211], v[64:67], v[132:135]
  s_cbranch_scc1 Lrare80
Lrr81:
  v_exp_f32 v35, v179
  s_nop 0
  ds_read_b128 a[184:187], v52 offset:22528
  v_cvt_pk_bf16_f32 v201, v34, v35
  v_exp_f32 v32, v180
  s_nop 0
  ds_read_b128 a[188:191], v52 offset:23552
  buffer_load_dwordx4 v55, s[8:11], s45 offen offset:2048 sc1 lds
  v_exp_f32 v33, v181
  v_mfma_f32_16x16x32_bf16 v[152:155], a[192:195], v[112:115], v[232:235]
  v_cvt_pk_bf16_f32 v202, v32, v33
  v_mfma_f32_16x16x32_bf16 v[152:155], a[196:199], v[116:119], v[152:155]
  v_exp_f32 v34, v182
  v_mfma_f32_16x16x32_bf16 v[152:155], a[200:203], v[120:123], v[152:155]
  v_mfma_f32_16x16x32_bf16 v[152:155], a[204:207], v[124:127], v[152:155]
  v_exp_f32 v35, v183
  v_mfma_f32_16x16x32_bf16 v[156:159], a[208:211], v[112:115], v[236:239]
  v_cvt_pk_bf16_f32 v203, v34, v35
  v_mfma_f32_16x16x32_bf16 v[156:159], a[212:215], v[116:119], v[156:159]
  v_exp_f32 v32, v184
  v_mfma_f32_16x16x32_bf16 v[56:59], a[224:227], v[200:203], 0
  buffer_load_dwordx4 v30, s[8:11], s45 offen offset:3072 sc1 lds
  v_mfma_f32_16x16x32_bf16 v[156:159], a[216:219], v[120:123], v[156:159]
  s_add_u32 s45, s45, s101
  v_exp_f32 v33, v185
  v_mfma_f32_16x16x32_bf16 v[156:159], a[220:223], v[124:127], v[156:159]
  v_cvt_pk_bf16_f32 v204, v32, v33
  v_exp_f32 v34, v186
  s_nop 0
  v_add_f32 v40, v41, v56
  v_exp_f32 v35, v187
  s_nop 0
  s_waitcnt lgkmcnt(4)
  v_cvt_pk_bf16_f32 v205, v34, v35
  v_mfma_f32_16x16x32_bf16 a[0:3], a[160:163], v[248:251], a[0:3]
  s_cmp_gt_u32 s51, 2
  s_cselect_b64 s[0:1], -1, 0
  v_exp_f32 v32, v188
  v_mfma_f32_16x16x32_bf16 a[32:35], a[160:163], v[252:255], a[32:35]
  s_cmp_eq_u32 s51, 2
  s_cselect_b64 s[66:67], s[56:57], s[0:1]
  s_cselect_b64 s[68:69], s[58:59], s[0:1]
  s_cselect_b64 s[34:35], s[60:61], s[0:1]
  s_cselect_b64 s[36:37], s[62:63], s[0:1]
  v_mfma_f32_16x16x32_bf16 a[36:39], a[164:167], v[252:255], a[36:39]
  v_exp_f32 v33, v189
  v_mfma_f32_16x16x32_bf16 a[4:7], a[164:167], v[248:251], a[4:7]
  v_cndmask_b32 v232, v50, v47, s[66:67]
  v_cvt_pk_bf16_f32 v206, v32, v33
  v_mfma_f32_16x16x32_bf16 a[8:11], a[168:171], v[248:251], a[8:11]
  v_exp_f32 v34, v190
  v_mfma_f32_16x16x32_bf16 a[40:43], a[168:171], v[252:255], a[40:43]
  v_cndmask_b32 v234, v50, v47, s[34:35]
  v_cndmask_b32 v233, v50, v47, s[68:69]
  v_mfma_f32_16x16x32_bf16 a[44:47], a[172:175], v[252:255], a[44:47]
  v_exp_f32 v35, v191
  v_mfma_f32_16x16x32_bf16 a[12:15], a[172:175], v[248:251], a[12:15]
  s_waitcnt lgkmcnt(0)
  v_cndmask_b32 v235, v50, v47, s[36:37]
  v_cvt_pk_bf16_f32 v207, v34, v35
  v_mfma_f32_16x16x32_bf16 a[16:19], a[176:179], v[248:251], a[16:19]
  ds_read_b128 a[192:195], v51 offset:24576
  ds_read_b128 a[196:199], v51 offset:25600
  v_mfma_f32_16x16x32_bf16 v[60:63], a[224:227], v[204:207], 0
  ds_read_b128 a[200:203], v51 offset:26624
  ds_read_b128 a[204:207], v51 offset:27648
  v_mfma_f32_16x16x32_bf16 a[48:51], a[176:179], v[252:255], a[48:51]
  v_exp_f32 v32, v128
  v_mfma_f32_16x16x32_bf16 a[52:55], a[180:183], v[252:255], a[52:55]
  v_add_f32 v42, v43, v60
  v_max_f32 v48, v40, v42
  v_mfma_f32_16x16x32_bf16 a[20:23], a[180:183], v[248:251], a[20:23]
  v_exp_f32 v33, v129
  v_mfma_f32_16x16x32_bf16 a[24:27], a[184:187], v[248:251], a[24:27]
  v_cmp_lt_f32 vcc, v49, v48
  v_cvt_pk_bf16_f32 v192, v32, v33
  v_mfma_f32_16x16x32_bf16 a[56:59], a[184:187], v[252:255], a[56:59]
  v_exp_f32 v34, v130
  v_mfma_f32_16x16x32_bf16 a[60:63], a[188:191], v[252:255], a[60:63]
  s_cmp_lg_u64 vcc, 0
  ds_read_b128 a[208:211], v51 offset:28672
  ds_read_b128 a[212:215], v51 offset:29696
  v_mfma_f32_16x16x32_bf16 a[28:31], a[188:191], v[248:251], a[28:31]
  s_cbranch_scc1 Lrare82
Lrr83:
  v_exp_f32 v35, v131
  v_mfma_f32_16x16x32_bf16 a[64:67], a[160:163], v[200:203], a[64:67]
  ds_read_b128 a[216:219], v51 offset:30720
  v_cvt_pk_bf16_f32 v193, v34, v35
  v_mfma_f32_16x16x32_bf16 a[96:99], a[160:163], v[204:207], a[96:99]
  v_exp_f32 v32, v132
  v_mfma_f32_16x16x32_bf16 a[100:103], a[164:167], v[204:207], a[100:103]
  ds_read_b128 a[220:223], v51 offset:31744
  v_mfma_f32_16x16x32_bf16 a[68:71], a[164:167], v[200:203], a[68:71]
  v_exp_f32 v33, v133
  v_mfma_f32_16x16x32_bf16 a[72:75], a[168:171], v[200:203], a[72:75]
  v_cvt_pk_bf16_f32 v194, v32, v33
  v_mfma_f32_16x16x32_bf16 a[104:107], a[168:171], v[204:207], a[104:107]
  v_exp_f32 v34, v134
  v_mfma_f32_16x16x32_bf16 a[108:111], a[172:175], v[204:207], a[108:111]
  v_mfma_f32_16x16x32_bf16 a[76:79], a[172:175], v[200:203], a[76:79]
  v_exp_f32 v35, v135
  v_mfma_f32_16x16x32_bf16 a[80:83], a[176:179], v[200:203], a[80:83]
  s_cmp_gt_u32 s51, 3
  s_cselect_b64 s[0:1], -1, 0
  v_cvt_pk_bf16_f32 v195, v34, v35
  v_mfma_f32_16x16x32_bf16 a[112:115], a[176:179], v[204:207], a[112:115]
  s_cmp_eq_u32 s51, 3
  s_cselect_b64 s[66:67], s[56:57], s[0:1]
  s_cselect_b64 s[68:69], s[58:59], s[0:1]
  s_cselect_b64 s[34:35], s[60:61], s[0:1]
  s_cselect_b64 s[36:37], s[62:63], s[0:1]
  v_exp_f32 v32, v136
  v_mfma_f32_16x16x32_bf16 v[56:59], a[224:227], v[192:195], 0
  v_cndmask_b32 v237, v50, v47, s[68:69]
  v_cndmask_b32 v236, v50, v47, s[66:67]
  v_mfma_f32_16x16x32_bf16 a[116:119], a[180:183], v[204:207], a[116:119]
  v_exp_f32 v33, v137
  v_mfma_f32_16x16x32_bf16 a[84:87], a[180:183], v[200:203], a[84:87]
  v_cndmask_b32 v238, v50, v47, s[34:35]
  v_cvt_pk_bf16_f32 v196, v32, v33
  v_mfma_f32_16x16x32_bf16 a[88:91], a[184:187], v[200:203], a[88:91]
  v_exp_f32 v34, v138
  v_mfma_f32_16x16x32_bf16 a[120:123], a[184:187], v[204:207], a[120:123]
  v_cndmask_b32 v239, v50, v47, s[36:37]
  v_add_f32 v37, v36, v56
  v_mfma_f32_16x16x32_bf16 a[124:127], a[188:191], v[204:207], a[124:127]
  v_exp_f32 v35, v139
  v_mfma_f32_16x16x32_bf16 a[92:95], a[188:191], v[200:203], a[92:95]
  s_waitcnt lgkmcnt(4)
  v_cvt_pk_bf16_f32 v197, v34, v35
  v_mfma_f32_16x16x32_bf16 v[160:163], a[192:195], v[64:67], v[208:211]
  v_exp_f32 v32, v140
  v_mfma_f32_16x16x32_bf16 v[160:163], a[196:199], v[68:71], v[160:163]
  v_mfma_f32_16x16x32_bf16 v[160:163], a[200:203], v[72:75], v[160:163]
  v_exp_f32 v33, v141
  v_mfma_f32_16x16x32_bf16 v[160:163], a[204:207], v[76:79], v[160:163]
  ds_read_b128 a[160:163], v52 offset:24576
  v_cvt_pk_bf16_f32 v198, v32, v33
  v_mfma_f32_16x16x32_bf16 v[168:171], a[204:207], v[92:95], v[216:219]
  v_exp_f32 v34, v142
  v_mfma_f32_16x16x32_bf16 v[168:171], a[200:203], v[88:91], v[168:171]
  ds_read_b128 a[164:167], v52 offset:25600
  v_mfma_f32_16x16x32_bf16 v[168:171], a[196:199], v[84:87], v[168:171]
  v_exp_f32 v35, v143
  v_mfma_f32_16x16x32_bf16 v[168:171], a[192:195], v[80:83], v[168:171]
  s_waitcnt lgkmcnt(2)
  ds_read_b128 a[168:171], v52 offset:26624
  v_cvt_pk_bf16_f32 v199, v34, v35
  v_mfma_f32_16x16x32_bf16 v[172:175], a[208:211], v[80:83], v[220:223]
  ds_read_b128 a[172:175], v52 offset:27648
  v_mfma_f32_16x16x32_bf16 v[60:63], a[224:227], v[196:199], 0
  v_mfma_f32_16x16x32_bf16 v[172:175], a[212:215], v[84:87], v[172:175]
  ds_read_b128 a[176:179], v52 offset:28672
  v_mfma_f32_16x16x32_bf16 v[172:175], a[216:219], v[88:91], v[172:175]
  v_add_f32 v39, v38, v60
  v_max_f32 v48, v37, v39
  v_mfma_f32_16x16x32_bf16 v[172:175], a[220:223], v[92:95], v[172:175]
  v_mfma_f32_16x16x32_bf16 v[164:167], a[220:223], v[76:79], v[212:215]
  ds_read_b128 a[180:183], v52 offset:29696
  v_cmp_lt_f32 vcc, v49, v48
  v_mfma_f32_16x16x32_bf16 v[164:167], a[216:219], v[72:75], v[164:167]
  v_mfma_f32_16x16x32_bf16 v[164:167], a[212:215], v[68:71], v[164:167]
  s_cmp_lg_u64 vcc, 0
  ds_read_b128 a[184:187], v52 offset:30720
  v_mfma_f32_16x16x32_bf16 v[164:167], a[208:211], v[64:67], v[164:167]
  s_cbranch_scc1 Lrare84
Lrr85:
  ds_read_b128 a[188:191], v52 offset:31744
  v_mfma_f32_16x16x32_bf16 v[184:187], a[192:195], v[112:115], v[232:235]
  v_mfma_f32_16x16x32_bf16 v[184:187], a[196:199], v[116:119], v[184:187]
  v_mfma_f32_16x16x32_bf16 v[184:187], a[200:203], v[120:123], v[184:187]
  v_mfma_f32_16x16x32_bf16 v[184:187], a[204:207], v[124:127], v[184:187]
  v_mfma_f32_16x16x32_bf16 v[188:191], a[208:211], v[112:115], v[236:239]
  v_mfma_f32_16x16x32_bf16 v[188:191], a[212:215], v[116:119], v[188:191]
  v_exp_f32 v32, v152
  s_nop 0
  v_mfma_f32_16x16x32_bf16 v[188:191], a[216:219], v[120:123], v[188:191]
  v_exp_f32 v33, v153
  v_mfma_f32_16x16x32_bf16 v[188:191], a[220:223], v[124:127], v[188:191]
  v_cvt_pk_bf16_f32 v204, v32, v33
  v_exp_f32 v34, v154
  s_nop 0
  v_mov_b32 v41, v40
  v_exp_f32 v35, v155
  s_nop 0
  s_waitcnt lgkmcnt(4)
  v_cvt_pk_bf16_f32 v205, v34, v35
  v_mfma_f32_16x16x32_bf16 a[0:3], a[160:163], v[192:195], a[0:3]
  v_exp_f32 v32, v156
  v_mfma_f32_16x16x32_bf16 a[32:35], a[160:163], v[196:199], a[32:35]
  v_mfma_f32_16x16x32_bf16 a[36:39], a[164:167], v[196:199], a[36:39]
  v_exp_f32 v33, v157
  v_mfma_f32_16x16x32_bf16 a[4:7], a[164:167], v[192:195], a[4:7]
  v_cvt_pk_bf16_f32 v206, v32, v33
  v_mfma_f32_16x16x32_bf16 a[8:11], a[168:171], v[192:195], a[8:11]
  v_exp_f32 v34, v158
  v_mfma_f32_16x16x32_bf16 a[40:43], a[168:171], v[196:199], a[40:43]
  v_mfma_f32_16x16x32_bf16 a[44:47], a[172:175], v[196:199], a[44:47]
  v_exp_f32 v35, v159
  v_mfma_f32_16x16x32_bf16 a[12:15], a[172:175], v[192:195], a[12:15]
  s_waitcnt lgkmcnt(0)
  v_cvt_pk_bf16_f32 v207, v34, v35
  v_mfma_f32_16x16x32_bf16 a[16:19], a[176:179], v[192:195], a[16:19]
  s_waitcnt vmcnt(8)
  s_barrier
  v_add_u32 v51, s53, v2
  v_xor_b32 v52, 32768, v52
  v_mfma_f32_16x16x32_bf16 v[60:63], a[224:227], v[204:207], 0
  s_mov_b32 s4, s52
  ds_read_b128 a[128:131], v51 offset:0
  ds_read_b128 a[132:135], v51 offset:1024
  ds_read_b128 a[136:139], v51 offset:2048
  v_mfma_f32_16x16x32_bf16 a[48:51], a[176:179], v[196:199], a[48:51]
  s_mov_b32 s52, s53
  ds_read_b128 a[140:143], v51 offset:3072
  v_exp_f32 v32, v160
  v_mfma_f32_16x16x32_bf16 a[52:55], a[180:183], v[196:199], a[52:55]
  s_mov_b32 s53, s54
  v_add_f32 v43, v42, v60
  v_max_f32 v48, v41, v43
  v_mfma_f32_16x16x32_bf16 a[20:23], a[180:183], v[192:195], a[20:23]
  s_mov_b32 s54, s4
  v_exp_f32 v33, v161
  v_mfma_f32_16x16x32_bf16 a[24:27], a[184:187], v[192:195], a[24:27]
  s_add_u32 s49, s49, 1
  v_cmp_lt_f32 vcc, v49, v48
  v_cvt_pk_bf16_f32 v248, v32, v33
  v_mfma_f32_16x16x32_bf16 a[56:59], a[184:187], v[196:199], a[56:59]
  v_exp_f32 v34, v162
  v_mfma_f32_16x16x32_bf16 a[60:63], a[188:191], v[196:199], a[60:63]
  s_cmp_lg_u64 vcc, 0
  ds_read_b128 a[144:147], v51 offset:4096
  ds_read_b128 a[148:151], v51 offset:5120
  v_mfma_f32_16x16x32_bf16 a[28:31], a[188:191], v[192:195], a[28:31]
  s_cbranch_scc1 Lrare86
Lrr87:
  v_exp_f32 v35, v163
  s_nop 0
  ds_read_b128 a[152:155], v51 offset:6144
  v_cvt_pk_bf16_f32 v249, v34, v35
  v_mfma_f32_16x16x32_bf16 a[96:99], a[160:163], v[204:207], a[96:99]
  v_exp_f32 v32, v164
  v_mfma_f32_16x16x32_bf16 a[100:103], a[164:167], v[204:207], a[100:103]
  ds_read_b128 a[156:159], v51 offset:7168
  v_exp_f32 v33, v165
  s_nop 0
  v_cvt_pk_bf16_f32 v250, v32, v33
  v_mfma_f32_16x16x32_bf16 a[104:107], a[168:171], v[204:207], a[104:107]
  v_exp_f32 v34, v166
  v_mfma_f32_16x16x32_bf16 a[108:111], a[172:175], v[204:207], a[108:111]
  v_exp_f32 v35, v167
  s_nop 0
  v_cvt_pk_bf16_f32 v251, v34, v35
  v_mfma_f32_16x16x32_bf16 a[112:115], a[176:179], v[204:207], a[112:115]
  v_exp_f32 v32, v168
  v_mfma_f32_16x16x32_bf16 v[56:59], a[224:227], v[248:251], 0
  v_mfma_f32_16x16x32_bf16 a[116:119], a[180:183], v[204:207], a[116:119]
  v_exp_f32 v33, v169
  s_nop 0
  v_cvt_pk_bf16_f32 v252, v32, v33
  v_exp_f32 v34, v170
  v_mfma_f32_16x16x32_bf16 a[120:123], a[184:187], v[204:207], a[120:123]
  v_add_f32 v36, v37, v56
  v_mfma_f32_16x16x32_bf16 a[124:127], a[188:191], v[204:207], a[124:127]
  v_exp_f32 v35, v171
  s_nop 0
  v_cvt_pk_bf16_f32 v253, v34, v35
  s_nop 0
Ltr:
  s_sub_u32 s50, 15, s42
  s_sub_u32 s46, s46, 8192
  s_cmp_eq_u32 s49, s50
  s_cselect_b32 s51, s40, 64
  s_cmp_eq_u32 s42, 7
  s_cbranch_scc1 Lt7
  s_waitcnt lgkmcnt(4)
  v_mfma_f32_16x16x32_bf16 v[128:131], a[128:131], v[64:67], v[208:211]
  v_exp_f32 v32, v172
  v_mov_b32 v224, v44
  v_mfma_f32_16x16x32_bf16 v[128:131], a[132:135], v[68:71], v[128:131]
  s_add_u32 m0, s48, 0
  ds_read_b128 a[160:163], v51 offset:8192
  v_mov_b32 v225, v44
  v_mfma_f32_16x16x32_bf16 v[128:131], a[136:139], v[72:75], v[128:131]
  v_exp_f32 v33, v173
  v_mov_b32 v226, v44
  v_mfma_f32_16x16x32_bf16 v[128:131], a[140:143], v[76:79], v[128:131]
  buffer_load_dwordx4 v2, s[12:15], s46 offen offset:0 sc1 lds
  v_cvt_pk_bf16_f32 v254, v32, v33
  v_mov_b32 v227, v44
  v_mfma_f32_16x16x32_bf16 v[136:139], a[140:143], v[92:95], v[216:219]
  v_exp_f32 v34, v174
  v_mov_b32 v228, v44
  v_mfma_f32_16x16x32_bf16 v[136:139], a[136:139], v[88:91], v[136:139]
  ds_read_b128 a[164:167], v51 offset:9216
  v_mov_b32 v229, v44
  v_mfma_f32_16x16x32_bf16 v[136:139], a[132:135], v[84:87], v[136:139]
  v_exp_f32 v35, v175
  v_mov_b32 v230, v44
  v_mfma_f32_16x16x32_bf16 v[136:139], a[128:131], v[80:83], v[136:139]
  s_waitcnt lgkmcnt(2)
  buffer_load_dwordx4 v2, s[12:15], s46 offen offset:1024 sc1 lds
  v_cvt_pk_bf16_f32 v255, v34, v35
  v_mov_b32 v231, v44
  v_mfma_f32_16x16x32_bf16 v[140:143], a[144:147], v[80:83], v[220:223]
  ds_read_b128 a[168:171], v51 offset:10240
  v_mov_b32 v232, v45
  v_mfma_f32_16x16x32_bf16 v[60:63], a[224:227], v[252:255], 0
  ds_read_b128 a[172:175], v51 offset:11264
  v_mov_b32 v233, v45
  v_mfma_f32_16x16x32_bf16 v[140:143], a[148:151], v[84:87], v[140:143]
  ds_read_b128 a[176:179], v51 offset:12288
  v_mov_b32 v234, v45
  v_mfma_f32_16x16x32_bf16 v[140:143], a[152:155], v[88:91], v[140:143]
  v_add_f32 v38, v39, v60
  v_max_f32 v48, v36, v38
  v_mov_b32 v235, v45
  v_mfma_f32_16x16x32_bf16 v[140:143], a[156:159], v[92:95], v[140:143]
  ds_read_b128 a[180:183], v51 offset:13312
  v_mov_b32 v236, v45
  v_mfma_f32_16x16x32_bf16 v[132:135], a[156:159], v[76:79], v[212:215]
  v_cmp_lt_f32 vcc, v49, v48
  v_mov_b32 v237, v45
  v_mfma_f32_16x16x32_bf16 v[132:135], a[152:155], v[72:75], v[132:135]
  s_waitcnt lgkmcnt(2)
  v_mov_b32 v238, v45
  v_mov_b32 v239, v45
  v_mfma_f32_16x16x32_bf16 v[132:135], a[148:151], v[68:71], v[132:135]
  s_cmp_lg_u64 vcc, 0
  ds_read_b128 a[184:187], v51 offset:14336
  ds_read_b128 a[188:191], v51 offset:15360
  v_mfma_f32_16x16x32_bf16 v[132:135], a[144:147], v[64:67], v[132:135]
  s_cbranch_scc1 Lrare100
Lrr101:
  ds_read_b128 a[192:195], v52 offset:0
  v_mfma_f32_16x16x32_bf16 v[144:147], a[160:163], v[64:67], v[224:227]
  ds_read_b128 a[196:199], v52 offset:1024
  buffer_load_dwordx4 v2, s[12:15], s46 offen offset:2048 sc1 lds
  v_mfma_f32_16x16x32_bf16 v[144:147], a[164:167], v[68:71], v[144:147]
  ds_read_b128 a[200:203], v52 offset:2048
  v_mfma_f32_16x16x32_bf16 v[144:147], a[168:171], v[72:75], v[144:147]
  buffer_load_dwordx4 v2, s[12:15], s46 offen offset:3072 sc1 lds
  v_mfma_f32_16x16x32_bf16 v[144:147], a[172:175], v[76:79], v[144:147]
  s_add_u32 m0, s48, 4096
  ds_read_b128 a[204:207], v52 offset:3072
  v_mfma_f32_16x16x32_bf16 v[152:155], a[172:175], v[92:95], v[232:235]
  s_add_u32 s46, s46, 4096
  v_mfma_f32_16x16x32_bf16 v[152:155], a[168:171], v[88:91], v[152:155]
  ds_read_b128 a[208:211], v52 offset:4096
  v_mfma_f32_16x16x32_bf16 v[152:155], a[164:167], v[84:87], v[152:155]
  v_mfma_f32_16x16x32_bf16 v[152:155], a[160:163], v[80:83], v[152:155]
  s_waitcnt lgkmcnt(5)
  v_mfma_f32_16x16x32_bf16 v[156:159], a[176:179], v[80:83], v[236:239]
  ds_read_b128 a[212:215], v52 offset:5120
  buffer_load_dwordx4 v2, s[12:15], s46 offen offset:0 sc1 lds
  v_mfma_f32_16x16x32_bf16 v[156:159], a[180:183], v[84:87], v[156:159]
  v_exp_f32 v32, v184
  s_nop 0
  ds_read_b128 a[216:219], v52 offset:6144
  v_mfma_f32_16x16x32_bf16 v[156:159], a[184:187], v[88:91], v[156:159]
  v_exp_f32 v33, v185
  v_mfma_f32_16x16x32_bf16 v[156:159], a[188:191], v[92:95], v[156:159]
  ds_read_b128 a[220:223], v52 offset:7168
  v_cvt_pk_bf16_f32 v204, v32, v33
  v_mfma_f32_16x16x32_bf16 v[148:151], a[188:191], v[76:79], v[228:231]
  v_exp_f32 v34, v186
  v_mfma_f32_16x16x32_bf16 v[148:151], a[184:187], v[72:75], v[148:151]
  buffer_load_dwordx4 v2, s[12:15], s46 offen offset:1024 sc1 lds
  v_mov_b32 v40, v41
  v_mfma_f32_16x16x32_bf16 v[148:151], a[180:183], v[68:71], v[148:151]
  v_exp_f32 v35, v187
  v_mfma_f32_16x16x32_bf16 v[148:151], a[176:179], v[64:67], v[148:151]
  s_waitcnt lgkmcnt(4)
  v_cvt_pk_bf16_f32 v205, v34, v35
  v_mfma_f32_16x16x32_bf16 a[0:3], a[192:195], v[248:251], a[0:3]
  v_exp_f32 v32, v188
  v_mfma_f32_16x16x32_bf16 a[32:35], a[192:195], v[252:255], a[32:35]
  v_mfma_f32_16x16x32_bf16 a[36:39], a[196:199], v[252:255], a[36:39]
  v_exp_f32 v33, v189
  v_mfma_f32_16x16x32_bf16 a[4:7], a[196:199], v[248:251], a[4:7]
  buffer_load_dwordx4 v2, s[12:15], s46 offen offset:2048 sc1 lds
  v_cvt_pk_bf16_f32 v206, v32, v33
  v_mfma_f32_16x16x32_bf16 a[8:11], a[200:203], v[248:251], a[8:11]
  v_exp_f32 v34, v190
  v_mfma_f32_16x16x32_bf16 a[40:43], a[200:203], v[252:255], a[40:43]
  v_mfma_f32_16x16x32_bf16 a[44:47], a[204:207], v[252:255], a[44:47]
  v_exp_f32 v35, v191
  v_mfma_f32_16x16x32_bf16 a[12:15], a[204:207], v[248:251], a[12:15]
  s_waitcnt lgkmcnt(0)
  v_cvt_pk_bf16_f32 v207, v34, v35
  v_mfma_f32_16x16x32_bf16 a[16:19], a[208:211], v[248:251], a[16:19]
  v_mfma_f32_16x16x32_bf16 v[60:63], a[224:227], v[204:207], 0
  buffer_load_dwordx4 v2, s[12:15], s46 offen offset:3072 sc1 lds
  v_mfma_f32_16x16x32_bf16 a[48:51], a[208:211], v[252:255], a[48:51]
  s_add_u32 s46, s46, 28672
  v_exp_f32 v32, v128
  v_mfma_f32_16x16x32_bf16 a[52:55], a[212:215], v[252:255], a[52:55]
  s_xor_b32 s48, s48, 32768
  buffer_store_dwordx4 v[20:23], v2, s[20:23], s87 offen sc1
  v_add_f32 v42, v43, v60
  v_max_f32 v48, v40, v42
  v_mfma_f32_16x16x32_bf16 a[20:23], a[212:215], v[248:251], a[20:23]
  s_add_u32 m0, s54, s47
  v_exp_f32 v33, v129
  v_mfma_f32_16x16x32_bf16 a[24:27], a[216:219], v[248:251], a[24:27]
  v_cmp_lt_f32 vcc, v49, v48
  v_cvt_pk_bf16_f32 v192, v32, v33
  v_mfma_f32_16x16x32_bf16 a[56:59], a[216:219], v[252:255], a[56:59]
  buffer_store_dwordx4 v[20:23], v26, s[20:23], s88 offen sc1
  v_exp_f32 v34, v130
  v_mfma_f32_16x16x32_bf16 a[60:63], a[220:223], v[252:255], a[60:63]
  s_cmp_lg_u64 vcc, 0
  ds_read_b128 a[160:163], v51 offset:16384
  ds_read_b128 a[164:167], v51 offset:17408
  v_mfma_f32_16x16x32_bf16 a[28:31], a[220:223], v[248:251], a[28:31]
  s_cbranch_scc1 Lrare102
Lrr103:
  v_exp_f32 v35, v131
  s_nop 0
  s_add_u32 s87, s87, 1024
  ds_read_b128 a[168:171], v51 offset:18432
  v_cvt_pk_bf16_f32 v193, v34, v35
  v_mfma_f32_16x16x32_bf16 a[96:99], a[192:195], v[204:207], a[96:99]
  s_add_u32 s88, s88, 512
  v_exp_f32 v32, v132
  v_mfma_f32_16x16x32_bf16 a[100:103], a[196:199], v[204:207], a[100:103]
  ds_read_b128 a[172:175], v51 offset:19456
  buffer_load_dwordx4 v53, s[8:11], s45 offen offset:0 sc1 lds
  v_exp_f32 v33, v133
  s_nop 0
  buffer_load_dwordx4 v54, s[8:11], s45 offen offset:1024 sc1 lds
  v_cvt_pk_bf16_f32 v194, v32, v33
  v_mfma_f32_16x16x32_bf16 a[104:107], a[200:203], v[204:207], a[104:107]
  v_exp_f32 v34, v134
  v_mfma_f32_16x16x32_bf16 a[108:111], a[204:207], v[204:207], a[108:111]
  ds_read_b128 a[176:179], v51 offset:20480
  buffer_store_dwordx4 v[20:23], v2, s[20:23], s87 offen sc1
  v_exp_f32 v35, v135
  s_nop 0
  ds_read_b128 a[180:183], v51 offset:21504
  v_cvt_pk_bf16_f32 v195, v34, v35
  v_mfma_f32_16x16x32_bf16 a[112:115], a[208:211], v[204:207], a[112:115]
  buffer_store_dwordx4 v[20:23], v26, s[20:23], s88 offen sc1
  v_exp_f32 v32, v136
  v_mfma_f32_16x16x32_bf16 v[56:59], a[224:227], v[192:195], 0
  s_add_u32 s87, s87, 1024
  ds_read_b128 a[184:187], v51 offset:22528
  ds_read_b128 a[188:191], v51 offset:23552
  v_mfma_f32_16x16x32_bf16 a[116:119], a[212:215], v[204:207], a[116:119]
  s_add_u32 s88, s88, 512
  v_exp_f32 v33, v137
  s_nop 0
  buffer_load_dwordx4 v55, s[8:11], s45 offen offset:2048 sc1 lds
  v_cvt_pk_bf16_f32 v196, v32, v33
  v_exp_f32 v34, v138
  v_mfma_f32_16x16x32_bf16 a[120:123], a[216:219], v[204:207], a[120:123]
  ds_read_b128 a[192:195], v51 offset:24576
  buffer_store_dwordx4 v[20:23], v2, s[20:23], s87 offen sc1
  v_add_f32 v37, v36, v56
  v_mfma_f32_16x16x32_bf16 a[124:127], a[220:223], v[204:207], a[124:127]
  v_exp_f32 v35, v139
  s_nop 0
  s_waitcnt lgkmcnt(5)
  ds_read_b128 a[196:199], v51 offset:25600
  v_cvt_pk_bf16_f32 v197, v34, v35
  v_mfma_f32_16x16x32_bf16 v[160:163], a[160:163], v[64:67], v[208:211]
  v_exp_f32 v32, v140
  v_mfma_f32_16x16x32_bf16 v[160:163], a[164:167], v[68:71], v[160:163]
  ds_read_b128 a[200:203], v51 offset:26624
  ds_read_b128 a[204:207], v51 offset:27648
  v_mfma_f32_16x16x32_bf16 v[160:163], a[168:171], v[72:75], v[160:163]
  v_exp_f32 v33, v141
  v_mfma_f32_16x16x32_bf16 v[160:163], a[172:175], v[76:79], v[160:163]
  buffer_load_dwordx4 v30, s[8:11], s45 offen offset:3072 sc1 lds
  v_cvt_pk_bf16_f32 v198, v32, v33
  v_mfma_f32_16x16x32_bf16 v[168:171], a[172:175], v[92:95], v[216:219]
  s_add_u32 m0, m0, 4096
  v_rcp_f32 v40, v40
  v_rcp_f32 v42, v42
  v_exp_f32 v34, v142
  v_mfma_f32_16x16x32_bf16 v[168:171], a[168:171], v[88:91], v[168:171]
  s_add_u32 s45, s45, s100
  ds_read_b128 a[208:211], v51 offset:28672
  buffer_store_dwordx4 v[20:23], v26, s[20:23], s88 offen sc1
  v_accvgpr_read_b32 v4, a64
  v_accvgpr_read_b32 v5, a65
  v_accvgpr_read_b32 v6, a66
  v_mfma_f32_16x16x32_bf16 v[168:171], a[164:167], v[84:87], v[168:171]
  s_add_u32 s87, s87, 1024
  v_accvgpr_read_b32 v7, a67
  v_accvgpr_read_b32 v8, a68
  v_exp_f32 v35, v143
  v_mfma_f32_16x16x32_bf16 v[168:171], a[160:163], v[80:83], v[168:171]
  s_waitcnt lgkmcnt(5)
  ds_read_b128 a[212:215], v51 offset:29696
  v_accvgpr_read_b32 v9, a69
  v_accvgpr_read_b32 v10, a70
  v_accvgpr_read_b32 v11, a71
  v_cvt_pk_bf16_f32 v199, v34, v35
  v_mfma_f32_16x16x32_bf16 v[172:175], a[176:179], v[80:83], v[220:223]
  s_add_u32 s88, s88, 512
  ds_read_b128 a[216:219], v51 offset:30720
  buffer_load_dwordx4 v53, s[8:11], s45 offen offset:0 sc1 lds
  v_mul_f32 v4, v4, v40
  v_mul_f32 v5, v5, v40
  v_mfma_f32_16x16x32_bf16 v[60:63], a[224:227], v[196:199], 0
  s_lshl_b32 s72, s2, 2
  ds_read_b128 a[220:223], v51 offset:31744
  v_mul_f32 v6, v6, v40
  v_mul_f32 v7, v7, v40
  v_mul_f32 v8, v8, v40
  v_mul_f32 v9, v9, v40
  v_mfma_f32_16x16x32_bf16 v[172:175], a[180:183], v[84:87], v[172:175]
  s_add_u32 s72, s72, s40
  v_mul_f32 v10, v10, v40
  v_mul_f32 v11, v11, v40
  v_cvt_pk_bf16_f32 v96, v4, v5
  v_exp_f32 v32, v144
  v_mfma_f32_16x16x32_bf16 v[172:175], a[184:187], v[88:91], v[172:175]
  s_lshl_b32 s72, s72, 11
  v_cvt_pk_bf16_f32 v97, v6, v7
  v_cvt_pk_bf16_f32 v98, v8, v9
  v_add_f32 v39, v38, v60
  v_max_f32 v48, v37, v39
  v_mfma_f32_16x16x32_bf16 v[172:175], a[188:191], v[92:95], v[172:175]
  v_lshlrev_b32 v24, 1, v2
  v_cvt_pk_bf16_f32 v99, v10, v11
  buffer_store_dwordx4 v[96:99], v2, s[20:23], s38 offen offset:0 sc1
  v_exp_f32 v33, v145
  v_mfma_f32_16x16x32_bf16 v[164:167], a[188:191], v[76:79], v[212:215]
  s_mov_b32 s24, s78
  v_accvgpr_read_b32 v12, a72
  v_accvgpr_read_b32 v13, a73
  v_cmp_lt_f32 vcc, v49, v48
  v_cvt_pk_bf16_f32 v200, v32, v33
  v_mfma_f32_16x16x32_bf16 v[164:167], a[184:187], v[72:75], v[164:167]
  s_waitcnt lgkmcnt(4)
  v_accvgpr_read_b32 v14, a74
  v_accvgpr_read_b32 v15, a75
  v_accvgpr_read_b32 v16, a76
  v_exp_f32 v34, v146
  v_mfma_f32_16x16x32_bf16 v[164:167], a[180:183], v[68:71], v[164:167]
  s_cmp_lg_u64 vcc, 0
  ds_read_b128 a[160:163], v52 offset:8192
  buffer_load_dwordx4 v54, s[8:11], s45 offen offset:1024 sc1 lds
  v_accvgpr_read_b32 v17, a77
  v_accvgpr_read_b32 v18, a78
  v_accvgpr_read_b32 v19, a79
  v_mfma_f32_16x16x32_bf16 v[164:167], a[176:179], v[64:67], v[164:167]
  s_cbranch_scc1 Lrare104
Lrr105:
  v_mul_f32 v12, v12, v40
  v_exp_f32 v35, v147
  v_mfma_f32_16x16x32_bf16 v[176:179], a[192:195], v[64:67], v[224:227]
  s_and_b32 s25, s79, 0xffff
  ds_read_b128 a[164:167], v52 offset:9216
  v_mul_f32 v13, v13, v40
  v_mul_f32 v14, v14, v40
  v_mul_f32 v15, v15, v40
  v_cvt_pk_bf16_f32 v201, v34, v35
  v_mfma_f32_16x16x32_bf16 v[176:179], a[196:199], v[68:71], v[176:179]
  s_mov_b32 s26, 1409024
  v_mul_f32 v16, v16, v40
  v_mul_f32 v17, v17, v40
  v_exp_f32 v32, v148
  v_mfma_f32_16x16x32_bf16 v[176:179], a[200:203], v[72:75], v[176:179]
  s_mov_b32 s27, 0x20000
  ds_read_b128 a[168:171], v52 offset:10240
  buffer_load_dwordx4 v55, s[8:11], s45 offen offset:2048 sc1 lds
  v_mul_f32 v18, v18, v40
  v_mul_f32 v19, v19, v40
  v_cvt_pk_bf16_f32 v100, v12, v13
  v_mfma_f32_16x16x32_bf16 v[176:179], a[204:207], v[76:79], v[176:179]
  v_cvt_pk_bf16_f32 v101, v14, v15
  v_cvt_pk_bf16_f32 v102, v16, v17
  v_cvt_pk_bf16_f32 v103, v18, v19
  v_exp_f32 v33, v149
  v_mfma_f32_16x16x32_bf16 v[184:187], a[204:207], v[92:95], v[232:235]
  ds_read_b128 a[172:175], v52 offset:11264
  buffer_store_dwordx4 v[100:103], v2, s[20:23], s38 offen offset:1024 sc1
  v_accvgpr_read_b32 v4, a80
  v_cvt_pk_bf16_f32 v202, v32, v33
  v_mfma_f32_16x16x32_bf16 v[184:187], a[200:203], v[88:91], v[184:187]
  v_accvgpr_read_b32 v5, a81
  v_accvgpr_read_b32 v6, a82
  v_accvgpr_read_b32 v7, a83
  v_exp_f32 v34, v150
  v_mfma_f32_16x16x32_bf16 v[184:187], a[196:199], v[84:87], v[184:187]
  ds_read_b128 a[176:179], v52 offset:12288
  buffer_load_dwordx4 v30, s[8:11], s45 offen offset:3072 sc1 lds
  v_accvgpr_read_b32 v8, a84
  v_accvgpr_read_b32 v9, a85
  v_mfma_f32_16x16x32_bf16 v[184:187], a[192:195], v[80:83], v[184:187]
  s_waitcnt lgkmcnt(5)
  v_accvgpr_read_b32 v10, a86
  v_accvgpr_read_b32 v11, a87
  v_mul_f32 v4, v4, v40
  v_exp_f32 v35, v151
  v_mfma_f32_16x16x32_bf16 v[188:191], a[208:211], v[80:83], v[236:239]
  s_add_u32 s45, s45, s101
  ds_read_b128 a[180:183], v52 offset:13312
  v_mul_f32 v5, v5, v40
  v_mul_f32 v6, v6, v40
  v_mul_f32 v7, v7, v40
  v_cvt_pk_bf16_f32 v203, v34, v35
  v_mfma_f32_16x16x32_bf16 v[188:191], a[212:215], v[84:87], v[188:191]
  v_mul_f32 v8, v8, v40
  v_mul_f32 v9, v9, v40
  v_exp_f32 v32, v152
  v_mfma_f32_16x16x32_bf16 v[56:59], a[224:227], v[200:203], 0
  ds_read_b128 a[184:187], v52 offset:14336
  buffer_load_dword v27, v24, s[24:27], s72 offen
  v_mul_f32 v10, v10, v40
  v_mul_f32 v11, v11, v40
  v_cvt_pk_bf16_f32 v104, v4, v5
  v_mfma_f32_16x16x32_bf16 v[188:191], a[216:219], v[88:91], v[188:191]
  s_lshl_b32 s72, s2, 2
  v_cvt_pk_bf16_f32 v105, v6, v7
  v_cvt_pk_bf16_f32 v106, v8, v9
  v_exp_f32 v33, v153
  v_mfma_f32_16x16x32_bf16 v[188:191], a[220:223], v[92:95], v[188:191]
  s_add_u32 s72, s72, s40
  ds_read_b128 a[188:191], v52 offset:15360
  v_cvt_pk_bf16_f32 v107, v10, v11
  s_waitcnt vmcnt(48)
  buffer_store_dwordx4 v[104:107], v2, s[20:23], s38 offen offset:2048 sc1
  v_accvgpr_read_b32 v12, a88
  v_cvt_pk_bf16_f32 v204, v32, v33
  v_mfma_f32_16x16x32_bf16 v[180:183], a[220:223], v[76:79], v[228:231]
  s_lshl_b32 s72, s72, 11
  v_accvgpr_read_b32 v13, a89
  v_accvgpr_read_b32 v14, a90
  v_accvgpr_read_b32 v15, a91
  v_exp_f32 v34, v154
  v_mfma_f32_16x16x32_bf16 v[180:183], a[216:219], v[72:75], v[180:183]
  v_lshlrev_b32 v24, 1, v2
  ds_read_b128 a[192:195], v52 offset:16384
  v_accvgpr_read_b32 v16, a92
  v_add_f32 v36, v37, v56
  v_mfma_f32_16x16x32_bf16 v[180:183], a[212:215], v[68:71], v[180:183]
  s_mov_b32 s24, s82
  v_accvgpr_read_b32 v17, a93
  v_accvgpr_read_b32 v18, a94
  v_accvgpr_read_b32 v19, a95
  v_exp_f32 v35, v155
  v_mfma_f32_16x16x32_bf16 v[180:183], a[208:211], v[64:67], v[180:183]
  s_waitcnt lgkmcnt(5)
  ds_read_b128 a[196:199], v52 offset:17408
  v_mul_f32 v12, v12, v40
  v_mul_f32 v13, v13, v40
  v_cvt_pk_bf16_f32 v205, v34, v35
  v_mfma_f32_16x16x32_bf16 a[0:3], a[160:163], v[192:195], a[0:3]
  s_and_b32 s25, s83, 0xffff
  v_mul_f32 v14, v14, v40
  v_mul_f32 v15, v15, v40
  v_mul_f32 v16, v16, v40
  v_exp_f32 v32, v156
  v_mfma_f32_16x16x32_bf16 a[32:35], a[160:163], v[196:199], a[32:35]
  s_mov_b32 s26, 1409024
  ds_read_b128 a[200:203], v52 offset:18432
  v_mul_f32 v17, v17, v40
  v_mul_f32 v18, v18, v40
  v_mul_f32 v19, v19, v40
  v_cvt_pk_bf16_f32 v108, v12, v13
  v_mfma_f32_16x16x32_bf16 a[36:39], a[164:167], v[196:199], a[36:39]
  s_mov_b32 s27, 0x20000
  v_cvt_pk_bf16_f32 v109, v14, v15
  v_cvt_pk_bf16_f32 v110, v16, v17
  v_exp_f32 v33, v157
  v_mfma_f32_16x16x32_bf16 a[4:7], a[164:167], v[192:195], a[4:7]
  ds_read_b128 a[204:207], v52 offset:19456
  v_cvt_pk_bf16_f32 v111, v18, v19
  buffer_store_dwordx4 v[108:111], v2, s[20:23], s38 offen offset:3072 sc1
  v_accvgpr_read_b32 v4, a96
  v_cvt_pk_bf16_f32 v206, v32, v33
  v_mfma_f32_16x16x32_bf16 a[8:11], a[168:171], v[192:195], a[8:11]
  v_accvgpr_read_b32 v5, a97
  v_accvgpr_read_b32 v6, a98
  v_exp_f32 v34, v158
  v_mfma_f32_16x16x32_bf16 a[40:43], a[168:171], v[196:199], a[40:43]
  ds_read_b128 a[208:211], v52 offset:20480
  buffer_load_dword v27, v24, s[24:27], s72 offen
  v_accvgpr_read_b32 v7, a99
  v_accvgpr_read_b32 v8, a100
  v_accvgpr_read_b32 v9, a101
  v_mfma_f32_16x16x32_bf16 a[44:47], a[172:175], v[196:199], a[44:47]
  v_accvgpr_read_b32 v10, a102
  v_accvgpr_read_b32 v11, a103
  v_exp_f32 v35, v159
  v_mfma_f32_16x16x32_bf16 a[12:15], a[172:175], v[192:195], a[12:15]
  s_waitcnt lgkmcnt(5)
  v_mul_f32 v4, v4, v42
  v_mul_f32 v5, v5, v42
  v_mul_f32 v6, v6, v42
  v_mul_f32 v7, v7, v42
  v_cvt_pk_bf16_f32 v207, v34, v35
  v_mfma_f32_16x16x32_bf16 a[16:19], a[176:179], v[192:195], a[16:19]
  ds_read_b128 a[212:215], v52 offset:21504
  v_mul_f32 v8, v8, v42
  v_mul_f32 v9, v9, v42
  v_mul_f32 v10, v10, v42
  v_mul_f32 v11, v11, v42
  v_mfma_f32_16x16x32_bf16 v[60:63], a[224:227], v[204:207], 0
  v_cvt_pk_bf16_f32 v112, v4, v5
  v_cvt_pk_bf16_f32 v113, v6, v7
  v_cvt_pk_bf16_f32 v114, v8, v9
  v_cvt_pk_bf16_f32 v115, v10, v11
  v_mfma_f32_16x16x32_bf16 a[48:51], a[176:179], v[196:199], a[48:51]
  buffer_store_dwordx4 v[112:115], v2, s[20:23], s39 offen offset:0 sc1
  v_accvgpr_read_b32 v12, a104
  v_accvgpr_read_b32 v13, a105
  v_exp_f32 v32, v160
  v_mfma_f32_16x16x32_bf16 a[52:55], a[180:183], v[196:199], a[52:55]
  v_accvgpr_read_b32 v14, a106
  v_accvgpr_read_b32 v15, a107
  v_add_f32 v38, v39, v60
  v_max_f32 v48, v36, v38
  v_mfma_f32_16x16x32_bf16 a[20:23], a[180:183], v[192:195], a[20:23]
  v_accvgpr_read_b32 v16, a108
  v_accvgpr_read_b32 v17, a109
  v_accvgpr_read_b32 v18, a110
  v_exp_f32 v33, v161
  v_mfma_f32_16x16x32_bf16 a[24:27], a[184:187], v[192:195], a[24:27]
  v_accvgpr_read_b32 v19, a111
  v_mul_f32 v12, v12, v42
  v_mul_f32 v13, v13, v42
  v_cmp_lt_f32 vcc, v49, v48
  v_cvt_pk_bf16_f32 v248, v32, v33
  v_mfma_f32_16x16x32_bf16 a[56:59], a[184:187], v[196:199], a[56:59]
  s_waitcnt lgkmcnt(2)
  v_mul_f32 v14, v14, v42
  v_mul_f32 v15, v15, v42
  v_exp_f32 v34, v162
  v_mfma_f32_16x16x32_bf16 a[60:63], a[188:191], v[196:199], a[60:63]
  s_cmp_lg_u64 vcc, 0
  ds_read_b128 a[216:219], v52 offset:22528
  ds_read_b128 a[220:223], v52 offset:23552
  v_mul_f32 v16, v16, v42
  v_mul_f32 v17, v17, v42
  v_mul_f32 v18, v18, v42
  v_mfma_f32_16x16x32_bf16 a[28:31], a[188:191], v[192:195], a[28:31]
  s_cbranch_scc1 Lrare107
Lrr108:
  v_mul_f32 v19, v19, v42
  v_exp_f32 v35, v163
  v_mfma_f32_16x16x32_bf16 a[0:3], a[192:195], v[200:203], a[0:3]
  v_cvt_pk_bf16_f32 v116, v12, v13
  v_cvt_pk_bf16_f32 v117, v14, v15
  v_cvt_pk_bf16_f32 v118, v16, v17
  v_cvt_pk_bf16_f32 v119, v18, v19
  v_cvt_pk_bf16_f32 v249, v34, v35
  v_mfma_f32_16x16x32_bf16 a[32:35], a[192:195], v[204:207], a[32:35]
  buffer_store_dwordx4 v[116:119], v2, s[20:23], s39 offen offset:1024 sc1
  v_accvgpr_read_b32 v4, a112
  v_accvgpr_read_b32 v5, a113
  v_exp_f32 v32, v164
  v_mfma_f32_16x16x32_bf16 a[36:39], a[196:199], v[204:207], a[36:39]
  v_accvgpr_read_b32 v6, a114
  v_accvgpr_read_b32 v7, a115
  v_accvgpr_read_b32 v8, a116
  v_accvgpr_read_b32 v9, a117
  v_mfma_f32_16x16x32_bf16 a[4:7], a[196:199], v[200:203], a[4:7]
  v_accvgpr_read_b32 v10, a118
  v_accvgpr_read_b32 v11, a119
  v_mul_f32 v4, v4, v42
  v_exp_f32 v33, v165
  v_mfma_f32_16x16x32_bf16 a[8:11], a[200:203], v[200:203], a[8:11]
  v_mul_f32 v5, v5, v42
  v_mul_f32 v6, v6, v42
  v_mul_f32 v7, v7, v42
  v_cvt_pk_bf16_f32 v250, v32, v33
  v_mfma_f32_16x16x32_bf16 a[40:43], a[200:203], v[204:207], a[40:43]
  v_mul_f32 v8, v8, v42
  v_mul_f32 v9, v9, v42
  v_mul_f32 v10, v10, v42
  v_exp_f32 v34, v166
  v_mfma_f32_16x16x32_bf16 a[44:47], a[204:207], v[204:207], a[44:47]
  s_waitcnt vmcnt(22) lgkmcnt(0)
  s_barrier
  v_add_u32 v51, s53, v2
  v_xor_b32 v52, 32768, v52
  ds_read_b128 a[128:131], v51 offset:0
  v_mul_f32 v11, v11, v42
  v_cvt_pk_bf16_f32 v120, v4, v5
  v_mfma_f32_16x16x32_bf16 a[12:15], a[204:207], v[200:203], a[12:15]
  ds_read_b128 a[132:135], v51 offset:1024
  v_cvt_pk_bf16_f32 v121, v6, v7
  v_exp_f32 v35, v167
  v_mfma_f32_16x16x32_bf16 a[16:19], a[208:211], v[200:203], a[16:19]
  s_mov_b32 s4, s52
  ds_read_b128 a[136:139], v51 offset:2048
  ds_read_b128 a[140:143], v51 offset:3072
  v_cvt_pk_bf16_f32 v122, v8, v9
  v_cvt_pk_bf16_f32 v123, v10, v11
  v_cvt_pk_bf16_f32 v251, v34, v35
  v_mfma_f32_16x16x32_bf16 a[48:51], a[208:211], v[204:207], a[48:51]
  s_mov_b32 s52, s53
  buffer_store_dwordx4 v[120:123], v2, s[20:23], s39 offen offset:2048 sc1
  v_accvgpr_read_b32 v12, a120
  v_exp_f32 v32, v168
  v_mfma_f32_16x16x32_bf16 v[56:59], a[224:227], v[248:251], 0
  s_mov_b32 s53, s54
  ds_read_b128 a[144:147], v51 offset:4096
  ds_read_b128 a[148:151], v51 offset:5120
  v_accvgpr_read_b32 v13, a121
  v_accvgpr_read_b32 v14, a122
  v_accvgpr_read_b32 v15, a123
  v_mfma_f32_16x16x32_bf16 a[52:55], a[212:215], v[204:207], a[52:55]
  s_mov_b32 s54, s4
  v_accvgpr_read_b32 v16, a124
  v_accvgpr_read_b32 v17, a125
  v_accvgpr_read_b32 v18, a126
  v_exp_f32 v33, v169
  v_mfma_f32_16x16x32_bf16 a[20:23], a[212:215], v[200:203], a[20:23]
  s_add_u32 s49, s49, 1
  ds_read_b128 a[152:155], v51 offset:6144
  ds_read_b128 a[156:159], v51 offset:7168
  v_accvgpr_read_b32 v19, a127
  v_cvt_pk_bf16_f32 v252, v32, v33
  v_mfma_f32_16x16x32_bf16 a[24:27], a[216:219], v[200:203], a[24:27]
  s_cmp_ge_u32 s49, s76
  v_mul_f32 v12, v12, v42
  v_mul_f32 v13, v13, v42
  v_mul_f32 v14, v14, v42
  v_exp_f32 v34, v170
  v_mfma_f32_16x16x32_bf16 a[56:59], a[216:219], v[204:207], a[56:59]
  v_mul_f32 v15, v15, v42
  v_mul_f32 v16, v16, v42
  v_mul_f32 v17, v17, v42
  v_add_f32 v37, v36, v56
  v_mfma_f32_16x16x32_bf16 a[60:63], a[220:223], v[204:207], a[60:63]
  v_mul_f32 v18, v18, v42
  v_mul_f32 v19, v19, v42
  v_cvt_pk_bf16_f32 v124, v12, v13
  v_exp_f32 v35, v171
  v_mfma_f32_16x16x32_bf16 a[28:31], a[220:223], v[200:203], a[28:31]
  v_cvt_pk_bf16_f32 v125, v14, v15
  v_cvt_pk_bf16_f32 v126, v16, v17
  v_cvt_pk_bf16_f32 v127, v18, v19
  buffer_store_dwordx4 v[124:127], v2, s[20:23], s39 offen offset:3072 sc1
  v_cvt_pk_bf16_f32 v253, v34, v35
  s_cbranch_scc1 Lp2x
Lp2:
  s_waitcnt lgkmcnt(4)
  v_mfma_f32_16x16x32_bf16 v[128:131], a[128:131], v[64:67], v[208:211]
  v_exp_f32 v32, v172
  v_mfma_f32_16x16x32_bf16 v[128:131], a[132:135], v[68:71], v[128:131]
  s_add_u32 m0, s48, 0
  ds_read_b128 a[160:163], v51 offset:8192
  ds_read_b128 a[164:167], v51 offset:9216
  v_mfma_f32_16x16x32_bf16 v[128:131], a[136:139], v[72:75], v[128:131]
  buffer_load_dwordx4 v2, s[12:15], s46 offen offset:0 sc1 lds
  v_exp_f32 v33, v173
  v_mfma_f32_16x16x32_bf16 v[128:131], a[140:143], v[76:79], v[128:131]
  ds_read_b128 a[168:171], v51 offset:10240
  v_cvt_pk_bf16_f32 v254, v32, v33
  v_mfma_f32_16x16x32_bf16 v[136:139], a[140:143], v[92:95], v[216:219]
  v_exp_f32 v34, v174
  v_mfma_f32_16x16x32_bf16 v[136:139], a[136:139], v[88:91], v[136:139]
  ds_read_b128 a[172:175], v51 offset:11264
  ds_read_b128 a[176:179], v51 offset:12288
  v_mfma_f32_16x16x32_bf16 v[136:139], a[132:135], v[84:87], v[136:139]
  v_exp_f32 v35, v175
  v_mfma_f32_16x16x32_bf16 v[136:139], a[128:131], v[80:83], v[136:139]
  s_waitcnt lgkmcnt(5)
  ds_read_b128 a[180:183], v51 offset:13312
  v_cvt_pk_bf16_f32 v255, v34, v35
  v_mfma_f32_16x16x32_bf16 v[140:143], a[144:147], v[80:83], v[220:223]
  ds_read_b128 a[184:187], v51 offset:14336
  buffer_load_dwordx4 v2, s[12:15], s46 offen offset:1024 sc1 lds
  v_mfma_f32_16x16x32_bf16 v[60:63], a[224:227], v[252:255], 0
  ds_read_b128 a[188:191], v51 offset:15360
  v_mfma_f32_16x16x32_bf16 v[140:143], a[148:151], v[84:87], v[140:143]
  v_exp_f32 v32, v176
  v_mfma_f32_16x16x32_bf16 v[140:143], a[152:155], v[88:91], v[140:143]
  v_add_f32 v39, v38, v60
  v_max_f32 v48, v37, v39
  v_mfma_f32_16x16x32_bf16 v[140:143], a[156:159], v[92:95], v[140:143]
  v_exp_f32 v33, v177
  v_mfma_f32_16x16x32_bf16 v[132:135], a[156:159], v[76:79], v[212:215]
  v_cmp_lt_f32 vcc, v49, v48
  v_cvt_pk_bf16_f32 v200, v32, v33
  v_mfma_f32_16x16x32_bf16 v[132:135], a[152:155], v[72:75], v[132:135]
  s_waitcnt lgkmcnt(4)
  v_exp_f32 v34, v178
  v_mfma_f32_16x16x32_bf16 v[132:135], a[148:151], v[68:71], v[132:135]
  s_cmp_lg_u64 vcc, 0
  ds_read_b128 a[192:195], v52 offset:0
  buffer_load_dwordx4 v2, s[12:15], s46 offen offset:2048 sc1 lds
  v_mfma_f32_16x16x32_bf16 v[132:135], a[144:147], v[64:67], v[132:135]
  s_cbranch_scc1 Lrare110
Lrr111:
  v_exp_f32 v35, v179
  v_mfma_f32_16x16x32_bf16 v[144:147], a[160:163], v[64:67], v[224:227]
  ds_read_b128 a[196:199], v52 offset:1024
  v_cvt_pk_bf16_f32 v201, v34, v35
  v_mfma_f32_16x16x32_bf16 v[144:147], a[164:167], v[68:71], v[144:147]
  v_exp_f32 v32, v180
  v_mfma_f32_16x16x32_bf16 v[144:147], a[168:171], v[72:75], v[144:147]
  ds_read_b128 a[200:203], v52 offset:2048
  buffer_load_dwordx4 v2, s[12:15], s46 offen offset:3072 sc1 lds
  v_mfma_f32_16x16x32_bf16 v[144:147], a[172:175], v[76:79], v[144:147]
  s_add_u32 m0, s48, 4096
  v_exp_f32 v33, v181
  v_mfma_f32_16x16x32_bf16 v[152:155], a[172:175], v[92:95], v[232:235]
  s_add_u32 s46, s46, 4096
  ds_read_b128 a[204:207], v52 offset:3072
  v_cvt_pk_bf16_f32 v202, v32, v33
  v_mfma_f32_16x16x32_bf16 v[152:155], a[168:171], v[88:91], v[152:155]
  v_exp_f32 v34, v182
  v_mfma_f32_16x16x32_bf16 v[152:155], a[164:167], v[84:87], v[152:155]
  ds_read_b128 a[208:211], v52 offset:4096
  v_mfma_f32_16x16x32_bf16 v[152:155], a[160:163], v[80:83], v[152:155]
  s_waitcnt lgkmcnt(5)
  v_exp_f32 v35, v183
  v_mfma_f32_16x16x32_bf16 v[156:159], a[176:179], v[80:83], v[236:239]
  ds_read_b128 a[212:215], v52 offset:5120
  v_cvt_pk_bf16_f32 v203, v34, v35
  v_mfma_f32_16x16x32_bf16 v[156:159], a[180:183], v[84:87], v[156:159]
  v_exp_f32 v32, v184
  v_mfma_f32_16x16x32_bf16 v[56:59], a[224:227], v[200:203], 0
  ds_read_b128 a[216:219], v52 offset:6144
  buffer_load_dwordx4 v2, s[12:15], s46 offen offset:0 sc1 lds
  v_mfma_f32_16x16x32_bf16 v[156:159], a[184:187], v[88:91], v[156:159]
  v_exp_f32 v33, v185
  v_mfma_f32_16x16x32_bf16 v[156:159], a[188:191], v[92:95], v[156:159]
  ds_read_b128 a[220:223], v52 offset:7168
  v_cvt_pk_bf16_f32 v204, v32, v33
  v_mfma_f32_16x16x32_bf16 v[148:151], a[188:191], v[76:79], v[228:231]
  v_exp_f32 v34, v186
  v_mfma_f32_16x16x32_bf16 v[148:151], a[184:187], v[72:75], v[148:151]
  ds_read_b128 a[160:163], v52 offset:8192
  v_add_f32 v36, v37, v56
  v_mfma_f32_16x16x32_bf16 v[148:151], a[180:183], v[68:71], v[148:151]
  v_exp_f32 v35, v187
  v_mfma_f32_16x16x32_bf16 v[148:151], a[176:179], v[64:67], v[148:151]
  s_waitcnt lgkmcnt(5)
  ds_read_b128 a[164:167], v52 offset:9216
  v_cvt_pk_bf16_f32 v205, v34, v35
  v_mfma_f32_16x16x32_bf16 a[0:3], a[192:195], v[248:251], a[0:3]
  v_exp_f32 v32, v188
  v_mfma_f32_16x16x32_bf16 a[32:35], a[192:195], v[252:255], a[32:35]
  ds_read_b128 a[168:171], v52 offset:10240
  buffer_load_dwordx4 v2, s[12:15], s46 offen offset:1024 sc1 lds
  v_mfma_f32_16x16x32_bf16 a[36:39], a[196:199], v[252:255], a[36:39]
  v_exp_f32 v33, v189
  v_mfma_f32_16x16x32_bf16 a[4:7], a[196:199], v[248:251], a[4:7]
  ds_read_b128 a[172:175], v52 offset:11264
  v_cvt_pk_bf16_f32 v206, v32, v33
  v_mfma_f32_16x16x32_bf16 a[8:11], a[200:203], v[248:251], a[8:11]
  v_exp_f32 v34, v190
  v_mfma_f32_16x16x32_bf16 a[40:43], a[200:203], v[252:255], a[40:43]
  ds_read_b128 a[176:179], v52 offset:12288
  buffer_load_dwordx4 v2, s[12:15], s46 offen offset:2048 sc1 lds
  v_mfma_f32_16x16x32_bf16 a[44:47], a[204:207], v[252:255], a[44:47]
  v_exp_f32 v35, v191
  v_mfma_f32_16x16x32_bf16 a[12:15], a[204:207], v[248:251], a[12:15]
  s_waitcnt lgkmcnt(5)
  v_cvt_pk_bf16_f32 v207, v34, v35
  v_mfma_f32_16x16x32_bf16 a[16:19], a[208:211], v[248:251], a[16:19]
  ds_read_b128 a[180:183], v52 offset:13312
  v_mfma_f32_16x16x32_bf16 v[60:63], a[224:227], v[204:207], 0
  buffer_load_dwordx4 v2, s[12:15], s46 offen offset:3072 sc1 lds
  v_mfma_f32_16x16x32_bf16 a[48:51], a[208:211], v[252:255], a[48:51]
  s_add_u32 s46, s46, 28672
  v_exp_f32 v32, v128
  v_mfma_f32_16x16x32_bf16 a[52:55], a[212:215], v[252:255], a[52:55]
  s_xor_b32 s48, s48, 32768
  v_add_f32 v38, v39, v60
  v_max_f32 v48, v36, v38
  v_mfma_f32_16x16x32_bf16 a[20:23], a[212:215], v[248:251], a[20:23]
  s_add_u32 m0, s54, s47
  v_exp_f32 v33, v129
  v_mfma_f32_16x16x32_bf16 a[24:27], a[216:219], v[248:251], a[24:27]
  v_cmp_lt_f32 vcc, v49, v48
  v_cvt_pk_bf16_f32 v192, v32, v33
  v_mfma_f32_16x16x32_bf16 a[56:59], a[216:219], v[252:255], a[56:59]
  s_waitcnt lgkmcnt(2)
  buffer_load_dwordx4 v53, s[8:11], s45 offen offset:0 sc1 lds
  v_exp_f32 v34, v130
  v_mfma_f32_16x16x32_bf16 a[60:63], a[220:223], v[252:255], a[60:63]
  s_cmp_lg_u64 vcc, 0
  ds_read_b128 a[184:187], v52 offset:14336
  ds_read_b128 a[188:191], v52 offset:15360
  v_mfma_f32_16x16x32_bf16 a[28:31], a[220:223], v[248:251], a[28:31]
  s_cbranch_scc1 Lrare113
Lrr114:
  v_exp_f32 v35, v131
  v_mfma_f32_16x16x32_bf16 a[0:3], a[160:163], v[200:203], a[0:3]
  ds_read_b128 a[192:195], v51 offset:16384
  v_cvt_pk_bf16_f32 v193, v34, v35
  v_mfma_f32_16x16x32_bf16 a[32:35], a[160:163], v[204:207], a[32:35]
  v_exp_f32 v32, v132
  v_mfma_f32_16x16x32_bf16 a[36:39], a[164:167], v[204:207], a[36:39]
  ds_read_b128 a[196:199], v51 offset:17408
  ds_read_b128 a[200:203], v51 offset:18432
  v_mfma_f32_16x16x32_bf16 a[4:7], a[164:167], v[200:203], a[4:7]
  v_exp_f32 v33, v133
  v_mfma_f32_16x16x32_bf16 a[8:11], a[168:171], v[200:203], a[8:11]
  ds_read_b128 a[204:207], v51 offset:19456
  v_cvt_pk_bf16_f32 v194, v32, v33
  v_mfma_f32_16x16x32_bf16 a[40:43], a[168:171], v[204:207], a[40:43]
  v_exp_f32 v34, v134
  v_mfma_f32_16x16x32_bf16 a[44:47], a[172:175], v[204:207], a[44:47]
  ds_read_b128 a[208:211], v51 offset:20480
  buffer_load_dwordx4 v54, s[8:11], s45 offen offset:1024 sc1 lds
  v_mfma_f32_16x16x32_bf16 a[12:15], a[172:175], v[200:203], a[12:15]
  s_waitcnt lgkmcnt(5)
  v_exp_f32 v35, v135
  v_mfma_f32_16x16x32_bf16 a[16:19], a[176:179], v[200:203], a[16:19]
  ds_read_b128 a[212:215], v51 offset:21504
  v_cvt_pk_bf16_f32 v195, v34, v35
  v_mfma_f32_16x16x32_bf16 a[48:51], a[176:179], v[204:207], a[48:51]
  v_exp_f32 v32, v136
  v_mfma_f32_16x16x32_bf16 v[56:59], a[224:227], v[192:195], 0
  ds_read_b128 a[216:219], v51 offset:22528
  ds_read_b128 a[220:223], v51 offset:23552
  v_mfma_f32_16x16x32_bf16 a[52:55], a[180:183], v[204:207], a[52:55]
  v_exp_f32 v33, v137
  v_mfma_f32_16x16x32_bf16 a[20:23], a[180:183], v[200:203], a[20:23]
  buffer_load_dwordx4 v55, s[8:11], s45 offen offset:2048 sc1 lds
  v_cvt_pk_bf16_f32 v196, v32, v33
  v_mfma_f32_16x16x32_bf16 a[24:27], a[184:187], v[200:203], a[24:27]
  v_exp_f32 v34, v138
  v_mfma_f32_16x16x32_bf16 a[56:59], a[184:187], v[204:207], a[56:59]
  ds_read_b128 a[160:163], v51 offset:24576
  v_add_f32 v37, v36, v56
  v_mfma_f32_16x16x32_bf16 a[60:63], a[188:191], v[204:207], a[60:63]
  v_exp_f32 v35, v139
  v_mfma_f32_16x16x32_bf16 a[28:31], a[188:191], v[200:203], a[28:31]
  s_waitcnt lgkmcnt(5)
  ds_read_b128 a[164:167], v51 offset:25600
  v_cvt_pk_bf16_f32 v197, v34, v35
  v_mfma_f32_16x16x32_bf16 v[160:163], a[192:195], v[64:67], v[208:211]
  v_exp_f32 v32, v140
  v_mfma_f32_16x16x32_bf16 v[160:163], a[196:199], v[68:71], v[160:163]
  ds_read_b128 a[168:171], v51 offset:26624
  ds_read_b128 a[172:175], v51 offset:27648
  v_mfma_f32_16x16x32_bf16 v[160:163], a[200:203], v[72:75], v[160:163]
  v_exp_f32 v33, v141
  v_mfma_f32_16x16x32_bf16 v[160:163], a[204:207], v[76:79], v[160:163]
  buffer_load_dwordx4 v30, s[8:11], s45 offen offset:3072 sc1 lds
  v_cvt_pk_bf16_f32 v198, v32, v33
  v_mfma_f32_16x16x32_bf16 v[168:171], a[204:207], v[92:95], v[216:219]
  s_add_u32 m0, m0, 4096
  v_exp_f32 v34, v142
  v_mfma_f32_16x16x32_bf16 v[168:171], a[200:203], v[88:91], v[168:171]
  s_add_u32 s45, s45, s100
  ds_read_b128 a[176:179], v51 offset:28672
  v_mfma_f32_16x16x32_bf16 v[168:171], a[196:199], v[84:87], v[168:171]
  v_exp_f32 v35, v143
  v_mfma_f32_16x16x32_bf16 v[168:171], a[192:195], v[80:83], v[168:171]
  s_waitcnt lgkmcnt(5)
  ds_read_b128 a[180:183], v51 offset:29696
  v_cvt_pk_bf16_f32 v199, v34, v35
  v_mfma_f32_16x16x32_bf16 v[172:175], a[208:211], v[80:83], v[220:223]
  ds_read_b128 a[184:187], v51 offset:30720
  buffer_load_dwordx4 v53, s[8:11], s45 offen offset:0 sc1 lds
  v_mfma_f32_16x16x32_bf16 v[60:63], a[224:227], v[196:199], 0
  ds_read_b128 a[188:191], v51 offset:31744
  v_mfma_f32_16x16x32_bf16 v[172:175], a[212:215], v[84:87], v[172:175]
  v_exp_f32 v32, v144
  v_mfma_f32_16x16x32_bf16 v[172:175], a[216:219], v[88:91], v[172:175]
  v_add_f32 v39, v38, v60
  v_max_f32 v48, v37, v39
  v_mfma_f32_16x16x32_bf16 v[172:175], a[220:223], v[92:95], v[172:175]
  v_exp_f32 v33, v145
  v_mfma_f32_16x16x32_bf16 v[164:167], a[220:223], v[76:79], v[212:215]
  v_cmp_lt_f32 vcc, v49, v48
  v_cvt_pk_bf16_f32 v200, v32, v33
  v_mfma_f32_16x16x32_bf16 v[164:167], a[216:219], v[72:75], v[164:167]
  s_waitcnt lgkmcnt(4)
  v_exp_f32 v34, v146
  v_mfma_f32_16x16x32_bf16 v[164:167], a[212:215], v[68:71], v[164:167]
  s_cmp_lg_u64 vcc, 0
  ds_read_b128 a[192:195], v52 offset:16384
  buffer_load_dwordx4 v54, s[8:11], s45 offen offset:1024 sc1 lds
  v_mfma_f32_16x16x32_bf16 v[164:167], a[208:211], v[64:67], v[164:167]
  s_cbranch_scc1 Lrare115
Lrr116:
  v_exp_f32 v35, v147
  v_mfma_f32_16x16x32_bf16 v[176:179], a[160:163], v[64:67], v[224:227]
  ds_read_b128 a[196:199], v52 offset:17408
  v_cvt_pk_bf16_f32 v201, v34, v35
  v_mfma_f32_16x16x32_bf16 v[176:179], a[164:167], v[68:71], v[176:179]
  v_exp_f32 v32, v148
  v_mfma_f32_16x16x32_bf16 v[176:179], a[168:171], v[72:75], v[176:179]
  ds_read_b128 a[200:203], v52 offset:18432
  buffer_load_dwordx4 v55, s[8:11], s45 offen offset:2048 sc1 lds
  v_mfma_f32_16x16x32_bf16 v[176:179], a[172:175], v[76:79], v[176:179]
  v_exp_f32 v33, v149
  v_mfma_f32_16x16x32_bf16 v[184:187], a[172:175], v[92:95], v[232:235]
  ds_read_b128 a[204:207], v52 offset:19456
  v_cvt_pk_bf16_f32 v202, v32, v33
  v_mfma_f32_16x16x32_bf16 v[184:187], a[168:171], v[88:91], v[184:187]
  v_exp_f32 v34, v150
  v_mfma_f32_16x16x32_bf16 v[184:187], a[164:167], v[84:87], v[184:187]
  ds_read_b128 a[208:211], v52 offset:20480
  buffer_load_dwordx4 v30, s[8:11], s45 offen offset:3072 sc1 lds
  v_mfma_f32_16x16x32_bf16 v[184:187], a[160:163], v[80:83], v[184:187]
  s_waitcnt lgkmcnt(5)
  v_exp_f32 v35, v151
  v_mfma_f32_16x16x32_bf16 v[188:191], a[176:179], v[80:83], v[236:239]
  s_add_u32 s45, s45, s101
  ds_read_b128 a[212:215], v52 offset:21504
  v_cvt_pk_bf16_f32 v203, v34, v35
  v_mfma_f32_16x16x32_bf16 v[188:191], a[180:183], v[84:87], v[188:191]
  v_exp_f32 v32, v152
  v_mfma_f32_16x16x32_bf16 v[56:59], a[224:227], v[200:203], 0
  ds_read_b128 a[216:219], v52 offset:22528
  v_mfma_f32_16x16x32_bf16 v[188:191], a[184:187], v[88:91], v[188:191]
  v_exp_f32 v33, v153
  v_mfma_f32_16x16x32_bf16 v[188:191], a[188:191], v[92:95], v[188:191]
  ds_read_b128 a[220:223], v52 offset:23552
  v_cvt_pk_bf16_f32 v204, v32, v33
  v_mfma_f32_16x16x32_bf16 v[180:183], a[188:191], v[76:79], v[228:231]
  v_exp_f32 v34, v154
  v_mfma_f32_16x16x32_bf16 v[180:183], a[184:187], v[72:75], v[180:183]
  ds_read_b128 a[160:163], v52 offset:24576
  v_add_f32 v36, v37, v56
  v_mfma_f32_16x16x32_bf16 v[180:183], a[180:183], v[68:71], v[180:183]
  v_exp_f32 v35, v155
  v_mfma_f32_16x16x32_bf16 v[180:183], a[176:179], v[64:67], v[180:183]
  s_waitcnt lgkmcnt(5)
  ds_read_b128 a[164:167], v52 offset:25600
  v_cvt_pk_bf16_f32 v205, v34, v35
  v_mfma_f32_16x16x32_bf16 a[0:3], a[192:195], v[192:195], a[0:3]
  v_exp_f32 v32, v156
  v_mfma_f32_16x16x32_bf16 a[32:35], a[192:195], v[196:199], a[32:35]
  ds_read_b128 a[168:171], v52 offset:26624
  v_mfma_f32_16x16x32_bf16 a[36:39], a[196:199], v[196:199], a[36:39]
  v_exp_f32 v33, v157
  v_mfma_f32_16x16x32_bf16 a[4:7], a[196:199], v[192:195], a[4:7]
  ds_read_b128 a[172:175], v52 offset:27648
  v_cvt_pk_bf16_f32 v206, v32, v33
  v_mfma_f32_16x16x32_bf16 a[8:11], a[200:203], v[192:195], a[8:11]
  v_exp_f32 v34, v158
  v_mfma_f32_16x16x32_bf16 a[40:43], a[200:203], v[196:199], a[40:43]
  ds_read_b128 a[176:179], v52 offset:28672
  v_mfma_f32_16x16x32_bf16 a[44:47], a[204:207], v[196:199], a[44:47]
  v_exp_f32 v35, v159
  v_mfma_f32_16x16x32_bf16 a[12:15], a[204:207], v[192:195], a[12:15]
  s_waitcnt lgkmcnt(5)
  v_cvt_pk_bf16_f32 v207, v34, v35
  v_mfma_f32_16x16x32_bf16 a[16:19], a[208:211], v[192:195], a[16:19]
  ds_read_b128 a[180:183], v52 offset:29696
  v_mfma_f32_16x16x32_bf16 v[60:63], a[224:227], v[204:207], 0
  v_mfma_f32_16x16x32_bf16 a[48:51], a[208:211], v[196:199], a[48:51]
  v_exp_f32 v32, v160
  v_mfma_f32_16x16x32_bf16 a[52:55], a[212:215], v[196:199], a[52:55]
  v_add_f32 v38, v39, v60
  v_max_f32 v48, v36, v38
  v_mfma_f32_16x16x32_bf16 a[20:23], a[212:215], v[192:195], a[20:23]
  v_exp_f32 v33, v161
  v_mfma_f32_16x16x32_bf16 a[24:27], a[216:219], v[192:195], a[24:27]
  v_cmp_lt_f32 vcc, v49, v48
  v_cvt_pk_bf16_f32 v248, v32, v33
  v_mfma_f32_16x16x32_bf16 a[56:59], a[216:219], v[196:199], a[56:59]
  s_waitcnt lgkmcnt(2)
  v_exp_f32 v34, v162
  v_mfma_f32_16x16x32_bf16 a[60:63], a[220:223], v[196:199], a[60:63]
  s_cmp_lg_u64 vcc, 0
  ds_read_b128 a[184:187], v52 offset:30720
  ds_read_b128 a[188:191], v52 offset:31744
  v_mfma_f32_16x16x32_bf16 a[28:31], a[220:223], v[192:195], a[28:31]
  s_cbranch_scc1 Lrare117
Lrr118:
  v_exp_f32 v35, v163
  v_mfma_f32_16x16x32_bf16 a[0:3], a[160:163], v[200:203], a[0:3]
  v_cvt_pk_bf16_f32 v249, v34, v35
  v_mfma_f32_16x16x32_bf16 a[32:35], a[160:163], v[204:207], a[32:35]
  v_exp_f32 v32, v164
  v_mfma_f32_16x16x32_bf16 a[36:39], a[164:167], v[204:207], a[36:39]
  v_mfma_f32_16x16x32_bf16 a[4:7], a[164:167], v[200:203], a[4:7]
  v_exp_f32 v33, v165
  v_mfma_f32_16x16x32_bf16 a[8:11], a[168:171], v[200:203], a[8:11]
  v_cvt_pk_bf16_f32 v250, v32, v33
  v_mfma_f32_16x16x32_bf16 a[40:43], a[168:171], v[204:207], a[40:43]
  v_exp_f32 v34, v166
  v_mfma_f32_16x16x32_bf16 a[44:47], a[172:175], v[204:207], a[44:47]
  s_waitcnt vmcnt(8) lgkmcnt(0)
  s_barrier
  v_add_u32 v51, s53, v2
  v_xor_b32 v52, 32768, v52
  ds_read_b128 a[128:131], v51 offset:0
  v_mfma_f32_16x16x32_bf16 a[12:15], a[172:175], v[200:203], a[12:15]
  ds_read_b128 a[132:135], v51 offset:1024
  v_exp_f32 v35, v167
  v_mfma_f32_16x16x32_bf16 a[16:19], a[176:179], v[200:203], a[16:19]
  s_mov_b32 s4, s52
  ds_read_b128 a[136:139], v51 offset:2048
  ds_read_b128 a[140:143], v51 offset:3072
  v_cvt_pk_bf16_f32 v251, v34, v35
  v_mfma_f32_16x16x32_bf16 a[48:51], a[176:179], v[204:207], a[48:51]
  s_mov_b32 s52, s53
  v_exp_f32 v32, v168
  v_mfma_f32_16x16x32_bf16 v[56:59], a[224:227], v[248:251], 0
  s_mov_b32 s53, s54
  ds_read_b128 a[144:147], v51 offset:4096
  ds_read_b128 a[148:151], v51 offset:5120
  v_mfma_f32_16x16x32_bf16 a[52:55], a[180:183], v[204:207], a[52:55]
  s_mov_b32 s54, s4
  v_exp_f32 v33, v169
  v_mfma_f32_16x16x32_bf16 a[20:23], a[180:183], v[200:203], a[20:23]
  s_add_u32 s49, s49, 1
  ds_read_b128 a[152:155], v51 offset:6144
  ds_read_b128 a[156:159], v51 offset:7168
  v_cvt_pk_bf16_f32 v252, v32, v33
  v_mfma_f32_16x16x32_bf16 a[24:27], a[184:187], v[200:203], a[24:27]
  s_cmp_lt_u32 s49, s76
  v_exp_f32 v34, v170
  v_mfma_f32_16x16x32_bf16 a[56:59], a[184:187], v[204:207], a[56:59]
  v_add_f32 v37, v36, v56
  v_mfma_f32_16x16x32_bf16 a[60:63], a[188:191], v[204:207], a[60:63]
  v_exp_f32 v35, v171
  v_mfma_f32_16x16x32_bf16 a[28:31], a[188:191], v[200:203], a[28:31]
  v_cvt_pk_bf16_f32 v253, v34, v35
  s_cbranch_scc1 Lp2
Lp2x:
  s_cmp_eq_u32 s49, s76
  s_cbranch_scc0 Lp2y
  s_cmp_lt_u32 s42, 6
  s_cbranch_scc0 Lps119
  s_lshl_b32 s3, s42, 5
  s_add_u32 s3, s3, s41
  s_cmp_lg_u32 s40, 0
  s_cbranch_scc1 Lpub120
  s_lshr_b32 s4, s3, 2
  s_lshl_b32 s4, s4, 5
  s_and_b32 s5, s3, 3
  s_add_u32 s4, s4, s5
  s_lshl_b32 s4, s4, 2
  s_add_u32 s4, s4, 65060864
  v_mov_b32 v24, 1
  s_mov_b64 exec, 1
  buffer_store_dword v24, off, s[20:23], s4 sc1
  s_mov_b64 exec, -1
Lpub120:
Lps119:
  s_mov_b32 s8, s74
  s_and_b32 s9, s75, 0xffff
  s_mov_b32 s10, 4194304
  s_mov_b32 s11, 0x20000
  s_and_b32 s4, s43, 3
  s_lshl_b32 s45, s4, 20
  s_lshl_b32 s4, s40, 14
  s_add_u32 s45, s45, s4
  s_lshl_b32 s4, s44, 8
  s_add_u32 s45, s45, s4
  s_mov_b32 s100, 65536
  s_mov_b32 s101, 65536
  v_lshrrev_b32 v54, 4, v1
  v_and_b32 v55, 15, v1
  v_lshlrev_b32 v30, 1, v54
  v_xor_b32 v30, v30, v55
  v_lshlrev_b32 v30, 4, v30
  v_lshl_add_u32 v53, v54, 10, v30
  v_xor_b32 v30, 128, v53
  v_add_u32 v54, 3072, v30
  v_add_u32 v55, 6144, v53
  v_add_u32 v30, 9216, v30
  buffer_load_dword v27, v0, s[28:31], 0 offen
  s_add_u32 s3, s49, 2
  s_cmp_gt_u32 s3, s50
  s_cselect_b32 s18, 4194304, 0
  buffer_load_dword v27, v25, s[16:19], s32 offen
  s_branch Lp2
Lf0:
  v_and_b32 v56, 15, v1
  v_lshrrev_b32 v57, 4, v1
  v_lshlrev_b32 v57, 2, v57
  v_sub_u32 v56, v56, v57
  v_mov_b32 v49, 0x5d800000
  v_mov_b32 v50, 0xf149f2ca
  v_mov_b32 v57, 0x3f803f80
  v_cmp_le_i32 s[56:57], 0, v56
  v_cmp_le_i32 s[58:59], 1, v56
  v_cmp_le_i32 s[60:61], 2, v56
  v_cmp_le_i32 s[62:63], 3, v56
  v_accvgpr_write_b32 a224, v57
  v_accvgpr_write_b32 a225, v57
  v_accvgpr_write_b32 a226, v57
  v_accvgpr_write_b32 a227, v57
  v_mov_b32 v36, 0
  v_mov_b32 v37, 0
  v_mov_b32 v38, 0
  v_mov_b32 v39, 0
  v_mov_b32 v40, 0
  v_mov_b32 v41, 0
  v_mov_b32 v42, 0
  v_mov_b32 v43, 0
  v_mov_b32 v44, 0
  v_mov_b32 v45, 0
  v_mov_b32 v46, 0
  v_mov_b32 v47, 0
  s_waitcnt lgkmcnt(4)
  v_mfma_f32_16x16x32_bf16 v[128:131], a[128:131], v[64:67], 0
  s_cmp_gt_u32 s51, 0
  s_cselect_b64 s[0:1], -1, 0
  ds_read_b128 a[160:163], v51 offset:8192
  v_mfma_f32_16x16x32_bf16 v[128:131], a[132:135], v[68:71], v[128:131]
  s_cmp_eq_u32 s51, 0
  s_cselect_b64 s[66:67], s[56:57], s[0:1]
  s_cselect_b64 s[68:69], s[58:59], s[0:1]
  s_cselect_b64 s[34:35], s[60:61], s[0:1]
  s_cselect_b64 s[36:37], s[62:63], s[0:1]
  v_mfma_f32_16x16x32_bf16 v[128:131], a[136:139], v[72:75], v[128:131]
  s_add_u32 m0, s48, 0
  v_cndmask_b32 v225, v50, v46, s[68:69]
  v_cndmask_b32 v224, v50, v46, s[66:67]
  v_mfma_f32_16x16x32_bf16 v[128:131], a[140:143], v[76:79], v[128:131]
  s_getpc_b64 s[28:29]
Lpc18:
  s_add_u32 s28, s28, Lp2y - Lpc18
  s_addc_u32 s29, s29, 0
  buffer_load_dwordx4 v2, s[12:15], s46 offen offset:0 sc1 lds
  v_cndmask_b32 v227, v50, v46, s[36:37]
  v_cndmask_b32 v226, v50, v46, s[34:35]
  v_mfma_f32_16x16x32_bf16 v[136:139], a[140:143], v[92:95], 0
  s_cmp_gt_u32 s51, 1
  s_cselect_b64 s[0:1], -1, 0
  ds_read_b128 a[164:167], v51 offset:9216
  ds_read_b128 a[168:171], v51 offset:10240
  v_mfma_f32_16x16x32_bf16 v[136:139], a[136:139], v[88:91], v[136:139]
  s_cmp_eq_u32 s51, 1
  s_cselect_b64 s[66:67], s[56:57], s[0:1]
  s_cselect_b64 s[68:69], s[58:59], s[0:1]
  s_cselect_b64 s[34:35], s[60:61], s[0:1]
  s_cselect_b64 s[36:37], s[62:63], s[0:1]
  v_mfma_f32_16x16x32_bf16 v[136:139], a[132:135], v[84:87], v[136:139]
  s_and_b32 s29, s29, 0xffff
  ds_read_b128 a[172:175], v51 offset:11264
  v_cndmask_b32 v229, v50, v46, s[68:69]
  v_cndmask_b32 v228, v50, v46, s[66:67]
  v_mfma_f32_16x16x32_bf16 v[136:139], a[128:131], v[80:83], v[136:139]
  s_waitcnt lgkmcnt(4)
  buffer_load_dwordx4 v2, s[12:15], s46 offen offset:1024 sc1 lds
  v_cndmask_b32 v231, v50, v46, s[36:37]
  v_cndmask_b32 v230, v50, v46, s[34:35]
  v_mfma_f32_16x16x32_bf16 v[140:143], a[144:147], v[80:83], 0
  s_mov_b32 s30, adaLN_cond__compressed_kv_cla__mixer_channel_mlp__prompt_kernel_end - Lp2y
  v_mov_b32 v233, v47
  v_mov_b32 v232, v47
  v_mfma_f32_16x16x32_bf16 v[140:143], a[148:151], v[84:87], v[140:143]
  s_mov_b32 s31, 0x20000
  v_mov_b32 v235, v47
  v_mov_b32 v234, v47
  v_mfma_f32_16x16x32_bf16 v[140:143], a[152:155], v[88:91], v[140:143]
  s_lshl_b32 s72, s44, 2
  v_mov_b32 v237, v47
  v_mov_b32 v236, v47
  v_mfma_f32_16x16x32_bf16 v[140:143], a[156:159], v[92:95], v[140:143]
  s_add_u32 s72, s72, s40
  v_mov_b32 v239, v47
  v_mov_b32 v238, v47
  v_mfma_f32_16x16x32_bf16 v[132:135], a[156:159], v[76:79], 0
  s_mul_i32 s72, s72, 2560
  ds_read_b128 a[176:179], v51 offset:12288
  ds_read_b128 a[180:183], v51 offset:13312
  v_mfma_f32_16x16x32_bf16 v[132:135], a[152:155], v[72:75], v[132:135]
  v_min_u32 v0, 19, v1
  ds_read_b128 a[184:187], v51 offset:14336
  ds_read_b128 a[188:191], v51 offset:15360
  v_mfma_f32_16x16x32_bf16 v[132:135], a[148:151], v[68:71], v[132:135]
  v_lshl_add_u32 v0, v0, 7, s72
  buffer_load_dwordx4 v2, s[12:15], s46 offen offset:2048 sc1 lds
  v_mfma_f32_16x16x32_bf16 v[132:135], a[144:147], v[64:67], v[132:135]
  s_lshr_b32 s32, s2, 3
  v_mfma_f32_16x16x32_bf16 v[144:147], a[128:131], v[96:99], v[224:227]
  s_lshl_b32 s32, s32, 2
  v_mfma_f32_16x16x32_bf16 v[144:147], a[132:135], v[100:103], v[144:147]
  s_add_u32 s32, s32, s40
  buffer_load_dwordx4 v2, s[12:15], s46 offen offset:3072 sc1 lds
  v_mfma_f32_16x16x32_bf16 v[144:147], a[136:139], v[104:107], v[144:147]
  s_add_u32 m0, s48, 4096
  v_max3_f32 v240, v128, v129, v130
  v_max3_f32 v240, v240, v131, v132
  v_max3_f32 v240, v240, v133, v134
  v_mfma_f32_16x16x32_bf16 v[144:147], a[140:143], v[108:111], v[144:147]
  s_add_u32 s46, s46, 4096
  v_max_f32 v240, v240, v135
  v_max3_f32 v241, v136, v137, v138
  v_max3_f32 v241, v241, v139, v140
  v_mfma_f32_16x16x32_bf16 v[152:155], a[140:143], v[124:127], v[232:235]
  s_lshl_b32 s32, s32, 13
  v_max3_f32 v241, v241, v141, v142
  v_max_f32 v241, v241, v143
  v_mov_b32 v244, v240
  v_mfma_f32_16x16x32_bf16 v[152:155], a[136:139], v[120:123], v[152:155]
  s_and_b32 s72, s43, 3
  v_mov_b32 v245, v241
  s_nop 0
  v_permlane16_swap_b32 v240, v244
  v_mfma_f32_16x16x32_bf16 v[152:155], a[132:135], v[116:119], v[152:155]
  s_lshl_b32 s72, s72, 20
  v_permlane16_swap_b32 v241, v245
  v_max_f32 v240, v240, v244
  v_max_f32 v241, v241, v245
  v_mfma_f32_16x16x32_bf16 v[152:155], a[128:131], v[112:115], v[152:155]
  s_add_u32 s32, s32, s72
  buffer_load_dwordx4 v2, s[12:15], s46 offen offset:0 sc1 lds
  v_mov_b32 v244, v240
  v_mov_b32 v245, v241
  s_nop 0
  v_mfma_f32_16x16x32_bf16 v[156:159], a[144:147], v[112:115], v[236:239]
  v_lshlrev_b32 v25, 7, v1
  v_permlane32_swap_b32 v240, v244
  v_permlane32_swap_b32 v241, v245
  v_max_f32 v240, v240, v244
  v_mfma_f32_16x16x32_bf16 v[156:159], a[148:151], v[116:119], v[156:159]
  s_mov_b32 s38, s42
  v_max_f32 v241, v241, v245
  v_sub_f32 v44, 0, v240
  v_sub_f32 v128, v128, v240
  v_mfma_f32_16x16x32_bf16 v[156:159], a[152:155], v[120:123], v[156:159]
  s_lshl_b32 s38, s38, 3
  v_sub_f32 v129, v129, v240
  v_sub_f32 v130, v130, v240
  v_sub_f32 v131, v131, v240
  v_mfma_f32_16x16x32_bf16 v[156:159], a[156:159], v[124:127], v[156:159]
  s_add_u32 s38, s38, s40
  v_sub_f32 v132, v132, v240
  v_sub_f32 v133, v133, v240
  v_sub_f32 v134, v134, v240
  v_mfma_f32_16x16x32_bf16 v[148:151], a[156:159], v[108:111], v[228:231]
  s_lshl_b32 s38, s38, 17
  buffer_load_dwordx4 v2, s[12:15], s46 offen offset:1024 sc1 lds
  v_sub_f32 v135, v135, v240
  v_mov_b32 v208, v44
  v_mov_b32 v209, v44
  v_mfma_f32_16x16x32_bf16 v[148:151], a[152:155], v[104:107], v[148:151]
  s_lshl_b32 s39, s41, 12
  v_mov_b32 v210, v44
  v_mov_b32 v211, v44
  v_mov_b32 v212, v44
  v_mfma_f32_16x16x32_bf16 v[148:151], a[148:151], v[100:103], v[148:151]
  s_add_u32 s38, s38, s39
  v_mov_b32 v213, v44
  v_mov_b32 v214, v44
  v_mov_b32 v215, v44
  v_mfma_f32_16x16x32_bf16 v[148:151], a[144:147], v[96:99], v[148:151]
  s_waitcnt lgkmcnt(4)
  v_sub_f32 v45, 0, v241
  v_sub_f32 v136, v136, v241
  v_sub_f32 v137, v137, v241
  v_sub_f32 v138, v138, v241
  v_sub_f32 v139, v139, v241
  v_sub_f32 v140, v140, v241
  v_sub_f32 v141, v141, v241
  v_sub_f32 v142, v142, v241
  v_sub_f32 v143, v143, v241
  v_mov_b32 v216, v45
  v_mov_b32 v217, v45
  v_mov_b32 v218, v45
  v_mov_b32 v219, v45
  v_mov_b32 v220, v45
  v_mov_b32 v221, v45
  v_mov_b32 v222, v45
  v_mov_b32 v223, v45
  v_exp_f32 v32, v128
  v_exp_f32 v33, v129
  v_exp_f32 v34, v130
  v_cvt_pk_bf16_f32 v192, v32, v33
  v_exp_f32 v35, v131
  v_exp_f32 v32, v132
  v_cvt_pk_bf16_f32 v193, v34, v35
  v_exp_f32 v33, v133
  v_exp_f32 v34, v134
  v_cvt_pk_bf16_f32 v194, v32, v33
  v_exp_f32 v35, v135
  v_exp_f32 v32, v136
  v_cvt_pk_bf16_f32 v195, v34, v35
  v_exp_f32 v33, v137
  v_exp_f32 v34, v138
  v_cvt_pk_bf16_f32 v196, v32, v33
  v_exp_f32 v35, v139
  s_nop 0
  v_cvt_pk_bf16_f32 v197, v34, v35
  v_mfma_f32_16x16x32_bf16 v[56:59], a[224:227], v[192:195], 0
  v_max3_f32 v242, v144, v145, v146
  v_max3_f32 v242, v242, v147, v148
  v_max3_f32 v242, v242, v149, v150
  v_max_f32 v242, v242, v151
  v_max3_f32 v243, v152, v153, v154
  v_max3_f32 v243, v243, v155, v156
  v_max3_f32 v243, v243, v157, v158
  v_max_f32 v243, v243, v159
  v_mov_b32 v244, v242
  v_mov_b32 v245, v243
  s_nop 0
  v_permlane16_swap_b32 v242, v244
  v_permlane16_swap_b32 v243, v245
  v_max_f32 v242, v242, v244
  v_max_f32 v243, v243, v245
  v_mov_b32 v244, v242
  v_mov_b32 v245, v243
  s_nop 0
  v_permlane32_swap_b32 v242, v244
  v_permlane32_swap_b32 v243, v245
  v_max_f32 v242, v242, v244
  v_max_f32 v243, v243, v245
  v_sub_f32 v46, 0, v242
  v_sub_f32 v144, v144, v242
  v_sub_f32 v145, v145, v242
  v_sub_f32 v146, v146, v242
  v_sub_f32 v147, v147, v242
  v_sub_f32 v148, v148, v242
  v_sub_f32 v149, v149, v242
  v_sub_f32 v150, v150, v242
  v_sub_f32 v151, v151, v242
  v_sub_f32 v47, 0, v243
  v_sub_f32 v152, v152, v243
  v_sub_f32 v153, v153, v243
  v_sub_f32 v154, v154, v243
  v_sub_f32 v155, v155, v243
  v_sub_f32 v156, v156, v243
  v_sub_f32 v157, v157, v243
  v_sub_f32 v158, v158, v243
  v_sub_f32 v159, v159, v243
  v_add_f32 v37, v36, v56
  v_mfma_f32_16x16x32_bf16 v[160:163], a[160:163], v[64:67], v[208:211]
  s_cmp_gt_u32 s51, 2
  s_cselect_b64 s[0:1], -1, 0
  v_exp_f32 v32, v140
  v_mfma_f32_16x16x32_bf16 v[160:163], a[164:167], v[68:71], v[160:163]
  s_cmp_eq_u32 s51, 2
  s_cselect_b64 s[66:67], s[56:57], s[0:1]
  s_cselect_b64 s[68:69], s[58:59], s[0:1]
  s_cselect_b64 s[34:35], s[60:61], s[0:1]
  s_cselect_b64 s[36:37], s[62:63], s[0:1]
  v_mfma_f32_16x16x32_bf16 v[160:163], a[168:171], v[72:75], v[160:163]
  s_add_u32 s38, s38, 33554432
  buffer_load_dwordx4 v2, s[12:15], s46 offen offset:2048 sc1 lds
  v_cndmask_b32 v225, v50, v46, s[68:69]
  v_exp_f32 v33, v141
  v_mfma_f32_16x16x32_bf16 v[160:163], a[172:175], v[76:79], v[160:163]
  s_add_u32 s39, s38, 524288
  v_cndmask_b32 v226, v50, v46, s[34:35]
  v_cndmask_b32 v224, v50, v46, s[66:67]
  v_cvt_pk_bf16_f32 v198, v32, v33
  v_mfma_f32_16x16x32_bf16 v[168:171], a[172:175], v[92:95], v[216:219]
  v_mov_b32 v20, -1
  v_cndmask_b32 v227, v50, v46, s[36:37]
  v_exp_f32 v34, v142
  v_mfma_f32_16x16x32_bf16 v[168:171], a[168:171], v[88:91], v[168:171]
  s_cmp_gt_u32 s51, 3
  s_cselect_b64 s[0:1], -1, 0
  ds_read_b128 a[192:195], v52 offset:8192
  ds_read_b128 a[196:199], v52 offset:9216
  v_mfma_f32_16x16x32_bf16 v[168:171], a[164:167], v[84:87], v[168:171]
  s_cmp_eq_u32 s51, 3
  s_cselect_b64 s[66:67], s[56:57], s[0:1]
  s_cselect_b64 s[68:69], s[58:59], s[0:1]
  s_cselect_b64 s[34:35], s[60:61], s[0:1]
  s_cselect_b64 s[36:37], s[62:63], s[0:1]
  v_exp_f32 v35, v143
  v_mfma_f32_16x16x32_bf16 v[168:171], a[160:163], v[80:83], v[168:171]
  s_waitcnt lgkmcnt(2)
  ds_read_b128 a[200:203], v52 offset:10240
  buffer_load_dwordx4 v2, s[12:15], s46 offen offset:3072 sc1 lds
  v_cndmask_b32 v228, v50, v46, s[66:67]
  v_cvt_pk_bf16_f32 v199, v34, v35
  v_mfma_f32_16x16x32_bf16 v[172:175], a[176:179], v[80:83], v[220:223]
  s_add_u32 s46, s46, 28672
  ds_read_b128 a[204:207], v52 offset:11264
  v_cndmask_b32 v230, v50, v46, s[34:35]
  v_cndmask_b32 v229, v50, v46, s[68:69]
  v_mfma_f32_16x16x32_bf16 v[60:63], a[224:227], v[196:199], 0
  s_xor_b32 s48, s48, 32768
  v_mov_b32 v235, v47
  v_mov_b32 v232, v47
  v_cndmask_b32 v231, v50, v46, s[36:37]
  v_mfma_f32_16x16x32_bf16 v[172:175], a[180:183], v[84:87], v[172:175]
  s_add_u32 m0, s53, s47
  v_mov_b32 v236, v47
  v_exp_f32 v32, v144
  v_mfma_f32_16x16x32_bf16 v[172:175], a[184:187], v[88:91], v[172:175]
  v_mov_b32 v21, -1
  v_mov_b32 v237, v47
  v_add_f32 v39, v38, v60
  v_max_f32 v48, v37, v39
  v_mfma_f32_16x16x32_bf16 v[172:175], a[188:191], v[92:95], v[172:175]
  v_mov_b32 v22, -1
  v_mov_b32 v238, v47
  v_exp_f32 v33, v145
  v_mfma_f32_16x16x32_bf16 v[164:167], a[188:191], v[76:79], v[212:215]
  v_mov_b32 v23, -1
  v_mov_b32 v239, v47
  v_cmp_lt_f32 vcc, v49, v48
  v_cvt_pk_bf16_f32 v200, v32, v33
  v_mfma_f32_16x16x32_bf16 v[164:167], a[184:187], v[72:75], v[164:167]
  s_lshr_b32 s72, s43, 2
  ds_read_b128 a[208:211], v52 offset:12288
  v_exp_f32 v34, v146
  v_mfma_f32_16x16x32_bf16 v[164:167], a[180:183], v[68:71], v[164:167]
  s_cmp_lg_u64 vcc, 0
  buffer_load_dwordx4 v53, s[8:11], s45 offen offset:0 sc1 lds
  v_mov_b32 v234, v47
  v_mov_b32 v233, v47
  v_mfma_f32_16x16x32_bf16 v[164:167], a[176:179], v[64:67], v[164:167]
  s_cbranch_scc1 Lrare20
Lrr21:
  v_exp_f32 v35, v147
  v_mfma_f32_16x16x32_bf16 v[176:179], a[160:163], v[96:99], v[224:227]
  s_sub_u32 s73, 15, s42
  ds_read_b128 a[212:215], v52 offset:13312
  v_cvt_pk_bf16_f32 v201, v34, v35
  v_mfma_f32_16x16x32_bf16 v[176:179], a[164:167], v[100:103], v[176:179]
  s_cmp_eq_u32 s72, 0
  s_cselect_b32 s72, s42, s73
  v_exp_f32 v32, v148
  v_mfma_f32_16x16x32_bf16 v[176:179], a[168:171], v[104:107], v[176:179]
  s_lshl_b32 s72, s72, 2
  ds_read_b128 a[216:219], v52 offset:14336
  ds_read_b128 a[220:223], v52 offset:15360
  v_mfma_f32_16x16x32_bf16 v[176:179], a[172:175], v[108:111], v[176:179]
  s_add_u32 s72, s72, s44
  v_exp_f32 v33, v149
  v_mfma_f32_16x16x32_bf16 v[184:187], a[172:175], v[124:127], v[232:235]
  s_lshl_b32 s72, s72, 2
  buffer_load_dwordx4 v54, s[8:11], s45 offen offset:1024 sc1 lds
  v_cvt_pk_bf16_f32 v202, v32, v33
  v_mfma_f32_16x16x32_bf16 v[184:187], a[168:171], v[120:123], v[184:187]
  s_and_b32 s73, s43, 3
  v_exp_f32 v34, v150
  v_mfma_f32_16x16x32_bf16 v[184:187], a[164:167], v[116:119], v[184:187]
  s_add_u32 s72, s72, s73
  buffer_load_dwordx4 v55, s[8:11], s45 offen offset:2048 sc1 lds
  v_mfma_f32_16x16x32_bf16 v[184:187], a[160:163], v[112:115], v[184:187]
  s_lshl_b32 s70, s72, 15
  v_exp_f32 v35, v151
  v_mfma_f32_16x16x32_bf16 v[188:191], a[176:179], v[112:115], v[236:239]
  s_lshl_b32 s72, s40, 13
  v_cvt_pk_bf16_f32 v203, v34, v35
  v_mfma_f32_16x16x32_bf16 v[188:191], a[180:183], v[116:119], v[188:191]
  s_add_u32 s70, s70, s72
  v_exp_f32 v32, v152
  v_mfma_f32_16x16x32_bf16 v[56:59], a[224:227], v[200:203], 0
  s_add_u32 s70, s70, 67108864
  buffer_load_dwordx4 v30, s[8:11], s45 offen offset:3072 sc1 lds
  v_mfma_f32_16x16x32_bf16 v[188:191], a[184:187], v[120:123], v[188:191]
  s_add_u32 m0, m0, 4096
  v_exp_f32 v33, v153
  v_mfma_f32_16x16x32_bf16 v[188:191], a[188:191], v[124:127], v[188:191]
  s_add_u32 s45, s45, s100
  v_cvt_pk_bf16_f32 v204, v32, v33
  v_mfma_f32_16x16x32_bf16 v[180:183], a[188:191], v[108:111], v[228:231]
  s_mov_b32 s87, s70
  v_exp_f32 v34, v154
  v_mfma_f32_16x16x32_bf16 v[180:183], a[184:187], v[104:107], v[180:183]
  s_lshr_b32 s72, s43, 2
  v_add_f32 v41, v40, v56
  v_mfma_f32_16x16x32_bf16 v[180:183], a[180:183], v[100:103], v[180:183]
  s_sub_u32 s73, 15, s42
  v_exp_f32 v35, v155
  v_mfma_f32_16x16x32_bf16 v[180:183], a[176:179], v[96:99], v[180:183]
  s_waitcnt lgkmcnt(4)
  buffer_load_dwordx4 v53, s[8:11], s45 offen offset:0 sc1 lds
  v_cvt_pk_bf16_f32 v205, v34, v35
  v_mfma_f32_16x16x32_bf16 a[0:3], a[192:195], v[192:195], 0
  s_cmp_gt_u32 s51, 0
  s_cselect_b64 s[0:1], -1, 0
  v_exp_f32 v32, v156
  v_mfma_f32_16x16x32_bf16 a[32:35], a[192:195], v[196:199], 0
  s_cmp_eq_u32 s51, 0
  s_cselect_b64 s[66:67], s[56:57], s[0:1]
  s_cselect_b64 s[68:69], s[58:59], s[0:1]
  s_cselect_b64 s[34:35], s[60:61], s[0:1]
  s_cselect_b64 s[36:37], s[62:63], s[0:1]
  v_mfma_f32_16x16x32_bf16 a[36:39], a[196:199], v[196:199], 0
  s_cmp_eq_u32 s72, 0
  s_cselect_b32 s72, s42, s73
  v_exp_f32 v33, v157
  v_mfma_f32_16x16x32_bf16 a[4:7], a[196:199], v[192:195], 0
  s_lshl_b32 s72, s72, 2
  v_cndmask_b32 v232, v50, v47, s[66:67]
  v_cvt_pk_bf16_f32 v206, v32, v33
  v_mfma_f32_16x16x32_bf16 a[8:11], a[200:203], v[192:195], 0
  s_add_u32 s72, s72, s40
  buffer_load_dwordx4 v54, s[8:11], s45 offen offset:1024 sc1 lds
  v_exp_f32 v34, v158
  v_mfma_f32_16x16x32_bf16 a[40:43], a[200:203], v[196:199], 0
  s_mul_i32 s72, s72, 88064
  v_cndmask_b32 v234, v50, v47, s[34:35]
  v_cndmask_b32 v233, v50, v47, s[68:69]
  v_mfma_f32_16x16x32_bf16 a[44:47], a[204:207], v[196:199], 0
  s_and_b32 s73, s43, 3
  v_exp_f32 v35, v159
  v_mfma_f32_16x16x32_bf16 a[12:15], a[204:207], v[192:195], 0
  s_waitcnt lgkmcnt(0)
  v_cndmask_b32 v235, v50, v47, s[36:37]
  v_cvt_pk_bf16_f32 v207, v34, v35
  v_mfma_f32_16x16x32_bf16 a[16:19], a[208:211], v[192:195], 0
  s_lshl_b32 s73, s73, 2
  ds_read_b128 a[160:163], v51 offset:16384
  ds_read_b128 a[164:167], v51 offset:17408
  v_mfma_f32_16x16x32_bf16 v[60:63], a[224:227], v[204:207], 0
  s_add_u32 s73, s73, s44
  ds_read_b128 a[168:171], v51 offset:18432
  ds_read_b128 a[172:175], v51 offset:19456
  buffer_load_dwordx4 v55, s[8:11], s45 offen offset:2048 sc1 lds
  v_mfma_f32_16x16x32_bf16 a[48:51], a[208:211], v[196:199], 0
  s_mul_i32 s73, s73, 3072
  v_exp_f32 v32, v160
  v_mfma_f32_16x16x32_bf16 a[52:55], a[212:215], v[196:199], 0
  s_min_u32 s73, s73, 40960
  v_add_f32 v43, v42, v60
  v_max_f32 v48, v41, v43
  v_mfma_f32_16x16x32_bf16 a[20:23], a[212:215], v[192:195], 0
  s_add_u32 s72, s72, s73
  v_exp_f32 v33, v161
  v_mfma_f32_16x16x32_bf16 a[24:27], a[216:219], v[192:195], 0
  s_add_u32 s88, s72, 56623104
  v_cmp_lt_f32 vcc, v49, v48
  v_cvt_pk_bf16_f32 v248, v32, v33
  v_mfma_f32_16x16x32_bf16 a[56:59], a[216:219], v[196:199], 0
  v_lshrrev_b32 v26, 5, v1
  v_exp_f32 v34, v162
  v_mfma_f32_16x16x32_bf16 a[60:63], a[220:223], v[196:199], 0
  s_cmp_lg_u64 vcc, 0
  ds_read_b128 a[176:179], v51 offset:20480
  ds_read_b128 a[180:183], v51 offset:21504
  v_mfma_f32_16x16x32_bf16 a[28:31], a[220:223], v[192:195], 0
  s_cbranch_scc1 Lrare23
Lrr24:
  v_exp_f32 v35, v163
  v_mfma_f32_16x16x32_bf16 a[64:67], a[192:195], v[200:203], 0
  v_mul_u32_u24 v26, 43520, v26
  ds_read_b128 a[184:187], v51 offset:22528
  v_cvt_pk_bf16_f32 v249, v34, v35
  v_mfma_f32_16x16x32_bf16 a[96:99], a[192:195], v[204:207], 0
  v_add_u32 v26, v26, v2
  v_exp_f32 v32, v164
  v_mfma_f32_16x16x32_bf16 a[100:103], a[196:199], v[204:207], 0
  s_lshr_b32 s72, s43, 2
  ds_read_b128 a[188:191], v51 offset:23552
  buffer_load_dwordx4 v30, s[8:11], s45 offen offset:3072 sc1 lds
  v_mfma_f32_16x16x32_bf16 a[68:71], a[196:199], v[200:203], 0
  s_add_u32 s45, s45, s101
  v_exp_f32 v33, v165
  v_mfma_f32_16x16x32_bf16 a[72:75], a[200:203], v[200:203], 0
  s_waitcnt vmcnt(16)
  v_cmp_ne_u32 vcc, 1, v28
  s_cbranch_vccz Lspok38
  s_mov_b32 s5, 0
Lspin37:
  s_sleep 16
  buffer_load_dword v28, v29, s[20:23], s55 offen sc1
  s_add_u32 s5, s5, 1
  s_waitcnt vmcnt(0)
  v_cmp_ne_u32 vcc, 1, v28
  s_cbranch_vccz Lspok38
  s_cmp_lt_u32 s5, 0x10000
  s_cbranch_scc1 Lspin37
Lspok38:
  v_cvt_pk_bf16_f32 v250, v32, v33
  v_mfma_f32_16x16x32_bf16 a[104:107], a[200:203], v[204:207], 0
  s_add_u32 m0, s54, s47
  v_exp_f32 v34, v166
  v_mfma_f32_16x16x32_bf16 a[108:111], a[204:207], v[204:207], 0
  s_sub_u32 s73, 15, s42
  buffer_load_dwordx4 v53, s[8:11], s45 offen offset:0 sc1 lds
  v_mfma_f32_16x16x32_bf16 a[76:79], a[204:207], v[200:203], 0
  s_cmp_eq_u32 s72, 0
  s_cselect_b32 s72, s42, s73
  v_exp_f32 v35, v167
  v_mfma_f32_16x16x32_bf16 a[80:83], a[208:211], v[200:203], 0
  s_cmp_gt_u32 s51, 1
  s_cselect_b64 s[0:1], -1, 0
  buffer_load_dwordx4 v54, s[8:11], s45 offen offset:1024 sc1 lds
  v_cvt_pk_bf16_f32 v251, v34, v35
  v_mfma_f32_16x16x32_bf16 a[112:115], a[208:211], v[204:207], 0
  s_cmp_eq_u32 s51, 1
  s_cselect_b64 s[66:67], s[56:57], s[0:1]
  s_cselect_b64 s[68:69], s[58:59], s[0:1]
  s_cselect_b64 s[34:35], s[60:61], s[0:1]
  s_cselect_b64 s[36:37], s[62:63], s[0:1]
  v_exp_f32 v32, v168
  v_mfma_f32_16x16x32_bf16 v[56:59], a[224:227], v[248:251], 0
  s_lshl_b32 s72, s72, 1
  v_cndmask_b32 v237, v50, v47, s[68:69]
  v_cndmask_b32 v236, v50, v47, s[66:67]
  v_mfma_f32_16x16x32_bf16 a[116:119], a[212:215], v[204:207], 0
  s_lshr_b32 s73, s40, 1
  v_exp_f32 v33, v169
  v_mfma_f32_16x16x32_bf16 a[84:87], a[212:215], v[200:203], 0
  s_add_u32 s72, s72, s73
  v_cndmask_b32 v238, v50, v47, s[34:35]
  v_cvt_pk_bf16_f32 v252, v32, v33
  v_mfma_f32_16x16x32_bf16 a[88:91], a[216:219], v[200:203], 0
  s_lshl_b32 s86, s72, 10
  v_exp_f32 v34, v170
  v_mfma_f32_16x16x32_bf16 a[120:123], a[216:219], v[204:207], 0
  s_and_b32 s72, s43, 3
  v_cndmask_b32 v239, v50, v47, s[36:37]
  v_add_f32 v36, v37, v56
  v_mfma_f32_16x16x32_bf16 a[124:127], a[220:223], v[204:207], 0
  s_lshl_b32 s72, s72, 8
  v_exp_f32 v35, v171
  v_mfma_f32_16x16x32_bf16 a[92:95], a[220:223], v[200:203], 0
  s_waitcnt lgkmcnt(4)
  buffer_load_dwordx4 v55, s[8:11], s45 offen offset:2048 sc1 lds
  v_cvt_pk_bf16_f32 v253, v34, v35
  v_mfma_f32_16x16x32_bf16 v[128:131], a[160:163], v[64:67], v[208:211]
  s_add_u32 s86, s86, s72
  v_exp_f32 v32, v172
  v_mfma_f32_16x16x32_bf16 v[128:131], a[164:167], v[68:71], v[128:131]
  s_lshr_b32 s72, s44, 1
  buffer_load_dwordx4 v30, s[8:11], s45 offen offset:3072 sc1 lds
  v_mfma_f32_16x16x32_bf16 v[128:131], a[168:171], v[72:75], v[128:131]
  s_add_u32 m0, m0, 4096
  v_exp_f32 v33, v173
  v_mfma_f32_16x16x32_bf16 v[128:131], a[172:175], v[76:79], v[128:131]
  s_add_u32 s45, s45, s100
  ds_read_b128 a[192:195], v52 offset:16384
  v_cvt_pk_bf16_f32 v254, v32, v33
  v_mfma_f32_16x16x32_bf16 v[136:139], a[172:175], v[92:95], v[216:219]
  s_lshl_b32 s72, s72, 7
  v_exp_f32 v34, v174
  v_mfma_f32_16x16x32_bf16 v[136:139], a[168:171], v[88:91], v[136:139]
  s_add_u32 s86, s86, s72
  ds_read_b128 a[196:199], v52 offset:17408
  v_mfma_f32_16x16x32_bf16 v[136:139], a[164:167], v[84:87], v[136:139]
  s_and_b32 s72, s44, 1
  v_exp_f32 v35, v175
  v_mfma_f32_16x16x32_bf16 v[136:139], a[160:163], v[80:83], v[136:139]
  s_waitcnt lgkmcnt(2)
  ds_read_b128 a[200:203], v52 offset:18432
  v_cvt_pk_bf16_f32 v255, v34, v35
  v_mfma_f32_16x16x32_bf16 v[140:143], a[176:179], v[80:83], v[220:223]
  s_lshl_b32 s72, s72, 3
  ds_read_b128 a[204:207], v52 offset:19456
  buffer_load_dwordx4 v53, s[8:11], s45 offen offset:0 sc1 lds
  v_mfma_f32_16x16x32_bf16 v[60:63], a[224:227], v[252:255], 0
  s_add_u32 s86, s86, s72
  v_mfma_f32_16x16x32_bf16 v[140:143], a[180:183], v[84:87], v[140:143]
  s_and_b32 s72, s40, 1
  v_exp_f32 v32, v176
  v_mfma_f32_16x16x32_bf16 v[140:143], a[184:187], v[88:91], v[140:143]
  s_lshl_b32 s72, s72, 2
  v_add_f32 v38, v39, v60
  v_max_f32 v48, v36, v38
  v_mfma_f32_16x16x32_bf16 v[140:143], a[188:191], v[92:95], v[140:143]
  s_add_u32 s86, s86, s72
  buffer_load_dwordx4 v54, s[8:11], s45 offen offset:1024 sc1 lds
  v_exp_f32 v33, v177
  v_mfma_f32_16x16x32_bf16 v[132:135], a[188:191], v[76:79], v[212:215]
  s_add_u32 s86, s86, 65142784
  v_cmp_lt_f32 vcc, v49, v48
  v_cvt_pk_bf16_f32 v200, v32, v33
  v_mfma_f32_16x16x32_bf16 v[132:135], a[184:187], v[72:75], v[132:135]
  v_exp_f32 v34, v178
  v_mfma_f32_16x16x32_bf16 v[132:135], a[180:183], v[68:71], v[132:135]
  s_cmp_lg_u64 vcc, 0
  ds_read_b128 a[208:211], v52 offset:20480
  ds_read_b128 a[212:215], v52 offset:21504
  v_mfma_f32_16x16x32_bf16 v[132:135], a[176:179], v[64:67], v[132:135]
  s_cbranch_scc1 Lrare26
Lrr27:
  v_exp_f32 v35, v179
  s_nop 0
  ds_read_b128 a[216:219], v52 offset:22528
  v_cvt_pk_bf16_f32 v201, v34, v35
  v_exp_f32 v32, v180
  s_nop 0
  ds_read_b128 a[220:223], v52 offset:23552
  buffer_load_dwordx4 v55, s[8:11], s45 offen offset:2048 sc1 lds
  v_exp_f32 v33, v181
  v_mfma_f32_16x16x32_bf16 v[152:155], a[160:163], v[112:115], v[232:235]
  s_mov_b64 exec, 1
  buffer_store_dword v20, off, s[20:23], s86 sc1
  s_mov_b64 exec, -1
  v_cvt_pk_bf16_f32 v202, v32, v33
  v_mfma_f32_16x16x32_bf16 v[152:155], a[164:167], v[116:119], v[152:155]
  v_exp_f32 v34, v182
  v_mfma_f32_16x16x32_bf16 v[152:155], a[168:171], v[120:123], v[152:155]
  buffer_load_dwordx4 v30, s[8:11], s45 offen offset:3072 sc1 lds
  v_mfma_f32_16x16x32_bf16 v[152:155], a[172:175], v[124:127], v[152:155]
  s_add_u32 s45, s45, s101
  v_exp_f32 v35, v183
  v_mfma_f32_16x16x32_bf16 v[156:159], a[176:179], v[112:115], v[236:239]
  v_cvt_pk_bf16_f32 v203, v34, v35
  v_mfma_f32_16x16x32_bf16 v[156:159], a[180:183], v[116:119], v[156:159]
  v_exp_f32 v32, v184
  v_mfma_f32_16x16x32_bf16 v[56:59], a[224:227], v[200:203], 0
  v_mfma_f32_16x16x32_bf16 v[156:159], a[184:187], v[120:123], v[156:159]
  v_exp_f32 v33, v185
  v_mfma_f32_16x16x32_bf16 v[156:159], a[188:191], v[124:127], v[156:159]
  buffer_store_dwordx4 v[20:23], v2, s[20:23], s87 offen sc1
  v_cvt_pk_bf16_f32 v204, v32, v33
  v_exp_f32 v34, v186
  s_nop 0
  v_add_f32 v40, v41, v56
  v_exp_f32 v35, v187
  s_nop 0
  s_waitcnt lgkmcnt(4)
  v_cvt_pk_bf16_f32 v205, v34, v35
  v_mfma_f32_16x16x32_bf16 a[0:3], a[192:195], v[248:251], a[0:3]
  s_cmp_gt_u32 s51, 2
  s_cselect_b64 s[0:1], -1, 0
  v_exp_f32 v32, v188
  v_mfma_f32_16x16x32_bf16 a[32:35], a[192:195], v[252:255], a[32:35]
  s_cmp_eq_u32 s51, 2
  s_cselect_b64 s[66:67], s[56:57], s[0:1]
  s_cselect_b64 s[68:69], s[58:59], s[0:1]
  s_cselect_b64 s[34:35], s[60:61], s[0:1]
  s_cselect_b64 s[36:37], s[62:63], s[0:1]
  v_mfma_f32_16x16x32_bf16 a[36:39], a[196:199], v[252:255], a[36:39]
  v_exp_f32 v33, v189
  v_mfma_f32_16x16x32_bf16 a[4:7], a[196:199], v[248:251], a[4:7]
  buffer_store_dwordx4 v[20:23], v26, s[20:23], s88 offen sc1
  v_cndmask_b32 v232, v50, v47, s[66:67]
  v_cvt_pk_bf16_f32 v206, v32, v33
  v_mfma_f32_16x16x32_bf16 a[8:11], a[200:203], v[248:251], a[8:11]
  s_add_u32 s87, s87, 1024
  v_exp_f32 v34, v190
  v_mfma_f32_16x16x32_bf16 a[40:43], a[200:203], v[252:255], a[40:43]
  s_add_u32 s88, s88, 512
  v_cndmask_b32 v234, v50, v47, s[34:35]
  v_cndmask_b32 v233, v50, v47, s[68:69]
  v_mfma_f32_16x16x32_bf16 a[44:47], a[204:207], v[252:255], a[44:47]
  v_exp_f32 v35, v191
  v_mfma_f32_16x16x32_bf16 a[12:15], a[204:207], v[248:251], a[12:15]
  s_waitcnt lgkmcnt(0)
  v_cndmask_b32 v235, v50, v47, s[36:37]
  v_cvt_pk_bf16_f32 v207, v34, v35
  v_mfma_f32_16x16x32_bf16 a[16:19], a[208:211], v[248:251], a[16:19]
  ds_read_b128 a[160:163], v51 offset:24576
  ds_read_b128 a[164:167], v51 offset:25600
  v_mfma_f32_16x16x32_bf16 v[60:63], a[224:227], v[204:207], 0
  ds_read_b128 a[168:171], v51 offset:26624
  ds_read_b128 a[172:175], v51 offset:27648
  v_mfma_f32_16x16x32_bf16 a[48:51], a[208:211], v[252:255], a[48:51]
  v_exp_f32 v32, v128
  v_mfma_f32_16x16x32_bf16 a[52:55], a[212:215], v[252:255], a[52:55]
  v_add_f32 v42, v43, v60
  v_max_f32 v48, v40, v42
  v_mfma_f32_16x16x32_bf16 a[20:23], a[212:215], v[248:251], a[20:23]
  v_exp_f32 v33, v129
  v_mfma_f32_16x16x32_bf16 a[24:27], a[216:219], v[248:251], a[24:27]
  buffer_store_dwordx4 v[20:23], v2, s[20:23], s87 offen sc1
  v_cmp_lt_f32 vcc, v49, v48
  v_cvt_pk_bf16_f32 v192, v32, v33
  v_mfma_f32_16x16x32_bf16 a[56:59], a[216:219], v[252:255], a[56:59]
  v_exp_f32 v34, v130
  v_mfma_f32_16x16x32_bf16 a[60:63], a[220:223], v[252:255], a[60:63]
  s_cmp_lg_u64 vcc, 0
  ds_read_b128 a[176:179], v51 offset:28672
  ds_read_b128 a[180:183], v51 offset:29696
  v_mfma_f32_16x16x32_bf16 a[28:31], a[220:223], v[248:251], a[28:31]
  s_cbranch_scc1 Lrare29
Lrr30:
  v_exp_f32 v35, v131
  v_mfma_f32_16x16x32_bf16 a[64:67], a[192:195], v[200:203], a[64:67]
  ds_read_b128 a[184:187], v51 offset:30720
  v_cvt_pk_bf16_f32 v193, v34, v35
  v_mfma_f32_16x16x32_bf16 a[96:99], a[192:195], v[204:207], a[96:99]
  v_exp_f32 v32, v132
  v_mfma_f32_16x16x32_bf16 a[100:103], a[196:199], v[204:207], a[100:103]
  ds_read_b128 a[188:191], v51 offset:31744
  v_mfma_f32_16x16x32_bf16 a[68:71], a[196:199], v[200:203], a[68:71]
  v_exp_f32 v33, v133
  v_mfma_f32_16x16x32_bf16 a[72:75], a[200:203], v[200:203], a[72:75]
  buffer_store_dwordx4 v[20:23], v26, s[20:23], s88 offen sc1
  v_cvt_pk_bf16_f32 v194, v32, v33
  v_mfma_f32_16x16x32_bf16 a[104:107], a[200:203], v[204:207], a[104:107]
  s_add_u32 s87, s87, 1024
  v_exp_f32 v34, v134
  v_mfma_f32_16x16x32_bf16 a[108:111], a[204:207], v[204:207], a[108:111]
  s_add_u32 s88, s88, 512
  v_mfma_f32_16x16x32_bf16 a[76:79], a[204:207], v[200:203], a[76:79]
  v_exp_f32 v35, v135
  v_mfma_f32_16x16x32_bf16 a[80:83], a[208:211], v[200:203], a[80:83]
  s_cmp_gt_u32 s51, 3
  s_cselect_b64 s[0:1], -1, 0
  v_cvt_pk_bf16_f32 v195, v34, v35
  v_mfma_f32_16x16x32_bf16 a[112:115], a[208:211], v[204:207], a[112:115]
  s_cmp_eq_u32 s51, 3
  s_cselect_b64 s[66:67], s[56:57], s[0:1]
  s_cselect_b64 s[68:69], s[58:59], s[0:1]
  s_cselect_b64 s[34:35], s[60:61], s[0:1]
  s_cselect_b64 s[36:37], s[62:63], s[0:1]
  v_exp_f32 v32, v136
  v_mfma_f32_16x16x32_bf16 v[56:59], a[224:227], v[192:195], 0
  v_cndmask_b32 v237, v50, v47, s[68:69]
  v_cndmask_b32 v236, v50, v47, s[66:67]
  v_mfma_f32_16x16x32_bf16 a[116:119], a[212:215], v[204:207], a[116:119]
  v_exp_f32 v33, v137
  v_mfma_f32_16x16x32_bf16 a[84:87], a[212:215], v[200:203], a[84:87]
  v_cndmask_b32 v238, v50, v47, s[34:35]
  v_cvt_pk_bf16_f32 v196, v32, v33
  v_mfma_f32_16x16x32_bf16 a[88:91], a[216:219], v[200:203], a[88:91]
  v_exp_f32 v34, v138
  v_mfma_f32_16x16x32_bf16 a[120:123], a[216:219], v[204:207], a[120:123]
  v_cndmask_b32 v239, v50, v47, s[36:37]
  v_add_f32 v37, v36, v56
  v_mfma_f32_16x16x32_bf16 a[124:127], a[220:223], v[204:207], a[124:127]
  v_exp_f32 v35, v139
  v_mfma_f32_16x16x32_bf16 a[92:95], a[220:223], v[200:203], a[92:95]
  s_waitcnt lgkmcnt(4)
  buffer_store_dwordx4 v[20:23], v2, s[20:23], s87 offen sc1
  v_cvt_pk_bf16_f32 v197, v34, v35
  v_mfma_f32_16x16x32_bf16 v[160:163], a[160:163], v[64:67], v[208:211]
  v_exp_f32 v32, v140
  v_mfma_f32_16x16x32_bf16 v[160:163], a[164:167], v[68:71], v[160:163]
  v_mfma_f32_16x16x32_bf16 v[160:163], a[168:171], v[72:75], v[160:163]
  v_exp_f32 v33, v141
  v_mfma_f32_16x16x32_bf16 v[160:163], a[172:175], v[76:79], v[160:163]
  ds_read_b128 a[192:195], v52 offset:24576
  v_cvt_pk_bf16_f32 v198, v32, v33
  v_mfma_f32_16x16x32_bf16 v[168:171], a[172:175], v[92:95], v[216:219]
  v_exp_f32 v34, v142
  v_mfma_f32_16x16x32_bf16 v[168:171], a[168:171], v[88:91], v[168:171]
  ds_read_b128 a[196:199], v52 offset:25600
  v_mfma_f32_16x16x32_bf16 v[168:171], a[164:167], v[84:87], v[168:171]
  v_exp_f32 v35, v143
  v_mfma_f32_16x16x32_bf16 v[168:171], a[160:163], v[80:83], v[168:171]
  s_waitcnt lgkmcnt(2)
  ds_read_b128 a[200:203], v52 offset:26624
  v_cvt_pk_bf16_f32 v199, v34, v35
  v_mfma_f32_16x16x32_bf16 v[172:175], a[176:179], v[80:83], v[220:223]
  ds_read_b128 a[204:207], v52 offset:27648
  buffer_store_dwordx4 v[20:23], v26, s[20:23], s88 offen sc1
  v_mfma_f32_16x16x32_bf16 v[60:63], a[224:227], v[196:199], 0
  s_add_u32 s87, s87, 1024
  v_mfma_f32_16x16x32_bf16 v[172:175], a[180:183], v[84:87], v[172:175]
  s_add_u32 s88, s88, 512
  ds_read_b128 a[208:211], v52 offset:28672
  v_mfma_f32_16x16x32_bf16 v[172:175], a[184:187], v[88:91], v[172:175]
  s_lshl_b32 s72, s2, 2
  v_add_f32 v39, v38, v60
  v_max_f32 v48, v37, v39
  v_mfma_f32_16x16x32_bf16 v[172:175], a[188:191], v[92:95], v[172:175]
  s_add_u32 s72, s72, s40
  v_mfma_f32_16x16x32_bf16 v[164:167], a[188:191], v[76:79], v[212:215]
  s_lshl_b32 s72, s72, 12
  ds_read_b128 a[212:215], v52 offset:29696
  v_cmp_lt_f32 vcc, v49, v48
  v_mfma_f32_16x16x32_bf16 v[164:167], a[184:187], v[72:75], v[164:167]
  v_lshlrev_b32 v24, 2, v2
  v_mfma_f32_16x16x32_bf16 v[164:167], a[180:183], v[68:71], v[164:167]
  s_cmp_lg_u64 vcc, 0
  ds_read_b128 a[216:219], v52 offset:30720
  v_mfma_f32_16x16x32_bf16 v[164:167], a[176:179], v[64:67], v[164:167]
  s_cbranch_scc1 Lrare32
Lrr33:
  s_mov_b32 s16, s74
  ds_read_b128 a[220:223], v52 offset:31744
  s_and_b32 s17, s75, 0xffff
  s_mov_b32 s18, 4194304
  s_mov_b32 s19, 0x20000
  v_mfma_f32_16x16x32_bf16 v[184:187], a[160:163], v[112:115], v[232:235]
  v_mfma_f32_16x16x32_bf16 v[184:187], a[164:167], v[116:119], v[184:187]
  v_mfma_f32_16x16x32_bf16 v[184:187], a[168:171], v[120:123], v[184:187]
  v_mfma_f32_16x16x32_bf16 v[184:187], a[172:175], v[124:127], v[184:187]
  v_mfma_f32_16x16x32_bf16 v[188:191], a[176:179], v[112:115], v[236:239]
  v_mfma_f32_16x16x32_bf16 v[188:191], a[180:183], v[116:119], v[188:191]
  v_exp_f32 v32, v152
  s_nop 0
  v_mfma_f32_16x16x32_bf16 v[188:191], a[184:187], v[120:123], v[188:191]
  v_exp_f32 v33, v153
  v_mfma_f32_16x16x32_bf16 v[188:191], a[188:191], v[124:127], v[188:191]
  buffer_load_dword v27, v24, s[16:19], s72 offen
  v_cvt_pk_bf16_f32 v204, v32, v33
  v_exp_f32 v34, v154
  s_nop 0
  v_mov_b32 v41, v40
  v_exp_f32 v35, v155
  s_nop 0
  s_waitcnt lgkmcnt(4)
  v_cvt_pk_bf16_f32 v205, v34, v35
  v_mfma_f32_16x16x32_bf16 a[0:3], a[192:195], v[192:195], a[0:3]
  v_exp_f32 v32, v156
  v_mfma_f32_16x16x32_bf16 a[32:35], a[192:195], v[196:199], a[32:35]
  v_mfma_f32_16x16x32_bf16 a[36:39], a[196:199], v[196:199], a[36:39]
  v_exp_f32 v33, v157
  v_mfma_f32_16x16x32_bf16 a[4:7], a[196:199], v[192:195], a[4:7]
  v_cvt_pk_bf16_f32 v206, v32, v33
  v_mfma_f32_16x16x32_bf16 a[8:11], a[200:203], v[192:195], a[8:11]
  v_exp_f32 v34, v158
  v_mfma_f32_16x16x32_bf16 a[40:43], a[200:203], v[196:199], a[40:43]
  v_mfma_f32_16x16x32_bf16 a[44:47], a[204:207], v[196:199], a[44:47]
  v_exp_f32 v35, v159
  v_mfma_f32_16x16x32_bf16 a[12:15], a[204:207], v[192:195], a[12:15]
  s_waitcnt lgkmcnt(0)
  v_cvt_pk_bf16_f32 v207, v34, v35
  v_mfma_f32_16x16x32_bf16 a[16:19], a[208:211], v[192:195], a[16:19]
  s_waitcnt vmcnt(16)
  s_barrier
  v_add_u32 v51, s53, v2
  v_xor_b32 v52, 32768, v52
  v_mfma_f32_16x16x32_bf16 v[60:63], a[224:227], v[204:207], 0
  s_mov_b32 s4, s52
  ds_read_b128 a[128:131], v51 offset:0
  ds_read_b128 a[132:135], v51 offset:1024
  ds_read_b128 a[136:139], v51 offset:2048
  v_mfma_f32_16x16x32_bf16 a[48:51], a[208:211], v[196:199], a[48:51]
  s_mov_b32 s52, s53
  ds_read_b128 a[140:143], v51 offset:3072
  v_exp_f32 v32, v160
  v_mfma_f32_16x16x32_bf16 a[52:55], a[212:215], v[196:199], a[52:55]
  s_mov_b32 s53, s54
  v_add_f32 v43, v42, v60
  v_max_f32 v48, v41, v43
  v_mfma_f32_16x16x32_bf16 a[20:23], a[212:215], v[192:195], a[20:23]
  s_mov_b32 s54, s4
  v_exp_f32 v33, v161
  v_mfma_f32_16x16x32_bf16 a[24:27], a[216:219], v[192:195], a[24:27]
  s_add_u32 s49, s49, 1
  v_cmp_lt_f32 vcc, v49, v48
  v_cvt_pk_bf16_f32 v248, v32, v33
  v_mfma_f32_16x16x32_bf16 a[56:59], a[216:219], v[196:199], a[56:59]
  v_exp_f32 v34, v162
  v_mfma_f32_16x16x32_bf16 a[60:63], a[220:223], v[196:199], a[60:63]
  s_cmp_lg_u64 vcc, 0
  ds_read_b128 a[144:147], v51 offset:4096
  ds_read_b128 a[148:151], v51 offset:5120
  v_mfma_f32_16x16x32_bf16 a[28:31], a[220:223], v[192:195], a[28:31]
  s_cbranch_scc1 Lrare35
Lrr36:
  v_exp_f32 v35, v163
  s_nop 0
  ds_read_b128 a[152:155], v51 offset:6144
  v_cvt_pk_bf16_f32 v249, v34, v35
  v_mfma_f32_16x16x32_bf16 a[96:99], a[192:195], v[204:207], a[96:99]
  v_exp_f32 v32, v164
  v_mfma_f32_16x16x32_bf16 a[100:103], a[196:199], v[204:207], a[100:103]
  ds_read_b128 a[156:159], v51 offset:7168
  v_exp_f32 v33, v165
  s_nop 0
  v_cvt_pk_bf16_f32 v250, v32, v33
  v_mfma_f32_16x16x32_bf16 a[104:107], a[200:203], v[204:207], a[104:107]
  v_exp_f32 v34, v166
  v_mfma_f32_16x16x32_bf16 a[108:111], a[204:207], v[204:207], a[108:111]
  v_exp_f32 v35, v167
  s_nop 0
  v_cvt_pk_bf16_f32 v251, v34, v35
  v_mfma_f32_16x16x32_bf16 a[112:115], a[208:211], v[204:207], a[112:115]
  v_exp_f32 v32, v168
  v_mfma_f32_16x16x32_bf16 v[56:59], a[224:227], v[248:251], 0
  v_mfma_f32_16x16x32_bf16 a[116:119], a[212:215], v[204:207], a[116:119]
  v_exp_f32 v33, v169
  s_nop 0
  v_cvt_pk_bf16_f32 v252, v32, v33
  v_exp_f32 v34, v170
  v_mfma_f32_16x16x32_bf16 a[120:123], a[216:219], v[204:207], a[120:123]
  v_add_f32 v36, v37, v56
  v_mfma_f32_16x16x32_bf16 a[124:127], a[220:223], v[204:207], a[124:127]
  v_exp_f32 v35, v171
  s_nop 0
  v_cvt_pk_bf16_f32 v253, v34, v35
  s_branch Ltr
Lt7:
  s_cmp_gt_u32 s51, 0
  s_cselect_b64 s[0:1], -1, 0
  s_cmp_eq_u32 s51, 0
  s_cselect_b64 s[66:67], s[56:57], s[0:1]
  s_cselect_b64 s[68:69], s[58:59], s[0:1]
  s_cselect_b64 s[34:35], s[60:61], s[0:1]
  s_cselect_b64 s[36:37], s[62:63], s[0:1]
  v_cndmask_b32 v208, v50, v44, s[66:67]
  v_cndmask_b32 v209, v50, v44, s[68:69]
  v_cndmask_b32 v210, v50, v44, s[34:35]
  v_cndmask_b32 v211, v50, v44, s[36:37]
  s_cmp_gt_u32 s51, 1
  s_cselect_b64 s[0:1], -1, 0
  s_cmp_eq_u32 s51, 1
  s_cselect_b64 s[66:67], s[56:57], s[0:1]
  s_cselect_b64 s[68:69], s[58:59], s[0:1]
  s_cselect_b64 s[34:35], s[60:61], s[0:1]
  s_cselect_b64 s[36:37], s[62:63], s[0:1]
  v_cndmask_b32 v212, v50, v44, s[66:67]
  v_cndmask_b32 v213, v50, v44, s[68:69]
  v_cndmask_b32 v214, v50, v44, s[34:35]
  v_cndmask_b32 v215, v50, v44, s[36:37]
  s_nop 0
  s_waitcnt lgkmcnt(4)
  v_mfma_f32_16x16x32_bf16 v[128:131], a[128:131], v[64:67], v[208:211]
  s_cmp_gt_u32 s51, 2
  s_cselect_b64 s[0:1], -1, 0
  v_exp_f32 v32, v172
  v_mfma_f32_16x16x32_bf16 v[128:131], a[132:135], v[68:71], v[128:131]
  s_cmp_eq_u32 s51, 2
  s_cselect_b64 s[66:67], s[56:57], s[0:1]
  s_cselect_b64 s[68:69], s[58:59], s[0:1]
  s_cselect_b64 s[34:35], s[60:61], s[0:1]
  s_cselect_b64 s[36:37], s[62:63], s[0:1]
  v_mfma_f32_16x16x32_bf16 v[128:131], a[136:139], v[72:75], v[128:131]
  s_add_u32 m0, s48, 0
  v_cndmask_b32 v225, v50, v44, s[68:69]
  v_exp_f32 v33, v173
  v_mfma_f32_16x16x32_bf16 v[128:131], a[140:143], v[76:79], v[128:131]
  buffer_load_dwordx4 v2, s[12:15], s46 offen offset:0 sc1 lds
  v_cndmask_b32 v226, v50, v44, s[34:35]
  v_cndmask_b32 v224, v50, v44, s[66:67]
  v_cvt_pk_bf16_f32 v254, v32, v33
  v_mfma_f32_16x16x32_bf16 v[136:139], a[140:143], v[92:95], v[216:219]
  v_cndmask_b32 v227, v50, v44, s[36:37]
  v_exp_f32 v34, v174
  v_mfma_f32_16x16x32_bf16 v[136:139], a[136:139], v[88:91], v[136:139]
  s_cmp_gt_u32 s51, 3
  s_cselect_b64 s[0:1], -1, 0
  ds_read_b128 a[160:163], v51 offset:8192
  ds_read_b128 a[164:167], v51 offset:9216
  v_mfma_f32_16x16x32_bf16 v[136:139], a[132:135], v[84:87], v[136:139]
  s_cmp_eq_u32 s51, 3
  s_cselect_b64 s[66:67], s[56:57], s[0:1]
  s_cselect_b64 s[68:69], s[58:59], s[0:1]
  s_cselect_b64 s[34:35], s[60:61], s[0:1]
  s_cselect_b64 s[36:37], s[62:63], s[0:1]
  v_exp_f32 v35, v175
  v_mfma_f32_16x16x32_bf16 v[136:139], a[128:131], v[80:83], v[136:139]
  s_waitcnt lgkmcnt(2)
  ds_read_b128 a[168:171], v51 offset:10240
  v_cndmask_b32 v228, v50, v44, s[66:67]
  v_cvt_pk_bf16_f32 v255, v34, v35
  v_mfma_f32_16x16x32_bf16 v[140:143], a[144:147], v[80:83], v[220:223]
  ds_read_b128 a[172:175], v51 offset:11264
  v_cndmask_b32 v230, v50, v44, s[34:35]
  v_cndmask_b32 v229, v50, v44, s[68:69]
  v_mfma_f32_16x16x32_bf16 v[60:63], a[224:227], v[252:255], 0
  ds_read_b128 a[176:179], v51 offset:12288
  v_mov_b32 v232, v45
  v_cndmask_b32 v231, v50, v44, s[36:37]
  v_mfma_f32_16x16x32_bf16 v[140:143], a[148:151], v[84:87], v[140:143]
  buffer_load_dwordx4 v2, s[12:15], s46 offen offset:1024 sc1 lds
  v_mov_b32 v234, v45
  v_mov_b32 v233, v45
  v_mfma_f32_16x16x32_bf16 v[140:143], a[152:155], v[88:91], v[140:143]
  v_add_f32 v38, v39, v60
  v_max_f32 v48, v36, v38
  v_mfma_f32_16x16x32_bf16 v[140:143], a[156:159], v[92:95], v[140:143]
  buffer_load_dwordx4 v2, s[12:15], s46 offen offset:2048 sc1 lds
  v_mov_b32 v236, v45
  v_mov_b32 v235, v45
  v_mfma_f32_16x16x32_bf16 v[132:135], a[156:159], v[76:79], v[212:215]
  v_mov_b32 v237, v45
  v_cmp_lt_f32 vcc, v49, v48
  v_mfma_f32_16x16x32_bf16 v[132:135], a[152:155], v[72:75], v[132:135]
  s_waitcnt lgkmcnt(1)
  v_mov_b32 v239, v45
  v_mov_b32 v238, v45
  v_mfma_f32_16x16x32_bf16 v[132:135], a[148:151], v[68:71], v[132:135]
  s_cmp_lg_u64 vcc, 0
  ds_read_b128 a[180:183], v51 offset:13312
  ds_read_b128 a[184:187], v51 offset:14336
  v_mfma_f32_16x16x32_bf16 v[132:135], a[144:147], v[64:67], v[132:135]
  s_cbranch_scc1 Lrare89
Lrr90:
  ds_read_b128 a[188:191], v51 offset:15360
  v_mfma_f32_16x16x32_bf16 v[144:147], a[160:163], v[64:67], v[224:227]
  ds_read_b128 a[192:195], v52 offset:0
  ds_read_b128 a[196:199], v52 offset:1024
  v_mfma_f32_16x16x32_bf16 v[144:147], a[164:167], v[68:71], v[144:147]
  ds_read_b128 a[200:203], v52 offset:2048
  buffer_load_dwordx4 v2, s[12:15], s46 offen offset:3072 sc1 lds
  v_mfma_f32_16x16x32_bf16 v[144:147], a[168:171], v[72:75], v[144:147]
  s_add_u32 m0, s48, 4096
  v_mfma_f32_16x16x32_bf16 v[144:147], a[172:175], v[76:79], v[144:147]
  s_cmp_gt_u32 s51, 0
  s_cselect_b64 s[0:1], -1, 0
  ds_read_b128 a[204:207], v52 offset:3072
  v_mfma_f32_16x16x32_bf16 v[152:155], a[172:175], v[92:95], v[232:235]
  s_cmp_eq_u32 s51, 0
  s_cselect_b64 s[66:67], s[56:57], s[0:1]
  s_cselect_b64 s[68:69], s[58:59], s[0:1]
  s_cselect_b64 s[34:35], s[60:61], s[0:1]
  s_cselect_b64 s[36:37], s[62:63], s[0:1]
  v_mfma_f32_16x16x32_bf16 v[152:155], a[168:171], v[88:91], v[152:155]
  s_add_u32 s46, s46, 4096
  v_cndmask_b32 v217, v50, v45, s[68:69]
  v_cndmask_b32 v216, v50, v45, s[66:67]
  v_mfma_f32_16x16x32_bf16 v[152:155], a[164:167], v[84:87], v[152:155]
  v_cndmask_b32 v219, v50, v45, s[36:37]
  v_cndmask_b32 v218, v50, v45, s[34:35]
  v_mfma_f32_16x16x32_bf16 v[152:155], a[160:163], v[80:83], v[152:155]
  s_waitcnt lgkmcnt(4)
  ds_read_b128 a[208:211], v52 offset:4096
  buffer_load_dwordx4 v2, s[12:15], s46 offen offset:0 sc1 lds
  v_mfma_f32_16x16x32_bf16 v[156:159], a[176:179], v[80:83], v[236:239]
  ds_read_b128 a[212:215], v52 offset:5120
  v_mfma_f32_16x16x32_bf16 v[156:159], a[180:183], v[84:87], v[156:159]
  v_exp_f32 v32, v184
  s_nop 0
  ds_read_b128 a[216:219], v52 offset:6144
  buffer_load_dwordx4 v2, s[12:15], s46 offen offset:1024 sc1 lds
  v_mfma_f32_16x16x32_bf16 v[156:159], a[184:187], v[88:91], v[156:159]
  v_exp_f32 v33, v185
  v_mfma_f32_16x16x32_bf16 v[156:159], a[188:191], v[92:95], v[156:159]
  ds_read_b128 a[220:223], v52 offset:7168
  v_cvt_pk_bf16_f32 v204, v32, v33
  v_mfma_f32_16x16x32_bf16 v[148:151], a[188:191], v[76:79], v[228:231]
  v_exp_f32 v34, v186
  v_mfma_f32_16x16x32_bf16 v[148:151], a[184:187], v[72:75], v[148:151]
  s_waitcnt lgkmcnt(4)
  v_mov_b32 v40, v41
  v_mfma_f32_16x16x32_bf16 v[148:151], a[180:183], v[68:71], v[148:151]
  s_cmp_gt_u32 s51, 1
  s_cselect_b64 s[0:1], -1, 0
  v_exp_f32 v35, v187
  v_mfma_f32_16x16x32_bf16 v[148:151], a[176:179], v[64:67], v[148:151]
  s_cmp_eq_u32 s51, 1
  s_cselect_b64 s[66:67], s[56:57], s[0:1]
  s_cselect_b64 s[68:69], s[58:59], s[0:1]
  s_cselect_b64 s[34:35], s[60:61], s[0:1]
  s_cselect_b64 s[36:37], s[62:63], s[0:1]
  v_cvt_pk_bf16_f32 v205, v34, v35
  v_mfma_f32_16x16x32_bf16 a[0:3], a[192:195], v[248:251], a[0:3]
  buffer_load_dwordx4 v2, s[12:15], s46 offen offset:2048 sc1 lds
  v_exp_f32 v32, v188
  v_mfma_f32_16x16x32_bf16 a[32:35], a[192:195], v[252:255], a[32:35]
  v_cndmask_b32 v221, v50, v45, s[68:69]
  v_cndmask_b32 v220, v50, v45, s[66:67]
  v_mfma_f32_16x16x32_bf16 a[36:39], a[196:199], v[252:255], a[36:39]
  v_exp_f32 v33, v189
  v_mfma_f32_16x16x32_bf16 a[4:7], a[196:199], v[248:251], a[4:7]
  v_cndmask_b32 v222, v50, v45, s[34:35]
  v_cvt_pk_bf16_f32 v206, v32, v33
  v_mfma_f32_16x16x32_bf16 a[8:11], a[200:203], v[248:251], a[8:11]
  v_exp_f32 v34, v190
  v_mfma_f32_16x16x32_bf16 a[40:43], a[200:203], v[252:255], a[40:43]
  buffer_load_dwordx4 v2, s[12:15], s46 offen offset:3072 sc1 lds
  v_cndmask_b32 v223, v50, v45, s[36:37]
  v_mfma_f32_16x16x32_bf16 a[44:47], a[204:207], v[252:255], a[44:47]
  s_add_u32 s46, s46, 28672
  v_exp_f32 v35, v191
  v_mfma_f32_16x16x32_bf16 a[12:15], a[204:207], v[248:251], a[12:15]
  s_waitcnt lgkmcnt(0)
  buffer_store_dwordx4 v[20:23], v2, s[20:23], s87 offen sc1
  v_cvt_pk_bf16_f32 v207, v34, v35
  v_mfma_f32_16x16x32_bf16 a[16:19], a[208:211], v[248:251], a[16:19]
  s_xor_b32 s48, s48, 32768
  v_mfma_f32_16x16x32_bf16 v[60:63], a[224:227], v[204:207], 0
  s_add_u32 m0, s54, s47
  v_mfma_f32_16x16x32_bf16 a[48:51], a[208:211], v[252:255], a[48:51]
  buffer_load_dwordx4 v53, s[8:11], s45 offen offset:0 sc1 lds
  v_exp_f32 v32, v128
  v_mfma_f32_16x16x32_bf16 a[52:55], a[212:215], v[252:255], a[52:55]
  buffer_store_dwordx4 v[20:23], v26, s[20:23], s88 offen sc1
  v_add_f32 v42, v43, v60
  v_max_f32 v48, v40, v42
  v_mfma_f32_16x16x32_bf16 a[20:23], a[212:215], v[248:251], a[20:23]
  s_cmp_gt_u32 s51, 2
  s_cselect_b64 s[0:1], -1, 0
  v_exp_f32 v33, v129
  v_mfma_f32_16x16x32_bf16 a[24:27], a[216:219], v[248:251], a[24:27]
  s_cmp_eq_u32 s51, 2
  s_cselect_b64 s[66:67], s[56:57], s[0:1]
  s_cselect_b64 s[68:69], s[58:59], s[0:1]
  s_cselect_b64 s[34:35], s[60:61], s[0:1]
  s_cselect_b64 s[36:37], s[62:63], s[0:1]
  v_cmp_lt_f32 vcc, v49, v48
  v_cvt_pk_bf16_f32 v192, v32, v33
  v_mfma_f32_16x16x32_bf16 a[56:59], a[216:219], v[252:255], a[56:59]
  s_add_u32 s87, s87, 1024
  buffer_load_dwordx4 v54, s[8:11], s45 offen offset:1024 sc1 lds
  v_exp_f32 v34, v130
  v_mfma_f32_16x16x32_bf16 a[60:63], a[220:223], v[252:255], a[60:63]
  s_cmp_lg_u64 vcc, 0
  v_cndmask_b32 v233, v50, v45, s[68:69]
  v_cndmask_b32 v232, v50, v45, s[66:67]
  v_mfma_f32_16x16x32_bf16 a[28:31], a[220:223], v[248:251], a[28:31]
  s_cbranch_scc1 Lrare92
Lrr93:
  v_exp_f32 v35, v131
  s_nop 0
  s_add_u32 s88, s88, 512
  v_cndmask_b32 v234, v50, v45, s[34:35]
  v_cvt_pk_bf16_f32 v193, v34, v35
  v_mfma_f32_16x16x32_bf16 a[96:99], a[192:195], v[204:207], a[96:99]
  buffer_load_dwordx4 v55, s[8:11], s45 offen offset:2048 sc1 lds
  v_exp_f32 v32, v132
  v_mfma_f32_16x16x32_bf16 a[100:103], a[196:199], v[204:207], a[100:103]
  ds_read_b128 a[160:163], v51 offset:16384
  v_cndmask_b32 v235, v50, v45, s[36:37]
  buffer_store_dwordx4 v[20:23], v2, s[20:23], s87 offen sc1
  v_exp_f32 v33, v133
  s_nop 0
  ds_read_b128 a[164:167], v51 offset:17408
  v_cvt_pk_bf16_f32 v194, v32, v33
  v_mfma_f32_16x16x32_bf16 a[104:107], a[200:203], v[204:207], a[104:107]
  v_exp_f32 v34, v134
  v_mfma_f32_16x16x32_bf16 a[108:111], a[204:207], v[204:207], a[108:111]
  ds_read_b128 a[168:171], v51 offset:18432
  ds_read_b128 a[172:175], v51 offset:19456
  buffer_load_dwordx4 v30, s[8:11], s45 offen offset:3072 sc1 lds
  s_add_u32 m0, m0, 4096
  buffer_store_dwordx4 v[20:23], v26, s[20:23], s88 offen sc1
  v_exp_f32 v35, v135
  s_nop 0
  s_add_u32 s45, s45, s100
  ds_read_b128 a[176:179], v51 offset:20480
  v_cvt_pk_bf16_f32 v195, v34, v35
  v_mfma_f32_16x16x32_bf16 a[112:115], a[208:211], v[204:207], a[112:115]
  s_add_u32 s87, s87, 1024
  v_exp_f32 v32, v136
  v_mfma_f32_16x16x32_bf16 v[56:59], a[224:227], v[192:195], 0
  s_add_u32 s88, s88, 512
  ds_read_b128 a[180:183], v51 offset:21504
  ds_read_b128 a[184:187], v51 offset:22528
  v_mfma_f32_16x16x32_bf16 a[116:119], a[212:215], v[204:207], a[116:119]
  v_exp_f32 v33, v137
  s_nop 0
  ds_read_b128 a[188:191], v51 offset:23552
  buffer_load_dwordx4 v53, s[8:11], s45 offen offset:0 sc1 lds
  v_cvt_pk_bf16_f32 v196, v32, v33
  buffer_store_dwordx4 v[20:23], v2, s[20:23], s87 offen sc1
  v_exp_f32 v34, v138
  v_mfma_f32_16x16x32_bf16 a[120:123], a[216:219], v[204:207], a[120:123]
  s_cmp_gt_u32 s51, 3
  s_cselect_b64 s[0:1], -1, 0
  v_add_f32 v37, v36, v56
  v_mfma_f32_16x16x32_bf16 a[124:127], a[220:223], v[204:207], a[124:127]
  s_cmp_eq_u32 s51, 3
  s_cselect_b64 s[66:67], s[56:57], s[0:1]
  s_cselect_b64 s[68:69], s[58:59], s[0:1]
  s_cselect_b64 s[34:35], s[60:61], s[0:1]
  s_cselect_b64 s[36:37], s[62:63], s[0:1]
  v_exp_f32 v35, v139
  s_nop 0
  buffer_store_dwordx4 v[20:23], v26, s[20:23], s88 offen sc1
  v_cndmask_b32 v236, v50, v45, s[66:67]
  v_cvt_pk_bf16_f32 v197, v34, v35
  s_add_u32 s87, s87, 1024
  buffer_load_dwordx4 v54, s[8:11], s45 offen offset:1024 sc1 lds
  v_exp_f32 v32, v140
  s_nop 0
  s_add_u32 s88, s88, 512
  v_cndmask_b32 v238, v50, v45, s[34:35]
  v_cndmask_b32 v237, v50, v45, s[68:69]
  s_lshl_b32 s72, s2, 2
  v_exp_f32 v33, v141
  s_nop 0
  s_waitcnt lgkmcnt(4)
  v_cndmask_b32 v239, v50, v45, s[36:37]
  v_cvt_pk_bf16_f32 v198, v32, v33
  v_mfma_f32_16x16x32_bf16 v[168:171], a[160:163], v[80:83], v[216:219]
  s_add_u32 s72, s72, s40
  v_rcp_f32 v40, v40
  v_rcp_f32 v42, v42
  v_exp_f32 v34, v142
  v_mfma_f32_16x16x32_bf16 v[168:171], a[164:167], v[84:87], v[168:171]
  s_lshl_b32 s72, s72, 11
  ds_read_b128 a[192:195], v51 offset:24576
  ds_read_b128 a[196:199], v51 offset:25600
  buffer_load_dwordx4 v55, s[8:11], s45 offen offset:2048 sc1 lds
  v_accvgpr_read_b32 v4, a64
  v_mfma_f32_16x16x32_bf16 v[168:171], a[168:171], v[88:91], v[168:171]
  v_lshlrev_b32 v24, 1, v2
  v_accvgpr_read_b32 v5, a65
  v_exp_f32 v35, v143
  v_mfma_f32_16x16x32_bf16 v[168:171], a[172:175], v[92:95], v[168:171]
  s_waitcnt lgkmcnt(2)
  ds_read_b128 a[200:203], v51 offset:26624
  v_accvgpr_read_b32 v6, a66
  v_accvgpr_read_b32 v7, a67
  v_accvgpr_read_b32 v8, a68
  v_cvt_pk_bf16_f32 v199, v34, v35
  v_mfma_f32_16x16x32_bf16 v[172:175], a[176:179], v[80:83], v[220:223]
  s_mov_b32 s24, s78
  ds_read_b128 a[204:207], v51 offset:27648
  ds_read_b128 a[208:211], v51 offset:28672
  v_accvgpr_read_b32 v9, a69
  v_accvgpr_read_b32 v10, a70
  v_mfma_f32_16x16x32_bf16 v[60:63], a[224:227], v[196:199], 0
  s_and_b32 s25, s79, 0xffff
  ds_read_b128 a[212:215], v51 offset:29696
  ds_read_b128 a[216:219], v51 offset:30720
  v_accvgpr_read_b32 v11, a71
  v_mul_f32 v4, v4, v40
  v_mfma_f32_16x16x32_bf16 v[172:175], a[180:183], v[84:87], v[172:175]
  s_mov_b32 s26, 1409024
  buffer_load_dwordx4 v30, s[8:11], s45 offen offset:3072 sc1 lds
  v_mul_f32 v5, v5, v40
  v_mul_f32 v6, v6, v40
  v_exp_f32 v32, v144
  v_mfma_f32_16x16x32_bf16 v[172:175], a[184:187], v[88:91], v[172:175]
  s_add_u32 s45, s45, s101
  v_mul_f32 v7, v7, v40
  v_mul_f32 v8, v8, v40
  v_add_f32 v39, v38, v60
  v_max_f32 v48, v37, v39
  v_mfma_f32_16x16x32_bf16 v[172:175], a[188:191], v[92:95], v[172:175]
  s_mov_b32 s27, 0x20000
  v_mul_f32 v9, v9, v40
  v_mul_f32 v10, v10, v40
  v_exp_f32 v33, v145
  s_nop 0
  v_mul_f32 v11, v11, v40
  v_cvt_pk_bf16_f32 v96, v4, v5
  v_cvt_pk_bf16_f32 v97, v6, v7
  v_cmp_lt_f32 vcc, v49, v48
  v_cvt_pk_bf16_f32 v200, v32, v33
  v_cvt_pk_bf16_f32 v98, v8, v9
  v_cvt_pk_bf16_f32 v99, v10, v11
  v_exp_f32 v34, v146
  s_nop 0
  s_cmp_lg_u64 vcc, 0
  ds_read_b128 a[220:223], v51 offset:31744
  ds_read_b128 a[160:163], v52 offset:8192
  buffer_load_dword v27, v24, s[24:27], s72 offen
  buffer_store_dwordx4 v[96:99], v2, s[20:23], s38 offen offset:0 sc1
  s_cbranch_scc1 Lrare95
Lrr96:
  v_accvgpr_read_b32 v12, a72
  v_accvgpr_read_b32 v13, a73
  v_exp_f32 v35, v147
  s_nop 0
  s_lshl_b32 s72, s2, 2
  ds_read_b128 a[164:167], v52 offset:9216
  v_accvgpr_read_b32 v14, a74
  v_accvgpr_read_b32 v15, a75
  v_cvt_pk_bf16_f32 v201, v34, v35
  s_add_u32 s72, s72, s40
  v_accvgpr_read_b32 v16, a76
  v_accvgpr_read_b32 v17, a77
  v_exp_f32 v32, v148
  s_nop 0
  s_lshl_b32 s72, s72, 11
  ds_read_b128 a[168:171], v52 offset:10240
  buffer_load_dword v27, v0, s[28:31], 0 offen
  v_accvgpr_read_b32 v18, a78
  v_accvgpr_read_b32 v19, a79
  v_mul_f32 v12, v12, v40
  s_waitcnt lgkmcnt(7)
  v_mul_f32 v13, v13, v40
  v_mul_f32 v14, v14, v40
  v_exp_f32 v33, v149
  v_mfma_f32_16x16x32_bf16 v[184:187], a[192:195], v[80:83], v[232:235]
  s_add_u32 s3, s49, 2
  ds_read_b128 a[172:175], v52 offset:11264
  v_mul_f32 v15, v15, v40
  v_mul_f32 v16, v16, v40
  v_cvt_pk_bf16_f32 v202, v32, v33
  v_mfma_f32_16x16x32_bf16 v[184:187], a[196:199], v[84:87], v[184:187]
  s_cmp_gt_u32 s3, s50
  s_cselect_b32 s18, 4194304, 0
  v_mul_f32 v17, v17, v40
  v_mul_f32 v18, v18, v40
  v_mul_f32 v19, v19, v40
  v_exp_f32 v34, v150
  v_mfma_f32_16x16x32_bf16 v[184:187], a[200:203], v[88:91], v[184:187]
  v_lshlrev_b32 v24, 1, v2
  ds_read_b128 a[176:179], v52 offset:12288
  s_waitcnt vmcnt(48)
  buffer_load_dword v27, v25, s[16:19], s32 offen
  v_cvt_pk_bf16_f32 v100, v12, v13
  v_mfma_f32_16x16x32_bf16 v[184:187], a[204:207], v[92:95], v[184:187]
  s_waitcnt lgkmcnt(5)
  v_cvt_pk_bf16_f32 v101, v14, v15
  v_cvt_pk_bf16_f32 v102, v16, v17
  v_exp_f32 v35, v151
  v_mfma_f32_16x16x32_bf16 v[188:191], a[208:211], v[80:83], v[236:239]
  s_mov_b32 s24, s82
  ds_read_b128 a[180:183], v52 offset:13312
  v_cvt_pk_bf16_f32 v103, v18, v19
  buffer_store_dwordx4 v[100:103], v2, s[20:23], s38 offen offset:1024 sc1
  v_accvgpr_read_b32 v4, a80
  v_cvt_pk_bf16_f32 v203, v34, v35
  v_mfma_f32_16x16x32_bf16 v[188:191], a[212:215], v[84:87], v[188:191]
  s_and_b32 s25, s83, 0xffff
  v_accvgpr_read_b32 v5, a81
  v_accvgpr_read_b32 v6, a82
  v_exp_f32 v32, v152
  v_mfma_f32_16x16x32_bf16 v[56:59], a[224:227], v[200:203], 0
  s_mov_b32 s26, 1409024
  ds_read_b128 a[184:187], v52 offset:14336
  v_accvgpr_read_b32 v7, a83
  v_accvgpr_read_b32 v8, a84
  v_accvgpr_read_b32 v9, a85
  v_mfma_f32_16x16x32_bf16 v[188:191], a[216:219], v[88:91], v[188:191]
  s_mov_b32 s27, 0x20000
  v_accvgpr_read_b32 v10, a86
  v_accvgpr_read_b32 v11, a87
  v_mul_f32 v4, v4, v40
  v_exp_f32 v33, v153
  v_mfma_f32_16x16x32_bf16 v[188:191], a[220:223], v[92:95], v[188:191]
  ds_read_b128 a[188:191], v52 offset:15360
  v_mul_f32 v5, v5, v40
  v_mul_f32 v6, v6, v40
  v_cvt_pk_bf16_f32 v204, v32, v33
  v_mul_f32 v7, v7, v40
  v_mul_f32 v8, v8, v40
  v_exp_f32 v34, v154
  s_nop 0
  ds_read_b128 a[192:195], v52 offset:16384
  v_mul_f32 v9, v9, v40
  v_mul_f32 v10, v10, v40
  v_mul_f32 v11, v11, v40
  v_add_f32 v36, v37, v56
  v_cvt_pk_bf16_f32 v104, v4, v5
  v_cvt_pk_bf16_f32 v105, v6, v7
  v_exp_f32 v35, v155
  s_nop 0
  s_waitcnt lgkmcnt(5)
  ds_read_b128 a[196:199], v52 offset:17408
  v_cvt_pk_bf16_f32 v106, v8, v9
  v_cvt_pk_bf16_f32 v107, v10, v11
  v_cvt_pk_bf16_f32 v205, v34, v35
  v_mfma_f32_16x16x32_bf16 a[0:3], a[160:163], v[192:195], a[0:3]
  buffer_store_dwordx4 v[104:107], v2, s[20:23], s38 offen offset:2048 sc1
  v_accvgpr_read_b32 v12, a88
  v_accvgpr_read_b32 v13, a89
  v_exp_f32 v32, v156
  v_mfma_f32_16x16x32_bf16 a[32:35], a[160:163], v[196:199], a[32:35]
  ds_read_b128 a[200:203], v52 offset:18432
  buffer_load_dword v27, v24, s[24:27], s72 offen
  v_accvgpr_read_b32 v14, a90
  v_accvgpr_read_b32 v15, a91
  v_mfma_f32_16x16x32_bf16 a[36:39], a[164:167], v[196:199], a[36:39]
  v_accvgpr_read_b32 v16, a92
  v_accvgpr_read_b32 v17, a93
  v_exp_f32 v33, v157
  v_mfma_f32_16x16x32_bf16 a[4:7], a[164:167], v[192:195], a[4:7]
  ds_read_b128 a[204:207], v52 offset:19456
  v_accvgpr_read_b32 v18, a94
  v_accvgpr_read_b32 v19, a95
  v_mul_f32 v12, v12, v40
  v_cvt_pk_bf16_f32 v206, v32, v33
  v_mfma_f32_16x16x32_bf16 a[8:11], a[168:171], v[192:195], a[8:11]
  v_mul_f32 v13, v13, v40
  v_mul_f32 v14, v14, v40
  v_exp_f32 v34, v158
  v_mfma_f32_16x16x32_bf16 a[40:43], a[168:171], v[196:199], a[40:43]
  ds_read_b128 a[208:211], v52 offset:20480
  v_mul_f32 v15, v15, v40
  v_mul_f32 v16, v16, v40
  v_mul_f32 v17, v17, v40
  v_mfma_f32_16x16x32_bf16 a[44:47], a[172:175], v[196:199], a[44:47]
  v_mul_f32 v18, v18, v40
  v_mul_f32 v19, v19, v40
  v_cvt_pk_bf16_f32 v108, v12, v13
  v_exp_f32 v35, v159
  v_mfma_f32_16x16x32_bf16 a[12:15], a[172:175], v[192:195], a[12:15]
  s_waitcnt lgkmcnt(5)
  v_cvt_pk_bf16_f32 v109, v14, v15
  v_cvt_pk_bf16_f32 v110, v16, v17
  v_cvt_pk_bf16_f32 v111, v18, v19
  v_cvt_pk_bf16_f32 v207, v34, v35
  v_mfma_f32_16x16x32_bf16 a[16:19], a[176:179], v[192:195], a[16:19]
  ds_read_b128 a[212:215], v52 offset:21504
  buffer_store_dwordx4 v[108:111], v2, s[20:23], s38 offen offset:3072 sc1
  v_accvgpr_read_b32 v4, a96
  v_accvgpr_read_b32 v5, a97
  v_mfma_f32_16x16x32_bf16 v[60:63], a[224:227], v[204:207], 0
  v_accvgpr_read_b32 v6, a98
  v_accvgpr_read_b32 v7, a99
  v_accvgpr_read_b32 v8, a100
  v_accvgpr_read_b32 v9, a101
  v_accvgpr_read_b32 v10, a102
  v_mfma_f32_16x16x32_bf16 a[48:51], a[176:179], v[196:199], a[48:51]
  ds_read_b128 a[216:219], v52 offset:22528
  v_accvgpr_read_b32 v11, a103
  v_mul_f32 v4, v4, v42
  v_mul_f32 v5, v5, v42
  v_mfma_f32_16x16x32_bf16 a[52:55], a[180:183], v[196:199], a[52:55]
  v_mul_f32 v6, v6, v42
  v_mul_f32 v7, v7, v42
  v_add_f32 v38, v39, v60
  v_max_f32 v48, v36, v38
  v_mfma_f32_16x16x32_bf16 a[20:23], a[180:183], v[192:195], a[20:23]
  ds_read_b128 a[220:223], v52 offset:23552
  v_mul_f32 v8, v8, v42
  v_mul_f32 v9, v9, v42
  v_mul_f32 v10, v10, v42
  v_mul_f32 v11, v11, v42
  v_mfma_f32_16x16x32_bf16 a[24:27], a[184:187], v[192:195], a[24:27]
  v_cvt_pk_bf16_f32 v112, v4, v5
  v_cvt_pk_bf16_f32 v113, v6, v7
  v_cvt_pk_bf16_f32 v114, v8, v9
  v_cmp_lt_f32 vcc, v49, v48
  v_mfma_f32_16x16x32_bf16 a[56:59], a[184:187], v[196:199], a[56:59]
  s_waitcnt lgkmcnt(4)
  v_cvt_pk_bf16_f32 v115, v10, v11
  buffer_store_dwordx4 v[112:115], v2, s[20:23], s39 offen offset:0 sc1
  v_accvgpr_read_b32 v12, a104
  v_accvgpr_read_b32 v13, a105
  v_mfma_f32_16x16x32_bf16 a[60:63], a[188:191], v[196:199], a[60:63]
  s_cmp_lg_u64 vcc, 0
  v_accvgpr_read_b32 v14, a106
  v_accvgpr_read_b32 v15, a107
  v_accvgpr_read_b32 v16, a108
  v_accvgpr_read_b32 v17, a109
  v_accvgpr_read_b32 v18, a110
  v_mfma_f32_16x16x32_bf16 a[28:31], a[188:191], v[192:195], a[28:31]
  s_cbranch_scc1 Lrare98
Lrr99:
  v_accvgpr_read_b32 v19, a111
  v_mul_f32 v12, v12, v42
  v_mul_f32 v13, v13, v42
  v_mfma_f32_16x16x32_bf16 a[0:3], a[192:195], v[200:203], a[0:3]
  v_mul_f32 v14, v14, v42
  v_mul_f32 v15, v15, v42
  v_mul_f32 v16, v16, v42
  v_mul_f32 v17, v17, v42
  v_mfma_f32_16x16x32_bf16 a[32:35], a[192:195], v[204:207], a[32:35]
  v_mul_f32 v18, v18, v42
  v_mul_f32 v19, v19, v42
  v_cvt_pk_bf16_f32 v116, v12, v13
  v_cvt_pk_bf16_f32 v117, v14, v15
  v_cvt_pk_bf16_f32 v118, v16, v17
  v_mfma_f32_16x16x32_bf16 a[36:39], a[196:199], v[204:207], a[36:39]
  v_cvt_pk_bf16_f32 v119, v18, v19
  buffer_store_dwordx4 v[116:119], v2, s[20:23], s39 offen offset:1024 sc1
  v_accvgpr_read_b32 v4, a112
  v_accvgpr_read_b32 v5, a113
  v_mfma_f32_16x16x32_bf16 a[4:7], a[196:199], v[200:203], a[4:7]
  s_waitcnt vmcnt(24) lgkmcnt(0)
  s_barrier
  v_add_u32 v51, s53, v2
  v_xor_b32 v52, 32768, v52
  v_accvgpr_read_b32 v6, a114
  v_accvgpr_read_b32 v7, a115
  v_mfma_f32_16x16x32_bf16 a[8:11], a[200:203], v[200:203], a[8:11]
  s_mov_b32 s4, s52
  ds_read_b128 a[128:131], v51 offset:0
  ds_read_b128 a[132:135], v51 offset:1024
  v_accvgpr_read_b32 v8, a116
  v_accvgpr_read_b32 v9, a117
  v_accvgpr_read_b32 v10, a118
  v_mfma_f32_16x16x32_bf16 a[40:43], a[200:203], v[204:207], a[40:43]
  s_mov_b32 s52, s53
  ds_read_b128 a[136:139], v51 offset:2048
  ds_read_b128 a[140:143], v51 offset:3072
  v_accvgpr_read_b32 v11, a119
  v_mul_f32 v4, v4, v42
  v_mfma_f32_16x16x32_bf16 a[44:47], a[204:207], v[204:207], a[44:47]
  s_mov_b32 s53, s54
  ds_read_b128 a[144:147], v51 offset:4096
  ds_read_b128 a[148:151], v51 offset:5120
  v_mul_f32 v5, v5, v42
  v_mul_f32 v6, v6, v42
  v_mfma_f32_16x16x32_bf16 a[12:15], a[204:207], v[200:203], a[12:15]
  ds_read_b128 a[152:155], v51 offset:6144
  ds_read_b128 a[156:159], v51 offset:7168
  v_mul_f32 v7, v7, v42
  v_mul_f32 v8, v8, v42
  v_mul_f32 v9, v9, v42
  v_mfma_f32_16x16x32_bf16 a[16:19], a[208:211], v[200:203], a[16:19]
  s_mov_b32 s54, s4
  v_mul_f32 v10, v10, v42
  v_mul_f32 v11, v11, v42
  v_cvt_pk_bf16_f32 v120, v4, v5
  v_cvt_pk_bf16_f32 v121, v6, v7
  v_mfma_f32_16x16x32_bf16 a[48:51], a[208:211], v[204:207], a[48:51]
  s_add_u32 s49, s49, 1
  v_cvt_pk_bf16_f32 v122, v8, v9
  v_cvt_pk_bf16_f32 v123, v10, v11
  v_exp_f32 v32, v168
  s_nop 0
  buffer_store_dwordx4 v[120:123], v2, s[20:23], s39 offen offset:2048 sc1
  v_accvgpr_read_b32 v12, a120
  v_accvgpr_read_b32 v13, a121
  v_accvgpr_read_b32 v14, a122
  v_accvgpr_read_b32 v15, a123
  v_mfma_f32_16x16x32_bf16 a[52:55], a[212:215], v[204:207], a[52:55]
  v_accvgpr_read_b32 v16, a124
  v_accvgpr_read_b32 v17, a125
  v_exp_f32 v33, v169
  v_mfma_f32_16x16x32_bf16 a[20:23], a[212:215], v[200:203], a[20:23]
  v_accvgpr_read_b32 v18, a126
  v_accvgpr_read_b32 v19, a127
  v_mul_f32 v12, v12, v42
  v_cvt_pk_bf16_f32 v252, v32, v33
  v_mfma_f32_16x16x32_bf16 a[24:27], a[216:219], v[200:203], a[24:27]
  v_mul_f32 v13, v13, v42
  v_mul_f32 v14, v14, v42
  v_mul_f32 v15, v15, v42
  v_exp_f32 v34, v170
  v_mfma_f32_16x16x32_bf16 a[56:59], a[216:219], v[204:207], a[56:59]
  v_mul_f32 v16, v16, v42
  v_mul_f32 v17, v17, v42
  v_mul_f32 v18, v18, v42
  v_mov_b32 v37, v36
  v_mfma_f32_16x16x32_bf16 a[60:63], a[220:223], v[204:207], a[60:63]
  v_mul_f32 v19, v19, v42
  v_cvt_pk_bf16_f32 v124, v12, v13
  v_exp_f32 v35, v171
  v_mfma_f32_16x16x32_bf16 a[28:31], a[220:223], v[200:203], a[28:31]
  v_cvt_pk_bf16_f32 v125, v14, v15
  v_cvt_pk_bf16_f32 v126, v16, v17
  v_cvt_pk_bf16_f32 v127, v18, v19
  buffer_store_dwordx4 v[124:127], v2, s[20:23], s39 offen offset:3072 sc1
  v_cvt_pk_bf16_f32 v253, v34, v35
  s_branch Ldrain
Lp2y:
  s_cmp_eq_u32 s49, s50
  s_cselect_b32 s51, s40, 64
  s_cbranch_scc0 Ldrain
  s_cmp_eq_u32 s42, 6
  s_cbranch_scc0 Lps121
  s_lshl_b32 s3, s42, 5
  s_add_u32 s3, s3, s41
  s_cmp_lg_u32 s40, 0
  s_cbranch_scc1 Lpub122
  s_lshr_b32 s4, s3, 2
  s_lshl_b32 s4, s4, 5
  s_and_b32 s5, s3, 3
  s_add_u32 s4, s4, s5
  s_lshl_b32 s4, s4, 2
  s_add_u32 s4, s4, 65060864
  v_mov_b32 v24, 1
  s_mov_b64 exec, 1
  buffer_store_dword v24, off, s[20:23], s4 sc1
  s_mov_b64 exec, -1
Lpub122:
Lps121:
  s_cmp_gt_u32 s51, 0
  s_cselect_b64 s[0:1], -1, 0
  s_cmp_eq_u32 s51, 0
  s_cselect_b64 s[66:67], s[56:57], s[0:1]
  s_cselect_b64 s[68:69], s[58:59], s[0:1]
  s_cselect_b64 s[34:35], s[60:61], s[0:1]
  s_cselect_b64 s[36:37], s[62:63], s[0:1]
  v_cndmask_b32 v208, v50, v44, s[66:67]
  v_cndmask_b32 v209, v50, v44, s[68:69]
  v_cndmask_b32 v210, v50, v44, s[34:35]
  v_cndmask_b32 v211, v50, v44, s[36:37]
  s_cmp_gt_u32 s51, 1
  s_cselect_b64 s[0:1], -1, 0
  s_cmp_eq_u32 s51, 1
  s_cselect_b64 s[66:67], s[56:57], s[0:1]
  s_cselect_b64 s[68:69], s[58:59], s[0:1]
  s_cselect_b64 s[34:35], s[60:61], s[0:1]
  s_cselect_b64 s[36:37], s[62:63], s[0:1]
  v_cndmask_b32 v212, v50, v44, s[66:67]
  v_cndmask_b32 v213, v50, v44, s[68:69]
  v_cndmask_b32 v214, v50, v44, s[34:35]
  v_cndmask_b32 v215, v50, v44, s[36:37]
  s_nop 0
  s_waitcnt lgkmcnt(4)
  v_mfma_f32_16x16x32_bf16 v[128:131], a[128:131], v[64:67], v[208:211]
  s_cmp_gt_u32 s51, 2
  s_cselect_b64 s[0:1], -1, 0
  v_exp_f32 v32, v172
  v_mfma_f32_16x16x32_bf16 v[128:131], a[132:135], v[68:71], v[128:131]
  s_cmp_eq_u32 s51, 2
  s_cselect_b64 s[66:67], s[56:57], s[0:1]
  s_cselect_b64 s[68:69], s[58:59], s[0:1]
  s_cselect_b64 s[34:35], s[60:61], s[0:1]
  s_cselect_b64 s[36:37], s[62:63], s[0:1]
  v_mfma_f32_16x16x32_bf16 v[128:131], a[136:139], v[72:75], v[128:131]
  s_add_u32 m0, s48, 0
  ds_read_b128 a[160:163], v51 offset:8192
  v_exp_f32 v33, v173
  v_mfma_f32_16x16x32_bf16 v[128:131], a[140:143], v[76:79], v[128:131]
  buffer_load_dwordx4 v2, s[12:15], s46 offen offset:0 sc1 lds
  v_cndmask_b32 v224, v50, v44, s[66:67]
  v_cvt_pk_bf16_f32 v254, v32, v33
  v_mfma_f32_16x16x32_bf16 v[136:139], a[140:143], v[92:95], v[216:219]
  v_exp_f32 v34, v174
  v_mfma_f32_16x16x32_bf16 v[136:139], a[136:139], v[88:91], v[136:139]
  v_cndmask_b32 v226, v50, v44, s[34:35]
  v_cndmask_b32 v225, v50, v44, s[68:69]
  v_mfma_f32_16x16x32_bf16 v[136:139], a[132:135], v[84:87], v[136:139]
  v_exp_f32 v35, v175
  v_mfma_f32_16x16x32_bf16 v[136:139], a[128:131], v[80:83], v[136:139]
  s_waitcnt lgkmcnt(1)
  buffer_load_dwordx4 v2, s[12:15], s46 offen offset:1024 sc1 lds
  v_cndmask_b32 v227, v50, v44, s[36:37]
  v_cvt_pk_bf16_f32 v255, v34, v35
  v_mfma_f32_16x16x32_bf16 v[140:143], a[144:147], v[80:83], v[220:223]
  s_cmp_gt_u32 s51, 3
  s_cselect_b64 s[0:1], -1, 0
  ds_read_b128 a[164:167], v51 offset:9216
  ds_read_b128 a[168:171], v51 offset:10240
  ds_read_b128 a[172:175], v51 offset:11264
  v_mfma_f32_16x16x32_bf16 v[60:63], a[224:227], v[252:255], 0
  s_cmp_eq_u32 s51, 3
  s_cselect_b64 s[66:67], s[56:57], s[0:1]
  s_cselect_b64 s[68:69], s[58:59], s[0:1]
  s_cselect_b64 s[34:35], s[60:61], s[0:1]
  s_cselect_b64 s[36:37], s[62:63], s[0:1]
  v_mfma_f32_16x16x32_bf16 v[140:143], a[148:151], v[84:87], v[140:143]
  v_cndmask_b32 v230, v50, v44, s[34:35]
  v_exp_f32 v32, v176
  v_mfma_f32_16x16x32_bf16 v[140:143], a[152:155], v[88:91], v[140:143]
  v_cndmask_b32 v231, v50, v44, s[36:37]
  v_add_f32 v39, v38, v60
  v_max_f32 v48, v37, v39
  v_mfma_f32_16x16x32_bf16 v[140:143], a[156:159], v[92:95], v[140:143]
  ds_read_b128 a[176:179], v51 offset:12288
  v_exp_f32 v33, v177
  v_mfma_f32_16x16x32_bf16 v[132:135], a[156:159], v[76:79], v[212:215]
  buffer_load_dwordx4 v2, s[12:15], s46 offen offset:2048 sc1 lds
  v_cmp_lt_f32 vcc, v49, v48
  v_cvt_pk_bf16_f32 v200, v32, v33
  v_mfma_f32_16x16x32_bf16 v[132:135], a[152:155], v[72:75], v[132:135]
  s_waitcnt lgkmcnt(1)
  v_exp_f32 v34, v178
  v_mfma_f32_16x16x32_bf16 v[132:135], a[148:151], v[68:71], v[132:135]
  s_cmp_lg_u64 vcc, 0
  v_cndmask_b32 v229, v50, v44, s[68:69]
  v_cndmask_b32 v228, v50, v44, s[66:67]
  v_mfma_f32_16x16x32_bf16 v[132:135], a[144:147], v[64:67], v[132:135]
  s_cbranch_scc1 Lrare123
Lrr124:
  v_exp_f32 v35, v179
  v_mfma_f32_16x16x32_bf16 v[144:147], a[160:163], v[64:67], v[224:227]
  ds_read_b128 a[180:183], v51 offset:13312
  ds_read_b128 a[184:187], v51 offset:14336
  v_cvt_pk_bf16_f32 v201, v34, v35
  v_mfma_f32_16x16x32_bf16 v[144:147], a[164:167], v[68:71], v[144:147]
  ds_read_b128 a[188:191], v51 offset:15360
  v_exp_f32 v32, v180
  v_mfma_f32_16x16x32_bf16 v[144:147], a[168:171], v[72:75], v[144:147]
  ds_read_b128 a[192:195], v52 offset:0
  ds_read_b128 a[196:199], v52 offset:1024
  ds_read_b128 a[200:203], v52 offset:2048
  v_mfma_f32_16x16x32_bf16 v[144:147], a[172:175], v[76:79], v[144:147]
  s_cmp_gt_u32 s51, 0
  s_cselect_b64 s[0:1], -1, 0
  v_exp_f32 v33, v181
  v_mfma_f32_16x16x32_bf16 v[152:155], a[172:175], v[92:95], v[232:235]
  s_cmp_eq_u32 s51, 0
  s_cselect_b64 s[66:67], s[56:57], s[0:1]
  s_cselect_b64 s[68:69], s[58:59], s[0:1]
  s_cselect_b64 s[34:35], s[60:61], s[0:1]
  s_cselect_b64 s[36:37], s[62:63], s[0:1]
  v_cvt_pk_bf16_f32 v202, v32, v33
  v_mfma_f32_16x16x32_bf16 v[152:155], a[168:171], v[88:91], v[152:155]
  ds_read_b128 a[204:207], v52 offset:3072
  v_exp_f32 v34, v182
  v_mfma_f32_16x16x32_bf16 v[152:155], a[164:167], v[84:87], v[152:155]
  buffer_load_dwordx4 v2, s[12:15], s46 offen offset:3072 sc1 lds
  v_cndmask_b32 v217, v50, v45, s[68:69]
  v_cndmask_b32 v216, v50, v45, s[66:67]
  v_mfma_f32_16x16x32_bf16 v[152:155], a[160:163], v[80:83], v[152:155]
  s_waitcnt lgkmcnt(4)
  v_exp_f32 v35, v183
  v_mfma_f32_16x16x32_bf16 v[156:159], a[176:179], v[80:83], v[236:239]
  s_add_u32 m0, s48, 4096
  v_cndmask_b32 v218, v50, v45, s[34:35]
  v_cvt_pk_bf16_f32 v203, v34, v35
  v_mfma_f32_16x16x32_bf16 v[156:159], a[180:183], v[84:87], v[156:159]
  s_add_u32 s46, s46, 4096
  v_exp_f32 v32, v184
  v_mfma_f32_16x16x32_bf16 v[56:59], a[224:227], v[200:203], 0
  ds_read_b128 a[208:211], v52 offset:4096
  buffer_load_dwordx4 v2, s[12:15], s46 offen offset:0 sc1 lds
  v_cndmask_b32 v219, v50, v45, s[36:37]
  v_mfma_f32_16x16x32_bf16 v[156:159], a[184:187], v[88:91], v[156:159]
  v_exp_f32 v33, v185
  v_mfma_f32_16x16x32_bf16 v[156:159], a[188:191], v[92:95], v[156:159]
  ds_read_b128 a[212:215], v52 offset:5120
  v_cvt_pk_bf16_f32 v204, v32, v33
  v_mfma_f32_16x16x32_bf16 v[148:151], a[188:191], v[76:79], v[228:231]
  buffer_load_dwordx4 v2, s[12:15], s46 offen offset:1024 sc1 lds
  v_exp_f32 v34, v186
  v_mfma_f32_16x16x32_bf16 v[148:151], a[184:187], v[72:75], v[148:151]
  s_waitcnt lgkmcnt(2)
  ds_read_b128 a[216:219], v52 offset:6144
  ds_read_b128 a[220:223], v52 offset:7168
  v_add_f32 v36, v37, v56
  v_mfma_f32_16x16x32_bf16 v[148:151], a[180:183], v[68:71], v[148:151]
  s_cmp_gt_u32 s51, 1
  s_cselect_b64 s[0:1], -1, 0
  v_exp_f32 v35, v187
  v_mfma_f32_16x16x32_bf16 v[148:151], a[176:179], v[64:67], v[148:151]
  s_cmp_eq_u32 s51, 1
  s_cselect_b64 s[66:67], s[56:57], s[0:1]
  s_cselect_b64 s[68:69], s[58:59], s[0:1]
  s_cselect_b64 s[34:35], s[60:61], s[0:1]
  s_cselect_b64 s[36:37], s[62:63], s[0:1]
  v_cvt_pk_bf16_f32 v205, v34, v35
  v_mfma_f32_16x16x32_bf16 a[0:3], a[192:195], v[248:251], a[0:3]
  ds_read_b128 a[160:163], v52 offset:8192
  v_exp_f32 v32, v188
  v_mfma_f32_16x16x32_bf16 a[32:35], a[192:195], v[252:255], a[32:35]
  v_cndmask_b32 v221, v50, v45, s[68:69]
  v_cndmask_b32 v220, v50, v45, s[66:67]
  v_mfma_f32_16x16x32_bf16 a[36:39], a[196:199], v[252:255], a[36:39]
  buffer_load_dwordx4 v2, s[12:15], s46 offen offset:2048 sc1 lds
  v_exp_f32 v33, v189
  v_mfma_f32_16x16x32_bf16 a[4:7], a[196:199], v[248:251], a[4:7]
  v_cndmask_b32 v222, v50, v45, s[34:35]
  v_cvt_pk_bf16_f32 v206, v32, v33
  v_mfma_f32_16x16x32_bf16 a[8:11], a[200:203], v[248:251], a[8:11]
  v_exp_f32 v34, v190
  v_mfma_f32_16x16x32_bf16 a[40:43], a[200:203], v[252:255], a[40:43]
  ds_read_b128 a[164:167], v52 offset:9216
  v_cndmask_b32 v223, v50, v45, s[36:37]
  v_mfma_f32_16x16x32_bf16 a[44:47], a[204:207], v[252:255], a[44:47]
  v_exp_f32 v35, v191
  v_mfma_f32_16x16x32_bf16 a[12:15], a[204:207], v[248:251], a[12:15]
  s_waitcnt lgkmcnt(2)
  ds_read_b128 a[168:171], v52 offset:10240
  v_cvt_pk_bf16_f32 v207, v34, v35
  v_mfma_f32_16x16x32_bf16 a[16:19], a[208:211], v[248:251], a[16:19]
  ds_read_b128 a[172:175], v52 offset:11264
  ds_read_b128 a[176:179], v52 offset:12288
  v_mfma_f32_16x16x32_bf16 v[60:63], a[224:227], v[204:207], 0
  ds_read_b128 a[180:183], v52 offset:13312
  buffer_load_dwordx4 v2, s[12:15], s46 offen offset:3072 sc1 lds
  v_mfma_f32_16x16x32_bf16 a[48:51], a[208:211], v[252:255], a[48:51]
  s_add_u32 s46, s46, 28672
  ds_read_b128 a[184:187], v52 offset:14336
  v_exp_f32 v32, v128
  v_mfma_f32_16x16x32_bf16 a[52:55], a[212:215], v[252:255], a[52:55]
  s_xor_b32 s48, s48, 32768
  v_add_f32 v38, v39, v60
  v_max_f32 v48, v36, v38
  v_mfma_f32_16x16x32_bf16 a[20:23], a[212:215], v[248:251], a[20:23]
  s_cmp_gt_u32 s51, 2
  s_cselect_b64 s[0:1], -1, 0
  v_exp_f32 v33, v129
  v_mfma_f32_16x16x32_bf16 a[24:27], a[216:219], v[248:251], a[24:27]
  s_cmp_eq_u32 s51, 2
  s_cselect_b64 s[66:67], s[56:57], s[0:1]
  s_cselect_b64 s[68:69], s[58:59], s[0:1]
  s_cselect_b64 s[34:35], s[60:61], s[0:1]
  s_cselect_b64 s[36:37], s[62:63], s[0:1]
  v_cmp_lt_f32 vcc, v49, v48
  v_cvt_pk_bf16_f32 v192, v32, v33
  v_mfma_f32_16x16x32_bf16 a[56:59], a[216:219], v[252:255], a[56:59]
  s_waitcnt lgkmcnt(3)
  ds_read_b128 a[188:191], v52 offset:15360
  v_exp_f32 v34, v130
  v_mfma_f32_16x16x32_bf16 a[60:63], a[220:223], v[252:255], a[60:63]
  s_cmp_lg_u64 vcc, 0
  v_cndmask_b32 v233, v50, v45, s[68:69]
  v_cndmask_b32 v232, v50, v45, s[66:67]
  v_mfma_f32_16x16x32_bf16 a[28:31], a[220:223], v[248:251], a[28:31]
  s_cbranch_scc1 Lrare125
Lrr126:
  v_exp_f32 v35, v131
  v_mfma_f32_16x16x32_bf16 a[0:3], a[160:163], v[200:203], a[0:3]
  s_add_u32 m0, s54, s47
  v_cndmask_b32 v234, v50, v45, s[34:35]
  v_cvt_pk_bf16_f32 v193, v34, v35
  v_mfma_f32_16x16x32_bf16 a[32:35], a[160:163], v[204:207], a[32:35]
  buffer_load_dwordx4 v53, s[8:11], s45 offen offset:0 sc1 lds
  v_exp_f32 v32, v132
  v_mfma_f32_16x16x32_bf16 a[36:39], a[164:167], v[204:207], a[36:39]
  ds_read_b128 a[192:195], v51 offset:16384
  buffer_load_dwordx4 v54, s[8:11], s45 offen offset:1024 sc1 lds
  v_cndmask_b32 v235, v50, v45, s[36:37]
  v_mfma_f32_16x16x32_bf16 a[4:7], a[164:167], v[200:203], a[4:7]
  v_exp_f32 v33, v133
  v_mfma_f32_16x16x32_bf16 a[8:11], a[168:171], v[200:203], a[8:11]
  ds_read_b128 a[196:199], v51 offset:17408
  v_cvt_pk_bf16_f32 v194, v32, v33
  v_mfma_f32_16x16x32_bf16 a[40:43], a[168:171], v[204:207], a[40:43]
  v_exp_f32 v34, v134
  v_mfma_f32_16x16x32_bf16 a[44:47], a[172:175], v[204:207], a[44:47]
  ds_read_b128 a[200:203], v51 offset:18432
  ds_read_b128 a[204:207], v51 offset:19456
  v_mfma_f32_16x16x32_bf16 a[12:15], a[172:175], v[200:203], a[12:15]
  s_waitcnt lgkmcnt(4)
  v_exp_f32 v35, v135
  v_mfma_f32_16x16x32_bf16 a[16:19], a[176:179], v[200:203], a[16:19]
  ds_read_b128 a[208:211], v51 offset:20480
  buffer_load_dwordx4 v55, s[8:11], s45 offen offset:2048 sc1 lds
  v_cvt_pk_bf16_f32 v195, v34, v35
  v_mfma_f32_16x16x32_bf16 a[48:51], a[176:179], v[204:207], a[48:51]
  v_exp_f32 v32, v136
  v_mfma_f32_16x16x32_bf16 v[56:59], a[224:227], v[192:195], 0
  ds_read_b128 a[212:215], v51 offset:21504
  ds_read_b128 a[216:219], v51 offset:22528
  v_mfma_f32_16x16x32_bf16 a[52:55], a[180:183], v[204:207], a[52:55]
  v_exp_f32 v33, v137
  v_mfma_f32_16x16x32_bf16 a[20:23], a[180:183], v[200:203], a[20:23]
  ds_read_b128 a[220:223], v51 offset:23552
  v_cvt_pk_bf16_f32 v196, v32, v33
  v_mfma_f32_16x16x32_bf16 a[24:27], a[184:187], v[200:203], a[24:27]
  buffer_load_dwordx4 v30, s[8:11], s45 offen offset:3072 sc1 lds
  v_exp_f32 v34, v138
  v_mfma_f32_16x16x32_bf16 a[56:59], a[184:187], v[204:207], a[56:59]
  s_cmp_gt_u32 s51, 3
  s_cselect_b64 s[0:1], -1, 0
  v_add_f32 v37, v36, v56
  v_mfma_f32_16x16x32_bf16 a[60:63], a[188:191], v[204:207], a[60:63]
  s_cmp_eq_u32 s51, 3
  s_cselect_b64 s[66:67], s[56:57], s[0:1]
  s_cselect_b64 s[68:69], s[58:59], s[0:1]
  s_cselect_b64 s[34:35], s[60:61], s[0:1]
  s_cselect_b64 s[36:37], s[62:63], s[0:1]
  v_exp_f32 v35, v139
  v_mfma_f32_16x16x32_bf16 a[28:31], a[188:191], v[200:203], a[28:31]
  s_add_u32 m0, m0, 4096
  v_cndmask_b32 v236, v50, v45, s[66:67]
  v_cvt_pk_bf16_f32 v197, v34, v35
  s_add_u32 s45, s45, s100
  v_exp_f32 v32, v140
  s_nop 0
  v_cndmask_b32 v238, v50, v45, s[34:35]
  v_cndmask_b32 v237, v50, v45, s[68:69]
  buffer_load_dwordx4 v53, s[8:11], s45 offen offset:0 sc1 lds
  v_exp_f32 v33, v141
  s_nop 0
  s_waitcnt lgkmcnt(4)
  v_cndmask_b32 v239, v50, v45, s[36:37]
  v_cvt_pk_bf16_f32 v198, v32, v33
  v_mfma_f32_16x16x32_bf16 v[168:171], a[192:195], v[80:83], v[216:219]
  v_exp_f32 v34, v142
  v_mfma_f32_16x16x32_bf16 v[168:171], a[196:199], v[84:87], v[168:171]
  ds_read_b128 a[160:163], v51 offset:24576
  ds_read_b128 a[164:167], v51 offset:25600
  v_mfma_f32_16x16x32_bf16 v[168:171], a[200:203], v[88:91], v[168:171]
  v_exp_f32 v35, v143
  v_mfma_f32_16x16x32_bf16 v[168:171], a[204:207], v[92:95], v[168:171]
  s_waitcnt lgkmcnt(2)
  ds_read_b128 a[168:171], v51 offset:26624
  v_cvt_pk_bf16_f32 v199, v34, v35
  v_mfma_f32_16x16x32_bf16 v[172:175], a[208:211], v[80:83], v[220:223]
  ds_read_b128 a[172:175], v51 offset:27648
  ds_read_b128 a[176:179], v51 offset:28672
  buffer_load_dwordx4 v54, s[8:11], s45 offen offset:1024 sc1 lds
  v_mfma_f32_16x16x32_bf16 v[60:63], a[224:227], v[196:199], 0
  ds_read_b128 a[180:183], v51 offset:29696
  ds_read_b128 a[184:187], v51 offset:30720
  v_mfma_f32_16x16x32_bf16 v[172:175], a[212:215], v[84:87], v[172:175]
  v_exp_f32 v32, v144
  v_mfma_f32_16x16x32_bf16 v[172:175], a[216:219], v[88:91], v[172:175]
  v_add_f32 v39, v38, v60
  v_max_f32 v48, v37, v39
  v_mfma_f32_16x16x32_bf16 v[172:175], a[220:223], v[92:95], v[172:175]
  v_exp_f32 v33, v145
  s_nop 0
  v_cmp_lt_f32 vcc, v49, v48
  v_cvt_pk_bf16_f32 v200, v32, v33
  v_exp_f32 v34, v146
  s_nop 0
  s_cmp_lg_u64 vcc, 0
  ds_read_b128 a[188:191], v51 offset:31744
  ds_read_b128 a[192:195], v52 offset:16384
  s_cbranch_scc1 Lrare127
Lrr128:
  v_exp_f32 v35, v147
  s_nop 0
  ds_read_b128 a[196:199], v52 offset:17408
  v_cvt_pk_bf16_f32 v201, v34, v35
  v_exp_f32 v32, v148
  s_nop 0
  ds_read_b128 a[200:203], v52 offset:18432
  buffer_load_dwordx4 v55, s[8:11], s45 offen offset:2048 sc1 lds
  s_waitcnt lgkmcnt(7)
  v_exp_f32 v33, v149
  v_mfma_f32_16x16x32_bf16 v[184:187], a[160:163], v[80:83], v[232:235]
  ds_read_b128 a[204:207], v52 offset:19456
  v_cvt_pk_bf16_f32 v202, v32, v33
  v_mfma_f32_16x16x32_bf16 v[184:187], a[164:167], v[84:87], v[184:187]
  v_exp_f32 v34, v150
  v_mfma_f32_16x16x32_bf16 v[184:187], a[168:171], v[88:91], v[184:187]
  ds_read_b128 a[208:211], v52 offset:20480
  buffer_load_dwordx4 v30, s[8:11], s45 offen offset:3072 sc1 lds
  v_mfma_f32_16x16x32_bf16 v[184:187], a[172:175], v[92:95], v[184:187]
  s_waitcnt lgkmcnt(5)
  v_exp_f32 v35, v151
  v_mfma_f32_16x16x32_bf16 v[188:191], a[176:179], v[80:83], v[236:239]
  s_add_u32 s45, s45, s101
  ds_read_b128 a[212:215], v52 offset:21504
  v_cvt_pk_bf16_f32 v203, v34, v35
  v_mfma_f32_16x16x32_bf16 v[188:191], a[180:183], v[84:87], v[188:191]
  v_exp_f32 v32, v152
  v_mfma_f32_16x16x32_bf16 v[56:59], a[224:227], v[200:203], 0
  ds_read_b128 a[216:219], v52 offset:22528
  v_mfma_f32_16x16x32_bf16 v[188:191], a[184:187], v[88:91], v[188:191]
  v_exp_f32 v33, v153
  v_mfma_f32_16x16x32_bf16 v[188:191], a[188:191], v[92:95], v[188:191]
  ds_read_b128 a[220:223], v52 offset:23552
  v_cvt_pk_bf16_f32 v204, v32, v33
  v_exp_f32 v34, v154
  s_nop 0
  ds_read_b128 a[160:163], v52 offset:24576
  v_add_f32 v36, v37, v56
  v_exp_f32 v35, v155
  s_nop 0
  s_waitcnt lgkmcnt(5)
  ds_read_b128 a[164:167], v52 offset:25600
  v_cvt_pk_bf16_f32 v205, v34, v35
  v_mfma_f32_16x16x32_bf16 a[0:3], a[192:195], v[192:195], a[0:3]
  v_exp_f32 v32, v156
  v_mfma_f32_16x16x32_bf16 a[32:35], a[192:195], v[196:199], a[32:35]
  ds_read_b128 a[168:171], v52 offset:26624
  v_mfma_f32_16x16x32_bf16 a[36:39], a[196:199], v[196:199], a[36:39]
  v_exp_f32 v33, v157
  v_mfma_f32_16x16x32_bf16 a[4:7], a[196:199], v[192:195], a[4:7]
  ds_read_b128 a[172:175], v52 offset:27648
  v_cvt_pk_bf16_f32 v206, v32, v33
  v_mfma_f32_16x16x32_bf16 a[8:11], a[200:203], v[192:195], a[8:11]
  v_exp_f32 v34, v158
  v_mfma_f32_16x16x32_bf16 a[40:43], a[200:203], v[196:199], a[40:43]
  ds_read_b128 a[176:179], v52 offset:28672
  v_mfma_f32_16x16x32_bf16 a[44:47], a[204:207], v[196:199], a[44:47]
  v_exp_f32 v35, v159
  v_mfma_f32_16x16x32_bf16 a[12:15], a[204:207], v[192:195], a[12:15]
  s_waitcnt lgkmcnt(5)
  v_cvt_pk_bf16_f32 v207, v34, v35
  v_mfma_f32_16x16x32_bf16 a[16:19], a[208:211], v[192:195], a[16:19]
  ds_read_b128 a[180:183], v52 offset:29696
  v_mfma_f32_16x16x32_bf16 v[60:63], a[224:227], v[204:207], 0
  v_mfma_f32_16x16x32_bf16 a[48:51], a[208:211], v[196:199], a[48:51]
  ds_read_b128 a[184:187], v52 offset:30720
  v_mfma_f32_16x16x32_bf16 a[52:55], a[212:215], v[196:199], a[52:55]
  v_add_f32 v38, v39, v60
  v_max_f32 v48, v36, v38
  v_mfma_f32_16x16x32_bf16 a[20:23], a[212:215], v[192:195], a[20:23]
  ds_read_b128 a[188:191], v52 offset:31744
  v_mfma_f32_16x16x32_bf16 a[24:27], a[216:219], v[192:195], a[24:27]
  v_cmp_lt_f32 vcc, v49, v48
  v_mfma_f32_16x16x32_bf16 a[56:59], a[216:219], v[196:199], a[56:59]
  s_waitcnt lgkmcnt(4)
  v_mfma_f32_16x16x32_bf16 a[60:63], a[220:223], v[196:199], a[60:63]
  s_cmp_lg_u64 vcc, 0
  v_mfma_f32_16x16x32_bf16 a[28:31], a[220:223], v[192:195], a[28:31]
  s_cbranch_scc1 Lrare129
Lrr130:
  v_mfma_f32_16x16x32_bf16 a[0:3], a[160:163], v[200:203], a[0:3]
  v_mfma_f32_16x16x32_bf16 a[32:35], a[160:163], v[204:207], a[32:35]
  v_mfma_f32_16x16x32_bf16 a[36:39], a[164:167], v[204:207], a[36:39]
  v_mfma_f32_16x16x32_bf16 a[4:7], a[164:167], v[200:203], a[4:7]
  s_waitcnt vmcnt(8) lgkmcnt(0)
  s_barrier
  v_add_u32 v51, s53, v2
  v_xor_b32 v52, 32768, v52
  v_mfma_f32_16x16x32_bf16 a[8:11], a[168:171], v[200:203], a[8:11]
  s_mov_b32 s4, s52
  ds_read_b128 a[128:131], v51 offset:0
  ds_read_b128 a[132:135], v51 offset:1024
  v_mfma_f32_16x16x32_bf16 a[40:43], a[168:171], v[204:207], a[40:43]
  s_mov_b32 s52, s53
  ds_read_b128 a[136:139], v51 offset:2048
  ds_read_b128 a[140:143], v51 offset:3072
  v_mfma_f32_16x16x32_bf16 a[44:47], a[172:175], v[204:207], a[44:47]
  s_mov_b32 s53, s54
  ds_read_b128 a[144:147], v51 offset:4096
  ds_read_b128 a[148:151], v51 offset:5120
  v_mfma_f32_16x16x32_bf16 a[12:15], a[172:175], v[200:203], a[12:15]
  ds_read_b128 a[152:155], v51 offset:6144
  ds_read_b128 a[156:159], v51 offset:7168
  v_mfma_f32_16x16x32_bf16 a[16:19], a[176:179], v[200:203], a[16:19]
  s_mov_b32 s54, s4
  v_mfma_f32_16x16x32_bf16 a[48:51], a[176:179], v[204:207], a[48:51]
  s_add_u32 s49, s49, 1
  v_exp_f32 v32, v168
  s_nop 0
  v_mfma_f32_16x16x32_bf16 a[52:55], a[180:183], v[204:207], a[52:55]
  v_exp_f32 v33, v169
  v_mfma_f32_16x16x32_bf16 a[20:23], a[180:183], v[200:203], a[20:23]
  v_cvt_pk_bf16_f32 v252, v32, v33
  v_mfma_f32_16x16x32_bf16 a[24:27], a[184:187], v[200:203], a[24:27]
  v_exp_f32 v34, v170
  v_mfma_f32_16x16x32_bf16 a[56:59], a[184:187], v[204:207], a[56:59]
  v_mov_b32 v37, v36
  v_mfma_f32_16x16x32_bf16 a[60:63], a[188:191], v[204:207], a[60:63]
  v_exp_f32 v35, v171
  v_mfma_f32_16x16x32_bf16 a[28:31], a[188:191], v[200:203], a[28:31]
  v_cvt_pk_bf16_f32 v253, v34, v35
  s_nop 0
Ldrain:
  ds_read_b128 a[160:163], v52 offset:0
  ds_read_b128 a[164:167], v52 offset:1024
  ds_read_b128 a[168:171], v52 offset:2048
  ds_read_b128 a[172:175], v52 offset:3072
  ds_read_b128 a[176:179], v52 offset:4096
  ds_read_b128 a[180:183], v52 offset:5120
  ds_read_b128 a[184:187], v52 offset:6144
  ds_read_b128 a[188:191], v52 offset:7168
  ds_read_b128 a[192:195], v52 offset:8192
  ds_read_b128 a[196:199], v52 offset:9216
  ds_read_b128 a[200:203], v52 offset:10240
  ds_read_b128 a[204:207], v52 offset:11264
  ds_read_b128 a[208:211], v52 offset:12288
  ds_read_b128 a[212:215], v52 offset:13312
  ds_read_b128 a[216:219], v52 offset:14336
  ds_read_b128 a[220:223], v52 offset:15360
  v_lshrrev_b32 v21, 4, v1
  v_lshrrev_b32 v22, 2, v1
  v_and_b32 v23, 1, v1
  v_lshlrev_b32 v23, 4, v23
  v_lshl_add_u32 v23, v22, 8, v23
  v_and_b32 v22, 7, v22
  s_lshl_b32 s4, s40, 1
  v_xor_b32 v22, s4, v22
  v_bfe_u32 v24, v1, 1, 1
  v_xor_b32 v22, v22, v24
  v_lshl_add_u32 v25, v22, 5, v23
  v_exp_f32 v32, v172
  v_exp_f32 v33, v173
  v_exp_f32 v34, v174
  v_cvt_pk_bf16_f32 v254, v32, v33
  v_exp_f32 v35, v175
  s_nop 0
  v_cvt_pk_bf16_f32 v255, v34, v35
  s_add_u32 m0, s47, s54
  s_add_u32 s50, s45, 0
  buffer_load_dwordx4 v53, s[8:11], s50 offen offset:0 lds
  s_sub_u32 s32, 15, s42
  s_lshl_b32 s32, s32, 3
  v_mfma_f32_16x16x32_bf16 v[60:63], a[224:227], v[252:255], 0
  s_add_u32 s32, s32, s40
  s_lshl_b32 s32, s32, 17
  s_lshl_b32 s33, s41, 12
  s_add_u32 s32, s32, s33
  s_add_u32 s32, s32, 33554432
  s_add_u32 s33, s32, 524288
  s_lshr_b32 s72, s43, 2
  s_sub_u32 s73, 15, s42
  s_cmp_eq_u32 s72, 0
  s_cselect_b32 s36, s42, s73
  buffer_load_dwordx4 v54, s[8:11], s50 offen offset:1024 lds
  v_add_f32 v39, v38, v60
  v_max_f32 v48, v37, v39
  v_cmp_lt_f32 vcc, v49, v48
  v_mov_b32 v36, v37
  s_lshl_b32 s72, s72, 2
  s_lshl_b32 s73, s73, 3
  s_add_u32 s67, s73, s72
  s_cmp_lg_u64 vcc, 0
  s_cbranch_scc1 Lrare132
Lrr133:
  s_waitcnt lgkmcnt(15)
  v_mfma_f32_16x16x32_bf16 a[32:35], a[160:163], v[252:255], a[32:35]
  v_exp_f32 v32, v184
  s_lshl_b32 s73, s42, 3
  buffer_load_dwordx4 v55, s[8:11], s50 offen offset:2048 lds
  s_waitcnt lgkmcnt(14)
  v_mfma_f32_16x16x32_bf16 a[36:39], a[164:167], v[252:255], a[36:39]
  v_exp_f32 v33, v185
  s_add_u32 s66, s73, s72
  buffer_load_dwordx4 v30, s[8:11], s50 offen offset:3072 lds
  s_waitcnt lgkmcnt(13)
  v_mfma_f32_16x16x32_bf16 a[40:43], a[168:171], v[252:255], a[40:43]
  v_cvt_pk_bf16_f32 v204, v32, v33
  v_exp_f32 v34, v186
  s_bfe_u32 s72, s43, 0x10001
  s_add_u32 m0, s47, s54
  s_add_u32 m0, m0, 4096
  s_add_u32 s50, s45, 65536
  buffer_load_dwordx4 v53, s[8:11], s50 offen offset:0 lds
  s_waitcnt lgkmcnt(12)
  v_mfma_f32_16x16x32_bf16 a[44:47], a[172:175], v[252:255], a[44:47]
  v_exp_f32 v35, v187
  s_lshl_b32 s34, s36, 1
  buffer_load_dwordx4 v54, s[8:11], s50 offen offset:1024 lds
  s_waitcnt lgkmcnt(11)
  v_mfma_f32_16x16x32_bf16 a[48:51], a[176:179], v[252:255], a[48:51]
  v_cvt_pk_bf16_f32 v205, v34, v35
  v_exp_f32 v32, v188
  s_add_u32 s34, s34, s72
  buffer_load_dwordx4 v55, s[8:11], s50 offen offset:2048 lds
  s_waitcnt lgkmcnt(10)
  v_mfma_f32_16x16x32_bf16 a[52:55], a[180:183], v[252:255], a[52:55]
  v_exp_f32 v33, v189
  s_and_b32 s72, s43, 1
  buffer_load_dwordx4 v30, s[8:11], s50 offen offset:3072 lds
  s_waitcnt lgkmcnt(9)
  v_mfma_f32_16x16x32_bf16 a[56:59], a[184:187], v[252:255], a[56:59]
  v_cvt_pk_bf16_f32 v206, v32, v33
  v_exp_f32 v34, v190
  s_lshl_b32 s35, s44, 1
  s_waitcnt lgkmcnt(8)
  v_mfma_f32_16x16x32_bf16 a[60:63], a[188:191], v[252:255], a[60:63]
  v_exp_f32 v35, v191
  s_add_u32 s35, s35, s72
  s_waitcnt vmcnt(8) lgkmcnt(0)
  s_barrier
  s_cmp_eq_u32 s42, 7
  s_cbranch_scc0 Lps134
  s_lshl_b32 s3, s42, 5
  s_add_u32 s3, s3, s41
  s_cmp_lg_u32 s40, 0
  s_cbranch_scc1 Lpub135
  s_lshr_b32 s4, s3, 2
  s_lshl_b32 s4, s4, 5
  s_and_b32 s5, s3, 3
  s_add_u32 s4, s4, s5
  s_lshl_b32 s4, s4, 2
  s_add_u32 s4, s4, 65060864
  v_mov_b32 v24, 1
  s_mov_b64 exec, 1
  buffer_store_dword v24, off, s[20:23], s4 sc1
  s_mov_b64 exec, -1
Lpub135:
Lps134:
  v_add_u32 v3, s52, v25
  ds_read_b64_tr_b16 a[64:65], v3 offset:0
  ds_read_b64_tr_b16 a[66:67], v3 offset:8192
  ds_read_b64_tr_b16 a[68:69], v3 offset:8
  s_add_u32 m0, s47, 65536
  s_add_u32 s50, s45, 131072
  buffer_load_dwordx4 v53, s[8:11], s50 offen offset:0 lds
  v_cvt_pk_bf16_f32 v207, v34, v35
  s_and_b32 s77, s43, 3
  s_lshl_b32 s37, s77, 2
  v_mfma_f32_16x16x32_bf16 v[60:63], a[224:227], v[204:207], 0
  s_add_u32 s37, s37, s44
  s_lshl_b32 s49, s44, 1
  s_lshl_b32 s69, s40, 12
  s_lshl_b32 s72, s77, 15
  s_add_u32 s72, s72, s69
  s_add_u32 s72, s72, 33554432
  s_add_u32 s73, s66, s77
  s_lshl_b32 s73, s73, 17
  s_add_u32 s16, s73, s72
  v_add_f32 v38, v39, v60
  v_max_f32 v48, v36, v38
  v_cmp_lt_f32 vcc, v49, v48
  s_add_u32 s73, s67, s77
  s_lshl_b32 s73, s73, 17
  s_add_u32 s17, s73, s72
  v_mov_b32 v4, v2
  s_cmp_lg_u64 vcc, 0
  s_cbranch_scc1 Lrare137
Lrr138:
  v_mfma_f32_16x16x32_bf16 a[32:35], a[192:195], v[204:207], a[32:35]
  s_lshl_b32 s55, s42, 10
  s_add_u32 s55, s55, 65060864
  ds_read_b64_tr_b16 a[70:71], v3 offset:8200
  ds_read_b64_tr_b16 a[72:73], v3 offset:16384
  ds_read_b64_tr_b16 a[74:75], v3 offset:24576
  buffer_load_dwordx4 v54, s[8:11], s50 offen offset:1024 lds
  v_mfma_f32_16x16x32_bf16 a[36:39], a[196:199], v[204:207], a[36:39]
  v_and_b32 v29, 3, v1
  v_lshlrev_b32 v29, 2, v29
  ds_read_b64_tr_b16 a[76:77], v3 offset:16392
  ds_read_b64_tr_b16 a[78:79], v3 offset:24584
  ds_read_b64_tr_b16 a[80:81], v3 offset:4096
  buffer_load_dwordx4 v55, s[8:11], s50 offen offset:2048 lds
  v_mfma_f32_16x16x32_bf16 a[40:43], a[200:203], v[204:207], a[40:43]
  v_bfe_u32 v28, v1, 2, 3
  v_lshl_add_u32 v29, v28, 7, v29
  ds_read_b64_tr_b16 a[82:83], v3 offset:12288
  ds_read_b64_tr_b16 a[84:85], v3 offset:4104
  ds_read_b64_tr_b16 a[86:87], v3 offset:12296
  buffer_load_dwordx4 v30, s[8:11], s50 offen offset:3072 lds
  v_mfma_f32_16x16x32_bf16 a[44:47], a[204:207], v[204:207], a[44:47]
  s_nop 0
  s_nop 0
  ds_read_b64_tr_b16 a[88:89], v3 offset:20480
  ds_read_b64_tr_b16 a[90:91], v3 offset:28672
  ds_read_b64_tr_b16 a[92:93], v3 offset:20488
  s_add_u32 m0, s47, 65536
  s_add_u32 m0, m0, 4096
  s_add_u32 s50, s45, 196608
  buffer_load_dwordx4 v53, s[8:11], s50 offen offset:0 lds
  v_mfma_f32_16x16x32_bf16 a[48:51], a[208:211], v[204:207], a[48:51]
  s_nop 0
  s_nop 0
  ds_read_b64_tr_b16 a[94:95], v3 offset:28680
  v_add_u32 v3, s53, v25
  ds_read_b64_tr_b16 a[96:97], v3 offset:0
  ds_read_b64_tr_b16 a[98:99], v3 offset:8192
  buffer_load_dwordx4 v54, s[8:11], s50 offen offset:1024 lds
  v_mfma_f32_16x16x32_bf16 a[52:55], a[212:215], v[204:207], a[52:55]
  s_nop 0
  s_nop 0
  ds_read_b64_tr_b16 a[100:101], v3 offset:8
  ds_read_b64_tr_b16 a[102:103], v3 offset:8200
  ds_read_b64_tr_b16 a[104:105], v3 offset:16384
  buffer_load_dwordx4 v55, s[8:11], s50 offen offset:2048 lds
  v_mfma_f32_16x16x32_bf16 a[56:59], a[216:219], v[204:207], a[56:59]
  s_nop 0
  s_nop 0
  ds_read_b64_tr_b16 a[106:107], v3 offset:24576
  ds_read_b64_tr_b16 a[108:109], v3 offset:16392
  ds_read_b64_tr_b16 a[110:111], v3 offset:24584
  buffer_load_dwordx4 v30, s[8:11], s50 offen offset:3072 lds
  v_mfma_f32_16x16x32_bf16 a[60:63], a[220:223], v[204:207], a[60:63]
  s_nop 0
  s_nop 0
  ds_read_b64_tr_b16 a[112:113], v3 offset:4096
  ds_read_b64_tr_b16 a[114:115], v3 offset:12288
  ds_read_b64_tr_b16 a[116:117], v3 offset:4104
  v_rcp_f32 v36, v36
  ds_read_b64_tr_b16 a[118:119], v3 offset:12296
  ds_read_b64_tr_b16 a[120:121], v3 offset:20480
  ds_read_b64_tr_b16 a[122:123], v3 offset:28672
  v_accvgpr_read_b32 v128, a0
  v_accvgpr_read_b32 v129, a1
  v_accvgpr_read_b32 v130, a2
  v_accvgpr_read_b32 v131, a3
  ds_read_b64_tr_b16 a[124:125], v3 offset:20488
  ds_read_b64_tr_b16 a[126:127], v3 offset:28680
  v_accvgpr_read_b32 v132, a4
  v_accvgpr_read_b32 v133, a5
  v_accvgpr_read_b32 v134, a6
  v_accvgpr_read_b32 v135, a7
  v_pk_mul_f32 v[128:129], v[128:129], v[36:37] op_sel_hi:[1,0]
  v_pk_mul_f32 v[130:131], v[130:131], v[36:37] op_sel_hi:[1,0]
  v_pk_mul_f32 v[132:133], v[132:133], v[36:37] op_sel_hi:[1,0]
  v_pk_mul_f32 v[134:135], v[134:135], v[36:37] op_sel_hi:[1,0]
  v_cvt_pk_bf16_f32 v64, v128, v129
  v_cvt_pk_bf16_f32 v65, v130, v131
  v_cvt_pk_bf16_f32 v66, v132, v133
  v_cvt_pk_bf16_f32 v67, v134, v135
  buffer_store_dwordx4 v[64:67], v2, s[20:23], s32 offen offset:0 sc1
  s_waitcnt vmcnt(9) lgkmcnt(0)
  s_barrier
  buffer_load_dword v28, v29, s[20:23], s55 offen sc1
  s_nop 5
  v_accvgpr_read_b32 v136, a8
  v_add_u32 v3, s54, v25
  ds_read_b64_tr_b16 a[128:129], v3 offset:0
  ds_read_b64_tr_b16 a[130:131], v3 offset:8192
  ds_read_b64_tr_b16 a[132:133], v3 offset:8
  s_add_u32 m0, s47, s52
  s_add_u32 s50, s45, 262144
  buffer_load_dwordx4 v53, s[8:11], s50 offen offset:0 lds
  v_accvgpr_read_b32 v137, a9
  v_accvgpr_read_b32 v138, a10
  v_accvgpr_read_b32 v139, a11
  v_accvgpr_read_b32 v140, a12
  v_accvgpr_read_b32 v141, a13
  v_accvgpr_read_b32 v142, a14
  v_accvgpr_read_b32 v143, a15
  ds_read_b64_tr_b16 a[134:135], v3 offset:8200
  ds_read_b64_tr_b16 a[136:137], v3 offset:16384
  ds_read_b64_tr_b16 a[138:139], v3 offset:24576
  buffer_load_dwordx4 v54, s[8:11], s50 offen offset:1024 lds
  v_pk_mul_f32 v[136:137], v[136:137], v[36:37] op_sel_hi:[1,0]
  v_pk_mul_f32 v[138:139], v[138:139], v[36:37] op_sel_hi:[1,0]
  v_pk_mul_f32 v[140:141], v[140:141], v[36:37] op_sel_hi:[1,0]
  v_pk_mul_f32 v[142:143], v[142:143], v[36:37] op_sel_hi:[1,0]
  v_cvt_pk_bf16_f32 v68, v136, v137
  v_cvt_pk_bf16_f32 v69, v138, v139
  v_cvt_pk_bf16_f32 v70, v140, v141
  ds_read_b64_tr_b16 a[140:141], v3 offset:16392
  ds_read_b64_tr_b16 a[142:143], v3 offset:24584
  ds_read_b64_tr_b16 a[144:145], v3 offset:4096
  buffer_load_dwordx4 v55, s[8:11], s50 offen offset:2048 lds
  v_cvt_pk_bf16_f32 v71, v142, v143
  buffer_store_dwordx4 v[68:71], v2, s[20:23], s32 offen offset:1024 sc1
  v_accvgpr_read_b32 v128, a16
  v_accvgpr_read_b32 v129, a17
  v_accvgpr_read_b32 v130, a18
  v_accvgpr_read_b32 v131, a19
  v_accvgpr_read_b32 v132, a20
  ds_read_b64_tr_b16 a[146:147], v3 offset:12288
  ds_read_b64_tr_b16 a[148:149], v3 offset:4104
  ds_read_b64_tr_b16 a[150:151], v3 offset:12296
  buffer_load_dwordx4 v30, s[8:11], s50 offen offset:3072 lds
  v_accvgpr_read_b32 v133, a21
  v_accvgpr_read_b32 v134, a22
  v_accvgpr_read_b32 v135, a23
  v_pk_mul_f32 v[128:129], v[128:129], v[36:37] op_sel_hi:[1,0]
  v_pk_mul_f32 v[130:131], v[130:131], v[36:37] op_sel_hi:[1,0]
  v_pk_mul_f32 v[132:133], v[132:133], v[36:37] op_sel_hi:[1,0]
  v_pk_mul_f32 v[134:135], v[134:135], v[36:37] op_sel_hi:[1,0]
  ds_read_b64_tr_b16 a[152:153], v3 offset:20480
  ds_read_b64_tr_b16 a[154:155], v3 offset:28672
  ds_read_b64_tr_b16 a[156:157], v3 offset:20488
  s_add_u32 m0, s47, s52
  s_add_u32 m0, m0, 4096
  s_add_u32 s50, s45, 327680
  buffer_load_dwordx4 v53, s[8:11], s50 offen offset:0 lds
  v_cvt_pk_bf16_f32 v72, v128, v129
  v_cvt_pk_bf16_f32 v73, v130, v131
  v_cvt_pk_bf16_f32 v74, v132, v133
  v_cvt_pk_bf16_f32 v75, v134, v135
  buffer_store_dwordx4 v[72:75], v2, s[20:23], s32 offen offset:2048 sc1
  v_accvgpr_read_b32 v136, a24
  v_accvgpr_read_b32 v137, a25
  ds_read_b64_tr_b16 a[158:159], v3 offset:28680
  buffer_load_dwordx4 v54, s[8:11], s50 offen offset:1024 lds
  v_accvgpr_read_b32 v138, a26
  v_accvgpr_read_b32 v139, a27
  v_accvgpr_read_b32 v140, a28
  v_accvgpr_read_b32 v141, a29
  v_accvgpr_read_b32 v142, a30
  v_accvgpr_read_b32 v143, a31
  v_pk_mul_f32 v[136:137], v[136:137], v[36:37] op_sel_hi:[1,0]
  buffer_load_dwordx4 v55, s[8:11], s50 offen offset:2048 lds
  v_pk_mul_f32 v[138:139], v[138:139], v[36:37] op_sel_hi:[1,0]
  v_pk_mul_f32 v[140:141], v[140:141], v[36:37] op_sel_hi:[1,0]
  v_pk_mul_f32 v[142:143], v[142:143], v[36:37] op_sel_hi:[1,0]
  v_cvt_pk_bf16_f32 v76, v136, v137
  v_cvt_pk_bf16_f32 v77, v138, v139
  v_cvt_pk_bf16_f32 v78, v140, v141
  v_cvt_pk_bf16_f32 v79, v142, v143
  buffer_load_dwordx4 v30, s[8:11], s50 offen offset:3072 lds
  buffer_store_dwordx4 v[76:79], v2, s[20:23], s32 offen offset:3072 sc1
  v_rcp_f32 v38, v38
  v_accvgpr_read_b32 v128, a32
  v_accvgpr_read_b32 v129, a33
  v_accvgpr_read_b32 v130, a34
  v_accvgpr_read_b32 v131, a35
  v_accvgpr_read_b32 v132, a36
  s_add_u32 m0, s47, s53
  s_add_u32 s50, s45, 393216
  buffer_load_dwordx4 v53, s[8:11], s50 offen offset:0 lds
  v_accvgpr_read_b32 v133, a37
  v_accvgpr_read_b32 v134, a38
  v_accvgpr_read_b32 v135, a39
  v_pk_mul_f32 v[128:129], v[128:129], v[38:39] op_sel_hi:[1,0]
  v_pk_mul_f32 v[130:131], v[130:131], v[38:39] op_sel_hi:[1,0]
  v_pk_mul_f32 v[132:133], v[132:133], v[38:39] op_sel_hi:[1,0]
  v_pk_mul_f32 v[134:135], v[134:135], v[38:39] op_sel_hi:[1,0]
  buffer_load_dwordx4 v54, s[8:11], s50 offen offset:1024 lds
  v_cvt_pk_bf16_f32 v80, v128, v129
  v_cvt_pk_bf16_f32 v81, v130, v131
  v_cvt_pk_bf16_f32 v82, v132, v133
  v_cvt_pk_bf16_f32 v83, v134, v135
  buffer_store_dwordx4 v[80:83], v2, s[20:23], s33 offen offset:0 sc1
  v_accvgpr_read_b32 v136, a40
  v_accvgpr_read_b32 v137, a41
  buffer_load_dwordx4 v55, s[8:11], s50 offen offset:2048 lds
  v_accvgpr_read_b32 v138, a42
  v_accvgpr_read_b32 v139, a43
  v_accvgpr_read_b32 v140, a44
  v_accvgpr_read_b32 v141, a45
  v_accvgpr_read_b32 v142, a46
  v_accvgpr_read_b32 v143, a47
  v_pk_mul_f32 v[136:137], v[136:137], v[38:39] op_sel_hi:[1,0]
  buffer_load_dwordx4 v30, s[8:11], s50 offen offset:3072 lds
  v_pk_mul_f32 v[138:139], v[138:139], v[38:39] op_sel_hi:[1,0]
  v_pk_mul_f32 v[140:141], v[140:141], v[38:39] op_sel_hi:[1,0]
  v_pk_mul_f32 v[142:143], v[142:143], v[38:39] op_sel_hi:[1,0]
  v_cvt_pk_bf16_f32 v84, v136, v137
  v_cvt_pk_bf16_f32 v85, v138, v139
  v_cvt_pk_bf16_f32 v86, v140, v141
  v_cvt_pk_bf16_f32 v87, v142, v143
  s_add_u32 m0, s47, s53
  s_add_u32 m0, m0, 4096
  s_add_u32 s50, s45, 458752
  buffer_load_dwordx4 v53, s[8:11], s50 offen offset:0 lds
  buffer_store_dwordx4 v[84:87], v2, s[20:23], s33 offen offset:1024 sc1
  v_accvgpr_read_b32 v128, a48
  v_accvgpr_read_b32 v129, a49
  v_accvgpr_read_b32 v130, a50
  v_accvgpr_read_b32 v131, a51
  v_accvgpr_read_b32 v132, a52
  v_accvgpr_read_b32 v133, a53
  buffer_load_dwordx4 v54, s[8:11], s50 offen offset:1024 lds
  v_accvgpr_read_b32 v134, a54
  v_accvgpr_read_b32 v135, a55
  v_pk_mul_f32 v[128:129], v[128:129], v[38:39] op_sel_hi:[1,0]
  v_pk_mul_f32 v[130:131], v[130:131], v[38:39] op_sel_hi:[1,0]
  v_pk_mul_f32 v[132:133], v[132:133], v[38:39] op_sel_hi:[1,0]
  v_pk_mul_f32 v[134:135], v[134:135], v[38:39] op_sel_hi:[1,0]
  v_cvt_pk_bf16_f32 v88, v128, v129
  buffer_load_dwordx4 v55, s[8:11], s50 offen offset:2048 lds
  v_cvt_pk_bf16_f32 v89, v130, v131
  v_cvt_pk_bf16_f32 v90, v132, v133
  v_cvt_pk_bf16_f32 v91, v134, v135
  buffer_store_dwordx4 v[88:91], v2, s[20:23], s33 offen offset:2048 sc1
  v_accvgpr_read_b32 v136, a56
  v_accvgpr_read_b32 v137, a57
  v_accvgpr_read_b32 v138, a58
  buffer_load_dwordx4 v30, s[8:11], s50 offen offset:3072 lds
  v_accvgpr_read_b32 v139, a59
  v_accvgpr_read_b32 v140, a60
  v_accvgpr_read_b32 v141, a61
  v_accvgpr_read_b32 v142, a62
  v_accvgpr_read_b32 v143, a63
  v_pk_mul_f32 v[136:137], v[136:137], v[38:39] op_sel_hi:[1,0]
  v_pk_mul_f32 v[138:139], v[138:139], v[38:39] op_sel_hi:[1,0]
  v_pk_mul_f32 v[140:141], v[140:141], v[38:39] op_sel_hi:[1,0]
  v_pk_mul_f32 v[142:143], v[142:143], v[38:39] op_sel_hi:[1,0]
  v_cvt_pk_bf16_f32 v92, v136, v137
  v_cvt_pk_bf16_f32 v93, v138, v139
  v_cvt_pk_bf16_f32 v94, v140, v141
  v_cvt_pk_bf16_f32 v95, v142, v143
  buffer_store_dwordx4 v[92:95], v2, s[20:23], s33 offen offset:3072 sc1
  s_waitcnt vmcnt(23)
  v_cmp_ne_u32 vcc, 1, v28
  s_cbranch_vccz Lspok140
  s_mov_b32 s5, 0
Lspin139:
  s_sleep 2
  buffer_load_dword v28, v29, s[20:23], s55 offen sc1
  s_add_u32 s5, s5, 1
  s_waitcnt vmcnt(0)
  v_cmp_ne_u32 vcc, 1, v28
  s_cbranch_vccz Lspok140
  s_cmp_lt_u32 s5, 0x10000
  s_cbranch_scc1 Lspin139
Lspok140:
  s_add_u32 m0, s69, 98304
  s_xor_b32 s51, s16, 131072
  buffer_load_dwordx4 v2, s[20:23], s51 offen offset:0 sc1 lds
  buffer_load_dwordx4 v2, s[20:23], s51 offen offset:1024 sc1 lds
  buffer_load_dwordx4 v2, s[20:23], s51 offen offset:2048 sc1 lds
  buffer_load_dwordx4 v2, s[20:23], s51 offen offset:3072 sc1 lds
  s_waitcnt vmcnt(4) lgkmcnt(0)
  s_barrier
  s_lshl_b32 s3, s42, 5
  s_add_u32 s3, s3, s41
  s_cmp_lg_u32 s40, 0
  s_cbranch_scc1 Lpub141
  s_lshr_b32 s4, s3, 2
  s_lshl_b32 s4, s4, 5
  s_and_b32 s5, s3, 3
  s_add_u32 s4, s4, s5
  s_lshl_b32 s4, s4, 2
  s_add_u32 s4, s4, 65028096
  v_mov_b32 v26, 1
  s_mov_b64 exec, 1
  buffer_store_dword v26, off, s[20:23], s4 sc1
  s_mov_b64 exec, -1
Lpub141:
  s_add_u32 m0, s69, 114688
  s_xor_b32 s51, s16, 262144
  buffer_load_dwordx4 v2, s[20:23], s51 offen offset:0 sc1 lds
  buffer_load_dwordx4 v2, s[20:23], s51 offen offset:1024 sc1 lds
  buffer_load_dwordx4 v2, s[20:23], s51 offen offset:2048 sc1 lds
  buffer_load_dwordx4 v2, s[20:23], s51 offen offset:3072 sc1 lds
  v_add_u32 v3, 65536, v25
  ds_read_b64_tr_b16 a[160:161], v3 offset:0
  ds_read_b64_tr_b16 a[162:163], v3 offset:8192
  ds_read_b64_tr_b16 a[164:165], v3 offset:8
  ds_read_b64_tr_b16 a[166:167], v3 offset:8200
  ds_read_b64_tr_b16 a[168:169], v3 offset:16384
  ds_read_b64_tr_b16 a[170:171], v3 offset:24576
  ds_read_b64_tr_b16 a[172:173], v3 offset:16392
  ds_read_b64_tr_b16 a[174:175], v3 offset:24584
  ds_read_b64_tr_b16 a[176:177], v3 offset:4096
  ds_read_b64_tr_b16 a[178:179], v3 offset:12288
  ds_read_b64_tr_b16 a[180:181], v3 offset:4104
  ds_read_b64_tr_b16 a[182:183], v3 offset:12296
  ds_read_b64_tr_b16 a[184:185], v3 offset:20480
  ds_read_b64_tr_b16 a[186:187], v3 offset:28672
  ds_read_b64_tr_b16 a[188:189], v3 offset:20488
  ds_read_b64_tr_b16 a[190:191], v3 offset:28680
  v_add_u32 v3, s52, v25
  ds_read_b64_tr_b16 a[192:193], v3 offset:0
  ds_read_b64_tr_b16 a[194:195], v3 offset:8192
  ds_read_b64_tr_b16 a[196:197], v3 offset:8
  ds_read_b64_tr_b16 a[198:199], v3 offset:8200
  ds_read_b64_tr_b16 a[200:201], v3 offset:16384
  ds_read_b64_tr_b16 a[202:203], v3 offset:24576
  ds_read_b64_tr_b16 a[204:205], v3 offset:16392
  ds_read_b64_tr_b16 a[206:207], v3 offset:24584
  ds_read_b64_tr_b16 a[208:209], v3 offset:4096
  ds_read_b64_tr_b16 a[210:211], v3 offset:12288
  ds_read_b64_tr_b16 a[212:213], v3 offset:4104
  ds_read_b64_tr_b16 a[214:215], v3 offset:12296
  ds_read_b64_tr_b16 a[216:217], v3 offset:20480
  ds_read_b64_tr_b16 a[218:219], v3 offset:28672
  ds_read_b64_tr_b16 a[220:221], v3 offset:20488
  ds_read_b64_tr_b16 a[222:223], v3 offset:28680
  v_add_u32 v3, s53, v25
  ds_read_b64_tr_b16 a[224:225], v3 offset:0
  ds_read_b64_tr_b16 a[226:227], v3 offset:8192
  ds_read_b64_tr_b16 a[228:229], v3 offset:8
  ds_read_b64_tr_b16 a[230:231], v3 offset:8200
  ds_read_b64_tr_b16 a[232:233], v3 offset:16384
  ds_read_b64_tr_b16 a[234:235], v3 offset:24576
  ds_read_b64_tr_b16 a[236:237], v3 offset:16392
  ds_read_b64_tr_b16 a[238:239], v3 offset:24584
  ds_read_b64_tr_b16 a[240:241], v3 offset:4096
  ds_read_b64_tr_b16 a[242:243], v3 offset:12288
  ds_read_b64_tr_b16 a[244:245], v3 offset:4104
  ds_read_b64_tr_b16 a[246:247], v3 offset:12296
  ds_read_b64_tr_b16 a[248:249], v3 offset:20480
  ds_read_b64_tr_b16 a[250:251], v3 offset:28672
  ds_read_b64_tr_b16 a[252:253], v3 offset:20488
  ds_read_b64_tr_b16 a[254:255], v3 offset:28680
  buffer_load_dword v27, v0, s[28:31], 0 offen
  s_add_u32 s55, s55, -32768
  s_waitcnt vmcnt(1) lgkmcnt(0)
  s_barrier
  s_add_u32 m0, s69, 65536
  s_xor_b32 s51, s16, 147456
  buffer_load_dwordx4 v2, s[20:23], s51 offen offset:0 sc1 lds
  buffer_load_dwordx4 v2, s[20:23], s51 offen offset:1024 sc1 lds
  buffer_load_dwordx4 v2, s[20:23], s51 offen offset:2048 sc1 lds
  buffer_load_dwordx4 v2, s[20:23], s51 offen offset:3072 sc1 lds
  s_add_u32 m0, s69, 81920
  s_xor_b32 s51, s16, 278528
  buffer_load_dwordx4 v2, s[20:23], s51 offen offset:0 sc1 lds
  buffer_load_dwordx4 v2, s[20:23], s51 offen offset:1024 sc1 lds
  buffer_load_dwordx4 v2, s[20:23], s51 offen offset:2048 sc1 lds
  buffer_load_dwordx4 v2, s[20:23], s51 offen offset:3072 sc1 lds
  v_add_u32 v4, 0x18000, v4
  ds_read_b128 v[192:195], v4 offset:0
  ds_read_b128 v[196:199], v4 offset:1024
  ds_read_b128 v[200:203], v4 offset:2048
  ds_read_b128 v[204:207], v4 offset:3072
  ds_read_b128 v[208:211], v4 offset:4096
  ds_read_b128 v[212:215], v4 offset:5120
  ds_read_b128 v[216:219], v4 offset:6144
  ds_read_b128 v[220:223], v4 offset:7168
  s_waitcnt lgkmcnt(4)
  v_mfma_f32_16x16x32_bf16 v[128:131], a[64:67], v[192:195], 0
  ds_read_b128 v[224:227], v4 offset:8192
  ds_read_b128 v[228:231], v4 offset:9216
  s_add_u32 m0, s47, 0
  s_add_u32 s50, s45, 524288
  buffer_load_dwordx4 v53, s[8:11], s50 offen offset:0 lds
  v_mfma_f32_16x16x32_bf16 v[128:131], a[72:75], v[196:199], v[128:131]
  v_mfma_f32_16x16x32_bf16 v[128:131], a[80:83], v[200:203], v[128:131]
  ds_read_b128 v[232:235], v4 offset:10240
  ds_read_b128 v[236:239], v4 offset:11264
  v_mfma_f32_16x16x32_bf16 v[128:131], a[88:91], v[204:207], v[128:131]
  buffer_load_dwordx4 v54, s[8:11], s50 offen offset:1024 lds
  v_mfma_f32_16x16x32_bf16 v[132:135], a[92:95], v[204:207], 0
  v_mfma_f32_16x16x32_bf16 v[132:135], a[84:87], v[200:203], v[132:135]
  v_mfma_f32_16x16x32_bf16 v[132:135], a[76:79], v[196:199], v[132:135]
  buffer_load_dwordx4 v55, s[8:11], s50 offen offset:2048 lds
  v_mfma_f32_16x16x32_bf16 v[132:135], a[68:71], v[192:195], v[132:135]
  s_waitcnt lgkmcnt(4)
  v_mfma_f32_16x16x32_bf16 v[132:135], a[100:103], v[208:211], v[132:135]
  ds_read_b128 v[192:195], v4 offset:12288
  ds_read_b128 v[196:199], v4 offset:13312
  v_mfma_f32_16x16x32_bf16 v[132:135], a[108:111], v[212:215], v[132:135]
  buffer_load_dwordx4 v30, s[8:11], s50 offen offset:3072 lds
  v_mfma_f32_16x16x32_bf16 v[132:135], a[116:119], v[216:219], v[132:135]
  ds_read_b128 v[200:203], v4 offset:14336
  ds_read_b128 v[204:207], v4 offset:15360
  v_mfma_f32_16x16x32_bf16 v[132:135], a[124:127], v[220:223], v[132:135]
  v_mfma_f32_16x16x32_bf16 v[128:131], a[120:123], v[220:223], v[128:131]
  s_add_u32 m0, s47, 0
  s_add_u32 m0, m0, 4096
  s_add_u32 s50, s45, 589824
  buffer_load_dwordx4 v53, s[8:11], s50 offen offset:0 lds
  v_mfma_f32_16x16x32_bf16 v[128:131], a[112:115], v[216:219], v[128:131]
  v_mfma_f32_16x16x32_bf16 v[128:131], a[104:107], v[212:215], v[128:131]
  v_mfma_f32_16x16x32_bf16 v[128:131], a[96:99], v[208:211], v[128:131]
  buffer_load_dwordx4 v54, s[8:11], s50 offen offset:1024 lds
  s_waitcnt lgkmcnt(4)
  v_mfma_f32_16x16x32_bf16 v[128:131], a[128:131], v[224:227], v[128:131]
  ds_read_b128 v[208:211], v4 offset:16384
  ds_read_b128 v[212:215], v4 offset:17408
  v_mfma_f32_16x16x32_bf16 v[128:131], a[136:139], v[228:231], v[128:131]
  v_mfma_f32_16x16x32_bf16 v[128:131], a[144:147], v[232:235], v[128:131]
  ds_read_b128 v[216:219], v4 offset:18432
  ds_read_b128 v[220:223], v4 offset:19456
  buffer_load_dwordx4 v55, s[8:11], s50 offen offset:2048 lds
  v_mfma_f32_16x16x32_bf16 v[128:131], a[152:155], v[236:239], v[128:131]
  v_mfma_f32_16x16x32_bf16 v[132:135], a[156:159], v[236:239], v[132:135]
  v_mfma_f32_16x16x32_bf16 v[132:135], a[148:151], v[232:235], v[132:135]
  buffer_load_dwordx4 v30, s[8:11], s50 offen offset:3072 lds
  v_mfma_f32_16x16x32_bf16 v[132:135], a[140:143], v[228:231], v[132:135]
  v_mfma_f32_16x16x32_bf16 v[132:135], a[132:135], v[224:227], v[132:135]
  s_waitcnt lgkmcnt(4)
  v_mfma_f32_16x16x32_bf16 v[132:135], a[164:167], v[192:195], v[132:135]
  ds_read_b128 v[224:227], v4 offset:20480
  ds_read_b128 v[228:231], v4 offset:21504
  s_add_u32 m0, s47, 32768
  s_add_u32 s50, s45, 655360
  buffer_load_dwordx4 v53, s[8:11], s50 offen offset:0 lds
  v_mfma_f32_16x16x32_bf16 v[132:135], a[172:175], v[196:199], v[132:135]
  v_mfma_f32_16x16x32_bf16 v[132:135], a[180:183], v[200:203], v[132:135]
  ds_read_b128 v[232:235], v4 offset:22528
  ds_read_b128 v[236:239], v4 offset:23552
  v_mfma_f32_16x16x32_bf16 v[132:135], a[188:191], v[204:207], v[132:135]
  buffer_load_dwordx4 v54, s[8:11], s50 offen offset:1024 lds
  v_mfma_f32_16x16x32_bf16 v[128:131], a[184:187], v[204:207], v[128:131]
  v_mfma_f32_16x16x32_bf16 v[128:131], a[176:179], v[200:203], v[128:131]
  v_mfma_f32_16x16x32_bf16 v[128:131], a[168:171], v[196:199], v[128:131]
  buffer_load_dwordx4 v55, s[8:11], s50 offen offset:2048 lds
  v_mfma_f32_16x16x32_bf16 v[128:131], a[160:163], v[192:195], v[128:131]
  s_waitcnt lgkmcnt(4)
  v_mfma_f32_16x16x32_bf16 v[136:139], a[64:67], v[208:211], 0
  ds_read_b128 v[192:195], v4 offset:24576
  ds_read_b128 v[196:199], v4 offset:25600
  v_mfma_f32_16x16x32_bf16 v[136:139], a[72:75], v[212:215], v[136:139]
  buffer_load_dwordx4 v30, s[8:11], s50 offen offset:3072 lds
  v_mfma_f32_16x16x32_bf16 v[136:139], a[80:83], v[216:219], v[136:139]
  ds_read_b128 v[200:203], v4 offset:26624
  ds_read_b128 v[204:207], v4 offset:27648
  v_mfma_f32_16x16x32_bf16 v[136:139], a[88:91], v[220:223], v[136:139]
  v_mfma_f32_16x16x32_bf16 v[140:143], a[92:95], v[220:223], 0
  s_add_u32 m0, s47, 32768
  s_add_u32 m0, m0, 4096
  s_add_u32 s50, s45, 720896
  buffer_load_dwordx4 v53, s[8:11], s50 offen offset:0 lds
  v_mfma_f32_16x16x32_bf16 v[140:143], a[84:87], v[216:219], v[140:143]
  v_mfma_f32_16x16x32_bf16 v[140:143], a[76:79], v[212:215], v[140:143]
  v_mfma_f32_16x16x32_bf16 v[140:143], a[68:71], v[208:211], v[140:143]
  buffer_load_dwordx4 v54, s[8:11], s50 offen offset:1024 lds
  s_waitcnt lgkmcnt(4)
  v_mfma_f32_16x16x32_bf16 v[140:143], a[100:103], v[224:227], v[140:143]
  ds_read_b128 v[208:211], v4 offset:28672
  ds_read_b128 v[212:215], v4 offset:29696
  v_mfma_f32_16x16x32_bf16 v[140:143], a[108:111], v[228:231], v[140:143]
  v_mfma_f32_16x16x32_bf16 v[140:143], a[116:119], v[232:235], v[140:143]
  ds_read_b128 v[216:219], v4 offset:30720
  ds_read_b128 v[220:223], v4 offset:31744
  buffer_load_dwordx4 v55, s[8:11], s50 offen offset:2048 lds
  v_mfma_f32_16x16x32_bf16 v[140:143], a[124:127], v[236:239], v[140:143]
  v_mfma_f32_16x16x32_bf16 v[136:139], a[120:123], v[236:239], v[136:139]
  v_mfma_f32_16x16x32_bf16 v[136:139], a[112:115], v[232:235], v[136:139]
  buffer_load_dwordx4 v30, s[8:11], s50 offen offset:3072 lds
  v_mfma_f32_16x16x32_bf16 v[136:139], a[104:107], v[228:231], v[136:139]
  v_mfma_f32_16x16x32_bf16 v[136:139], a[96:99], v[224:227], v[136:139]
  s_waitcnt lgkmcnt(4)
  v_mfma_f32_16x16x32_bf16 v[136:139], a[128:131], v[192:195], v[136:139]
  s_add_u32 m0, s69, 131072
  s_xor_b32 s51, s16, 393216
  buffer_load_dwordx4 v2, s[20:23], s51 offen offset:0 sc1 lds
  v_mfma_f32_16x16x32_bf16 v[136:139], a[136:139], v[196:199], v[136:139]
  v_mfma_f32_16x16x32_bf16 v[136:139], a[144:147], v[200:203], v[136:139]
  s_waitcnt vmcnt(17) lgkmcnt(0)
  s_barrier
  v_add_u32 v4, 0xffff8000, v4
  ds_read_b128 v[224:227], v4 offset:0
  ds_read_b128 v[228:231], v4 offset:1024
  v_mfma_f32_16x16x32_bf16 v[136:139], a[152:155], v[204:207], v[136:139]
  ds_read_b128 v[232:235], v4 offset:2048
  ds_read_b128 v[236:239], v4 offset:3072
  buffer_load_dwordx4 v2, s[20:23], s51 offen offset:1024 sc1 lds
  v_mfma_f32_16x16x32_bf16 v[140:143], a[156:159], v[204:207], v[140:143]
  v_mfma_f32_16x16x32_bf16 v[140:143], a[148:151], v[200:203], v[140:143]
  v_mfma_f32_16x16x32_bf16 v[140:143], a[140:143], v[196:199], v[140:143]
  buffer_load_dwordx4 v2, s[20:23], s51 offen offset:2048 sc1 lds
  v_mfma_f32_16x16x32_bf16 v[140:143], a[132:135], v[192:195], v[140:143]
  v_mfma_f32_16x16x32_bf16 v[140:143], a[164:167], v[208:211], v[140:143]
  ds_read_b128 v[192:195], v4 offset:4096
  ds_read_b128 v[196:199], v4 offset:5120
  v_mfma_f32_16x16x32_bf16 v[140:143], a[172:175], v[212:215], v[140:143]
  buffer_load_dwordx4 v2, s[20:23], s51 offen offset:3072 sc1 lds
  v_mfma_f32_16x16x32_bf16 v[140:143], a[180:183], v[216:219], v[140:143]
  ds_read_b128 v[200:203], v4 offset:6144
  ds_read_b128 v[204:207], v4 offset:7168
  v_mfma_f32_16x16x32_bf16 v[140:143], a[188:191], v[220:223], v[140:143]
  v_mfma_f32_16x16x32_bf16 v[136:139], a[184:187], v[220:223], v[136:139]
  s_add_u32 m0, s69, 147456
  s_xor_b32 s51, s16, 409600
  buffer_load_dwordx4 v2, s[20:23], s51 offen offset:0 sc1 lds
  v_mfma_f32_16x16x32_bf16 v[136:139], a[176:179], v[216:219], v[136:139]
  v_mfma_f32_16x16x32_bf16 v[136:139], a[168:171], v[212:215], v[136:139]
  v_mfma_f32_16x16x32_bf16 v[136:139], a[160:163], v[208:211], v[136:139]
  buffer_load_dwordx4 v2, s[20:23], s51 offen offset:1024 sc1 lds
  s_waitcnt vmcnt(6)
  s_barrier
  s_waitcnt lgkmcnt(4)
  v_mfma_f32_16x16x32_bf16 v[128:131], a[192:195], v[224:227], v[128:131]
  ds_read_b128 v[208:211], v4 offset:8192
  ds_read_b128 v[212:215], v4 offset:9216
  v_add_u32 v3, 0, v25
  ds_read_b64_tr_b16 a[0:1], v3 offset:0
  ds_read_b64_tr_b16 a[2:3], v3 offset:8192
  v_mfma_f32_16x16x32_bf16 v[128:131], a[200:203], v[228:231], v[128:131]
  ds_read_b64_tr_b16 a[4:5], v3 offset:8
  ds_read_b64_tr_b16 a[6:7], v3 offset:8200
  v_mfma_f32_16x16x32_bf16 v[128:131], a[208:211], v[232:235], v[128:131]
  ds_read_b128 v[216:219], v4 offset:10240
  ds_read_b128 v[220:223], v4 offset:11264
  ds_read_b64_tr_b16 a[8:9], v3 offset:16384
  ds_read_b64_tr_b16 a[10:11], v3 offset:24576
  buffer_load_dwordx4 v2, s[20:23], s51 offen offset:2048 sc1 lds
  v_mfma_f32_16x16x32_bf16 v[128:131], a[216:219], v[236:239], v[128:131]
  ds_read_b64_tr_b16 a[12:13], v3 offset:16392
  ds_read_b64_tr_b16 a[14:15], v3 offset:24584
  v_mfma_f32_16x16x32_bf16 v[132:135], a[220:223], v[236:239], v[132:135]
  ds_read_b64_tr_b16 a[16:17], v3 offset:4096
  ds_read_b64_tr_b16 a[18:19], v3 offset:12288
  v_mfma_f32_16x16x32_bf16 v[132:135], a[212:215], v[232:235], v[132:135]
  ds_read_b64_tr_b16 a[20:21], v3 offset:4104
  ds_read_b64_tr_b16 a[22:23], v3 offset:12296
  v_mfma_f32_16x16x32_bf16 v[132:135], a[204:207], v[228:231], v[132:135]
  ds_read_b64_tr_b16 a[24:25], v3 offset:20480
  ds_read_b64_tr_b16 a[26:27], v3 offset:28672
  buffer_load_dwordx4 v2, s[20:23], s51 offen offset:3072 sc1 lds
  v_mfma_f32_16x16x32_bf16 v[132:135], a[196:199], v[224:227], v[132:135]
  ds_read_b64_tr_b16 a[28:29], v3 offset:20488
  ds_read_b64_tr_b16 a[30:31], v3 offset:28680
  s_waitcnt lgkmcnt(15)
  v_mfma_f32_16x16x32_bf16 v[132:135], a[228:231], v[192:195], v[132:135]
  ds_read_b128 v[224:227], v4 offset:12288
  ds_read_b128 v[228:231], v4 offset:13312
  v_add_u32 v3, 32768, v25
  ds_read_b64_tr_b16 a[32:33], v3 offset:0
  ds_read_b64_tr_b16 a[34:35], v3 offset:8192
  v_mfma_f32_16x16x32_bf16 v[132:135], a[236:239], v[196:199], v[132:135]
  ds_read_b64_tr_b16 a[36:37], v3 offset:8
  ds_read_b64_tr_b16 a[38:39], v3 offset:8200
  v_mfma_f32_16x16x32_bf16 v[132:135], a[244:247], v[200:203], v[132:135]
  ds_read_b128 v[232:235], v4 offset:14336
  ds_read_b128 v[236:239], v4 offset:15360
  ds_read_b64_tr_b16 a[40:41], v3 offset:16384
  ds_read_b64_tr_b16 a[42:43], v3 offset:24576
  s_add_u32 m0, s69, 98304
  s_xor_b32 s51, s16, 0
  buffer_load_dwordx4 v2, s[20:23], s51 offen offset:0 sc1 lds
  v_mfma_f32_16x16x32_bf16 v[132:135], a[252:255], v[204:207], v[132:135]
  ds_read_b64_tr_b16 a[44:45], v3 offset:16392
  ds_read_b64_tr_b16 a[46:47], v3 offset:24584
  v_mfma_f32_16x16x32_bf16 v[128:131], a[248:251], v[204:207], v[128:131]
  ds_read_b64_tr_b16 a[48:49], v3 offset:4096
  ds_read_b64_tr_b16 a[50:51], v3 offset:12288
  v_mfma_f32_16x16x32_bf16 v[128:131], a[240:243], v[200:203], v[128:131]
  ds_read_b64_tr_b16 a[52:53], v3 offset:4104
  ds_read_b64_tr_b16 a[54:55], v3 offset:12296
  v_mfma_f32_16x16x32_bf16 v[128:131], a[232:235], v[196:199], v[128:131]
  ds_read_b64_tr_b16 a[56:57], v3 offset:20480
  ds_read_b64_tr_b16 a[58:59], v3 offset:28672
  buffer_load_dwordx4 v2, s[20:23], s51 offen offset:1024 sc1 lds
  v_mfma_f32_16x16x32_bf16 v[128:131], a[224:227], v[192:195], v[128:131]
  ds_read_b64_tr_b16 a[60:61], v3 offset:20488
  ds_read_b64_tr_b16 a[62:63], v3 offset:28680
  buffer_load_dword v28, v29, s[20:23], s55 offen sc1
  s_waitcnt lgkmcnt(0)
  v_mfma_f32_16x16x32_bf16 v[128:131], a[0:3], v[208:211], v[128:131]
  ds_read_b128 v[192:195], v4 offset:16384
  ds_read_b128 v[196:199], v4 offset:17408
  v_mfma_f32_16x16x32_bf16 v[128:131], a[8:11], v[212:215], v[128:131]
  v_mfma_f32_16x16x32_bf16 v[128:131], a[16:19], v[216:219], v[128:131]
  ds_read_b128 v[200:203], v4 offset:18432
  ds_read_b128 v[204:207], v4 offset:19456
  buffer_load_dwordx4 v2, s[20:23], s51 offen offset:2048 sc1 lds
  v_mfma_f32_16x16x32_bf16 v[128:131], a[24:27], v[220:223], v[128:131]
  v_mfma_f32_16x16x32_bf16 v[132:135], a[28:31], v[220:223], v[132:135]
  v_mfma_f32_16x16x32_bf16 v[132:135], a[20:23], v[216:219], v[132:135]
  v_mfma_f32_16x16x32_bf16 v[132:135], a[12:15], v[212:215], v[132:135]
  buffer_load_dwordx4 v2, s[20:23], s51 offen offset:3072 sc1 lds
  v_mfma_f32_16x16x32_bf16 v[132:135], a[4:7], v[208:211], v[132:135]
  v_mfma_f32_16x16x32_bf16 v[132:135], a[36:39], v[224:227], v[132:135]
  ds_read_b128 v[208:211], v4 offset:20480
  ds_read_b128 v[212:215], v4 offset:21504
  v_mfma_f32_16x16x32_bf16 v[132:135], a[44:47], v[228:231], v[132:135]
  v_mfma_f32_16x16x32_bf16 v[132:135], a[52:55], v[232:235], v[132:135]
  ds_read_b128 v[216:219], v4 offset:22528
  ds_read_b128 v[220:223], v4 offset:23552
  s_add_u32 m0, s69, 114688
  s_xor_b32 s51, s16, 16384
  buffer_load_dwordx4 v2, s[20:23], s51 offen offset:0 sc1 lds
  v_mfma_f32_16x16x32_bf16 v[132:135], a[60:63], v[236:239], v[132:135]
  v_mfma_f32_16x16x32_bf16 v[128:131], a[56:59], v[236:239], v[128:131]
  v_mfma_f32_16x16x32_bf16 v[128:131], a[48:51], v[232:235], v[128:131]
  v_mfma_f32_16x16x32_bf16 v[128:131], a[40:43], v[228:231], v[128:131]
  buffer_load_dwordx4 v2, s[20:23], s51 offen offset:1024 sc1 lds
  v_mfma_f32_16x16x32_bf16 v[128:131], a[32:35], v[224:227], v[128:131]
  s_waitcnt lgkmcnt(4)
  v_mfma_f32_16x16x32_bf16 v[136:139], a[192:195], v[192:195], v[136:139]
  ds_read_b128 v[224:227], v4 offset:24576
  ds_read_b128 v[228:231], v4 offset:25600
  v_mfma_f32_16x16x32_bf16 v[136:139], a[200:203], v[196:199], v[136:139]
  v_mfma_f32_16x16x32_bf16 v[136:139], a[208:211], v[200:203], v[136:139]
  ds_read_b128 v[232:235], v4 offset:26624
  ds_read_b128 v[236:239], v4 offset:27648
  v_cvt_pk_bf16_f32 v248, v128, v129
  v_cvt_pk_bf16_f32 v249, v130, v131
  v_mfma_f32_16x16x32_bf16 v[136:139], a[216:219], v[204:207], v[136:139]
  v_cvt_pk_bf16_f32 v250, v132, v133
  v_cvt_pk_bf16_f32 v251, v134, v135
  v_mfma_f32_16x16x32_bf16 v[140:143], a[220:223], v[204:207], v[140:143]
  s_xor_b32 s52, s70, 32768
  buffer_store_dwordx4 v[248:251], v2, s[20:23], s52 offen offset:0 sc1
  v_mfma_f32_16x16x32_bf16 v[140:143], a[212:215], v[200:203], v[140:143]
  buffer_load_dwordx4 v2, s[20:23], s51 offen offset:2048 sc1 lds
  v_mfma_f32_16x16x32_bf16 v[140:143], a[204:207], v[196:199], v[140:143]
  v_mfma_f32_16x16x32_bf16 v[140:143], a[196:199], v[192:195], v[140:143]
  s_waitcnt vmcnt(6)
  v_cmp_ne_u32 vcc, 1, v28
  s_cbranch_vccz Lspok143
  s_mov_b32 s5, 0
Lspin142:
  s_sleep 2
  buffer_load_dword v28, v29, s[20:23], s55 offen sc1
  s_add_u32 s5, s5, 1
  s_waitcnt vmcnt(0)
  v_cmp_ne_u32 vcc, 1, v28
  s_cbranch_vccz Lspok143
  s_cmp_lt_u32 s5, 0x10000
  s_cbranch_scc1 Lspin142
Lspok143:
  s_waitcnt lgkmcnt(4)
  v_mfma_f32_16x16x32_bf16 v[140:143], a[228:231], v[208:211], v[140:143]
  ds_read_b128 v[192:195], v4 offset:28672
  ds_read_b128 v[196:199], v4 offset:29696
  v_mfma_f32_16x16x32_bf16 v[140:143], a[236:239], v[212:215], v[140:143]
  s_mov_b32 s8, s64
  s_and_b32 s9, s65, 0xffff
  s_mov_b32 s10, 2097152
  buffer_load_dwordx4 v2, s[20:23], s51 offen offset:3072 sc1 lds
  v_mfma_f32_16x16x32_bf16 v[140:143], a[244:247], v[216:219], v[140:143]
  ds_read_b128 v[200:203], v4 offset:30720
  ds_read_b128 v[204:207], v4 offset:31744
  v_mfma_f32_16x16x32_bf16 v[140:143], a[252:255], v[220:223], v[140:143]
  s_mov_b32 s11, 0x20000
  s_lshl_b32 s6, s36, 2
  s_add_u32 s6, s6, s77
  v_mfma_f32_16x16x32_bf16 v[136:139], a[248:251], v[220:223], v[136:139]
  v_mfma_f32_16x16x32_bf16 v[136:139], a[240:243], v[216:219], v[136:139]
  s_lshl_b32 s7, s44, 2
  s_add_u32 s7, s7, s40
  s_lshl_b32 s4, s7, 6
  v_mfma_f32_16x16x32_bf16 v[136:139], a[232:235], v[212:215], v[136:139]
  v_mfma_f32_16x16x32_bf16 v[136:139], a[224:227], v[208:211], v[136:139]
  s_add_u32 s5, s66, s77
  s_lshl_b32 s18, s5, 14
  s_add_u32 s18, s18, s4
  s_waitcnt lgkmcnt(4)
  v_mfma_f32_16x16x32_bf16 v[136:139], a[0:3], v[224:227], v[136:139]
  v_mfma_f32_16x16x32_bf16 v[136:139], a[8:11], v[228:231], v[136:139]
  s_add_u32 s5, s67, s77
  s_lshl_b32 s19, s5, 14
  s_add_u32 s19, s19, s4
  v_mfma_f32_16x16x32_bf16 v[136:139], a[16:19], v[232:235], v[136:139]
  s_waitcnt lgkmcnt(0)
  s_barrier
  v_add_u32 v4, 0x10000, v4
  ds_read_b128 v[208:211], v4 offset:0
  ds_read_b128 v[212:215], v4 offset:1024
  s_add_u32 m0, s69, 32768
  s_xor_b32 s51, s17, 131072
  buffer_load_dwordx4 v2, s[20:23], s51 offen offset:0 sc1 lds
  v_mfma_f32_16x16x32_bf16 v[136:139], a[24:27], v[236:239], v[136:139]
  ds_read_b128 v[216:219], v4 offset:2048
  ds_read_b128 v[220:223], v4 offset:3072
  s_lshl_b32 s5, s6, 15
  s_add_u32 s39, s5, s4
  s_add_u32 s39, s39, 52428800
  v_mfma_f32_16x16x32_bf16 v[140:143], a[28:31], v[236:239], v[140:143]
  v_mfma_f32_16x16x32_bf16 v[140:143], a[20:23], v[232:235], v[140:143]
  s_lshl_b32 s4, s7, 10
  s_add_u32 s38, s5, s4
  s_add_u32 s38, s38, 54525952
  v_mfma_f32_16x16x32_bf16 v[140:143], a[12:15], v[228:231], v[140:143]
  buffer_load_dwordx4 v2, s[20:23], s51 offen offset:1024 sc1 lds
  v_mfma_f32_16x16x32_bf16 v[140:143], a[4:7], v[224:227], v[140:143]
  s_lshl_b32 s68, s6, 12
  s_lshl_b32 s4, s44, 9
  s_add_u32 s68, s68, s4
  v_mfma_f32_16x16x32_bf16 v[140:143], a[36:39], v[192:195], v[140:143]
  ds_read_b128 v[224:227], v4 offset:4096
  ds_read_b128 v[228:231], v4 offset:5120
  v_mfma_f32_16x16x32_bf16 v[140:143], a[44:47], v[196:199], v[140:143]
  s_add_u32 s68, s68, 62980096
  s_lshl_b32 s71, s6, 2
  s_add_u32 s71, s71, s44
  v_mfma_f32_16x16x32_bf16 v[140:143], a[52:55], v[200:203], v[140:143]
  ds_read_b128 v[232:235], v4 offset:6144
  ds_read_b128 v[236:239], v4 offset:7168
  buffer_load_dwordx4 v2, s[20:23], s51 offen offset:2048 sc1 lds
  v_mfma_f32_16x16x32_bf16 v[140:143], a[60:63], v[204:207], v[140:143]
  v_and_b32 v22, 15, v1
  v_lshlrev_b32 v22, 10, v22
  v_lshl_add_u32 v5, v21, 4, v22
  v_mfma_f32_16x16x32_bf16 v[136:139], a[56:59], v[204:207], v[136:139]
  v_mfma_f32_16x16x32_bf16 v[136:139], a[48:51], v[200:203], v[136:139]
  v_lshlrev_b32 v7, 5, v21
  s_lshl_b32 s60, s7, 7
  s_add_u32 s60, s60, 62918656
  v_mfma_f32_16x16x32_bf16 v[136:139], a[40:43], v[196:199], v[136:139]
  buffer_load_dwordx4 v2, s[20:23], s51 offen offset:3072 sc1 lds
  v_mfma_f32_16x16x32_bf16 v[136:139], a[32:35], v[192:195], v[136:139]
  s_add_u32 s61, s60, 4096
  s_mov_b32 s24, s78
  s_and_b32 s25, s79, 0xffff
  s_waitcnt lgkmcnt(4)
  v_mfma_f32_16x16x32_bf16 v[128:131], a[64:67], v[208:211], 0
  ds_read_b128 v[192:195], v4 offset:8192
  ds_read_b128 v[196:199], v4 offset:9216
  v_mfma_f32_16x16x32_bf16 v[128:131], a[72:75], v[212:215], v[128:131]
  s_mov_b32 s26, 1409024
  s_mov_b32 s27, 0x20000
  s_mov_b32 s4, 43691
  v_mfma_f32_16x16x32_bf16 v[128:131], a[80:83], v[216:219], v[128:131]
  ds_read_b128 v[200:203], v4 offset:10240
  ds_read_b128 v[204:207], v4 offset:11264
  v_cvt_pk_bf16_f32 v248, v136, v137
  v_cvt_pk_bf16_f32 v249, v138, v139
  v_mfma_f32_16x16x32_bf16 v[128:131], a[88:91], v[220:223], v[128:131]
  s_mov_b32 s5, 2752
  v_add_u32 v22, 0, v1
  v_mul_lo_u32 v23, v22, s4
  v_cvt_pk_bf16_f32 v250, v140, v141
  v_cvt_pk_bf16_f32 v251, v142, v143
  v_mfma_f32_16x16x32_bf16 v[132:135], a[92:95], v[220:223], 0
  s_xor_b32 s52, s70, 65536
  buffer_store_dwordx4 v[248:251], v2, s[20:23], s52 offen offset:1024 sc1
  v_mfma_f32_16x16x32_bf16 v[132:135], a[84:87], v[216:219], v[132:135]
  v_lshrrev_b32 v23, 19, v23
  v_mul_u32_u24 v24, 12, v23
  v_sub_u32 v24, v22, v24
  s_add_u32 m0, s69, 49152
  s_xor_b32 s51, s17, 147456
  buffer_load_dwordx4 v2, s[20:23], s51 offen offset:0 sc1 lds
  v_mfma_f32_16x16x32_bf16 v[132:135], a[76:79], v[212:215], v[132:135]
  v_mfma_f32_16x16x32_bf16 v[132:135], a[68:71], v[208:211], v[132:135]
  v_bfe_u32 v22, v23, 3, 1
  v_lshlrev_b32 v22, 1, v22
  v_xor_b32 v24, v24, v22
  s_waitcnt lgkmcnt(4)
  v_mfma_f32_16x16x32_bf16 v[132:135], a[100:103], v[224:227], v[132:135]
  ds_read_b128 v[208:211], v4 offset:12288
  ds_read_b128 v[212:215], v4 offset:13312
  v_mfma_f32_16x16x32_bf16 v[132:135], a[108:111], v[228:231], v[132:135]
  v_mul_lo_u32 v23, v23, s5
  v_lshl_add_u32 v23, v24, 4, v23
  v_subrev_u32 v92, 0, v23
  buffer_load_dwordx4 v2, s[20:23], s51 offen offset:1024 sc1 lds
  v_mfma_f32_16x16x32_bf16 v[132:135], a[116:119], v[232:235], v[132:135]
  ds_read_b128 v[216:219], v4 offset:14336
  ds_read_b128 v[220:223], v4 offset:15360
  v_mfma_f32_16x16x32_bf16 v[132:135], a[124:127], v[236:239], v[132:135]
  v_add_u32 v22, 64, v1
  v_mul_lo_u32 v23, v22, s4
  v_lshrrev_b32 v23, 19, v23
  v_mfma_f32_16x16x32_bf16 v[128:131], a[120:123], v[236:239], v[128:131]
  v_mfma_f32_16x16x32_bf16 v[128:131], a[112:115], v[232:235], v[128:131]
  v_mul_u32_u24 v24, 12, v23
  v_sub_u32 v24, v22, v24
  v_bfe_u32 v22, v23, 3, 1
  buffer_load_dwordx4 v2, s[20:23], s51 offen offset:2048 sc1 lds
  v_mfma_f32_16x16x32_bf16 v[128:131], a[104:107], v[228:231], v[128:131]
  v_mfma_f32_16x16x32_bf16 v[128:131], a[96:99], v[224:227], v[128:131]
  v_lshlrev_b32 v22, 1, v22
  v_xor_b32 v24, v24, v22
  v_mul_lo_u32 v23, v23, s5
  s_waitcnt lgkmcnt(4)
  v_mfma_f32_16x16x32_bf16 v[128:131], a[128:131], v[192:195], v[128:131]
  ds_read_b128 v[224:227], v4 offset:16384
  ds_read_b128 v[228:231], v4 offset:17408
  v_mfma_f32_16x16x32_bf16 v[128:131], a[136:139], v[196:199], v[128:131]
  v_lshl_add_u32 v23, v24, 4, v23
  v_subrev_u32 v93, 1024, v23
  v_add_u32 v22, 128, v1
  buffer_load_dwordx4 v2, s[20:23], s51 offen offset:3072 sc1 lds
  v_mfma_f32_16x16x32_bf16 v[128:131], a[144:147], v[200:203], v[128:131]
  ds_read_b128 v[232:235], v4 offset:18432
  ds_read_b128 v[236:239], v4 offset:19456
  v_mfma_f32_16x16x32_bf16 v[128:131], a[152:155], v[204:207], v[128:131]
  v_mul_lo_u32 v23, v22, s4
  v_lshrrev_b32 v23, 19, v23
  v_mul_u32_u24 v24, 12, v23
  v_mfma_f32_16x16x32_bf16 v[132:135], a[156:159], v[204:207], v[132:135]
  v_mfma_f32_16x16x32_bf16 v[132:135], a[148:151], v[200:203], v[132:135]
  v_sub_u32 v24, v22, v24
  v_bfe_u32 v22, v23, 3, 1
  v_lshlrev_b32 v22, 1, v22
  s_add_u32 m0, s69, 65536
  s_xor_b32 s51, s17, 262144
  buffer_load_dwordx4 v2, s[20:23], s51 offen offset:0 sc1 lds
  v_mfma_f32_16x16x32_bf16 v[132:135], a[140:143], v[196:199], v[132:135]
  v_mfma_f32_16x16x32_bf16 v[132:135], a[132:135], v[192:195], v[132:135]
  v_xor_b32 v24, v24, v22
  v_mul_lo_u32 v23, v23, s5
  v_lshl_add_u32 v23, v24, 4, v23
  s_waitcnt lgkmcnt(4)
  v_mfma_f32_16x16x32_bf16 v[132:135], a[164:167], v[208:211], v[132:135]
  ds_read_b128 v[192:195], v4 offset:20480
  ds_read_b128 v[196:199], v4 offset:21504
  v_mfma_f32_16x16x32_bf16 v[132:135], a[172:175], v[212:215], v[132:135]
  v_subrev_u32 v94, 2048, v23
  s_mov_b32 s12, s80
  s_and_b32 s13, s81, 0xffff
  buffer_load_dwordx4 v2, s[20:23], s51 offen offset:1024 sc1 lds
  v_mfma_f32_16x16x32_bf16 v[132:135], a[180:183], v[216:219], v[132:135]
  ds_read_b128 v[200:203], v4 offset:22528
  ds_read_b128 v[204:207], v4 offset:23552
  v_mfma_f32_16x16x32_bf16 v[132:135], a[188:191], v[220:223], v[132:135]
  s_mov_b32 s14, 2752
  s_mov_b32 s15, 0x20000
  s_mul_i32 s62, s37, 192
  v_mfma_f32_16x16x32_bf16 v[128:131], a[184:187], v[220:223], v[128:131]
  v_mfma_f32_16x16x32_bf16 v[128:131], a[176:179], v[216:219], v[128:131]
  s_mul_i32 s4, s40, 44032
  s_lshl_b32 s56, s40, 5
  s_add_u32 s56, s56, s62
  buffer_load_dwordx4 v2, s[20:23], s51 offen offset:2048 sc1 lds
  v_mfma_f32_16x16x32_bf16 v[128:131], a[168:171], v[212:215], v[128:131]
  v_mfma_f32_16x16x32_bf16 v[128:131], a[160:163], v[208:211], v[128:131]
  s_add_u32 s59, s40, 4
  s_min_u32 s59, s59, 5
  s_lshl_b32 s57, s59, 5
  s_waitcnt lgkmcnt(4)
  v_mfma_f32_16x16x32_bf16 v[128:131], a[192:195], v[224:227], v[128:131]
  ds_read_b128 v[208:211], v4 offset:24576
  ds_read_b128 v[212:215], v4 offset:25600
  v_mfma_f32_16x16x32_bf16 v[128:131], a[200:203], v[228:231], v[128:131]
  s_add_u32 s57, s57, s62
  s_add_u32 s62, s62, s4
  s_mul_i32 s63, s40, 3072
  buffer_load_dwordx4 v2, s[20:23], s51 offen offset:3072 sc1 lds
  v_mfma_f32_16x16x32_bf16 v[128:131], a[208:211], v[232:235], v[128:131]
  ds_read_b128 v[216:219], v4 offset:26624
  ds_read_b128 v[220:223], v4 offset:27648
  v_mfma_f32_16x16x32_bf16 v[128:131], a[216:219], v[236:239], v[128:131]
  s_mov_b32 s4, 0xfffffef4
  v_and_b32 v22, 15, v1
  v_lshlrev_b32 v121, 1, v22
  v_mfma_f32_16x16x32_bf16 v[132:135], a[220:223], v[236:239], v[132:135]
  v_mfma_f32_16x16x32_bf16 v[132:135], a[212:215], v[232:235], v[132:135]
  v_lshrrev_b32 v23, v121, s4
  v_and_b32 v23, 3, v23
  v_mul_u32_u24 v23, 8256, v23
  s_add_u32 m0, s69, 81920
  s_xor_b32 s51, s17, 278528
  buffer_load_dwordx4 v2, s[20:23], s51 offen offset:0 sc1 lds
  v_mfma_f32_16x16x32_bf16 v[132:135], a[204:207], v[228:231], v[132:135]
  v_mfma_f32_16x16x32_bf16 v[132:135], a[196:199], v[224:227], v[132:135]
  v_lshl_add_u32 v23, v21, 4, v23
  v_add_u32 v120, 100864, v23
  s_mul_i32 s46, s40, 8256
  s_waitcnt lgkmcnt(4)
  v_mfma_f32_16x16x32_bf16 v[132:135], a[228:231], v[192:195], v[132:135]
  ds_read_b128 v[224:227], v4 offset:28672
  ds_read_b128 v[228:231], v4 offset:29696
  v_mfma_f32_16x16x32_bf16 v[132:135], a[236:239], v[196:199], v[132:135]
  s_lshl_b32 s4, s40, 3
  s_lshr_b32 s58, 0x000304, s4
  s_and_b32 s58, s58, 0xff
  buffer_load_dwordx4 v2, s[20:23], s51 offen offset:1024 sc1 lds
  v_mfma_f32_16x16x32_bf16 v[132:135], a[244:247], v[200:203], v[132:135]
  ds_read_b128 v[232:235], v4 offset:30720
  ds_read_b128 v[236:239], v4 offset:31744
  v_mfma_f32_16x16x32_bf16 v[132:135], a[252:255], v[204:207], v[132:135]
  s_lshl_b32 s58, s58, 10
  s_add_u32 s58, s58, 62930944
  s_cmp_eq_u32 s40, 3
  s_cselect_b32 s58, 0x70000000, s58
  v_mfma_f32_16x16x32_bf16 v[128:131], a[248:251], v[204:207], v[128:131]
  v_mfma_f32_16x16x32_bf16 v[128:131], a[240:243], v[200:203], v[128:131]
  v_bfe_u32 v22, v1, 2, 2
  v_lshl_add_u32 v22, v21, 3, v22
  v_mul_u32_u24 v22, 192, v22
  buffer_load_dwordx4 v2, s[20:23], s51 offen offset:2048 sc1 lds
  v_mfma_f32_16x16x32_bf16 v[128:131], a[232:235], v[196:199], v[128:131]
  v_mfma_f32_16x16x32_bf16 v[128:131], a[224:227], v[192:195], v[128:131]
  v_and_b32 v23, 3, v1
  v_lshl_add_u32 v22, v23, 3, v22
  v_and_b32 v23, 1, v21
  s_waitcnt lgkmcnt(4)
  v_mfma_f32_16x16x32_bf16 v[128:131], a[0:3], v[208:211], v[128:131]
  v_mfma_f32_16x16x32_bf16 v[128:131], a[8:11], v[212:215], v[128:131]
  v_lshl_add_u32 v112, v23, 5, v22
  v_xor_b32 v113, 32, v112
  s_and_b32 s4, s40, 1
  buffer_load_dwordx4 v2, s[20:23], s51 offen offset:3072 sc1 lds
  v_mfma_f32_16x16x32_bf16 v[128:131], a[16:19], v[216:219], v[128:131]
  s_waitcnt vmcnt(17) lgkmcnt(0)
  s_barrier
  v_add_u32 v4, 0xffff8000, v4
  ds_read_b128 v[192:195], v4 offset:0
  ds_read_b128 v[196:199], v4 offset:1024
  v_mfma_f32_16x16x32_bf16 v[128:131], a[24:27], v[220:223], v[128:131]
  ds_read_b128 v[200:203], v4 offset:2048
  ds_read_b128 v[204:207], v4 offset:3072
  s_lshl_b32 s4, s4, 5
  v_xor_b32 v114, s4, v112
  s_lshr_b32 s4, s40, 1
  v_mfma_f32_16x16x32_bf16 v[132:135], a[28:31], v[220:223], v[132:135]
  v_mfma_f32_16x16x32_bf16 v[132:135], a[20:23], v[216:219], v[132:135]
  s_lshl_b32 s4, s4, 6
  v_add_u32 v114, s4, v114
  s_and_b32 s4, s59, 1
  v_mfma_f32_16x16x32_bf16 v[132:135], a[12:15], v[212:215], v[132:135]
  v_mfma_f32_16x16x32_bf16 v[132:135], a[4:7], v[208:211], v[132:135]
  s_lshl_b32 s4, s4, 5
  v_xor_b32 v115, s4, v112
  v_add_u32 v115, 128, v115
  buffer_load_dwordx4 v[56:59], v5, s[8:11], s18 offen
  v_mfma_f32_16x16x32_bf16 v[132:135], a[36:39], v[224:227], v[132:135]
  ds_read_b128 v[208:211], v4 offset:4096
  ds_read_b128 v[212:215], v4 offset:5120
  v_mfma_f32_16x16x32_bf16 v[132:135], a[44:47], v[228:231], v[132:135]
  v_lshlrev_b32 v22, 1, v21
  v_and_b32 v23, 7, v1
  v_xor_b32 v22, v22, v23
  v_mfma_f32_16x16x32_bf16 v[132:135], a[52:55], v[232:235], v[132:135]
  ds_read_b128 v[216:219], v4 offset:6144
  ds_read_b128 v[220:223], v4 offset:7168
  v_mfma_f32_16x16x32_bf16 v[132:135], a[60:63], v[236:239], v[132:135]
  v_lshlrev_b32 v22, 4, v22
  v_lshrrev_b32 v23, 3, v1
  v_lshl_add_u32 v8, v23, 10, v22
  v_mfma_f32_16x16x32_bf16 v[128:131], a[56:59], v[236:239], v[128:131]
  v_mfma_f32_16x16x32_bf16 v[128:131], a[48:51], v[232:235], v[128:131]
  v_add_u32 v9, 7168, v8
  v_add_u32 v10, 14336, v8
  v_add_u32 v11, 21504, v8
  buffer_load_dwordx4 v[60:63], v5, s[8:11], s19 offen
  v_mfma_f32_16x16x32_bf16 v[128:131], a[40:43], v[228:231], v[128:131]
  v_mfma_f32_16x16x32_bf16 v[128:131], a[32:35], v[224:227], v[128:131]
  v_lshrrev_b32 v22, 2, v1
  v_lshlrev_b32 v23, 7, v22
  v_and_b32 v24, 3, v1
  s_waitcnt lgkmcnt(4)
  v_mfma_f32_16x16x32_bf16 v[144:147], a[64:67], v[192:195], 0
  ds_read_b128 v[224:227], v4 offset:8192
  ds_read_b128 v[228:231], v4 offset:9216
  v_mfma_f32_16x16x32_bf16 v[144:147], a[72:75], v[196:199], v[144:147]
  v_lshl_add_u32 v23, v24, 3, v23
  v_add_u32 v23, s47, v23
  v_bfe_u32 v22, v1, 3, 2
  v_mfma_f32_16x16x32_bf16 v[144:147], a[80:83], v[200:203], v[144:147]
  ds_read_b128 v[232:235], v4 offset:10240
  ds_read_b128 v[236:239], v4 offset:11264
  v_cvt_pk_bf16_f32 v248, v128, v129
  v_cvt_pk_bf16_f32 v249, v130, v131
  v_mfma_f32_16x16x32_bf16 v[144:147], a[88:91], v[204:207], v[144:147]
  v_xor_b32 v24, 0, v22
  v_lshl_add_u32 v12, v24, 5, v23
  v_xor_b32 v24, 1, v22
  v_cvt_pk_bf16_f32 v250, v132, v133
  v_cvt_pk_bf16_f32 v251, v134, v135
  v_mfma_f32_16x16x32_bf16 v[148:151], a[92:95], v[204:207], 0
  s_xor_b32 s52, s70, 98304
  buffer_store_dwordx4 v[248:251], v2, s[20:23], s52 offen offset:2048 sc1
  v_mfma_f32_16x16x32_bf16 v[148:151], a[84:87], v[200:203], v[148:151]
  v_lshl_add_u32 v13, v24, 5, v23
  v_xor_b32 v24, 2, v22
  v_lshl_add_u32 v14, v24, 5, v23
  buffer_load_dwordx4 v[64:67], v7, s[20:23], s60 offen offset:0 sc1
  v_mfma_f32_16x16x32_bf16 v[148:151], a[76:79], v[196:199], v[148:151]
  v_mfma_f32_16x16x32_bf16 v[148:151], a[68:71], v[192:195], v[148:151]
  v_xor_b32 v24, 3, v22
  v_lshl_add_u32 v15, v24, 5, v23
  s_waitcnt lgkmcnt(4)
  v_mfma_f32_16x16x32_bf16 v[148:151], a[100:103], v[208:211], v[148:151]
  ds_read_b128 v[192:195], v4 offset:12288
  ds_read_b128 v[196:199], v4 offset:13312
  v_mfma_f32_16x16x32_bf16 v[148:151], a[108:111], v[212:215], v[148:151]
  v_mfma_f32_16x16x32_bf16 v[148:151], a[116:119], v[216:219], v[148:151]
  ds_read_b128 v[200:203], v4 offset:14336
  ds_read_b128 v[204:207], v4 offset:15360
  v_mfma_f32_16x16x32_bf16 v[148:151], a[124:127], v[220:223], v[148:151]
  buffer_load_dwordx4 v[68:71], v7, s[20:23], s60 offen offset:16 sc1
  v_mfma_f32_16x16x32_bf16 v[144:147], a[120:123], v[220:223], v[144:147]
  v_mfma_f32_16x16x32_bf16 v[144:147], a[112:115], v[216:219], v[144:147]
  v_mfma_f32_16x16x32_bf16 v[144:147], a[104:107], v[212:215], v[144:147]
  v_mfma_f32_16x16x32_bf16 v[144:147], a[96:99], v[208:211], v[144:147]
  s_waitcnt lgkmcnt(4)
  v_mfma_f32_16x16x32_bf16 v[144:147], a[128:131], v[224:227], v[144:147]
  ds_read_b128 v[208:211], v4 offset:16384
  ds_read_b128 v[212:215], v4 offset:17408
  v_mfma_f32_16x16x32_bf16 v[144:147], a[136:139], v[228:231], v[144:147]
  buffer_load_dwordx4 v[72:75], v7, s[20:23], s60 offen offset:2048 sc1
  v_mfma_f32_16x16x32_bf16 v[144:147], a[144:147], v[232:235], v[144:147]
  ds_read_b128 v[216:219], v4 offset:18432
  ds_read_b128 v[220:223], v4 offset:19456
  v_mfma_f32_16x16x32_bf16 v[144:147], a[152:155], v[236:239], v[144:147]
  v_mfma_f32_16x16x32_bf16 v[148:151], a[156:159], v[236:239], v[148:151]
  v_mfma_f32_16x16x32_bf16 v[148:151], a[148:151], v[232:235], v[148:151]
  v_mfma_f32_16x16x32_bf16 v[148:151], a[140:143], v[228:231], v[148:151]
  v_mfma_f32_16x16x32_bf16 v[148:151], a[132:135], v[224:227], v[148:151]
  buffer_load_dwordx4 v[76:79], v7, s[20:23], s60 offen offset:2064 sc1
  s_waitcnt lgkmcnt(4)
  v_mfma_f32_16x16x32_bf16 v[148:151], a[164:167], v[192:195], v[148:151]
  ds_read_b128 v[224:227], v4 offset:20480
  ds_read_b128 v[228:231], v4 offset:21504
  v_mfma_f32_16x16x32_bf16 v[148:151], a[172:175], v[196:199], v[148:151]
  v_mfma_f32_16x16x32_bf16 v[148:151], a[180:183], v[200:203], v[148:151]
  ds_read_b128 v[232:235], v4 offset:22528
  ds_read_b128 v[236:239], v4 offset:23552
  v_mfma_f32_16x16x32_bf16 v[148:151], a[188:191], v[204:207], v[148:151]
  v_mfma_f32_16x16x32_bf16 v[144:147], a[184:187], v[204:207], v[144:147]
  v_mfma_f32_16x16x32_bf16 v[144:147], a[176:179], v[200:203], v[144:147]
  buffer_load_dwordx4 v[80:83], v7, s[20:23], s61 offen offset:0 sc1
  v_mfma_f32_16x16x32_bf16 v[144:147], a[168:171], v[196:199], v[144:147]
  v_mfma_f32_16x16x32_bf16 v[144:147], a[160:163], v[192:195], v[144:147]
  s_waitcnt lgkmcnt(4)
  v_mfma_f32_16x16x32_bf16 v[144:147], a[192:195], v[208:211], v[144:147]
  ds_read_b128 v[192:195], v4 offset:24576
  ds_read_b128 v[196:199], v4 offset:25600
  v_mfma_f32_16x16x32_bf16 v[144:147], a[200:203], v[212:215], v[144:147]
  v_mfma_f32_16x16x32_bf16 v[144:147], a[208:211], v[216:219], v[144:147]
  ds_read_b128 v[200:203], v4 offset:26624
  ds_read_b128 v[204:207], v4 offset:27648
  v_mfma_f32_16x16x32_bf16 v[144:147], a[216:219], v[220:223], v[144:147]
  buffer_load_dwordx4 v[84:87], v7, s[20:23], s61 offen offset:16 sc1
  v_mfma_f32_16x16x32_bf16 v[148:151], a[220:223], v[220:223], v[148:151]
  v_mfma_f32_16x16x32_bf16 v[148:151], a[212:215], v[216:219], v[148:151]
  v_mfma_f32_16x16x32_bf16 v[148:151], a[204:207], v[212:215], v[148:151]
  v_mfma_f32_16x16x32_bf16 v[148:151], a[196:199], v[208:211], v[148:151]
  s_waitcnt lgkmcnt(4)
  v_mfma_f32_16x16x32_bf16 v[148:151], a[228:231], v[224:227], v[148:151]
  ds_read_b128 v[208:211], v4 offset:28672
  ds_read_b128 v[212:215], v4 offset:29696
  v_mfma_f32_16x16x32_bf16 v[148:151], a[236:239], v[228:231], v[148:151]
  s_add_u32 m0, s69, 131072
  s_xor_b32 s51, s17, 0
  buffer_load_dwordx4 v2, s[20:23], s51 offen offset:0 sc1 lds
  v_mfma_f32_16x16x32_bf16 v[148:151], a[244:247], v[232:235], v[148:151]
  ds_read_b128 v[216:219], v4 offset:30720
  ds_read_b128 v[220:223], v4 offset:31744
  v_mfma_f32_16x16x32_bf16 v[148:151], a[252:255], v[236:239], v[148:151]
  v_mfma_f32_16x16x32_bf16 v[144:147], a[248:251], v[236:239], v[144:147]
  v_mfma_f32_16x16x32_bf16 v[144:147], a[240:243], v[232:235], v[144:147]
  v_mfma_f32_16x16x32_bf16 v[144:147], a[232:235], v[228:231], v[144:147]
  v_mfma_f32_16x16x32_bf16 v[144:147], a[224:227], v[224:227], v[144:147]
  buffer_load_dwordx4 v2, s[20:23], s51 offen offset:1024 sc1 lds
  s_waitcnt lgkmcnt(4)
  v_mfma_f32_16x16x32_bf16 v[144:147], a[0:3], v[192:195], v[144:147]
  v_mfma_f32_16x16x32_bf16 v[144:147], a[8:11], v[196:199], v[144:147]
  v_mfma_f32_16x16x32_bf16 v[144:147], a[16:19], v[200:203], v[144:147]
  s_waitcnt vmcnt(19) lgkmcnt(0)
  s_barrier
  v_add_u32 v4, 0xffff0000, v4
  ds_read_b128 v[224:227], v4 offset:0
  ds_read_b128 v[228:231], v4 offset:1024
  v_mfma_f32_16x16x32_bf16 v[144:147], a[24:27], v[204:207], v[144:147]
  ds_read_b128 v[232:235], v4 offset:2048
  ds_read_b128 v[236:239], v4 offset:3072
  v_mfma_f32_16x16x32_bf16 v[148:151], a[28:31], v[204:207], v[148:151]
  v_mfma_f32_16x16x32_bf16 v[148:151], a[20:23], v[200:203], v[148:151]
  buffer_load_dwordx4 v2, s[20:23], s51 offen offset:2048 sc1 lds
  v_mfma_f32_16x16x32_bf16 v[148:151], a[12:15], v[196:199], v[148:151]
  v_mfma_f32_16x16x32_bf16 v[148:151], a[4:7], v[192:195], v[148:151]
  v_mfma_f32_16x16x32_bf16 v[148:151], a[36:39], v[208:211], v[148:151]
  ds_read_b128 v[192:195], v4 offset:4096
  ds_read_b128 v[196:199], v4 offset:5120
  s_add_u32 s53, s70, 0
  buffer_load_dwordx4 v[32:35], v2, s[20:23], s53 offen offset:0 sc1
  v_mfma_f32_16x16x32_bf16 v[148:151], a[44:47], v[212:215], v[148:151]
  buffer_load_dwordx4 v[36:39], v2, s[20:23], s53 offen offset:1024 sc1
  v_mfma_f32_16x16x32_bf16 v[148:151], a[52:55], v[216:219], v[148:151]
  ds_read_b128 v[200:203], v4 offset:6144
  ds_read_b128 v[204:207], v4 offset:7168
  buffer_load_dwordx4 v[40:43], v2, s[20:23], s53 offen offset:2048 sc1
  v_mfma_f32_16x16x32_bf16 v[148:151], a[60:63], v[220:223], v[148:151]
  buffer_load_dwordx4 v2, s[20:23], s51 offen offset:3072 sc1 lds
  v_mfma_f32_16x16x32_bf16 v[144:147], a[56:59], v[220:223], v[144:147]
  v_mfma_f32_16x16x32_bf16 v[144:147], a[48:51], v[216:219], v[144:147]
  v_mfma_f32_16x16x32_bf16 v[144:147], a[40:43], v[212:215], v[144:147]
  v_mfma_f32_16x16x32_bf16 v[144:147], a[32:35], v[208:211], v[144:147]
  s_waitcnt lgkmcnt(4)
  v_mfma_f32_16x16x32_bf16 v[128:131], a[64:67], v[224:227], 0
  ds_read_b128 v[208:211], v4 offset:8192
  ds_read_b128 v[212:215], v4 offset:9216
  v_mfma_f32_16x16x32_bf16 v[128:131], a[72:75], v[228:231], v[128:131]
  s_add_u32 m0, s69, 147456
  s_xor_b32 s51, s17, 16384
  buffer_load_dwordx4 v2, s[20:23], s51 offen offset:0 sc1 lds
  v_mfma_f32_16x16x32_bf16 v[128:131], a[80:83], v[232:235], v[128:131]
  ds_read_b128 v[216:219], v4 offset:10240
  ds_read_b128 v[220:223], v4 offset:11264
  v_mfma_f32_16x16x32_bf16 v[128:131], a[88:91], v[236:239], v[128:131]
  v_mfma_f32_16x16x32_bf16 v[132:135], a[92:95], v[236:239], 0
  v_mfma_f32_16x16x32_bf16 v[132:135], a[84:87], v[232:235], v[132:135]
  v_mfma_f32_16x16x32_bf16 v[132:135], a[76:79], v[228:231], v[132:135]
  v_mfma_f32_16x16x32_bf16 v[132:135], a[68:71], v[224:227], v[132:135]
  buffer_load_dwordx4 v2, s[20:23], s51 offen offset:1024 sc1 lds
  s_waitcnt lgkmcnt(4)
  v_mfma_f32_16x16x32_bf16 v[132:135], a[100:103], v[192:195], v[132:135]
  ds_read_b128 v[224:227], v4 offset:12288
  ds_read_b128 v[228:231], v4 offset:13312
  v_mfma_f32_16x16x32_bf16 v[132:135], a[108:111], v[196:199], v[132:135]
  v_mfma_f32_16x16x32_bf16 v[132:135], a[116:119], v[200:203], v[132:135]
  ds_read_b128 v[232:235], v4 offset:14336
  ds_read_b128 v[236:239], v4 offset:15360
  v_mfma_f32_16x16x32_bf16 v[132:135], a[124:127], v[204:207], v[132:135]
  v_mfma_f32_16x16x32_bf16 v[128:131], a[120:123], v[204:207], v[128:131]
  v_mfma_f32_16x16x32_bf16 v[128:131], a[112:115], v[200:203], v[128:131]
  buffer_load_dwordx4 v2, s[20:23], s51 offen offset:2048 sc1 lds
  v_mfma_f32_16x16x32_bf16 v[128:131], a[104:107], v[196:199], v[128:131]
  v_mfma_f32_16x16x32_bf16 v[128:131], a[96:99], v[192:195], v[128:131]
  s_waitcnt lgkmcnt(4)
  v_mfma_f32_16x16x32_bf16 v[128:131], a[128:131], v[208:211], v[128:131]
  ds_read_b128 v[192:195], v4 offset:16384
  ds_read_b128 v[196:199], v4 offset:17408
  v_mfma_f32_16x16x32_bf16 v[128:131], a[136:139], v[212:215], v[128:131]
  v_mfma_f32_16x16x32_bf16 v[128:131], a[144:147], v[216:219], v[128:131]
  ds_read_b128 v[200:203], v4 offset:18432
  ds_read_b128 v[204:207], v4 offset:19456
  v_mfma_f32_16x16x32_bf16 v[128:131], a[152:155], v[220:223], v[128:131]
  buffer_load_dwordx4 v2, s[20:23], s51 offen offset:3072 sc1 lds
  v_mfma_f32_16x16x32_bf16 v[132:135], a[156:159], v[220:223], v[132:135]
  v_mfma_f32_16x16x32_bf16 v[132:135], a[148:151], v[216:219], v[132:135]
  v_mfma_f32_16x16x32_bf16 v[132:135], a[140:143], v[212:215], v[132:135]
  v_mfma_f32_16x16x32_bf16 v[132:135], a[132:135], v[208:211], v[132:135]
  s_waitcnt lgkmcnt(4)
  v_mfma_f32_16x16x32_bf16 v[132:135], a[164:167], v[224:227], v[132:135]
  ds_read_b128 v[208:211], v4 offset:20480
  ds_read_b128 v[212:215], v4 offset:21504
  v_mfma_f32_16x16x32_bf16 v[132:135], a[172:175], v[228:231], v[132:135]
  s_add_u32 m0, s69, 98304
  s_xor_b32 s51, s17, 393216
  buffer_load_dwordx4 v2, s[20:23], s51 offen offset:0 sc1 lds
  v_mfma_f32_16x16x32_bf16 v[132:135], a[180:183], v[232:235], v[132:135]
  ds_read_b128 v[216:219], v4 offset:22528
  ds_read_b128 v[220:223], v4 offset:23552
  v_mfma_f32_16x16x32_bf16 v[132:135], a[188:191], v[236:239], v[132:135]
  v_mfma_f32_16x16x32_bf16 v[128:131], a[184:187], v[236:239], v[128:131]
  v_mfma_f32_16x16x32_bf16 v[128:131], a[176:179], v[232:235], v[128:131]
  v_mfma_f32_16x16x32_bf16 v[128:131], a[168:171], v[228:231], v[128:131]
  v_mfma_f32_16x16x32_bf16 v[128:131], a[160:163], v[224:227], v[128:131]
  buffer_load_dwordx4 v2, s[20:23], s51 offen offset:1024 sc1 lds
  s_waitcnt lgkmcnt(4)
  v_mfma_f32_16x16x32_bf16 v[128:131], a[192:195], v[192:195], v[128:131]
  ds_read_b128 v[224:227], v4 offset:24576
  ds_read_b128 v[228:231], v4 offset:25600
  v_mfma_f32_16x16x32_bf16 v[128:131], a[200:203], v[196:199], v[128:131]
  s_waitcnt vmcnt(7)
  v_max3_u32 v22, v32, v33, v34
  v_max3_u32 v22, v22, v35, v36
  v_mfma_f32_16x16x32_bf16 v[128:131], a[208:211], v[200:203], v[128:131]
  ds_read_b128 v[232:235], v4 offset:26624
  ds_read_b128 v[236:239], v4 offset:27648
  v_max3_u32 v22, v22, v37, v38
  v_max3_u32 v22, v22, v39, v40
  v_max3_u32 v22, v22, v41, v42
  v_mfma_f32_16x16x32_bf16 v[128:131], a[216:219], v[204:207], v[128:131]
  v_max_u32 v22, v22, v43
  v_cmp_eq_u32 vcc, -1, v22
  s_cbranch_vccz Lpxo145
  s_mov_b32 s5, 0
Lpxr144:
  s_sleep 2
  s_add_u32 s53, s70, 0
  buffer_load_dwordx4 v[32:35], v2, s[20:23], s53 offen offset:0 sc1
  buffer_load_dwordx4 v[36:39], v2, s[20:23], s53 offen offset:1024 sc1
  buffer_load_dwordx4 v[40:43], v2, s[20:23], s53 offen offset:2048 sc1
  s_add_u32 s5, s5, 1
  s_waitcnt vmcnt(0)
  v_max3_u32 v22, v32, v33, v34
  v_max3_u32 v22, v22, v35, v36
  v_max3_u32 v22, v22, v37, v38
  v_max3_u32 v22, v22, v39, v40
  v_max3_u32 v22, v22, v41, v42
  v_max_u32 v22, v22, v43
  v_cmp_eq_u32 vcc, -1, v22
  s_cbranch_vccz Lpxo145
  s_cmp_lt_u32 s5, 0x4000
  s_cbranch_scc1 Lpxr144
Lpxo145:
  v_lshlrev_b32 v160, 16, v56
  v_mfma_f32_16x16x32_bf16 v[132:135], a[220:223], v[204:207], v[132:135]
  v_mfma_f32_16x16x32_bf16 v[132:135], a[212:215], v[200:203], v[132:135]
  buffer_load_dwordx4 v2, s[20:23], s51 offen offset:2048 sc1 lds
  v_and_b32 v161, 0xffff0000, v56
  v_lshlrev_b32 v162, 16, v57
  v_and_b32 v163, 0xffff0000, v57
  v_mfma_f32_16x16x32_bf16 v[132:135], a[204:207], v[196:199], v[132:135]
  v_lshlrev_b32 v164, 16, v58
  v_and_b32 v165, 0xffff0000, v58
  v_lshlrev_b32 v166, 16, v59
  v_mfma_f32_16x16x32_bf16 v[132:135], a[196:199], v[192:195], v[132:135]
  v_and_b32 v167, 0xffff0000, v59
  v_lshlrev_b32 v168, 16, v32
  v_and_b32 v169, 0xffff0000, v32
  s_waitcnt lgkmcnt(4)
  v_mfma_f32_16x16x32_bf16 v[132:135], a[228:231], v[208:211], v[132:135]
  ds_read_b128 v[192:195], v4 offset:28672
  ds_read_b128 v[196:199], v4 offset:29696
  v_mfma_f32_16x16x32_bf16 v[132:135], a[236:239], v[212:215], v[132:135]
  v_lshlrev_b32 v170, 16, v33
  v_and_b32 v171, 0xffff0000, v33
  v_lshlrev_b32 v172, 16, v34
  v_mfma_f32_16x16x32_bf16 v[132:135], a[244:247], v[216:219], v[132:135]
  ds_read_b128 v[200:203], v4 offset:30720
  ds_read_b128 v[204:207], v4 offset:31744
  v_and_b32 v173, 0xffff0000, v34
  v_lshlrev_b32 v174, 16, v35
  v_and_b32 v175, 0xffff0000, v35
  v_mfma_f32_16x16x32_bf16 v[132:135], a[252:255], v[220:223], v[132:135]
  buffer_load_dwordx4 v2, s[20:23], s51 offen offset:3072 sc1 lds
  v_add_f32 v144, v144, v168
  v_add_f32 v145, v145, v169
  v_add_f32 v146, v146, v170
  v_mfma_f32_16x16x32_bf16 v[128:131], a[248:251], v[220:223], v[128:131]
  v_mfma_f32_16x16x32_bf16 v[128:131], a[240:243], v[216:219], v[128:131]
  v_add_f32 v147, v147, v171
  v_add_f32 v148, v148, v172
  v_add_f32 v149, v149, v173
  v_mfma_f32_16x16x32_bf16 v[128:131], a[232:235], v[212:215], v[128:131]
  v_add_f32 v150, v150, v174
  v_add_f32 v151, v151, v175
  v_lshlrev_b32 v168, 16, v36
  v_mfma_f32_16x16x32_bf16 v[128:131], a[224:227], v[208:211], v[128:131]
  v_and_b32 v169, 0xffff0000, v36
  v_lshlrev_b32 v170, 16, v37
  v_and_b32 v171, 0xffff0000, v37
  s_waitcnt lgkmcnt(4)
  v_mfma_f32_16x16x32_bf16 v[128:131], a[0:3], v[224:227], v[128:131]
  v_mfma_f32_16x16x32_bf16 v[128:131], a[8:11], v[228:231], v[128:131]
  s_add_u32 m0, s69, 114688
  s_xor_b32 s51, s17, 409600
  buffer_load_dwordx4 v2, s[20:23], s51 offen offset:0 sc1 lds
  v_lshlrev_b32 v172, 16, v38
  v_and_b32 v173, 0xffff0000, v38
  v_lshlrev_b32 v174, 16, v39
  v_mfma_f32_16x16x32_bf16 v[128:131], a[16:19], v[232:235], v[128:131]
  s_waitcnt lgkmcnt(0)
  s_barrier
  ds_read_b128 v[208:211], v4 offset:32768
  ds_read_b128 v[212:215], v4 offset:33792
  v_and_b32 v175, 0xffff0000, v39
  v_add_f32 v144, v144, v168
  v_add_f32 v145, v145, v169
  v_mfma_f32_16x16x32_bf16 v[128:131], a[24:27], v[236:239], v[128:131]
  ds_read_b128 v[216:219], v4 offset:34816
  ds_read_b128 v[220:223], v4 offset:35840
  v_add_f32 v146, v146, v170
  v_add_f32 v147, v147, v171
  v_add_f32 v148, v148, v172
  v_mfma_f32_16x16x32_bf16 v[132:135], a[28:31], v[236:239], v[132:135]
  v_mfma_f32_16x16x32_bf16 v[132:135], a[20:23], v[232:235], v[132:135]
  v_add_f32 v149, v149, v173
  v_add_f32 v150, v150, v174
  v_add_f32 v151, v151, v175
  v_mfma_f32_16x16x32_bf16 v[132:135], a[12:15], v[228:231], v[132:135]
  v_lshlrev_b32 v168, 16, v40
  v_and_b32 v169, 0xffff0000, v40
  v_lshlrev_b32 v170, 16, v41
  v_mfma_f32_16x16x32_bf16 v[132:135], a[4:7], v[224:227], v[132:135]
  buffer_load_dwordx4 v2, s[20:23], s51 offen offset:1024 sc1 lds
  v_and_b32 v171, 0xffff0000, v41
  v_lshlrev_b32 v172, 16, v42
  v_and_b32 v173, 0xffff0000, v42
  v_mfma_f32_16x16x32_bf16 v[132:135], a[36:39], v[192:195], v[132:135]
  ds_read_b128 v[224:227], v4 offset:36864
  ds_read_b128 v[228:231], v4 offset:37888
  v_mfma_f32_16x16x32_bf16 v[132:135], a[44:47], v[196:199], v[132:135]
  v_lshlrev_b32 v174, 16, v43
  v_and_b32 v175, 0xffff0000, v43
  v_add_f32 v144, v144, v168
  v_mfma_f32_16x16x32_bf16 v[132:135], a[52:55], v[200:203], v[132:135]
  ds_read_b128 v[232:235], v4 offset:38912
  ds_read_b128 v[236:239], v4 offset:39936
  v_add_f32 v145, v145, v169
  v_add_f32 v146, v146, v170
  v_add_f32 v147, v147, v171
  v_mfma_f32_16x16x32_bf16 v[132:135], a[60:63], v[204:207], v[132:135]
  v_add_f32 v148, v148, v172
  v_add_f32 v149, v149, v173
  v_add_f32 v150, v150, v174
  v_mfma_f32_16x16x32_bf16 v[128:131], a[56:59], v[204:207], v[128:131]
  v_mfma_f32_16x16x32_bf16 v[128:131], a[48:51], v[200:203], v[128:131]
  buffer_load_dwordx4 v2, s[20:23], s51 offen offset:2048 sc1 lds
  v_add_f32 v151, v151, v175
  v_fma_f32 v160, v144, v64, v160
  v_fma_f32 v161, v145, v65, v161
  v_mfma_f32_16x16x32_bf16 v[128:131], a[40:43], v[196:199], v[128:131]
  v_fma_f32 v162, v146, v66, v162
  v_fma_f32 v163, v147, v67, v163
  v_fma_f32 v164, v148, v68, v164
  v_mfma_f32_16x16x32_bf16 v[128:131], a[32:35], v[192:195], v[128:131]
  v_fma_f32 v165, v149, v69, v165
  v_fma_f32 v166, v150, v70, v166
  v_fma_f32 v167, v151, v71, v167
  s_waitcnt lgkmcnt(4)
  v_mfma_f32_16x16x32_bf16 v[136:139], a[64:67], v[208:211], 0
  ds_read_b128 v[192:195], v4 offset:40960
  ds_read_b128 v[196:199], v4 offset:41984
  v_mfma_f32_16x16x32_bf16 v[136:139], a[72:75], v[212:215], v[136:139]
  v_cvt_pk_bf16_f32 v56, v160, v161
  v_cvt_pk_bf16_f32 v57, v162, v163
  v_cvt_pk_bf16_f32 v58, v164, v165
  v_mfma_f32_16x16x32_bf16 v[136:139], a[80:83], v[216:219], v[136:139]
  ds_read_b128 v[200:203], v4 offset:43008
  ds_read_b128 v[204:207], v4 offset:44032
  v_cvt_pk_bf16_f32 v248, v128, v129
  v_cvt_pk_bf16_f32 v249, v130, v131
  v_cvt_pk_bf16_f32 v59, v166, v167
  v_lshlrev_b32 v160, 16, v56
  v_and_b32 v161, 0xffff0000, v56
  v_mfma_f32_16x16x32_bf16 v[136:139], a[88:91], v[220:223], v[136:139]
  v_cvt_pk_bf16_f32 v250, v132, v133
  v_cvt_pk_bf16_f32 v251, v134, v135
  v_lshlrev_b32 v162, 16, v57
  v_and_b32 v163, 0xffff0000, v57
  v_lshlrev_b32 v164, 16, v58
  v_mfma_f32_16x16x32_bf16 v[140:143], a[92:95], v[220:223], 0
  s_xor_b32 s52, s70, 32768
  buffer_store_dwordx4 v[248:251], v2, s[20:23], s52 offen offset:3072 sc1
  v_mfma_f32_16x16x32_bf16 v[140:143], a[84:87], v[216:219], v[140:143]
  buffer_load_dwordx4 v2, s[20:23], s51 offen offset:3072 sc1 lds
  v_and_b32 v165, 0xffff0000, v58
  v_lshlrev_b32 v166, 16, v59
  v_and_b32 v167, 0xffff0000, v59
  v_mfma_f32_16x16x32_bf16 v[140:143], a[76:79], v[212:215], v[140:143]
  v_mul_f32 v176, v160, v80
  v_mul_f32 v177, v161, v81
  v_mul_f32 v178, v162, v82
  v_mfma_f32_16x16x32_bf16 v[140:143], a[68:71], v[208:211], v[140:143]
  v_mul_f32 v179, v163, v83
  v_mul_f32 v180, v164, v84
  v_mul_f32 v181, v165, v85
  s_waitcnt lgkmcnt(4)
  v_mfma_f32_16x16x32_bf16 v[140:143], a[100:103], v[224:227], v[140:143]
  ds_read_b128 v[208:211], v4 offset:45056
  ds_read_b128 v[212:215], v4 offset:46080
  v_mfma_f32_16x16x32_bf16 v[140:143], a[108:111], v[228:231], v[140:143]
  v_mul_f32 v182, v166, v86
  v_mul_f32 v183, v167, v87
  v_cvt_pk_bf16_f32 v240, v176, v177
  v_mfma_f32_16x16x32_bf16 v[140:143], a[116:119], v[232:235], v[140:143]
  ds_read_b128 v[216:219], v4 offset:47104
  ds_read_b128 v[220:223], v4 offset:48128
  v_cvt_pk_bf16_f32 v241, v178, v179
  v_cvt_pk_bf16_f32 v242, v180, v181
  v_cvt_pk_bf16_f32 v243, v182, v183
  v_mfma_f32_16x16x32_bf16 v[140:143], a[124:127], v[236:239], v[140:143]
  s_add_u32 m0, s63, 0
  s_add_u32 s3, s62, 0
  buffer_load_dwordx4 v92, s[24:27], s3 offen offset:0 lds
  buffer_store_dwordx4 v[240:243], v2, s[20:23], s38 offen sc1
  buffer_store_dwordx4 v[56:59], v5, s[20:23], s39 offen sc1
  v_add_f32 v184, v160, v161
  v_mfma_f32_16x16x32_bf16 v[136:139], a[120:123], v[236:239], v[136:139]
  v_mfma_f32_16x16x32_bf16 v[136:139], a[112:115], v[232:235], v[136:139]
  v_mul_f32 v185, v160, v160
  v_add_f32 v186, v176, v177
  v_mul_f32 v188, v176, v176
  v_mfma_f32_16x16x32_bf16 v[136:139], a[104:107], v[228:231], v[136:139]
  v_mul_f32 v189, v176, v80
  v_mul_f32 v190, v176, v72
  v_fmac_f32 v185, v161, v161
  v_mfma_f32_16x16x32_bf16 v[136:139], a[96:99], v[224:227], v[136:139]
  v_fmac_f32 v188, v177, v177
  v_fmac_f32 v189, v177, v81
  v_fmac_f32 v190, v177, v73
  s_waitcnt lgkmcnt(4)
  v_mfma_f32_16x16x32_bf16 v[136:139], a[128:131], v[192:195], v[136:139]
  ds_read_b128 v[224:227], v4 offset:49152
  ds_read_b128 v[228:231], v4 offset:50176
  v_mfma_f32_16x16x32_bf16 v[136:139], a[136:139], v[196:199], v[136:139]
  buffer_load_dwordx4 v93, s[24:27], s3 offen offset:1024 lds
  v_add_f32 v184, v184, v162
  v_fmac_f32 v185, v162, v162
  v_add_f32 v186, v186, v178
  v_mfma_f32_16x16x32_bf16 v[136:139], a[144:147], v[200:203], v[136:139]
  ds_read_b128 v[232:235], v4 offset:51200
  ds_read_b128 v[236:239], v4 offset:52224
  v_fmac_f32 v188, v178, v178
  v_fmac_f32 v189, v178, v82
  v_fmac_f32 v190, v178, v74
  v_mfma_f32_16x16x32_bf16 v[136:139], a[152:155], v[204:207], v[136:139]
  v_add_f32 v184, v184, v163
  v_fmac_f32 v185, v163, v163
  v_add_f32 v186, v186, v179
  v_mfma_f32_16x16x32_bf16 v[140:143], a[156:159], v[204:207], v[140:143]
  v_mfma_f32_16x16x32_bf16 v[140:143], a[148:151], v[200:203], v[140:143]
  v_fmac_f32 v188, v179, v179
  v_fmac_f32 v189, v179, v83
  v_fmac_f32 v190, v179, v75
  v_mfma_f32_16x16x32_bf16 v[140:143], a[140:143], v[196:199], v[140:143]
  v_add_f32 v184, v184, v164
  v_fmac_f32 v185, v164, v164
  v_add_f32 v186, v186, v180
  v_mfma_f32_16x16x32_bf16 v[140:143], a[132:135], v[192:195], v[140:143]
  buffer_load_dwordx4 v94, s[24:27], s3 offen offset:2048 lds
  v_fmac_f32 v188, v180, v180
  v_fmac_f32 v189, v180, v84
  v_fmac_f32 v190, v180, v76
  s_waitcnt lgkmcnt(4)
  v_mfma_f32_16x16x32_bf16 v[140:143], a[164:167], v[208:211], v[140:143]
  ds_read_b128 v[192:195], v4 offset:53248
  ds_read_b128 v[196:199], v4 offset:54272
  v_mfma_f32_16x16x32_bf16 v[140:143], a[172:175], v[212:215], v[140:143]
  v_add_f32 v184, v184, v165
  v_fmac_f32 v185, v165, v165
  v_add_f32 v186, v186, v181
  v_mfma_f32_16x16x32_bf16 v[140:143], a[180:183], v[216:219], v[140:143]
  ds_read_b128 v[200:203], v4 offset:55296
  ds_read_b128 v[204:207], v4 offset:56320
  v_fmac_f32 v188, v181, v181
  v_fmac_f32 v189, v181, v85
  v_fmac_f32 v190, v181, v77
  v_mfma_f32_16x16x32_bf16 v[140:143], a[188:191], v[220:223], v[140:143]
  v_add_f32 v184, v184, v166
  v_fmac_f32 v185, v166, v166
  v_add_f32 v186, v186, v182
  v_mfma_f32_16x16x32_bf16 v[136:139], a[184:187], v[220:223], v[136:139]
  v_mfma_f32_16x16x32_bf16 v[136:139], a[176:179], v[216:219], v[136:139]
  s_add_u32 m0, s63, 12288
  s_add_u32 s3, s62, 176128
  buffer_load_dwordx4 v92, s[24:27], s3 offen offset:0 lds
  v_fmac_f32 v188, v182, v182
  v_fmac_f32 v189, v182, v86
  v_fmac_f32 v190, v182, v78
  v_mfma_f32_16x16x32_bf16 v[136:139], a[168:171], v[212:215], v[136:139]
  v_add_f32 v184, v184, v167
  v_fmac_f32 v185, v167, v167
  v_add_f32 v186, v186, v183
  v_mfma_f32_16x16x32_bf16 v[136:139], a[160:163], v[208:211], v[136:139]
  v_fmac_f32 v188, v183, v183
  v_fmac_f32 v189, v183, v87
  v_fmac_f32 v190, v183, v79
  s_waitcnt lgkmcnt(4)
  v_mfma_f32_16x16x32_bf16 v[136:139], a[192:195], v[224:227], v[136:139]
  ds_read_b128 v[208:211], v4 offset:57344
  ds_read_b128 v[212:215], v4 offset:58368
  v_mfma_f32_16x16x32_bf16 v[136:139], a[200:203], v[228:231], v[136:139]
  s_mul_i32 s32, s40, 512
  s_add_u32 s32, s32, 24576
  v_add_u32 v22, s32, v2
  v_mfma_f32_16x16x32_bf16 v[136:139], a[208:211], v[232:235], v[136:139]
  ds_read_b128 v[216:219], v4 offset:59392
  ds_read_b128 v[220:223], v4 offset:60416
  v_permlane16_swap_b32 v184, v188
  v_permlane16_swap_b32 v185, v189
  v_permlane16_swap_b32 v186, v190
  v_mfma_f32_16x16x32_bf16 v[136:139], a[216:219], v[236:239], v[136:139]
  buffer_load_dwordx4 v93, s[24:27], s3 offen offset:1024 lds
  v_add_f32 v184, v184, v188
  v_add_f32 v185, v185, v189
  v_add_f32 v186, v186, v190
  v_mfma_f32_16x16x32_bf16 v[140:143], a[220:223], v[236:239], v[140:143]
  v_mfma_f32_16x16x32_bf16 v[140:143], a[212:215], v[232:235], v[140:143]
  v_mov_b32 v188, v184
  v_mov_b32 v189, v185
  v_mov_b32 v190, v186
  v_mfma_f32_16x16x32_bf16 v[140:143], a[204:207], v[228:231], v[140:143]
  v_add_u32 v23, 24576, v2
  v_mov_b32 v187, 0
  v_permlane32_swap_b32 v184, v188
  v_mfma_f32_16x16x32_bf16 v[140:143], a[196:199], v[224:227], v[140:143]
  v_permlane32_swap_b32 v185, v189
  v_permlane32_swap_b32 v186, v190
  v_add_f32 v184, v184, v188
  s_waitcnt lgkmcnt(4)
  v_mfma_f32_16x16x32_bf16 v[140:143], a[228:231], v[192:195], v[140:143]
  ds_read_b128 v[224:227], v4 offset:61440
  ds_read_b128 v[228:231], v4 offset:62464
  v_mfma_f32_16x16x32_bf16 v[140:143], a[236:239], v[196:199], v[140:143]
  buffer_load_dwordx4 v94, s[24:27], s3 offen offset:2048 lds
  v_add_f32 v185, v185, v189
  v_add_f32 v186, v186, v190
  s_mov_b32 exec_hi, 0
  ds_write_b128 v22, v[184:187]
  s_mov_b32 exec_hi, -1
  v_mfma_f32_16x16x32_bf16 v[140:143], a[244:247], v[200:203], v[140:143]
  ds_read_b128 v[232:235], v4 offset:63488
  ds_read_b128 v[236:239], v4 offset:64512
  v_mfma_f32_16x16x32_bf16 v[140:143], a[252:255], v[204:207], v[140:143]
  v_mfma_f32_16x16x32_bf16 v[136:139], a[248:251], v[204:207], v[136:139]
  v_mfma_f32_16x16x32_bf16 v[136:139], a[240:243], v[200:203], v[136:139]
  v_mfma_f32_16x16x32_bf16 v[136:139], a[232:235], v[196:199], v[136:139]
  v_mfma_f32_16x16x32_bf16 v[136:139], a[224:227], v[192:195], v[136:139]
  s_add_u32 m0, s63, 36864
  s_add_u32 s3, s62, 528384
  buffer_load_dwordx4 v92, s[24:27], s3 offen offset:0 lds
  s_waitcnt lgkmcnt(5)
  v_mfma_f32_16x16x32_bf16 v[136:139], a[0:3], v[208:211], v[136:139]
  v_mfma_f32_16x16x32_bf16 v[136:139], a[8:11], v[212:215], v[136:139]
  v_mfma_f32_16x16x32_bf16 v[136:139], a[16:19], v[216:219], v[136:139]
  s_waitcnt vmcnt(9) lgkmcnt(0)
  s_barrier
  s_cmp_lg_u32 s40, 0
  s_cbranch_scc1 Lst146
  ds_read_b128 v[164:167], v23 offset:512
  ds_read_b128 v[168:171], v23 offset:1024
  ds_read_b128 v[172:175], v23 offset:1536
  s_waitcnt lgkmcnt(0)
  v_add_f32 v184, v184, v164
  v_add_f32 v168, v168, v172
  v_add_f32 v185, v185, v165
  v_add_f32 v169, v169, v173
  v_add_f32 v186, v186, v166
  v_add_f32 v170, v170, v174
  v_add_f32 v184, v184, v168
  v_add_f32 v185, v185, v169
  v_add_f32 v186, v186, v170
  s_mov_b32 exec_hi, 0
  buffer_store_dwordx4 v[184:187], v2, s[20:23], s68 offen sc1
  s_mov_b32 exec_hi, -1
Lst146:
  v_add_u32 v4, 0x10000, v4
  ds_read_b128 v[192:195], v4 offset:0
  ds_read_b128 v[196:199], v4 offset:1024
  v_mfma_f32_16x16x32_bf16 v[136:139], a[24:27], v[220:223], v[136:139]
  ds_read_b128 v[200:203], v4 offset:2048
  ds_read_b128 v[204:207], v4 offset:3072
  v_mfma_f32_16x16x32_bf16 v[140:143], a[28:31], v[220:223], v[140:143]
  v_mfma_f32_16x16x32_bf16 v[140:143], a[20:23], v[216:219], v[140:143]
  buffer_load_dwordx4 v93, s[24:27], s3 offen offset:1024 lds
  v_mfma_f32_16x16x32_bf16 v[140:143], a[12:15], v[212:215], v[140:143]
  v_mfma_f32_16x16x32_bf16 v[140:143], a[4:7], v[208:211], v[140:143]
  v_mfma_f32_16x16x32_bf16 v[140:143], a[36:39], v[224:227], v[140:143]
  ds_read_b128 v[208:211], v4 offset:4096
  ds_read_b128 v[212:215], v4 offset:5120
  v_mfma_f32_16x16x32_bf16 v[140:143], a[44:47], v[228:231], v[140:143]
  v_mfma_f32_16x16x32_bf16 v[140:143], a[52:55], v[232:235], v[140:143]
  ds_read_b128 v[216:219], v4 offset:6144
  ds_read_b128 v[220:223], v4 offset:7168
  v_mfma_f32_16x16x32_bf16 v[140:143], a[60:63], v[236:239], v[140:143]
  buffer_load_dwordx4 v94, s[24:27], s3 offen offset:2048 lds
  v_mfma_f32_16x16x32_bf16 v[136:139], a[56:59], v[236:239], v[136:139]
  v_mfma_f32_16x16x32_bf16 v[136:139], a[48:51], v[232:235], v[136:139]
  v_mfma_f32_16x16x32_bf16 v[136:139], a[40:43], v[228:231], v[136:139]
  v_mfma_f32_16x16x32_bf16 v[136:139], a[32:35], v[224:227], v[136:139]
  s_waitcnt lgkmcnt(4)
  v_mfma_f32_16x16x32_bf16 v[128:131], a[64:67], v[192:195], 0
  ds_read_b128 v[224:227], v4 offset:8192
  ds_read_b128 v[228:231], v4 offset:9216
  v_mfma_f32_16x16x32_bf16 v[128:131], a[72:75], v[196:199], v[128:131]
  v_mfma_f32_16x16x32_bf16 v[128:131], a[80:83], v[200:203], v[128:131]
  ds_read_b128 v[232:235], v4 offset:10240
  ds_read_b128 v[236:239], v4 offset:11264
  v_cvt_pk_bf16_f32 v248, v136, v137
  v_cvt_pk_bf16_f32 v249, v138, v139
  v_mfma_f32_16x16x32_bf16 v[128:131], a[88:91], v[204:207], v[128:131]
  v_cvt_pk_bf16_f32 v250, v140, v141
  v_cvt_pk_bf16_f32 v251, v142, v143
  v_mfma_f32_16x16x32_bf16 v[132:135], a[92:95], v[204:207], 0
  s_xor_b32 s52, s70, 69632
  buffer_store_dwordx4 v[248:251], v2, s[20:23], s52 offen offset:0 sc1
  v_mfma_f32_16x16x32_bf16 v[132:135], a[84:87], v[200:203], v[132:135]
  s_add_u32 m0, s63, 49152
  s_add_u32 s3, s62, 704512
  buffer_load_dwordx4 v92, s[24:27], s3 offen offset:0 lds
  v_mfma_f32_16x16x32_bf16 v[132:135], a[76:79], v[196:199], v[132:135]
  v_mfma_f32_16x16x32_bf16 v[132:135], a[68:71], v[192:195], v[132:135]
  s_waitcnt lgkmcnt(4)
  v_mfma_f32_16x16x32_bf16 v[132:135], a[100:103], v[208:211], v[132:135]
  ds_read_b128 v[192:195], v4 offset:12288
  ds_read_b128 v[196:199], v4 offset:13312
  v_mfma_f32_16x16x32_bf16 v[132:135], a[108:111], v[212:215], v[132:135]
  v_mfma_f32_16x16x32_bf16 v[132:135], a[116:119], v[216:219], v[132:135]
  ds_read_b128 v[200:203], v4 offset:14336
  ds_read_b128 v[204:207], v4 offset:15360
  v_mfma_f32_16x16x32_bf16 v[132:135], a[124:127], v[220:223], v[132:135]
  buffer_load_dwordx4 v93, s[24:27], s3 offen offset:1024 lds
  v_mfma_f32_16x16x32_bf16 v[128:131], a[120:123], v[220:223], v[128:131]
  v_mfma_f32_16x16x32_bf16 v[128:131], a[112:115], v[216:219], v[128:131]
  v_mfma_f32_16x16x32_bf16 v[128:131], a[104:107], v[212:215], v[128:131]
  v_mfma_f32_16x16x32_bf16 v[128:131], a[96:99], v[208:211], v[128:131]
  s_waitcnt lgkmcnt(4)
  v_mfma_f32_16x16x32_bf16 v[128:131], a[128:131], v[224:227], v[128:131]
  ds_read_b128 v[208:211], v4 offset:16384
  ds_read_b128 v[212:215], v4 offset:17408
  v_mfma_f32_16x16x32_bf16 v[128:131], a[136:139], v[228:231], v[128:131]
  buffer_load_dwordx4 v94, s[24:27], s3 offen offset:2048 lds
  v_mfma_f32_16x16x32_bf16 v[128:131], a[144:147], v[232:235], v[128:131]
  ds_read_b128 v[216:219], v4 offset:18432
  ds_read_b128 v[220:223], v4 offset:19456
  v_mfma_f32_16x16x32_bf16 v[128:131], a[152:155], v[236:239], v[128:131]
  v_mfma_f32_16x16x32_bf16 v[132:135], a[156:159], v[236:239], v[132:135]
  v_mfma_f32_16x16x32_bf16 v[132:135], a[148:151], v[232:235], v[132:135]
  v_mfma_f32_16x16x32_bf16 v[132:135], a[140:143], v[228:231], v[132:135]
  v_mfma_f32_16x16x32_bf16 v[132:135], a[132:135], v[224:227], v[132:135]
  s_add_u32 m0, s63, 24576
  s_add_u32 s3, s62, 352256
  buffer_load_dwordx4 v92, s[24:27], s3 offen offset:0 lds
  s_waitcnt lgkmcnt(4)
  v_mfma_f32_16x16x32_bf16 v[132:135], a[164:167], v[192:195], v[132:135]
  ds_read_b128 v[224:227], v4 offset:20480
  ds_read_b128 v[228:231], v4 offset:21504
  v_mfma_f32_16x16x32_bf16 v[132:135], a[172:175], v[196:199], v[132:135]
  v_mfma_f32_16x16x32_bf16 v[132:135], a[180:183], v[200:203], v[132:135]
  ds_read_b128 v[232:235], v4 offset:22528
  ds_read_b128 v[236:239], v4 offset:23552
  v_mfma_f32_16x16x32_bf16 v[132:135], a[188:191], v[204:207], v[132:135]
  v_mfma_f32_16x16x32_bf16 v[128:131], a[184:187], v[204:207], v[128:131]
  v_mfma_f32_16x16x32_bf16 v[128:131], a[176:179], v[200:203], v[128:131]
  buffer_load_dwordx4 v93, s[24:27], s3 offen offset:1024 lds
  v_mfma_f32_16x16x32_bf16 v[128:131], a[168:171], v[196:199], v[128:131]
  v_mfma_f32_16x16x32_bf16 v[128:131], a[160:163], v[192:195], v[128:131]
  s_waitcnt lgkmcnt(4)
  v_mfma_f32_16x16x32_bf16 v[128:131], a[192:195], v[208:211], v[128:131]
  ds_read_b128 v[192:195], v4 offset:24576
  ds_read_b128 v[196:199], v4 offset:25600
  v_mfma_f32_16x16x32_bf16 v[128:131], a[200:203], v[212:215], v[128:131]
  v_mfma_f32_16x16x32_bf16 v[128:131], a[208:211], v[216:219], v[128:131]
  ds_read_b128 v[200:203], v4 offset:26624
  ds_read_b128 v[204:207], v4 offset:27648
  v_mfma_f32_16x16x32_bf16 v[128:131], a[216:219], v[220:223], v[128:131]
  buffer_load_dwordx4 v94, s[24:27], s3 offen offset:2048 lds
  v_mfma_f32_16x16x32_bf16 v[132:135], a[220:223], v[220:223], v[132:135]
  v_mfma_f32_16x16x32_bf16 v[132:135], a[212:215], v[216:219], v[132:135]
  v_mfma_f32_16x16x32_bf16 v[132:135], a[204:207], v[212:215], v[132:135]
  v_mfma_f32_16x16x32_bf16 v[132:135], a[196:199], v[208:211], v[132:135]
  s_waitcnt lgkmcnt(4)
  v_mfma_f32_16x16x32_bf16 v[132:135], a[228:231], v[224:227], v[132:135]
  ds_read_b128 v[208:211], v4 offset:28672
  ds_read_b128 v[212:215], v4 offset:29696
  v_mfma_f32_16x16x32_bf16 v[132:135], a[236:239], v[228:231], v[132:135]
  s_add_u32 m0, s63, 61440
  s_add_u32 s3, s62, 880640
  buffer_load_dwordx4 v92, s[24:27], s3 offen offset:0 lds
  v_mfma_f32_16x16x32_bf16 v[132:135], a[244:247], v[232:235], v[132:135]
  ds_read_b128 v[216:219], v4 offset:30720
  ds_read_b128 v[220:223], v4 offset:31744
  v_mfma_f32_16x16x32_bf16 v[132:135], a[252:255], v[236:239], v[132:135]
  v_mfma_f32_16x16x32_bf16 v[128:131], a[248:251], v[236:239], v[128:131]
  v_mfma_f32_16x16x32_bf16 v[128:131], a[240:243], v[232:235], v[128:131]
  v_mfma_f32_16x16x32_bf16 v[128:131], a[232:235], v[228:231], v[128:131]
  v_mfma_f32_16x16x32_bf16 v[128:131], a[224:227], v[224:227], v[128:131]
  buffer_load_dwordx4 v93, s[24:27], s3 offen offset:1024 lds
  s_waitcnt lgkmcnt(4)
  v_mfma_f32_16x16x32_bf16 v[128:131], a[0:3], v[192:195], v[128:131]
  v_mfma_f32_16x16x32_bf16 v[128:131], a[8:11], v[196:199], v[128:131]
  v_mfma_f32_16x16x32_bf16 v[128:131], a[16:19], v[200:203], v[128:131]
  s_waitcnt vmcnt(11) lgkmcnt(0)
  s_barrier
  s_cmp_lg_u32 s40, 0
  s_cbranch_scc1 Lpub147
  s_lshr_b32 s4, s71, 2
  s_lshl_b32 s4, s4, 5
  s_and_b32 s5, s71, 3
  s_add_u32 s4, s4, s5
  s_lshl_b32 s4, s4, 2
  s_add_u32 s4, s4, 65036288
  v_mov_b32 v26, 1
  s_mov_b64 exec, 1
  buffer_store_dword v26, off, s[20:23], s4 sc1
  s_mov_b64 exec, -1
Lpub147:
  ds_read_b128 v[224:227], v4 offset:32768
  ds_read_b128 v[228:231], v4 offset:33792
  v_mfma_f32_16x16x32_bf16 v[128:131], a[24:27], v[204:207], v[128:131]
  ds_read_b128 v[232:235], v4 offset:34816
  ds_read_b128 v[236:239], v4 offset:35840
  v_mfma_f32_16x16x32_bf16 v[132:135], a[28:31], v[204:207], v[132:135]
  v_mfma_f32_16x16x32_bf16 v[132:135], a[20:23], v[200:203], v[132:135]
  buffer_load_dwordx4 v94, s[24:27], s3 offen offset:2048 lds
  v_mfma_f32_16x16x32_bf16 v[132:135], a[12:15], v[196:199], v[132:135]
  v_mfma_f32_16x16x32_bf16 v[132:135], a[4:7], v[192:195], v[132:135]
  v_mfma_f32_16x16x32_bf16 v[132:135], a[36:39], v[208:211], v[132:135]
  ds_read_b128 v[192:195], v4 offset:36864
  ds_read_b128 v[196:199], v4 offset:37888
  v_mfma_f32_16x16x32_bf16 v[132:135], a[44:47], v[212:215], v[132:135]
  v_mfma_f32_16x16x32_bf16 v[132:135], a[52:55], v[216:219], v[132:135]
  ds_read_b128 v[200:203], v4 offset:38912
  ds_read_b128 v[204:207], v4 offset:39936
  v_mfma_f32_16x16x32_bf16 v[132:135], a[60:63], v[220:223], v[132:135]
  s_add_u32 m0, s63, 73728
  s_add_u32 s3, s62, 1056768
  buffer_load_dwordx4 v92, s[24:27], s3 offen offset:0 lds
  v_mfma_f32_16x16x32_bf16 v[128:131], a[56:59], v[220:223], v[128:131]
  v_mfma_f32_16x16x32_bf16 v[128:131], a[48:51], v[216:219], v[128:131]
  v_mfma_f32_16x16x32_bf16 v[128:131], a[40:43], v[212:215], v[128:131]
  v_mfma_f32_16x16x32_bf16 v[128:131], a[32:35], v[208:211], v[128:131]
  s_waitcnt lgkmcnt(4)
  v_mfma_f32_16x16x32_bf16 v[152:155], a[64:67], v[224:227], 0
  ds_read_b128 v[208:211], v4 offset:40960
  ds_read_b128 v[212:215], v4 offset:41984
  v_mfma_f32_16x16x32_bf16 v[152:155], a[72:75], v[228:231], v[152:155]
  v_mfma_f32_16x16x32_bf16 v[152:155], a[80:83], v[232:235], v[152:155]
  ds_read_b128 v[216:219], v4 offset:43008
  ds_read_b128 v[220:223], v4 offset:44032
  v_cvt_pk_bf16_f32 v248, v128, v129
  v_cvt_pk_bf16_f32 v249, v130, v131
  v_mfma_f32_16x16x32_bf16 v[152:155], a[88:91], v[236:239], v[152:155]
  v_cvt_pk_bf16_f32 v250, v132, v133
  v_cvt_pk_bf16_f32 v251, v134, v135
  v_mfma_f32_16x16x32_bf16 v[156:159], a[92:95], v[236:239], 0
  s_xor_b32 s52, s70, 102400
  buffer_store_dwordx4 v[248:251], v2, s[20:23], s52 offen offset:1024 sc1
  v_mfma_f32_16x16x32_bf16 v[156:159], a[84:87], v[232:235], v[156:159]
  buffer_load_dwordx4 v93, s[24:27], s3 offen offset:1024 lds
  v_mfma_f32_16x16x32_bf16 v[156:159], a[76:79], v[228:231], v[156:159]
  v_mfma_f32_16x16x32_bf16 v[156:159], a[68:71], v[224:227], v[156:159]
  s_waitcnt lgkmcnt(4)
  v_mfma_f32_16x16x32_bf16 v[156:159], a[100:103], v[192:195], v[156:159]
  ds_read_b128 v[224:227], v4 offset:45056
  ds_read_b128 v[228:231], v4 offset:46080
  v_mfma_f32_16x16x32_bf16 v[156:159], a[108:111], v[196:199], v[156:159]
  v_mfma_f32_16x16x32_bf16 v[156:159], a[116:119], v[200:203], v[156:159]
  ds_read_b128 v[232:235], v4 offset:47104
  ds_read_b128 v[236:239], v4 offset:48128
  v_mfma_f32_16x16x32_bf16 v[156:159], a[124:127], v[204:207], v[156:159]
  buffer_load_dwordx4 v94, s[24:27], s3 offen offset:2048 lds
  v_mfma_f32_16x16x32_bf16 v[152:155], a[120:123], v[204:207], v[152:155]
  v_mfma_f32_16x16x32_bf16 v[152:155], a[112:115], v[200:203], v[152:155]
  v_mfma_f32_16x16x32_bf16 v[152:155], a[104:107], v[196:199], v[152:155]
  v_mfma_f32_16x16x32_bf16 v[152:155], a[96:99], v[192:195], v[152:155]
  s_waitcnt lgkmcnt(4)
  v_mfma_f32_16x16x32_bf16 v[152:155], a[128:131], v[208:211], v[152:155]
  ds_read_b128 v[192:195], v4 offset:49152
  ds_read_b128 v[196:199], v4 offset:50176
  v_mfma_f32_16x16x32_bf16 v[152:155], a[136:139], v[212:215], v[152:155]
  s_add_u32 m0, s63, 86016
  s_add_u32 s3, s62, 1232896
  buffer_load_dwordx4 v92, s[24:27], s3 offen offset:0 lds
  v_mfma_f32_16x16x32_bf16 v[152:155], a[144:147], v[216:219], v[152:155]
  ds_read_b128 v[200:203], v4 offset:51200
  ds_read_b128 v[204:207], v4 offset:52224
  v_mfma_f32_16x16x32_bf16 v[152:155], a[152:155], v[220:223], v[152:155]
  v_mfma_f32_16x16x32_bf16 v[156:159], a[156:159], v[220:223], v[156:159]
  v_mfma_f32_16x16x32_bf16 v[156:159], a[148:151], v[216:219], v[156:159]
  v_mfma_f32_16x16x32_bf16 v[156:159], a[140:143], v[212:215], v[156:159]
  v_mfma_f32_16x16x32_bf16 v[156:159], a[132:135], v[208:211], v[156:159]
  buffer_load_dwordx4 v93, s[24:27], s3 offen offset:1024 lds
  s_waitcnt lgkmcnt(4)
  v_mfma_f32_16x16x32_bf16 v[156:159], a[164:167], v[224:227], v[156:159]
  ds_read_b128 v[208:211], v4 offset:53248
  ds_read_b128 v[212:215], v4 offset:54272
  v_mfma_f32_16x16x32_bf16 v[156:159], a[172:175], v[228:231], v[156:159]
  v_mfma_f32_16x16x32_bf16 v[156:159], a[180:183], v[232:235], v[156:159]
  ds_read_b128 v[216:219], v4 offset:55296
  ds_read_b128 v[220:223], v4 offset:56320
  v_mfma_f32_16x16x32_bf16 v[156:159], a[188:191], v[236:239], v[156:159]
  v_mfma_f32_16x16x32_bf16 v[152:155], a[184:187], v[236:239], v[152:155]
  v_mfma_f32_16x16x32_bf16 v[152:155], a[176:179], v[232:235], v[152:155]
  buffer_load_dwordx4 v94, s[24:27], s3 offen offset:2048 lds
  v_mfma_f32_16x16x32_bf16 v[152:155], a[168:171], v[228:231], v[152:155]
  v_mfma_f32_16x16x32_bf16 v[152:155], a[160:163], v[224:227], v[152:155]
  s_lshl_b32 s33, s36, 2
  s_add_u32 s33, s33, s40
  s_lshl_b32 s55, s33, 7
  s_add_u32 s55, s55, 65036288
  v_and_b32 v29, 3, v1
  v_lshlrev_b32 v29, 2, v29
  s_waitcnt lgkmcnt(4)
  v_mfma_f32_16x16x32_bf16 v[152:155], a[192:195], v[192:195], v[152:155]
  ds_read_b128 v[224:227], v4 offset:57344
  ds_read_b128 v[228:231], v4 offset:58368
  v_mfma_f32_16x16x32_bf16 v[152:155], a[200:203], v[196:199], v[152:155]
  v_mfma_f32_16x16x32_bf16 v[152:155], a[208:211], v[200:203], v[152:155]
  ds_read_b128 v[232:235], v4 offset:59392
  ds_read_b128 v[236:239], v4 offset:60416
  v_mfma_f32_16x16x32_bf16 v[152:155], a[216:219], v[204:207], v[152:155]
  s_add_u32 m0, s46, 100864
  buffer_load_ushort v116, v121, s[12:15], s56 offen
  v_mfma_f32_16x16x32_bf16 v[156:159], a[220:223], v[204:207], v[156:159]
  v_mfma_f32_16x16x32_bf16 v[156:159], a[212:215], v[200:203], v[156:159]
  v_mfma_f32_16x16x32_bf16 v[156:159], a[204:207], v[196:199], v[156:159]
  v_mfma_f32_16x16x32_bf16 v[156:159], a[196:199], v[192:195], v[156:159]
  s_waitcnt lgkmcnt(4)
  v_mfma_f32_16x16x32_bf16 v[156:159], a[228:231], v[208:211], v[156:159]
  ds_read_b128 v[192:195], v4 offset:61440
  ds_read_b128 v[196:199], v4 offset:62464
  v_mfma_f32_16x16x32_bf16 v[156:159], a[236:239], v[212:215], v[156:159]
  buffer_load_dwordx4 v2, s[20:23], s58 offen sc1 lds
  v_mfma_f32_16x16x32_bf16 v[156:159], a[244:247], v[216:219], v[156:159]
  ds_read_b128 v[200:203], v4 offset:63488
  ds_read_b128 v[204:207], v4 offset:64512
  v_mfma_f32_16x16x32_bf16 v[156:159], a[252:255], v[220:223], v[156:159]
  v_mfma_f32_16x16x32_bf16 v[152:155], a[248:251], v[220:223], v[152:155]
  v_mfma_f32_16x16x32_bf16 v[152:155], a[240:243], v[216:219], v[152:155]
  v_mfma_f32_16x16x32_bf16 v[152:155], a[232:235], v[212:215], v[152:155]
  v_mfma_f32_16x16x32_bf16 v[152:155], a[224:227], v[208:211], v[152:155]
  buffer_load_ushort v117, v121, s[12:15], s57 offen
  s_waitcnt lgkmcnt(4)
  v_mfma_f32_16x16x32_bf16 v[152:155], a[0:3], v[224:227], v[152:155]
  v_mfma_f32_16x16x32_bf16 v[152:155], a[8:11], v[228:231], v[152:155]
  v_mfma_f32_16x16x32_bf16 v[152:155], a[16:19], v[232:235], v[152:155]
  v_mfma_f32_16x16x32_bf16 v[152:155], a[24:27], v[236:239], v[152:155]
  v_mfma_f32_16x16x32_bf16 v[156:159], a[28:31], v[236:239], v[156:159]
  v_mfma_f32_16x16x32_bf16 v[156:159], a[20:23], v[232:235], v[156:159]
  v_mfma_f32_16x16x32_bf16 v[156:159], a[12:15], v[228:231], v[156:159]
  v_mfma_f32_16x16x32_bf16 v[156:159], a[4:7], v[224:227], v[156:159]
  s_waitcnt lgkmcnt(0)
  v_mfma_f32_16x16x32_bf16 v[156:159], a[36:39], v[192:195], v[156:159]
  v_mfma_f32_16x16x32_bf16 v[156:159], a[44:47], v[196:199], v[156:159]
  v_mfma_f32_16x16x32_bf16 v[156:159], a[52:55], v[200:203], v[156:159]
  v_mfma_f32_16x16x32_bf16 v[156:159], a[60:63], v[204:207], v[156:159]
  v_mfma_f32_16x16x32_bf16 v[152:155], a[56:59], v[204:207], v[152:155]
  v_mfma_f32_16x16x32_bf16 v[152:155], a[48:51], v[200:203], v[152:155]
  v_mfma_f32_16x16x32_bf16 v[152:155], a[40:43], v[196:199], v[152:155]
  v_mfma_f32_16x16x32_bf16 v[152:155], a[32:35], v[192:195], v[152:155]
  s_lshl_b32 s89, s33, 12
  s_add_u32 s89, s89, 62980096
  s_waitcnt vmcnt(0)
  s_barrier
  s_lshl_b32 s58, s33, 15
  s_add_u32 s58, s58, 54525952
  s_mov_b32 s45, s39
  buffer_load_dword v28, v29, s[20:23], s55 offen sc1
  s_mov_b32 s16, s82
  s_and_b32 s17, s83, 0xffff
  s_mov_b32 s18, 1409024
  s_mov_b32 s19, 0x20000
  s_mul_i32 s39, s40, 360448
  s_lshl_b32 s4, s35, 7
  s_add_u32 s39, s39, s4
  ds_read_b128 v[128:131], v120 offset:0
  ds_read_b64_tr_b16 a[128:129], v114 offset:0
  ds_read_b64_tr_b16 a[130:131], v114 offset:768
  ds_read_b64_tr_b16 a[132:133], v115 offset:0
  ds_read_b64_tr_b16 a[134:135], v115 offset:768
  ds_read_b128 v[132:135], v120 offset:64
  ds_read_b64_tr_b16 a[136:137], v114 offset:6144
  ds_read_b64_tr_b16 a[138:139], v114 offset:6912
  ds_read_b64_tr_b16 a[140:141], v115 offset:6144
  ds_read_b64_tr_b16 a[142:143], v115 offset:6912
  ds_read_b128 v[136:139], v120 offset:128
  ds_read_b64_tr_b16 a[144:145], v114 offset:12288
  ds_read_b64_tr_b16 a[146:147], v114 offset:13056
  ds_read_b64_tr_b16 a[148:149], v115 offset:12288
  ds_read_b64_tr_b16 a[150:151], v115 offset:13056
  s_waitcnt lgkmcnt(10)
  v_mfma_f32_16x16x32_bf16 v[200:203], v[128:131], v[128:131], 0
  ds_read_b128 v[140:143], v120 offset:192
  ds_read_b64_tr_b16 a[152:153], v114 offset:18432
  ds_read_b64_tr_b16 a[154:155], v114 offset:19200
  ds_read_b64_tr_b16 a[156:157], v115 offset:18432
  ds_read_b64_tr_b16 a[158:159], v115 offset:19200
  s_add_u32 m0, s47, 131072
  s_add_u32 s50, s39, 0
  buffer_load_dwordx4 v8, s[16:19], s50 offen offset:0 lds
  v_mfma_f32_16x16x32_bf16 v[192:195], v[128:131], a[128:131], 0
  v_mfma_f32_16x16x32_bf16 v[196:199], v[128:131], a[132:135], 0
  s_waitcnt lgkmcnt(10)
  v_mfma_f32_16x16x32_bf16 v[200:203], v[132:135], v[132:135], v[200:203]
  ds_read_b128 v[128:131], v120 offset:256
  ds_read_b64_tr_b16 a[128:129], v114 offset:24576
  ds_read_b64_tr_b16 a[130:131], v114 offset:25344
  ds_read_b64_tr_b16 a[132:133], v115 offset:24576
  ds_read_b64_tr_b16 a[134:135], v115 offset:25344
  buffer_load_dwordx4 v9, s[16:19], s50 offen offset:1024 lds
  v_mfma_f32_16x16x32_bf16 v[192:195], v[132:135], a[136:139], v[192:195]
  v_mfma_f32_16x16x32_bf16 v[196:199], v[132:135], a[140:143], v[196:199]
  s_waitcnt lgkmcnt(10)
  v_mfma_f32_16x16x32_bf16 v[200:203], v[136:139], v[136:139], v[200:203]
  ds_read_b128 v[132:135], v120 offset:320
  ds_read_b64_tr_b16 a[136:137], v114 offset:30720
  ds_read_b64_tr_b16 a[138:139], v114 offset:31488
  ds_read_b64_tr_b16 a[140:141], v115 offset:30720
  ds_read_b64_tr_b16 a[142:143], v115 offset:31488
  buffer_load_dwordx4 v10, s[16:19], s50 offen offset:2048 lds
  v_mfma_f32_16x16x32_bf16 v[192:195], v[136:139], a[144:147], v[192:195]
  v_mfma_f32_16x16x32_bf16 v[196:199], v[136:139], a[148:151], v[196:199]
  s_waitcnt lgkmcnt(10)
  v_mfma_f32_16x16x32_bf16 v[200:203], v[140:143], v[140:143], v[200:203]
  ds_read_b128 v[136:139], v120 offset:384
  ds_read_b64_tr_b16 a[144:145], v114 offset:36864
  ds_read_b64_tr_b16 a[146:147], v114 offset:37632
  ds_read_b64_tr_b16 a[148:149], v115 offset:36864
  ds_read_b64_tr_b16 a[150:151], v115 offset:37632
  buffer_load_dwordx4 v11, s[16:19], s50 offen offset:3072 lds
  v_mfma_f32_16x16x32_bf16 v[192:195], v[140:143], a[152:155], v[192:195]
  v_mfma_f32_16x16x32_bf16 v[196:199], v[140:143], a[156:159], v[196:199]
  s_waitcnt lgkmcnt(10)
  v_mfma_f32_16x16x32_bf16 v[200:203], v[128:131], v[128:131], v[200:203]
  ds_read_b128 v[140:143], v120 offset:448
  ds_read_b64_tr_b16 a[152:153], v114 offset:43008
  ds_read_b64_tr_b16 a[154:155], v114 offset:43776
  ds_read_b64_tr_b16 a[156:157], v115 offset:43008
  ds_read_b64_tr_b16 a[158:159], v115 offset:43776
  s_add_u32 s53, s70, 3072
  buffer_load_dwordx4 v[44:47], v2, s[20:23], s53 offen offset:0 sc1
  buffer_load_dwordx4 v[48:51], v2, s[20:23], s53 offen offset:1024 sc1
  buffer_load_dwordx4 v[52:55], v2, s[20:23], s53 offen offset:2048 sc1
  v_mfma_f32_16x16x32_bf16 v[192:195], v[128:131], a[128:131], v[192:195]
  v_mfma_f32_16x16x32_bf16 v[196:199], v[128:131], a[132:135], v[196:199]
  s_waitcnt lgkmcnt(10)
  v_mfma_f32_16x16x32_bf16 v[200:203], v[132:135], v[132:135], v[200:203]
  ds_read_b128 v[128:131], v120 offset:512
  ds_read_b64_tr_b16 a[128:129], v114 offset:49152
  ds_read_b64_tr_b16 a[130:131], v114 offset:49920
  ds_read_b64_tr_b16 a[132:133], v115 offset:49152
  ds_read_b64_tr_b16 a[134:135], v115 offset:49920
  s_waitcnt vmcnt(7)
  v_cmp_ne_u32 vcc, 1, v28
  s_cbranch_vccz Lspok149
  s_mov_b32 s5, 0
Lspin148:
  s_sleep 2
  buffer_load_dword v28, v29, s[20:23], s55 offen sc1
  s_add_u32 s5, s5, 1
  s_waitcnt vmcnt(0)
  v_cmp_ne_u32 vcc, 1, v28
  s_cbranch_vccz Lspok149
  s_cmp_lt_u32 s5, 0x10000
  s_cbranch_scc1 Lspin148
Lspok149:
  buffer_load_dwordx4 v[96:99], v2, s[20:23], s89 offen offset:0 sc1
  v_mfma_f32_16x16x32_bf16 v[192:195], v[132:135], a[136:139], v[192:195]
  v_mfma_f32_16x16x32_bf16 v[196:199], v[132:135], a[140:143], v[196:199]
  s_waitcnt lgkmcnt(10)
  v_mfma_f32_16x16x32_bf16 v[200:203], v[136:139], v[136:139], v[200:203]
  ds_read_b128 v[132:135], v120 offset:576
  ds_read_b64_tr_b16 a[136:137], v114 offset:55296
  ds_read_b64_tr_b16 a[138:139], v114 offset:56064
  ds_read_b64_tr_b16 a[140:141], v115 offset:55296
  ds_read_b64_tr_b16 a[142:143], v115 offset:56064
  buffer_load_dwordx4 v[100:103], v2, s[20:23], s89 offen offset:1024 sc1
  v_mfma_f32_16x16x32_bf16 v[192:195], v[136:139], a[144:147], v[192:195]
  v_mfma_f32_16x16x32_bf16 v[196:199], v[136:139], a[148:151], v[196:199]
  s_waitcnt lgkmcnt(10)
  v_mfma_f32_16x16x32_bf16 v[200:203], v[140:143], v[140:143], v[200:203]
  ds_read_b128 v[136:139], v120 offset:640
  ds_read_b64_tr_b16 a[144:145], v114 offset:61440
  ds_read_b64_tr_b16 a[146:147], v114 offset:62208
  ds_read_b64_tr_b16 a[148:149], v115 offset:61440
  ds_read_b64_tr_b16 a[150:151], v115 offset:62208
  s_add_u32 s52, s58, 0
  buffer_load_dwordx4 a[0:3], v2, s[20:23], s52 offen offset:0 sc1
  v_mfma_f32_16x16x32_bf16 v[192:195], v[140:143], a[152:155], v[192:195]
  v_mfma_f32_16x16x32_bf16 v[196:199], v[140:143], a[156:159], v[196:199]
  s_waitcnt lgkmcnt(10)
  v_mfma_f32_16x16x32_bf16 v[200:203], v[128:131], v[128:131], v[200:203]
  ds_read_b128 v[140:143], v120 offset:704
  v_add_u32 v114, 0x10000, v114
  v_add_u32 v115, 0x10000, v115
  ds_read_b64_tr_b16 a[152:153], v114 offset:2048
  ds_read_b64_tr_b16 a[154:155], v114 offset:2816
  ds_read_b64_tr_b16 a[156:157], v115 offset:2048
  ds_read_b64_tr_b16 a[158:159], v115 offset:2816
  buffer_load_dwordx4 a[4:7], v2, s[20:23], s52 offen offset:1024 sc1
  v_mfma_f32_16x16x32_bf16 v[192:195], v[128:131], a[128:131], v[192:195]
  v_mfma_f32_16x16x32_bf16 v[196:199], v[128:131], a[132:135], v[196:199]
  s_waitcnt lgkmcnt(10)
  v_mfma_f32_16x16x32_bf16 v[200:203], v[132:135], v[132:135], v[200:203]
  ds_read_b128 v[128:131], v120 offset:768
  ds_read_b64_tr_b16 a[128:129], v114 offset:8192
  ds_read_b64_tr_b16 a[130:131], v114 offset:8960
  ds_read_b64_tr_b16 a[132:133], v115 offset:8192
  ds_read_b64_tr_b16 a[134:135], v115 offset:8960
  buffer_load_dwordx4 a[8:11], v2, s[20:23], s52 offen offset:2048 sc1
  v_mfma_f32_16x16x32_bf16 v[192:195], v[132:135], a[136:139], v[192:195]
  v_mfma_f32_16x16x32_bf16 v[196:199], v[132:135], a[140:143], v[196:199]
  s_waitcnt lgkmcnt(10)
  v_mfma_f32_16x16x32_bf16 v[200:203], v[136:139], v[136:139], v[200:203]
  ds_read_b128 v[132:135], v120 offset:832
  ds_read_b64_tr_b16 a[136:137], v114 offset:14336
  ds_read_b64_tr_b16 a[138:139], v114 offset:15104
  ds_read_b64_tr_b16 a[140:141], v115 offset:14336
  ds_read_b64_tr_b16 a[142:143], v115 offset:15104
  buffer_load_dwordx4 a[12:15], v2, s[20:23], s52 offen offset:3072 sc1
  v_mfma_f32_16x16x32_bf16 v[192:195], v[136:139], a[144:147], v[192:195]
  v_mfma_f32_16x16x32_bf16 v[196:199], v[136:139], a[148:151], v[196:199]
  s_waitcnt lgkmcnt(10)
  v_mfma_f32_16x16x32_bf16 v[200:203], v[140:143], v[140:143], v[200:203]
  ds_read_b128 v[136:139], v120 offset:896
  ds_read_b64_tr_b16 a[144:145], v114 offset:20480
  ds_read_b64_tr_b16 a[146:147], v114 offset:21248
  ds_read_b64_tr_b16 a[148:149], v115 offset:20480
  ds_read_b64_tr_b16 a[150:151], v115 offset:21248
  s_add_u32 s52, s58, 4096
  buffer_load_dwordx4 a[16:19], v2, s[20:23], s52 offen offset:0 sc1
  v_mfma_f32_16x16x32_bf16 v[192:195], v[140:143], a[152:155], v[192:195]
  v_mfma_f32_16x16x32_bf16 v[196:199], v[140:143], a[156:159], v[196:199]
  s_waitcnt lgkmcnt(10)
  v_mfma_f32_16x16x32_bf16 v[200:203], v[128:131], v[128:131], v[200:203]
  ds_read_b128 v[140:143], v120 offset:960
  ds_read_b64_tr_b16 a[152:153], v114 offset:26624
  ds_read_b64_tr_b16 a[154:155], v114 offset:27392
  ds_read_b64_tr_b16 a[156:157], v115 offset:26624
  ds_read_b64_tr_b16 a[158:159], v115 offset:27392
  buffer_load_dwordx4 a[20:23], v2, s[20:23], s52 offen offset:1024 sc1
  v_mfma_f32_16x16x32_bf16 v[192:195], v[128:131], a[128:131], v[192:195]
  v_mfma_f32_16x16x32_bf16 v[196:199], v[128:131], a[132:135], v[196:199]
  s_waitcnt lgkmcnt(10)
  v_mfma_f32_16x16x32_bf16 v[200:203], v[132:135], v[132:135], v[200:203]
  buffer_load_dwordx4 a[24:27], v2, s[20:23], s52 offen offset:2048 sc1
  v_mfma_f32_16x16x32_bf16 v[192:195], v[132:135], a[136:139], v[192:195]
  v_mfma_f32_16x16x32_bf16 v[196:199], v[132:135], a[140:143], v[196:199]
  s_waitcnt lgkmcnt(5)
  v_mfma_f32_16x16x32_bf16 v[200:203], v[136:139], v[136:139], v[200:203]
  buffer_load_dwordx4 a[28:31], v2, s[20:23], s52 offen offset:3072 sc1
  v_mfma_f32_16x16x32_bf16 v[192:195], v[136:139], a[144:147], v[192:195]
  v_mfma_f32_16x16x32_bf16 v[196:199], v[136:139], a[148:151], v[196:199]
  s_waitcnt lgkmcnt(0)
  v_mfma_f32_16x16x32_bf16 v[200:203], v[140:143], v[140:143], v[200:203]
  s_add_u32 s52, s58, 8192
  buffer_load_dwordx4 a[32:35], v2, s[20:23], s52 offen offset:0 sc1
  v_mfma_f32_16x16x32_bf16 v[192:195], v[140:143], a[152:155], v[192:195]
  v_mfma_f32_16x16x32_bf16 v[196:199], v[140:143], a[156:159], v[196:199]
  v_cmp_gt_u32 vcc, 16, v1
  v_cmp_gt_u32 s[14:15], 16, v1
  v_cmp_gt_u32 s[6:7], 32, v1
  v_add_u32 v219, 98304, v2
  v_add_u32 v218, s47, v219
  s_add_u32 s55, s55, 32768
  s_nop 1
  v_readlane_b32 s8, v200, 16
  v_readlane_b32 s9, v200, 0
  v_readlane_b32 s10, v200, 1
  v_readlane_b32 s12, v200, 17
  v_readlane_b32 s13, v201, 1
  v_lshlrev_b32 v116, 16, v116
  v_cndmask_b32 v205, v116, v193, vcc
  v_cvt_pk_bf16_f32 v206, v192, v205
  v_lshlrev_b32 v207, 16, v206
  v_and_b32 v216, 0xffff0000, v206
  v_sub_f32 v204, v192, v207
  v_sub_f32 v205, v205, v216
  v_cvt_pk_bf16_f32 v208, v207, v207
  v_cvt_pk_bf16_f32 v209, v204, v216
  v_cvt_pk_bf16_f32 v210, v216, v205
  v_mov_b32 v211, 0
  ds_write_b128 v218, v[208:211] offset:0
  v_lshlrev_b32 v117, 16, v117
  v_cndmask_b32 v205, v117, v197, vcc
  v_cvt_pk_bf16_f32 v206, v196, v205
  v_lshlrev_b32 v207, 16, v206
  v_and_b32 v216, 0xffff0000, v206
  v_sub_f32 v204, v196, v207
  v_sub_f32 v205, v205, v216
  v_cvt_pk_bf16_f32 v212, v207, v207
  v_cvt_pk_bf16_f32 v213, v204, v216
  v_cvt_pk_bf16_f32 v214, v216, v205
  v_mov_b32 v215, 0
  ds_write_b128 v218, v[212:215] offset:1024
  s_waitcnt vmcnt(11)
  v_max3_u32 v22, v44, v45, v46
  v_max3_u32 v22, v22, v47, v48
  v_max3_u32 v22, v22, v49, v50
  v_max3_u32 v22, v22, v51, v52
  v_max3_u32 v22, v22, v53, v54
  v_max_u32 v22, v22, v55
  v_cmp_eq_u32 vcc, -1, v22
  s_cbranch_vccz Lpxo151
  s_mov_b32 s5, 0
Lpxr150:
  s_sleep 2
  s_add_u32 s53, s70, 3072
  buffer_load_dwordx4 v[44:47], v2, s[20:23], s53 offen offset:0 sc1
  buffer_load_dwordx4 v[48:51], v2, s[20:23], s53 offen offset:1024 sc1
  buffer_load_dwordx4 v[52:55], v2, s[20:23], s53 offen offset:2048 sc1
  s_add_u32 s5, s5, 1
  s_waitcnt vmcnt(0)
  v_max3_u32 v22, v44, v45, v46
  v_max3_u32 v22, v22, v47, v48
  v_max3_u32 v22, v22, v49, v50
  v_max3_u32 v22, v22, v51, v52
  v_max3_u32 v22, v22, v53, v54
  v_max_u32 v22, v22, v55
  v_cmp_eq_u32 vcc, -1, v22
  s_cbranch_vccz Lpxo151
  s_cmp_lt_u32 s5, 0x4000
  s_cbranch_scc1 Lpxr150
Lpxo151:
  v_lshlrev_b32 v160, 16, v60
  v_and_b32 v161, 0xffff0000, v60
  v_lshlrev_b32 v162, 16, v61
  v_and_b32 v163, 0xffff0000, v61
  v_lshlrev_b32 v164, 16, v62
  buffer_load_dwordx4 a[36:39], v2, s[20:23], s52 offen offset:1024 sc1
  v_and_b32 v165, 0xffff0000, v62
  v_lshlrev_b32 v166, 16, v63
  v_and_b32 v167, 0xffff0000, v63
  v_lshlrev_b32 v168, 16, v44
  v_and_b32 v169, 0xffff0000, v44
  v_lshlrev_b32 v170, 16, v45
  v_and_b32 v171, 0xffff0000, v45
  v_lshlrev_b32 v172, 16, v46
  v_and_b32 v173, 0xffff0000, v46
  v_lshlrev_b32 v174, 16, v47
  v_and_b32 v175, 0xffff0000, v47
  v_pk_add_f32 v[152:153], v[152:153], v[168:169]
  buffer_load_dwordx4 a[40:43], v2, s[20:23], s52 offen offset:2048 sc1
  v_pk_add_f32 v[154:155], v[154:155], v[170:171]
  v_pk_add_f32 v[156:157], v[156:157], v[172:173]
  v_pk_add_f32 v[158:159], v[158:159], v[174:175]
  v_lshlrev_b32 v168, 16, v48
  v_and_b32 v169, 0xffff0000, v48
  v_lshlrev_b32 v170, 16, v49
  v_and_b32 v171, 0xffff0000, v49
  v_lshlrev_b32 v172, 16, v50
  v_and_b32 v173, 0xffff0000, v50
  v_lshlrev_b32 v174, 16, v51
  v_and_b32 v175, 0xffff0000, v51
  v_pk_add_f32 v[152:153], v[152:153], v[168:169]
  buffer_load_dwordx4 a[44:47], v2, s[20:23], s52 offen offset:3072 sc1
  v_pk_add_f32 v[154:155], v[154:155], v[170:171]
  v_pk_add_f32 v[156:157], v[156:157], v[172:173]
  v_pk_add_f32 v[158:159], v[158:159], v[174:175]
  v_lshlrev_b32 v168, 16, v52
  v_and_b32 v169, 0xffff0000, v52
  v_lshlrev_b32 v170, 16, v53
  v_and_b32 v171, 0xffff0000, v53
  v_lshlrev_b32 v172, 16, v54
  v_and_b32 v173, 0xffff0000, v54
  v_lshlrev_b32 v174, 16, v55
  v_and_b32 v175, 0xffff0000, v55
  v_pk_add_f32 v[152:153], v[152:153], v[168:169]
  s_add_u32 s52, s58, 12288
  buffer_load_dwordx4 a[48:51], v2, s[20:23], s52 offen offset:0 sc1
  v_pk_add_f32 v[154:155], v[154:155], v[170:171]
  v_pk_add_f32 v[156:157], v[156:157], v[172:173]
  v_pk_add_f32 v[158:159], v[158:159], v[174:175]
  v_pk_fma_f32 v[160:161], v[152:153], v[64:65], v[160:161]
  v_pk_fma_f32 v[162:163], v[154:155], v[66:67], v[162:163]
  v_pk_fma_f32 v[164:165], v[156:157], v[68:69], v[164:165]
  v_pk_fma_f32 v[166:167], v[158:159], v[70:71], v[166:167]
  v_cvt_pk_bf16_f32 v60, v160, v161
  v_cvt_pk_bf16_f32 v61, v162, v163
  v_cvt_pk_bf16_f32 v62, v164, v165
  v_cvt_pk_bf16_f32 v63, v166, v167
  v_lshlrev_b32 v160, 16, v60
  buffer_load_dwordx4 a[52:55], v2, s[20:23], s52 offen offset:1024 sc1
  v_and_b32 v161, 0xffff0000, v60
  v_lshlrev_b32 v162, 16, v61
  v_and_b32 v163, 0xffff0000, v61
  v_lshlrev_b32 v164, 16, v62
  v_and_b32 v165, 0xffff0000, v62
  v_lshlrev_b32 v166, 16, v63
  v_and_b32 v167, 0xffff0000, v63
  v_pk_mul_f32 v[176:177], v[160:161], v[80:81]
  v_pk_mul_f32 v[178:179], v[162:163], v[82:83]
  v_pk_mul_f32 v[180:181], v[164:165], v[84:85]
  v_pk_mul_f32 v[182:183], v[166:167], v[86:87]
  v_cvt_pk_bf16_f32 v240, v176, v177
  buffer_load_dwordx4 a[56:59], v2, s[20:23], s52 offen offset:2048 sc1
  v_cvt_pk_bf16_f32 v241, v178, v179
  v_cvt_pk_bf16_f32 v242, v180, v181
  v_cvt_pk_bf16_f32 v243, v182, v183
  s_add_u32 s38, s38, 16384
  s_add_u32 s45, s45, 16384
  s_add_u32 s68, s68, 2048
  buffer_store_dwordx4 v[240:243], v2, s[20:23], s38 offen sc1
  buffer_store_dwordx4 v[60:63], v5, s[20:23], s45 offen sc1
  v_pk_add_f32 v[44:45], v[160:161], v[162:163]
  v_pk_mul_f32 v[46:47], v[160:161], v[160:161]
  v_pk_add_f32 v[48:49], v[176:177], v[178:179]
  v_pk_mul_f32 v[50:51], v[176:177], v[176:177]
  buffer_load_dwordx4 a[60:63], v2, s[20:23], s52 offen offset:3072 sc1
  v_pk_mul_f32 v[52:53], v[176:177], v[80:81]
  v_pk_mul_f32 v[54:55], v[176:177], v[72:73]
  v_pk_fma_f32 v[46:47], v[162:163], v[162:163], v[46:47]
  v_pk_fma_f32 v[50:51], v[178:179], v[178:179], v[50:51]
  v_pk_fma_f32 v[52:53], v[178:179], v[82:83], v[52:53]
  v_pk_fma_f32 v[54:55], v[178:179], v[74:75], v[54:55]
  v_pk_add_f32 v[44:45], v[44:45], v[164:165]
  v_pk_fma_f32 v[46:47], v[164:165], v[164:165], v[46:47]
  v_pk_add_f32 v[48:49], v[48:49], v[180:181]
  v_pk_fma_f32 v[50:51], v[180:181], v[180:181], v[50:51]
  v_pk_fma_f32 v[52:53], v[180:181], v[84:85], v[52:53]
  v_pk_fma_f32 v[54:55], v[180:181], v[76:77], v[54:55]
  v_pk_add_f32 v[44:45], v[44:45], v[166:167]
  v_pk_fma_f32 v[46:47], v[166:167], v[166:167], v[46:47]
  v_pk_add_f32 v[48:49], v[48:49], v[182:183]
  v_pk_fma_f32 v[50:51], v[182:183], v[182:183], v[50:51]
  v_pk_fma_f32 v[52:53], v[182:183], v[86:87], v[52:53]
  v_pk_fma_f32 v[54:55], v[182:183], v[78:79], v[54:55]
  v_add_f32 v184, v44, v45
  v_add_f32 v185, v46, v47
  v_add_f32 v186, v48, v49
  v_add_f32 v188, v50, v51
  v_add_f32 v189, v52, v53
  v_add_f32 v190, v54, v55
  s_mul_i32 s32, s40, 8192
  s_add_u32 s32, s32, 100352
  v_add_u32 v22, s32, v2
  v_permlane16_swap_b32 v184, v188
  v_permlane16_swap_b32 v185, v189
  v_permlane16_swap_b32 v186, v190
  v_add_f32 v184, v184, v188
  v_add_f32 v185, v185, v189
  v_add_f32 v186, v186, v190
  v_mov_b32 v188, v184
  v_mov_b32 v189, v185
  v_mov_b32 v190, v186
  v_add_u32 v23, 100352, v2
  v_mov_b32 v187, 0
  v_permlane32_swap_b32 v184, v188
  v_permlane32_swap_b32 v185, v189
  v_permlane32_swap_b32 v186, v190
  v_add_f32 v184, v184, v188
  v_add_f32 v185, v185, v189
  v_add_f32 v186, v186, v190
  s_mov_b32 exec_hi, 0
  ds_write_b128 v22, v[184:187]
  s_mov_b32 exec_hi, -1
  s_waitcnt lgkmcnt(0)
  s_barrier
  s_cmp_lg_u32 s40, 0
  s_cbranch_scc1 Lst152
  ds_read_b128 v[164:167], v23 offset:8192
  ds_read_b128 v[168:171], v23 offset:16384
  ds_read_b128 v[172:175], v23 offset:24576
  s_waitcnt lgkmcnt(0)
  v_add_f32 v184, v184, v164
  v_add_f32 v168, v168, v172
  v_add_f32 v185, v185, v165
  v_add_f32 v169, v169, v173
  v_add_f32 v186, v186, v166
  v_add_f32 v170, v170, v174
  v_add_f32 v184, v184, v168
  v_add_f32 v185, v185, v169
  v_add_f32 v186, v186, v170
  s_mov_b32 exec_hi, 0
  buffer_store_dwordx4 v[184:187], v2, s[20:23], s68 offen sc1
  s_mov_b32 exec_hi, -1
Lst152:
  ds_read_b128 a[224:227], v219 offset:0
  ds_read_b128 a[228:231], v219 offset:8192
  ds_read_b128 a[232:235], v219 offset:16384
  ds_read_b128 a[236:239], v219 offset:24576
  ds_read_b128 a[240:243], v219 offset:1024
  ds_read_b128 a[244:247], v219 offset:9216
  buffer_load_dword v27, v0, s[28:31], 0 offen
  ds_read_b64_tr_b16 a[128:129], v112 offset:0
  ds_read_b64_tr_b16 a[130:131], v112 offset:768
  ds_read_b64_tr_b16 a[132:133], v113 offset:0
  ds_read_b64_tr_b16 a[134:135], v113 offset:768
  ds_read_b64_tr_b16 a[136:137], v112 offset:64
  ds_read_b64_tr_b16 a[138:139], v112 offset:832
  ds_read_b64_tr_b16 a[140:141], v113 offset:64
  ds_read_b64_tr_b16 a[142:143], v113 offset:832
  ds_read_b64_tr_b16 a[144:145], v112 offset:128
  ds_read_b64_tr_b16 a[146:147], v112 offset:896
  ds_read_b64_tr_b16 a[148:149], v113 offset:128
  ds_read_b64_tr_b16 a[150:151], v113 offset:896
  s_waitcnt vmcnt(18) lgkmcnt(8)
  v_mfma_f32_16x16x32_bf16 v[216:219], a[128:131], a[0:3], 0
  s_mul_i32 s62, s33, 88064
  ds_read_b64_tr_b16 a[152:153], v112 offset:6144
  ds_read_b64_tr_b16 a[154:155], v112 offset:6912
  v_mfma_f32_16x16x32_bf16 v[220:223], a[132:135], a[0:3], 0
  s_waitcnt lgkmcnt(6)
  ds_read_b64_tr_b16 a[156:157], v113 offset:6144
  ds_read_b64_tr_b16 a[158:159], v113 offset:6912
  v_mfma_f32_16x16x32_bf16 v[224:227], a[136:139], a[0:3], 0
  s_add_u32 m0, s47, 135168
  ds_read_b64_tr_b16 a[160:161], v112 offset:6208
  ds_read_b64_tr_b16 a[162:163], v112 offset:6976
  v_add_u32 v12, 0x20000, v12
  v_add_u32 v13, 0x20000, v13
  v_add_u32 v14, 0x20000, v14
  v_add_u32 v15, 0x20000, v15
  ds_read_b64_tr_b16 v[32:33], v12 offset:0
  ds_read_b64_tr_b16 v[34:35], v12 offset:2048
  v_mfma_f32_16x16x32_bf16 v[228:231], a[140:143], a[0:3], 0
  s_waitcnt lgkmcnt(8)
  ds_read_b64_tr_b16 a[164:165], v113 offset:6208
  ds_read_b64_tr_b16 a[166:167], v113 offset:6976
  v_mfma_f32_16x16x32_bf16 v[232:235], a[144:147], a[0:3], 0
  s_add_u32 s50, s39, 32768
  ds_read_b64_tr_b16 a[168:169], v112 offset:6272
  ds_read_b64_tr_b16 a[170:171], v112 offset:7040
  buffer_load_dwordx4 v8, s[16:19], s50 offen offset:0 lds
  v_mfma_f32_16x16x32_bf16 v[236:239], a[148:151], a[0:3], 0
  s_waitcnt vmcnt(18) lgkmcnt(8)
  ds_read_b64_tr_b16 a[172:173], v113 offset:6272
  ds_read_b64_tr_b16 a[174:175], v113 offset:7040
  ds_read_b64_tr_b16 v[36:37], v13 offset:0
  ds_read_b64_tr_b16 v[38:39], v13 offset:2048
  v_mfma_f32_16x16x32_bf16 v[216:219], a[152:155], a[4:7], v[216:219]
  s_add_u32 s62, s62, 56623104
  ds_read_b64_tr_b16 a[176:177], v112 offset:12288
  ds_read_b64_tr_b16 a[178:179], v112 offset:13056
  v_mfma_f32_16x16x32_bf16 v[220:223], a[156:159], a[4:7], v[220:223]
  s_waitcnt lgkmcnt(8)
  ds_read_b64_tr_b16 a[180:181], v113 offset:12288
  ds_read_b64_tr_b16 a[182:183], v113 offset:13056
  buffer_load_dwordx4 v9, s[16:19], s50 offen offset:1024 lds
  v_add_f32 v96, v96, v100
  v_mfma_f32_16x16x32_bf16 v[224:227], a[160:163], a[4:7], v[224:227]
  s_add_u32 s24, s20, s62
  s_addc_u32 s25, s21, 0
  ds_read_b64_tr_b16 a[184:185], v112 offset:12352
  ds_read_b64_tr_b16 a[186:187], v112 offset:13120
  ds_read_b64_tr_b16 v[40:41], v14 offset:0
  ds_read_b64_tr_b16 v[42:43], v14 offset:2048
  v_mfma_f32_16x16x32_bf16 v[228:231], a[164:167], a[4:7], v[228:231]
  s_waitcnt lgkmcnt(10)
  ds_read_b64_tr_b16 a[188:189], v113 offset:12352
  ds_read_b64_tr_b16 a[190:191], v113 offset:13120
  v_mfma_f32_16x16x32_bf16 v[232:235], a[168:171], a[4:7], v[232:235]
  s_mov_b32 s26, 44032
  ds_read_b64_tr_b16 a[192:193], v112 offset:12416
  ds_read_b64_tr_b16 a[194:195], v112 offset:13184
  buffer_load_dwordx4 v10, s[16:19], s50 offen offset:2048 lds
  v_add_f32 v97, v97, v101
  v_mfma_f32_16x16x32_bf16 v[236:239], a[172:175], a[4:7], v[236:239]
  s_waitcnt vmcnt(19) lgkmcnt(8)
  ds_read_b64_tr_b16 a[196:197], v113 offset:12416
  ds_read_b64_tr_b16 a[198:199], v113 offset:13184
  ds_read_b64_tr_b16 v[44:45], v15 offset:0
  ds_read_b64_tr_b16 v[46:47], v15 offset:2048
  v_mfma_f32_16x16x32_bf16 v[216:219], a[176:179], a[8:11], v[216:219]
  s_mul_i32 s63, s37, 3072
  ds_read_b64_tr_b16 a[128:129], v112 offset:18432
  ds_read_b64_tr_b16 a[130:131], v112 offset:19200
  v_add_f32 v98, v98, v102
  v_mfma_f32_16x16x32_bf16 v[220:223], a[180:183], a[8:11], v[220:223]
  s_waitcnt lgkmcnt(8)
  ds_read_b64_tr_b16 a[132:133], v113 offset:18432
  ds_read_b64_tr_b16 a[134:135], v113 offset:19200
  buffer_load_dwordx4 v11, s[16:19], s50 offen offset:3072 lds
  v_mfma_f32_16x16x32_bf16 v[224:227], a[184:187], a[8:11], v[224:227]
  s_mov_b32 s60, 0xbdd2d3e8
  ds_read_b64_tr_b16 a[136:137], v112 offset:18496
  ds_read_b64_tr_b16 a[138:139], v112 offset:19264
  v_mov_b32 v100, v96
  v_mfma_f32_16x16x32_bf16 v[228:231], a[188:191], a[8:11], v[228:231]
  s_waitcnt lgkmcnt(8)
  ds_read_b64_tr_b16 a[140:141], v113 offset:18496
  ds_read_b64_tr_b16 a[142:143], v113 offset:19264
  v_mov_b32 v101, v97
  v_mfma_f32_16x16x32_bf16 v[232:235], a[192:195], a[8:11], v[232:235]
  s_mov_b32 s61, 0xbdd2d3e8
  ds_read_b64_tr_b16 a[144:145], v112 offset:18560
  ds_read_b64_tr_b16 a[146:147], v112 offset:19328
  v_mov_b32 v102, v98
  s_nop 0
  v_mfma_f32_16x16x32_bf16 v[236:239], a[196:199], a[8:11], v[236:239]
  s_waitcnt vmcnt(19) lgkmcnt(6)
  ds_read_b64_tr_b16 a[148:149], v113 offset:18560
  ds_read_b64_tr_b16 a[150:151], v113 offset:19328
  v_mfma_f32_16x16x32_bf16 v[216:219], a[128:131], a[12:15], v[216:219]
  s_add_u32 m0, s47, 102400
  ds_read_b64_tr_b16 a[152:153], v112 offset:24576
  ds_read_b64_tr_b16 a[154:155], v112 offset:25344
  v_permlane32_swap_b32 v96, v100
  v_mfma_f32_16x16x32_bf16 v[220:223], a[132:135], a[12:15], v[220:223]
  s_waitcnt lgkmcnt(6)
  ds_read_b64_tr_b16 a[156:157], v113 offset:24576
  ds_read_b64_tr_b16 a[158:159], v113 offset:25344
  v_permlane32_swap_b32 v97, v101
  v_mfma_f32_16x16x32_bf16 v[224:227], a[136:139], a[12:15], v[224:227]
  s_add_u32 s50, s39, 65536
  ds_read_b64_tr_b16 a[160:161], v112 offset:24640
  ds_read_b64_tr_b16 a[162:163], v112 offset:25408
  v_permlane32_swap_b32 v98, v102
  v_mfma_f32_16x16x32_bf16 v[228:231], a[140:143], a[12:15], v[228:231]
  s_waitcnt lgkmcnt(6)
  ds_read_b64_tr_b16 a[164:165], v113 offset:24640
  ds_read_b64_tr_b16 a[166:167], v113 offset:25408
  v_mfma_f32_16x16x32_bf16 v[232:235], a[144:147], a[12:15], v[232:235]
  v_mov_b32 v22, 0xc0135761
  ds_read_b64_tr_b16 a[168:169], v112 offset:24704
  ds_read_b64_tr_b16 a[170:171], v112 offset:25472
  buffer_load_dwordx4 v8, s[16:19], s50 offen offset:0 lds
  v_add_f32 v96, v96, v100
  v_mfma_f32_16x16x32_bf16 v[236:239], a[148:151], a[12:15], v[236:239]
  s_waitcnt vmcnt(19) lgkmcnt(6)
  ds_read_b64_tr_b16 a[172:173], v113 offset:24704
  ds_read_b64_tr_b16 a[174:175], v113 offset:25472
  v_add_f32 v97, v97, v101
  v_mfma_f32_16x16x32_bf16 v[216:219], a[152:155], a[16:19], v[216:219]
  v_mov_b32 v23, 0xc0135761
  ds_read_b64_tr_b16 a[176:177], v112 offset:30720
  ds_read_b64_tr_b16 a[178:179], v112 offset:31488
  v_add_f32 v98, v98, v102
  v_mfma_f32_16x16x32_bf16 v[220:223], a[156:159], a[16:19], v[220:223]
  s_waitcnt lgkmcnt(6)
  ds_read_b64_tr_b16 a[180:181], v113 offset:30720
  ds_read_b64_tr_b16 a[182:183], v113 offset:31488
  buffer_load_dwordx4 v9, s[16:19], s50 offen offset:1024 lds
  v_mfma_f32_16x16x32_bf16 v[224:227], a[160:163], a[16:19], v[224:227]
  ds_read_b64_tr_b16 a[184:185], v112 offset:30784
  ds_read_b64_tr_b16 a[186:187], v112 offset:31552
  v_mov_b32 v100, v96
  v_mfma_f32_16x16x32_bf16 v[228:231], a[164:167], a[16:19], v[228:231]
  s_waitcnt lgkmcnt(6)
  ds_read_b64_tr_b16 a[188:189], v113 offset:30784
  ds_read_b64_tr_b16 a[190:191], v113 offset:31552
  v_mov_b32 v101, v97
  v_mfma_f32_16x16x32_bf16 v[232:235], a[168:171], a[16:19], v[232:235]
  ds_read_b64_tr_b16 a[192:193], v112 offset:30848
  ds_read_b64_tr_b16 a[194:195], v112 offset:31616
  buffer_load_dwordx4 v10, s[16:19], s50 offen offset:2048 lds
  v_mov_b32 v102, v98
  s_nop 0
  v_mfma_f32_16x16x32_bf16 v[236:239], a[172:175], a[16:19], v[236:239]
  s_waitcnt vmcnt(20) lgkmcnt(6)
  ds_read_b64_tr_b16 a[196:197], v113 offset:30848
  ds_read_b64_tr_b16 a[198:199], v113 offset:31616
  s_waitcnt vmcnt(8)
  s_barrier
  s_cmp_lg_u32 s40, 0
  s_cbranch_scc1 Lpub153
  s_lshr_b32 s4, s71, 2
  s_lshl_b32 s4, s4, 5
  s_and_b32 s5, s71, 3
  s_add_u32 s4, s4, s5
  s_lshl_b32 s4, s4, 2
  s_add_u32 s4, s4, 65069056
  v_mov_b32 v26, 1
  s_mov_b64 exec, 1
  buffer_store_dword v26, off, s[20:23], s4 sc1
  s_mov_b64 exec, -1
Lpub153:
  v_mfma_f32_16x16x32_bf16 v[216:219], a[176:179], a[20:23], v[216:219]
  ds_read_b64_tr_b16 a[128:129], v112 offset:36864
  ds_read_b64_tr_b16 a[130:131], v112 offset:37632
  v_permlane16_swap_b32 v96, v100
  v_mfma_f32_16x16x32_bf16 v[220:223], a[180:183], a[20:23], v[220:223]
  s_waitcnt lgkmcnt(6)
  ds_read_b64_tr_b16 a[132:133], v113 offset:36864
  ds_read_b64_tr_b16 a[134:135], v113 offset:37632
  buffer_load_dwordx4 v11, s[16:19], s50 offen offset:3072 lds
  v_permlane16_swap_b32 v97, v101
  v_mfma_f32_16x16x32_bf16 v[224:227], a[184:187], a[20:23], v[224:227]
  ds_read_b64_tr_b16 a[136:137], v112 offset:36928
  ds_read_b64_tr_b16 a[138:139], v112 offset:37696
  v_permlane16_swap_b32 v98, v102
  v_mfma_f32_16x16x32_bf16 v[228:231], a[188:191], a[20:23], v[228:231]
  s_waitcnt lgkmcnt(6)
  ds_read_b64_tr_b16 a[140:141], v113 offset:36928
  ds_read_b64_tr_b16 a[142:143], v113 offset:37696
  v_mfma_f32_16x16x32_bf16 v[232:235], a[192:195], a[20:23], v[232:235]
  ds_read_b64_tr_b16 a[144:145], v112 offset:36992
  ds_read_b64_tr_b16 a[146:147], v112 offset:37760
  v_mul_f32 v136, 0x3b000000, v96
  v_mfma_f32_16x16x32_bf16 v[236:239], a[196:199], a[20:23], v[236:239]
  s_waitcnt lgkmcnt(6)
  ds_read_b64_tr_b16 a[148:149], v113 offset:36992
  ds_read_b64_tr_b16 a[150:151], v113 offset:37760
  v_mul_f32 v137, 0x3b000000, v97
  v_mfma_f32_16x16x32_bf16 v[216:219], a[128:131], a[24:27], v[216:219]
  s_add_u32 m0, s47, 131072
  ds_read_b64_tr_b16 a[152:153], v112 offset:43008
  ds_read_b64_tr_b16 a[154:155], v112 offset:43776
  v_fma_f32 v137, -v136, v136, v137
  v_mfma_f32_16x16x32_bf16 v[220:223], a[132:135], a[24:27], v[220:223]
  s_waitcnt lgkmcnt(6)
  ds_read_b64_tr_b16 a[156:157], v113 offset:43008
  ds_read_b64_tr_b16 a[158:159], v113 offset:43776
  v_mfma_f32_16x16x32_bf16 v[224:227], a[136:139], a[24:27], v[224:227]
  s_add_u32 s50, s39, 98304
  ds_read_b64_tr_b16 a[160:161], v112 offset:43072
  ds_read_b64_tr_b16 a[162:163], v112 offset:43840
  v_add_f32 v137, 0x3727c5ac, v137
  v_mfma_f32_16x16x32_bf16 v[228:231], a[140:143], a[24:27], v[228:231]
  s_waitcnt lgkmcnt(6)
  ds_read_b64_tr_b16 a[164:165], v113 offset:43072
  ds_read_b64_tr_b16 a[166:167], v113 offset:43840
  v_rsq_f32 v138, v137
  v_mfma_f32_16x16x32_bf16 v[232:235], a[144:147], a[24:27], v[232:235]
  ds_read_b64_tr_b16 a[168:169], v112 offset:43136
  ds_read_b64_tr_b16 a[170:171], v112 offset:43904
  buffer_load_dwordx4 v8, s[16:19], s50 offen offset:0 lds
  v_sqrt_f32 v139, v137
  v_mfma_f32_16x16x32_bf16 v[236:239], a[148:151], a[24:27], v[236:239]
  s_waitcnt lgkmcnt(6)
  ds_read_b64_tr_b16 a[172:173], v113 offset:43136
  ds_read_b64_tr_b16 a[174:175], v113 offset:43904
  v_mfma_f32_16x16x32_bf16 v[216:219], a[152:155], a[28:31], v[216:219]
  ds_read_b64_tr_b16 a[176:177], v112 offset:49152
  ds_read_b64_tr_b16 a[178:179], v112 offset:49920
  v_fma_f32 v140, -v136, s8, v98
  v_mfma_f32_16x16x32_bf16 v[220:223], a[156:159], a[28:31], v[220:223]
  s_waitcnt lgkmcnt(6)
  ds_read_b64_tr_b16 a[180:181], v113 offset:49152
  ds_read_b64_tr_b16 a[182:183], v113 offset:49920
  buffer_load_dwordx4 v9, s[16:19], s50 offen offset:1024 lds
  v_fma_f32 v140, v140, v138, s12
  v_mfma_f32_16x16x32_bf16 v[224:227], a[160:163], a[28:31], v[224:227]
  ds_read_b64_tr_b16 a[184:185], v112 offset:49216
  ds_read_b64_tr_b16 a[186:187], v112 offset:49984
  s_waitcnt vmcnt(6)
  ds_read_b64_tr_b16 v[48:49], v12 offset:4096
  ds_read_b64_tr_b16 v[50:51], v12 offset:6144
  v_mfma_f32_16x16x32_bf16 v[228:231], a[164:167], a[28:31], v[228:231]
  s_waitcnt lgkmcnt(8)
  ds_read_b64_tr_b16 a[188:189], v113 offset:49216
  ds_read_b64_tr_b16 a[190:191], v113 offset:49984
  v_mfma_f32_16x16x32_bf16 v[232:235], a[168:171], a[28:31], v[232:235]
  ds_read_b64_tr_b16 a[192:193], v112 offset:49280
  ds_read_b64_tr_b16 a[194:195], v112 offset:50048
  buffer_load_dwordx4 v10, s[16:19], s50 offen offset:2048 lds
  v_mul_f32 v140, 0x3b000000, v140
  v_mfma_f32_16x16x32_bf16 v[236:239], a[172:175], a[28:31], v[236:239]
  s_waitcnt lgkmcnt(8)
  ds_read_b64_tr_b16 a[196:197], v113 offset:49280
  ds_read_b64_tr_b16 a[198:199], v113 offset:50048
  ds_read_b64_tr_b16 v[52:53], v13 offset:4096
  ds_read_b64_tr_b16 v[54:55], v13 offset:6144
  v_mfma_f32_16x16x32_bf16 v[216:219], a[176:179], a[32:35], v[216:219]
  ds_read_b64_tr_b16 a[128:129], v112 offset:55296
  ds_read_b64_tr_b16 a[130:131], v112 offset:56064
  v_mul_f32 v141, s9, v136
  v_mfma_f32_16x16x32_bf16 v[220:223], a[180:183], a[32:35], v[220:223]
  s_waitcnt lgkmcnt(8)
  ds_read_b64_tr_b16 a[132:133], v113 offset:55296
  ds_read_b64_tr_b16 a[134:135], v113 offset:56064
  buffer_load_dwordx4 v11, s[16:19], s50 offen offset:3072 lds
  v_mfma_f32_16x16x32_bf16 v[224:227], a[184:187], a[32:35], v[224:227]
  ds_read_b64_tr_b16 a[136:137], v112 offset:55360
  ds_read_b64_tr_b16 a[138:139], v112 offset:56128
  ds_read_b64_tr_b16 v[56:57], v14 offset:4096
  ds_read_b64_tr_b16 v[58:59], v14 offset:6144
  v_mfma_f32_16x16x32_bf16 v[228:231], a[188:191], a[32:35], v[228:231]
  s_waitcnt lgkmcnt(10)
  ds_read_b64_tr_b16 a[140:141], v113 offset:55360
  ds_read_b64_tr_b16 a[142:143], v113 offset:56128
  v_fma_f32 v141, -2.0, v101, v141
  v_mfma_f32_16x16x32_bf16 v[232:235], a[192:195], a[32:35], v[232:235]
  ds_read_b64_tr_b16 a[144:145], v112 offset:55424
  ds_read_b64_tr_b16 a[146:147], v112 offset:56192
  v_fma_f32 v141, v141, v136, v100
  v_mfma_f32_16x16x32_bf16 v[236:239], a[196:199], a[32:35], v[236:239]
  s_waitcnt lgkmcnt(8)
  ds_read_b64_tr_b16 a[148:149], v113 offset:55424
  ds_read_b64_tr_b16 a[150:151], v113 offset:56192
  ds_read_b64_tr_b16 v[60:61], v15 offset:4096
  ds_read_b64_tr_b16 v[62:63], v15 offset:6144
  v_mfma_f32_16x16x32_bf16 v[216:219], a[128:131], a[36:39], v[216:219]
  ds_read_b64_tr_b16 a[152:153], v112 offset:61440
  ds_read_b64_tr_b16 a[154:155], v112 offset:62208
  v_fma_f32 v142, -v136, s10, v102
  v_mfma_f32_16x16x32_bf16 v[220:223], a[132:135], a[36:39], v[220:223]
  s_waitcnt lgkmcnt(8)
  ds_read_b64_tr_b16 a[156:157], v113 offset:61440
  ds_read_b64_tr_b16 a[158:159], v113 offset:62208
  s_waitcnt lgkmcnt(4)
  v_add_f32 v142, v142, v142
  v_mfma_f32_16x16x32_bf16 v[224:227], a[136:139], a[36:39], v[224:227]
  s_add_u32 m0, s47, 135168
  ds_read_b64_tr_b16 a[160:161], v112 offset:61504
  ds_read_b64_tr_b16 a[162:163], v112 offset:62272
  v_fma_f32 v141, v141, v138, v142
  v_mfma_f32_16x16x32_bf16 v[228:231], a[140:143], a[36:39], v[228:231]
  ds_read_b64_tr_b16 a[164:165], v113 offset:61504
  ds_read_b64_tr_b16 a[166:167], v113 offset:62272
  v_mfma_f32_16x16x32_bf16 v[232:235], a[144:147], a[36:39], v[232:235]
  s_add_u32 s50, s39, 131072
  ds_read_b64_tr_b16 a[168:169], v112 offset:61568
  ds_read_b64_tr_b16 a[170:171], v112 offset:62336
  buffer_load_dwordx4 v8, s[16:19], s50 offen offset:0 lds
  v_fma_f32 v141, v141, v138, s13
  v_mfma_f32_16x16x32_bf16 v[236:239], a[148:151], a[36:39], v[236:239]
  s_waitcnt lgkmcnt(6)
  ds_read_b64_tr_b16 a[172:173], v113 offset:61568
  ds_read_b64_tr_b16 a[174:175], v113 offset:62336
  s_waitcnt vmcnt(5)
  v_add_u32 v12, 0xffff8000, v12
  v_add_u32 v13, 0xffff8000, v13
  v_add_u32 v14, 0xffff8000, v14
  v_add_u32 v15, 0xffff8000, v15
  ds_read_b64_tr_b16 v[64:65], v12 offset:4096
  ds_read_b64_tr_b16 v[66:67], v12 offset:6144
  v_mfma_f32_16x16x32_bf16 v[216:219], a[152:155], a[40:43], v[216:219]
  v_add_u32 v112, 0x10000, v112
  v_add_u32 v113, 0x10000, v113
  ds_read_b64_tr_b16 a[176:177], v112 offset:2048
  ds_read_b64_tr_b16 a[178:179], v112 offset:2816
  v_mul_f32 v141, 0x3b000000, v141
  v_mfma_f32_16x16x32_bf16 v[220:223], a[156:159], a[40:43], v[220:223]
  s_waitcnt lgkmcnt(8)
  ds_read_b64_tr_b16 a[180:181], v113 offset:2048
  ds_read_b64_tr_b16 a[182:183], v113 offset:2816
  buffer_load_dwordx4 v9, s[16:19], s50 offen offset:1024 lds
  v_mfma_f32_16x16x32_bf16 v[224:227], a[160:163], a[40:43], v[224:227]
  ds_read_b64_tr_b16 a[184:185], v112 offset:2112
  ds_read_b64_tr_b16 a[186:187], v112 offset:2880
  ds_read_b64_tr_b16 v[68:69], v13 offset:4096
  ds_read_b64_tr_b16 v[70:71], v13 offset:6144
  v_mfma_f32_16x16x32_bf16 v[228:231], a[164:167], a[40:43], v[228:231]
  s_waitcnt lgkmcnt(10)
  ds_read_b64_tr_b16 a[188:189], v113 offset:2112
  ds_read_b64_tr_b16 a[190:191], v113 offset:2880
  v_fma_f32 v141, -v140, v140, v141
  v_mfma_f32_16x16x32_bf16 v[232:235], a[168:171], a[40:43], v[232:235]
  ds_read_b64_tr_b16 a[192:193], v112 offset:2176
  ds_read_b64_tr_b16 a[194:195], v112 offset:2944
  buffer_load_dwordx4 v10, s[16:19], s50 offen offset:2048 lds
  v_add_f32 v141, 0x3727c5ac, v141
  v_mfma_f32_16x16x32_bf16 v[236:239], a[172:175], a[40:43], v[236:239]
  s_waitcnt lgkmcnt(8)
  ds_read_b64_tr_b16 a[196:197], v113 offset:2176
  ds_read_b64_tr_b16 a[198:199], v113 offset:2944
  ds_read_b64_tr_b16 v[72:73], v14 offset:4096
  ds_read_b64_tr_b16 v[74:75], v14 offset:6144
  v_mfma_f32_16x16x32_bf16 v[216:219], a[176:179], a[44:47], v[216:219]
  ds_read_b64_tr_b16 a[128:129], v112 offset:8192
  ds_read_b64_tr_b16 a[130:131], v112 offset:8960
  v_rsq_f32 v142, v141
  v_mfma_f32_16x16x32_bf16 v[220:223], a[180:183], a[44:47], v[220:223]
  s_waitcnt lgkmcnt(8)
  ds_read_b64_tr_b16 a[132:133], v113 offset:8192
  ds_read_b64_tr_b16 a[134:135], v113 offset:8960
  buffer_load_dwordx4 v11, s[16:19], s50 offen offset:3072 lds
  v_sqrt_f32 v143, v141
  v_mfma_f32_16x16x32_bf16 v[224:227], a[184:187], a[44:47], v[224:227]
  ds_read_b64_tr_b16 a[136:137], v112 offset:8256
  ds_read_b64_tr_b16 a[138:139], v112 offset:9024
  ds_read_b64_tr_b16 v[76:77], v15 offset:4096
  ds_read_b64_tr_b16 v[78:79], v15 offset:6144
  v_mfma_f32_16x16x32_bf16 v[228:231], a[188:191], a[44:47], v[228:231]
  s_waitcnt lgkmcnt(10)
  ds_read_b64_tr_b16 a[140:141], v113 offset:8256
  ds_read_b64_tr_b16 a[142:143], v113 offset:9024
  v_mfma_f32_16x16x32_bf16 v[232:235], a[192:195], a[44:47], v[232:235]
  ds_read_b64_tr_b16 a[144:145], v112 offset:8320
  ds_read_b64_tr_b16 a[146:147], v112 offset:9088
  s_waitcnt lgkmcnt(4)
  v_mul_f32 v144, v140, v139
  v_mfma_f32_16x16x32_bf16 v[236:239], a[196:199], a[44:47], v[236:239]
  ds_read_b64_tr_b16 a[148:149], v113 offset:8320
  ds_read_b64_tr_b16 a[150:151], v113 offset:9088
  v_mul_f32 v118, v138, v142
  v_mfma_f32_16x16x32_bf16 v[216:219], a[128:131], a[48:51], v[216:219]
  s_add_u32 m0, s47, 102400
  ds_read_b64_tr_b16 a[152:153], v112 offset:14336
  ds_read_b64_tr_b16 a[154:155], v112 offset:15104
  v_mul_f32 v145, v139, v143
  v_mfma_f32_16x16x32_bf16 v[220:223], a[132:135], a[48:51], v[220:223]
  s_waitcnt lgkmcnt(6)
  ds_read_b64_tr_b16 a[156:157], v113 offset:14336
  ds_read_b64_tr_b16 a[158:159], v113 offset:15104
  v_mfma_f32_16x16x32_bf16 v[224:227], a[136:139], a[48:51], v[224:227]
  s_add_u32 s50, s39, 163840
  ds_read_b64_tr_b16 a[160:161], v112 offset:14400
  ds_read_b64_tr_b16 a[162:163], v112 offset:15168
  v_cndmask_b32 v146, v144, v136, s[14:15]
  v_mfma_f32_16x16x32_bf16 v[228:231], a[140:143], a[48:51], v[228:231]
  s_waitcnt lgkmcnt(6)
  ds_read_b64_tr_b16 a[164:165], v113 offset:14400
  ds_read_b64_tr_b16 a[166:167], v113 offset:15168
  v_cndmask_b32 v147, v145, v139, s[14:15]
  v_mfma_f32_16x16x32_bf16 v[232:235], a[144:147], a[48:51], v[232:235]
  ds_read_b64_tr_b16 a[168:169], v112 offset:14464
  ds_read_b64_tr_b16 a[170:171], v112 offset:15232
  buffer_load_dwordx4 v8, s[16:19], s50 offen offset:0 lds
  v_cndmask_b32 v146, 0, -v146, s[6:7]
  v_mfma_f32_16x16x32_bf16 v[236:239], a[148:151], a[48:51], v[236:239]
  s_waitcnt lgkmcnt(6)
  ds_read_b64_tr_b16 a[172:173], v113 offset:14464
  ds_read_b64_tr_b16 a[174:175], v113 offset:15232
  s_waitcnt vmcnt(5)
  ds_read_b64_tr_b16 v[80:81], v12 offset:32768
  ds_read_b64_tr_b16 v[82:83], v12 offset:34816
  buffer_load_dword v28, v29, s[20:23], s55 offen sc1
  v_mfma_f32_16x16x32_bf16 v[216:219], a[152:155], a[52:55], v[216:219]
  ds_read_b64_tr_b16 a[176:177], v112 offset:20480
  ds_read_b64_tr_b16 a[178:179], v112 offset:21248
  v_cndmask_b32 v147, 0, v147, s[6:7]
  v_mfma_f32_16x16x32_bf16 v[220:223], a[156:159], a[52:55], v[220:223]
  s_waitcnt lgkmcnt(8)
  ds_read_b64_tr_b16 a[180:181], v113 offset:20480
  ds_read_b64_tr_b16 a[182:183], v113 offset:21248
  buffer_load_dwordx4 v9, s[16:19], s50 offen offset:1024 lds
  v_cvt_pk_bf16_f32 v121, v146, v147
  v_mfma_f32_16x16x32_bf16 v[224:227], a[160:163], a[52:55], v[224:227]
  ds_read_b64_tr_b16 a[184:185], v112 offset:20544
  ds_read_b64_tr_b16 a[186:187], v112 offset:21312
  ds_read_b64_tr_b16 v[84:85], v13 offset:32768
  ds_read_b64_tr_b16 v[86:87], v13 offset:34816
  v_mfma_f32_16x16x32_bf16 v[228:231], a[164:167], a[52:55], v[228:231]
  s_waitcnt lgkmcnt(10)
  ds_read_b64_tr_b16 a[188:189], v113 offset:20544
  ds_read_b64_tr_b16 a[190:191], v113 offset:21312
  v_mfma_f32_16x16x32_bf16 v[232:235], a[168:171], a[52:55], v[232:235]
  ds_read_b64_tr_b16 a[192:193], v112 offset:20608
  ds_read_b64_tr_b16 a[194:195], v112 offset:21376
  buffer_load_dwordx4 v10, s[16:19], s50 offen offset:2048 lds
  v_lshlrev_b32 v148, 16, v121
  v_mfma_f32_16x16x32_bf16 v[236:239], a[172:175], a[52:55], v[236:239]
  s_waitcnt lgkmcnt(8)
  ds_read_b64_tr_b16 a[196:197], v113 offset:20608
  ds_read_b64_tr_b16 a[198:199], v113 offset:21376
  ds_read_b64_tr_b16 v[88:89], v14 offset:32768
  ds_read_b64_tr_b16 v[90:91], v14 offset:34816
  v_mfma_f32_16x16x32_bf16 v[216:219], a[176:179], a[56:59], v[216:219]
  ds_read_b64_tr_b16 a[128:129], v112 offset:26624
  ds_read_b64_tr_b16 a[130:131], v112 offset:27392
  v_and_b32 v149, 0xffff0000, v121
  v_mfma_f32_16x16x32_bf16 v[220:223], a[180:183], a[56:59], v[220:223]
  s_waitcnt lgkmcnt(8)
  ds_read_b64_tr_b16 a[132:133], v113 offset:26624
  ds_read_b64_tr_b16 a[134:135], v113 offset:27392
  buffer_load_dwordx4 v11, s[16:19], s50 offen offset:3072 lds
  v_mfma_f32_16x16x32_bf16 v[224:227], a[184:187], a[56:59], v[224:227]
  ds_read_b64_tr_b16 a[136:137], v112 offset:26688
  ds_read_b64_tr_b16 a[138:139], v112 offset:27456
  ds_read_b64_tr_b16 v[92:93], v15 offset:32768
  ds_read_b64_tr_b16 v[94:95], v15 offset:34816
  v_mfma_f32_16x16x32_bf16 v[228:231], a[188:191], a[56:59], v[228:231]
  s_waitcnt lgkmcnt(10)
  ds_read_b64_tr_b16 a[140:141], v113 offset:26688
  ds_read_b64_tr_b16 a[142:143], v113 offset:27456
  v_sub_f32 v146, v146, v148
  v_mfma_f32_16x16x32_bf16 v[232:235], a[192:195], a[56:59], v[232:235]
  ds_read_b64_tr_b16 a[144:145], v112 offset:26752
  ds_read_b64_tr_b16 a[146:147], v112 offset:27520
  s_waitcnt lgkmcnt(4)
  v_sub_f32 v147, v147, v149
  v_mfma_f32_16x16x32_bf16 v[236:239], a[196:199], a[56:59], v[236:239]
  ds_read_b64_tr_b16 a[148:149], v113 offset:26752
  ds_read_b64_tr_b16 a[150:151], v113 offset:27520
  v_mfma_f32_16x16x32_bf16 v[216:219], a[128:131], a[60:63], v[216:219]
  s_add_u32 m0, s47, 131072
  v_cvt_pk_bf16_f32 v120, v148, v146
  v_mfma_f32_16x16x32_bf16 v[220:223], a[132:135], a[60:63], v[220:223]
  s_waitcnt lgkmcnt(4)
  v_cvt_pk_bf16_f32 v122, v147, v149
  v_mfma_f32_16x16x32_bf16 v[224:227], a[136:139], a[60:63], v[224:227]
  s_add_u32 s50, s39, 196608
  v_mov_b32 v123, 0
  v_mfma_f32_16x16x32_bf16 v[228:231], a[140:143], a[60:63], v[228:231]
  s_waitcnt lgkmcnt(0)
  v_mfma_f32_16x16x32_bf16 v[232:235], a[144:147], a[60:63], v[232:235]
  buffer_load_dwordx4 v8, s[16:19], s50 offen offset:0 lds
  v_mov_b32 v119, v118
  v_mfma_f32_16x16x32_bf16 v[236:239], a[148:151], a[60:63], v[236:239]
  s_nop 1
  v_mfma_f32_16x16x32_bf16 v[216:219], a[224:227], v[120:123], v[216:219]
  v_mfma_f32_16x16x32_bf16 v[220:223], a[228:231], v[120:123], v[220:223]
  v_mfma_f32_16x16x32_bf16 v[224:227], a[232:235], v[120:123], v[224:227]
  v_mfma_f32_16x16x32_bf16 v[228:231], a[236:239], v[120:123], v[228:231]
  v_mfma_f32_16x16x32_bf16 v[232:235], a[240:243], v[120:123], v[232:235]
  v_mfma_f32_16x16x32_bf16 v[236:239], a[244:247], v[120:123], v[236:239]
  buffer_load_dwordx4 v9, s[16:19], s50 offen offset:1024 lds
  buffer_load_dwordx4 v10, s[16:19], s50 offen offset:2048 lds
  buffer_load_dwordx4 v11, s[16:19], s50 offen offset:3072 lds
  s_waitcnt vmcnt(7)
  v_cmp_ne_u32 vcc, 1, v28
  s_cbranch_vccz Lspok155
  s_mov_b32 s5, 0
Lspin154:
  s_sleep 2
  buffer_load_dword v28, v29, s[20:23], s55 offen sc1
  s_add_u32 s5, s5, 1
  s_waitcnt vmcnt(0)
  v_cmp_ne_u32 vcc, 1, v28
  s_cbranch_vccz Lspok155
  s_cmp_lt_u32 s5, 0x10000
  s_cbranch_scc1 Lspin154
Lspok155:
  v_pk_mul_f32 v[216:217], v[216:217], v[118:119]
  v_pk_mul_f32 v[218:219], v[218:219], v[118:119]
  v_pk_mul_f32 v[220:221], v[220:221], v[118:119]
  v_pk_mul_f32 v[222:223], v[222:223], v[118:119]
  v_pk_mul_f32 v[240:241], v[216:217], v[216:217]
  v_pk_mul_f32 v[242:243], v[218:219], v[218:219]
  v_pk_mul_f32 v[244:245], v[220:221], v[220:221]
  v_pk_mul_f32 v[246:247], v[222:223], v[222:223]
  v_pk_fma_f32 v[240:241], v[240:241], s[60:61], v[22:23]
  v_pk_fma_f32 v[242:243], v[242:243], s[60:61], v[22:23]
  v_pk_fma_f32 v[244:245], v[244:245], s[60:61], v[22:23]
  v_pk_fma_f32 v[246:247], v[246:247], s[60:61], v[22:23]
  v_pk_mul_f32 v[240:241], v[240:241], v[216:217]
  v_pk_mul_f32 v[242:243], v[242:243], v[218:219]
  v_pk_mul_f32 v[244:245], v[244:245], v[220:221]
  v_pk_mul_f32 v[246:247], v[246:247], v[222:223]
  v_exp_f32 v240, v240
  v_exp_f32 v241, v241
  v_exp_f32 v242, v242
  v_exp_f32 v243, v243
  v_exp_f32 v244, v244
  v_exp_f32 v245, v245
  v_exp_f32 v246, v246
  v_exp_f32 v247, v247
  buffer_load_dwordx4 v[128:131], v2, s[20:23], s89 offen offset:2048 sc1
  buffer_load_dwordx4 v[132:135], v2, s[20:23], s89 offen offset:3072 sc1
  ds_read_b64_tr_b16 a[200:201], v12 offset:36864
  ds_read_b64_tr_b16 a[202:203], v12 offset:38912
  ds_read_b64_tr_b16 a[204:205], v13 offset:36864
  ds_read_b64_tr_b16 a[206:207], v13 offset:38912
  ds_read_b64_tr_b16 a[208:209], v14 offset:36864
  ds_read_b64_tr_b16 a[210:211], v14 offset:38912
  ds_read_b64_tr_b16 a[212:213], v15 offset:36864
  ds_read_b64_tr_b16 a[214:215], v15 offset:38912
  v_pk_add_f32 v[240:241], v[240:241], 1.0 op_sel_hi:[1,0]
  v_pk_add_f32 v[242:243], v[242:243], 1.0 op_sel_hi:[1,0]
  v_pk_add_f32 v[244:245], v[244:245], 1.0 op_sel_hi:[1,0]
  v_pk_add_f32 v[246:247], v[246:247], 1.0 op_sel_hi:[1,0]
  v_rcp_f32 v240, v240
  v_rcp_f32 v241, v241
  v_rcp_f32 v242, v242
  v_rcp_f32 v243, v243
  v_rcp_f32 v244, v244
  v_rcp_f32 v245, v245
  v_rcp_f32 v246, v246
  v_rcp_f32 v247, v247
  s_add_u32 s52, s58, 16384
  buffer_load_dwordx4 a[64:67], v2, s[20:23], s52 offen offset:0 sc1
  buffer_load_dwordx4 a[68:71], v2, s[20:23], s52 offen offset:1024 sc1
  v_pk_mul_f32 v[216:217], v[216:217], v[240:241]
  v_pk_mul_f32 v[218:219], v[218:219], v[242:243]
  v_pk_mul_f32 v[220:221], v[220:221], v[244:245]
  v_pk_mul_f32 v[222:223], v[222:223], v[246:247]
  v_cvt_pk_bf16_f32 v248, v216, v217
  v_cvt_pk_bf16_f32 v249, v218, v219
  v_cvt_pk_bf16_f32 v250, v220, v221
  v_cvt_pk_bf16_f32 v251, v222, v223
  buffer_store_dwordx4 v[248:251], v2, s[24:27], s63 offen offset:0 sc1
  v_pk_mul_f32 v[224:225], v[224:225], v[118:119]
  v_pk_mul_f32 v[226:227], v[226:227], v[118:119]
  v_pk_mul_f32 v[228:229], v[228:229], v[118:119]
  v_pk_mul_f32 v[230:231], v[230:231], v[118:119]
  v_pk_mul_f32 v[240:241], v[224:225], v[224:225]
  v_pk_mul_f32 v[242:243], v[226:227], v[226:227]
  v_pk_mul_f32 v[244:245], v[228:229], v[228:229]
  v_pk_mul_f32 v[246:247], v[230:231], v[230:231]
  v_pk_fma_f32 v[240:241], v[240:241], s[60:61], v[22:23]
  v_pk_fma_f32 v[242:243], v[242:243], s[60:61], v[22:23]
  v_pk_fma_f32 v[244:245], v[244:245], s[60:61], v[22:23]
  v_pk_fma_f32 v[246:247], v[246:247], s[60:61], v[22:23]
  v_pk_mul_f32 v[240:241], v[240:241], v[224:225]
  v_pk_mul_f32 v[242:243], v[242:243], v[226:227]
  v_pk_mul_f32 v[244:245], v[244:245], v[228:229]
  v_pk_mul_f32 v[246:247], v[246:247], v[230:231]
  v_exp_f32 v240, v240
  v_exp_f32 v241, v241
  v_exp_f32 v242, v242
  v_exp_f32 v243, v243
  v_exp_f32 v244, v244
  v_exp_f32 v245, v245
  v_exp_f32 v246, v246
  v_exp_f32 v247, v247
  buffer_load_dwordx4 a[72:75], v2, s[20:23], s52 offen offset:2048 sc1
  buffer_load_dwordx4 a[76:79], v2, s[20:23], s52 offen offset:3072 sc1
  s_waitcnt vmcnt(11)
  ds_read_b64_tr_b16 v[96:97], v12 offset:4096
  ds_read_b64_tr_b16 v[98:99], v12 offset:6144
  ds_read_b64_tr_b16 v[100:101], v13 offset:4096
  ds_read_b64_tr_b16 v[102:103], v13 offset:6144
  ds_read_b64_tr_b16 v[104:105], v14 offset:4096
  ds_read_b64_tr_b16 v[106:107], v14 offset:6144
  ds_read_b64_tr_b16 v[108:109], v15 offset:4096
  ds_read_b64_tr_b16 v[110:111], v15 offset:6144
  v_pk_add_f32 v[240:241], v[240:241], 1.0 op_sel_hi:[1,0]
  v_pk_add_f32 v[242:243], v[242:243], 1.0 op_sel_hi:[1,0]
  v_pk_add_f32 v[244:245], v[244:245], 1.0 op_sel_hi:[1,0]
  v_pk_add_f32 v[246:247], v[246:247], 1.0 op_sel_hi:[1,0]
  v_rcp_f32 v240, v240
  v_rcp_f32 v241, v241
  v_rcp_f32 v242, v242
  v_rcp_f32 v243, v243
  v_rcp_f32 v244, v244
  v_rcp_f32 v245, v245
  v_rcp_f32 v246, v246
  v_rcp_f32 v247, v247
  s_add_u32 s52, s58, 20480
  buffer_load_dwordx4 a[80:83], v2, s[20:23], s52 offen offset:0 sc1
  buffer_load_dwordx4 a[84:87], v2, s[20:23], s52 offen offset:1024 sc1
  s_waitcnt vmcnt(9)
  ds_read_b64_tr_b16 a[0:1], v12 offset:32768
  ds_read_b64_tr_b16 a[2:3], v12 offset:34816
  ds_read_b64_tr_b16 a[4:5], v13 offset:32768
  ds_read_b64_tr_b16 a[6:7], v13 offset:34816
  ds_read_b64_tr_b16 a[8:9], v14 offset:32768
  ds_read_b64_tr_b16 a[10:11], v14 offset:34816
  ds_read_b64_tr_b16 a[12:13], v15 offset:32768
  ds_read_b64_tr_b16 a[14:15], v15 offset:34816
  v_pk_mul_f32 v[224:225], v[224:225], v[240:241]
  v_pk_mul_f32 v[226:227], v[226:227], v[242:243]
  v_pk_mul_f32 v[228:229], v[228:229], v[244:245]
  v_pk_mul_f32 v[230:231], v[230:231], v[246:247]
  v_cvt_pk_bf16_f32 v252, v224, v225
  v_cvt_pk_bf16_f32 v253, v226, v227
  v_cvt_pk_bf16_f32 v254, v228, v229
  v_cvt_pk_bf16_f32 v255, v230, v231
  buffer_store_dwordx4 v[252:255], v2, s[24:27], s63 offen offset:1024 sc1
  v_pk_mul_f32 v[232:233], v[232:233], v[118:119]
  v_pk_mul_f32 v[234:235], v[234:235], v[118:119]
  v_pk_mul_f32 v[236:237], v[236:237], v[118:119]
  v_pk_mul_f32 v[238:239], v[238:239], v[118:119]
  v_pk_mul_f32 v[240:241], v[232:233], v[232:233]
  v_pk_mul_f32 v[242:243], v[234:235], v[234:235]
  v_pk_mul_f32 v[244:245], v[236:237], v[236:237]
  v_pk_mul_f32 v[246:247], v[238:239], v[238:239]
  v_pk_fma_f32 v[240:241], v[240:241], s[60:61], v[22:23]
  v_pk_fma_f32 v[242:243], v[242:243], s[60:61], v[22:23]
  v_pk_fma_f32 v[244:245], v[244:245], s[60:61], v[22:23]
  v_pk_fma_f32 v[246:247], v[246:247], s[60:61], v[22:23]
  v_pk_mul_f32 v[240:241], v[240:241], v[232:233]
  v_pk_mul_f32 v[242:243], v[242:243], v[234:235]
  v_pk_mul_f32 v[244:245], v[244:245], v[236:237]
  v_pk_mul_f32 v[246:247], v[246:247], v[238:239]
  v_exp_f32 v240, v240
  v_exp_f32 v241, v241
  v_exp_f32 v242, v242
  v_exp_f32 v243, v243
  v_exp_f32 v244, v244
  v_exp_f32 v245, v245
  v_exp_f32 v246, v246
  v_exp_f32 v247, v247
  buffer_load_dwordx4 a[88:91], v2, s[20:23], s52 offen offset:2048 sc1
  buffer_load_dwordx4 a[92:95], v2, s[20:23], s52 offen offset:3072 sc1
  v_pk_add_f32 v[240:241], v[240:241], 1.0 op_sel_hi:[1,0]
  v_pk_add_f32 v[242:243], v[242:243], 1.0 op_sel_hi:[1,0]
  v_pk_add_f32 v[244:245], v[244:245], 1.0 op_sel_hi:[1,0]
  v_pk_add_f32 v[246:247], v[246:247], 1.0 op_sel_hi:[1,0]
  v_rcp_f32 v240, v240
  v_rcp_f32 v241, v241
  v_rcp_f32 v242, v242
  v_rcp_f32 v243, v243
  v_rcp_f32 v244, v244
  v_rcp_f32 v245, v245
  v_rcp_f32 v246, v246
  v_rcp_f32 v247, v247
  s_add_u32 s52, s58, 24576
  buffer_load_dwordx4 a[96:99], v2, s[20:23], s52 offen offset:0 sc1
  buffer_load_dwordx4 a[100:103], v2, s[20:23], s52 offen offset:1024 sc1
  v_pk_mul_f32 v[232:233], v[232:233], v[240:241]
  v_pk_mul_f32 v[234:235], v[234:235], v[242:243]
  v_pk_mul_f32 v[236:237], v[236:237], v[244:245]
  v_pk_mul_f32 v[238:239], v[238:239], v[246:247]
  v_cvt_pk_bf16_f32 v248, v232, v233
  v_cvt_pk_bf16_f32 v249, v234, v235
  v_cvt_pk_bf16_f32 v250, v236, v237
  v_cvt_pk_bf16_f32 v251, v238, v239
  buffer_store_dwordx4 v[248:251], v2, s[24:27], s63 offen offset:2048 sc1
  v_mov_b32 v26, 1
  s_mov_b64 exec, 1
  buffer_store_dword v26, off, s[20:23], s86 sc1
  s_mov_b64 exec, -1
  s_add_u32 s24, s24, 44032
  s_addc_u32 s25, s25, 0
  s_lshl_b32 s4, s40, 3
  s_lshr_b32 s5, 0x0e0a0703, s4
  s_and_b32 s5, s5, 0xff
  s_lshr_b32 s4, 0x0b070300, s4
  s_and_b32 s4, s4, 0xff
  v_lshrrev_b32 v29, 1, v1
  v_add_u32 v29, s4, v29
  v_min_u32 v29, s5, v29
  v_and_b32 v28, 1, v29
  v_lshrrev_b32 v29, 1, v29
  v_lshlrev_b32 v29, 7, v29
  v_lshl_add_u32 v29, v28, 3, v29
  v_and_b32 v28, 1, v1
  v_lshl_add_u32 v29, v28, 2, v29
  s_lshl_b32 s55, s34, 10
  s_add_u32 s55, s55, 65142784
  v_add_u32 v112, 0xffff0000, v112
  v_add_u32 v113, 0xffff0000, v113
  ds_read_b64_tr_b16 a[128:129], v112 offset:0
  ds_read_b64_tr_b16 a[130:131], v112 offset:768
  ds_read_b64_tr_b16 a[132:133], v113 offset:0
  ds_read_b64_tr_b16 a[134:135], v113 offset:768
  ds_read_b64_tr_b16 a[136:137], v112 offset:64
  ds_read_b64_tr_b16 a[138:139], v112 offset:832
  ds_read_b64_tr_b16 a[140:141], v113 offset:64
  ds_read_b64_tr_b16 a[142:143], v113 offset:832
  ds_read_b64_tr_b16 a[144:145], v112 offset:128
  ds_read_b64_tr_b16 a[146:147], v112 offset:896
  ds_read_b64_tr_b16 a[148:149], v113 offset:128
  ds_read_b64_tr_b16 a[150:151], v113 offset:896
  s_waitcnt vmcnt(13) lgkmcnt(8)
  v_mfma_f32_16x16x32_bf16 v[216:219], a[128:131], a[64:67], 0
  s_mul_i32 s38, s34, 176128
  ds_read_b64_tr_b16 a[152:153], v112 offset:6144
  ds_read_b64_tr_b16 a[154:155], v112 offset:6912
  v_mfma_f32_16x16x32_bf16 v[220:223], a[132:135], a[64:67], 0
  s_waitcnt lgkmcnt(6)
  ds_read_b64_tr_b16 a[156:157], v113 offset:6144
  ds_read_b64_tr_b16 a[158:159], v113 offset:6912
  buffer_load_dwordx4 a[104:107], v2, s[20:23], s52 offen offset:2048 sc1
  v_mfma_f32_16x16x32_bf16 v[224:227], a[136:139], a[64:67], 0
  s_mul_i32 s3, s40, 11264
  ds_read_b64_tr_b16 a[160:161], v112 offset:6208
  ds_read_b64_tr_b16 a[162:163], v112 offset:6976
  v_mfma_f32_16x16x32_bf16 v[228:231], a[140:143], a[64:67], 0
  s_waitcnt lgkmcnt(6)
  ds_read_b64_tr_b16 a[164:165], v113 offset:6208
  ds_read_b64_tr_b16 a[166:167], v113 offset:6976
  v_mfma_f32_16x16x32_bf16 v[232:235], a[144:147], a[64:67], 0
  s_add_u32 s38, s38, s3
  ds_read_b64_tr_b16 a[168:169], v112 offset:6272
  ds_read_b64_tr_b16 a[170:171], v112 offset:7040
  v_mfma_f32_16x16x32_bf16 v[236:239], a[148:151], a[64:67], 0
  s_waitcnt vmcnt(13) lgkmcnt(6)
  ds_read_b64_tr_b16 a[172:173], v113 offset:6272
  ds_read_b64_tr_b16 a[174:175], v113 offset:7040
  buffer_load_dwordx4 a[108:111], v2, s[20:23], s52 offen offset:3072 sc1
  v_mfma_f32_16x16x32_bf16 v[216:219], a[152:155], a[68:71], v[216:219]
  s_add_u32 s38, s38, 56623104
  ds_read_b64_tr_b16 a[176:177], v112 offset:12288
  ds_read_b64_tr_b16 a[178:179], v112 offset:13056
  v_mfma_f32_16x16x32_bf16 v[220:223], a[156:159], a[68:71], v[220:223]
  s_waitcnt lgkmcnt(6)
  ds_read_b64_tr_b16 a[180:181], v113 offset:12288
  ds_read_b64_tr_b16 a[182:183], v113 offset:13056
  v_add_f32 v128, v128, v132
  v_mfma_f32_16x16x32_bf16 v[224:227], a[160:163], a[68:71], v[224:227]
  v_add_u32 v3, 88064, v2
  ds_read_b64_tr_b16 a[184:185], v112 offset:12352
  ds_read_b64_tr_b16 a[186:187], v112 offset:13120
  v_add_f32 v129, v129, v133
  v_mfma_f32_16x16x32_bf16 v[228:231], a[164:167], a[68:71], v[228:231]
  s_waitcnt lgkmcnt(6)
  ds_read_b64_tr_b16 a[188:189], v113 offset:12352
  ds_read_b64_tr_b16 a[190:191], v113 offset:13120
  s_add_u32 s52, s58, 28672
  buffer_load_dwordx4 a[112:115], v2, s[20:23], s52 offen offset:0 sc1
  v_mfma_f32_16x16x32_bf16 v[232:235], a[168:171], a[68:71], v[232:235]
  v_add_u32 v16, s47, v2
  ds_read_b64_tr_b16 a[192:193], v112 offset:12416
  ds_read_b64_tr_b16 a[194:195], v112 offset:13184
  v_add_f32 v130, v130, v134
  v_mfma_f32_16x16x32_bf16 v[236:239], a[172:175], a[68:71], v[236:239]
  s_waitcnt vmcnt(13) lgkmcnt(6)
  ds_read_b64_tr_b16 a[196:197], v113 offset:12416
  ds_read_b64_tr_b16 a[198:199], v113 offset:13184
  v_mov_b32 v132, v128
  v_mfma_f32_16x16x32_bf16 v[216:219], a[176:179], a[72:75], v[216:219]
  v_and_b32 v24, 15, v1
  ds_read_b64_tr_b16 a[128:129], v112 offset:18432
  ds_read_b64_tr_b16 a[130:131], v112 offset:19200
  v_mov_b32 v133, v129
  v_mfma_f32_16x16x32_bf16 v[220:223], a[180:183], a[72:75], v[220:223]
  s_waitcnt lgkmcnt(6)
  ds_read_b64_tr_b16 a[132:133], v113 offset:18432
  ds_read_b64_tr_b16 a[134:135], v113 offset:19200
  buffer_load_dwordx4 a[116:119], v2, s[20:23], s52 offen offset:1024 sc1
  v_mfma_f32_16x16x32_bf16 v[224:227], a[184:187], a[72:75], v[224:227]
  v_lshlrev_b32 v17, 4, v24
  ds_read_b64_tr_b16 a[136:137], v112 offset:18496
  ds_read_b64_tr_b16 a[138:139], v112 offset:19264
  v_mov_b32 v134, v130
  s_nop 0
  v_mfma_f32_16x16x32_bf16 v[228:231], a[188:191], a[72:75], v[228:231]
  s_waitcnt lgkmcnt(6)
  ds_read_b64_tr_b16 a[140:141], v113 offset:18496
  ds_read_b64_tr_b16 a[142:143], v113 offset:19264
  v_permlane32_swap_b32 v128, v132
  v_mfma_f32_16x16x32_bf16 v[232:235], a[192:195], a[72:75], v[232:235]
  v_lshl_add_u32 v17, v21, 9, v17
  ds_read_b64_tr_b16 a[144:145], v112 offset:18560
  ds_read_b64_tr_b16 a[146:147], v112 offset:19328
  v_permlane32_swap_b32 v129, v133
  v_mfma_f32_16x16x32_bf16 v[236:239], a[196:199], a[72:75], v[236:239]
  s_waitcnt vmcnt(13) lgkmcnt(6)
  ds_read_b64_tr_b16 a[148:149], v113 offset:18560
  ds_read_b64_tr_b16 a[150:151], v113 offset:19328
  buffer_load_dwordx4 a[120:123], v2, s[20:23], s52 offen offset:2048 sc1
  v_mfma_f32_16x16x32_bf16 v[216:219], a[128:131], a[76:79], v[216:219]
  s_lshl_b32 s3, s40, 11
  ds_read_b64_tr_b16 a[152:153], v112 offset:24576
  ds_read_b64_tr_b16 a[154:155], v112 offset:25344
  v_permlane32_swap_b32 v130, v134
  v_mfma_f32_16x16x32_bf16 v[220:223], a[132:135], a[76:79], v[220:223]
  s_waitcnt lgkmcnt(6)
  ds_read_b64_tr_b16 a[156:157], v113 offset:24576
  ds_read_b64_tr_b16 a[158:159], v113 offset:25344
  v_add_f32 v128, v128, v132
  v_mfma_f32_16x16x32_bf16 v[224:227], a[136:139], a[76:79], v[224:227]
  v_add_u32 v17, s3, v17
  ds_read_b64_tr_b16 a[160:161], v112 offset:24640
  ds_read_b64_tr_b16 a[162:163], v112 offset:25408
  v_add_f32 v129, v129, v133
  v_mfma_f32_16x16x32_bf16 v[228:231], a[140:143], a[76:79], v[228:231]
  s_waitcnt lgkmcnt(6)
  ds_read_b64_tr_b16 a[164:165], v113 offset:24640
  ds_read_b64_tr_b16 a[166:167], v113 offset:25408
  buffer_load_dwordx4 a[124:127], v2, s[20:23], s52 offen offset:3072 sc1
  v_mfma_f32_16x16x32_bf16 v[232:235], a[144:147], a[76:79], v[232:235]
  s_and_b32 s3, s40, 1
  ds_read_b64_tr_b16 a[168:169], v112 offset:24704
  ds_read_b64_tr_b16 a[170:171], v112 offset:25472
  v_add_f32 v130, v130, v134
  v_mfma_f32_16x16x32_bf16 v[236:239], a[148:151], a[76:79], v[236:239]
  s_waitcnt vmcnt(14) lgkmcnt(6)
  ds_read_b64_tr_b16 a[172:173], v113 offset:24704
  ds_read_b64_tr_b16 a[174:175], v113 offset:25472
  v_mov_b32 v132, v128
  v_mfma_f32_16x16x32_bf16 v[216:219], a[152:155], a[80:83], v[216:219]
  s_add_u32 m0, s47, 135168
  ds_read_b64_tr_b16 a[176:177], v112 offset:30720
  ds_read_b64_tr_b16 a[178:179], v112 offset:31488
  v_mov_b32 v133, v129
  v_mfma_f32_16x16x32_bf16 v[220:223], a[156:159], a[80:83], v[220:223]
  s_waitcnt lgkmcnt(6)
  ds_read_b64_tr_b16 a[180:181], v113 offset:30720
  ds_read_b64_tr_b16 a[182:183], v113 offset:31488
  v_mfma_f32_16x16x32_bf16 v[224:227], a[160:163], a[80:83], v[224:227]
  s_add_u32 s50, s39, 229376
  ds_read_b64_tr_b16 a[184:185], v112 offset:30784
  ds_read_b64_tr_b16 a[186:187], v112 offset:31552
  v_mov_b32 v134, v130
  s_nop 0
  v_mfma_f32_16x16x32_bf16 v[228:231], a[164:167], a[80:83], v[228:231]
  s_waitcnt lgkmcnt(6)
  ds_read_b64_tr_b16 a[188:189], v113 offset:30784
  ds_read_b64_tr_b16 a[190:191], v113 offset:31552
  v_permlane16_swap_b32 v128, v132
  v_mfma_f32_16x16x32_bf16 v[232:235], a[168:171], a[80:83], v[232:235]
  s_lshl_b32 s3, s3, 6
  ds_read_b64_tr_b16 a[192:193], v112 offset:30848
  ds_read_b64_tr_b16 a[194:195], v112 offset:31616
  buffer_load_dwordx4 v8, s[16:19], s50 offen offset:0 lds
  v_permlane16_swap_b32 v129, v133
  v_mfma_f32_16x16x32_bf16 v[236:239], a[172:175], a[80:83], v[236:239]
  s_waitcnt vmcnt(14) lgkmcnt(6)
  ds_read_b64_tr_b16 a[196:197], v113 offset:30848
  ds_read_b64_tr_b16 a[198:199], v113 offset:31616
  v_mfma_f32_16x16x32_bf16 v[216:219], a[176:179], a[84:87], v[216:219]
  s_lshl_b32 s48, s35, 7
  ds_read_b64_tr_b16 a[128:129], v112 offset:36864
  ds_read_b64_tr_b16 a[130:131], v112 offset:37632
  v_permlane16_swap_b32 v130, v134
  v_mfma_f32_16x16x32_bf16 v[220:223], a[180:183], a[84:87], v[220:223]
  s_waitcnt lgkmcnt(6)
  ds_read_b64_tr_b16 a[132:133], v113 offset:36864
  ds_read_b64_tr_b16 a[134:135], v113 offset:37632
  buffer_load_dwordx4 v9, s[16:19], s50 offen offset:1024 lds
  v_mul_f32 v136, 0x3b000000, v128
  v_mfma_f32_16x16x32_bf16 v[224:227], a[184:187], a[84:87], v[224:227]
  s_add_u32 s48, s48, s3
  ds_read_b64_tr_b16 a[136:137], v112 offset:36928
  ds_read_b64_tr_b16 a[138:139], v112 offset:37696
  v_mul_f32 v137, 0x3b000000, v129
  v_mfma_f32_16x16x32_bf16 v[228:231], a[188:191], a[84:87], v[228:231]
  s_waitcnt lgkmcnt(6)
  ds_read_b64_tr_b16 a[140:141], v113 offset:36928
  ds_read_b64_tr_b16 a[142:143], v113 offset:37696
  v_mfma_f32_16x16x32_bf16 v[232:235], a[192:195], a[84:87], v[232:235]
  s_lshr_b32 s3, s40, 1
  ds_read_b64_tr_b16 a[144:145], v112 offset:36992
  ds_read_b64_tr_b16 a[146:147], v112 offset:37760
  buffer_load_dwordx4 v10, s[16:19], s50 offen offset:2048 lds
  v_fma_f32 v137, -v136, v136, v137
  v_mfma_f32_16x16x32_bf16 v[236:239], a[196:199], a[84:87], v[236:239]
  s_waitcnt vmcnt(14) lgkmcnt(6)
  ds_read_b64_tr_b16 a[148:149], v113 offset:36992
  ds_read_b64_tr_b16 a[150:151], v113 offset:37760
  v_add_f32 v137, 0x3727c5ac, v137
  v_mfma_f32_16x16x32_bf16 v[216:219], a[128:131], a[88:91], v[216:219]
  s_and_b32 s32, s77, 2
  ds_read_b64_tr_b16 a[152:153], v112 offset:43008
  ds_read_b64_tr_b16 a[154:155], v112 offset:43776
  v_rsq_f32 v138, v137
  v_mfma_f32_16x16x32_bf16 v[220:223], a[132:135], a[88:91], v[220:223]
  s_waitcnt lgkmcnt(6)
  ds_read_b64_tr_b16 a[156:157], v113 offset:43008
  ds_read_b64_tr_b16 a[158:159], v113 offset:43776
  buffer_load_dwordx4 v11, s[16:19], s50 offen offset:3072 lds
  v_mfma_f32_16x16x32_bf16 v[224:227], a[136:139], a[88:91], v[224:227]
  s_add_u32 s32, s32, s3
  ds_read_b64_tr_b16 a[160:161], v112 offset:43072
  ds_read_b64_tr_b16 a[162:163], v112 offset:43840
  v_sqrt_f32 v139, v137
  v_mfma_f32_16x16x32_bf16 v[228:231], a[140:143], a[88:91], v[228:231]
  s_waitcnt lgkmcnt(6)
  ds_read_b64_tr_b16 a[164:165], v113 offset:43072
  ds_read_b64_tr_b16 a[166:167], v113 offset:43840
  v_fma_f32 v140, -v136, s8, v130
  v_mfma_f32_16x16x32_bf16 v[232:235], a[144:147], a[88:91], v[232:235]
  s_add_u32 s66, s66, s32
  ds_read_b64_tr_b16 a[168:169], v112 offset:43136
  ds_read_b64_tr_b16 a[170:171], v112 offset:43904
  v_fma_f32 v140, v140, v138, s12
  v_mfma_f32_16x16x32_bf16 v[236:239], a[148:151], a[88:91], v[236:239]
  s_waitcnt vmcnt(14) lgkmcnt(6)
  ds_read_b64_tr_b16 a[172:173], v113 offset:43136
  ds_read_b64_tr_b16 a[174:175], v113 offset:43904
  v_mfma_f32_16x16x32_bf16 v[216:219], a[152:155], a[92:95], v[216:219]
  s_add_u32 m0, s47, 102400
  ds_read_b64_tr_b16 a[176:177], v112 offset:49152
  ds_read_b64_tr_b16 a[178:179], v112 offset:49920
  v_mul_f32 v140, 0x3b000000, v140
  v_mfma_f32_16x16x32_bf16 v[220:223], a[156:159], a[92:95], v[220:223]
  s_waitcnt lgkmcnt(6)
  ds_read_b64_tr_b16 a[180:181], v113 offset:49152
  ds_read_b64_tr_b16 a[182:183], v113 offset:49920
  v_mul_f32 v141, s9, v136
  v_mfma_f32_16x16x32_bf16 v[224:227], a[160:163], a[92:95], v[224:227]
  s_add_u32 s50, s39, 262144
  ds_read_b64_tr_b16 a[184:185], v112 offset:49216
  ds_read_b64_tr_b16 a[186:187], v112 offset:49984
  v_fma_f32 v141, -2.0, v133, v141
  v_mfma_f32_16x16x32_bf16 v[228:231], a[164:167], a[92:95], v[228:231]
  s_waitcnt lgkmcnt(6)
  ds_read_b64_tr_b16 a[188:189], v113 offset:49216
  ds_read_b64_tr_b16 a[190:191], v113 offset:49984
  v_mfma_f32_16x16x32_bf16 v[232:235], a[168:171], a[92:95], v[232:235]
  s_lshl_b32 s66, s66, 14
  ds_read_b64_tr_b16 a[192:193], v112 offset:49280
  ds_read_b64_tr_b16 a[194:195], v112 offset:50048
  buffer_load_dwordx4 v8, s[16:19], s50 offen offset:0 lds
  v_fma_f32 v141, v141, v136, v132
  v_mfma_f32_16x16x32_bf16 v[236:239], a[172:175], a[92:95], v[236:239]
  s_waitcnt vmcnt(14) lgkmcnt(6)
  ds_read_b64_tr_b16 a[196:197], v113 offset:49280
  ds_read_b64_tr_b16 a[198:199], v113 offset:50048
  v_fma_f32 v142, -v136, s10, v134
  v_mfma_f32_16x16x32_bf16 v[216:219], a[176:179], a[96:99], v[216:219]
  s_add_u32 s66, s66, s48
  ds_read_b64_tr_b16 a[128:129], v112 offset:55296
  ds_read_b64_tr_b16 a[130:131], v112 offset:56064
  v_add_f32 v142, v142, v142
  v_mfma_f32_16x16x32_bf16 v[220:223], a[180:183], a[96:99], v[220:223]
  s_waitcnt lgkmcnt(6)
  ds_read_b64_tr_b16 a[132:133], v113 offset:55296
  ds_read_b64_tr_b16 a[134:135], v113 offset:56064
  buffer_load_dwordx4 v9, s[16:19], s50 offen offset:1024 lds
  v_mfma_f32_16x16x32_bf16 v[224:227], a[184:187], a[96:99], v[224:227]
  s_add_u32 s67, s67, s32
  ds_read_b64_tr_b16 a[136:137], v112 offset:55360
  ds_read_b64_tr_b16 a[138:139], v112 offset:56128
  v_fma_f32 v141, v141, v138, v142
  v_mfma_f32_16x16x32_bf16 v[228:231], a[188:191], a[96:99], v[228:231]
  s_waitcnt lgkmcnt(6)
  ds_read_b64_tr_b16 a[140:141], v113 offset:55360
  ds_read_b64_tr_b16 a[142:143], v113 offset:56128
  v_fma_f32 v141, v141, v138, s13
  v_mfma_f32_16x16x32_bf16 v[232:235], a[192:195], a[96:99], v[232:235]
  s_lshl_b32 s67, s67, 14
  ds_read_b64_tr_b16 a[144:145], v112 offset:55424
  ds_read_b64_tr_b16 a[146:147], v112 offset:56192
  buffer_load_dwordx4 v10, s[16:19], s50 offen offset:2048 lds
  v_mul_f32 v141, 0x3b000000, v141
  v_mfma_f32_16x16x32_bf16 v[236:239], a[196:199], a[96:99], v[236:239]
  s_waitcnt vmcnt(15) lgkmcnt(6)
  ds_read_b64_tr_b16 a[148:149], v113 offset:55424
  ds_read_b64_tr_b16 a[150:151], v113 offset:56192
  v_mfma_f32_16x16x32_bf16 v[216:219], a[128:131], a[100:103], v[216:219]
  s_add_u32 s67, s67, s48
  ds_read_b64_tr_b16 a[152:153], v112 offset:61440
  ds_read_b64_tr_b16 a[154:155], v112 offset:62208
  v_fma_f32 v141, -v140, v140, v141
  v_mfma_f32_16x16x32_bf16 v[220:223], a[132:135], a[100:103], v[220:223]
  s_waitcnt lgkmcnt(6)
  ds_read_b64_tr_b16 a[156:157], v113 offset:61440
  ds_read_b64_tr_b16 a[158:159], v113 offset:62208
  buffer_load_dwordx4 v11, s[16:19], s50 offen offset:3072 lds
  v_add_f32 v141, 0x3727c5ac, v141
  v_mfma_f32_16x16x32_bf16 v[224:227], a[136:139], a[100:103], v[224:227]
  s_lshl_b32 s46, s36, 2
  ds_read_b64_tr_b16 a[160:161], v112 offset:61504
  ds_read_b64_tr_b16 a[162:163], v112 offset:62272
  v_rsq_f32 v142, v141
  v_mfma_f32_16x16x32_bf16 v[228:231], a[140:143], a[100:103], v[228:231]
  s_waitcnt lgkmcnt(6)
  ds_read_b64_tr_b16 a[164:165], v113 offset:61504
  ds_read_b64_tr_b16 a[166:167], v113 offset:62272
  v_mfma_f32_16x16x32_bf16 v[232:235], a[144:147], a[100:103], v[232:235]
  s_add_u32 s46, s46, s32
  ds_read_b64_tr_b16 a[168:169], v112 offset:61568
  ds_read_b64_tr_b16 a[170:171], v112 offset:62336
  v_sqrt_f32 v143, v141
  v_mfma_f32_16x16x32_bf16 v[236:239], a[148:151], a[100:103], v[236:239]
  s_waitcnt vmcnt(13) lgkmcnt(6)
  ds_read_b64_tr_b16 a[172:173], v113 offset:61568
  ds_read_b64_tr_b16 a[174:175], v113 offset:62336
  v_mul_f32 v144, v140, v139
  buffer_load_dword v28, v29, s[20:23], s55 offen sc1
  v_mfma_f32_16x16x32_bf16 v[216:219], a[152:155], a[104:107], v[216:219]
  s_add_u32 m0, s47, 131072
  v_add_u32 v112, 0x10000, v112
  v_add_u32 v113, 0x10000, v113
  ds_read_b64_tr_b16 a[176:177], v112 offset:2048
  ds_read_b64_tr_b16 a[178:179], v112 offset:2816
  v_mul_f32 v118, v138, v142
  v_mfma_f32_16x16x32_bf16 v[220:223], a[156:159], a[104:107], v[220:223]
  s_waitcnt lgkmcnt(6)
  ds_read_b64_tr_b16 a[180:181], v113 offset:2048
  ds_read_b64_tr_b16 a[182:183], v113 offset:2816
  v_mfma_f32_16x16x32_bf16 v[224:227], a[160:163], a[104:107], v[224:227]
  s_add_u32 s50, s39, 294912
  ds_read_b64_tr_b16 a[184:185], v112 offset:2112
  ds_read_b64_tr_b16 a[186:187], v112 offset:2880
  v_mul_f32 v145, v139, v143
  v_mfma_f32_16x16x32_bf16 v[228:231], a[164:167], a[104:107], v[228:231]
  s_waitcnt lgkmcnt(6)
  ds_read_b64_tr_b16 a[188:189], v113 offset:2112
  ds_read_b64_tr_b16 a[190:191], v113 offset:2880
  v_cndmask_b32 v146, v144, v136, s[14:15]
  v_mfma_f32_16x16x32_bf16 v[232:235], a[168:171], a[104:107], v[232:235]
  s_lshl_b32 s46, s46, 15
  ds_read_b64_tr_b16 a[192:193], v112 offset:2176
  ds_read_b64_tr_b16 a[194:195], v112 offset:2944
  buffer_load_dwordx4 v8, s[16:19], s50 offen offset:0 lds
  v_cndmask_b32 v147, v145, v139, s[14:15]
  v_mfma_f32_16x16x32_bf16 v[236:239], a[172:175], a[104:107], v[236:239]
  s_waitcnt vmcnt(14) lgkmcnt(6)
  ds_read_b64_tr_b16 a[196:197], v113 offset:2176
  ds_read_b64_tr_b16 a[198:199], v113 offset:2944
  v_mfma_f32_16x16x32_bf16 v[216:219], a[176:179], a[108:111], v[216:219]
  s_add_u32 s46, s46, s48
  ds_read_b64_tr_b16 a[128:129], v112 offset:8192
  ds_read_b64_tr_b16 a[130:131], v112 offset:8960
  v_cndmask_b32 v146, 0, -v146, s[6:7]
  v_mfma_f32_16x16x32_bf16 v[220:223], a[180:183], a[108:111], v[220:223]
  s_waitcnt lgkmcnt(6)
  ds_read_b64_tr_b16 a[132:133], v113 offset:8192
  ds_read_b64_tr_b16 a[134:135], v113 offset:8960
  buffer_load_dwordx4 v9, s[16:19], s50 offen offset:1024 lds
  v_cndmask_b32 v147, 0, v147, s[6:7]
  v_mfma_f32_16x16x32_bf16 v[224:227], a[184:187], a[108:111], v[224:227]
  s_add_u32 s46, s46, 52428800
  ds_read_b64_tr_b16 a[136:137], v112 offset:8256
  ds_read_b64_tr_b16 a[138:139], v112 offset:9024
  s_waitcnt vmcnt(7)
  ds_read_b64_tr_b16 a[16:17], v12 offset:36864
  ds_read_b64_tr_b16 a[18:19], v12 offset:38912
  v_mfma_f32_16x16x32_bf16 v[228:231], a[188:191], a[108:111], v[228:231]
  s_waitcnt lgkmcnt(8)
  ds_read_b64_tr_b16 a[140:141], v113 offset:8256
  ds_read_b64_tr_b16 a[142:143], v113 offset:9024
  v_mfma_f32_16x16x32_bf16 v[232:235], a[192:195], a[108:111], v[232:235]
  s_lshl_b32 s3, s48, 1
  ds_read_b64_tr_b16 a[144:145], v112 offset:8320
  ds_read_b64_tr_b16 a[146:147], v112 offset:9088
  buffer_load_dwordx4 v10, s[16:19], s50 offen offset:2048 lds
  v_cvt_pk_bf16_f32 v121, v146, v147
  v_mfma_f32_16x16x32_bf16 v[236:239], a[196:199], a[108:111], v[236:239]
  s_waitcnt lgkmcnt(8)
  ds_read_b64_tr_b16 a[148:149], v113 offset:8320
  ds_read_b64_tr_b16 a[150:151], v113 offset:9088
  ds_read_b64_tr_b16 a[20:21], v13 offset:36864
  ds_read_b64_tr_b16 a[22:23], v13 offset:38912
  v_mfma_f32_16x16x32_bf16 v[216:219], a[128:131], a[112:115], v[216:219]
  s_add_u32 s68, s3, 62924800
  ds_read_b64_tr_b16 a[152:153], v112 offset:14336
  ds_read_b64_tr_b16 a[154:155], v112 offset:15104
  v_lshlrev_b32 v148, 16, v121
  v_mfma_f32_16x16x32_bf16 v[220:223], a[132:135], a[112:115], v[220:223]
  s_waitcnt lgkmcnt(8)
  ds_read_b64_tr_b16 a[156:157], v113 offset:14336
  ds_read_b64_tr_b16 a[158:159], v113 offset:15104
  buffer_load_dwordx4 v11, s[16:19], s50 offen offset:3072 lds
  v_mfma_f32_16x16x32_bf16 v[224:227], a[136:139], a[112:115], v[224:227]
  v_lshlrev_b32 v6, 4, v21
  ds_read_b64_tr_b16 a[160:161], v112 offset:14400
  ds_read_b64_tr_b16 a[162:163], v112 offset:15168
  ds_read_b64_tr_b16 a[24:25], v14 offset:36864
  ds_read_b64_tr_b16 a[26:27], v14 offset:38912
  v_mfma_f32_16x16x32_bf16 v[228:231], a[140:143], a[112:115], v[228:231]
  s_waitcnt lgkmcnt(10)
  ds_read_b64_tr_b16 a[164:165], v113 offset:14400
  ds_read_b64_tr_b16 a[166:167], v113 offset:15168
  v_and_b32 v149, 0xffff0000, v121
  v_mfma_f32_16x16x32_bf16 v[232:235], a[144:147], a[112:115], v[232:235]
  ds_read_b64_tr_b16 a[168:169], v112 offset:14464
  ds_read_b64_tr_b16 a[170:171], v112 offset:15232
  v_sub_f32 v146, v146, v148
  v_mfma_f32_16x16x32_bf16 v[236:239], a[148:151], a[112:115], v[236:239]
  s_waitcnt lgkmcnt(8)
  ds_read_b64_tr_b16 a[172:173], v113 offset:14464
  ds_read_b64_tr_b16 a[174:175], v113 offset:15232
  ds_read_b64_tr_b16 a[28:29], v15 offset:36864
  ds_read_b64_tr_b16 a[30:31], v15 offset:38912
  v_mfma_f32_16x16x32_bf16 v[216:219], a[152:155], a[116:119], v[216:219]
  ds_read_b64_tr_b16 a[176:177], v112 offset:20480
  ds_read_b64_tr_b16 a[178:179], v112 offset:21248
  v_sub_f32 v147, v147, v149
  v_mfma_f32_16x16x32_bf16 v[220:223], a[156:159], a[116:119], v[220:223]
  s_waitcnt lgkmcnt(8)
  ds_read_b64_tr_b16 a[180:181], v113 offset:20480
  ds_read_b64_tr_b16 a[182:183], v113 offset:21248
  s_waitcnt lgkmcnt(4)
  v_cvt_pk_bf16_f32 v120, v148, v146
  v_mfma_f32_16x16x32_bf16 v[224:227], a[160:163], a[116:119], v[224:227]
  s_add_u32 m0, s47, 135168
  ds_read_b64_tr_b16 a[184:185], v112 offset:20544
  ds_read_b64_tr_b16 a[186:187], v112 offset:21312
  v_cvt_pk_bf16_f32 v122, v147, v149
  v_mfma_f32_16x16x32_bf16 v[228:231], a[164:167], a[116:119], v[228:231]
  ds_read_b64_tr_b16 a[188:189], v113 offset:20544
  ds_read_b64_tr_b16 a[190:191], v113 offset:21312
  v_mfma_f32_16x16x32_bf16 v[232:235], a[168:171], a[116:119], v[232:235]
  s_add_u32 s50, s39, 327680
  ds_read_b64_tr_b16 a[192:193], v112 offset:20608
  ds_read_b64_tr_b16 a[194:195], v112 offset:21376
  buffer_load_dwordx4 v8, s[16:19], s50 offen offset:0 lds
  v_mov_b32 v123, 0
  v_mfma_f32_16x16x32_bf16 v[236:239], a[172:175], a[116:119], v[236:239]
  s_waitcnt lgkmcnt(6)
  ds_read_b64_tr_b16 a[196:197], v113 offset:20608
  ds_read_b64_tr_b16 a[198:199], v113 offset:21376
  s_waitcnt vmcnt(6)
  ds_read_b64_tr_b16 a[32:33], v12 offset:4096
  ds_read_b64_tr_b16 a[34:35], v12 offset:6144
  v_mfma_f32_16x16x32_bf16 v[216:219], a[176:179], a[120:123], v[216:219]
  ds_read_b64_tr_b16 a[128:129], v112 offset:26624
  ds_read_b64_tr_b16 a[130:131], v112 offset:27392
  v_mov_b32 v119, v118
  v_mfma_f32_16x16x32_bf16 v[220:223], a[180:183], a[120:123], v[220:223]
  s_waitcnt lgkmcnt(8)
  ds_read_b64_tr_b16 a[132:133], v113 offset:26624
  ds_read_b64_tr_b16 a[134:135], v113 offset:27392
  buffer_load_dwordx4 v9, s[16:19], s50 offen offset:1024 lds
  v_mfma_f32_16x16x32_bf16 v[224:227], a[184:187], a[120:123], v[224:227]
  ds_read_b64_tr_b16 a[136:137], v112 offset:26688
  ds_read_b64_tr_b16 a[138:139], v112 offset:27456
  ds_read_b64_tr_b16 a[36:37], v13 offset:4096
  ds_read_b64_tr_b16 a[38:39], v13 offset:6144
  v_mfma_f32_16x16x32_bf16 v[228:231], a[188:191], a[120:123], v[228:231]
  s_waitcnt lgkmcnt(10)
  ds_read_b64_tr_b16 a[140:141], v113 offset:26688
  ds_read_b64_tr_b16 a[142:143], v113 offset:27456
  v_mfma_f32_16x16x32_bf16 v[232:235], a[192:195], a[120:123], v[232:235]
  ds_read_b64_tr_b16 a[144:145], v112 offset:26752
  ds_read_b64_tr_b16 a[146:147], v112 offset:27520
  buffer_load_dwordx4 v10, s[16:19], s50 offen offset:2048 lds
  v_mfma_f32_16x16x32_bf16 v[236:239], a[196:199], a[120:123], v[236:239]
  s_waitcnt lgkmcnt(8)
  ds_read_b64_tr_b16 a[148:149], v113 offset:26752
  ds_read_b64_tr_b16 a[150:151], v113 offset:27520
  ds_read_b64_tr_b16 a[40:41], v14 offset:4096
  ds_read_b64_tr_b16 a[42:43], v14 offset:6144
  v_mfma_f32_16x16x32_bf16 v[216:219], a[128:131], a[124:127], v[216:219]
  v_mfma_f32_16x16x32_bf16 v[220:223], a[132:135], a[124:127], v[220:223]
  s_waitcnt lgkmcnt(6)
  buffer_load_dwordx4 v11, s[16:19], s50 offen offset:3072 lds
  v_mfma_f32_16x16x32_bf16 v[224:227], a[136:139], a[124:127], v[224:227]
  ds_read_b64_tr_b16 a[44:45], v15 offset:4096
  ds_read_b64_tr_b16 a[46:47], v15 offset:6144
  v_mfma_f32_16x16x32_bf16 v[228:231], a[140:143], a[124:127], v[228:231]
  s_waitcnt lgkmcnt(4)
  v_mfma_f32_16x16x32_bf16 v[232:235], a[144:147], a[124:127], v[232:235]
  v_mfma_f32_16x16x32_bf16 v[236:239], a[148:151], a[124:127], v[236:239]
  s_nop 1
  v_mfma_f32_16x16x32_bf16 v[216:219], a[224:227], v[120:123], v[216:219]
  v_mfma_f32_16x16x32_bf16 v[220:223], a[228:231], v[120:123], v[220:223]
  v_mfma_f32_16x16x32_bf16 v[224:227], a[232:235], v[120:123], v[224:227]
  v_mfma_f32_16x16x32_bf16 v[228:231], a[236:239], v[120:123], v[228:231]
  v_mfma_f32_16x16x32_bf16 v[232:235], a[240:243], v[120:123], v[232:235]
  v_mfma_f32_16x16x32_bf16 v[236:239], a[244:247], v[120:123], v[236:239]
  s_waitcnt vmcnt(8)
  v_cmp_gt_i32 vcc, 1, v28
  s_cbranch_vccz Lspok157
  s_mov_b32 s5, 0
Lspin156:
  s_sleep 2
  buffer_load_dword v28, v29, s[20:23], s55 offen sc1
  s_add_u32 s5, s5, 1
  s_waitcnt vmcnt(0)
  v_cmp_gt_i32 vcc, 1, v28
  s_cbranch_vccz Lspok157
  s_cmp_lt_u32 s5, 0x10000
  s_cbranch_scc1 Lspin156
Lspok157:
  v_pk_mul_f32 v[216:217], v[216:217], v[118:119]
  v_pk_mul_f32 v[218:219], v[218:219], v[118:119]
  v_pk_mul_f32 v[220:221], v[220:221], v[118:119]
  v_pk_mul_f32 v[222:223], v[222:223], v[118:119]
  v_pk_mul_f32 v[240:241], v[216:217], v[216:217]
  v_pk_mul_f32 v[242:243], v[218:219], v[218:219]
  v_pk_mul_f32 v[244:245], v[220:221], v[220:221]
  v_pk_mul_f32 v[246:247], v[222:223], v[222:223]
  v_pk_fma_f32 v[240:241], v[240:241], s[60:61], v[22:23]
  v_pk_fma_f32 v[242:243], v[242:243], s[60:61], v[22:23]
  v_pk_fma_f32 v[244:245], v[244:245], s[60:61], v[22:23]
  v_pk_fma_f32 v[246:247], v[246:247], s[60:61], v[22:23]
  v_pk_mul_f32 v[240:241], v[240:241], v[216:217]
  v_pk_mul_f32 v[242:243], v[242:243], v[218:219]
  v_pk_mul_f32 v[244:245], v[244:245], v[220:221]
  v_pk_mul_f32 v[246:247], v[246:247], v[222:223]
  v_exp_f32 v240, v240
  v_exp_f32 v241, v241
  v_exp_f32 v242, v242
  v_exp_f32 v243, v243
  v_exp_f32 v244, v244
  v_exp_f32 v245, v245
  v_exp_f32 v246, v246
  v_exp_f32 v247, v247
  s_add_u32 s51, s38, 0
  buffer_load_dwordx4 v[128:131], v2, s[20:23], s51 offen sc1
  buffer_load_dwordx4 v[132:135], v3, s[20:23], s51 offen sc1
  s_waitcnt vmcnt(6)
  ds_read_b64_tr_b16 a[48:49], v12 offset:32768
  ds_read_b64_tr_b16 a[50:51], v12 offset:34816
  ds_read_b64_tr_b16 a[52:53], v13 offset:32768
  ds_read_b64_tr_b16 a[54:55], v13 offset:34816
  ds_read_b64_tr_b16 a[56:57], v14 offset:32768
  ds_read_b64_tr_b16 a[58:59], v14 offset:34816
  ds_read_b64_tr_b16 a[60:61], v15 offset:32768
  ds_read_b64_tr_b16 a[62:63], v15 offset:34816
  v_pk_add_f32 v[240:241], v[240:241], 1.0 op_sel_hi:[1,0]
  v_pk_add_f32 v[242:243], v[242:243], 1.0 op_sel_hi:[1,0]
  v_pk_add_f32 v[244:245], v[244:245], 1.0 op_sel_hi:[1,0]
  v_pk_add_f32 v[246:247], v[246:247], 1.0 op_sel_hi:[1,0]
  v_rcp_f32 v240, v240
  v_rcp_f32 v241, v241
  v_rcp_f32 v242, v242
  v_rcp_f32 v243, v243
  v_rcp_f32 v244, v244
  v_rcp_f32 v245, v245
  v_rcp_f32 v246, v246
  v_rcp_f32 v247, v247
  s_add_u32 s51, s38, 1024
  buffer_load_dwordx4 v[136:139], v2, s[20:23], s51 offen sc1
  buffer_load_dwordx4 v[140:143], v3, s[20:23], s51 offen sc1
  v_pk_mul_f32 v[216:217], v[216:217], v[240:241]
  v_pk_mul_f32 v[218:219], v[218:219], v[242:243]
  v_pk_mul_f32 v[220:221], v[220:221], v[244:245]
  v_pk_mul_f32 v[222:223], v[222:223], v[246:247]
  v_cvt_pk_bf16_f32 v248, v216, v217
  v_cvt_pk_bf16_f32 v249, v218, v219
  v_cvt_pk_bf16_f32 v250, v220, v221
  v_cvt_pk_bf16_f32 v251, v222, v223
  buffer_store_dwordx4 v[248:251], v2, s[24:27], s63 offen offset:0 sc1
  v_pk_mul_f32 v[224:225], v[224:225], v[118:119]
  v_pk_mul_f32 v[226:227], v[226:227], v[118:119]
  v_pk_mul_f32 v[228:229], v[228:229], v[118:119]
  v_pk_mul_f32 v[230:231], v[230:231], v[118:119]
  v_pk_mul_f32 v[240:241], v[224:225], v[224:225]
  v_pk_mul_f32 v[242:243], v[226:227], v[226:227]
  v_pk_mul_f32 v[244:245], v[228:229], v[228:229]
  v_pk_mul_f32 v[246:247], v[230:231], v[230:231]
  v_pk_fma_f32 v[240:241], v[240:241], s[60:61], v[22:23]
  v_pk_fma_f32 v[242:243], v[242:243], s[60:61], v[22:23]
  v_pk_fma_f32 v[244:245], v[244:245], s[60:61], v[22:23]
  v_pk_fma_f32 v[246:247], v[246:247], s[60:61], v[22:23]
  v_pk_mul_f32 v[240:241], v[240:241], v[224:225]
  v_pk_mul_f32 v[242:243], v[242:243], v[226:227]
  v_pk_mul_f32 v[244:245], v[244:245], v[228:229]
  v_pk_mul_f32 v[246:247], v[246:247], v[230:231]
  v_exp_f32 v240, v240
  v_exp_f32 v241, v241
  v_exp_f32 v242, v242
  v_exp_f32 v243, v243
  v_exp_f32 v244, v244
  v_exp_f32 v245, v245
  v_exp_f32 v246, v246
  v_exp_f32 v247, v247
  s_add_u32 s51, s38, 2048
  buffer_load_dwordx4 v[144:147], v2, s[20:23], s51 offen sc1
  buffer_load_dwordx4 v[148:151], v3, s[20:23], s51 offen sc1
  v_pk_add_f32 v[240:241], v[240:241], 1.0 op_sel_hi:[1,0]
  v_pk_add_f32 v[242:243], v[242:243], 1.0 op_sel_hi:[1,0]
  v_pk_add_f32 v[244:245], v[244:245], 1.0 op_sel_hi:[1,0]
  v_pk_add_f32 v[246:247], v[246:247], 1.0 op_sel_hi:[1,0]
  v_rcp_f32 v240, v240
  v_rcp_f32 v241, v241
  v_rcp_f32 v242, v242
  v_rcp_f32 v243, v243
  v_rcp_f32 v244, v244
  v_rcp_f32 v245, v245
  v_rcp_f32 v246, v246
  v_rcp_f32 v247, v247
  s_add_u32 s51, s38, 3072
  buffer_load_dwordx4 v[152:155], v2, s[20:23], s51 offen sc1
  buffer_load_dwordx4 v[156:159], v3, s[20:23], s51 offen sc1
  s_waitcnt vmcnt(9)
  ds_read_b64_tr_b16 a[128:129], v12 offset:36864
  ds_read_b64_tr_b16 a[130:131], v12 offset:38912
  ds_read_b64_tr_b16 a[132:133], v13 offset:36864
  ds_read_b64_tr_b16 a[134:135], v13 offset:38912
  ds_read_b64_tr_b16 a[136:137], v14 offset:36864
  ds_read_b64_tr_b16 a[138:139], v14 offset:38912
  ds_read_b64_tr_b16 a[140:141], v15 offset:36864
  ds_read_b64_tr_b16 a[142:143], v15 offset:38912
  v_pk_mul_f32 v[224:225], v[224:225], v[240:241]
  v_pk_mul_f32 v[226:227], v[226:227], v[242:243]
  v_pk_mul_f32 v[228:229], v[228:229], v[244:245]
  v_pk_mul_f32 v[230:231], v[230:231], v[246:247]
  v_cvt_pk_bf16_f32 v252, v224, v225
  v_cvt_pk_bf16_f32 v253, v226, v227
  v_cvt_pk_bf16_f32 v254, v228, v229
  v_cvt_pk_bf16_f32 v255, v230, v231
  buffer_store_dwordx4 v[252:255], v2, s[24:27], s63 offen offset:1024 sc1
  v_pk_mul_f32 v[232:233], v[232:233], v[118:119]
  v_pk_mul_f32 v[234:235], v[234:235], v[118:119]
  v_pk_mul_f32 v[236:237], v[236:237], v[118:119]
  v_pk_mul_f32 v[238:239], v[238:239], v[118:119]
  v_pk_mul_f32 v[240:241], v[232:233], v[232:233]
  v_pk_mul_f32 v[242:243], v[234:235], v[234:235]
  v_pk_mul_f32 v[244:245], v[236:237], v[236:237]
  v_pk_mul_f32 v[246:247], v[238:239], v[238:239]
  v_pk_fma_f32 v[240:241], v[240:241], s[60:61], v[22:23]
  v_pk_fma_f32 v[242:243], v[242:243], s[60:61], v[22:23]
  v_pk_fma_f32 v[244:245], v[244:245], s[60:61], v[22:23]
  v_pk_fma_f32 v[246:247], v[246:247], s[60:61], v[22:23]
  v_pk_mul_f32 v[240:241], v[240:241], v[232:233]
  v_pk_mul_f32 v[242:243], v[242:243], v[234:235]
  v_pk_mul_f32 v[244:245], v[244:245], v[236:237]
  v_pk_mul_f32 v[246:247], v[246:247], v[238:239]
  v_exp_f32 v240, v240
  v_exp_f32 v241, v241
  v_exp_f32 v242, v242
  v_exp_f32 v243, v243
  v_exp_f32 v244, v244
  v_exp_f32 v245, v245
  v_exp_f32 v246, v246
  v_exp_f32 v247, v247
  s_add_u32 s51, s38, 4096
  buffer_load_dwordx4 v[160:163], v2, s[20:23], s51 offen sc1
  buffer_load_dwordx4 v[164:167], v3, s[20:23], s51 offen sc1
  v_pk_add_f32 v[240:241], v[240:241], 1.0 op_sel_hi:[1,0]
  v_pk_add_f32 v[242:243], v[242:243], 1.0 op_sel_hi:[1,0]
  v_pk_add_f32 v[244:245], v[244:245], 1.0 op_sel_hi:[1,0]
  v_pk_add_f32 v[246:247], v[246:247], 1.0 op_sel_hi:[1,0]
  v_rcp_f32 v240, v240
  v_rcp_f32 v241, v241
  v_rcp_f32 v242, v242
  v_rcp_f32 v243, v243
  v_rcp_f32 v244, v244
  v_rcp_f32 v245, v245
  v_rcp_f32 v246, v246
  v_rcp_f32 v247, v247
  s_add_u32 s51, s38, 5120
  buffer_load_dwordx4 v[168:171], v2, s[20:23], s51 offen sc1
  buffer_load_dwordx4 v[172:175], v3, s[20:23], s51 offen sc1
  v_pk_mul_f32 v[232:233], v[232:233], v[240:241]
  v_pk_mul_f32 v[234:235], v[234:235], v[242:243]
  v_pk_mul_f32 v[236:237], v[236:237], v[244:245]
  v_pk_mul_f32 v[238:239], v[238:239], v[246:247]
  v_cvt_pk_bf16_f32 v248, v232, v233
  v_cvt_pk_bf16_f32 v249, v234, v235
  v_cvt_pk_bf16_f32 v250, v236, v237
  v_cvt_pk_bf16_f32 v251, v238, v239
  buffer_store_dwordx4 v[248:251], v2, s[24:27], s63 offen offset:2048 sc1
  v_mov_b32 v26, 2
  s_mov_b64 exec, 1
  buffer_store_dword v26, off, s[20:23], s86 sc1
  s_mov_b64 exec, -1
  s_waitcnt lgkmcnt(0)
  s_barrier
  s_mov_b32 s24, s84
  s_and_b32 s25, s85, 0xffff
  s_mov_b32 s26, 1024
  s_mov_b32 s27, 0x20000
  buffer_load_dwordx4 v[216:219], v7, s[20:23], s68 offen offset:0 sc1
  buffer_load_dwordx4 v[220:223], v7, s[20:23], s68 offen offset:16 sc1
  buffer_load_dwordx4 v[224:227], v6, s[24:27], s48 offen
  buffer_load_dwordx4 v[228:231], v5, s[20:23], s46 offen sc1
  s_add_u32 s46, s46, 16384
  buffer_load_dwordx4 v[232:235], v5, s[20:23], s46 offen sc1
  s_mov_b32 s24, s90
  s_and_b32 s25, s91, 0xffff
  s_mov_b32 s26, 2097152
  s_mov_b32 s27, 0x20000
  s_mov_b32 s3, 0
Ld0a:
  v_mov_b32 v22, 0
  v_mov_b32 v23, 0
  s_waitcnt vmcnt(19)
  v_mfma_f32_16x16x32_bf16 a[64:67], v[32:35], v[128:131], 0
  s_add_u32 s51, s38, 6144
  buffer_load_dwordx4 v[176:179], v2, s[20:23], s51 offen sc1
  v_mfma_f32_16x16x32_bf16 a[80:83], v[32:35], v[132:135], 0
  v_max3_u32 v22, v22, v128, v129
  v_mfma_f32_16x16x32_bf16 a[84:87], v[36:39], v[132:135], 0
  v_mfma_f32_16x16x32_bf16 a[68:71], v[36:39], v[128:131], 0
  v_max3_u32 v23, v23, v130, v131
  v_mfma_f32_16x16x32_bf16 a[72:75], v[40:43], v[128:131], 0
  buffer_load_dwordx4 v[180:183], v3, s[20:23], s51 offen sc1
  v_mfma_f32_16x16x32_bf16 a[88:91], v[40:43], v[132:135], 0
  v_max3_u32 v22, v22, v132, v133
  v_mfma_f32_16x16x32_bf16 a[92:95], v[44:47], v[132:135], 0
  v_mfma_f32_16x16x32_bf16 a[76:79], v[44:47], v[128:131], 0
  v_max3_u32 v23, v23, v134, v135
  s_waitcnt vmcnt(19)
  v_mfma_f32_16x16x32_bf16 a[76:79], v[60:63], v[136:139], a[76:79]
  s_add_u32 s51, s38, 7168
  buffer_load_dwordx4 v[184:187], v2, s[20:23], s51 offen sc1
  v_mfma_f32_16x16x32_bf16 a[92:95], v[60:63], v[140:143], a[92:95]
  v_max3_u32 v22, v22, v136, v137
  v_mfma_f32_16x16x32_bf16 a[88:91], v[56:59], v[140:143], a[88:91]
  v_mfma_f32_16x16x32_bf16 a[72:75], v[56:59], v[136:139], a[72:75]
  v_max3_u32 v23, v23, v138, v139
  v_mfma_f32_16x16x32_bf16 a[68:71], v[52:55], v[136:139], a[68:71]
  buffer_load_dwordx4 v[188:191], v3, s[20:23], s51 offen sc1
  v_mfma_f32_16x16x32_bf16 a[84:87], v[52:55], v[140:143], a[84:87]
  v_max3_u32 v22, v22, v140, v141
  v_mfma_f32_16x16x32_bf16 a[80:83], v[48:51], v[140:143], a[80:83]
  v_mfma_f32_16x16x32_bf16 a[64:67], v[48:51], v[136:139], a[64:67]
  v_max3_u32 v23, v23, v142, v143
  s_waitcnt vmcnt(18)
  v_mfma_f32_16x16x32_bf16 a[64:67], v[64:67], v[144:147], a[64:67]
  s_add_u32 s51, s38, 8192
  buffer_load_dwordx4 v[192:195], v2, s[20:23], s51 offen sc1
  v_mfma_f32_16x16x32_bf16 a[80:83], v[64:67], v[148:151], a[80:83]
  v_max3_u32 v22, v22, v144, v145
  v_mfma_f32_16x16x32_bf16 a[84:87], v[68:71], v[148:151], a[84:87]
  v_mfma_f32_16x16x32_bf16 a[68:71], v[68:71], v[144:147], a[68:71]
  v_max3_u32 v23, v23, v146, v147
  v_mfma_f32_16x16x32_bf16 a[72:75], v[72:75], v[144:147], a[72:75]
  buffer_load_dwordx4 v[196:199], v3, s[20:23], s51 offen sc1
  v_mfma_f32_16x16x32_bf16 a[88:91], v[72:75], v[148:151], a[88:91]
  v_max3_u32 v22, v22, v148, v149
  v_mfma_f32_16x16x32_bf16 a[92:95], v[76:79], v[148:151], a[92:95]
  v_mfma_f32_16x16x32_bf16 a[76:79], v[76:79], v[144:147], a[76:79]
  v_max3_u32 v23, v23, v150, v151
  s_waitcnt vmcnt(18)
  v_mfma_f32_16x16x32_bf16 a[76:79], v[92:95], v[152:155], a[76:79]
  s_add_u32 s51, s38, 9216
  buffer_load_dwordx4 v[200:203], v2, s[20:23], s51 offen sc1
  v_mfma_f32_16x16x32_bf16 a[92:95], v[92:95], v[156:159], a[92:95]
  v_max3_u32 v22, v22, v152, v153
  v_mfma_f32_16x16x32_bf16 a[88:91], v[88:91], v[156:159], a[88:91]
  v_mfma_f32_16x16x32_bf16 a[72:75], v[88:91], v[152:155], a[72:75]
  v_max3_u32 v23, v23, v154, v155
  v_mfma_f32_16x16x32_bf16 a[68:71], v[84:87], v[152:155], a[68:71]
  buffer_load_dwordx4 v[204:207], v3, s[20:23], s51 offen sc1
  v_mfma_f32_16x16x32_bf16 a[84:87], v[84:87], v[156:159], a[84:87]
  v_max3_u32 v22, v22, v156, v157
  v_mfma_f32_16x16x32_bf16 a[80:83], v[80:83], v[156:159], a[80:83]
  v_mfma_f32_16x16x32_bf16 a[64:67], v[80:83], v[152:155], a[64:67]
  v_max3_u32 v23, v23, v158, v159
  s_waitcnt vmcnt(17)
  v_mfma_f32_16x16x32_bf16 a[64:67], a[200:203], v[160:163], a[64:67]
  s_add_u32 s51, s38, 10240
  buffer_load_dwordx4 v[208:211], v2, s[20:23], s51 offen sc1
  v_mfma_f32_16x16x32_bf16 a[80:83], a[200:203], v[164:167], a[80:83]
  v_max3_u32 v22, v22, v160, v161
  v_mfma_f32_16x16x32_bf16 a[84:87], a[204:207], v[164:167], a[84:87]
  v_mfma_f32_16x16x32_bf16 a[68:71], a[204:207], v[160:163], a[68:71]
  v_max3_u32 v23, v23, v162, v163
  v_mfma_f32_16x16x32_bf16 a[72:75], a[208:211], v[160:163], a[72:75]
  buffer_load_dwordx4 v[212:215], v3, s[20:23], s51 offen sc1
  v_mfma_f32_16x16x32_bf16 a[88:91], a[208:211], v[164:167], a[88:91]
  v_max3_u32 v22, v22, v164, v165
  v_mfma_f32_16x16x32_bf16 a[92:95], a[212:215], v[164:167], a[92:95]
  v_mfma_f32_16x16x32_bf16 a[76:79], a[212:215], v[160:163], a[76:79]
  v_max3_u32 v23, v23, v166, v167
  s_waitcnt vmcnt(17)
  v_mfma_f32_16x16x32_bf16 a[76:79], v[108:111], v[168:171], a[76:79]
  v_mfma_f32_16x16x32_bf16 a[92:95], v[108:111], v[172:175], a[92:95]
  v_max3_u32 v22, v22, v168, v169
  v_mfma_f32_16x16x32_bf16 a[88:91], v[104:107], v[172:175], a[88:91]
  v_mfma_f32_16x16x32_bf16 a[72:75], v[104:107], v[168:171], a[72:75]
  v_max3_u32 v23, v23, v170, v171
  v_mfma_f32_16x16x32_bf16 a[68:71], v[100:103], v[168:171], a[68:71]
  v_mfma_f32_16x16x32_bf16 a[84:87], v[100:103], v[172:175], a[84:87]
  v_max3_u32 v22, v22, v172, v173
  v_mfma_f32_16x16x32_bf16 a[80:83], v[96:99], v[172:175], a[80:83]
  v_mfma_f32_16x16x32_bf16 a[64:67], v[96:99], v[168:171], a[64:67]
  v_max3_u32 v23, v23, v174, v175
  s_waitcnt vmcnt(8)
  buffer_load_dword v28, v29, s[20:23], s55 offen sc1
  v_mfma_f32_16x16x32_bf16 a[64:67], a[0:3], v[176:179], a[64:67]
  v_mfma_f32_16x16x32_bf16 a[80:83], a[0:3], v[180:183], a[80:83]
  v_max3_u32 v22, v22, v176, v177
  v_mfma_f32_16x16x32_bf16 a[84:87], a[4:7], v[180:183], a[84:87]
  v_mfma_f32_16x16x32_bf16 a[68:71], a[4:7], v[176:179], a[68:71]
  v_max3_u32 v23, v23, v178, v179
  v_mfma_f32_16x16x32_bf16 a[72:75], a[8:11], v[176:179], a[72:75]
  v_mfma_f32_16x16x32_bf16 a[88:91], a[8:11], v[180:183], a[88:91]
  v_max3_u32 v22, v22, v180, v181
  v_mfma_f32_16x16x32_bf16 a[92:95], a[12:15], v[180:183], a[92:95]
  v_mfma_f32_16x16x32_bf16 a[76:79], a[12:15], v[176:179], a[76:79]
  v_max3_u32 v23, v23, v182, v183
  s_waitcnt vmcnt(7)
  v_mfma_f32_16x16x32_bf16 a[76:79], a[28:31], v[184:187], a[76:79]
  v_mfma_f32_16x16x32_bf16 a[92:95], a[28:31], v[188:191], a[92:95]
  v_max3_u32 v22, v22, v184, v185
  v_mfma_f32_16x16x32_bf16 a[88:91], a[24:27], v[188:191], a[88:91]
  v_mfma_f32_16x16x32_bf16 a[72:75], a[24:27], v[184:187], a[72:75]
  v_max3_u32 v23, v23, v186, v187
  v_mfma_f32_16x16x32_bf16 a[68:71], a[20:23], v[184:187], a[68:71]
  v_mfma_f32_16x16x32_bf16 a[84:87], a[20:23], v[188:191], a[84:87]
  v_max3_u32 v22, v22, v188, v189
  v_mfma_f32_16x16x32_bf16 a[80:83], a[16:19], v[188:191], a[80:83]
  v_mfma_f32_16x16x32_bf16 a[64:67], a[16:19], v[184:187], a[64:67]
  v_max3_u32 v23, v23, v190, v191
  s_waitcnt vmcnt(5)
  v_mfma_f32_16x16x32_bf16 a[64:67], a[32:35], v[192:195], a[64:67]
  v_mfma_f32_16x16x32_bf16 a[80:83], a[32:35], v[196:199], a[80:83]
  v_max3_u32 v22, v22, v192, v193
  v_mfma_f32_16x16x32_bf16 a[84:87], a[36:39], v[196:199], a[84:87]
  v_mfma_f32_16x16x32_bf16 a[68:71], a[36:39], v[192:195], a[68:71]
  v_max3_u32 v23, v23, v194, v195
  v_mfma_f32_16x16x32_bf16 a[72:75], a[40:43], v[192:195], a[72:75]
  v_mfma_f32_16x16x32_bf16 a[88:91], a[40:43], v[196:199], a[88:91]
  v_max3_u32 v22, v22, v196, v197
  v_mfma_f32_16x16x32_bf16 a[92:95], a[44:47], v[196:199], a[92:95]
  v_mfma_f32_16x16x32_bf16 a[76:79], a[44:47], v[192:195], a[76:79]
  v_max3_u32 v23, v23, v198, v199
  s_waitcnt vmcnt(3)
  v_mfma_f32_16x16x32_bf16 a[76:79], a[60:63], v[200:203], a[76:79]
  v_mfma_f32_16x16x32_bf16 a[92:95], a[60:63], v[204:207], a[92:95]
  v_max3_u32 v22, v22, v200, v201
  v_mfma_f32_16x16x32_bf16 a[88:91], a[56:59], v[204:207], a[88:91]
  v_mfma_f32_16x16x32_bf16 a[72:75], a[56:59], v[200:203], a[72:75]
  v_max3_u32 v23, v23, v202, v203
  v_mfma_f32_16x16x32_bf16 a[68:71], a[52:55], v[200:203], a[68:71]
  v_mfma_f32_16x16x32_bf16 a[84:87], a[52:55], v[204:207], a[84:87]
  v_max3_u32 v22, v22, v204, v205
  v_mfma_f32_16x16x32_bf16 a[80:83], a[48:51], v[204:207], a[80:83]
  v_mfma_f32_16x16x32_bf16 a[64:67], a[48:51], v[200:203], a[64:67]
  v_max3_u32 v23, v23, v206, v207
  s_waitcnt vmcnt(1)
  s_cmp_eq_u32 s40, 3
  s_cbranch_scc1 Ld0s
  v_mfma_f32_16x16x32_bf16 a[64:67], a[128:131], v[208:211], a[64:67]
  v_mfma_f32_16x16x32_bf16 a[80:83], a[128:131], v[212:215], a[80:83]
  v_max3_u32 v22, v22, v208, v209
  v_mfma_f32_16x16x32_bf16 a[84:87], a[132:135], v[212:215], a[84:87]
  v_mfma_f32_16x16x32_bf16 a[68:71], a[132:135], v[208:211], a[68:71]
  v_max3_u32 v23, v23, v210, v211
  v_mfma_f32_16x16x32_bf16 a[72:75], a[136:139], v[208:211], a[72:75]
  v_mfma_f32_16x16x32_bf16 a[88:91], a[136:139], v[212:215], a[88:91]
  v_max3_u32 v22, v22, v212, v213
  v_mfma_f32_16x16x32_bf16 a[92:95], a[140:143], v[212:215], a[92:95]
  v_mfma_f32_16x16x32_bf16 a[76:79], a[140:143], v[208:211], a[76:79]
  v_max3_u32 v23, v23, v214, v215
Ld0s:
  v_max_u32 v22, v22, v23
  v_cmp_eq_u32 vcc, -1, v22
  s_cbranch_vccz Ld0o
  s_add_u32 s3, s3, 1
  s_cmp_ge_u32 s3, 0x800
  s_cbranch_scc1 Ld0o
  s_add_u32 s51, s38, 0
  buffer_load_dwordx4 v[128:131], v2, s[20:23], s51 offen sc1
  buffer_load_dwordx4 v[132:135], v3, s[20:23], s51 offen sc1
  s_add_u32 s51, s38, 1024
  buffer_load_dwordx4 v[136:139], v2, s[20:23], s51 offen sc1
  buffer_load_dwordx4 v[140:143], v3, s[20:23], s51 offen sc1
  s_add_u32 s51, s38, 2048
  buffer_load_dwordx4 v[144:147], v2, s[20:23], s51 offen sc1
  buffer_load_dwordx4 v[148:151], v3, s[20:23], s51 offen sc1
  s_add_u32 s51, s38, 3072
  buffer_load_dwordx4 v[152:155], v2, s[20:23], s51 offen sc1
  buffer_load_dwordx4 v[156:159], v3, s[20:23], s51 offen sc1
  s_add_u32 s51, s38, 4096
  buffer_load_dwordx4 v[160:163], v2, s[20:23], s51 offen sc1
  buffer_load_dwordx4 v[164:167], v3, s[20:23], s51 offen sc1
  s_add_u32 s51, s38, 5120
  buffer_load_dwordx4 v[168:171], v2, s[20:23], s51 offen sc1
  buffer_load_dwordx4 v[172:175], v3, s[20:23], s51 offen sc1
  s_add_u32 s51, s38, 6144
  buffer_load_dwordx4 v[176:179], v2, s[20:23], s51 offen sc1
  buffer_load_dwordx4 v[180:183], v3, s[20:23], s51 offen sc1
  s_add_u32 s51, s38, 7168
  buffer_load_dwordx4 v[184:187], v2, s[20:23], s51 offen sc1
  buffer_load_dwordx4 v[188:191], v3, s[20:23], s51 offen sc1
  s_add_u32 s51, s38, 8192
  buffer_load_dwordx4 v[192:195], v2, s[20:23], s51 offen sc1
  buffer_load_dwordx4 v[196:199], v3, s[20:23], s51 offen sc1
  s_add_u32 s51, s38, 9216
  buffer_load_dwordx4 v[200:203], v2, s[20:23], s51 offen sc1
  buffer_load_dwordx4 v[204:207], v3, s[20:23], s51 offen sc1
  s_add_u32 s51, s38, 10240
  buffer_load_dwordx4 v[208:211], v2, s[20:23], s51 offen sc1
  buffer_load_dwordx4 v[212:215], v3, s[20:23], s51 offen sc1
  s_waitcnt vmcnt(0)
  s_branch Ld0a
Ld0o:
  s_nop 3
  ds_write_b128 v16, a[64:67] offset:0
  ds_write_b128 v16, a[68:71] offset:1024
  ds_write_b128 v16, a[72:75] offset:2048
  ds_write_b128 v16, a[76:79] offset:3072
  ds_write_b128 v16, a[80:83] offset:4096
  ds_write_b128 v16, a[84:87] offset:5120
  ds_write_b128 v16, a[88:91] offset:6144
  ds_write_b128 v16, a[92:95] offset:7168
  s_waitcnt vmcnt(0)
  v_cmp_gt_i32 vcc, 2, v28
  s_cbranch_vccz Lspok159
  s_mov_b32 s5, 0
Lspin158:
  s_sleep 2
  buffer_load_dword v28, v29, s[20:23], s55 offen sc1
  s_add_u32 s5, s5, 1
  s_waitcnt vmcnt(0)
  v_cmp_gt_i32 vcc, 2, v28
  s_cbranch_vccz Lspok159
  s_cmp_lt_u32 s5, 0x10000
  s_cbranch_scc1 Lspin158
Lspok159:
  s_add_u32 s38, s38, 44032
  s_add_u32 s51, s38, 0
  buffer_load_dwordx4 v[128:131], v2, s[20:23], s51 offen sc1
  buffer_load_dwordx4 v[132:135], v3, s[20:23], s51 offen sc1
  s_add_u32 s51, s38, 1024
  buffer_load_dwordx4 v[136:139], v2, s[20:23], s51 offen sc1
  buffer_load_dwordx4 v[140:143], v3, s[20:23], s51 offen sc1
  s_add_u32 s51, s38, 2048
  buffer_load_dwordx4 v[144:147], v2, s[20:23], s51 offen sc1
  buffer_load_dwordx4 v[148:151], v3, s[20:23], s51 offen sc1
  s_add_u32 s51, s38, 3072
  buffer_load_dwordx4 v[152:155], v2, s[20:23], s51 offen sc1
  buffer_load_dwordx4 v[156:159], v3, s[20:23], s51 offen sc1
  s_add_u32 s51, s38, 4096
  buffer_load_dwordx4 v[160:163], v2, s[20:23], s51 offen sc1
  buffer_load_dwordx4 v[164:167], v3, s[20:23], s51 offen sc1
  s_add_u32 s51, s38, 5120
  buffer_load_dwordx4 v[168:171], v2, s[20:23], s51 offen sc1
  buffer_load_dwordx4 v[172:175], v3, s[20:23], s51 offen sc1
  s_add_u32 s51, s38, 6144
  buffer_load_dwordx4 v[176:179], v2, s[20:23], s51 offen sc1
  buffer_load_dwordx4 v[180:183], v3, s[20:23], s51 offen sc1
  s_waitcnt lgkmcnt(0)
  s_barrier
  ds_read_b128 v[112:115], v17 offset:0
  ds_read_b128 v[116:119], v17 offset:256
  ds_read_b128 v[120:123], v17 offset:8192
  ds_read_b128 v[124:127], v17 offset:8448
  ds_read_b128 v[240:243], v17 offset:16384
  ds_read_b128 v[244:247], v17 offset:16640
  ds_read_b128 v[248:251], v17 offset:24576
  ds_read_b128 v[252:255], v17 offset:24832
  s_waitcnt lgkmcnt(4)
  v_pk_add_f32 v[112:113], v[112:113], v[120:121]
  v_pk_add_f32 v[114:115], v[114:115], v[122:123]
  v_pk_add_f32 v[116:117], v[116:117], v[124:125]
  v_pk_add_f32 v[118:119], v[118:119], v[126:127]
  v_lshlrev_b32 v120, 16, v224
  v_and_b32 v121, 0xffff0000, v224
  v_lshlrev_b32 v122, 16, v225
  v_and_b32 v123, 0xffff0000, v225
  v_lshlrev_b32 v124, 16, v226
  v_and_b32 v125, 0xffff0000, v226
  v_lshlrev_b32 v126, 16, v227
  v_and_b32 v127, 0xffff0000, v227
  s_waitcnt lgkmcnt(0)
  v_pk_add_f32 v[240:241], v[240:241], v[248:249]
  v_pk_add_f32 v[242:243], v[242:243], v[250:251]
  v_pk_add_f32 v[244:245], v[244:245], v[252:253]
  v_pk_add_f32 v[246:247], v[246:247], v[254:255]
  v_pk_add_f32 v[112:113], v[112:113], v[120:121]
  v_pk_add_f32 v[114:115], v[114:115], v[122:123]
  v_pk_add_f32 v[116:117], v[116:117], v[124:125]
  v_pk_add_f32 v[118:119], v[118:119], v[126:127]
  v_lshlrev_b32 v248, 16, v228
  v_and_b32 v249, 0xffff0000, v228
  v_lshlrev_b32 v250, 16, v229
  v_and_b32 v251, 0xffff0000, v229
  v_lshlrev_b32 v252, 16, v230
  v_and_b32 v253, 0xffff0000, v230
  v_lshlrev_b32 v254, 16, v231
  v_and_b32 v255, 0xffff0000, v231
  v_pk_add_f32 v[112:113], v[112:113], v[240:241]
  v_pk_add_f32 v[114:115], v[114:115], v[242:243]
  v_pk_add_f32 v[116:117], v[116:117], v[244:245]
  v_pk_add_f32 v[118:119], v[118:119], v[246:247]
  v_pk_fma_f32 v[248:249], v[112:113], v[216:217], v[248:249]
  v_pk_fma_f32 v[250:251], v[114:115], v[218:219], v[250:251]
  v_pk_fma_f32 v[252:253], v[116:117], v[220:221], v[252:253]
  v_pk_fma_f32 v[254:255], v[118:119], v[222:223], v[254:255]
  v_cvt_pk_bf16_f32 v236, v248, v249
  v_cvt_pk_bf16_f32 v237, v250, v251
  v_cvt_pk_bf16_f32 v238, v252, v253
  v_cvt_pk_bf16_f32 v239, v254, v255
  buffer_store_dwordx4 v[236:239], v5, s[24:27], s66 offen nt
  s_mov_b32 s3, 0
Ld1a:
  v_mov_b32 v22, 0
  v_mov_b32 v23, 0
  s_waitcnt vmcnt(13)
  v_mfma_f32_16x16x32_bf16 a[96:99], v[32:35], v[128:131], 0
  s_add_u32 s51, s38, 7168
  buffer_load_dwordx4 v[184:187], v2, s[20:23], s51 offen sc1
  v_mfma_f32_16x16x32_bf16 a[112:115], v[32:35], v[132:135], 0
  v_max3_u32 v22, v22, v128, v129
  v_mfma_f32_16x16x32_bf16 a[116:119], v[36:39], v[132:135], 0
  v_mfma_f32_16x16x32_bf16 a[100:103], v[36:39], v[128:131], 0
  v_max3_u32 v23, v23, v130, v131
  v_mfma_f32_16x16x32_bf16 a[104:107], v[40:43], v[128:131], 0
  buffer_load_dwordx4 v[188:191], v3, s[20:23], s51 offen sc1
  v_mfma_f32_16x16x32_bf16 a[120:123], v[40:43], v[132:135], 0
  v_max3_u32 v22, v22, v132, v133
  v_mfma_f32_16x16x32_bf16 a[124:127], v[44:47], v[132:135], 0
  v_mfma_f32_16x16x32_bf16 a[108:111], v[44:47], v[128:131], 0
  v_max3_u32 v23, v23, v134, v135
  s_waitcnt vmcnt(13)
  v_mfma_f32_16x16x32_bf16 a[108:111], v[60:63], v[136:139], a[108:111]
  s_add_u32 s51, s38, 8192
  buffer_load_dwordx4 v[192:195], v2, s[20:23], s51 offen sc1
  v_mfma_f32_16x16x32_bf16 a[124:127], v[60:63], v[140:143], a[124:127]
  v_max3_u32 v22, v22, v136, v137
  v_mfma_f32_16x16x32_bf16 a[120:123], v[56:59], v[140:143], a[120:123]
  v_mfma_f32_16x16x32_bf16 a[104:107], v[56:59], v[136:139], a[104:107]
  v_max3_u32 v23, v23, v138, v139
  v_mfma_f32_16x16x32_bf16 a[100:103], v[52:55], v[136:139], a[100:103]
  buffer_load_dwordx4 v[196:199], v3, s[20:23], s51 offen sc1
  v_mfma_f32_16x16x32_bf16 a[116:119], v[52:55], v[140:143], a[116:119]
  v_max3_u32 v22, v22, v140, v141
  v_mfma_f32_16x16x32_bf16 a[112:115], v[48:51], v[140:143], a[112:115]
  v_mfma_f32_16x16x32_bf16 a[96:99], v[48:51], v[136:139], a[96:99]
  v_max3_u32 v23, v23, v142, v143
  s_waitcnt vmcnt(13)
  v_mfma_f32_16x16x32_bf16 a[96:99], v[64:67], v[144:147], a[96:99]
  s_add_u32 s51, s38, 9216
  buffer_load_dwordx4 v[200:203], v2, s[20:23], s51 offen sc1
  v_mfma_f32_16x16x32_bf16 a[112:115], v[64:67], v[148:151], a[112:115]
  v_max3_u32 v22, v22, v144, v145
  v_mfma_f32_16x16x32_bf16 a[116:119], v[68:71], v[148:151], a[116:119]
  v_mfma_f32_16x16x32_bf16 a[100:103], v[68:71], v[144:147], a[100:103]
  v_max3_u32 v23, v23, v146, v147
  v_mfma_f32_16x16x32_bf16 a[104:107], v[72:75], v[144:147], a[104:107]
  buffer_load_dwordx4 v[204:207], v3, s[20:23], s51 offen sc1
  v_mfma_f32_16x16x32_bf16 a[120:123], v[72:75], v[148:151], a[120:123]
  v_max3_u32 v22, v22, v148, v149
  v_mfma_f32_16x16x32_bf16 a[124:127], v[76:79], v[148:151], a[124:127]
  v_mfma_f32_16x16x32_bf16 a[108:111], v[76:79], v[144:147], a[108:111]
  v_max3_u32 v23, v23, v150, v151
  s_waitcnt vmcnt(13)
  v_mfma_f32_16x16x32_bf16 a[108:111], v[92:95], v[152:155], a[108:111]
  s_add_u32 s51, s38, 10240
  buffer_load_dwordx4 v[208:211], v2, s[20:23], s51 offen sc1
  v_mfma_f32_16x16x32_bf16 a[124:127], v[92:95], v[156:159], a[124:127]
  v_max3_u32 v22, v22, v152, v153
  v_mfma_f32_16x16x32_bf16 a[120:123], v[88:91], v[156:159], a[120:123]
  v_mfma_f32_16x16x32_bf16 a[104:107], v[88:91], v[152:155], a[104:107]
  v_max3_u32 v23, v23, v154, v155
  v_mfma_f32_16x16x32_bf16 a[100:103], v[84:87], v[152:155], a[100:103]
  buffer_load_dwordx4 v[212:215], v3, s[20:23], s51 offen sc1
  v_mfma_f32_16x16x32_bf16 a[116:119], v[84:87], v[156:159], a[116:119]
  v_max3_u32 v22, v22, v156, v157
  v_mfma_f32_16x16x32_bf16 a[112:115], v[80:83], v[156:159], a[112:115]
  v_mfma_f32_16x16x32_bf16 a[96:99], v[80:83], v[152:155], a[96:99]
  v_max3_u32 v23, v23, v158, v159
  s_waitcnt vmcnt(13)
  v_mfma_f32_16x16x32_bf16 a[96:99], a[200:203], v[160:163], a[96:99]
  v_mfma_f32_16x16x32_bf16 a[112:115], a[200:203], v[164:167], a[112:115]
  v_max3_u32 v22, v22, v160, v161
  v_mfma_f32_16x16x32_bf16 a[116:119], a[204:207], v[164:167], a[116:119]
  v_mfma_f32_16x16x32_bf16 a[100:103], a[204:207], v[160:163], a[100:103]
  v_max3_u32 v23, v23, v162, v163
  v_mfma_f32_16x16x32_bf16 a[104:107], a[208:211], v[160:163], a[104:107]
  v_mfma_f32_16x16x32_bf16 a[120:123], a[208:211], v[164:167], a[120:123]
  v_max3_u32 v22, v22, v164, v165
  v_mfma_f32_16x16x32_bf16 a[124:127], a[212:215], v[164:167], a[124:127]
  v_mfma_f32_16x16x32_bf16 a[108:111], a[212:215], v[160:163], a[108:111]
  v_max3_u32 v23, v23, v166, v167
  s_waitcnt vmcnt(11)
  v_mfma_f32_16x16x32_bf16 a[108:111], v[108:111], v[168:171], a[108:111]
  v_mfma_f32_16x16x32_bf16 a[124:127], v[108:111], v[172:175], a[124:127]
  v_max3_u32 v22, v22, v168, v169
  v_mfma_f32_16x16x32_bf16 a[120:123], v[104:107], v[172:175], a[120:123]
  v_mfma_f32_16x16x32_bf16 a[104:107], v[104:107], v[168:171], a[104:107]
  v_max3_u32 v23, v23, v170, v171
  v_mfma_f32_16x16x32_bf16 a[100:103], v[100:103], v[168:171], a[100:103]
  v_mfma_f32_16x16x32_bf16 a[116:119], v[100:103], v[172:175], a[116:119]
  v_max3_u32 v22, v22, v172, v173
  v_mfma_f32_16x16x32_bf16 a[112:115], v[96:99], v[172:175], a[112:115]
  v_mfma_f32_16x16x32_bf16 a[96:99], v[96:99], v[168:171], a[96:99]
  v_max3_u32 v23, v23, v174, v175
  s_waitcnt vmcnt(9)
  v_mfma_f32_16x16x32_bf16 a[96:99], a[0:3], v[176:179], a[96:99]
  v_mfma_f32_16x16x32_bf16 a[112:115], a[0:3], v[180:183], a[112:115]
  v_max3_u32 v22, v22, v176, v177
  v_mfma_f32_16x16x32_bf16 a[116:119], a[4:7], v[180:183], a[116:119]
  v_mfma_f32_16x16x32_bf16 a[100:103], a[4:7], v[176:179], a[100:103]
  v_max3_u32 v23, v23, v178, v179
  v_mfma_f32_16x16x32_bf16 a[104:107], a[8:11], v[176:179], a[104:107]
  v_mfma_f32_16x16x32_bf16 a[120:123], a[8:11], v[180:183], a[120:123]
  v_max3_u32 v22, v22, v180, v181
  v_mfma_f32_16x16x32_bf16 a[124:127], a[12:15], v[180:183], a[124:127]
  v_mfma_f32_16x16x32_bf16 a[108:111], a[12:15], v[176:179], a[108:111]
  v_max3_u32 v23, v23, v182, v183
  s_waitcnt vmcnt(6)
  v_mfma_f32_16x16x32_bf16 a[108:111], a[28:31], v[184:187], a[108:111]
  v_mfma_f32_16x16x32_bf16 a[124:127], a[28:31], v[188:191], a[124:127]
  v_max3_u32 v22, v22, v184, v185
  v_mfma_f32_16x16x32_bf16 a[120:123], a[24:27], v[188:191], a[120:123]
  v_mfma_f32_16x16x32_bf16 a[104:107], a[24:27], v[184:187], a[104:107]
  v_max3_u32 v23, v23, v186, v187
  v_mfma_f32_16x16x32_bf16 a[100:103], a[20:23], v[184:187], a[100:103]
  v_mfma_f32_16x16x32_bf16 a[116:119], a[20:23], v[188:191], a[116:119]
  v_max3_u32 v22, v22, v188, v189
  v_mfma_f32_16x16x32_bf16 a[112:115], a[16:19], v[188:191], a[112:115]
  v_mfma_f32_16x16x32_bf16 a[96:99], a[16:19], v[184:187], a[96:99]
  v_max3_u32 v23, v23, v190, v191
  s_waitcnt vmcnt(4)
  v_mfma_f32_16x16x32_bf16 a[96:99], a[32:35], v[192:195], a[96:99]
  v_mfma_f32_16x16x32_bf16 a[112:115], a[32:35], v[196:199], a[112:115]
  v_max3_u32 v22, v22, v192, v193
  v_mfma_f32_16x16x32_bf16 a[116:119], a[36:39], v[196:199], a[116:119]
  v_mfma_f32_16x16x32_bf16 a[100:103], a[36:39], v[192:195], a[100:103]
  v_max3_u32 v23, v23, v194, v195
  v_mfma_f32_16x16x32_bf16 a[104:107], a[40:43], v[192:195], a[104:107]
  v_mfma_f32_16x16x32_bf16 a[120:123], a[40:43], v[196:199], a[120:123]
  v_max3_u32 v22, v22, v196, v197
  v_mfma_f32_16x16x32_bf16 a[124:127], a[44:47], v[196:199], a[124:127]
  v_mfma_f32_16x16x32_bf16 a[108:111], a[44:47], v[192:195], a[108:111]
  v_max3_u32 v23, v23, v198, v199
  s_waitcnt vmcnt(2)
  v_mfma_f32_16x16x32_bf16 a[108:111], a[60:63], v[200:203], a[108:111]
  v_mfma_f32_16x16x32_bf16 a[124:127], a[60:63], v[204:207], a[124:127]
  v_max3_u32 v22, v22, v200, v201
  v_mfma_f32_16x16x32_bf16 a[120:123], a[56:59], v[204:207], a[120:123]
  v_mfma_f32_16x16x32_bf16 a[104:107], a[56:59], v[200:203], a[104:107]
  v_max3_u32 v23, v23, v202, v203
  v_mfma_f32_16x16x32_bf16 a[100:103], a[52:55], v[200:203], a[100:103]
  v_mfma_f32_16x16x32_bf16 a[116:119], a[52:55], v[204:207], a[116:119]
  v_max3_u32 v22, v22, v204, v205
  v_mfma_f32_16x16x32_bf16 a[112:115], a[48:51], v[204:207], a[112:115]
  v_mfma_f32_16x16x32_bf16 a[96:99], a[48:51], v[200:203], a[96:99]
  v_max3_u32 v23, v23, v206, v207
  s_waitcnt vmcnt(0)
  s_cmp_eq_u32 s40, 3
  s_cbranch_scc1 Ld1s
  v_mfma_f32_16x16x32_bf16 a[96:99], a[128:131], v[208:211], a[96:99]
  v_mfma_f32_16x16x32_bf16 a[112:115], a[128:131], v[212:215], a[112:115]
  v_max3_u32 v22, v22, v208, v209
  v_mfma_f32_16x16x32_bf16 a[116:119], a[132:135], v[212:215], a[116:119]
  v_mfma_f32_16x16x32_bf16 a[100:103], a[132:135], v[208:211], a[100:103]
  v_max3_u32 v23, v23, v210, v211
  v_mfma_f32_16x16x32_bf16 a[104:107], a[136:139], v[208:211], a[104:107]
  v_mfma_f32_16x16x32_bf16 a[120:123], a[136:139], v[212:215], a[120:123]
  v_max3_u32 v22, v22, v212, v213
  v_mfma_f32_16x16x32_bf16 a[124:127], a[140:143], v[212:215], a[124:127]
  v_mfma_f32_16x16x32_bf16 a[108:111], a[140:143], v[208:211], a[108:111]
  v_max3_u32 v23, v23, v214, v215
Ld1s:
  v_max_u32 v22, v22, v23
  v_cmp_eq_u32 vcc, -1, v22
  s_cbranch_vccz Ld1o
  s_add_u32 s3, s3, 1
  s_cmp_ge_u32 s3, 0x800
  s_cbranch_scc1 Ld1o
  s_add_u32 s51, s38, 0
  buffer_load_dwordx4 v[128:131], v2, s[20:23], s51 offen sc1
  buffer_load_dwordx4 v[132:135], v3, s[20:23], s51 offen sc1
  s_add_u32 s51, s38, 1024
  buffer_load_dwordx4 v[136:139], v2, s[20:23], s51 offen sc1
  buffer_load_dwordx4 v[140:143], v3, s[20:23], s51 offen sc1
  s_add_u32 s51, s38, 2048
  buffer_load_dwordx4 v[144:147], v2, s[20:23], s51 offen sc1
  buffer_load_dwordx4 v[148:151], v3, s[20:23], s51 offen sc1
  s_add_u32 s51, s38, 3072
  buffer_load_dwordx4 v[152:155], v2, s[20:23], s51 offen sc1
  buffer_load_dwordx4 v[156:159], v3, s[20:23], s51 offen sc1
  s_add_u32 s51, s38, 4096
  buffer_load_dwordx4 v[160:163], v2, s[20:23], s51 offen sc1
  buffer_load_dwordx4 v[164:167], v3, s[20:23], s51 offen sc1
  s_add_u32 s51, s38, 5120
  buffer_load_dwordx4 v[168:171], v2, s[20:23], s51 offen sc1
  buffer_load_dwordx4 v[172:175], v3, s[20:23], s51 offen sc1
  s_add_u32 s51, s38, 6144
  buffer_load_dwordx4 v[176:179], v2, s[20:23], s51 offen sc1
  buffer_load_dwordx4 v[180:183], v3, s[20:23], s51 offen sc1
  s_add_u32 s51, s38, 7168
  buffer_load_dwordx4 v[184:187], v2, s[20:23], s51 offen sc1
  buffer_load_dwordx4 v[188:191], v3, s[20:23], s51 offen sc1
  s_add_u32 s51, s38, 8192
  buffer_load_dwordx4 v[192:195], v2, s[20:23], s51 offen sc1
  buffer_load_dwordx4 v[196:199], v3, s[20:23], s51 offen sc1
  s_add_u32 s51, s38, 9216
  buffer_load_dwordx4 v[200:203], v2, s[20:23], s51 offen sc1
  buffer_load_dwordx4 v[204:207], v3, s[20:23], s51 offen sc1
  s_add_u32 s51, s38, 10240
  buffer_load_dwordx4 v[208:211], v2, s[20:23], s51 offen sc1
  buffer_load_dwordx4 v[212:215], v3, s[20:23], s51 offen sc1
  s_waitcnt vmcnt(0)
  s_branch Ld1a
Ld1o:
  s_nop 3
  ds_write_b128 v16, a[96:99] offset:32768
  ds_write_b128 v16, a[100:103] offset:33792
  ds_write_b128 v16, a[104:107] offset:34816
  ds_write_b128 v16, a[108:111] offset:35840
  ds_write_b128 v16, a[112:115] offset:36864
  ds_write_b128 v16, a[116:119] offset:37888
  ds_write_b128 v16, a[120:123] offset:38912
  ds_write_b128 v16, a[124:127] offset:39936
  s_waitcnt lgkmcnt(0)
  s_barrier
  ds_read_b128 v[112:115], v17 offset:32768
  ds_read_b128 v[116:119], v17 offset:33024
  ds_read_b128 v[120:123], v17 offset:40960
  ds_read_b128 v[124:127], v17 offset:41216
  ds_read_b128 v[240:243], v17 offset:49152
  ds_read_b128 v[244:247], v17 offset:49408
  ds_read_b128 v[248:251], v17 offset:57344
  ds_read_b128 v[252:255], v17 offset:57600
  s_waitcnt lgkmcnt(4)
  v_pk_add_f32 v[112:113], v[112:113], v[120:121]
  v_pk_add_f32 v[114:115], v[114:115], v[122:123]
  v_pk_add_f32 v[116:117], v[116:117], v[124:125]
  v_pk_add_f32 v[118:119], v[118:119], v[126:127]
  v_lshlrev_b32 v120, 16, v224
  v_and_b32 v121, 0xffff0000, v224
  v_lshlrev_b32 v122, 16, v225
  v_and_b32 v123, 0xffff0000, v225
  v_lshlrev_b32 v124, 16, v226
  v_and_b32 v125, 0xffff0000, v226
  v_lshlrev_b32 v126, 16, v227
  v_and_b32 v127, 0xffff0000, v227
  s_waitcnt lgkmcnt(0)
  v_pk_add_f32 v[240:241], v[240:241], v[248:249]
  v_pk_add_f32 v[242:243], v[242:243], v[250:251]
  v_pk_add_f32 v[244:245], v[244:245], v[252:253]
  v_pk_add_f32 v[246:247], v[246:247], v[254:255]
  v_pk_add_f32 v[112:113], v[112:113], v[120:121]
  v_pk_add_f32 v[114:115], v[114:115], v[122:123]
  v_pk_add_f32 v[116:117], v[116:117], v[124:125]
  v_pk_add_f32 v[118:119], v[118:119], v[126:127]
  v_lshlrev_b32 v248, 16, v232
  v_and_b32 v249, 0xffff0000, v232
  v_lshlrev_b32 v250, 16, v233
  v_and_b32 v251, 0xffff0000, v233
  v_lshlrev_b32 v252, 16, v234
  v_and_b32 v253, 0xffff0000, v234
  v_lshlrev_b32 v254, 16, v235
  v_and_b32 v255, 0xffff0000, v235
  v_pk_add_f32 v[112:113], v[112:113], v[240:241]
  v_pk_add_f32 v[114:115], v[114:115], v[242:243]
  v_pk_add_f32 v[116:117], v[116:117], v[244:245]
  v_pk_add_f32 v[118:119], v[118:119], v[246:247]
  v_pk_fma_f32 v[248:249], v[112:113], v[216:217], v[248:249]
  v_pk_fma_f32 v[250:251], v[114:115], v[218:219], v[250:251]
  v_pk_fma_f32 v[252:253], v[116:117], v[220:221], v[252:253]
  v_pk_fma_f32 v[254:255], v[118:119], v[222:223], v[254:255]
  v_cvt_pk_bf16_f32 v236, v248, v249
  v_cvt_pk_bf16_f32 v237, v250, v251
  v_cvt_pk_bf16_f32 v238, v252, v253
  v_cvt_pk_bf16_f32 v239, v254, v255
  buffer_store_dwordx4 v[236:239], v5, s[24:27], s67 offen nt
adaLN_cond__compressed_kv_cla__mixer_channel_mlp__prompt_kernel_end:
  s_endpgm
Lrh19:
  s_nop 15
  v_log_f32 v242, v36
  v_max3_f32 v240, v128, v129, v130
  v_max3_f32 v240, v240, v131, v132
  v_max3_f32 v240, v240, v133, v134
  v_max3_f32 v240, v240, v135, 0
  v_max_f32 v240, v240, v242
  v_mov_b32 v242, v240
  s_nop 1
  v_permlane16_swap_b32 v240, v242
  v_max_f32 v240, v240, v242
  v_mov_b32 v242, v240
  s_nop 1
  v_permlane32_swap_b32 v240, v242
  v_max_f32 v240, v240, v242
  v_exp_f32 v243, -v240
  v_sub_f32 v44, v44, v240
  v_mul_f32 v36, v36, v243
  v_accvgpr_read_b32 v244, a0
  v_accvgpr_read_b32 v245, a1
  v_accvgpr_read_b32 v246, a2
  v_accvgpr_read_b32 v247, a3
  v_mul_f32 v244, v244, v243
  v_mul_f32 v245, v245, v243
  v_mul_f32 v246, v246, v243
  v_mul_f32 v247, v247, v243
  v_accvgpr_write_b32 a0, v244
  v_accvgpr_write_b32 a1, v245
  v_accvgpr_write_b32 a2, v246
  v_accvgpr_write_b32 a3, v247
  v_accvgpr_read_b32 v244, a4
  v_accvgpr_read_b32 v245, a5
  v_accvgpr_read_b32 v246, a6
  v_accvgpr_read_b32 v247, a7
  v_mul_f32 v244, v244, v243
  v_mul_f32 v245, v245, v243
  v_mul_f32 v246, v246, v243
  v_mul_f32 v247, v247, v243
  v_accvgpr_write_b32 a4, v244
  v_accvgpr_write_b32 a5, v245
  v_accvgpr_write_b32 a6, v246
  v_accvgpr_write_b32 a7, v247
  v_accvgpr_read_b32 v244, a8
  v_accvgpr_read_b32 v245, a9
  v_accvgpr_read_b32 v246, a10
  v_accvgpr_read_b32 v247, a11
  v_mul_f32 v244, v244, v243
  v_mul_f32 v245, v245, v243
  v_mul_f32 v246, v246, v243
  v_mul_f32 v247, v247, v243
  v_accvgpr_write_b32 a8, v244
  v_accvgpr_write_b32 a9, v245
  v_accvgpr_write_b32 a10, v246
  v_accvgpr_write_b32 a11, v247
  v_accvgpr_read_b32 v244, a12
  v_accvgpr_read_b32 v245, a13
  v_accvgpr_read_b32 v246, a14
  v_accvgpr_read_b32 v247, a15
  v_mul_f32 v244, v244, v243
  v_mul_f32 v245, v245, v243
  v_mul_f32 v246, v246, v243
  v_mul_f32 v247, v247, v243
  v_accvgpr_write_b32 a12, v244
  v_accvgpr_write_b32 a13, v245
  v_accvgpr_write_b32 a14, v246
  v_accvgpr_write_b32 a15, v247
  v_accvgpr_read_b32 v244, a16
  v_accvgpr_read_b32 v245, a17
  v_accvgpr_read_b32 v246, a18
  v_accvgpr_read_b32 v247, a19
  v_mul_f32 v244, v244, v243
  v_mul_f32 v245, v245, v243
  v_mul_f32 v246, v246, v243
  v_mul_f32 v247, v247, v243
  v_accvgpr_write_b32 a16, v244
  v_accvgpr_write_b32 a17, v245
  v_accvgpr_write_b32 a18, v246
  v_accvgpr_write_b32 a19, v247
  v_accvgpr_read_b32 v244, a20
  v_accvgpr_read_b32 v245, a21
  v_accvgpr_read_b32 v246, a22
  v_accvgpr_read_b32 v247, a23
  v_mul_f32 v244, v244, v243
  v_mul_f32 v245, v245, v243
  v_mul_f32 v246, v246, v243
  v_mul_f32 v247, v247, v243
  v_accvgpr_write_b32 a20, v244
  v_accvgpr_write_b32 a21, v245
  v_accvgpr_write_b32 a22, v246
  v_accvgpr_write_b32 a23, v247
  v_accvgpr_read_b32 v244, a24
  v_accvgpr_read_b32 v245, a25
  v_accvgpr_read_b32 v246, a26
  v_accvgpr_read_b32 v247, a27
  v_mul_f32 v244, v244, v243
  v_mul_f32 v245, v245, v243
  v_mul_f32 v246, v246, v243
  v_mul_f32 v247, v247, v243
  v_accvgpr_write_b32 a24, v244
  v_accvgpr_write_b32 a25, v245
  v_accvgpr_write_b32 a26, v246
  v_accvgpr_write_b32 a27, v247
  v_accvgpr_read_b32 v244, a28
  v_accvgpr_read_b32 v245, a29
  v_accvgpr_read_b32 v246, a30
  v_accvgpr_read_b32 v247, a31
  v_mul_f32 v244, v244, v243
  v_mul_f32 v245, v245, v243
  v_mul_f32 v246, v246, v243
  v_mul_f32 v247, v247, v243
  v_accvgpr_write_b32 a28, v244
  v_accvgpr_write_b32 a29, v245
  v_accvgpr_write_b32 a30, v246
  v_accvgpr_write_b32 a31, v247
  v_sub_f32 v128, v128, v240
  v_sub_f32 v129, v129, v240
  v_sub_f32 v130, v130, v240
  v_sub_f32 v131, v131, v240
  v_sub_f32 v132, v132, v240
  v_sub_f32 v133, v133, v240
  v_sub_f32 v134, v134, v240
  v_sub_f32 v135, v135, v240
  v_sub_f32 v160, v160, v240
  v_sub_f32 v161, v161, v240
  v_sub_f32 v162, v162, v240
  v_sub_f32 v163, v163, v240
  v_sub_f32 v164, v164, v240
  v_sub_f32 v165, v165, v240
  v_sub_f32 v166, v166, v240
  v_sub_f32 v167, v167, v240
  v_sub_f32 v208, v208, v240
  v_sub_f32 v209, v209, v240
  v_sub_f32 v210, v210, v240
  v_sub_f32 v211, v211, v240
  v_sub_f32 v212, v212, v240
  v_sub_f32 v213, v213, v240
  v_sub_f32 v214, v214, v240
  v_sub_f32 v215, v215, v240
  v_log_f32 v242, v38
  v_max3_f32 v241, v136, v137, v138
  v_max3_f32 v241, v241, v139, v140
  v_max3_f32 v241, v241, v141, v142
  v_max3_f32 v241, v241, v143, 0
  v_max_f32 v241, v241, v242
  v_mov_b32 v242, v241
  s_nop 1
  v_permlane16_swap_b32 v241, v242
  v_max_f32 v241, v241, v242
  v_mov_b32 v242, v241
  s_nop 1
  v_permlane32_swap_b32 v241, v242
  v_max_f32 v241, v241, v242
  v_exp_f32 v243, -v241
  v_sub_f32 v45, v45, v241
  v_mul_f32 v38, v38, v243
  v_accvgpr_read_b32 v244, a32
  v_accvgpr_read_b32 v245, a33
  v_accvgpr_read_b32 v246, a34
  v_accvgpr_read_b32 v247, a35
  v_mul_f32 v244, v244, v243
  v_mul_f32 v245, v245, v243
  v_mul_f32 v246, v246, v243
  v_mul_f32 v247, v247, v243
  v_accvgpr_write_b32 a32, v244
  v_accvgpr_write_b32 a33, v245
  v_accvgpr_write_b32 a34, v246
  v_accvgpr_write_b32 a35, v247
  v_accvgpr_read_b32 v244, a36
  v_accvgpr_read_b32 v245, a37
  v_accvgpr_read_b32 v246, a38
  v_accvgpr_read_b32 v247, a39
  v_mul_f32 v244, v244, v243
  v_mul_f32 v245, v245, v243
  v_mul_f32 v246, v246, v243
  v_mul_f32 v247, v247, v243
  v_accvgpr_write_b32 a36, v244
  v_accvgpr_write_b32 a37, v245
  v_accvgpr_write_b32 a38, v246
  v_accvgpr_write_b32 a39, v247
  v_accvgpr_read_b32 v244, a40
  v_accvgpr_read_b32 v245, a41
  v_accvgpr_read_b32 v246, a42
  v_accvgpr_read_b32 v247, a43
  v_mul_f32 v244, v244, v243
  v_mul_f32 v245, v245, v243
  v_mul_f32 v246, v246, v243
  v_mul_f32 v247, v247, v243
  v_accvgpr_write_b32 a40, v244
  v_accvgpr_write_b32 a41, v245
  v_accvgpr_write_b32 a42, v246
  v_accvgpr_write_b32 a43, v247
  v_accvgpr_read_b32 v244, a44
  v_accvgpr_read_b32 v245, a45
  v_accvgpr_read_b32 v246, a46
  v_accvgpr_read_b32 v247, a47
  v_mul_f32 v244, v244, v243
  v_mul_f32 v245, v245, v243
  v_mul_f32 v246, v246, v243
  v_mul_f32 v247, v247, v243
  v_accvgpr_write_b32 a44, v244
  v_accvgpr_write_b32 a45, v245
  v_accvgpr_write_b32 a46, v246
  v_accvgpr_write_b32 a47, v247
  v_accvgpr_read_b32 v244, a48
  v_accvgpr_read_b32 v245, a49
  v_accvgpr_read_b32 v246, a50
  v_accvgpr_read_b32 v247, a51
  v_mul_f32 v244, v244, v243
  v_mul_f32 v245, v245, v243
  v_mul_f32 v246, v246, v243
  v_mul_f32 v247, v247, v243
  v_accvgpr_write_b32 a48, v244
  v_accvgpr_write_b32 a49, v245
  v_accvgpr_write_b32 a50, v246
  v_accvgpr_write_b32 a51, v247
  v_accvgpr_read_b32 v244, a52
  v_accvgpr_read_b32 v245, a53
  v_accvgpr_read_b32 v246, a54
  v_accvgpr_read_b32 v247, a55
  v_mul_f32 v244, v244, v243
  v_mul_f32 v245, v245, v243
  v_mul_f32 v246, v246, v243
  v_mul_f32 v247, v247, v243
  v_accvgpr_write_b32 a52, v244
  v_accvgpr_write_b32 a53, v245
  v_accvgpr_write_b32 a54, v246
  v_accvgpr_write_b32 a55, v247
  v_accvgpr_read_b32 v244, a56
  v_accvgpr_read_b32 v245, a57
  v_accvgpr_read_b32 v246, a58
  v_accvgpr_read_b32 v247, a59
  v_mul_f32 v244, v244, v243
  v_mul_f32 v245, v245, v243
  v_mul_f32 v246, v246, v243
  v_mul_f32 v247, v247, v243
  v_accvgpr_write_b32 a56, v244
  v_accvgpr_write_b32 a57, v245
  v_accvgpr_write_b32 a58, v246
  v_accvgpr_write_b32 a59, v247
  v_accvgpr_read_b32 v244, a60
  v_accvgpr_read_b32 v245, a61
  v_accvgpr_read_b32 v246, a62
  v_accvgpr_read_b32 v247, a63
  v_mul_f32 v244, v244, v243
  v_mul_f32 v245, v245, v243
  v_mul_f32 v246, v246, v243
  v_mul_f32 v247, v247, v243
  v_accvgpr_write_b32 a60, v244
  v_accvgpr_write_b32 a61, v245
  v_accvgpr_write_b32 a62, v246
  v_accvgpr_write_b32 a63, v247
  v_sub_f32 v136, v136, v241
  v_sub_f32 v137, v137, v241
  v_sub_f32 v138, v138, v241
  v_sub_f32 v139, v139, v241
  v_sub_f32 v140, v140, v241
  v_sub_f32 v141, v141, v241
  v_sub_f32 v142, v142, v241
  v_sub_f32 v143, v143, v241
  v_sub_f32 v168, v168, v241
  v_sub_f32 v169, v169, v241
  v_sub_f32 v170, v170, v241
  v_sub_f32 v171, v171, v241
  v_sub_f32 v172, v172, v241
  v_sub_f32 v173, v173, v241
  v_sub_f32 v174, v174, v241
  v_sub_f32 v175, v175, v241
  v_sub_f32 v216, v216, v241
  v_sub_f32 v217, v217, v241
  v_sub_f32 v218, v218, v241
  v_sub_f32 v219, v219, v241
  v_sub_f32 v220, v220, v241
  v_sub_f32 v221, v221, v241
  v_sub_f32 v222, v222, v241
  v_sub_f32 v223, v223, v241
  v_exp_f32 v32, v128
  v_exp_f32 v33, v129
  v_exp_f32 v34, v130
  v_cvt_pk_bf16_f32 v192, v32, v33
  v_exp_f32 v35, v131
  v_exp_f32 v32, v132
  v_cvt_pk_bf16_f32 v193, v34, v35
  v_exp_f32 v33, v133
  v_exp_f32 v34, v134
  v_cvt_pk_bf16_f32 v194, v32, v33
  v_exp_f32 v35, v135
  v_exp_f32 v32, v136
  v_cvt_pk_bf16_f32 v195, v34, v35
  v_exp_f32 v33, v137
  v_exp_f32 v34, v138
  v_cvt_pk_bf16_f32 v196, v32, v33
  v_exp_f32 v35, v139
  v_exp_f32 v32, v140
  v_cvt_pk_bf16_f32 v197, v34, v35
  v_exp_f32 v33, v141
  v_exp_f32 v34, v142
  v_cvt_pk_bf16_f32 v198, v32, v33
  v_exp_f32 v35, v143
  s_nop 0
  v_cvt_pk_bf16_f32 v199, v34, v35
  s_nop 1
  v_mfma_f32_16x16x32_bf16 v[56:59], a[224:227], v[192:195], 0
  v_mfma_f32_16x16x32_bf16 v[60:63], a[224:227], v[196:199], 0
  s_nop 9
  v_add_f32 v37, v36, v56
  v_add_f32 v39, v38, v60
  v_exp_f32 v32, v144
  v_exp_f32 v33, v145
  v_exp_f32 v34, v146
  v_cvt_pk_bf16_f32 v200, v32, v33
  s_nop 3
  s_setpc_b64 s[6:7]
Lrare20:
  s_call_b64 s[6:7], Lrh19
  s_branch Lrr21
Lrh22:
  s_nop 15
  v_log_f32 v242, v40
  v_max3_f32 v240, v144, v145, v146
  v_max3_f32 v240, v240, v147, v148
  v_max3_f32 v240, v240, v149, v150
  v_max3_f32 v240, v240, v151, 0
  v_max_f32 v240, v240, v242
  v_mov_b32 v242, v240
  s_nop 1
  v_permlane16_swap_b32 v240, v242
  v_max_f32 v240, v240, v242
  v_mov_b32 v242, v240
  s_nop 1
  v_permlane32_swap_b32 v240, v242
  v_max_f32 v240, v240, v242
  v_exp_f32 v243, -v240
  v_sub_f32 v46, v46, v240
  v_mul_f32 v40, v40, v243
  v_accvgpr_read_b32 v244, a64
  v_accvgpr_read_b32 v245, a65
  v_accvgpr_read_b32 v246, a66
  v_accvgpr_read_b32 v247, a67
  v_mul_f32 v244, v244, v243
  v_mul_f32 v245, v245, v243
  v_mul_f32 v246, v246, v243
  v_mul_f32 v247, v247, v243
  v_accvgpr_write_b32 a64, v244
  v_accvgpr_write_b32 a65, v245
  v_accvgpr_write_b32 a66, v246
  v_accvgpr_write_b32 a67, v247
  v_accvgpr_read_b32 v244, a68
  v_accvgpr_read_b32 v245, a69
  v_accvgpr_read_b32 v246, a70
  v_accvgpr_read_b32 v247, a71
  v_mul_f32 v244, v244, v243
  v_mul_f32 v245, v245, v243
  v_mul_f32 v246, v246, v243
  v_mul_f32 v247, v247, v243
  v_accvgpr_write_b32 a68, v244
  v_accvgpr_write_b32 a69, v245
  v_accvgpr_write_b32 a70, v246
  v_accvgpr_write_b32 a71, v247
  v_accvgpr_read_b32 v244, a72
  v_accvgpr_read_b32 v245, a73
  v_accvgpr_read_b32 v246, a74
  v_accvgpr_read_b32 v247, a75
  v_mul_f32 v244, v244, v243
  v_mul_f32 v245, v245, v243
  v_mul_f32 v246, v246, v243
  v_mul_f32 v247, v247, v243
  v_accvgpr_write_b32 a72, v244
  v_accvgpr_write_b32 a73, v245
  v_accvgpr_write_b32 a74, v246
  v_accvgpr_write_b32 a75, v247
  v_accvgpr_read_b32 v244, a76
  v_accvgpr_read_b32 v245, a77
  v_accvgpr_read_b32 v246, a78
  v_accvgpr_read_b32 v247, a79
  v_mul_f32 v244, v244, v243
  v_mul_f32 v245, v245, v243
  v_mul_f32 v246, v246, v243
  v_mul_f32 v247, v247, v243
  v_accvgpr_write_b32 a76, v244
  v_accvgpr_write_b32 a77, v245
  v_accvgpr_write_b32 a78, v246
  v_accvgpr_write_b32 a79, v247
  v_accvgpr_read_b32 v244, a80
  v_accvgpr_read_b32 v245, a81
  v_accvgpr_read_b32 v246, a82
  v_accvgpr_read_b32 v247, a83
  v_mul_f32 v244, v244, v243
  v_mul_f32 v245, v245, v243
  v_mul_f32 v246, v246, v243
  v_mul_f32 v247, v247, v243
  v_accvgpr_write_b32 a80, v244
  v_accvgpr_write_b32 a81, v245
  v_accvgpr_write_b32 a82, v246
  v_accvgpr_write_b32 a83, v247
  v_accvgpr_read_b32 v244, a84
  v_accvgpr_read_b32 v245, a85
  v_accvgpr_read_b32 v246, a86
  v_accvgpr_read_b32 v247, a87
  v_mul_f32 v244, v244, v243
  v_mul_f32 v245, v245, v243
  v_mul_f32 v246, v246, v243
  v_mul_f32 v247, v247, v243
  v_accvgpr_write_b32 a84, v244
  v_accvgpr_write_b32 a85, v245
  v_accvgpr_write_b32 a86, v246
  v_accvgpr_write_b32 a87, v247
  v_accvgpr_read_b32 v244, a88
  v_accvgpr_read_b32 v245, a89
  v_accvgpr_read_b32 v246, a90
  v_accvgpr_read_b32 v247, a91
  v_mul_f32 v244, v244, v243
  v_mul_f32 v245, v245, v243
  v_mul_f32 v246, v246, v243
  v_mul_f32 v247, v247, v243
  v_accvgpr_write_b32 a88, v244
  v_accvgpr_write_b32 a89, v245
  v_accvgpr_write_b32 a90, v246
  v_accvgpr_write_b32 a91, v247
  v_accvgpr_read_b32 v244, a92
  v_accvgpr_read_b32 v245, a93
  v_accvgpr_read_b32 v246, a94
  v_accvgpr_read_b32 v247, a95
  v_mul_f32 v244, v244, v243
  v_mul_f32 v245, v245, v243
  v_mul_f32 v246, v246, v243
  v_mul_f32 v247, v247, v243
  v_accvgpr_write_b32 a92, v244
  v_accvgpr_write_b32 a93, v245
  v_accvgpr_write_b32 a94, v246
  v_accvgpr_write_b32 a95, v247
  v_sub_f32 v144, v144, v240
  v_sub_f32 v145, v145, v240
  v_sub_f32 v146, v146, v240
  v_sub_f32 v147, v147, v240
  v_sub_f32 v148, v148, v240
  v_sub_f32 v149, v149, v240
  v_sub_f32 v150, v150, v240
  v_sub_f32 v151, v151, v240
  v_sub_f32 v176, v176, v240
  v_sub_f32 v177, v177, v240
  v_sub_f32 v178, v178, v240
  v_sub_f32 v179, v179, v240
  v_sub_f32 v180, v180, v240
  v_sub_f32 v181, v181, v240
  v_sub_f32 v182, v182, v240
  v_sub_f32 v183, v183, v240
  v_sub_f32 v224, v224, v240
  v_sub_f32 v225, v225, v240
  v_sub_f32 v226, v226, v240
  v_sub_f32 v227, v227, v240
  v_sub_f32 v228, v228, v240
  v_sub_f32 v229, v229, v240
  v_sub_f32 v230, v230, v240
  v_sub_f32 v231, v231, v240
  v_log_f32 v242, v42
  v_max3_f32 v241, v152, v153, v154
  v_max3_f32 v241, v241, v155, v156
  v_max3_f32 v241, v241, v157, v158
  v_max3_f32 v241, v241, v159, 0
  v_max_f32 v241, v241, v242
  v_mov_b32 v242, v241
  s_nop 1
  v_permlane16_swap_b32 v241, v242
  v_max_f32 v241, v241, v242
  v_mov_b32 v242, v241
  s_nop 1
  v_permlane32_swap_b32 v241, v242
  v_max_f32 v241, v241, v242
  v_exp_f32 v243, -v241
  v_sub_f32 v47, v47, v241
  v_mul_f32 v42, v42, v243
  v_accvgpr_read_b32 v244, a96
  v_accvgpr_read_b32 v245, a97
  v_accvgpr_read_b32 v246, a98
  v_accvgpr_read_b32 v247, a99
  v_mul_f32 v244, v244, v243
  v_mul_f32 v245, v245, v243
  v_mul_f32 v246, v246, v243
  v_mul_f32 v247, v247, v243
  v_accvgpr_write_b32 a96, v244
  v_accvgpr_write_b32 a97, v245
  v_accvgpr_write_b32 a98, v246
  v_accvgpr_write_b32 a99, v247
  v_accvgpr_read_b32 v244, a100
  v_accvgpr_read_b32 v245, a101
  v_accvgpr_read_b32 v246, a102
  v_accvgpr_read_b32 v247, a103
  v_mul_f32 v244, v244, v243
  v_mul_f32 v245, v245, v243
  v_mul_f32 v246, v246, v243
  v_mul_f32 v247, v247, v243
  v_accvgpr_write_b32 a100, v244
  v_accvgpr_write_b32 a101, v245
  v_accvgpr_write_b32 a102, v246
  v_accvgpr_write_b32 a103, v247
  v_accvgpr_read_b32 v244, a104
  v_accvgpr_read_b32 v245, a105
  v_accvgpr_read_b32 v246, a106
  v_accvgpr_read_b32 v247, a107
  v_mul_f32 v244, v244, v243
  v_mul_f32 v245, v245, v243
  v_mul_f32 v246, v246, v243
  v_mul_f32 v247, v247, v243
  v_accvgpr_write_b32 a104, v244
  v_accvgpr_write_b32 a105, v245
  v_accvgpr_write_b32 a106, v246
  v_accvgpr_write_b32 a107, v247
  v_accvgpr_read_b32 v244, a108
  v_accvgpr_read_b32 v245, a109
  v_accvgpr_read_b32 v246, a110
  v_accvgpr_read_b32 v247, a111
  v_mul_f32 v244, v244, v243
  v_mul_f32 v245, v245, v243
  v_mul_f32 v246, v246, v243
  v_mul_f32 v247, v247, v243
  v_accvgpr_write_b32 a108, v244
  v_accvgpr_write_b32 a109, v245
  v_accvgpr_write_b32 a110, v246
  v_accvgpr_write_b32 a111, v247
  v_accvgpr_read_b32 v244, a112
  v_accvgpr_read_b32 v245, a113
  v_accvgpr_read_b32 v246, a114
  v_accvgpr_read_b32 v247, a115
  v_mul_f32 v244, v244, v243
  v_mul_f32 v245, v245, v243
  v_mul_f32 v246, v246, v243
  v_mul_f32 v247, v247, v243
  v_accvgpr_write_b32 a112, v244
  v_accvgpr_write_b32 a113, v245
  v_accvgpr_write_b32 a114, v246
  v_accvgpr_write_b32 a115, v247
  v_accvgpr_read_b32 v244, a116
  v_accvgpr_read_b32 v245, a117
  v_accvgpr_read_b32 v246, a118
  v_accvgpr_read_b32 v247, a119
  v_mul_f32 v244, v244, v243
  v_mul_f32 v245, v245, v243
  v_mul_f32 v246, v246, v243
  v_mul_f32 v247, v247, v243
  v_accvgpr_write_b32 a116, v244
  v_accvgpr_write_b32 a117, v245
  v_accvgpr_write_b32 a118, v246
  v_accvgpr_write_b32 a119, v247
  v_accvgpr_read_b32 v244, a120
  v_accvgpr_read_b32 v245, a121
  v_accvgpr_read_b32 v246, a122
  v_accvgpr_read_b32 v247, a123
  v_mul_f32 v244, v244, v243
  v_mul_f32 v245, v245, v243
  v_mul_f32 v246, v246, v243
  v_mul_f32 v247, v247, v243
  v_accvgpr_write_b32 a120, v244
  v_accvgpr_write_b32 a121, v245
  v_accvgpr_write_b32 a122, v246
  v_accvgpr_write_b32 a123, v247
  v_accvgpr_read_b32 v244, a124
  v_accvgpr_read_b32 v245, a125
  v_accvgpr_read_b32 v246, a126
  v_accvgpr_read_b32 v247, a127
  v_mul_f32 v244, v244, v243
  v_mul_f32 v245, v245, v243
  v_mul_f32 v246, v246, v243
  v_mul_f32 v247, v247, v243
  v_accvgpr_write_b32 a124, v244
  v_accvgpr_write_b32 a125, v245
  v_accvgpr_write_b32 a126, v246
  v_accvgpr_write_b32 a127, v247
  v_sub_f32 v152, v152, v241
  v_sub_f32 v153, v153, v241
  v_sub_f32 v154, v154, v241
  v_sub_f32 v155, v155, v241
  v_sub_f32 v156, v156, v241
  v_sub_f32 v157, v157, v241
  v_sub_f32 v158, v158, v241
  v_sub_f32 v159, v159, v241
  v_sub_f32 v184, v184, v241
  v_sub_f32 v185, v185, v241
  v_sub_f32 v186, v186, v241
  v_sub_f32 v187, v187, v241
  v_sub_f32 v188, v188, v241
  v_sub_f32 v189, v189, v241
  v_sub_f32 v190, v190, v241
  v_sub_f32 v191, v191, v241
  v_sub_f32 v232, v232, v241
  v_sub_f32 v233, v233, v241
  v_sub_f32 v234, v234, v241
  v_sub_f32 v235, v235, v241
  v_sub_f32 v236, v236, v241
  v_sub_f32 v237, v237, v241
  v_sub_f32 v238, v238, v241
  v_sub_f32 v239, v239, v241
  v_exp_f32 v32, v144
  v_exp_f32 v33, v145
  v_exp_f32 v34, v146
  v_cvt_pk_bf16_f32 v200, v32, v33
  v_exp_f32 v35, v147
  v_exp_f32 v32, v148
  v_cvt_pk_bf16_f32 v201, v34, v35
  v_exp_f32 v33, v149
  v_exp_f32 v34, v150
  v_cvt_pk_bf16_f32 v202, v32, v33
  v_exp_f32 v35, v151
  v_exp_f32 v32, v152
  v_cvt_pk_bf16_f32 v203, v34, v35
  v_exp_f32 v33, v153
  v_exp_f32 v34, v154
  v_cvt_pk_bf16_f32 v204, v32, v33
  v_exp_f32 v35, v155
  v_exp_f32 v32, v156
  v_cvt_pk_bf16_f32 v205, v34, v35
  v_exp_f32 v33, v157
  v_exp_f32 v34, v158
  v_cvt_pk_bf16_f32 v206, v32, v33
  v_exp_f32 v35, v159
  s_nop 0
  v_cvt_pk_bf16_f32 v207, v34, v35
  s_nop 1
  v_mfma_f32_16x16x32_bf16 v[56:59], a[224:227], v[200:203], 0
  v_mfma_f32_16x16x32_bf16 v[60:63], a[224:227], v[204:207], 0
  s_nop 9
  v_add_f32 v41, v40, v56
  v_add_f32 v43, v42, v60
  v_exp_f32 v32, v160
  v_exp_f32 v33, v161
  v_exp_f32 v34, v162
  v_cvt_pk_bf16_f32 v248, v32, v33
  s_nop 3
  s_setpc_b64 s[6:7]
Lrare23:
  s_call_b64 s[6:7], Lrh22
  s_branch Lrr24
Lrh25:
  s_nop 15
  v_log_f32 v242, v37
  v_max3_f32 v240, v160, v161, v162
  v_max3_f32 v240, v240, v163, v164
  v_max3_f32 v240, v240, v165, v166
  v_max3_f32 v240, v240, v167, 0
  v_max_f32 v240, v240, v242
  v_mov_b32 v242, v240
  s_nop 1
  v_permlane16_swap_b32 v240, v242
  v_max_f32 v240, v240, v242
  v_mov_b32 v242, v240
  s_nop 1
  v_permlane32_swap_b32 v240, v242
  v_max_f32 v240, v240, v242
  v_exp_f32 v243, -v240
  v_sub_f32 v44, v44, v240
  v_mul_f32 v37, v37, v243
  v_accvgpr_read_b32 v244, a0
  v_accvgpr_read_b32 v245, a1
  v_accvgpr_read_b32 v246, a2
  v_accvgpr_read_b32 v247, a3
  v_mul_f32 v244, v244, v243
  v_mul_f32 v245, v245, v243
  v_mul_f32 v246, v246, v243
  v_mul_f32 v247, v247, v243
  v_accvgpr_write_b32 a0, v244
  v_accvgpr_write_b32 a1, v245
  v_accvgpr_write_b32 a2, v246
  v_accvgpr_write_b32 a3, v247
  v_accvgpr_read_b32 v244, a4
  v_accvgpr_read_b32 v245, a5
  v_accvgpr_read_b32 v246, a6
  v_accvgpr_read_b32 v247, a7
  v_mul_f32 v244, v244, v243
  v_mul_f32 v245, v245, v243
  v_mul_f32 v246, v246, v243
  v_mul_f32 v247, v247, v243
  v_accvgpr_write_b32 a4, v244
  v_accvgpr_write_b32 a5, v245
  v_accvgpr_write_b32 a6, v246
  v_accvgpr_write_b32 a7, v247
  v_accvgpr_read_b32 v244, a8
  v_accvgpr_read_b32 v245, a9
  v_accvgpr_read_b32 v246, a10
  v_accvgpr_read_b32 v247, a11
  v_mul_f32 v244, v244, v243
  v_mul_f32 v245, v245, v243
  v_mul_f32 v246, v246, v243
  v_mul_f32 v247, v247, v243
  v_accvgpr_write_b32 a8, v244
  v_accvgpr_write_b32 a9, v245
  v_accvgpr_write_b32 a10, v246
  v_accvgpr_write_b32 a11, v247
  v_accvgpr_read_b32 v244, a12
  v_accvgpr_read_b32 v245, a13
  v_accvgpr_read_b32 v246, a14
  v_accvgpr_read_b32 v247, a15
  v_mul_f32 v244, v244, v243
  v_mul_f32 v245, v245, v243
  v_mul_f32 v246, v246, v243
  v_mul_f32 v247, v247, v243
  v_accvgpr_write_b32 a12, v244
  v_accvgpr_write_b32 a13, v245
  v_accvgpr_write_b32 a14, v246
  v_accvgpr_write_b32 a15, v247
  v_accvgpr_read_b32 v244, a16
  v_accvgpr_read_b32 v245, a17
  v_accvgpr_read_b32 v246, a18
  v_accvgpr_read_b32 v247, a19
  v_mul_f32 v244, v244, v243
  v_mul_f32 v245, v245, v243
  v_mul_f32 v246, v246, v243
  v_mul_f32 v247, v247, v243
  v_accvgpr_write_b32 a16, v244
  v_accvgpr_write_b32 a17, v245
  v_accvgpr_write_b32 a18, v246
  v_accvgpr_write_b32 a19, v247
  v_accvgpr_read_b32 v244, a20
  v_accvgpr_read_b32 v245, a21
  v_accvgpr_read_b32 v246, a22
  v_accvgpr_read_b32 v247, a23
  v_mul_f32 v244, v244, v243
  v_mul_f32 v245, v245, v243
  v_mul_f32 v246, v246, v243
  v_mul_f32 v247, v247, v243
  v_accvgpr_write_b32 a20, v244
  v_accvgpr_write_b32 a21, v245
  v_accvgpr_write_b32 a22, v246
  v_accvgpr_write_b32 a23, v247
  v_accvgpr_read_b32 v244, a24
  v_accvgpr_read_b32 v245, a25
  v_accvgpr_read_b32 v246, a26
  v_accvgpr_read_b32 v247, a27
  v_mul_f32 v244, v244, v243
  v_mul_f32 v245, v245, v243
  v_mul_f32 v246, v246, v243
  v_mul_f32 v247, v247, v243
  v_accvgpr_write_b32 a24, v244
  v_accvgpr_write_b32 a25, v245
  v_accvgpr_write_b32 a26, v246
  v_accvgpr_write_b32 a27, v247
  v_accvgpr_read_b32 v244, a28
  v_accvgpr_read_b32 v245, a29
  v_accvgpr_read_b32 v246, a30
  v_accvgpr_read_b32 v247, a31
  v_mul_f32 v244, v244, v243
  v_mul_f32 v245, v245, v243
  v_mul_f32 v246, v246, v243
  v_mul_f32 v247, v247, v243
  v_accvgpr_write_b32 a28, v244
  v_accvgpr_write_b32 a29, v245
  v_accvgpr_write_b32 a30, v246
  v_accvgpr_write_b32 a31, v247
  v_sub_f32 v160, v160, v240
  v_sub_f32 v161, v161, v240
  v_sub_f32 v162, v162, v240
  v_sub_f32 v163, v163, v240
  v_sub_f32 v164, v164, v240
  v_sub_f32 v165, v165, v240
  v_sub_f32 v166, v166, v240
  v_sub_f32 v167, v167, v240
  v_sub_f32 v128, v128, v240
  v_sub_f32 v129, v129, v240
  v_sub_f32 v130, v130, v240
  v_sub_f32 v131, v131, v240
  v_sub_f32 v132, v132, v240
  v_sub_f32 v133, v133, v240
  v_sub_f32 v134, v134, v240
  v_sub_f32 v135, v135, v240
  v_sub_f32 v208, v208, v240
  v_sub_f32 v209, v209, v240
  v_sub_f32 v210, v210, v240
  v_sub_f32 v211, v211, v240
  v_sub_f32 v212, v212, v240
  v_sub_f32 v213, v213, v240
  v_sub_f32 v214, v214, v240
  v_sub_f32 v215, v215, v240
  v_log_f32 v242, v39
  v_max3_f32 v241, v168, v169, v170
  v_max3_f32 v241, v241, v171, v172
  v_max3_f32 v241, v241, v173, v174
  v_max3_f32 v241, v241, v175, 0
  v_max_f32 v241, v241, v242
  v_mov_b32 v242, v241
  s_nop 1
  v_permlane16_swap_b32 v241, v242
  v_max_f32 v241, v241, v242
  v_mov_b32 v242, v241
  s_nop 1
  v_permlane32_swap_b32 v241, v242
  v_max_f32 v241, v241, v242
  v_exp_f32 v243, -v241
  v_sub_f32 v45, v45, v241
  v_mul_f32 v39, v39, v243
  v_accvgpr_read_b32 v244, a32
  v_accvgpr_read_b32 v245, a33
  v_accvgpr_read_b32 v246, a34
  v_accvgpr_read_b32 v247, a35
  v_mul_f32 v244, v244, v243
  v_mul_f32 v245, v245, v243
  v_mul_f32 v246, v246, v243
  v_mul_f32 v247, v247, v243
  v_accvgpr_write_b32 a32, v244
  v_accvgpr_write_b32 a33, v245
  v_accvgpr_write_b32 a34, v246
  v_accvgpr_write_b32 a35, v247
  v_accvgpr_read_b32 v244, a36
  v_accvgpr_read_b32 v245, a37
  v_accvgpr_read_b32 v246, a38
  v_accvgpr_read_b32 v247, a39
  v_mul_f32 v244, v244, v243
  v_mul_f32 v245, v245, v243
  v_mul_f32 v246, v246, v243
  v_mul_f32 v247, v247, v243
  v_accvgpr_write_b32 a36, v244
  v_accvgpr_write_b32 a37, v245
  v_accvgpr_write_b32 a38, v246
  v_accvgpr_write_b32 a39, v247
  v_accvgpr_read_b32 v244, a40
  v_accvgpr_read_b32 v245, a41
  v_accvgpr_read_b32 v246, a42
  v_accvgpr_read_b32 v247, a43
  v_mul_f32 v244, v244, v243
  v_mul_f32 v245, v245, v243
  v_mul_f32 v246, v246, v243
  v_mul_f32 v247, v247, v243
  v_accvgpr_write_b32 a40, v244
  v_accvgpr_write_b32 a41, v245
  v_accvgpr_write_b32 a42, v246
  v_accvgpr_write_b32 a43, v247
  v_accvgpr_read_b32 v244, a44
  v_accvgpr_read_b32 v245, a45
  v_accvgpr_read_b32 v246, a46
  v_accvgpr_read_b32 v247, a47
  v_mul_f32 v244, v244, v243
  v_mul_f32 v245, v245, v243
  v_mul_f32 v246, v246, v243
  v_mul_f32 v247, v247, v243
  v_accvgpr_write_b32 a44, v244
  v_accvgpr_write_b32 a45, v245
  v_accvgpr_write_b32 a46, v246
  v_accvgpr_write_b32 a47, v247
  v_accvgpr_read_b32 v244, a48
  v_accvgpr_read_b32 v245, a49
  v_accvgpr_read_b32 v246, a50
  v_accvgpr_read_b32 v247, a51
  v_mul_f32 v244, v244, v243
  v_mul_f32 v245, v245, v243
  v_mul_f32 v246, v246, v243
  v_mul_f32 v247, v247, v243
  v_accvgpr_write_b32 a48, v244
  v_accvgpr_write_b32 a49, v245
  v_accvgpr_write_b32 a50, v246
  v_accvgpr_write_b32 a51, v247
  v_accvgpr_read_b32 v244, a52
  v_accvgpr_read_b32 v245, a53
  v_accvgpr_read_b32 v246, a54
  v_accvgpr_read_b32 v247, a55
  v_mul_f32 v244, v244, v243
  v_mul_f32 v245, v245, v243
  v_mul_f32 v246, v246, v243
  v_mul_f32 v247, v247, v243
  v_accvgpr_write_b32 a52, v244
  v_accvgpr_write_b32 a53, v245
  v_accvgpr_write_b32 a54, v246
  v_accvgpr_write_b32 a55, v247
  v_accvgpr_read_b32 v244, a56
  v_accvgpr_read_b32 v245, a57
  v_accvgpr_read_b32 v246, a58
  v_accvgpr_read_b32 v247, a59
  v_mul_f32 v244, v244, v243
  v_mul_f32 v245, v245, v243
  v_mul_f32 v246, v246, v243
  v_mul_f32 v247, v247, v243
  v_accvgpr_write_b32 a56, v244
  v_accvgpr_write_b32 a57, v245
  v_accvgpr_write_b32 a58, v246
  v_accvgpr_write_b32 a59, v247
  v_accvgpr_read_b32 v244, a60
  v_accvgpr_read_b32 v245, a61
  v_accvgpr_read_b32 v246, a62
  v_accvgpr_read_b32 v247, a63
  v_mul_f32 v244, v244, v243
  v_mul_f32 v245, v245, v243
  v_mul_f32 v246, v246, v243
  v_mul_f32 v247, v247, v243
  v_accvgpr_write_b32 a60, v244
  v_accvgpr_write_b32 a61, v245
  v_accvgpr_write_b32 a62, v246
  v_accvgpr_write_b32 a63, v247
  v_sub_f32 v168, v168, v241
  v_sub_f32 v169, v169, v241
  v_sub_f32 v170, v170, v241
  v_sub_f32 v171, v171, v241
  v_sub_f32 v172, v172, v241
  v_sub_f32 v173, v173, v241
  v_sub_f32 v174, v174, v241
  v_sub_f32 v175, v175, v241
  v_sub_f32 v136, v136, v241
  v_sub_f32 v137, v137, v241
  v_sub_f32 v138, v138, v241
  v_sub_f32 v139, v139, v241
  v_sub_f32 v140, v140, v241
  v_sub_f32 v141, v141, v241
  v_sub_f32 v142, v142, v241
  v_sub_f32 v143, v143, v241
  v_sub_f32 v216, v216, v241
  v_sub_f32 v217, v217, v241
  v_sub_f32 v218, v218, v241
  v_sub_f32 v219, v219, v241
  v_sub_f32 v220, v220, v241
  v_sub_f32 v221, v221, v241
  v_sub_f32 v222, v222, v241
  v_sub_f32 v223, v223, v241
  v_exp_f32 v32, v160
  v_exp_f32 v33, v161
  v_exp_f32 v34, v162
  v_cvt_pk_bf16_f32 v248, v32, v33
  v_exp_f32 v35, v163
  v_exp_f32 v32, v164
  v_cvt_pk_bf16_f32 v249, v34, v35
  v_exp_f32 v33, v165
  v_exp_f32 v34, v166
  v_cvt_pk_bf16_f32 v250, v32, v33
  v_exp_f32 v35, v167
  v_exp_f32 v32, v168
  v_cvt_pk_bf16_f32 v251, v34, v35
  v_exp_f32 v33, v169
  v_exp_f32 v34, v170
  v_cvt_pk_bf16_f32 v252, v32, v33
  v_exp_f32 v35, v171
  v_exp_f32 v32, v172
  v_cvt_pk_bf16_f32 v253, v34, v35
  v_exp_f32 v33, v173
  v_exp_f32 v34, v174
  v_cvt_pk_bf16_f32 v254, v32, v33
  v_exp_f32 v35, v175
  s_nop 0
  v_cvt_pk_bf16_f32 v255, v34, v35
  s_nop 1
  v_mfma_f32_16x16x32_bf16 v[56:59], a[224:227], v[248:251], 0
  v_mfma_f32_16x16x32_bf16 v[60:63], a[224:227], v[252:255], 0
  s_nop 9
  v_add_f32 v36, v37, v56
  v_add_f32 v38, v39, v60
  v_exp_f32 v32, v176
  v_exp_f32 v33, v177
  v_exp_f32 v34, v178
  v_cvt_pk_bf16_f32 v200, v32, v33
  s_nop 3
  s_setpc_b64 s[6:7]
Lrare26:
  s_call_b64 s[6:7], Lrh25
  s_branch Lrr27
Lrh28:
  s_nop 15
  v_log_f32 v242, v41
  v_max3_f32 v240, v176, v177, v178
  v_max3_f32 v240, v240, v179, v180
  v_max3_f32 v240, v240, v181, v182
  v_max3_f32 v240, v240, v183, 0
  v_max_f32 v240, v240, v242
  v_mov_b32 v242, v240
  s_nop 1
  v_permlane16_swap_b32 v240, v242
  v_max_f32 v240, v240, v242
  v_mov_b32 v242, v240
  s_nop 1
  v_permlane32_swap_b32 v240, v242
  v_max_f32 v240, v240, v242
  v_exp_f32 v243, -v240
  v_sub_f32 v46, v46, v240
  v_mul_f32 v41, v41, v243
  v_accvgpr_read_b32 v244, a64
  v_accvgpr_read_b32 v245, a65
  v_accvgpr_read_b32 v246, a66
  v_accvgpr_read_b32 v247, a67
  v_mul_f32 v244, v244, v243
  v_mul_f32 v245, v245, v243
  v_mul_f32 v246, v246, v243
  v_mul_f32 v247, v247, v243
  v_accvgpr_write_b32 a64, v244
  v_accvgpr_write_b32 a65, v245
  v_accvgpr_write_b32 a66, v246
  v_accvgpr_write_b32 a67, v247
  v_accvgpr_read_b32 v244, a68
  v_accvgpr_read_b32 v245, a69
  v_accvgpr_read_b32 v246, a70
  v_accvgpr_read_b32 v247, a71
  v_mul_f32 v244, v244, v243
  v_mul_f32 v245, v245, v243
  v_mul_f32 v246, v246, v243
  v_mul_f32 v247, v247, v243
  v_accvgpr_write_b32 a68, v244
  v_accvgpr_write_b32 a69, v245
  v_accvgpr_write_b32 a70, v246
  v_accvgpr_write_b32 a71, v247
  v_accvgpr_read_b32 v244, a72
  v_accvgpr_read_b32 v245, a73
  v_accvgpr_read_b32 v246, a74
  v_accvgpr_read_b32 v247, a75
  v_mul_f32 v244, v244, v243
  v_mul_f32 v245, v245, v243
  v_mul_f32 v246, v246, v243
  v_mul_f32 v247, v247, v243
  v_accvgpr_write_b32 a72, v244
  v_accvgpr_write_b32 a73, v245
  v_accvgpr_write_b32 a74, v246
  v_accvgpr_write_b32 a75, v247
  v_accvgpr_read_b32 v244, a76
  v_accvgpr_read_b32 v245, a77
  v_accvgpr_read_b32 v246, a78
  v_accvgpr_read_b32 v247, a79
  v_mul_f32 v244, v244, v243
  v_mul_f32 v245, v245, v243
  v_mul_f32 v246, v246, v243
  v_mul_f32 v247, v247, v243
  v_accvgpr_write_b32 a76, v244
  v_accvgpr_write_b32 a77, v245
  v_accvgpr_write_b32 a78, v246
  v_accvgpr_write_b32 a79, v247
  v_accvgpr_read_b32 v244, a80
  v_accvgpr_read_b32 v245, a81
  v_accvgpr_read_b32 v246, a82
  v_accvgpr_read_b32 v247, a83
  v_mul_f32 v244, v244, v243
  v_mul_f32 v245, v245, v243
  v_mul_f32 v246, v246, v243
  v_mul_f32 v247, v247, v243
  v_accvgpr_write_b32 a80, v244
  v_accvgpr_write_b32 a81, v245
  v_accvgpr_write_b32 a82, v246
  v_accvgpr_write_b32 a83, v247
  v_accvgpr_read_b32 v244, a84
  v_accvgpr_read_b32 v245, a85
  v_accvgpr_read_b32 v246, a86
  v_accvgpr_read_b32 v247, a87
  v_mul_f32 v244, v244, v243
  v_mul_f32 v245, v245, v243
  v_mul_f32 v246, v246, v243
  v_mul_f32 v247, v247, v243
  v_accvgpr_write_b32 a84, v244
  v_accvgpr_write_b32 a85, v245
  v_accvgpr_write_b32 a86, v246
  v_accvgpr_write_b32 a87, v247
  v_accvgpr_read_b32 v244, a88
  v_accvgpr_read_b32 v245, a89
  v_accvgpr_read_b32 v246, a90
  v_accvgpr_read_b32 v247, a91
  v_mul_f32 v244, v244, v243
  v_mul_f32 v245, v245, v243
  v_mul_f32 v246, v246, v243
  v_mul_f32 v247, v247, v243
  v_accvgpr_write_b32 a88, v244
  v_accvgpr_write_b32 a89, v245
  v_accvgpr_write_b32 a90, v246
  v_accvgpr_write_b32 a91, v247
  v_accvgpr_read_b32 v244, a92
  v_accvgpr_read_b32 v245, a93
  v_accvgpr_read_b32 v246, a94
  v_accvgpr_read_b32 v247, a95
  v_mul_f32 v244, v244, v243
  v_mul_f32 v245, v245, v243
  v_mul_f32 v246, v246, v243
  v_mul_f32 v247, v247, v243
  v_accvgpr_write_b32 a92, v244
  v_accvgpr_write_b32 a93, v245
  v_accvgpr_write_b32 a94, v246
  v_accvgpr_write_b32 a95, v247
  v_sub_f32 v176, v176, v240
  v_sub_f32 v177, v177, v240
  v_sub_f32 v178, v178, v240
  v_sub_f32 v179, v179, v240
  v_sub_f32 v180, v180, v240
  v_sub_f32 v181, v181, v240
  v_sub_f32 v182, v182, v240
  v_sub_f32 v183, v183, v240
  v_sub_f32 v144, v144, v240
  v_sub_f32 v145, v145, v240
  v_sub_f32 v146, v146, v240
  v_sub_f32 v147, v147, v240
  v_sub_f32 v148, v148, v240
  v_sub_f32 v149, v149, v240
  v_sub_f32 v150, v150, v240
  v_sub_f32 v151, v151, v240
  v_sub_f32 v224, v224, v240
  v_sub_f32 v225, v225, v240
  v_sub_f32 v226, v226, v240
  v_sub_f32 v227, v227, v240
  v_sub_f32 v228, v228, v240
  v_sub_f32 v229, v229, v240
  v_sub_f32 v230, v230, v240
  v_sub_f32 v231, v231, v240
  v_log_f32 v242, v43
  v_max3_f32 v241, v184, v185, v186
  v_max3_f32 v241, v241, v187, v188
  v_max3_f32 v241, v241, v189, v190
  v_max3_f32 v241, v241, v191, 0
  v_max_f32 v241, v241, v242
  v_mov_b32 v242, v241
  s_nop 1
  v_permlane16_swap_b32 v241, v242
  v_max_f32 v241, v241, v242
  v_mov_b32 v242, v241
  s_nop 1
  v_permlane32_swap_b32 v241, v242
  v_max_f32 v241, v241, v242
  v_exp_f32 v243, -v241
  v_sub_f32 v47, v47, v241
  v_mul_f32 v43, v43, v243
  v_accvgpr_read_b32 v244, a96
  v_accvgpr_read_b32 v245, a97
  v_accvgpr_read_b32 v246, a98
  v_accvgpr_read_b32 v247, a99
  v_mul_f32 v244, v244, v243
  v_mul_f32 v245, v245, v243
  v_mul_f32 v246, v246, v243
  v_mul_f32 v247, v247, v243
  v_accvgpr_write_b32 a96, v244
  v_accvgpr_write_b32 a97, v245
  v_accvgpr_write_b32 a98, v246
  v_accvgpr_write_b32 a99, v247
  v_accvgpr_read_b32 v244, a100
  v_accvgpr_read_b32 v245, a101
  v_accvgpr_read_b32 v246, a102
  v_accvgpr_read_b32 v247, a103
  v_mul_f32 v244, v244, v243
  v_mul_f32 v245, v245, v243
  v_mul_f32 v246, v246, v243
  v_mul_f32 v247, v247, v243
  v_accvgpr_write_b32 a100, v244
  v_accvgpr_write_b32 a101, v245
  v_accvgpr_write_b32 a102, v246
  v_accvgpr_write_b32 a103, v247
  v_accvgpr_read_b32 v244, a104
  v_accvgpr_read_b32 v245, a105
  v_accvgpr_read_b32 v246, a106
  v_accvgpr_read_b32 v247, a107
  v_mul_f32 v244, v244, v243
  v_mul_f32 v245, v245, v243
  v_mul_f32 v246, v246, v243
  v_mul_f32 v247, v247, v243
  v_accvgpr_write_b32 a104, v244
  v_accvgpr_write_b32 a105, v245
  v_accvgpr_write_b32 a106, v246
  v_accvgpr_write_b32 a107, v247
  v_accvgpr_read_b32 v244, a108
  v_accvgpr_read_b32 v245, a109
  v_accvgpr_read_b32 v246, a110
  v_accvgpr_read_b32 v247, a111
  v_mul_f32 v244, v244, v243
  v_mul_f32 v245, v245, v243
  v_mul_f32 v246, v246, v243
  v_mul_f32 v247, v247, v243
  v_accvgpr_write_b32 a108, v244
  v_accvgpr_write_b32 a109, v245
  v_accvgpr_write_b32 a110, v246
  v_accvgpr_write_b32 a111, v247
  v_accvgpr_read_b32 v244, a112
  v_accvgpr_read_b32 v245, a113
  v_accvgpr_read_b32 v246, a114
  v_accvgpr_read_b32 v247, a115
  v_mul_f32 v244, v244, v243
  v_mul_f32 v245, v245, v243
  v_mul_f32 v246, v246, v243
  v_mul_f32 v247, v247, v243
  v_accvgpr_write_b32 a112, v244
  v_accvgpr_write_b32 a113, v245
  v_accvgpr_write_b32 a114, v246
  v_accvgpr_write_b32 a115, v247
  v_accvgpr_read_b32 v244, a116
  v_accvgpr_read_b32 v245, a117
  v_accvgpr_read_b32 v246, a118
  v_accvgpr_read_b32 v247, a119
  v_mul_f32 v244, v244, v243
  v_mul_f32 v245, v245, v243
  v_mul_f32 v246, v246, v243
  v_mul_f32 v247, v247, v243
  v_accvgpr_write_b32 a116, v244
  v_accvgpr_write_b32 a117, v245
  v_accvgpr_write_b32 a118, v246
  v_accvgpr_write_b32 a119, v247
  v_accvgpr_read_b32 v244, a120
  v_accvgpr_read_b32 v245, a121
  v_accvgpr_read_b32 v246, a122
  v_accvgpr_read_b32 v247, a123
  v_mul_f32 v244, v244, v243
  v_mul_f32 v245, v245, v243
  v_mul_f32 v246, v246, v243
  v_mul_f32 v247, v247, v243
  v_accvgpr_write_b32 a120, v244
  v_accvgpr_write_b32 a121, v245
  v_accvgpr_write_b32 a122, v246
  v_accvgpr_write_b32 a123, v247
  v_accvgpr_read_b32 v244, a124
  v_accvgpr_read_b32 v245, a125
  v_accvgpr_read_b32 v246, a126
  v_accvgpr_read_b32 v247, a127
  v_mul_f32 v244, v244, v243
  v_mul_f32 v245, v245, v243
  v_mul_f32 v246, v246, v243
  v_mul_f32 v247, v247, v243
  v_accvgpr_write_b32 a124, v244
  v_accvgpr_write_b32 a125, v245
  v_accvgpr_write_b32 a126, v246
  v_accvgpr_write_b32 a127, v247
  v_sub_f32 v184, v184, v241
  v_sub_f32 v185, v185, v241
  v_sub_f32 v186, v186, v241
  v_sub_f32 v187, v187, v241
  v_sub_f32 v188, v188, v241
  v_sub_f32 v189, v189, v241
  v_sub_f32 v190, v190, v241
  v_sub_f32 v191, v191, v241
  v_sub_f32 v152, v152, v241
  v_sub_f32 v153, v153, v241
  v_sub_f32 v154, v154, v241
  v_sub_f32 v155, v155, v241
  v_sub_f32 v156, v156, v241
  v_sub_f32 v157, v157, v241
  v_sub_f32 v158, v158, v241
  v_sub_f32 v159, v159, v241
  v_sub_f32 v232, v232, v241
  v_sub_f32 v233, v233, v241
  v_sub_f32 v234, v234, v241
  v_sub_f32 v235, v235, v241
  v_sub_f32 v236, v236, v241
  v_sub_f32 v237, v237, v241
  v_sub_f32 v238, v238, v241
  v_sub_f32 v239, v239, v241
  v_exp_f32 v32, v176
  v_exp_f32 v33, v177
  v_exp_f32 v34, v178
  v_cvt_pk_bf16_f32 v200, v32, v33
  v_exp_f32 v35, v179
  v_exp_f32 v32, v180
  v_cvt_pk_bf16_f32 v201, v34, v35
  v_exp_f32 v33, v181
  v_exp_f32 v34, v182
  v_cvt_pk_bf16_f32 v202, v32, v33
  v_exp_f32 v35, v183
  v_exp_f32 v32, v184
  v_cvt_pk_bf16_f32 v203, v34, v35
  v_exp_f32 v33, v185
  v_exp_f32 v34, v186
  v_cvt_pk_bf16_f32 v204, v32, v33
  v_exp_f32 v35, v187
  v_exp_f32 v32, v188
  v_cvt_pk_bf16_f32 v205, v34, v35
  v_exp_f32 v33, v189
  v_exp_f32 v34, v190
  v_cvt_pk_bf16_f32 v206, v32, v33
  v_exp_f32 v35, v191
  s_nop 0
  v_cvt_pk_bf16_f32 v207, v34, v35
  s_nop 1
  v_mfma_f32_16x16x32_bf16 v[56:59], a[224:227], v[200:203], 0
  v_mfma_f32_16x16x32_bf16 v[60:63], a[224:227], v[204:207], 0
  s_nop 9
  v_add_f32 v40, v41, v56
  v_add_f32 v42, v43, v60
  v_exp_f32 v32, v128
  v_exp_f32 v33, v129
  v_exp_f32 v34, v130
  v_cvt_pk_bf16_f32 v192, v32, v33
  s_nop 3
  s_setpc_b64 s[6:7]
Lrare29:
  s_call_b64 s[6:7], Lrh28
  s_branch Lrr30
Lrh31:
  s_nop 15
  v_log_f32 v242, v36
  v_max3_f32 v240, v128, v129, v130
  v_max3_f32 v240, v240, v131, v132
  v_max3_f32 v240, v240, v133, v134
  v_max3_f32 v240, v240, v135, 0
  v_max_f32 v240, v240, v242
  v_mov_b32 v242, v240
  s_nop 1
  v_permlane16_swap_b32 v240, v242
  v_max_f32 v240, v240, v242
  v_mov_b32 v242, v240
  s_nop 1
  v_permlane32_swap_b32 v240, v242
  v_max_f32 v240, v240, v242
  v_exp_f32 v243, -v240
  v_sub_f32 v44, v44, v240
  v_mul_f32 v36, v36, v243
  v_accvgpr_read_b32 v244, a0
  v_accvgpr_read_b32 v245, a1
  v_accvgpr_read_b32 v246, a2
  v_accvgpr_read_b32 v247, a3
  v_mul_f32 v244, v244, v243
  v_mul_f32 v245, v245, v243
  v_mul_f32 v246, v246, v243
  v_mul_f32 v247, v247, v243
  v_accvgpr_write_b32 a0, v244
  v_accvgpr_write_b32 a1, v245
  v_accvgpr_write_b32 a2, v246
  v_accvgpr_write_b32 a3, v247
  v_accvgpr_read_b32 v244, a4
  v_accvgpr_read_b32 v245, a5
  v_accvgpr_read_b32 v246, a6
  v_accvgpr_read_b32 v247, a7
  v_mul_f32 v244, v244, v243
  v_mul_f32 v245, v245, v243
  v_mul_f32 v246, v246, v243
  v_mul_f32 v247, v247, v243
  v_accvgpr_write_b32 a4, v244
  v_accvgpr_write_b32 a5, v245
  v_accvgpr_write_b32 a6, v246
  v_accvgpr_write_b32 a7, v247
  v_accvgpr_read_b32 v244, a8
  v_accvgpr_read_b32 v245, a9
  v_accvgpr_read_b32 v246, a10
  v_accvgpr_read_b32 v247, a11
  v_mul_f32 v244, v244, v243
  v_mul_f32 v245, v245, v243
  v_mul_f32 v246, v246, v243
  v_mul_f32 v247, v247, v243
  v_accvgpr_write_b32 a8, v244
  v_accvgpr_write_b32 a9, v245
  v_accvgpr_write_b32 a10, v246
  v_accvgpr_write_b32 a11, v247
  v_accvgpr_read_b32 v244, a12
  v_accvgpr_read_b32 v245, a13
  v_accvgpr_read_b32 v246, a14
  v_accvgpr_read_b32 v247, a15
  v_mul_f32 v244, v244, v243
  v_mul_f32 v245, v245, v243
  v_mul_f32 v246, v246, v243
  v_mul_f32 v247, v247, v243
  v_accvgpr_write_b32 a12, v244
  v_accvgpr_write_b32 a13, v245
  v_accvgpr_write_b32 a14, v246
  v_accvgpr_write_b32 a15, v247
  v_accvgpr_read_b32 v244, a16
  v_accvgpr_read_b32 v245, a17
  v_accvgpr_read_b32 v246, a18
  v_accvgpr_read_b32 v247, a19
  v_mul_f32 v244, v244, v243
  v_mul_f32 v245, v245, v243
  v_mul_f32 v246, v246, v243
  v_mul_f32 v247, v247, v243
  v_accvgpr_write_b32 a16, v244
  v_accvgpr_write_b32 a17, v245
  v_accvgpr_write_b32 a18, v246
  v_accvgpr_write_b32 a19, v247
  v_accvgpr_read_b32 v244, a20
  v_accvgpr_read_b32 v245, a21
  v_accvgpr_read_b32 v246, a22
  v_accvgpr_read_b32 v247, a23
  v_mul_f32 v244, v244, v243
  v_mul_f32 v245, v245, v243
  v_mul_f32 v246, v246, v243
  v_mul_f32 v247, v247, v243
  v_accvgpr_write_b32 a20, v244
  v_accvgpr_write_b32 a21, v245
  v_accvgpr_write_b32 a22, v246
  v_accvgpr_write_b32 a23, v247
  v_accvgpr_read_b32 v244, a24
  v_accvgpr_read_b32 v245, a25
  v_accvgpr_read_b32 v246, a26
  v_accvgpr_read_b32 v247, a27
  v_mul_f32 v244, v244, v243
  v_mul_f32 v245, v245, v243
  v_mul_f32 v246, v246, v243
  v_mul_f32 v247, v247, v243
  v_accvgpr_write_b32 a24, v244
  v_accvgpr_write_b32 a25, v245
  v_accvgpr_write_b32 a26, v246
  v_accvgpr_write_b32 a27, v247
  v_accvgpr_read_b32 v244, a28
  v_accvgpr_read_b32 v245, a29
  v_accvgpr_read_b32 v246, a30
  v_accvgpr_read_b32 v247, a31
  v_mul_f32 v244, v244, v243
  v_mul_f32 v245, v245, v243
  v_mul_f32 v246, v246, v243
  v_mul_f32 v247, v247, v243
  v_accvgpr_write_b32 a28, v244
  v_accvgpr_write_b32 a29, v245
  v_accvgpr_write_b32 a30, v246
  v_accvgpr_write_b32 a31, v247
  v_sub_f32 v128, v128, v240
  v_sub_f32 v129, v129, v240
  v_sub_f32 v130, v130, v240
  v_sub_f32 v131, v131, v240
  v_sub_f32 v132, v132, v240
  v_sub_f32 v133, v133, v240
  v_sub_f32 v134, v134, v240
  v_sub_f32 v135, v135, v240
  v_sub_f32 v160, v160, v240
  v_sub_f32 v161, v161, v240
  v_sub_f32 v162, v162, v240
  v_sub_f32 v163, v163, v240
  v_sub_f32 v164, v164, v240
  v_sub_f32 v165, v165, v240
  v_sub_f32 v166, v166, v240
  v_sub_f32 v167, v167, v240
  v_sub_f32 v208, v208, v240
  v_sub_f32 v209, v209, v240
  v_sub_f32 v210, v210, v240
  v_sub_f32 v211, v211, v240
  v_sub_f32 v212, v212, v240
  v_sub_f32 v213, v213, v240
  v_sub_f32 v214, v214, v240
  v_sub_f32 v215, v215, v240
  v_log_f32 v242, v38
  v_max3_f32 v241, v136, v137, v138
  v_max3_f32 v241, v241, v139, v140
  v_max3_f32 v241, v241, v141, v142
  v_max3_f32 v241, v241, v143, 0
  v_max_f32 v241, v241, v242
  v_mov_b32 v242, v241
  s_nop 1
  v_permlane16_swap_b32 v241, v242
  v_max_f32 v241, v241, v242
  v_mov_b32 v242, v241
  s_nop 1
  v_permlane32_swap_b32 v241, v242
  v_max_f32 v241, v241, v242
  v_exp_f32 v243, -v241
  v_sub_f32 v45, v45, v241
  v_mul_f32 v38, v38, v243
  v_accvgpr_read_b32 v244, a32
  v_accvgpr_read_b32 v245, a33
  v_accvgpr_read_b32 v246, a34
  v_accvgpr_read_b32 v247, a35
  v_mul_f32 v244, v244, v243
  v_mul_f32 v245, v245, v243
  v_mul_f32 v246, v246, v243
  v_mul_f32 v247, v247, v243
  v_accvgpr_write_b32 a32, v244
  v_accvgpr_write_b32 a33, v245
  v_accvgpr_write_b32 a34, v246
  v_accvgpr_write_b32 a35, v247
  v_accvgpr_read_b32 v244, a36
  v_accvgpr_read_b32 v245, a37
  v_accvgpr_read_b32 v246, a38
  v_accvgpr_read_b32 v247, a39
  v_mul_f32 v244, v244, v243
  v_mul_f32 v245, v245, v243
  v_mul_f32 v246, v246, v243
  v_mul_f32 v247, v247, v243
  v_accvgpr_write_b32 a36, v244
  v_accvgpr_write_b32 a37, v245
  v_accvgpr_write_b32 a38, v246
  v_accvgpr_write_b32 a39, v247
  v_accvgpr_read_b32 v244, a40
  v_accvgpr_read_b32 v245, a41
  v_accvgpr_read_b32 v246, a42
  v_accvgpr_read_b32 v247, a43
  v_mul_f32 v244, v244, v243
  v_mul_f32 v245, v245, v243
  v_mul_f32 v246, v246, v243
  v_mul_f32 v247, v247, v243
  v_accvgpr_write_b32 a40, v244
  v_accvgpr_write_b32 a41, v245
  v_accvgpr_write_b32 a42, v246
  v_accvgpr_write_b32 a43, v247
  v_accvgpr_read_b32 v244, a44
  v_accvgpr_read_b32 v245, a45
  v_accvgpr_read_b32 v246, a46
  v_accvgpr_read_b32 v247, a47
  v_mul_f32 v244, v244, v243
  v_mul_f32 v245, v245, v243
  v_mul_f32 v246, v246, v243
  v_mul_f32 v247, v247, v243
  v_accvgpr_write_b32 a44, v244
  v_accvgpr_write_b32 a45, v245
  v_accvgpr_write_b32 a46, v246
  v_accvgpr_write_b32 a47, v247
  v_accvgpr_read_b32 v244, a48
  v_accvgpr_read_b32 v245, a49
  v_accvgpr_read_b32 v246, a50
  v_accvgpr_read_b32 v247, a51
  v_mul_f32 v244, v244, v243
  v_mul_f32 v245, v245, v243
  v_mul_f32 v246, v246, v243
  v_mul_f32 v247, v247, v243
  v_accvgpr_write_b32 a48, v244
  v_accvgpr_write_b32 a49, v245
  v_accvgpr_write_b32 a50, v246
  v_accvgpr_write_b32 a51, v247
  v_accvgpr_read_b32 v244, a52
  v_accvgpr_read_b32 v245, a53
  v_accvgpr_read_b32 v246, a54
  v_accvgpr_read_b32 v247, a55
  v_mul_f32 v244, v244, v243
  v_mul_f32 v245, v245, v243
  v_mul_f32 v246, v246, v243
  v_mul_f32 v247, v247, v243
  v_accvgpr_write_b32 a52, v244
  v_accvgpr_write_b32 a53, v245
  v_accvgpr_write_b32 a54, v246
  v_accvgpr_write_b32 a55, v247
  v_accvgpr_read_b32 v244, a56
  v_accvgpr_read_b32 v245, a57
  v_accvgpr_read_b32 v246, a58
  v_accvgpr_read_b32 v247, a59
  v_mul_f32 v244, v244, v243
  v_mul_f32 v245, v245, v243
  v_mul_f32 v246, v246, v243
  v_mul_f32 v247, v247, v243
  v_accvgpr_write_b32 a56, v244
  v_accvgpr_write_b32 a57, v245
  v_accvgpr_write_b32 a58, v246
  v_accvgpr_write_b32 a59, v247
  v_accvgpr_read_b32 v244, a60
  v_accvgpr_read_b32 v245, a61
  v_accvgpr_read_b32 v246, a62
  v_accvgpr_read_b32 v247, a63
  v_mul_f32 v244, v244, v243
  v_mul_f32 v245, v245, v243
  v_mul_f32 v246, v246, v243
  v_mul_f32 v247, v247, v243
  v_accvgpr_write_b32 a60, v244
  v_accvgpr_write_b32 a61, v245
  v_accvgpr_write_b32 a62, v246
  v_accvgpr_write_b32 a63, v247
  v_sub_f32 v136, v136, v241
  v_sub_f32 v137, v137, v241
  v_sub_f32 v138, v138, v241
  v_sub_f32 v139, v139, v241
  v_sub_f32 v140, v140, v241
  v_sub_f32 v141, v141, v241
  v_sub_f32 v142, v142, v241
  v_sub_f32 v143, v143, v241
  v_sub_f32 v168, v168, v241
  v_sub_f32 v169, v169, v241
  v_sub_f32 v170, v170, v241
  v_sub_f32 v171, v171, v241
  v_sub_f32 v172, v172, v241
  v_sub_f32 v173, v173, v241
  v_sub_f32 v174, v174, v241
  v_sub_f32 v175, v175, v241
  v_sub_f32 v216, v216, v241
  v_sub_f32 v217, v217, v241
  v_sub_f32 v218, v218, v241
  v_sub_f32 v219, v219, v241
  v_sub_f32 v220, v220, v241
  v_sub_f32 v221, v221, v241
  v_sub_f32 v222, v222, v241
  v_sub_f32 v223, v223, v241
  v_exp_f32 v32, v128
  v_exp_f32 v33, v129
  v_exp_f32 v34, v130
  v_cvt_pk_bf16_f32 v192, v32, v33
  v_exp_f32 v35, v131
  v_exp_f32 v32, v132
  v_cvt_pk_bf16_f32 v193, v34, v35
  v_exp_f32 v33, v133
  v_exp_f32 v34, v134
  v_cvt_pk_bf16_f32 v194, v32, v33
  v_exp_f32 v35, v135
  v_exp_f32 v32, v136
  v_cvt_pk_bf16_f32 v195, v34, v35
  v_exp_f32 v33, v137
  v_exp_f32 v34, v138
  v_cvt_pk_bf16_f32 v196, v32, v33
  v_exp_f32 v35, v139
  v_exp_f32 v32, v140
  v_cvt_pk_bf16_f32 v197, v34, v35
  v_exp_f32 v33, v141
  v_exp_f32 v34, v142
  v_cvt_pk_bf16_f32 v198, v32, v33
  v_exp_f32 v35, v143
  s_nop 0
  v_cvt_pk_bf16_f32 v199, v34, v35
  s_nop 1
  v_mfma_f32_16x16x32_bf16 v[56:59], a[224:227], v[192:195], 0
  v_mfma_f32_16x16x32_bf16 v[60:63], a[224:227], v[196:199], 0
  s_nop 9
  v_add_f32 v37, v36, v56
  v_add_f32 v39, v38, v60
  s_nop 3
  s_setpc_b64 s[6:7]
Lrare32:
  s_call_b64 s[6:7], Lrh31
  s_branch Lrr33
Lrh34:
  s_nop 15
  v_log_f32 v242, v42
  v_max3_f32 v241, v152, v153, v154
  v_max3_f32 v241, v241, v155, v156
  v_max3_f32 v241, v241, v157, v158
  v_max3_f32 v241, v241, v159, 0
  v_max_f32 v241, v241, v242
  v_mov_b32 v242, v241
  s_nop 1
  v_permlane16_swap_b32 v241, v242
  v_max_f32 v241, v241, v242
  v_mov_b32 v242, v241
  s_nop 1
  v_permlane32_swap_b32 v241, v242
  v_max_f32 v241, v241, v242
  v_exp_f32 v243, -v241
  v_sub_f32 v47, v47, v241
  v_mul_f32 v42, v42, v243
  v_accvgpr_read_b32 v244, a96
  v_accvgpr_read_b32 v245, a97
  v_accvgpr_read_b32 v246, a98
  v_accvgpr_read_b32 v247, a99
  v_mul_f32 v244, v244, v243
  v_mul_f32 v245, v245, v243
  v_mul_f32 v246, v246, v243
  v_mul_f32 v247, v247, v243
  v_accvgpr_write_b32 a96, v244
  v_accvgpr_write_b32 a97, v245
  v_accvgpr_write_b32 a98, v246
  v_accvgpr_write_b32 a99, v247
  v_accvgpr_read_b32 v244, a100
  v_accvgpr_read_b32 v245, a101
  v_accvgpr_read_b32 v246, a102
  v_accvgpr_read_b32 v247, a103
  v_mul_f32 v244, v244, v243
  v_mul_f32 v245, v245, v243
  v_mul_f32 v246, v246, v243
  v_mul_f32 v247, v247, v243
  v_accvgpr_write_b32 a100, v244
  v_accvgpr_write_b32 a101, v245
  v_accvgpr_write_b32 a102, v246
  v_accvgpr_write_b32 a103, v247
  v_accvgpr_read_b32 v244, a104
  v_accvgpr_read_b32 v245, a105
  v_accvgpr_read_b32 v246, a106
  v_accvgpr_read_b32 v247, a107
  v_mul_f32 v244, v244, v243
  v_mul_f32 v245, v245, v243
  v_mul_f32 v246, v246, v243
  v_mul_f32 v247, v247, v243
  v_accvgpr_write_b32 a104, v244
  v_accvgpr_write_b32 a105, v245
  v_accvgpr_write_b32 a106, v246
  v_accvgpr_write_b32 a107, v247
  v_accvgpr_read_b32 v244, a108
  v_accvgpr_read_b32 v245, a109
  v_accvgpr_read_b32 v246, a110
  v_accvgpr_read_b32 v247, a111
  v_mul_f32 v244, v244, v243
  v_mul_f32 v245, v245, v243
  v_mul_f32 v246, v246, v243
  v_mul_f32 v247, v247, v243
  v_accvgpr_write_b32 a108, v244
  v_accvgpr_write_b32 a109, v245
  v_accvgpr_write_b32 a110, v246
  v_accvgpr_write_b32 a111, v247
  v_accvgpr_read_b32 v244, a112
  v_accvgpr_read_b32 v245, a113
  v_accvgpr_read_b32 v246, a114
  v_accvgpr_read_b32 v247, a115
  v_mul_f32 v244, v244, v243
  v_mul_f32 v245, v245, v243
  v_mul_f32 v246, v246, v243
  v_mul_f32 v247, v247, v243
  v_accvgpr_write_b32 a112, v244
  v_accvgpr_write_b32 a113, v245
  v_accvgpr_write_b32 a114, v246
  v_accvgpr_write_b32 a115, v247
  v_accvgpr_read_b32 v244, a116
  v_accvgpr_read_b32 v245, a117
  v_accvgpr_read_b32 v246, a118
  v_accvgpr_read_b32 v247, a119
  v_mul_f32 v244, v244, v243
  v_mul_f32 v245, v245, v243
  v_mul_f32 v246, v246, v243
  v_mul_f32 v247, v247, v243
  v_accvgpr_write_b32 a116, v244
  v_accvgpr_write_b32 a117, v245
  v_accvgpr_write_b32 a118, v246
  v_accvgpr_write_b32 a119, v247
  v_accvgpr_read_b32 v244, a120
  v_accvgpr_read_b32 v245, a121
  v_accvgpr_read_b32 v246, a122
  v_accvgpr_read_b32 v247, a123
  v_mul_f32 v244, v244, v243
  v_mul_f32 v245, v245, v243
  v_mul_f32 v246, v246, v243
  v_mul_f32 v247, v247, v243
  v_accvgpr_write_b32 a120, v244
  v_accvgpr_write_b32 a121, v245
  v_accvgpr_write_b32 a122, v246
  v_accvgpr_write_b32 a123, v247
  v_accvgpr_read_b32 v244, a124
  v_accvgpr_read_b32 v245, a125
  v_accvgpr_read_b32 v246, a126
  v_accvgpr_read_b32 v247, a127
  v_mul_f32 v244, v244, v243
  v_mul_f32 v245, v245, v243
  v_mul_f32 v246, v246, v243
  v_mul_f32 v247, v247, v243
  v_accvgpr_write_b32 a124, v244
  v_accvgpr_write_b32 a125, v245
  v_accvgpr_write_b32 a126, v246
  v_accvgpr_write_b32 a127, v247
  v_sub_f32 v152, v152, v241
  v_sub_f32 v153, v153, v241
  v_sub_f32 v154, v154, v241
  v_sub_f32 v155, v155, v241
  v_sub_f32 v156, v156, v241
  v_sub_f32 v157, v157, v241
  v_sub_f32 v158, v158, v241
  v_sub_f32 v159, v159, v241
  v_sub_f32 v184, v184, v241
  v_sub_f32 v185, v185, v241
  v_sub_f32 v186, v186, v241
  v_sub_f32 v187, v187, v241
  v_sub_f32 v188, v188, v241
  v_sub_f32 v189, v189, v241
  v_sub_f32 v190, v190, v241
  v_sub_f32 v191, v191, v241
  v_sub_f32 v232, v232, v241
  v_sub_f32 v233, v233, v241
  v_sub_f32 v234, v234, v241
  v_sub_f32 v235, v235, v241
  v_sub_f32 v236, v236, v241
  v_sub_f32 v237, v237, v241
  v_sub_f32 v238, v238, v241
  v_sub_f32 v239, v239, v241
  v_exp_f32 v32, v152
  v_exp_f32 v33, v153
  v_exp_f32 v34, v154
  v_cvt_pk_bf16_f32 v204, v32, v33
  v_exp_f32 v35, v155
  v_exp_f32 v32, v156
  v_cvt_pk_bf16_f32 v205, v34, v35
  v_exp_f32 v33, v157
  v_exp_f32 v34, v158
  v_cvt_pk_bf16_f32 v206, v32, v33
  v_exp_f32 v35, v159
  s_nop 0
  v_cvt_pk_bf16_f32 v207, v34, v35
  s_nop 1
  v_mfma_f32_16x16x32_bf16 v[60:63], a[224:227], v[204:207], 0
  s_nop 9
  v_mov_b32 v41, v40
  v_add_f32 v43, v42, v60
  v_exp_f32 v32, v160
  v_exp_f32 v33, v161
  v_exp_f32 v34, v162
  v_cvt_pk_bf16_f32 v248, v32, v33
  s_nop 3
  s_setpc_b64 s[6:7]
Lrare35:
  s_call_b64 s[6:7], Lrh34
  s_branch Lrr36
Lrare40:
  s_call_b64 s[6:7], Lrh19
  s_branch Lrr41
Lrare42:
  s_call_b64 s[6:7], Lrh22
  s_branch Lrr43
Lrare44:
  s_call_b64 s[6:7], Lrh25
  s_branch Lrr45
Lrare46:
  s_call_b64 s[6:7], Lrh28
  s_branch Lrr47
Lrare48:
  s_call_b64 s[6:7], Lrh19
  s_branch Lrr49
Lrare50:
  s_call_b64 s[6:7], Lrh22
  s_branch Lrr51
Lrare54:
  s_call_b64 s[6:7], Lrh25
  s_branch Lrr55
Lrare56:
  s_call_b64 s[6:7], Lrh28
  s_branch Lrr57
Lrare58:
  s_call_b64 s[6:7], Lrh19
  s_branch Lrr59
Lrare60:
  s_call_b64 s[6:7], Lrh22
  s_branch Lrr61
Lrare62:
  s_call_b64 s[6:7], Lrh25
  s_branch Lrr63
Lrare64:
  s_call_b64 s[6:7], Lrh28
  s_branch Lrr65
Lrare66:
  s_call_b64 s[6:7], Lrh19
  s_branch Lrr67
Lrare68:
  s_call_b64 s[6:7], Lrh22
  s_branch Lrr69
Lrare72:
  s_call_b64 s[6:7], Lrh25
  s_branch Lrr73
Lrare74:
  s_call_b64 s[6:7], Lrh28
  s_branch Lrr75
Lrare76:
  s_call_b64 s[6:7], Lrh19
  s_branch Lrr77
Lrare78:
  s_call_b64 s[6:7], Lrh22
  s_branch Lrr79
Lrare80:
  s_call_b64 s[6:7], Lrh25
  s_branch Lrr81
Lrare82:
  s_call_b64 s[6:7], Lrh28
  s_branch Lrr83
Lrare84:
  s_call_b64 s[6:7], Lrh31
  s_branch Lrr85
Lrare86:
  s_call_b64 s[6:7], Lrh34
  s_branch Lrr87
Lrh88:
  s_nop 15
  v_log_f32 v242, v37
  v_max3_f32 v240, v160, v161, v162
  v_max3_f32 v240, v240, v163, v164
  v_max3_f32 v240, v240, v165, v166
  v_max3_f32 v240, v240, v167, 0
  v_max_f32 v240, v240, v242
  v_mov_b32 v242, v240
  s_nop 1
  v_permlane16_swap_b32 v240, v242
  v_max_f32 v240, v240, v242
  v_mov_b32 v242, v240
  s_nop 1
  v_permlane32_swap_b32 v240, v242
  v_max_f32 v240, v240, v242
  v_exp_f32 v243, -v240
  v_sub_f32 v44, v44, v240
  v_mul_f32 v37, v37, v243
  v_accvgpr_read_b32 v244, a0
  v_accvgpr_read_b32 v245, a1
  v_accvgpr_read_b32 v246, a2
  v_accvgpr_read_b32 v247, a3
  v_mul_f32 v244, v244, v243
  v_mul_f32 v245, v245, v243
  v_mul_f32 v246, v246, v243
  v_mul_f32 v247, v247, v243
  v_accvgpr_write_b32 a0, v244
  v_accvgpr_write_b32 a1, v245
  v_accvgpr_write_b32 a2, v246
  v_accvgpr_write_b32 a3, v247
  v_accvgpr_read_b32 v244, a4
  v_accvgpr_read_b32 v245, a5
  v_accvgpr_read_b32 v246, a6
  v_accvgpr_read_b32 v247, a7
  v_mul_f32 v244, v244, v243
  v_mul_f32 v245, v245, v243
  v_mul_f32 v246, v246, v243
  v_mul_f32 v247, v247, v243
  v_accvgpr_write_b32 a4, v244
  v_accvgpr_write_b32 a5, v245
  v_accvgpr_write_b32 a6, v246
  v_accvgpr_write_b32 a7, v247
  v_accvgpr_read_b32 v244, a8
  v_accvgpr_read_b32 v245, a9
  v_accvgpr_read_b32 v246, a10
  v_accvgpr_read_b32 v247, a11
  v_mul_f32 v244, v244, v243
  v_mul_f32 v245, v245, v243
  v_mul_f32 v246, v246, v243
  v_mul_f32 v247, v247, v243
  v_accvgpr_write_b32 a8, v244
  v_accvgpr_write_b32 a9, v245
  v_accvgpr_write_b32 a10, v246
  v_accvgpr_write_b32 a11, v247
  v_accvgpr_read_b32 v244, a12
  v_accvgpr_read_b32 v245, a13
  v_accvgpr_read_b32 v246, a14
  v_accvgpr_read_b32 v247, a15
  v_mul_f32 v244, v244, v243
  v_mul_f32 v245, v245, v243
  v_mul_f32 v246, v246, v243
  v_mul_f32 v247, v247, v243
  v_accvgpr_write_b32 a12, v244
  v_accvgpr_write_b32 a13, v245
  v_accvgpr_write_b32 a14, v246
  v_accvgpr_write_b32 a15, v247
  v_accvgpr_read_b32 v244, a16
  v_accvgpr_read_b32 v245, a17
  v_accvgpr_read_b32 v246, a18
  v_accvgpr_read_b32 v247, a19
  v_mul_f32 v244, v244, v243
  v_mul_f32 v245, v245, v243
  v_mul_f32 v246, v246, v243
  v_mul_f32 v247, v247, v243
  v_accvgpr_write_b32 a16, v244
  v_accvgpr_write_b32 a17, v245
  v_accvgpr_write_b32 a18, v246
  v_accvgpr_write_b32 a19, v247
  v_accvgpr_read_b32 v244, a20
  v_accvgpr_read_b32 v245, a21
  v_accvgpr_read_b32 v246, a22
  v_accvgpr_read_b32 v247, a23
  v_mul_f32 v244, v244, v243
  v_mul_f32 v245, v245, v243
  v_mul_f32 v246, v246, v243
  v_mul_f32 v247, v247, v243
  v_accvgpr_write_b32 a20, v244
  v_accvgpr_write_b32 a21, v245
  v_accvgpr_write_b32 a22, v246
  v_accvgpr_write_b32 a23, v247
  v_accvgpr_read_b32 v244, a24
  v_accvgpr_read_b32 v245, a25
  v_accvgpr_read_b32 v246, a26
  v_accvgpr_read_b32 v247, a27
  v_mul_f32 v244, v244, v243
  v_mul_f32 v245, v245, v243
  v_mul_f32 v246, v246, v243
  v_mul_f32 v247, v247, v243
  v_accvgpr_write_b32 a24, v244
  v_accvgpr_write_b32 a25, v245
  v_accvgpr_write_b32 a26, v246
  v_accvgpr_write_b32 a27, v247
  v_accvgpr_read_b32 v244, a28
  v_accvgpr_read_b32 v245, a29
  v_accvgpr_read_b32 v246, a30
  v_accvgpr_read_b32 v247, a31
  v_mul_f32 v244, v244, v243
  v_mul_f32 v245, v245, v243
  v_mul_f32 v246, v246, v243
  v_mul_f32 v247, v247, v243
  v_accvgpr_write_b32 a28, v244
  v_accvgpr_write_b32 a29, v245
  v_accvgpr_write_b32 a30, v246
  v_accvgpr_write_b32 a31, v247
  v_sub_f32 v160, v160, v240
  v_sub_f32 v161, v161, v240
  v_sub_f32 v162, v162, v240
  v_sub_f32 v163, v163, v240
  v_sub_f32 v164, v164, v240
  v_sub_f32 v165, v165, v240
  v_sub_f32 v166, v166, v240
  v_sub_f32 v167, v167, v240
  v_sub_f32 v128, v128, v240
  v_sub_f32 v129, v129, v240
  v_sub_f32 v130, v130, v240
  v_sub_f32 v131, v131, v240
  v_sub_f32 v132, v132, v240
  v_sub_f32 v133, v133, v240
  v_sub_f32 v134, v134, v240
  v_sub_f32 v135, v135, v240
  v_sub_f32 v208, v208, v240
  v_sub_f32 v209, v209, v240
  v_sub_f32 v210, v210, v240
  v_sub_f32 v211, v211, v240
  v_sub_f32 v212, v212, v240
  v_sub_f32 v213, v213, v240
  v_sub_f32 v214, v214, v240
  v_sub_f32 v215, v215, v240
  v_sub_f32 v144, v144, v240
  v_sub_f32 v145, v145, v240
  v_sub_f32 v146, v146, v240
  v_sub_f32 v147, v147, v240
  v_sub_f32 v148, v148, v240
  v_sub_f32 v149, v149, v240
  v_sub_f32 v150, v150, v240
  v_sub_f32 v151, v151, v240
  v_sub_f32 v224, v224, v240
  v_sub_f32 v225, v225, v240
  v_sub_f32 v226, v226, v240
  v_sub_f32 v227, v227, v240
  v_sub_f32 v228, v228, v240
  v_sub_f32 v229, v229, v240
  v_sub_f32 v230, v230, v240
  v_sub_f32 v231, v231, v240
  v_log_f32 v242, v39
  v_max3_f32 v241, v168, v169, v170
  v_max3_f32 v241, v241, v171, v172
  v_max3_f32 v241, v241, v173, v174
  v_max3_f32 v241, v241, v175, 0
  v_max_f32 v241, v241, v242
  v_mov_b32 v242, v241
  s_nop 1
  v_permlane16_swap_b32 v241, v242
  v_max_f32 v241, v241, v242
  v_mov_b32 v242, v241
  s_nop 1
  v_permlane32_swap_b32 v241, v242
  v_max_f32 v241, v241, v242
  v_exp_f32 v243, -v241
  v_sub_f32 v45, v45, v241
  v_mul_f32 v39, v39, v243
  v_accvgpr_read_b32 v244, a32
  v_accvgpr_read_b32 v245, a33
  v_accvgpr_read_b32 v246, a34
  v_accvgpr_read_b32 v247, a35
  v_mul_f32 v244, v244, v243
  v_mul_f32 v245, v245, v243
  v_mul_f32 v246, v246, v243
  v_mul_f32 v247, v247, v243
  v_accvgpr_write_b32 a32, v244
  v_accvgpr_write_b32 a33, v245
  v_accvgpr_write_b32 a34, v246
  v_accvgpr_write_b32 a35, v247
  v_accvgpr_read_b32 v244, a36
  v_accvgpr_read_b32 v245, a37
  v_accvgpr_read_b32 v246, a38
  v_accvgpr_read_b32 v247, a39
  v_mul_f32 v244, v244, v243
  v_mul_f32 v245, v245, v243
  v_mul_f32 v246, v246, v243
  v_mul_f32 v247, v247, v243
  v_accvgpr_write_b32 a36, v244
  v_accvgpr_write_b32 a37, v245
  v_accvgpr_write_b32 a38, v246
  v_accvgpr_write_b32 a39, v247
  v_accvgpr_read_b32 v244, a40
  v_accvgpr_read_b32 v245, a41
  v_accvgpr_read_b32 v246, a42
  v_accvgpr_read_b32 v247, a43
  v_mul_f32 v244, v244, v243
  v_mul_f32 v245, v245, v243
  v_mul_f32 v246, v246, v243
  v_mul_f32 v247, v247, v243
  v_accvgpr_write_b32 a40, v244
  v_accvgpr_write_b32 a41, v245
  v_accvgpr_write_b32 a42, v246
  v_accvgpr_write_b32 a43, v247
  v_accvgpr_read_b32 v244, a44
  v_accvgpr_read_b32 v245, a45
  v_accvgpr_read_b32 v246, a46
  v_accvgpr_read_b32 v247, a47
  v_mul_f32 v244, v244, v243
  v_mul_f32 v245, v245, v243
  v_mul_f32 v246, v246, v243
  v_mul_f32 v247, v247, v243
  v_accvgpr_write_b32 a44, v244
  v_accvgpr_write_b32 a45, v245
  v_accvgpr_write_b32 a46, v246
  v_accvgpr_write_b32 a47, v247
  v_accvgpr_read_b32 v244, a48
  v_accvgpr_read_b32 v245, a49
  v_accvgpr_read_b32 v246, a50
  v_accvgpr_read_b32 v247, a51
  v_mul_f32 v244, v244, v243
  v_mul_f32 v245, v245, v243
  v_mul_f32 v246, v246, v243
  v_mul_f32 v247, v247, v243
  v_accvgpr_write_b32 a48, v244
  v_accvgpr_write_b32 a49, v245
  v_accvgpr_write_b32 a50, v246
  v_accvgpr_write_b32 a51, v247
  v_accvgpr_read_b32 v244, a52
  v_accvgpr_read_b32 v245, a53
  v_accvgpr_read_b32 v246, a54
  v_accvgpr_read_b32 v247, a55
  v_mul_f32 v244, v244, v243
  v_mul_f32 v245, v245, v243
  v_mul_f32 v246, v246, v243
  v_mul_f32 v247, v247, v243
  v_accvgpr_write_b32 a52, v244
  v_accvgpr_write_b32 a53, v245
  v_accvgpr_write_b32 a54, v246
  v_accvgpr_write_b32 a55, v247
  v_accvgpr_read_b32 v244, a56
  v_accvgpr_read_b32 v245, a57
  v_accvgpr_read_b32 v246, a58
  v_accvgpr_read_b32 v247, a59
  v_mul_f32 v244, v244, v243
  v_mul_f32 v245, v245, v243
  v_mul_f32 v246, v246, v243
  v_mul_f32 v247, v247, v243
  v_accvgpr_write_b32 a56, v244
  v_accvgpr_write_b32 a57, v245
  v_accvgpr_write_b32 a58, v246
  v_accvgpr_write_b32 a59, v247
  v_accvgpr_read_b32 v244, a60
  v_accvgpr_read_b32 v245, a61
  v_accvgpr_read_b32 v246, a62
  v_accvgpr_read_b32 v247, a63
  v_mul_f32 v244, v244, v243
  v_mul_f32 v245, v245, v243
  v_mul_f32 v246, v246, v243
  v_mul_f32 v247, v247, v243
  v_accvgpr_write_b32 a60, v244
  v_accvgpr_write_b32 a61, v245
  v_accvgpr_write_b32 a62, v246
  v_accvgpr_write_b32 a63, v247
  v_sub_f32 v168, v168, v241
  v_sub_f32 v169, v169, v241
  v_sub_f32 v170, v170, v241
  v_sub_f32 v171, v171, v241
  v_sub_f32 v172, v172, v241
  v_sub_f32 v173, v173, v241
  v_sub_f32 v174, v174, v241
  v_sub_f32 v175, v175, v241
  v_sub_f32 v136, v136, v241
  v_sub_f32 v137, v137, v241
  v_sub_f32 v138, v138, v241
  v_sub_f32 v139, v139, v241
  v_sub_f32 v140, v140, v241
  v_sub_f32 v141, v141, v241
  v_sub_f32 v142, v142, v241
  v_sub_f32 v143, v143, v241
  v_sub_f32 v216, v216, v241
  v_sub_f32 v217, v217, v241
  v_sub_f32 v218, v218, v241
  v_sub_f32 v219, v219, v241
  v_sub_f32 v220, v220, v241
  v_sub_f32 v221, v221, v241
  v_sub_f32 v222, v222, v241
  v_sub_f32 v223, v223, v241
  v_sub_f32 v152, v152, v241
  v_sub_f32 v153, v153, v241
  v_sub_f32 v154, v154, v241
  v_sub_f32 v155, v155, v241
  v_sub_f32 v156, v156, v241
  v_sub_f32 v157, v157, v241
  v_sub_f32 v158, v158, v241
  v_sub_f32 v159, v159, v241
  v_sub_f32 v232, v232, v241
  v_sub_f32 v233, v233, v241
  v_sub_f32 v234, v234, v241
  v_sub_f32 v235, v235, v241
  v_sub_f32 v236, v236, v241
  v_sub_f32 v237, v237, v241
  v_sub_f32 v238, v238, v241
  v_sub_f32 v239, v239, v241
  v_exp_f32 v32, v160
  v_exp_f32 v33, v161
  v_exp_f32 v34, v162
  v_cvt_pk_bf16_f32 v248, v32, v33
  v_exp_f32 v35, v163
  v_exp_f32 v32, v164
  v_cvt_pk_bf16_f32 v249, v34, v35
  v_exp_f32 v33, v165
  v_exp_f32 v34, v166
  v_cvt_pk_bf16_f32 v250, v32, v33
  v_exp_f32 v35, v167
  v_exp_f32 v32, v168
  v_cvt_pk_bf16_f32 v251, v34, v35
  v_exp_f32 v33, v169
  v_exp_f32 v34, v170
  v_cvt_pk_bf16_f32 v252, v32, v33
  v_exp_f32 v35, v171
  v_exp_f32 v32, v172
  v_cvt_pk_bf16_f32 v253, v34, v35
  v_exp_f32 v33, v173
  v_exp_f32 v34, v174
  v_cvt_pk_bf16_f32 v254, v32, v33
  v_exp_f32 v35, v175
  s_nop 0
  v_cvt_pk_bf16_f32 v255, v34, v35
  s_nop 1
  v_mfma_f32_16x16x32_bf16 v[56:59], a[224:227], v[248:251], 0
  v_mfma_f32_16x16x32_bf16 v[60:63], a[224:227], v[252:255], 0
  s_nop 9
  v_add_f32 v36, v37, v56
  v_add_f32 v38, v39, v60
  s_nop 3
  s_setpc_b64 s[6:7]
Lrare89:
  s_call_b64 s[6:7], Lrh88
  s_branch Lrr90
Lrh91:
  s_nop 15
  v_log_f32 v242, v43
  v_max3_f32 v241, v184, v185, v186
  v_max3_f32 v241, v241, v187, v188
  v_max3_f32 v241, v241, v189, v190
  v_max3_f32 v241, v241, v191, 0
  v_max_f32 v241, v241, v242
  v_mov_b32 v242, v241
  s_nop 1
  v_permlane16_swap_b32 v241, v242
  v_max_f32 v241, v241, v242
  v_mov_b32 v242, v241
  s_nop 1
  v_permlane32_swap_b32 v241, v242
  v_max_f32 v241, v241, v242
  v_exp_f32 v243, -v241
  v_sub_f32 v47, v47, v241
  v_mul_f32 v43, v43, v243
  v_accvgpr_read_b32 v244, a96
  v_accvgpr_read_b32 v245, a97
  v_accvgpr_read_b32 v246, a98
  v_accvgpr_read_b32 v247, a99
  v_mul_f32 v244, v244, v243
  v_mul_f32 v245, v245, v243
  v_mul_f32 v246, v246, v243
  v_mul_f32 v247, v247, v243
  v_accvgpr_write_b32 a96, v244
  v_accvgpr_write_b32 a97, v245
  v_accvgpr_write_b32 a98, v246
  v_accvgpr_write_b32 a99, v247
  v_accvgpr_read_b32 v244, a100
  v_accvgpr_read_b32 v245, a101
  v_accvgpr_read_b32 v246, a102
  v_accvgpr_read_b32 v247, a103
  v_mul_f32 v244, v244, v243
  v_mul_f32 v245, v245, v243
  v_mul_f32 v246, v246, v243
  v_mul_f32 v247, v247, v243
  v_accvgpr_write_b32 a100, v244
  v_accvgpr_write_b32 a101, v245
  v_accvgpr_write_b32 a102, v246
  v_accvgpr_write_b32 a103, v247
  v_accvgpr_read_b32 v244, a104
  v_accvgpr_read_b32 v245, a105
  v_accvgpr_read_b32 v246, a106
  v_accvgpr_read_b32 v247, a107
  v_mul_f32 v244, v244, v243
  v_mul_f32 v245, v245, v243
  v_mul_f32 v246, v246, v243
  v_mul_f32 v247, v247, v243
  v_accvgpr_write_b32 a104, v244
  v_accvgpr_write_b32 a105, v245
  v_accvgpr_write_b32 a106, v246
  v_accvgpr_write_b32 a107, v247
  v_accvgpr_read_b32 v244, a108
  v_accvgpr_read_b32 v245, a109
  v_accvgpr_read_b32 v246, a110
  v_accvgpr_read_b32 v247, a111
  v_mul_f32 v244, v244, v243
  v_mul_f32 v245, v245, v243
  v_mul_f32 v246, v246, v243
  v_mul_f32 v247, v247, v243
  v_accvgpr_write_b32 a108, v244
  v_accvgpr_write_b32 a109, v245
  v_accvgpr_write_b32 a110, v246
  v_accvgpr_write_b32 a111, v247
  v_accvgpr_read_b32 v244, a112
  v_accvgpr_read_b32 v245, a113
  v_accvgpr_read_b32 v246, a114
  v_accvgpr_read_b32 v247, a115
  v_mul_f32 v244, v244, v243
  v_mul_f32 v245, v245, v243
  v_mul_f32 v246, v246, v243
  v_mul_f32 v247, v247, v243
  v_accvgpr_write_b32 a112, v244
  v_accvgpr_write_b32 a113, v245
  v_accvgpr_write_b32 a114, v246
  v_accvgpr_write_b32 a115, v247
  v_accvgpr_read_b32 v244, a116
  v_accvgpr_read_b32 v245, a117
  v_accvgpr_read_b32 v246, a118
  v_accvgpr_read_b32 v247, a119
  v_mul_f32 v244, v244, v243
  v_mul_f32 v245, v245, v243
  v_mul_f32 v246, v246, v243
  v_mul_f32 v247, v247, v243
  v_accvgpr_write_b32 a116, v244
  v_accvgpr_write_b32 a117, v245
  v_accvgpr_write_b32 a118, v246
  v_accvgpr_write_b32 a119, v247
  v_accvgpr_read_b32 v244, a120
  v_accvgpr_read_b32 v245, a121
  v_accvgpr_read_b32 v246, a122
  v_accvgpr_read_b32 v247, a123
  v_mul_f32 v244, v244, v243
  v_mul_f32 v245, v245, v243
  v_mul_f32 v246, v246, v243
  v_mul_f32 v247, v247, v243
  v_accvgpr_write_b32 a120, v244
  v_accvgpr_write_b32 a121, v245
  v_accvgpr_write_b32 a122, v246
  v_accvgpr_write_b32 a123, v247
  v_accvgpr_read_b32 v244, a124
  v_accvgpr_read_b32 v245, a125
  v_accvgpr_read_b32 v246, a126
  v_accvgpr_read_b32 v247, a127
  v_mul_f32 v244, v244, v243
  v_mul_f32 v245, v245, v243
  v_mul_f32 v246, v246, v243
  v_mul_f32 v247, v247, v243
  v_accvgpr_write_b32 a124, v244
  v_accvgpr_write_b32 a125, v245
  v_accvgpr_write_b32 a126, v246
  v_accvgpr_write_b32 a127, v247
  v_sub_f32 v184, v184, v241
  v_sub_f32 v185, v185, v241
  v_sub_f32 v186, v186, v241
  v_sub_f32 v187, v187, v241
  v_sub_f32 v188, v188, v241
  v_sub_f32 v189, v189, v241
  v_sub_f32 v190, v190, v241
  v_sub_f32 v191, v191, v241
  v_exp_f32 v32, v184
  v_exp_f32 v33, v185
  v_exp_f32 v34, v186
  v_cvt_pk_bf16_f32 v204, v32, v33
  v_exp_f32 v35, v187
  v_exp_f32 v32, v188
  v_cvt_pk_bf16_f32 v205, v34, v35
  v_exp_f32 v33, v189
  v_exp_f32 v34, v190
  v_cvt_pk_bf16_f32 v206, v32, v33
  v_exp_f32 v35, v191
  s_nop 0
  v_cvt_pk_bf16_f32 v207, v34, v35
  s_nop 1
  v_mfma_f32_16x16x32_bf16 v[60:63], a[224:227], v[204:207], 0
  s_nop 9
  v_mov_b32 v40, v41
  v_add_f32 v42, v43, v60
  v_exp_f32 v32, v128
  v_exp_f32 v33, v129
  v_exp_f32 v34, v130
  v_cvt_pk_bf16_f32 v192, v32, v33
  s_nop 3
  s_setpc_b64 s[6:7]
Lrare92:
  s_call_b64 s[6:7], Lrh91
  s_branch Lrr93
Lrh94:
  s_nop 15
  v_log_f32 v242, v36
  v_max3_f32 v240, v128, v129, v130
  v_max3_f32 v240, v240, v131, v132
  v_max3_f32 v240, v240, v133, v134
  v_max3_f32 v240, v240, v135, 0
  v_max_f32 v240, v240, v242
  v_mov_b32 v242, v240
  s_nop 1
  v_permlane16_swap_b32 v240, v242
  v_max_f32 v240, v240, v242
  v_mov_b32 v242, v240
  s_nop 1
  v_permlane32_swap_b32 v240, v242
  v_max_f32 v240, v240, v242
  v_exp_f32 v243, -v240
  v_sub_f32 v44, v44, v240
  v_mul_f32 v36, v36, v243
  v_accvgpr_read_b32 v244, a0
  v_accvgpr_read_b32 v245, a1
  v_accvgpr_read_b32 v246, a2
  v_accvgpr_read_b32 v247, a3
  v_mul_f32 v244, v244, v243
  v_mul_f32 v245, v245, v243
  v_mul_f32 v246, v246, v243
  v_mul_f32 v247, v247, v243
  v_accvgpr_write_b32 a0, v244
  v_accvgpr_write_b32 a1, v245
  v_accvgpr_write_b32 a2, v246
  v_accvgpr_write_b32 a3, v247
  v_accvgpr_read_b32 v244, a4
  v_accvgpr_read_b32 v245, a5
  v_accvgpr_read_b32 v246, a6
  v_accvgpr_read_b32 v247, a7
  v_mul_f32 v244, v244, v243
  v_mul_f32 v245, v245, v243
  v_mul_f32 v246, v246, v243
  v_mul_f32 v247, v247, v243
  v_accvgpr_write_b32 a4, v244
  v_accvgpr_write_b32 a5, v245
  v_accvgpr_write_b32 a6, v246
  v_accvgpr_write_b32 a7, v247
  v_accvgpr_read_b32 v244, a8
  v_accvgpr_read_b32 v245, a9
  v_accvgpr_read_b32 v246, a10
  v_accvgpr_read_b32 v247, a11
  v_mul_f32 v244, v244, v243
  v_mul_f32 v245, v245, v243
  v_mul_f32 v246, v246, v243
  v_mul_f32 v247, v247, v243
  v_accvgpr_write_b32 a8, v244
  v_accvgpr_write_b32 a9, v245
  v_accvgpr_write_b32 a10, v246
  v_accvgpr_write_b32 a11, v247
  v_accvgpr_read_b32 v244, a12
  v_accvgpr_read_b32 v245, a13
  v_accvgpr_read_b32 v246, a14
  v_accvgpr_read_b32 v247, a15
  v_mul_f32 v244, v244, v243
  v_mul_f32 v245, v245, v243
  v_mul_f32 v246, v246, v243
  v_mul_f32 v247, v247, v243
  v_accvgpr_write_b32 a12, v244
  v_accvgpr_write_b32 a13, v245
  v_accvgpr_write_b32 a14, v246
  v_accvgpr_write_b32 a15, v247
  v_accvgpr_read_b32 v244, a16
  v_accvgpr_read_b32 v245, a17
  v_accvgpr_read_b32 v246, a18
  v_accvgpr_read_b32 v247, a19
  v_mul_f32 v244, v244, v243
  v_mul_f32 v245, v245, v243
  v_mul_f32 v246, v246, v243
  v_mul_f32 v247, v247, v243
  v_accvgpr_write_b32 a16, v244
  v_accvgpr_write_b32 a17, v245
  v_accvgpr_write_b32 a18, v246
  v_accvgpr_write_b32 a19, v247
  v_accvgpr_read_b32 v244, a20
  v_accvgpr_read_b32 v245, a21
  v_accvgpr_read_b32 v246, a22
  v_accvgpr_read_b32 v247, a23
  v_mul_f32 v244, v244, v243
  v_mul_f32 v245, v245, v243
  v_mul_f32 v246, v246, v243
  v_mul_f32 v247, v247, v243
  v_accvgpr_write_b32 a20, v244
  v_accvgpr_write_b32 a21, v245
  v_accvgpr_write_b32 a22, v246
  v_accvgpr_write_b32 a23, v247
  v_accvgpr_read_b32 v244, a24
  v_accvgpr_read_b32 v245, a25
  v_accvgpr_read_b32 v246, a26
  v_accvgpr_read_b32 v247, a27
  v_mul_f32 v244, v244, v243
  v_mul_f32 v245, v245, v243
  v_mul_f32 v246, v246, v243
  v_mul_f32 v247, v247, v243
  v_accvgpr_write_b32 a24, v244
  v_accvgpr_write_b32 a25, v245
  v_accvgpr_write_b32 a26, v246
  v_accvgpr_write_b32 a27, v247
  v_accvgpr_read_b32 v244, a28
  v_accvgpr_read_b32 v245, a29
  v_accvgpr_read_b32 v246, a30
  v_accvgpr_read_b32 v247, a31
  v_mul_f32 v244, v244, v243
  v_mul_f32 v245, v245, v243
  v_mul_f32 v246, v246, v243
  v_mul_f32 v247, v247, v243
  v_accvgpr_write_b32 a28, v244
  v_accvgpr_write_b32 a29, v245
  v_accvgpr_write_b32 a30, v246
  v_accvgpr_write_b32 a31, v247
  v_sub_f32 v128, v128, v240
  v_sub_f32 v129, v129, v240
  v_sub_f32 v130, v130, v240
  v_sub_f32 v131, v131, v240
  v_sub_f32 v132, v132, v240
  v_sub_f32 v133, v133, v240
  v_sub_f32 v134, v134, v240
  v_sub_f32 v135, v135, v240
  v_sub_f32 v160, v160, v240
  v_sub_f32 v161, v161, v240
  v_sub_f32 v162, v162, v240
  v_sub_f32 v163, v163, v240
  v_sub_f32 v164, v164, v240
  v_sub_f32 v165, v165, v240
  v_sub_f32 v166, v166, v240
  v_sub_f32 v167, v167, v240
  v_sub_f32 v208, v208, v240
  v_sub_f32 v209, v209, v240
  v_sub_f32 v210, v210, v240
  v_sub_f32 v211, v211, v240
  v_sub_f32 v212, v212, v240
  v_sub_f32 v213, v213, v240
  v_sub_f32 v214, v214, v240
  v_sub_f32 v215, v215, v240
  v_sub_f32 v144, v144, v240
  v_sub_f32 v145, v145, v240
  v_sub_f32 v146, v146, v240
  v_sub_f32 v147, v147, v240
  v_sub_f32 v148, v148, v240
  v_sub_f32 v149, v149, v240
  v_sub_f32 v150, v150, v240
  v_sub_f32 v151, v151, v240
  v_sub_f32 v176, v176, v240
  v_sub_f32 v177, v177, v240
  v_sub_f32 v178, v178, v240
  v_sub_f32 v179, v179, v240
  v_sub_f32 v180, v180, v240
  v_sub_f32 v181, v181, v240
  v_sub_f32 v182, v182, v240
  v_sub_f32 v183, v183, v240
  v_sub_f32 v224, v224, v240
  v_sub_f32 v225, v225, v240
  v_sub_f32 v226, v226, v240
  v_sub_f32 v227, v227, v240
  v_sub_f32 v228, v228, v240
  v_sub_f32 v229, v229, v240
  v_sub_f32 v230, v230, v240
  v_sub_f32 v231, v231, v240
  v_log_f32 v242, v38
  v_max3_f32 v241, v136, v137, v138
  v_max3_f32 v241, v241, v139, v140
  v_max3_f32 v241, v241, v141, v142
  v_max3_f32 v241, v241, v143, 0
  v_max_f32 v241, v241, v242
  v_mov_b32 v242, v241
  s_nop 1
  v_permlane16_swap_b32 v241, v242
  v_max_f32 v241, v241, v242
  v_mov_b32 v242, v241
  s_nop 1
  v_permlane32_swap_b32 v241, v242
  v_max_f32 v241, v241, v242
  v_exp_f32 v243, -v241
  v_sub_f32 v45, v45, v241
  v_mul_f32 v38, v38, v243
  v_accvgpr_read_b32 v244, a32
  v_accvgpr_read_b32 v245, a33
  v_accvgpr_read_b32 v246, a34
  v_accvgpr_read_b32 v247, a35
  v_mul_f32 v244, v244, v243
  v_mul_f32 v245, v245, v243
  v_mul_f32 v246, v246, v243
  v_mul_f32 v247, v247, v243
  v_accvgpr_write_b32 a32, v244
  v_accvgpr_write_b32 a33, v245
  v_accvgpr_write_b32 a34, v246
  v_accvgpr_write_b32 a35, v247
  v_accvgpr_read_b32 v244, a36
  v_accvgpr_read_b32 v245, a37
  v_accvgpr_read_b32 v246, a38
  v_accvgpr_read_b32 v247, a39
  v_mul_f32 v244, v244, v243
  v_mul_f32 v245, v245, v243
  v_mul_f32 v246, v246, v243
  v_mul_f32 v247, v247, v243
  v_accvgpr_write_b32 a36, v244
  v_accvgpr_write_b32 a37, v245
  v_accvgpr_write_b32 a38, v246
  v_accvgpr_write_b32 a39, v247
  v_accvgpr_read_b32 v244, a40
  v_accvgpr_read_b32 v245, a41
  v_accvgpr_read_b32 v246, a42
  v_accvgpr_read_b32 v247, a43
  v_mul_f32 v244, v244, v243
  v_mul_f32 v245, v245, v243
  v_mul_f32 v246, v246, v243
  v_mul_f32 v247, v247, v243
  v_accvgpr_write_b32 a40, v244
  v_accvgpr_write_b32 a41, v245
  v_accvgpr_write_b32 a42, v246
  v_accvgpr_write_b32 a43, v247
  v_accvgpr_read_b32 v244, a44
  v_accvgpr_read_b32 v245, a45
  v_accvgpr_read_b32 v246, a46
  v_accvgpr_read_b32 v247, a47
  v_mul_f32 v244, v244, v243
  v_mul_f32 v245, v245, v243
  v_mul_f32 v246, v246, v243
  v_mul_f32 v247, v247, v243
  v_accvgpr_write_b32 a44, v244
  v_accvgpr_write_b32 a45, v245
  v_accvgpr_write_b32 a46, v246
  v_accvgpr_write_b32 a47, v247
  v_accvgpr_read_b32 v244, a48
  v_accvgpr_read_b32 v245, a49
  v_accvgpr_read_b32 v246, a50
  v_accvgpr_read_b32 v247, a51
  v_mul_f32 v244, v244, v243
  v_mul_f32 v245, v245, v243
  v_mul_f32 v246, v246, v243
  v_mul_f32 v247, v247, v243
  v_accvgpr_write_b32 a48, v244
  v_accvgpr_write_b32 a49, v245
  v_accvgpr_write_b32 a50, v246
  v_accvgpr_write_b32 a51, v247
  v_accvgpr_read_b32 v244, a52
  v_accvgpr_read_b32 v245, a53
  v_accvgpr_read_b32 v246, a54
  v_accvgpr_read_b32 v247, a55
  v_mul_f32 v244, v244, v243
  v_mul_f32 v245, v245, v243
  v_mul_f32 v246, v246, v243
  v_mul_f32 v247, v247, v243
  v_accvgpr_write_b32 a52, v244
  v_accvgpr_write_b32 a53, v245
  v_accvgpr_write_b32 a54, v246
  v_accvgpr_write_b32 a55, v247
  v_accvgpr_read_b32 v244, a56
  v_accvgpr_read_b32 v245, a57
  v_accvgpr_read_b32 v246, a58
  v_accvgpr_read_b32 v247, a59
  v_mul_f32 v244, v244, v243
  v_mul_f32 v245, v245, v243
  v_mul_f32 v246, v246, v243
  v_mul_f32 v247, v247, v243
  v_accvgpr_write_b32 a56, v244
  v_accvgpr_write_b32 a57, v245
  v_accvgpr_write_b32 a58, v246
  v_accvgpr_write_b32 a59, v247
  v_accvgpr_read_b32 v244, a60
  v_accvgpr_read_b32 v245, a61
  v_accvgpr_read_b32 v246, a62
  v_accvgpr_read_b32 v247, a63
  v_mul_f32 v244, v244, v243
  v_mul_f32 v245, v245, v243
  v_mul_f32 v246, v246, v243
  v_mul_f32 v247, v247, v243
  v_accvgpr_write_b32 a60, v244
  v_accvgpr_write_b32 a61, v245
  v_accvgpr_write_b32 a62, v246
  v_accvgpr_write_b32 a63, v247
  v_sub_f32 v136, v136, v241
  v_sub_f32 v137, v137, v241
  v_sub_f32 v138, v138, v241
  v_sub_f32 v139, v139, v241
  v_sub_f32 v140, v140, v241
  v_sub_f32 v141, v141, v241
  v_sub_f32 v142, v142, v241
  v_sub_f32 v143, v143, v241
  v_sub_f32 v168, v168, v241
  v_sub_f32 v169, v169, v241
  v_sub_f32 v170, v170, v241
  v_sub_f32 v171, v171, v241
  v_sub_f32 v172, v172, v241
  v_sub_f32 v173, v173, v241
  v_sub_f32 v174, v174, v241
  v_sub_f32 v175, v175, v241
  v_sub_f32 v216, v216, v241
  v_sub_f32 v217, v217, v241
  v_sub_f32 v218, v218, v241
  v_sub_f32 v219, v219, v241
  v_sub_f32 v220, v220, v241
  v_sub_f32 v221, v221, v241
  v_sub_f32 v222, v222, v241
  v_sub_f32 v223, v223, v241
  v_sub_f32 v152, v152, v241
  v_sub_f32 v153, v153, v241
  v_sub_f32 v154, v154, v241
  v_sub_f32 v155, v155, v241
  v_sub_f32 v156, v156, v241
  v_sub_f32 v157, v157, v241
  v_sub_f32 v158, v158, v241
  v_sub_f32 v159, v159, v241
  v_sub_f32 v184, v184, v241
  v_sub_f32 v185, v185, v241
  v_sub_f32 v186, v186, v241
  v_sub_f32 v187, v187, v241
  v_sub_f32 v188, v188, v241
  v_sub_f32 v189, v189, v241
  v_sub_f32 v190, v190, v241
  v_sub_f32 v191, v191, v241
  v_sub_f32 v232, v232, v241
  v_sub_f32 v233, v233, v241
  v_sub_f32 v234, v234, v241
  v_sub_f32 v235, v235, v241
  v_sub_f32 v236, v236, v241
  v_sub_f32 v237, v237, v241
  v_sub_f32 v238, v238, v241
  v_sub_f32 v239, v239, v241
  v_exp_f32 v32, v128
  v_exp_f32 v33, v129
  v_exp_f32 v34, v130
  v_cvt_pk_bf16_f32 v192, v32, v33
  v_exp_f32 v35, v131
  v_exp_f32 v32, v132
  v_cvt_pk_bf16_f32 v193, v34, v35
  v_exp_f32 v33, v133
  v_exp_f32 v34, v134
  v_cvt_pk_bf16_f32 v194, v32, v33
  v_exp_f32 v35, v135
  v_exp_f32 v32, v136
  v_cvt_pk_bf16_f32 v195, v34, v35
  v_exp_f32 v33, v137
  v_exp_f32 v34, v138
  v_cvt_pk_bf16_f32 v196, v32, v33
  v_exp_f32 v35, v139
  v_exp_f32 v32, v140
  v_cvt_pk_bf16_f32 v197, v34, v35
  v_exp_f32 v33, v141
  v_exp_f32 v34, v142
  v_cvt_pk_bf16_f32 v198, v32, v33
  v_exp_f32 v35, v143
  s_nop 0
  v_cvt_pk_bf16_f32 v199, v34, v35
  s_nop 1
  v_mfma_f32_16x16x32_bf16 v[56:59], a[224:227], v[192:195], 0
  v_mfma_f32_16x16x32_bf16 v[60:63], a[224:227], v[196:199], 0
  s_nop 9
  v_add_f32 v37, v36, v56
  v_add_f32 v39, v38, v60
  v_exp_f32 v32, v144
  v_exp_f32 v33, v145
  v_exp_f32 v34, v146
  v_cvt_pk_bf16_f32 v200, v32, v33
  s_nop 3
  s_setpc_b64 s[6:7]
Lrare95:
  s_call_b64 s[6:7], Lrh94
  s_branch Lrr96
Lrh97:
  s_nop 15
  v_log_f32 v242, v37
  v_max3_f32 v240, v144, v145, v146
  v_max3_f32 v240, v240, v147, v148
  v_max3_f32 v240, v240, v149, v150
  v_max3_f32 v240, v240, v151, 0
  v_max_f32 v240, v240, v242
  v_mov_b32 v242, v240
  s_nop 1
  v_permlane16_swap_b32 v240, v242
  v_max_f32 v240, v240, v242
  v_mov_b32 v242, v240
  s_nop 1
  v_permlane32_swap_b32 v240, v242
  v_max_f32 v240, v240, v242
  v_exp_f32 v243, -v240
  v_sub_f32 v44, v44, v240
  v_mul_f32 v37, v37, v243
  v_accvgpr_read_b32 v244, a0
  v_accvgpr_read_b32 v245, a1
  v_accvgpr_read_b32 v246, a2
  v_accvgpr_read_b32 v247, a3
  v_mul_f32 v244, v244, v243
  v_mul_f32 v245, v245, v243
  v_mul_f32 v246, v246, v243
  v_mul_f32 v247, v247, v243
  v_accvgpr_write_b32 a0, v244
  v_accvgpr_write_b32 a1, v245
  v_accvgpr_write_b32 a2, v246
  v_accvgpr_write_b32 a3, v247
  v_accvgpr_read_b32 v244, a4
  v_accvgpr_read_b32 v245, a5
  v_accvgpr_read_b32 v246, a6
  v_accvgpr_read_b32 v247, a7
  v_mul_f32 v244, v244, v243
  v_mul_f32 v245, v245, v243
  v_mul_f32 v246, v246, v243
  v_mul_f32 v247, v247, v243
  v_accvgpr_write_b32 a4, v244
  v_accvgpr_write_b32 a5, v245
  v_accvgpr_write_b32 a6, v246
  v_accvgpr_write_b32 a7, v247
  v_accvgpr_read_b32 v244, a8
  v_accvgpr_read_b32 v245, a9
  v_accvgpr_read_b32 v246, a10
  v_accvgpr_read_b32 v247, a11
  v_mul_f32 v244, v244, v243
  v_mul_f32 v245, v245, v243
  v_mul_f32 v246, v246, v243
  v_mul_f32 v247, v247, v243
  v_accvgpr_write_b32 a8, v244
  v_accvgpr_write_b32 a9, v245
  v_accvgpr_write_b32 a10, v246
  v_accvgpr_write_b32 a11, v247
  v_accvgpr_read_b32 v244, a12
  v_accvgpr_read_b32 v245, a13
  v_accvgpr_read_b32 v246, a14
  v_accvgpr_read_b32 v247, a15
  v_mul_f32 v244, v244, v243
  v_mul_f32 v245, v245, v243
  v_mul_f32 v246, v246, v243
  v_mul_f32 v247, v247, v243
  v_accvgpr_write_b32 a12, v244
  v_accvgpr_write_b32 a13, v245
  v_accvgpr_write_b32 a14, v246
  v_accvgpr_write_b32 a15, v247
  v_accvgpr_read_b32 v244, a16
  v_accvgpr_read_b32 v245, a17
  v_accvgpr_read_b32 v246, a18
  v_accvgpr_read_b32 v247, a19
  v_mul_f32 v244, v244, v243
  v_mul_f32 v245, v245, v243
  v_mul_f32 v246, v246, v243
  v_mul_f32 v247, v247, v243
  v_accvgpr_write_b32 a16, v244
  v_accvgpr_write_b32 a17, v245
  v_accvgpr_write_b32 a18, v246
  v_accvgpr_write_b32 a19, v247
  v_accvgpr_read_b32 v244, a20
  v_accvgpr_read_b32 v245, a21
  v_accvgpr_read_b32 v246, a22
  v_accvgpr_read_b32 v247, a23
  v_mul_f32 v244, v244, v243
  v_mul_f32 v245, v245, v243
  v_mul_f32 v246, v246, v243
  v_mul_f32 v247, v247, v243
  v_accvgpr_write_b32 a20, v244
  v_accvgpr_write_b32 a21, v245
  v_accvgpr_write_b32 a22, v246
  v_accvgpr_write_b32 a23, v247
  v_accvgpr_read_b32 v244, a24
  v_accvgpr_read_b32 v245, a25
  v_accvgpr_read_b32 v246, a26
  v_accvgpr_read_b32 v247, a27
  v_mul_f32 v244, v244, v243
  v_mul_f32 v245, v245, v243
  v_mul_f32 v246, v246, v243
  v_mul_f32 v247, v247, v243
  v_accvgpr_write_b32 a24, v244
  v_accvgpr_write_b32 a25, v245
  v_accvgpr_write_b32 a26, v246
  v_accvgpr_write_b32 a27, v247
  v_accvgpr_read_b32 v244, a28
  v_accvgpr_read_b32 v245, a29
  v_accvgpr_read_b32 v246, a30
  v_accvgpr_read_b32 v247, a31
  v_mul_f32 v244, v244, v243
  v_mul_f32 v245, v245, v243
  v_mul_f32 v246, v246, v243
  v_mul_f32 v247, v247, v243
  v_accvgpr_write_b32 a28, v244
  v_accvgpr_write_b32 a29, v245
  v_accvgpr_write_b32 a30, v246
  v_accvgpr_write_b32 a31, v247
  v_sub_f32 v128, v128, v240
  v_sub_f32 v129, v129, v240
  v_sub_f32 v130, v130, v240
  v_sub_f32 v131, v131, v240
  v_sub_f32 v132, v132, v240
  v_sub_f32 v133, v133, v240
  v_sub_f32 v134, v134, v240
  v_sub_f32 v135, v135, v240
  v_sub_f32 v160, v160, v240
  v_sub_f32 v161, v161, v240
  v_sub_f32 v162, v162, v240
  v_sub_f32 v163, v163, v240
  v_sub_f32 v164, v164, v240
  v_sub_f32 v165, v165, v240
  v_sub_f32 v166, v166, v240
  v_sub_f32 v167, v167, v240
  v_sub_f32 v208, v208, v240
  v_sub_f32 v209, v209, v240
  v_sub_f32 v210, v210, v240
  v_sub_f32 v211, v211, v240
  v_sub_f32 v212, v212, v240
  v_sub_f32 v213, v213, v240
  v_sub_f32 v214, v214, v240
  v_sub_f32 v215, v215, v240
  v_sub_f32 v144, v144, v240
  v_sub_f32 v145, v145, v240
  v_sub_f32 v146, v146, v240
  v_sub_f32 v147, v147, v240
  v_sub_f32 v148, v148, v240
  v_sub_f32 v149, v149, v240
  v_sub_f32 v150, v150, v240
  v_sub_f32 v151, v151, v240
  v_sub_f32 v176, v176, v240
  v_sub_f32 v177, v177, v240
  v_sub_f32 v178, v178, v240
  v_sub_f32 v179, v179, v240
  v_sub_f32 v180, v180, v240
  v_sub_f32 v181, v181, v240
  v_sub_f32 v182, v182, v240
  v_sub_f32 v183, v183, v240
  v_sub_f32 v224, v224, v240
  v_sub_f32 v225, v225, v240
  v_sub_f32 v226, v226, v240
  v_sub_f32 v227, v227, v240
  v_sub_f32 v228, v228, v240
  v_sub_f32 v229, v229, v240
  v_sub_f32 v230, v230, v240
  v_sub_f32 v231, v231, v240
  v_log_f32 v242, v39
  v_max3_f32 v241, v152, v153, v154
  v_max3_f32 v241, v241, v155, v156
  v_max3_f32 v241, v241, v157, v158
  v_max3_f32 v241, v241, v159, 0
  v_max_f32 v241, v241, v242
  v_mov_b32 v242, v241
  s_nop 1
  v_permlane16_swap_b32 v241, v242
  v_max_f32 v241, v241, v242
  v_mov_b32 v242, v241
  s_nop 1
  v_permlane32_swap_b32 v241, v242
  v_max_f32 v241, v241, v242
  v_exp_f32 v243, -v241
  v_sub_f32 v45, v45, v241
  v_mul_f32 v39, v39, v243
  v_accvgpr_read_b32 v244, a32
  v_accvgpr_read_b32 v245, a33
  v_accvgpr_read_b32 v246, a34
  v_accvgpr_read_b32 v247, a35
  v_mul_f32 v244, v244, v243
  v_mul_f32 v245, v245, v243
  v_mul_f32 v246, v246, v243
  v_mul_f32 v247, v247, v243
  v_accvgpr_write_b32 a32, v244
  v_accvgpr_write_b32 a33, v245
  v_accvgpr_write_b32 a34, v246
  v_accvgpr_write_b32 a35, v247
  v_accvgpr_read_b32 v244, a36
  v_accvgpr_read_b32 v245, a37
  v_accvgpr_read_b32 v246, a38
  v_accvgpr_read_b32 v247, a39
  v_mul_f32 v244, v244, v243
  v_mul_f32 v245, v245, v243
  v_mul_f32 v246, v246, v243
  v_mul_f32 v247, v247, v243
  v_accvgpr_write_b32 a36, v244
  v_accvgpr_write_b32 a37, v245
  v_accvgpr_write_b32 a38, v246
  v_accvgpr_write_b32 a39, v247
  v_accvgpr_read_b32 v244, a40
  v_accvgpr_read_b32 v245, a41
  v_accvgpr_read_b32 v246, a42
  v_accvgpr_read_b32 v247, a43
  v_mul_f32 v244, v244, v243
  v_mul_f32 v245, v245, v243
  v_mul_f32 v246, v246, v243
  v_mul_f32 v247, v247, v243
  v_accvgpr_write_b32 a40, v244
  v_accvgpr_write_b32 a41, v245
  v_accvgpr_write_b32 a42, v246
  v_accvgpr_write_b32 a43, v247
  v_accvgpr_read_b32 v244, a44
  v_accvgpr_read_b32 v245, a45
  v_accvgpr_read_b32 v246, a46
  v_accvgpr_read_b32 v247, a47
  v_mul_f32 v244, v244, v243
  v_mul_f32 v245, v245, v243
  v_mul_f32 v246, v246, v243
  v_mul_f32 v247, v247, v243
  v_accvgpr_write_b32 a44, v244
  v_accvgpr_write_b32 a45, v245
  v_accvgpr_write_b32 a46, v246
  v_accvgpr_write_b32 a47, v247
  v_accvgpr_read_b32 v244, a48
  v_accvgpr_read_b32 v245, a49
  v_accvgpr_read_b32 v246, a50
  v_accvgpr_read_b32 v247, a51
  v_mul_f32 v244, v244, v243
  v_mul_f32 v245, v245, v243
  v_mul_f32 v246, v246, v243
  v_mul_f32 v247, v247, v243
  v_accvgpr_write_b32 a48, v244
  v_accvgpr_write_b32 a49, v245
  v_accvgpr_write_b32 a50, v246
  v_accvgpr_write_b32 a51, v247
  v_accvgpr_read_b32 v244, a52
  v_accvgpr_read_b32 v245, a53
  v_accvgpr_read_b32 v246, a54
  v_accvgpr_read_b32 v247, a55
  v_mul_f32 v244, v244, v243
  v_mul_f32 v245, v245, v243
  v_mul_f32 v246, v246, v243
  v_mul_f32 v247, v247, v243
  v_accvgpr_write_b32 a52, v244
  v_accvgpr_write_b32 a53, v245
  v_accvgpr_write_b32 a54, v246
  v_accvgpr_write_b32 a55, v247
  v_accvgpr_read_b32 v244, a56
  v_accvgpr_read_b32 v245, a57
  v_accvgpr_read_b32 v246, a58
  v_accvgpr_read_b32 v247, a59
  v_mul_f32 v244, v244, v243
  v_mul_f32 v245, v245, v243
  v_mul_f32 v246, v246, v243
  v_mul_f32 v247, v247, v243
  v_accvgpr_write_b32 a56, v244
  v_accvgpr_write_b32 a57, v245
  v_accvgpr_write_b32 a58, v246
  v_accvgpr_write_b32 a59, v247
  v_accvgpr_read_b32 v244, a60
  v_accvgpr_read_b32 v245, a61
  v_accvgpr_read_b32 v246, a62
  v_accvgpr_read_b32 v247, a63
  v_mul_f32 v244, v244, v243
  v_mul_f32 v245, v245, v243
  v_mul_f32 v246, v246, v243
  v_mul_f32 v247, v247, v243
  v_accvgpr_write_b32 a60, v244
  v_accvgpr_write_b32 a61, v245
  v_accvgpr_write_b32 a62, v246
  v_accvgpr_write_b32 a63, v247
  v_sub_f32 v136, v136, v241
  v_sub_f32 v137, v137, v241
  v_sub_f32 v138, v138, v241
  v_sub_f32 v139, v139, v241
  v_sub_f32 v140, v140, v241
  v_sub_f32 v141, v141, v241
  v_sub_f32 v142, v142, v241
  v_sub_f32 v143, v143, v241
  v_sub_f32 v168, v168, v241
  v_sub_f32 v169, v169, v241
  v_sub_f32 v170, v170, v241
  v_sub_f32 v171, v171, v241
  v_sub_f32 v172, v172, v241
  v_sub_f32 v173, v173, v241
  v_sub_f32 v174, v174, v241
  v_sub_f32 v175, v175, v241
  v_sub_f32 v216, v216, v241
  v_sub_f32 v217, v217, v241
  v_sub_f32 v218, v218, v241
  v_sub_f32 v219, v219, v241
  v_sub_f32 v220, v220, v241
  v_sub_f32 v221, v221, v241
  v_sub_f32 v222, v222, v241
  v_sub_f32 v223, v223, v241
  v_sub_f32 v152, v152, v241
  v_sub_f32 v153, v153, v241
  v_sub_f32 v154, v154, v241
  v_sub_f32 v155, v155, v241
  v_sub_f32 v156, v156, v241
  v_sub_f32 v157, v157, v241
  v_sub_f32 v158, v158, v241
  v_sub_f32 v159, v159, v241
  v_sub_f32 v184, v184, v241
  v_sub_f32 v185, v185, v241
  v_sub_f32 v186, v186, v241
  v_sub_f32 v187, v187, v241
  v_sub_f32 v188, v188, v241
  v_sub_f32 v189, v189, v241
  v_sub_f32 v190, v190, v241
  v_sub_f32 v191, v191, v241
  v_sub_f32 v232, v232, v241
  v_sub_f32 v233, v233, v241
  v_sub_f32 v234, v234, v241
  v_sub_f32 v235, v235, v241
  v_sub_f32 v236, v236, v241
  v_sub_f32 v237, v237, v241
  v_sub_f32 v238, v238, v241
  v_sub_f32 v239, v239, v241
  v_exp_f32 v32, v144
  v_exp_f32 v33, v145
  v_exp_f32 v34, v146
  v_cvt_pk_bf16_f32 v200, v32, v33
  v_exp_f32 v35, v147
  v_exp_f32 v32, v148
  v_cvt_pk_bf16_f32 v201, v34, v35
  v_exp_f32 v33, v149
  v_exp_f32 v34, v150
  v_cvt_pk_bf16_f32 v202, v32, v33
  v_exp_f32 v35, v151
  v_exp_f32 v32, v152
  v_cvt_pk_bf16_f32 v203, v34, v35
  v_exp_f32 v33, v153
  v_exp_f32 v34, v154
  v_cvt_pk_bf16_f32 v204, v32, v33
  v_exp_f32 v35, v155
  v_exp_f32 v32, v156
  v_cvt_pk_bf16_f32 v205, v34, v35
  v_exp_f32 v33, v157
  v_exp_f32 v34, v158
  v_cvt_pk_bf16_f32 v206, v32, v33
  v_exp_f32 v35, v159
  s_nop 0
  v_cvt_pk_bf16_f32 v207, v34, v35
  s_nop 1
  v_mfma_f32_16x16x32_bf16 v[56:59], a[224:227], v[200:203], 0
  v_mfma_f32_16x16x32_bf16 v[60:63], a[224:227], v[204:207], 0
  s_nop 9
  v_add_f32 v36, v37, v56
  v_add_f32 v38, v39, v60
  s_nop 3
  s_setpc_b64 s[6:7]
Lrare98:
  s_call_b64 s[6:7], Lrh97
  s_branch Lrr99
Lrare100:
  s_call_b64 s[6:7], Lrh88
  s_branch Lrr101
Lrare102:
  s_call_b64 s[6:7], Lrh91
  s_branch Lrr103
Lrare104:
  s_call_b64 s[6:7], Lrh94
  s_branch Lrr105
Lrh106:
  s_nop 15
  v_log_f32 v242, v37
  v_max3_f32 v240, v144, v145, v146
  v_max3_f32 v240, v240, v147, v148
  v_max3_f32 v240, v240, v149, v150
  v_max3_f32 v240, v240, v151, 0
  v_max_f32 v240, v240, v242
  v_mov_b32 v242, v240
  s_nop 1
  v_permlane16_swap_b32 v240, v242
  v_max_f32 v240, v240, v242
  v_mov_b32 v242, v240
  s_nop 1
  v_permlane32_swap_b32 v240, v242
  v_max_f32 v240, v240, v242
  v_exp_f32 v243, -v240
  v_sub_f32 v44, v44, v240
  v_mul_f32 v37, v37, v243
  v_accvgpr_read_b32 v244, a0
  v_accvgpr_read_b32 v245, a1
  v_accvgpr_read_b32 v246, a2
  v_accvgpr_read_b32 v247, a3
  v_mul_f32 v244, v244, v243
  v_mul_f32 v245, v245, v243
  v_mul_f32 v246, v246, v243
  v_mul_f32 v247, v247, v243
  v_accvgpr_write_b32 a0, v244
  v_accvgpr_write_b32 a1, v245
  v_accvgpr_write_b32 a2, v246
  v_accvgpr_write_b32 a3, v247
  v_accvgpr_read_b32 v244, a4
  v_accvgpr_read_b32 v245, a5
  v_accvgpr_read_b32 v246, a6
  v_accvgpr_read_b32 v247, a7
  v_mul_f32 v244, v244, v243
  v_mul_f32 v245, v245, v243
  v_mul_f32 v246, v246, v243
  v_mul_f32 v247, v247, v243
  v_accvgpr_write_b32 a4, v244
  v_accvgpr_write_b32 a5, v245
  v_accvgpr_write_b32 a6, v246
  v_accvgpr_write_b32 a7, v247
  v_accvgpr_read_b32 v244, a8
  v_accvgpr_read_b32 v245, a9
  v_accvgpr_read_b32 v246, a10
  v_accvgpr_read_b32 v247, a11
  v_mul_f32 v244, v244, v243
  v_mul_f32 v245, v245, v243
  v_mul_f32 v246, v246, v243
  v_mul_f32 v247, v247, v243
  v_accvgpr_write_b32 a8, v244
  v_accvgpr_write_b32 a9, v245
  v_accvgpr_write_b32 a10, v246
  v_accvgpr_write_b32 a11, v247
  v_accvgpr_read_b32 v244, a12
  v_accvgpr_read_b32 v245, a13
  v_accvgpr_read_b32 v246, a14
  v_accvgpr_read_b32 v247, a15
  v_mul_f32 v244, v244, v243
  v_mul_f32 v245, v245, v243
  v_mul_f32 v246, v246, v243
  v_mul_f32 v247, v247, v243
  v_accvgpr_write_b32 a12, v244
  v_accvgpr_write_b32 a13, v245
  v_accvgpr_write_b32 a14, v246
  v_accvgpr_write_b32 a15, v247
  v_accvgpr_read_b32 v244, a16
  v_accvgpr_read_b32 v245, a17
  v_accvgpr_read_b32 v246, a18
  v_accvgpr_read_b32 v247, a19
  v_mul_f32 v244, v244, v243
  v_mul_f32 v245, v245, v243
  v_mul_f32 v246, v246, v243
  v_mul_f32 v247, v247, v243
  v_accvgpr_write_b32 a16, v244
  v_accvgpr_write_b32 a17, v245
  v_accvgpr_write_b32 a18, v246
  v_accvgpr_write_b32 a19, v247
  v_accvgpr_read_b32 v244, a20
  v_accvgpr_read_b32 v245, a21
  v_accvgpr_read_b32 v246, a22
  v_accvgpr_read_b32 v247, a23
  v_mul_f32 v244, v244, v243
  v_mul_f32 v245, v245, v243
  v_mul_f32 v246, v246, v243
  v_mul_f32 v247, v247, v243
  v_accvgpr_write_b32 a20, v244
  v_accvgpr_write_b32 a21, v245
  v_accvgpr_write_b32 a22, v246
  v_accvgpr_write_b32 a23, v247
  v_accvgpr_read_b32 v244, a24
  v_accvgpr_read_b32 v245, a25
  v_accvgpr_read_b32 v246, a26
  v_accvgpr_read_b32 v247, a27
  v_mul_f32 v244, v244, v243
  v_mul_f32 v245, v245, v243
  v_mul_f32 v246, v246, v243
  v_mul_f32 v247, v247, v243
  v_accvgpr_write_b32 a24, v244
  v_accvgpr_write_b32 a25, v245
  v_accvgpr_write_b32 a26, v246
  v_accvgpr_write_b32 a27, v247
  v_accvgpr_read_b32 v244, a28
  v_accvgpr_read_b32 v245, a29
  v_accvgpr_read_b32 v246, a30
  v_accvgpr_read_b32 v247, a31
  v_mul_f32 v244, v244, v243
  v_mul_f32 v245, v245, v243
  v_mul_f32 v246, v246, v243
  v_mul_f32 v247, v247, v243
  v_accvgpr_write_b32 a28, v244
  v_accvgpr_write_b32 a29, v245
  v_accvgpr_write_b32 a30, v246
  v_accvgpr_write_b32 a31, v247
  v_sub_f32 v128, v128, v240
  v_sub_f32 v129, v129, v240
  v_sub_f32 v130, v130, v240
  v_sub_f32 v131, v131, v240
  v_sub_f32 v132, v132, v240
  v_sub_f32 v133, v133, v240
  v_sub_f32 v134, v134, v240
  v_sub_f32 v135, v135, v240
  v_sub_f32 v160, v160, v240
  v_sub_f32 v161, v161, v240
  v_sub_f32 v162, v162, v240
  v_sub_f32 v163, v163, v240
  v_sub_f32 v164, v164, v240
  v_sub_f32 v165, v165, v240
  v_sub_f32 v166, v166, v240
  v_sub_f32 v167, v167, v240
  v_sub_f32 v208, v208, v240
  v_sub_f32 v209, v209, v240
  v_sub_f32 v210, v210, v240
  v_sub_f32 v211, v211, v240
  v_sub_f32 v212, v212, v240
  v_sub_f32 v213, v213, v240
  v_sub_f32 v214, v214, v240
  v_sub_f32 v215, v215, v240
  v_sub_f32 v144, v144, v240
  v_sub_f32 v145, v145, v240
  v_sub_f32 v146, v146, v240
  v_sub_f32 v147, v147, v240
  v_sub_f32 v148, v148, v240
  v_sub_f32 v149, v149, v240
  v_sub_f32 v150, v150, v240
  v_sub_f32 v151, v151, v240
  v_sub_f32 v176, v176, v240
  v_sub_f32 v177, v177, v240
  v_sub_f32 v178, v178, v240
  v_sub_f32 v179, v179, v240
  v_sub_f32 v180, v180, v240
  v_sub_f32 v181, v181, v240
  v_sub_f32 v182, v182, v240
  v_sub_f32 v183, v183, v240
  v_sub_f32 v224, v224, v240
  v_sub_f32 v225, v225, v240
  v_sub_f32 v226, v226, v240
  v_sub_f32 v227, v227, v240
  v_sub_f32 v228, v228, v240
  v_sub_f32 v229, v229, v240
  v_sub_f32 v230, v230, v240
  v_sub_f32 v231, v231, v240
  v_log_f32 v242, v39
  v_max3_f32 v241, v152, v153, v154
  v_max3_f32 v241, v241, v155, v156
  v_max3_f32 v241, v241, v157, v158
  v_max3_f32 v241, v241, v159, 0
  v_max_f32 v241, v241, v242
  v_mov_b32 v242, v241
  s_nop 1
  v_permlane16_swap_b32 v241, v242
  v_max_f32 v241, v241, v242
  v_mov_b32 v242, v241
  s_nop 1
  v_permlane32_swap_b32 v241, v242
  v_max_f32 v241, v241, v242
  v_exp_f32 v243, -v241
  v_sub_f32 v45, v45, v241
  v_mul_f32 v39, v39, v243
  v_accvgpr_read_b32 v244, a32
  v_accvgpr_read_b32 v245, a33
  v_accvgpr_read_b32 v246, a34
  v_accvgpr_read_b32 v247, a35
  v_mul_f32 v244, v244, v243
  v_mul_f32 v245, v245, v243
  v_mul_f32 v246, v246, v243
  v_mul_f32 v247, v247, v243
  v_accvgpr_write_b32 a32, v244
  v_accvgpr_write_b32 a33, v245
  v_accvgpr_write_b32 a34, v246
  v_accvgpr_write_b32 a35, v247
  v_accvgpr_read_b32 v244, a36
  v_accvgpr_read_b32 v245, a37
  v_accvgpr_read_b32 v246, a38
  v_accvgpr_read_b32 v247, a39
  v_mul_f32 v244, v244, v243
  v_mul_f32 v245, v245, v243
  v_mul_f32 v246, v246, v243
  v_mul_f32 v247, v247, v243
  v_accvgpr_write_b32 a36, v244
  v_accvgpr_write_b32 a37, v245
  v_accvgpr_write_b32 a38, v246
  v_accvgpr_write_b32 a39, v247
  v_accvgpr_read_b32 v244, a40
  v_accvgpr_read_b32 v245, a41
  v_accvgpr_read_b32 v246, a42
  v_accvgpr_read_b32 v247, a43
  v_mul_f32 v244, v244, v243
  v_mul_f32 v245, v245, v243
  v_mul_f32 v246, v246, v243
  v_mul_f32 v247, v247, v243
  v_accvgpr_write_b32 a40, v244
  v_accvgpr_write_b32 a41, v245
  v_accvgpr_write_b32 a42, v246
  v_accvgpr_write_b32 a43, v247
  v_accvgpr_read_b32 v244, a44
  v_accvgpr_read_b32 v245, a45
  v_accvgpr_read_b32 v246, a46
  v_accvgpr_read_b32 v247, a47
  v_mul_f32 v244, v244, v243
  v_mul_f32 v245, v245, v243
  v_mul_f32 v246, v246, v243
  v_mul_f32 v247, v247, v243
  v_accvgpr_write_b32 a44, v244
  v_accvgpr_write_b32 a45, v245
  v_accvgpr_write_b32 a46, v246
  v_accvgpr_write_b32 a47, v247
  v_accvgpr_read_b32 v244, a48
  v_accvgpr_read_b32 v245, a49
  v_accvgpr_read_b32 v246, a50
  v_accvgpr_read_b32 v247, a51
  v_mul_f32 v244, v244, v243
  v_mul_f32 v245, v245, v243
  v_mul_f32 v246, v246, v243
  v_mul_f32 v247, v247, v243
  v_accvgpr_write_b32 a48, v244
  v_accvgpr_write_b32 a49, v245
  v_accvgpr_write_b32 a50, v246
  v_accvgpr_write_b32 a51, v247
  v_accvgpr_read_b32 v244, a52
  v_accvgpr_read_b32 v245, a53
  v_accvgpr_read_b32 v246, a54
  v_accvgpr_read_b32 v247, a55
  v_mul_f32 v244, v244, v243
  v_mul_f32 v245, v245, v243
  v_mul_f32 v246, v246, v243
  v_mul_f32 v247, v247, v243
  v_accvgpr_write_b32 a52, v244
  v_accvgpr_write_b32 a53, v245
  v_accvgpr_write_b32 a54, v246
  v_accvgpr_write_b32 a55, v247
  v_accvgpr_read_b32 v244, a56
  v_accvgpr_read_b32 v245, a57
  v_accvgpr_read_b32 v246, a58
  v_accvgpr_read_b32 v247, a59
  v_mul_f32 v244, v244, v243
  v_mul_f32 v245, v245, v243
  v_mul_f32 v246, v246, v243
  v_mul_f32 v247, v247, v243
  v_accvgpr_write_b32 a56, v244
  v_accvgpr_write_b32 a57, v245
  v_accvgpr_write_b32 a58, v246
  v_accvgpr_write_b32 a59, v247
  v_accvgpr_read_b32 v244, a60
  v_accvgpr_read_b32 v245, a61
  v_accvgpr_read_b32 v246, a62
  v_accvgpr_read_b32 v247, a63
  v_mul_f32 v244, v244, v243
  v_mul_f32 v245, v245, v243
  v_mul_f32 v246, v246, v243
  v_mul_f32 v247, v247, v243
  v_accvgpr_write_b32 a60, v244
  v_accvgpr_write_b32 a61, v245
  v_accvgpr_write_b32 a62, v246
  v_accvgpr_write_b32 a63, v247
  v_sub_f32 v136, v136, v241
  v_sub_f32 v137, v137, v241
  v_sub_f32 v138, v138, v241
  v_sub_f32 v139, v139, v241
  v_sub_f32 v140, v140, v241
  v_sub_f32 v141, v141, v241
  v_sub_f32 v142, v142, v241
  v_sub_f32 v143, v143, v241
  v_sub_f32 v168, v168, v241
  v_sub_f32 v169, v169, v241
  v_sub_f32 v170, v170, v241
  v_sub_f32 v171, v171, v241
  v_sub_f32 v172, v172, v241
  v_sub_f32 v173, v173, v241
  v_sub_f32 v174, v174, v241
  v_sub_f32 v175, v175, v241
  v_sub_f32 v216, v216, v241
  v_sub_f32 v217, v217, v241
  v_sub_f32 v218, v218, v241
  v_sub_f32 v219, v219, v241
  v_sub_f32 v220, v220, v241
  v_sub_f32 v221, v221, v241
  v_sub_f32 v222, v222, v241
  v_sub_f32 v223, v223, v241
  v_sub_f32 v152, v152, v241
  v_sub_f32 v153, v153, v241
  v_sub_f32 v154, v154, v241
  v_sub_f32 v155, v155, v241
  v_sub_f32 v156, v156, v241
  v_sub_f32 v157, v157, v241
  v_sub_f32 v158, v158, v241
  v_sub_f32 v159, v159, v241
  v_sub_f32 v184, v184, v241
  v_sub_f32 v185, v185, v241
  v_sub_f32 v186, v186, v241
  v_sub_f32 v187, v187, v241
  v_sub_f32 v188, v188, v241
  v_sub_f32 v189, v189, v241
  v_sub_f32 v190, v190, v241
  v_sub_f32 v191, v191, v241
  v_sub_f32 v232, v232, v241
  v_sub_f32 v233, v233, v241
  v_sub_f32 v234, v234, v241
  v_sub_f32 v235, v235, v241
  v_sub_f32 v236, v236, v241
  v_sub_f32 v237, v237, v241
  v_sub_f32 v238, v238, v241
  v_sub_f32 v239, v239, v241
  v_exp_f32 v32, v144
  v_exp_f32 v33, v145
  v_exp_f32 v34, v146
  v_cvt_pk_bf16_f32 v200, v32, v33
  v_exp_f32 v35, v147
  v_exp_f32 v32, v148
  v_cvt_pk_bf16_f32 v201, v34, v35
  v_exp_f32 v33, v149
  v_exp_f32 v34, v150
  v_cvt_pk_bf16_f32 v202, v32, v33
  v_exp_f32 v35, v151
  v_exp_f32 v32, v152
  v_cvt_pk_bf16_f32 v203, v34, v35
  v_exp_f32 v33, v153
  v_exp_f32 v34, v154
  v_cvt_pk_bf16_f32 v204, v32, v33
  v_exp_f32 v35, v155
  v_exp_f32 v32, v156
  v_cvt_pk_bf16_f32 v205, v34, v35
  v_exp_f32 v33, v157
  v_exp_f32 v34, v158
  v_cvt_pk_bf16_f32 v206, v32, v33
  v_exp_f32 v35, v159
  s_nop 0
  v_cvt_pk_bf16_f32 v207, v34, v35
  s_nop 1
  v_mfma_f32_16x16x32_bf16 v[56:59], a[224:227], v[200:203], 0
  v_mfma_f32_16x16x32_bf16 v[60:63], a[224:227], v[204:207], 0
  s_nop 9
  v_add_f32 v36, v37, v56
  v_add_f32 v38, v39, v60
  v_exp_f32 v32, v160
  v_exp_f32 v33, v161
  v_exp_f32 v34, v162
  v_cvt_pk_bf16_f32 v248, v32, v33
  s_nop 3
  s_setpc_b64 s[6:7]
Lrare107:
  s_call_b64 s[6:7], Lrh106
  s_branch Lrr108
Lrh109:
  s_nop 15
  v_log_f32 v242, v36
  v_max3_f32 v240, v160, v161, v162
  v_max3_f32 v240, v240, v163, v164
  v_max3_f32 v240, v240, v165, v166
  v_max3_f32 v240, v240, v167, 0
  v_max_f32 v240, v240, v242
  v_mov_b32 v242, v240
  s_nop 1
  v_permlane16_swap_b32 v240, v242
  v_max_f32 v240, v240, v242
  v_mov_b32 v242, v240
  s_nop 1
  v_permlane32_swap_b32 v240, v242
  v_max_f32 v240, v240, v242
  v_exp_f32 v243, -v240
  v_sub_f32 v44, v44, v240
  v_mul_f32 v36, v36, v243
  v_accvgpr_read_b32 v244, a0
  v_accvgpr_read_b32 v245, a1
  v_accvgpr_read_b32 v246, a2
  v_accvgpr_read_b32 v247, a3
  v_mul_f32 v244, v244, v243
  v_mul_f32 v245, v245, v243
  v_mul_f32 v246, v246, v243
  v_mul_f32 v247, v247, v243
  v_accvgpr_write_b32 a0, v244
  v_accvgpr_write_b32 a1, v245
  v_accvgpr_write_b32 a2, v246
  v_accvgpr_write_b32 a3, v247
  v_accvgpr_read_b32 v244, a4
  v_accvgpr_read_b32 v245, a5
  v_accvgpr_read_b32 v246, a6
  v_accvgpr_read_b32 v247, a7
  v_mul_f32 v244, v244, v243
  v_mul_f32 v245, v245, v243
  v_mul_f32 v246, v246, v243
  v_mul_f32 v247, v247, v243
  v_accvgpr_write_b32 a4, v244
  v_accvgpr_write_b32 a5, v245
  v_accvgpr_write_b32 a6, v246
  v_accvgpr_write_b32 a7, v247
  v_accvgpr_read_b32 v244, a8
  v_accvgpr_read_b32 v245, a9
  v_accvgpr_read_b32 v246, a10
  v_accvgpr_read_b32 v247, a11
  v_mul_f32 v244, v244, v243
  v_mul_f32 v245, v245, v243
  v_mul_f32 v246, v246, v243
  v_mul_f32 v247, v247, v243
  v_accvgpr_write_b32 a8, v244
  v_accvgpr_write_b32 a9, v245
  v_accvgpr_write_b32 a10, v246
  v_accvgpr_write_b32 a11, v247
  v_accvgpr_read_b32 v244, a12
  v_accvgpr_read_b32 v245, a13
  v_accvgpr_read_b32 v246, a14
  v_accvgpr_read_b32 v247, a15
  v_mul_f32 v244, v244, v243
  v_mul_f32 v245, v245, v243
  v_mul_f32 v246, v246, v243
  v_mul_f32 v247, v247, v243
  v_accvgpr_write_b32 a12, v244
  v_accvgpr_write_b32 a13, v245
  v_accvgpr_write_b32 a14, v246
  v_accvgpr_write_b32 a15, v247
  v_accvgpr_read_b32 v244, a16
  v_accvgpr_read_b32 v245, a17
  v_accvgpr_read_b32 v246, a18
  v_accvgpr_read_b32 v247, a19
  v_mul_f32 v244, v244, v243
  v_mul_f32 v245, v245, v243
  v_mul_f32 v246, v246, v243
  v_mul_f32 v247, v247, v243
  v_accvgpr_write_b32 a16, v244
  v_accvgpr_write_b32 a17, v245
  v_accvgpr_write_b32 a18, v246
  v_accvgpr_write_b32 a19, v247
  v_accvgpr_read_b32 v244, a20
  v_accvgpr_read_b32 v245, a21
  v_accvgpr_read_b32 v246, a22
  v_accvgpr_read_b32 v247, a23
  v_mul_f32 v244, v244, v243
  v_mul_f32 v245, v245, v243
  v_mul_f32 v246, v246, v243
  v_mul_f32 v247, v247, v243
  v_accvgpr_write_b32 a20, v244
  v_accvgpr_write_b32 a21, v245
  v_accvgpr_write_b32 a22, v246
  v_accvgpr_write_b32 a23, v247
  v_accvgpr_read_b32 v244, a24
  v_accvgpr_read_b32 v245, a25
  v_accvgpr_read_b32 v246, a26
  v_accvgpr_read_b32 v247, a27
  v_mul_f32 v244, v244, v243
  v_mul_f32 v245, v245, v243
  v_mul_f32 v246, v246, v243
  v_mul_f32 v247, v247, v243
  v_accvgpr_write_b32 a24, v244
  v_accvgpr_write_b32 a25, v245
  v_accvgpr_write_b32 a26, v246
  v_accvgpr_write_b32 a27, v247
  v_accvgpr_read_b32 v244, a28
  v_accvgpr_read_b32 v245, a29
  v_accvgpr_read_b32 v246, a30
  v_accvgpr_read_b32 v247, a31
  v_mul_f32 v244, v244, v243
  v_mul_f32 v245, v245, v243
  v_mul_f32 v246, v246, v243
  v_mul_f32 v247, v247, v243
  v_accvgpr_write_b32 a28, v244
  v_accvgpr_write_b32 a29, v245
  v_accvgpr_write_b32 a30, v246
  v_accvgpr_write_b32 a31, v247
  v_sub_f32 v160, v160, v240
  v_sub_f32 v161, v161, v240
  v_sub_f32 v162, v162, v240
  v_sub_f32 v163, v163, v240
  v_sub_f32 v164, v164, v240
  v_sub_f32 v165, v165, v240
  v_sub_f32 v166, v166, v240
  v_sub_f32 v167, v167, v240
  v_sub_f32 v128, v128, v240
  v_sub_f32 v129, v129, v240
  v_sub_f32 v130, v130, v240
  v_sub_f32 v131, v131, v240
  v_sub_f32 v132, v132, v240
  v_sub_f32 v133, v133, v240
  v_sub_f32 v134, v134, v240
  v_sub_f32 v135, v135, v240
  v_sub_f32 v208, v208, v240
  v_sub_f32 v209, v209, v240
  v_sub_f32 v210, v210, v240
  v_sub_f32 v211, v211, v240
  v_sub_f32 v212, v212, v240
  v_sub_f32 v213, v213, v240
  v_sub_f32 v214, v214, v240
  v_sub_f32 v215, v215, v240
  v_sub_f32 v176, v176, v240
  v_sub_f32 v177, v177, v240
  v_sub_f32 v178, v178, v240
  v_sub_f32 v179, v179, v240
  v_sub_f32 v180, v180, v240
  v_sub_f32 v181, v181, v240
  v_sub_f32 v182, v182, v240
  v_sub_f32 v183, v183, v240
  v_sub_f32 v144, v144, v240
  v_sub_f32 v145, v145, v240
  v_sub_f32 v146, v146, v240
  v_sub_f32 v147, v147, v240
  v_sub_f32 v148, v148, v240
  v_sub_f32 v149, v149, v240
  v_sub_f32 v150, v150, v240
  v_sub_f32 v151, v151, v240
  v_sub_f32 v224, v224, v240
  v_sub_f32 v225, v225, v240
  v_sub_f32 v226, v226, v240
  v_sub_f32 v227, v227, v240
  v_sub_f32 v228, v228, v240
  v_sub_f32 v229, v229, v240
  v_sub_f32 v230, v230, v240
  v_sub_f32 v231, v231, v240
  v_log_f32 v242, v38
  v_max3_f32 v241, v168, v169, v170
  v_max3_f32 v241, v241, v171, v172
  v_max3_f32 v241, v241, v173, v174
  v_max3_f32 v241, v241, v175, 0
  v_max_f32 v241, v241, v242
  v_mov_b32 v242, v241
  s_nop 1
  v_permlane16_swap_b32 v241, v242
  v_max_f32 v241, v241, v242
  v_mov_b32 v242, v241
  s_nop 1
  v_permlane32_swap_b32 v241, v242
  v_max_f32 v241, v241, v242
  v_exp_f32 v243, -v241
  v_sub_f32 v45, v45, v241
  v_mul_f32 v38, v38, v243
  v_accvgpr_read_b32 v244, a32
  v_accvgpr_read_b32 v245, a33
  v_accvgpr_read_b32 v246, a34
  v_accvgpr_read_b32 v247, a35
  v_mul_f32 v244, v244, v243
  v_mul_f32 v245, v245, v243
  v_mul_f32 v246, v246, v243
  v_mul_f32 v247, v247, v243
  v_accvgpr_write_b32 a32, v244
  v_accvgpr_write_b32 a33, v245
  v_accvgpr_write_b32 a34, v246
  v_accvgpr_write_b32 a35, v247
  v_accvgpr_read_b32 v244, a36
  v_accvgpr_read_b32 v245, a37
  v_accvgpr_read_b32 v246, a38
  v_accvgpr_read_b32 v247, a39
  v_mul_f32 v244, v244, v243
  v_mul_f32 v245, v245, v243
  v_mul_f32 v246, v246, v243
  v_mul_f32 v247, v247, v243
  v_accvgpr_write_b32 a36, v244
  v_accvgpr_write_b32 a37, v245
  v_accvgpr_write_b32 a38, v246
  v_accvgpr_write_b32 a39, v247
  v_accvgpr_read_b32 v244, a40
  v_accvgpr_read_b32 v245, a41
  v_accvgpr_read_b32 v246, a42
  v_accvgpr_read_b32 v247, a43
  v_mul_f32 v244, v244, v243
  v_mul_f32 v245, v245, v243
  v_mul_f32 v246, v246, v243
  v_mul_f32 v247, v247, v243
  v_accvgpr_write_b32 a40, v244
  v_accvgpr_write_b32 a41, v245
  v_accvgpr_write_b32 a42, v246
  v_accvgpr_write_b32 a43, v247
  v_accvgpr_read_b32 v244, a44
  v_accvgpr_read_b32 v245, a45
  v_accvgpr_read_b32 v246, a46
  v_accvgpr_read_b32 v247, a47
  v_mul_f32 v244, v244, v243
  v_mul_f32 v245, v245, v243
  v_mul_f32 v246, v246, v243
  v_mul_f32 v247, v247, v243
  v_accvgpr_write_b32 a44, v244
  v_accvgpr_write_b32 a45, v245
  v_accvgpr_write_b32 a46, v246
  v_accvgpr_write_b32 a47, v247
  v_accvgpr_read_b32 v244, a48
  v_accvgpr_read_b32 v245, a49
  v_accvgpr_read_b32 v246, a50
  v_accvgpr_read_b32 v247, a51
  v_mul_f32 v244, v244, v243
  v_mul_f32 v245, v245, v243
  v_mul_f32 v246, v246, v243
  v_mul_f32 v247, v247, v243
  v_accvgpr_write_b32 a48, v244
  v_accvgpr_write_b32 a49, v245
  v_accvgpr_write_b32 a50, v246
  v_accvgpr_write_b32 a51, v247
  v_accvgpr_read_b32 v244, a52
  v_accvgpr_read_b32 v245, a53
  v_accvgpr_read_b32 v246, a54
  v_accvgpr_read_b32 v247, a55
  v_mul_f32 v244, v244, v243
  v_mul_f32 v245, v245, v243
  v_mul_f32 v246, v246, v243
  v_mul_f32 v247, v247, v243
  v_accvgpr_write_b32 a52, v244
  v_accvgpr_write_b32 a53, v245
  v_accvgpr_write_b32 a54, v246
  v_accvgpr_write_b32 a55, v247
  v_accvgpr_read_b32 v244, a56
  v_accvgpr_read_b32 v245, a57
  v_accvgpr_read_b32 v246, a58
  v_accvgpr_read_b32 v247, a59
  v_mul_f32 v244, v244, v243
  v_mul_f32 v245, v245, v243
  v_mul_f32 v246, v246, v243
  v_mul_f32 v247, v247, v243
  v_accvgpr_write_b32 a56, v244
  v_accvgpr_write_b32 a57, v245
  v_accvgpr_write_b32 a58, v246
  v_accvgpr_write_b32 a59, v247
  v_accvgpr_read_b32 v244, a60
  v_accvgpr_read_b32 v245, a61
  v_accvgpr_read_b32 v246, a62
  v_accvgpr_read_b32 v247, a63
  v_mul_f32 v244, v244, v243
  v_mul_f32 v245, v245, v243
  v_mul_f32 v246, v246, v243
  v_mul_f32 v247, v247, v243
  v_accvgpr_write_b32 a60, v244
  v_accvgpr_write_b32 a61, v245
  v_accvgpr_write_b32 a62, v246
  v_accvgpr_write_b32 a63, v247
  v_sub_f32 v168, v168, v241
  v_sub_f32 v169, v169, v241
  v_sub_f32 v170, v170, v241
  v_sub_f32 v171, v171, v241
  v_sub_f32 v172, v172, v241
  v_sub_f32 v173, v173, v241
  v_sub_f32 v174, v174, v241
  v_sub_f32 v175, v175, v241
  v_sub_f32 v136, v136, v241
  v_sub_f32 v137, v137, v241
  v_sub_f32 v138, v138, v241
  v_sub_f32 v139, v139, v241
  v_sub_f32 v140, v140, v241
  v_sub_f32 v141, v141, v241
  v_sub_f32 v142, v142, v241
  v_sub_f32 v143, v143, v241
  v_sub_f32 v216, v216, v241
  v_sub_f32 v217, v217, v241
  v_sub_f32 v218, v218, v241
  v_sub_f32 v219, v219, v241
  v_sub_f32 v220, v220, v241
  v_sub_f32 v221, v221, v241
  v_sub_f32 v222, v222, v241
  v_sub_f32 v223, v223, v241
  v_sub_f32 v184, v184, v241
  v_sub_f32 v185, v185, v241
  v_sub_f32 v186, v186, v241
  v_sub_f32 v187, v187, v241
  v_sub_f32 v188, v188, v241
  v_sub_f32 v189, v189, v241
  v_sub_f32 v190, v190, v241
  v_sub_f32 v191, v191, v241
  v_sub_f32 v152, v152, v241
  v_sub_f32 v153, v153, v241
  v_sub_f32 v154, v154, v241
  v_sub_f32 v155, v155, v241
  v_sub_f32 v156, v156, v241
  v_sub_f32 v157, v157, v241
  v_sub_f32 v158, v158, v241
  v_sub_f32 v159, v159, v241
  v_sub_f32 v232, v232, v241
  v_sub_f32 v233, v233, v241
  v_sub_f32 v234, v234, v241
  v_sub_f32 v235, v235, v241
  v_sub_f32 v236, v236, v241
  v_sub_f32 v237, v237, v241
  v_sub_f32 v238, v238, v241
  v_sub_f32 v239, v239, v241
  v_exp_f32 v32, v160
  v_exp_f32 v33, v161
  v_exp_f32 v34, v162
  v_cvt_pk_bf16_f32 v248, v32, v33
  v_exp_f32 v35, v163
  v_exp_f32 v32, v164
  v_cvt_pk_bf16_f32 v249, v34, v35
  v_exp_f32 v33, v165
  v_exp_f32 v34, v166
  v_cvt_pk_bf16_f32 v250, v32, v33
  v_exp_f32 v35, v167
  v_exp_f32 v32, v168
  v_cvt_pk_bf16_f32 v251, v34, v35
  v_exp_f32 v33, v169
  v_exp_f32 v34, v170
  v_cvt_pk_bf16_f32 v252, v32, v33
  v_exp_f32 v35, v171
  v_exp_f32 v32, v172
  v_cvt_pk_bf16_f32 v253, v34, v35
  v_exp_f32 v33, v173
  v_exp_f32 v34, v174
  v_cvt_pk_bf16_f32 v254, v32, v33
  v_exp_f32 v35, v175
  s_nop 0
  v_cvt_pk_bf16_f32 v255, v34, v35
  s_nop 1
  v_mfma_f32_16x16x32_bf16 v[56:59], a[224:227], v[248:251], 0
  v_mfma_f32_16x16x32_bf16 v[60:63], a[224:227], v[252:255], 0
  s_nop 9
  v_add_f32 v37, v36, v56
  v_add_f32 v39, v38, v60
  v_exp_f32 v32, v176
  v_exp_f32 v33, v177
  v_exp_f32 v34, v178
  v_cvt_pk_bf16_f32 v200, v32, v33
  s_nop 3
  s_setpc_b64 s[6:7]
Lrare110:
  s_call_b64 s[6:7], Lrh109
  s_branch Lrr111
Lrh112:
  s_nop 15
  v_log_f32 v242, v37
  v_max3_f32 v240, v176, v177, v178
  v_max3_f32 v240, v240, v179, v180
  v_max3_f32 v240, v240, v181, v182
  v_max3_f32 v240, v240, v183, 0
  v_max_f32 v240, v240, v242
  v_mov_b32 v242, v240
  s_nop 1
  v_permlane16_swap_b32 v240, v242
  v_max_f32 v240, v240, v242
  v_mov_b32 v242, v240
  s_nop 1
  v_permlane32_swap_b32 v240, v242
  v_max_f32 v240, v240, v242
  v_exp_f32 v243, -v240
  v_sub_f32 v44, v44, v240
  v_mul_f32 v37, v37, v243
  v_accvgpr_read_b32 v244, a0
  v_accvgpr_read_b32 v245, a1
  v_accvgpr_read_b32 v246, a2
  v_accvgpr_read_b32 v247, a3
  v_mul_f32 v244, v244, v243
  v_mul_f32 v245, v245, v243
  v_mul_f32 v246, v246, v243
  v_mul_f32 v247, v247, v243
  v_accvgpr_write_b32 a0, v244
  v_accvgpr_write_b32 a1, v245
  v_accvgpr_write_b32 a2, v246
  v_accvgpr_write_b32 a3, v247
  v_accvgpr_read_b32 v244, a4
  v_accvgpr_read_b32 v245, a5
  v_accvgpr_read_b32 v246, a6
  v_accvgpr_read_b32 v247, a7
  v_mul_f32 v244, v244, v243
  v_mul_f32 v245, v245, v243
  v_mul_f32 v246, v246, v243
  v_mul_f32 v247, v247, v243
  v_accvgpr_write_b32 a4, v244
  v_accvgpr_write_b32 a5, v245
  v_accvgpr_write_b32 a6, v246
  v_accvgpr_write_b32 a7, v247
  v_accvgpr_read_b32 v244, a8
  v_accvgpr_read_b32 v245, a9
  v_accvgpr_read_b32 v246, a10
  v_accvgpr_read_b32 v247, a11
  v_mul_f32 v244, v244, v243
  v_mul_f32 v245, v245, v243
  v_mul_f32 v246, v246, v243
  v_mul_f32 v247, v247, v243
  v_accvgpr_write_b32 a8, v244
  v_accvgpr_write_b32 a9, v245
  v_accvgpr_write_b32 a10, v246
  v_accvgpr_write_b32 a11, v247
  v_accvgpr_read_b32 v244, a12
  v_accvgpr_read_b32 v245, a13
  v_accvgpr_read_b32 v246, a14
  v_accvgpr_read_b32 v247, a15
  v_mul_f32 v244, v244, v243
  v_mul_f32 v245, v245, v243
  v_mul_f32 v246, v246, v243
  v_mul_f32 v247, v247, v243
  v_accvgpr_write_b32 a12, v244
  v_accvgpr_write_b32 a13, v245
  v_accvgpr_write_b32 a14, v246
  v_accvgpr_write_b32 a15, v247
  v_accvgpr_read_b32 v244, a16
  v_accvgpr_read_b32 v245, a17
  v_accvgpr_read_b32 v246, a18
  v_accvgpr_read_b32 v247, a19
  v_mul_f32 v244, v244, v243
  v_mul_f32 v245, v245, v243
  v_mul_f32 v246, v246, v243
  v_mul_f32 v247, v247, v243
  v_accvgpr_write_b32 a16, v244
  v_accvgpr_write_b32 a17, v245
  v_accvgpr_write_b32 a18, v246
  v_accvgpr_write_b32 a19, v247
  v_accvgpr_read_b32 v244, a20
  v_accvgpr_read_b32 v245, a21
  v_accvgpr_read_b32 v246, a22
  v_accvgpr_read_b32 v247, a23
  v_mul_f32 v244, v244, v243
  v_mul_f32 v245, v245, v243
  v_mul_f32 v246, v246, v243
  v_mul_f32 v247, v247, v243
  v_accvgpr_write_b32 a20, v244
  v_accvgpr_write_b32 a21, v245
  v_accvgpr_write_b32 a22, v246
  v_accvgpr_write_b32 a23, v247
  v_accvgpr_read_b32 v244, a24
  v_accvgpr_read_b32 v245, a25
  v_accvgpr_read_b32 v246, a26
  v_accvgpr_read_b32 v247, a27
  v_mul_f32 v244, v244, v243
  v_mul_f32 v245, v245, v243
  v_mul_f32 v246, v246, v243
  v_mul_f32 v247, v247, v243
  v_accvgpr_write_b32 a24, v244
  v_accvgpr_write_b32 a25, v245
  v_accvgpr_write_b32 a26, v246
  v_accvgpr_write_b32 a27, v247
  v_accvgpr_read_b32 v244, a28
  v_accvgpr_read_b32 v245, a29
  v_accvgpr_read_b32 v246, a30
  v_accvgpr_read_b32 v247, a31
  v_mul_f32 v244, v244, v243
  v_mul_f32 v245, v245, v243
  v_mul_f32 v246, v246, v243
  v_mul_f32 v247, v247, v243
  v_accvgpr_write_b32 a28, v244
  v_accvgpr_write_b32 a29, v245
  v_accvgpr_write_b32 a30, v246
  v_accvgpr_write_b32 a31, v247
  v_sub_f32 v160, v160, v240
  v_sub_f32 v161, v161, v240
  v_sub_f32 v162, v162, v240
  v_sub_f32 v163, v163, v240
  v_sub_f32 v164, v164, v240
  v_sub_f32 v165, v165, v240
  v_sub_f32 v166, v166, v240
  v_sub_f32 v167, v167, v240
  v_sub_f32 v128, v128, v240
  v_sub_f32 v129, v129, v240
  v_sub_f32 v130, v130, v240
  v_sub_f32 v131, v131, v240
  v_sub_f32 v132, v132, v240
  v_sub_f32 v133, v133, v240
  v_sub_f32 v134, v134, v240
  v_sub_f32 v135, v135, v240
  v_sub_f32 v208, v208, v240
  v_sub_f32 v209, v209, v240
  v_sub_f32 v210, v210, v240
  v_sub_f32 v211, v211, v240
  v_sub_f32 v212, v212, v240
  v_sub_f32 v213, v213, v240
  v_sub_f32 v214, v214, v240
  v_sub_f32 v215, v215, v240
  v_sub_f32 v176, v176, v240
  v_sub_f32 v177, v177, v240
  v_sub_f32 v178, v178, v240
  v_sub_f32 v179, v179, v240
  v_sub_f32 v180, v180, v240
  v_sub_f32 v181, v181, v240
  v_sub_f32 v182, v182, v240
  v_sub_f32 v183, v183, v240
  v_sub_f32 v144, v144, v240
  v_sub_f32 v145, v145, v240
  v_sub_f32 v146, v146, v240
  v_sub_f32 v147, v147, v240
  v_sub_f32 v148, v148, v240
  v_sub_f32 v149, v149, v240
  v_sub_f32 v150, v150, v240
  v_sub_f32 v151, v151, v240
  v_sub_f32 v224, v224, v240
  v_sub_f32 v225, v225, v240
  v_sub_f32 v226, v226, v240
  v_sub_f32 v227, v227, v240
  v_sub_f32 v228, v228, v240
  v_sub_f32 v229, v229, v240
  v_sub_f32 v230, v230, v240
  v_sub_f32 v231, v231, v240
  v_log_f32 v242, v39
  v_max3_f32 v241, v184, v185, v186
  v_max3_f32 v241, v241, v187, v188
  v_max3_f32 v241, v241, v189, v190
  v_max3_f32 v241, v241, v191, 0
  v_max_f32 v241, v241, v242
  v_mov_b32 v242, v241
  s_nop 1
  v_permlane16_swap_b32 v241, v242
  v_max_f32 v241, v241, v242
  v_mov_b32 v242, v241
  s_nop 1
  v_permlane32_swap_b32 v241, v242
  v_max_f32 v241, v241, v242
  v_exp_f32 v243, -v241
  v_sub_f32 v45, v45, v241
  v_mul_f32 v39, v39, v243
  v_accvgpr_read_b32 v244, a32
  v_accvgpr_read_b32 v245, a33
  v_accvgpr_read_b32 v246, a34
  v_accvgpr_read_b32 v247, a35
  v_mul_f32 v244, v244, v243
  v_mul_f32 v245, v245, v243
  v_mul_f32 v246, v246, v243
  v_mul_f32 v247, v247, v243
  v_accvgpr_write_b32 a32, v244
  v_accvgpr_write_b32 a33, v245
  v_accvgpr_write_b32 a34, v246
  v_accvgpr_write_b32 a35, v247
  v_accvgpr_read_b32 v244, a36
  v_accvgpr_read_b32 v245, a37
  v_accvgpr_read_b32 v246, a38
  v_accvgpr_read_b32 v247, a39
  v_mul_f32 v244, v244, v243
  v_mul_f32 v245, v245, v243
  v_mul_f32 v246, v246, v243
  v_mul_f32 v247, v247, v243
  v_accvgpr_write_b32 a36, v244
  v_accvgpr_write_b32 a37, v245
  v_accvgpr_write_b32 a38, v246
  v_accvgpr_write_b32 a39, v247
  v_accvgpr_read_b32 v244, a40
  v_accvgpr_read_b32 v245, a41
  v_accvgpr_read_b32 v246, a42
  v_accvgpr_read_b32 v247, a43
  v_mul_f32 v244, v244, v243
  v_mul_f32 v245, v245, v243
  v_mul_f32 v246, v246, v243
  v_mul_f32 v247, v247, v243
  v_accvgpr_write_b32 a40, v244
  v_accvgpr_write_b32 a41, v245
  v_accvgpr_write_b32 a42, v246
  v_accvgpr_write_b32 a43, v247
  v_accvgpr_read_b32 v244, a44
  v_accvgpr_read_b32 v245, a45
  v_accvgpr_read_b32 v246, a46
  v_accvgpr_read_b32 v247, a47
  v_mul_f32 v244, v244, v243
  v_mul_f32 v245, v245, v243
  v_mul_f32 v246, v246, v243
  v_mul_f32 v247, v247, v243
  v_accvgpr_write_b32 a44, v244
  v_accvgpr_write_b32 a45, v245
  v_accvgpr_write_b32 a46, v246
  v_accvgpr_write_b32 a47, v247
  v_accvgpr_read_b32 v244, a48
  v_accvgpr_read_b32 v245, a49
  v_accvgpr_read_b32 v246, a50
  v_accvgpr_read_b32 v247, a51
  v_mul_f32 v244, v244, v243
  v_mul_f32 v245, v245, v243
  v_mul_f32 v246, v246, v243
  v_mul_f32 v247, v247, v243
  v_accvgpr_write_b32 a48, v244
  v_accvgpr_write_b32 a49, v245
  v_accvgpr_write_b32 a50, v246
  v_accvgpr_write_b32 a51, v247
  v_accvgpr_read_b32 v244, a52
  v_accvgpr_read_b32 v245, a53
  v_accvgpr_read_b32 v246, a54
  v_accvgpr_read_b32 v247, a55
  v_mul_f32 v244, v244, v243
  v_mul_f32 v245, v245, v243
  v_mul_f32 v246, v246, v243
  v_mul_f32 v247, v247, v243
  v_accvgpr_write_b32 a52, v244
  v_accvgpr_write_b32 a53, v245
  v_accvgpr_write_b32 a54, v246
  v_accvgpr_write_b32 a55, v247
  v_accvgpr_read_b32 v244, a56
  v_accvgpr_read_b32 v245, a57
  v_accvgpr_read_b32 v246, a58
  v_accvgpr_read_b32 v247, a59
  v_mul_f32 v244, v244, v243
  v_mul_f32 v245, v245, v243
  v_mul_f32 v246, v246, v243
  v_mul_f32 v247, v247, v243
  v_accvgpr_write_b32 a56, v244
  v_accvgpr_write_b32 a57, v245
  v_accvgpr_write_b32 a58, v246
  v_accvgpr_write_b32 a59, v247
  v_accvgpr_read_b32 v244, a60
  v_accvgpr_read_b32 v245, a61
  v_accvgpr_read_b32 v246, a62
  v_accvgpr_read_b32 v247, a63
  v_mul_f32 v244, v244, v243
  v_mul_f32 v245, v245, v243
  v_mul_f32 v246, v246, v243
  v_mul_f32 v247, v247, v243
  v_accvgpr_write_b32 a60, v244
  v_accvgpr_write_b32 a61, v245
  v_accvgpr_write_b32 a62, v246
  v_accvgpr_write_b32 a63, v247
  v_sub_f32 v168, v168, v241
  v_sub_f32 v169, v169, v241
  v_sub_f32 v170, v170, v241
  v_sub_f32 v171, v171, v241
  v_sub_f32 v172, v172, v241
  v_sub_f32 v173, v173, v241
  v_sub_f32 v174, v174, v241
  v_sub_f32 v175, v175, v241
  v_sub_f32 v136, v136, v241
  v_sub_f32 v137, v137, v241
  v_sub_f32 v138, v138, v241
  v_sub_f32 v139, v139, v241
  v_sub_f32 v140, v140, v241
  v_sub_f32 v141, v141, v241
  v_sub_f32 v142, v142, v241
  v_sub_f32 v143, v143, v241
  v_sub_f32 v216, v216, v241
  v_sub_f32 v217, v217, v241
  v_sub_f32 v218, v218, v241
  v_sub_f32 v219, v219, v241
  v_sub_f32 v220, v220, v241
  v_sub_f32 v221, v221, v241
  v_sub_f32 v222, v222, v241
  v_sub_f32 v223, v223, v241
  v_sub_f32 v184, v184, v241
  v_sub_f32 v185, v185, v241
  v_sub_f32 v186, v186, v241
  v_sub_f32 v187, v187, v241
  v_sub_f32 v188, v188, v241
  v_sub_f32 v189, v189, v241
  v_sub_f32 v190, v190, v241
  v_sub_f32 v191, v191, v241
  v_sub_f32 v152, v152, v241
  v_sub_f32 v153, v153, v241
  v_sub_f32 v154, v154, v241
  v_sub_f32 v155, v155, v241
  v_sub_f32 v156, v156, v241
  v_sub_f32 v157, v157, v241
  v_sub_f32 v158, v158, v241
  v_sub_f32 v159, v159, v241
  v_sub_f32 v232, v232, v241
  v_sub_f32 v233, v233, v241
  v_sub_f32 v234, v234, v241
  v_sub_f32 v235, v235, v241
  v_sub_f32 v236, v236, v241
  v_sub_f32 v237, v237, v241
  v_sub_f32 v238, v238, v241
  v_sub_f32 v239, v239, v241
  v_exp_f32 v32, v176
  v_exp_f32 v33, v177
  v_exp_f32 v34, v178
  v_cvt_pk_bf16_f32 v200, v32, v33
  v_exp_f32 v35, v179
  v_exp_f32 v32, v180
  v_cvt_pk_bf16_f32 v201, v34, v35
  v_exp_f32 v33, v181
  v_exp_f32 v34, v182
  v_cvt_pk_bf16_f32 v202, v32, v33
  v_exp_f32 v35, v183
  v_exp_f32 v32, v184
  v_cvt_pk_bf16_f32 v203, v34, v35
  v_exp_f32 v33, v185
  v_exp_f32 v34, v186
  v_cvt_pk_bf16_f32 v204, v32, v33
  v_exp_f32 v35, v187
  v_exp_f32 v32, v188
  v_cvt_pk_bf16_f32 v205, v34, v35
  v_exp_f32 v33, v189
  v_exp_f32 v34, v190
  v_cvt_pk_bf16_f32 v206, v32, v33
  v_exp_f32 v35, v191
  s_nop 0
  v_cvt_pk_bf16_f32 v207, v34, v35
  s_nop 1
  v_mfma_f32_16x16x32_bf16 v[56:59], a[224:227], v[200:203], 0
  v_mfma_f32_16x16x32_bf16 v[60:63], a[224:227], v[204:207], 0
  s_nop 9
  v_add_f32 v36, v37, v56
  v_add_f32 v38, v39, v60
  v_exp_f32 v32, v128
  v_exp_f32 v33, v129
  v_exp_f32 v34, v130
  v_cvt_pk_bf16_f32 v192, v32, v33
  s_nop 3
  s_setpc_b64 s[6:7]
Lrare113:
  s_call_b64 s[6:7], Lrh112
  s_branch Lrr114
Lrare115:
  s_call_b64 s[6:7], Lrh94
  s_branch Lrr116
Lrare117:
  s_call_b64 s[6:7], Lrh106
  s_branch Lrr118
Lrare123:
  s_call_b64 s[6:7], Lrh109
  s_branch Lrr124
Lrare125:
  s_call_b64 s[6:7], Lrh112
  s_branch Lrr126
Lrare127:
  s_call_b64 s[6:7], Lrh94
  s_branch Lrr128
Lrare129:
  s_call_b64 s[6:7], Lrh97
  s_branch Lrr130
Lrh131:
  s_nop 15
  v_log_f32 v242, v38
  v_max3_f32 v241, v168, v169, v170
  v_max3_f32 v241, v241, v171, v172
  v_max3_f32 v241, v241, v173, v174
  v_max3_f32 v241, v241, v175, 0
  v_max_f32 v241, v241, v242
  v_mov_b32 v242, v241
  s_nop 1
  v_permlane16_swap_b32 v241, v242
  v_max_f32 v241, v241, v242
  v_mov_b32 v242, v241
  s_nop 1
  v_permlane32_swap_b32 v241, v242
  v_max_f32 v241, v241, v242
  v_exp_f32 v243, -v241
  v_sub_f32 v45, v45, v241
  v_mul_f32 v38, v38, v243
  v_accvgpr_read_b32 v244, a32
  v_accvgpr_read_b32 v245, a33
  v_accvgpr_read_b32 v246, a34
  v_accvgpr_read_b32 v247, a35
  v_mul_f32 v244, v244, v243
  v_mul_f32 v245, v245, v243
  v_mul_f32 v246, v246, v243
  v_mul_f32 v247, v247, v243
  v_accvgpr_write_b32 a32, v244
  v_accvgpr_write_b32 a33, v245
  v_accvgpr_write_b32 a34, v246
  v_accvgpr_write_b32 a35, v247
  v_accvgpr_read_b32 v244, a36
  v_accvgpr_read_b32 v245, a37
  v_accvgpr_read_b32 v246, a38
  v_accvgpr_read_b32 v247, a39
  v_mul_f32 v244, v244, v243
  v_mul_f32 v245, v245, v243
  v_mul_f32 v246, v246, v243
  v_mul_f32 v247, v247, v243
  v_accvgpr_write_b32 a36, v244
  v_accvgpr_write_b32 a37, v245
  v_accvgpr_write_b32 a38, v246
  v_accvgpr_write_b32 a39, v247
  v_accvgpr_read_b32 v244, a40
  v_accvgpr_read_b32 v245, a41
  v_accvgpr_read_b32 v246, a42
  v_accvgpr_read_b32 v247, a43
  v_mul_f32 v244, v244, v243
  v_mul_f32 v245, v245, v243
  v_mul_f32 v246, v246, v243
  v_mul_f32 v247, v247, v243
  v_accvgpr_write_b32 a40, v244
  v_accvgpr_write_b32 a41, v245
  v_accvgpr_write_b32 a42, v246
  v_accvgpr_write_b32 a43, v247
  v_accvgpr_read_b32 v244, a44
  v_accvgpr_read_b32 v245, a45
  v_accvgpr_read_b32 v246, a46
  v_accvgpr_read_b32 v247, a47
  v_mul_f32 v244, v244, v243
  v_mul_f32 v245, v245, v243
  v_mul_f32 v246, v246, v243
  v_mul_f32 v247, v247, v243
  v_accvgpr_write_b32 a44, v244
  v_accvgpr_write_b32 a45, v245
  v_accvgpr_write_b32 a46, v246
  v_accvgpr_write_b32 a47, v247
  v_accvgpr_read_b32 v244, a48
  v_accvgpr_read_b32 v245, a49
  v_accvgpr_read_b32 v246, a50
  v_accvgpr_read_b32 v247, a51
  v_mul_f32 v244, v244, v243
  v_mul_f32 v245, v245, v243
  v_mul_f32 v246, v246, v243
  v_mul_f32 v247, v247, v243
  v_accvgpr_write_b32 a48, v244
  v_accvgpr_write_b32 a49, v245
  v_accvgpr_write_b32 a50, v246
  v_accvgpr_write_b32 a51, v247
  v_accvgpr_read_b32 v244, a52
  v_accvgpr_read_b32 v245, a53
  v_accvgpr_read_b32 v246, a54
  v_accvgpr_read_b32 v247, a55
  v_mul_f32 v244, v244, v243
  v_mul_f32 v245, v245, v243
  v_mul_f32 v246, v246, v243
  v_mul_f32 v247, v247, v243
  v_accvgpr_write_b32 a52, v244
  v_accvgpr_write_b32 a53, v245
  v_accvgpr_write_b32 a54, v246
  v_accvgpr_write_b32 a55, v247
  v_accvgpr_read_b32 v244, a56
  v_accvgpr_read_b32 v245, a57
  v_accvgpr_read_b32 v246, a58
  v_accvgpr_read_b32 v247, a59
  v_mul_f32 v244, v244, v243
  v_mul_f32 v245, v245, v243
  v_mul_f32 v246, v246, v243
  v_mul_f32 v247, v247, v243
  v_accvgpr_write_b32 a56, v244
  v_accvgpr_write_b32 a57, v245
  v_accvgpr_write_b32 a58, v246
  v_accvgpr_write_b32 a59, v247
  v_accvgpr_read_b32 v244, a60
  v_accvgpr_read_b32 v245, a61
  v_accvgpr_read_b32 v246, a62
  v_accvgpr_read_b32 v247, a63
  v_mul_f32 v244, v244, v243
  v_mul_f32 v245, v245, v243
  v_mul_f32 v246, v246, v243
  v_mul_f32 v247, v247, v243
  v_accvgpr_write_b32 a60, v244
  v_accvgpr_write_b32 a61, v245
  v_accvgpr_write_b32 a62, v246
  v_accvgpr_write_b32 a63, v247
  v_sub_f32 v168, v168, v241
  v_sub_f32 v169, v169, v241
  v_sub_f32 v170, v170, v241
  v_sub_f32 v171, v171, v241
  v_sub_f32 v172, v172, v241
  v_sub_f32 v173, v173, v241
  v_sub_f32 v174, v174, v241
  v_sub_f32 v175, v175, v241
  v_sub_f32 v184, v184, v241
  v_sub_f32 v185, v185, v241
  v_sub_f32 v186, v186, v241
  v_sub_f32 v187, v187, v241
  v_sub_f32 v188, v188, v241
  v_sub_f32 v189, v189, v241
  v_sub_f32 v190, v190, v241
  v_sub_f32 v191, v191, v241
  v_exp_f32 v32, v168
  v_exp_f32 v33, v169
  v_exp_f32 v34, v170
  v_cvt_pk_bf16_f32 v252, v32, v33
  v_exp_f32 v35, v171
  v_exp_f32 v32, v172
  v_cvt_pk_bf16_f32 v253, v34, v35
  v_exp_f32 v33, v173
  v_exp_f32 v34, v174
  v_cvt_pk_bf16_f32 v254, v32, v33
  v_exp_f32 v35, v175
  s_nop 0
  v_cvt_pk_bf16_f32 v255, v34, v35
  s_nop 1
  v_mfma_f32_16x16x32_bf16 v[60:63], a[224:227], v[252:255], 0
  s_nop 9
  v_mov_b32 v37, v36
  v_add_f32 v39, v38, v60
  s_nop 3
  s_setpc_b64 s[6:7]
Lrare132:
  s_call_b64 s[6:7], Lrh131
  s_branch Lrr133
Lrh136:
  s_nop 15
  v_log_f32 v242, v39
  v_max3_f32 v241, v184, v185, v186
  v_max3_f32 v241, v241, v187, v188
  v_max3_f32 v241, v241, v189, v190
  v_max3_f32 v241, v241, v191, 0
  v_max_f32 v241, v241, v242
  v_mov_b32 v242, v241
  s_nop 1
  v_permlane16_swap_b32 v241, v242
  v_max_f32 v241, v241, v242
  v_mov_b32 v242, v241
  s_nop 1
  v_permlane32_swap_b32 v241, v242
  v_max_f32 v241, v241, v242
  v_exp_f32 v243, -v241
  v_sub_f32 v45, v45, v241
  v_mul_f32 v39, v39, v243
  v_accvgpr_read_b32 v244, a32
  v_accvgpr_read_b32 v245, a33
  v_accvgpr_read_b32 v246, a34
  v_accvgpr_read_b32 v247, a35
  v_mul_f32 v244, v244, v243
  v_mul_f32 v245, v245, v243
  v_mul_f32 v246, v246, v243
  v_mul_f32 v247, v247, v243
  v_accvgpr_write_b32 a32, v244
  v_accvgpr_write_b32 a33, v245
  v_accvgpr_write_b32 a34, v246
  v_accvgpr_write_b32 a35, v247
  v_accvgpr_read_b32 v244, a36
  v_accvgpr_read_b32 v245, a37
  v_accvgpr_read_b32 v246, a38
  v_accvgpr_read_b32 v247, a39
  v_mul_f32 v244, v244, v243
  v_mul_f32 v245, v245, v243
  v_mul_f32 v246, v246, v243
  v_mul_f32 v247, v247, v243
  v_accvgpr_write_b32 a36, v244
  v_accvgpr_write_b32 a37, v245
  v_accvgpr_write_b32 a38, v246
  v_accvgpr_write_b32 a39, v247
  v_accvgpr_read_b32 v244, a40
  v_accvgpr_read_b32 v245, a41
  v_accvgpr_read_b32 v246, a42
  v_accvgpr_read_b32 v247, a43
  v_mul_f32 v244, v244, v243
  v_mul_f32 v245, v245, v243
  v_mul_f32 v246, v246, v243
  v_mul_f32 v247, v247, v243
  v_accvgpr_write_b32 a40, v244
  v_accvgpr_write_b32 a41, v245
  v_accvgpr_write_b32 a42, v246
  v_accvgpr_write_b32 a43, v247
  v_accvgpr_read_b32 v244, a44
  v_accvgpr_read_b32 v245, a45
  v_accvgpr_read_b32 v246, a46
  v_accvgpr_read_b32 v247, a47
  v_mul_f32 v244, v244, v243
  v_mul_f32 v245, v245, v243
  v_mul_f32 v246, v246, v243
  v_mul_f32 v247, v247, v243
  v_accvgpr_write_b32 a44, v244
  v_accvgpr_write_b32 a45, v245
  v_accvgpr_write_b32 a46, v246
  v_accvgpr_write_b32 a47, v247
  v_accvgpr_read_b32 v244, a48
  v_accvgpr_read_b32 v245, a49
  v_accvgpr_read_b32 v246, a50
  v_accvgpr_read_b32 v247, a51
  v_mul_f32 v244, v244, v243
  v_mul_f32 v245, v245, v243
  v_mul_f32 v246, v246, v243
  v_mul_f32 v247, v247, v243
  v_accvgpr_write_b32 a48, v244
  v_accvgpr_write_b32 a49, v245
  v_accvgpr_write_b32 a50, v246
  v_accvgpr_write_b32 a51, v247
  v_accvgpr_read_b32 v244, a52
  v_accvgpr_read_b32 v245, a53
  v_accvgpr_read_b32 v246, a54
  v_accvgpr_read_b32 v247, a55
  v_mul_f32 v244, v244, v243
  v_mul_f32 v245, v245, v243
  v_mul_f32 v246, v246, v243
  v_mul_f32 v247, v247, v243
  v_accvgpr_write_b32 a52, v244
  v_accvgpr_write_b32 a53, v245
  v_accvgpr_write_b32 a54, v246
  v_accvgpr_write_b32 a55, v247
  v_accvgpr_read_b32 v244, a56
  v_accvgpr_read_b32 v245, a57
  v_accvgpr_read_b32 v246, a58
  v_accvgpr_read_b32 v247, a59
  v_mul_f32 v244, v244, v243
  v_mul_f32 v245, v245, v243
  v_mul_f32 v246, v246, v243
  v_mul_f32 v247, v247, v243
  v_accvgpr_write_b32 a56, v244
  v_accvgpr_write_b32 a57, v245
  v_accvgpr_write_b32 a58, v246
  v_accvgpr_write_b32 a59, v247
  v_accvgpr_read_b32 v244, a60
  v_accvgpr_read_b32 v245, a61
  v_accvgpr_read_b32 v246, a62
  v_accvgpr_read_b32 v247, a63
  v_mul_f32 v244, v244, v243
  v_mul_f32 v245, v245, v243
  v_mul_f32 v246, v246, v243
  v_mul_f32 v247, v247, v243
  v_accvgpr_write_b32 a60, v244
  v_accvgpr_write_b32 a61, v245
  v_accvgpr_write_b32 a62, v246
  v_accvgpr_write_b32 a63, v247
  v_sub_f32 v168, v168, v241
  v_sub_f32 v169, v169, v241
  v_sub_f32 v170, v170, v241
  v_sub_f32 v171, v171, v241
  v_sub_f32 v172, v172, v241
  v_sub_f32 v173, v173, v241
  v_sub_f32 v174, v174, v241
  v_sub_f32 v175, v175, v241
  v_sub_f32 v184, v184, v241
  v_sub_f32 v185, v185, v241
  v_sub_f32 v186, v186, v241
  v_sub_f32 v187, v187, v241
  v_sub_f32 v188, v188, v241
  v_sub_f32 v189, v189, v241
  v_sub_f32 v190, v190, v241
  v_sub_f32 v191, v191, v241
  v_exp_f32 v32, v184
  v_exp_f32 v33, v185
  v_exp_f32 v34, v186
  v_cvt_pk_bf16_f32 v204, v32, v33
  v_exp_f32 v35, v187
  v_exp_f32 v32, v188
  v_cvt_pk_bf16_f32 v205, v34, v35
  v_exp_f32 v33, v189
  v_exp_f32 v34, v190
  v_cvt_pk_bf16_f32 v206, v32, v33
  v_exp_f32 v35, v191
  s_nop 0
  v_cvt_pk_bf16_f32 v207, v34, v35
  s_nop 1
  v_mfma_f32_16x16x32_bf16 v[60:63], a[224:227], v[204:207], 0
  s_nop 9
  v_mov_b32 v36, v37
  v_add_f32 v38, v39, v60
  s_nop 3
  s_setpc_b64 s[6:7]
Lrare137:
  s_call_b64 s[6:7], Lrh136
  s_branch Lrr138
.section .rodata,"a"
.p2align 6
.amdhsa_kernel adaLN_cond__compressed_kv_cla__mixer_channel_mlp__prompt_kernel
  .amdhsa_next_free_vgpr 512
  .amdhsa_next_free_sgpr 102
  .amdhsa_accum_offset 256
  .amdhsa_group_segment_fixed_size 0
  .amdhsa_kernarg_size 128
  .amdhsa_user_sgpr_count 2
  .amdhsa_user_sgpr_kernarg_segment_ptr 1
  .amdhsa_system_sgpr_workgroup_id_x 1
  .amdhsa_float_denorm_mode_32 3
  .amdhsa_float_denorm_mode_16_64 3
.end_amdhsa_kernel
```
